```python
import torch

def _softmax(x, axis=-1):
    return torch.softmax(x, dim=axis)

def _gelu(x):
    return torch.nn.functional.gelu(x, approximate='tanh')

def _silu(x):
    return torch.nn.functional.silu(x)

def _sigmoid(x):
    return torch.sigmoid(x)

def _layernorm(x, axis=-1, eps=1e-05):
    m = x.mean(dim=axis, keepdim=True)
    v = x.var(dim=axis, keepdim=True, unbiased=False)
    return (x - m) / torch.sqrt(v + eps)

def _scatter_add(tgt, idx, src, axis=0):
    return tgt.clone().index_add_(axis, idx, src)

def _segment_sum(src, seg, n):
    out = torch.zeros((n,) + src.shape[1:], dtype=src.dtype)
    return out.index_add_(0, seg, src)

def _pad(x, pw):
    flat = tuple((v for pair in reversed(pw) for v in pair))
    return torch.nn.functional.pad(x, flat)
kernel_name = 'interleave_layers__memory_aug_recurrent_mem_tr__spectral_gfnet__prompt'

def setup_inputs():

    _w = lambda a: (lambda t: t.to(torch.bfloat16) if t.is_floating_point() else t)(torch.as_tensor(a))

    def _A_setup():
        B, S, Dm = (1, 2048, 640)
        H, Dh = (32, 128)
        M, seg = (8, 32)
        seg = min(seg, S)
        S = S // seg * seg
        return {'x': _w((lambda *s: torch.randn(*s, dtype=torch.bfloat16) * 0.05)(B, S, Dm)), 'mem0': _w((lambda *s: torch.randn(*s, dtype=torch.bfloat16) * 0.2)(B, M, Dm)), 'Wq': _w((lambda *s: torch.randn(*s, dtype=torch.bfloat16) * 1.6)(Dm, H, Dh) * Dm ** (-0.5)), 'Wk': _w((lambda *s: torch.randn(*s, dtype=torch.bfloat16) * 1.6)(Dm, H, Dh) * Dm ** (-0.5)), 'Wv': _w((lambda *s: torch.randn(*s, dtype=torch.bfloat16) * 0.2)(Dm, H, Dh) * Dm ** (-0.5)), 'Wo': _w((lambda *s: torch.randn(*s, dtype=torch.bfloat16) * 0.2)(H, Dh, Dm) * (H * Dh) ** (-0.5)), 'seg_len': seg}
    _A_in = _A_setup()

    def _B_setup():
        B, S, D = (1, 2048, 640)
        Df = D // 2 + 1
        return {'x': _w((lambda *s: torch.randn(*s, dtype=torch.bfloat16) * 0.05)(B, S, D)), 'w_r': _w((lambda *s: torch.randn(*s, dtype=torch.bfloat16) * 0.4)(S, Df) * 0.02), 'w_i': _w((lambda *s: torch.randn(*s, dtype=torch.bfloat16) * 0.4)(S, Df) * 0.02)}
    _B_in = _B_setup()
    return {'A_x': _A_in['x'], 'A_mem0': _A_in['mem0'], 'A_Wq': _A_in['Wq'], 'A_Wk': _A_in['Wk'], 'A_Wv': _A_in['Wv'], 'A_Wo': _A_in['Wo'], 'A_seg_len': _A_in['seg_len'], 'B_x': _B_in['x'], 'B_w_r': _B_in['w_r'], 'B_w_i': _B_in['w_i']}

def reference(A_x, A_mem0, A_Wq, A_Wk, A_Wv, A_Wo, A_seg_len, B_x, B_w_r, B_w_i):

    def _A_ref(x, mem0, Wq, Wk, Wv, Wo, seg_len):
        B, S, Dm = x.shape
        H, Dh = (Wq.shape[1], Wq.shape[2])
        M = mem0.shape[1]
        scale = Dh ** (-0.5)
        n_seg = S // seg_len
        L = M + seg_len
        idx = torch.arange(L)
        mask = (idx[:, None] < M) | (idx[:, None] >= idx[None, :])
        mem = mem0
        outs = []
        for s in range(n_seg):
            xs = x[:, s * seg_len:(s + 1) * seg_len, :].clone()
            h = torch.concatenate([mem, xs], axis=1)
            q = torch.einsum('btd,dhe->bhte', h, Wq)
            k = torch.einsum('btd,dhe->bhte', h, Wk)
            v = torch.einsum('btd,dhe->bhte', h, Wv)
            scores = torch.einsum('bhqe,bhke->bhqk', q, k) * scale
            scores = torch.where(mask[None, None], scores, -1000000000.0)
            p = _softmax(scores, axis=-1)
            o = torch.einsum('bhqk,bhke->bhqe', p, v)
            o = torch.einsum('bhte,hed->btd', o, Wo)
            mem = o[:, :M, :].clone()
            outs.append(o[:, M:, :])
        return torch.concatenate(outs, axis=1)

    def _B_ref(x, w_r, w_i):
        B, S, D = x.shape
        X = (lambda x, axes=(-2, -1): torch.fft.rfft2(x.float(), dim=axes))(x, axes=(-2, -1))
        W = w_r + 1j * w_i
        X = X * W
        y = (lambda x, s, axes=(-2, -1): torch.fft.irfft2(x, s=s, dim=axes).to(torch.bfloat16))(X, (S, D), axes=(-2, -1))
        return y
    x = A_x
    x = x + _A_ref(_layernorm(x, axis=-1), A_mem0, A_Wq, A_Wk, A_Wv, A_Wo, A_seg_len)
    x = x + _B_ref(_layernorm(x, axis=-1), B_w_r, B_w_i)
    x = x + _A_ref(_layernorm(x, axis=-1), A_mem0, A_Wq, A_Wk, A_Wv, A_Wo, A_seg_len)
    x = x + _B_ref(_layernorm(x, axis=-1), B_w_r, B_w_i)
    return x
```

```asm
; @launch kernel=prep_kernel grid=(1739,1,1) block=(256,1,1) lds=2048
; @launch kernel=main_kernel grid=(256,1,1) block=(256,1,1) lds=163840
.amdgcn_target "amdgcn-amd-amdhsa--gfx950"
.text
.globl prep_kernel
.p2align 8
.type prep_kernel,@function
prep_kernel:
    s_cmp_ge_u32 s2, 1739
    s_cbranch_scc1 Lp_end
    s_load_dwordx2 s[8:9], s[0:1], 96
    s_load_dwordx2 s[12:13], s[0:1], 16
    s_load_dwordx2 s[16:17], s[0:1], 24
    s_load_dwordx2 s[20:21], s[0:1], 32
    s_load_dwordx2 s[24:25], s[0:1], 40
    s_load_dwordx2 s[28:29], s[0:1], 8
    v_and_b32 v1, 63, v0
    v_lshrrev_b32 v2, 6, v0
    v_lshrrev_b32 v3, 4, v1
    v_readfirstlane_b32 s33, v2
    v_and_b32 v4, 15, v1
    v_lshlrev_b32 v5, 4, v1
    s_waitcnt lgkmcnt(0)
    s_and_b32 s9, s9, 0xffff
    s_mov_b32 s10, 268435456
    s_mov_b32 s11, 0x00020000
    s_and_b32 s13, s13, 0xffff
    s_mov_b32 s14, 5242880
    s_mov_b32 s15, 0x00020000
    s_and_b32 s17, s17, 0xffff
    s_mov_b32 s18, 5242880
    s_mov_b32 s19, 0x00020000
    s_and_b32 s21, s21, 0xffff
    s_mov_b32 s22, 5242880
    s_mov_b32 s23, 0x00020000
    s_and_b32 s25, s25, 0xffff
    s_mov_b32 s26, 5242880
    s_mov_b32 s27, 0x00020000
    s_and_b32 s29, s29, 0xffff
    s_mov_b32 s30, 10240
    s_mov_b32 s31, 0x00020000
    s_cmp_lt_u32 s2, 320
    s_cbranch_scc1 Lp_b
    s_sub_u32 s34, s2, 320
    s_cmp_lt_u32 s34, 480
    s_cbranch_scc1 Lp_pack
    s_sub_u32 s34, s34, 480
    s_cmp_lt_u32 s34, 26
    s_cbranch_scc1 Lp_fill
    s_sub_u32 s34, s34, 26
    s_cmp_lt_u32 s34, 1
    s_cbranch_scc1 Lp_m0
    s_sub_u32 s34, s34, 1
    s_cmp_lt_u32 s34, 128
    s_cbranch_scc1 Lp_wo
    s_sub_u32 s34, s34, 128
    s_cmp_ge_u32 s34, 400
    s_cbranch_scc1 Lp_wt
    s_cmp_ge_u32 s34, 200
    s_cselect_b32 s35, 1, 0
    s_mul_i32 s36, s35, 200
    s_sub_u32 s36, s34, s36
    s_lshl_b32 s36, s36, 2
    s_add_u32 s36, s36, s33
    s_mul_hi_u32 s37, s36, 0xccccccd
    s_mul_i32 s38, s37, 20
    s_sub_u32 s38, s36, s38
    s_lshl_b32 s37, s37, 4
    v_add_u32 v6, s37, v4
    s_lshl_b32 s38, s38, 5
    v_lshlrev_b32 v7, 3, v3
    v_add_u32 v7, s38, v7
    s_mov_b32 s39, 0x666667
    s_movk_i32 s40, 640
    s_cmp_eq_u32 s35, 1
    s_cbranch_scc1 Lp_t2
    v_cmp_lt_u32 vcc, 320, v6
    v_subrev_u32 v8, 320, v6
    s_nop 1
    v_cndmask_b32 v8, v6, v8, vcc
    v_mov_b32 v9, 0
    v_mov_b32 v10, 0x3e800000
    v_cndmask_b32 v9, v9, v10, vcc
    v_add_u32 v11, 0, v7
    v_mul_u32_u24 v11, v11, v8
    v_mul_hi_u32 v12, v11, s39
    v_mul_lo_u32 v12, v12, s40
    v_sub_u32 v11, v11, v12
    v_cvt_f32_u32 v11, v11
    v_mov_b32 v12, v9
    v_fmac_f32 v12, 0x3acccccd, v11
    v_cos_f32 v16, v12
    v_add_u32 v11, 1, v7
    v_mul_u32_u24 v11, v11, v8
    v_mul_hi_u32 v12, v11, s39
    v_mul_lo_u32 v12, v12, s40
    v_sub_u32 v11, v11, v12
    v_cvt_f32_u32 v11, v11
    v_mov_b32 v12, v9
    v_fmac_f32 v12, 0x3acccccd, v11
    v_cos_f32 v17, v12
    v_add_u32 v11, 2, v7
    v_mul_u32_u24 v11, v11, v8
    v_mul_hi_u32 v12, v11, s39
    v_mul_lo_u32 v12, v12, s40
    v_sub_u32 v11, v11, v12
    v_cvt_f32_u32 v11, v11
    v_mov_b32 v12, v9
    v_fmac_f32 v12, 0x3acccccd, v11
    v_cos_f32 v18, v12
    v_add_u32 v11, 3, v7
    v_mul_u32_u24 v11, v11, v8
    v_mul_hi_u32 v12, v11, s39
    v_mul_lo_u32 v12, v12, s40
    v_sub_u32 v11, v11, v12
    v_cvt_f32_u32 v11, v11
    v_mov_b32 v12, v9
    v_fmac_f32 v12, 0x3acccccd, v11
    v_cos_f32 v19, v12
    v_add_u32 v11, 4, v7
    v_mul_u32_u24 v11, v11, v8
    v_mul_hi_u32 v12, v11, s39
    v_mul_lo_u32 v12, v12, s40
    v_sub_u32 v11, v11, v12
    v_cvt_f32_u32 v11, v11
    v_mov_b32 v12, v9
    v_fmac_f32 v12, 0x3acccccd, v11
    v_cos_f32 v20, v12
    v_add_u32 v11, 5, v7
    v_mul_u32_u24 v11, v11, v8
    v_mul_hi_u32 v12, v11, s39
    v_mul_lo_u32 v12, v12, s40
    v_sub_u32 v11, v11, v12
    v_cvt_f32_u32 v11, v11
    v_mov_b32 v12, v9
    v_fmac_f32 v12, 0x3acccccd, v11
    v_cos_f32 v21, v12
    v_add_u32 v11, 6, v7
    v_mul_u32_u24 v11, v11, v8
    v_mul_hi_u32 v12, v11, s39
    v_mul_lo_u32 v12, v12, s40
    v_sub_u32 v11, v11, v12
    v_cvt_f32_u32 v11, v11
    v_mov_b32 v12, v9
    v_fmac_f32 v12, 0x3acccccd, v11
    v_cos_f32 v22, v12
    v_add_u32 v11, 7, v7
    v_mul_u32_u24 v11, v11, v8
    v_mul_hi_u32 v12, v11, s39
    v_mul_lo_u32 v12, v12, s40
    v_sub_u32 v11, v11, v12
    v_cvt_f32_u32 v11, v11
    v_mov_b32 v12, v9
    v_fmac_f32 v12, 0x3acccccd, v11
    v_cos_f32 v23, v12
    s_nop 0
    v_cvt_pk_f16_f32 v24, v16, v17
    v_cvt_pk_f16_f32 v25, v18, v19
    v_cvt_pk_f16_f32 v26, v20, v21
    v_cvt_pk_f16_f32 v27, v22, v23
    s_lshl_b32 s36, s36, 10
    s_add_u32 s36, s36, 146800640
    buffer_store_dwordx4 v[24:27], v5, s[8:11], s36 offen
    s_branch Lp_end
Lp_t2:
    v_lshrrev_b32 v8, 1, v7
    v_cmp_eq_u32 vcc, 0, v7
    v_add_u32 v11, 0, v8
    v_mov_b32 v13, 0x00000000
    v_mov_b32 v14, 0x35cccccd
    v_mov_b32 v15, 0x354ccccd
    v_cndmask_b32 v14, v14, v15, vcc
    v_mul_u32_u24 v11, v11, v6
    v_mul_hi_u32 v12, v11, s39
    v_mul_lo_u32 v12, v12, s40
    v_sub_u32 v11, v11, v12
    v_cvt_f32_u32 v11, v11
    v_fmac_f32 v13, 0x3acccccd, v11
    v_cos_f32 v13, v13
    s_nop 0
    v_mul_f32 v16, v13, v14
    v_add_u32 v11, 0, v8
    v_mov_b32 v13, 0x3e800000
    v_mov_b32 v14, 0x35cccccd
    v_mov_b32 v15, 0x354ccccd
    v_cndmask_b32 v14, v14, v15, vcc
    v_mov_b32 v15, 320
    v_cndmask_b32 v11, v11, v15, vcc
    v_mov_b32 v15, 0
    v_cndmask_b32 v13, v13, v15, vcc
    v_mul_u32_u24 v11, v11, v6
    v_mul_hi_u32 v12, v11, s39
    v_mul_lo_u32 v12, v12, s40
    v_sub_u32 v11, v11, v12
    v_cvt_f32_u32 v11, v11
    v_fmac_f32 v13, 0x3acccccd, v11
    v_cos_f32 v13, v13
    s_nop 0
    v_mul_f32 v17, v13, v14
    v_add_u32 v11, 1, v8
    v_mov_b32 v13, 0x00000000
    v_mov_b32 v14, 0x35cccccd
    v_mul_u32_u24 v11, v11, v6
    v_mul_hi_u32 v12, v11, s39
    v_mul_lo_u32 v12, v12, s40
    v_sub_u32 v11, v11, v12
    v_cvt_f32_u32 v11, v11
    v_fmac_f32 v13, 0x3acccccd, v11
    v_cos_f32 v13, v13
    s_nop 0
    v_mul_f32 v18, v13, v14
    v_add_u32 v11, 1, v8
    v_mov_b32 v13, 0x3e800000
    v_mov_b32 v14, 0x35cccccd
    v_mul_u32_u24 v11, v11, v6
    v_mul_hi_u32 v12, v11, s39
    v_mul_lo_u32 v12, v12, s40
    v_sub_u32 v11, v11, v12
    v_cvt_f32_u32 v11, v11
    v_fmac_f32 v13, 0x3acccccd, v11
    v_cos_f32 v13, v13
    s_nop 0
    v_mul_f32 v19, v13, v14
    v_add_u32 v11, 2, v8
    v_mov_b32 v13, 0x00000000
    v_mov_b32 v14, 0x35cccccd
    v_mul_u32_u24 v11, v11, v6
    v_mul_hi_u32 v12, v11, s39
    v_mul_lo_u32 v12, v12, s40
    v_sub_u32 v11, v11, v12
    v_cvt_f32_u32 v11, v11
    v_fmac_f32 v13, 0x3acccccd, v11
    v_cos_f32 v13, v13
    s_nop 0
    v_mul_f32 v20, v13, v14
    v_add_u32 v11, 2, v8
    v_mov_b32 v13, 0x3e800000
    v_mov_b32 v14, 0x35cccccd
    v_mul_u32_u24 v11, v11, v6
    v_mul_hi_u32 v12, v11, s39
    v_mul_lo_u32 v12, v12, s40
    v_sub_u32 v11, v11, v12
    v_cvt_f32_u32 v11, v11
    v_fmac_f32 v13, 0x3acccccd, v11
    v_cos_f32 v13, v13
    s_nop 0
    v_mul_f32 v21, v13, v14
    v_add_u32 v11, 3, v8
    v_mov_b32 v13, 0x00000000
    v_mov_b32 v14, 0x35cccccd
    v_mul_u32_u24 v11, v11, v6
    v_mul_hi_u32 v12, v11, s39
    v_mul_lo_u32 v12, v12, s40
    v_sub_u32 v11, v11, v12
    v_cvt_f32_u32 v11, v11
    v_fmac_f32 v13, 0x3acccccd, v11
    v_cos_f32 v13, v13
    s_nop 0
    v_mul_f32 v22, v13, v14
    v_add_u32 v11, 3, v8
    v_mov_b32 v13, 0x3e800000
    v_mov_b32 v14, 0x35cccccd
    v_mul_u32_u24 v11, v11, v6
    v_mul_hi_u32 v12, v11, s39
    v_mul_lo_u32 v12, v12, s40
    v_sub_u32 v11, v11, v12
    v_cvt_f32_u32 v11, v11
    v_fmac_f32 v13, 0x3acccccd, v11
    v_cos_f32 v13, v13
    s_nop 0
    v_mul_f32 v23, v13, v14
    v_cvt_pk_bf16_f32 v24, v16, v17
    v_cvt_pk_bf16_f32 v25, v18, v19
    v_cvt_pk_bf16_f32 v26, v20, v21
    v_cvt_pk_bf16_f32 v27, v22, v23
    s_lshl_b32 s36, s36, 10
    s_add_u32 s36, s36, 147849216
    buffer_store_dwordx4 v[24:27], v5, s[8:11], s36 offen
    s_branch Lp_end
Lp_wt:
    s_load_dwordx2 s[44:45], s[0:1], 64
    s_load_dwordx2 s[48:49], s[0:1], 72
    s_sub_u32 s35, s34, 400
    s_lshl_b32 s35, s35, 2
    s_add_u32 s35, s35, s33
    s_lshr_b32 s36, s35, 8
    s_and_b32 s37, s35, 255
    s_lshl_b32 s36, s36, 6
    v_add_u32 v6, s36, v1
    s_lshr_b32 s38, s37, 5
    s_bfe_u32 s39, s37, 0x30002
    s_lshl_b32 s39, s39, 3
    s_add_u32 s38, s38, s39
    s_and_b32 s39, s37, 3
    s_lshl_b32 s39, s39, 7
    s_add_u32 s38, s38, s39
    s_mul_i32 s38, s38, 642
    v_lshlrev_b32 v7, 1, v6
    s_waitcnt lgkmcnt(0)
    s_and_b32 s45, s45, 0xffff
    s_mov_b32 s46, 1314816
    s_mov_b32 s47, 0x00020000
    s_and_b32 s49, s49, 0xffff
    s_mov_b32 s50, 1314816
    s_mov_b32 s51, 0x00020000
    v_cmp_gt_u32 vcc, 321, v6
    s_and_saveexec_b64 s[52:53], vcc
    s_cbranch_execz Lp_end
    s_add_u32 s39, s38, 0
    buffer_load_ushort v8, v7, s[44:47], s39 offen
    buffer_load_ushort v16, v7, s[48:51], s39 offen
    s_add_u32 s39, s38, 328704
    buffer_load_ushort v9, v7, s[44:47], s39 offen
    buffer_load_ushort v17, v7, s[48:51], s39 offen
    s_add_u32 s39, s38, 657408
    buffer_load_ushort v10, v7, s[44:47], s39 offen
    buffer_load_ushort v18, v7, s[48:51], s39 offen
    s_add_u32 s39, s38, 986112
    buffer_load_ushort v11, v7, s[44:47], s39 offen
    buffer_load_ushort v19, v7, s[48:51], s39 offen
    s_add_u32 s39, s38, 41088
    buffer_load_ushort v12, v7, s[44:47], s39 offen
    buffer_load_ushort v20, v7, s[48:51], s39 offen
    s_add_u32 s39, s38, 369792
    buffer_load_ushort v13, v7, s[44:47], s39 offen
    buffer_load_ushort v21, v7, s[48:51], s39 offen
    s_add_u32 s39, s38, 698496
    buffer_load_ushort v14, v7, s[44:47], s39 offen
    buffer_load_ushort v22, v7, s[48:51], s39 offen
    s_add_u32 s39, s38, 1027200
    buffer_load_ushort v15, v7, s[44:47], s39 offen
    buffer_load_ushort v23, v7, s[48:51], s39 offen
    v_lshlrev_b32 v7, 13, v6
    s_lshl_b32 s37, s37, 5
    s_add_u32 s37, s37, 148897792
    s_waitcnt vmcnt(0)
    v_lshl_or_b32 v8, v16, 16, v8
    v_lshl_or_b32 v9, v17, 16, v9
    v_lshl_or_b32 v10, v18, 16, v10
    v_lshl_or_b32 v11, v19, 16, v11
    v_lshl_or_b32 v12, v20, 16, v12
    v_lshl_or_b32 v13, v21, 16, v13
    v_lshl_or_b32 v14, v22, 16, v14
    v_lshl_or_b32 v15, v23, 16, v15
    buffer_store_dwordx4 v[8:11], v7, s[8:11], s37 offen
    buffer_store_dwordx4 v[12:15], v7, s[8:11], s37 offen offset:16
    s_branch Lp_end
Lp_m0:
    v_mov_b32 v8, 0
    v_mov_b32 v9, 0
    v_mov_b32 v10, 0
    v_mov_b32 v11, 0
    v_lshlrev_b32 v6, 4, v0
    s_mov_b32 s37, 167837696
    buffer_store_dwordx4 v[8:11], v6, s[8:11], s37 offen
    s_mov_b32 s37, 167841792
    buffer_store_dwordx4 v[8:11], v6, s[8:11], s37 offen
    s_mov_b32 s37, 167845888
    buffer_store_dwordx4 v[8:11], v6, s[8:11], s37 offen
    s_mov_b32 s37, 167849984
    buffer_store_dwordx4 v[8:11], v6, s[8:11], s37 offen
    s_mov_b32 s37, 167854080
    buffer_store_dwordx4 v[8:11], v6, s[8:11], s37 offen
    s_mov_b32 s37, 167858176
    buffer_store_dwordx4 v[8:11], v6, s[8:11], s37 offen
    s_mov_b32 s37, 167862272
    buffer_store_dwordx4 v[8:11], v6, s[8:11], s37 offen
    s_mov_b32 s37, 167866368
    buffer_store_dwordx4 v[8:11], v6, s[8:11], s37 offen
    s_mov_b32 s37, 167870464
    buffer_store_dwordx4 v[8:11], v6, s[8:11], s37 offen
    s_mov_b32 s37, 167874560
    buffer_store_dwordx4 v[8:11], v6, s[8:11], s37 offen
    s_mov_b32 s37, 167878656
    buffer_store_dwordx4 v[8:11], v6, s[8:11], s37 offen
    s_mov_b32 s37, 167882752
    buffer_store_dwordx4 v[8:11], v6, s[8:11], s37 offen
    s_mov_b32 s37, 167886848
    buffer_store_dwordx4 v[8:11], v6, s[8:11], s37 offen
    s_mov_b32 s37, 167890944
    buffer_store_dwordx4 v[8:11], v6, s[8:11], s37 offen
    s_mov_b32 s37, 167895040
    buffer_store_dwordx4 v[8:11], v6, s[8:11], s37 offen
    s_mov_b32 s37, 167899136
    buffer_store_dwordx4 v[8:11], v6, s[8:11], s37 offen
    s_mov_b32 s37, 167903232
    buffer_store_dwordx4 v[8:11], v6, s[8:11], s37 offen
    s_mov_b32 s37, 167907328
    buffer_store_dwordx4 v[8:11], v6, s[8:11], s37 offen
    s_mov_b32 s37, 167911424
    buffer_store_dwordx4 v[8:11], v6, s[8:11], s37 offen
    s_mov_b32 s37, 167915520
    buffer_store_dwordx4 v[8:11], v6, s[8:11], s37 offen
    s_waitcnt vmcnt(0)
    v_and_b32 v6, 7, v1
    v_mul_u32_u24 v6, 1280, v6
    v_lshlrev_b32 v7, 5, v3
    v_add_u32 v6, v6, v7
    v_bfe_u32 v7, v1, 3, 1
    v_lshlrev_b32 v7, 2, v7
    v_add_u32 v6, v6, v7
    s_lshl_b32 s35, s33, 7
    v_add_u32 v6, s35, v6
    v_and_b32 v7, 0x200, v5
    v_bfe_u32 v12, v5, 6, 1
    v_lshl_or_b32 v7, v12, 8, v7
    v_bfe_u32 v12, v5, 4, 1
    v_lshl_or_b32 v7, v12, 7, v7
    v_bfe_u32 v12, v5, 5, 1
    v_lshl_or_b32 v7, v12, 6, v7
    v_bfe_u32 v12, v5, 8, 1
    v_lshl_or_b32 v7, v12, 5, v7
    v_bfe_u32 v12, v5, 7, 1
    v_lshl_or_b32 v7, v12, 4, v7
    s_lshl_b32 s36, s33, 10
    v_add_u32 v7, s36, v7
    buffer_load_dword v8, v6, s[28:31], 0 offen offset:0
    buffer_load_dword v9, v6, s[28:31], 0 offen offset:8
    buffer_load_dword v10, v6, s[28:31], 0 offen offset:16
    buffer_load_dword v11, v6, s[28:31], 0 offen offset:24
    s_waitcnt vmcnt(0)
    v_min_u32 v8, -2, v8
    v_min_u32 v9, -2, v9
    v_min_u32 v10, -2, v10
    v_min_u32 v11, -2, v11
    s_mov_b32 s37, 167772160
    buffer_store_dwordx4 v[8:11], v7, s[8:11], s37 offen
    s_waitcnt vmcnt(0)
    buffer_load_dword v8, v6, s[28:31], 0 offen offset:512
    buffer_load_dword v9, v6, s[28:31], 0 offen offset:520
    buffer_load_dword v10, v6, s[28:31], 0 offen offset:528
    buffer_load_dword v11, v6, s[28:31], 0 offen offset:536
    s_waitcnt vmcnt(0)
    v_min_u32 v8, -2, v8
    v_min_u32 v9, -2, v9
    v_min_u32 v10, -2, v10
    v_min_u32 v11, -2, v11
    s_mov_b32 s37, 167776256
    buffer_store_dwordx4 v[8:11], v7, s[8:11], s37 offen
    s_waitcnt vmcnt(0)
    s_cmp_ge_u32 s33, 2
    s_cbranch_scc1 Lp_end
    buffer_load_dword v8, v6, s[28:31], 0 offen offset:1024
    buffer_load_dword v9, v6, s[28:31], 0 offen offset:1032
    buffer_load_dword v10, v6, s[28:31], 0 offen offset:1040
    buffer_load_dword v11, v6, s[28:31], 0 offen offset:1048
    s_waitcnt vmcnt(0)
    v_min_u32 v8, -2, v8
    v_min_u32 v9, -2, v9
    v_min_u32 v10, -2, v10
    v_min_u32 v11, -2, v11
    s_mov_b32 s37, 167780352
    buffer_store_dwordx4 v[8:11], v7, s[8:11], s37 offen
    s_waitcnt vmcnt(0)
    s_branch Lp_end
Lp_fill:
    v_mov_b32 v8, -1
    v_mov_b32 v9, -1
    v_mov_b32 v10, -1
    v_mov_b32 v11, -1
    v_lshlrev_b32 v6, 4, v0
    s_lshl_b32 s35, s34, 16
    s_add_u32 s35, s35, 171966464
    buffer_store_dwordx4 v[8:11], v6, s[8:11], s35 offen
    s_add_u32 s35, s35, 4096
    buffer_store_dwordx4 v[8:11], v6, s[8:11], s35 offen
    s_add_u32 s35, s35, 4096
    buffer_store_dwordx4 v[8:11], v6, s[8:11], s35 offen
    s_add_u32 s35, s35, 4096
    buffer_store_dwordx4 v[8:11], v6, s[8:11], s35 offen
    s_add_u32 s35, s35, 4096
    buffer_store_dwordx4 v[8:11], v6, s[8:11], s35 offen
    s_add_u32 s35, s35, 4096
    buffer_store_dwordx4 v[8:11], v6, s[8:11], s35 offen
    s_add_u32 s35, s35, 4096
    buffer_store_dwordx4 v[8:11], v6, s[8:11], s35 offen
    s_add_u32 s35, s35, 4096
    buffer_store_dwordx4 v[8:11], v6, s[8:11], s35 offen
    s_add_u32 s35, s35, 4096
    buffer_store_dwordx4 v[8:11], v6, s[8:11], s35 offen
    s_add_u32 s35, s35, 4096
    buffer_store_dwordx4 v[8:11], v6, s[8:11], s35 offen
    s_add_u32 s35, s35, 4096
    buffer_store_dwordx4 v[8:11], v6, s[8:11], s35 offen
    s_add_u32 s35, s35, 4096
    buffer_store_dwordx4 v[8:11], v6, s[8:11], s35 offen
    s_add_u32 s35, s35, 4096
    buffer_store_dwordx4 v[8:11], v6, s[8:11], s35 offen
    s_add_u32 s35, s35, 4096
    buffer_store_dwordx4 v[8:11], v6, s[8:11], s35 offen
    s_add_u32 s35, s35, 4096
    buffer_store_dwordx4 v[8:11], v6, s[8:11], s35 offen
    s_add_u32 s35, s35, 4096
    buffer_store_dwordx4 v[8:11], v6, s[8:11], s35 offen
    s_add_u32 s35, s35, 4096
    s_branch Lp_end
Lp_pack:
    s_lshl_b32 s35, s34, 2
    s_add_u32 s35, s35, s33
    s_and_b32 s37, s35, 31
    s_lshr_b32 s35, s35, 5
    s_mul_hi_u32 s38, s35, 0xccccccd
    s_mul_i32 s41, s38, 20
    s_sub_u32 s35, s35, s41
    v_lshlrev_b32 v6, 16, v3
    v_lshl_add_u32 v6, v4, 4, v6
    s_lshl_b32 s40, s35, 18
    s_lshl_b32 s41, s37, 8
    s_add_u32 s40, s40, s41
    s_mul_i32 s42, s37, 491520
    s_mul_i32 s41, s38, 40960
    s_add_u32 s42, s42, s41
    s_lshl_b32 s41, s35, 10
    s_add_u32 s42, s42, s41
    s_add_u32 s42, s42, 0
    s_cmp_eq_u32 s38, 1
    s_cbranch_scc1 Lp_packk
    s_cmp_eq_u32 s38, 2
    s_cbranch_scc1 Lp_packv
    s_add_u32 s43, s40, 0
    buffer_load_dwordx4 v[16:19], v6, s[12:15], s43 offen
    s_add_u32 s43, s40, 8192
    buffer_load_dwordx4 v[20:23], v6, s[12:15], s43 offen
    s_add_u32 s43, s40, 16384
    buffer_load_dwordx4 v[24:27], v6, s[12:15], s43 offen
    s_add_u32 s43, s40, 24576
    buffer_load_dwordx4 v[28:31], v6, s[12:15], s43 offen
    s_add_u32 s43, s40, 32768
    buffer_load_dwordx4 v[32:35], v6, s[12:15], s43 offen
    s_add_u32 s43, s40, 40960
    buffer_load_dwordx4 v[36:39], v6, s[12:15], s43 offen
    s_add_u32 s43, s40, 49152
    buffer_load_dwordx4 v[40:43], v6, s[12:15], s43 offen
    s_add_u32 s43, s40, 57344
    buffer_load_dwordx4 v[44:47], v6, s[12:15], s43 offen
    s_branch Lp_pack2
Lp_packk:
    s_add_u32 s43, s40, 0
    buffer_load_dwordx4 v[16:19], v6, s[16:19], s43 offen
    s_add_u32 s43, s40, 8192
    buffer_load_dwordx4 v[20:23], v6, s[16:19], s43 offen
    s_add_u32 s43, s40, 16384
    buffer_load_dwordx4 v[24:27], v6, s[16:19], s43 offen
    s_add_u32 s43, s40, 24576
    buffer_load_dwordx4 v[28:31], v6, s[16:19], s43 offen
    s_add_u32 s43, s40, 32768
    buffer_load_dwordx4 v[32:35], v6, s[16:19], s43 offen
    s_add_u32 s43, s40, 40960
    buffer_load_dwordx4 v[36:39], v6, s[16:19], s43 offen
    s_add_u32 s43, s40, 49152
    buffer_load_dwordx4 v[40:43], v6, s[16:19], s43 offen
    s_add_u32 s43, s40, 57344
    buffer_load_dwordx4 v[44:47], v6, s[16:19], s43 offen
    s_branch Lp_pack2
Lp_packv:
    s_add_u32 s43, s40, 0
    buffer_load_dwordx4 v[16:19], v6, s[20:23], s43 offen
    s_add_u32 s43, s40, 8192
    buffer_load_dwordx4 v[20:23], v6, s[20:23], s43 offen
    s_add_u32 s43, s40, 16384
    buffer_load_dwordx4 v[24:27], v6, s[20:23], s43 offen
    s_add_u32 s43, s40, 24576
    buffer_load_dwordx4 v[28:31], v6, s[20:23], s43 offen
    s_add_u32 s43, s40, 32768
    buffer_load_dwordx4 v[32:35], v6, s[20:23], s43 offen
    s_add_u32 s43, s40, 40960
    buffer_load_dwordx4 v[36:39], v6, s[20:23], s43 offen
    s_add_u32 s43, s40, 49152
    buffer_load_dwordx4 v[40:43], v6, s[20:23], s43 offen
    s_add_u32 s43, s40, 57344
    buffer_load_dwordx4 v[44:47], v6, s[20:23], s43 offen
Lp_pack2:
    s_mov_b32 s44, 0x05040100
    s_mov_b32 s45, 0x07060302
    s_waitcnt vmcnt(0)
    v_perm_b32 v48, v20, v16, s44
    v_perm_b32 v49, v28, v24, s44
    v_perm_b32 v50, v36, v32, s44
    v_perm_b32 v51, v44, v40, s44
    v_perm_b32 v52, v20, v16, s45
    v_perm_b32 v53, v28, v24, s45
    v_perm_b32 v54, v36, v32, s45
    v_perm_b32 v55, v44, v40, s45
    v_perm_b32 v56, v21, v17, s44
    v_perm_b32 v57, v29, v25, s44
    v_perm_b32 v58, v37, v33, s44
    v_perm_b32 v59, v45, v41, s44
    v_perm_b32 v60, v21, v17, s45
    v_perm_b32 v61, v29, v25, s45
    v_perm_b32 v62, v37, v33, s45
    v_perm_b32 v63, v45, v41, s45
    v_perm_b32 v64, v22, v18, s44
    v_perm_b32 v65, v30, v26, s44
    v_perm_b32 v66, v38, v34, s44
    v_perm_b32 v67, v46, v42, s44
    v_perm_b32 v68, v22, v18, s45
    v_perm_b32 v69, v30, v26, s45
    v_perm_b32 v70, v38, v34, s45
    v_perm_b32 v71, v46, v42, s45
    v_perm_b32 v72, v23, v19, s44
    v_perm_b32 v73, v31, v27, s44
    v_perm_b32 v74, v39, v35, s44
    v_perm_b32 v75, v47, v43, s44
    v_perm_b32 v76, v23, v19, s45
    v_perm_b32 v77, v31, v27, s45
    v_perm_b32 v78, v39, v35, s45
    v_perm_b32 v79, v47, v43, s45
    s_add_u32 s43, s42, 0
    buffer_store_dwordx4 v[48:51], v5, s[8:11], s43 offen
    s_add_u32 s43, s42, 20480
    buffer_store_dwordx4 v[52:55], v5, s[8:11], s43 offen
    s_add_u32 s43, s42, 122880
    buffer_store_dwordx4 v[56:59], v5, s[8:11], s43 offen
    s_add_u32 s43, s42, 143360
    buffer_store_dwordx4 v[60:63], v5, s[8:11], s43 offen
    s_add_u32 s43, s42, 245760
    buffer_store_dwordx4 v[64:67], v5, s[8:11], s43 offen
    s_add_u32 s43, s42, 266240
    buffer_store_dwordx4 v[68:71], v5, s[8:11], s43 offen
    s_add_u32 s43, s42, 368640
    buffer_store_dwordx4 v[72:75], v5, s[8:11], s43 offen
    s_add_u32 s43, s42, 389120
    buffer_store_dwordx4 v[76:79], v5, s[8:11], s43 offen
    s_branch Lp_end
Lp_wo:
    s_load_dwordx2 s[44:45], s[0:1], 0
    s_waitcnt lgkmcnt(0)
    s_and_b32 s45, s45, 0xffff
    s_mov_b32 s46, 2621440
    s_mov_b32 s47, 0x00020000
    v_mul_u32_u24 v6, 1280, v4
    v_lshl_add_u32 v6, v3, 4, v6
    s_mul_i32 s36, s34, 20480
    s_mul_i32 s35, s33, 320
    s_add_u32 s36, s36, s35
    buffer_load_dwordx4 v[8:11], v6, s[44:47], s36 offen offset:0
    buffer_load_dwordx4 v[12:15], v6, s[44:47], s36 offen offset:64
    buffer_load_dwordx4 v[16:19], v6, s[44:47], s36 offen offset:128
    buffer_load_dwordx4 v[20:23], v6, s[44:47], s36 offen offset:192
    buffer_load_dwordx4 v[24:27], v6, s[44:47], s36 offen offset:256
    s_waitcnt vmcnt(4)
    v_lshlrev_b32 v32, 16, v8
    v_and_b32 v33, 0xffff0000, v8
    v_lshlrev_b32 v34, 16, v9
    v_and_b32 v35, 0xffff0000, v9
    v_lshlrev_b32 v36, 16, v10
    v_and_b32 v37, 0xffff0000, v10
    v_lshlrev_b32 v38, 16, v11
    v_and_b32 v39, 0xffff0000, v11
    s_waitcnt vmcnt(3)
    v_lshlrev_b32 v40, 16, v12
    v_and_b32 v41, 0xffff0000, v12
    v_lshlrev_b32 v42, 16, v13
    v_and_b32 v43, 0xffff0000, v13
    v_lshlrev_b32 v44, 16, v14
    v_and_b32 v45, 0xffff0000, v14
    v_lshlrev_b32 v46, 16, v15
    v_and_b32 v47, 0xffff0000, v15
    s_waitcnt vmcnt(2)
    v_lshlrev_b32 v48, 16, v16
    v_and_b32 v49, 0xffff0000, v16
    v_lshlrev_b32 v50, 16, v17
    v_and_b32 v51, 0xffff0000, v17
    v_lshlrev_b32 v52, 16, v18
    v_and_b32 v53, 0xffff0000, v18
    v_lshlrev_b32 v54, 16, v19
    v_and_b32 v55, 0xffff0000, v19
    s_waitcnt vmcnt(1)
    v_lshlrev_b32 v56, 16, v20
    v_and_b32 v57, 0xffff0000, v20
    v_lshlrev_b32 v58, 16, v21
    v_and_b32 v59, 0xffff0000, v21
    v_lshlrev_b32 v60, 16, v22
    v_and_b32 v61, 0xffff0000, v22
    v_lshlrev_b32 v62, 16, v23
    v_and_b32 v63, 0xffff0000, v23
    s_waitcnt vmcnt(0)
    v_lshlrev_b32 v64, 16, v24
    v_and_b32 v65, 0xffff0000, v24
    v_lshlrev_b32 v66, 16, v25
    v_and_b32 v67, 0xffff0000, v25
    v_lshlrev_b32 v68, 16, v26
    v_and_b32 v69, 0xffff0000, v26
    v_lshlrev_b32 v70, 16, v27
    v_and_b32 v71, 0xffff0000, v27
    v_add_f32 v72, v32, v33
    v_add_f32 v72, v72, v34
    v_add_f32 v72, v72, v35
    v_add_f32 v72, v72, v36
    v_add_f32 v72, v72, v37
    v_add_f32 v72, v72, v38
    v_add_f32 v72, v72, v39
    v_add_f32 v72, v72, v40
    v_add_f32 v72, v72, v41
    v_add_f32 v72, v72, v42
    v_add_f32 v72, v72, v43
    v_add_f32 v72, v72, v44
    v_add_f32 v72, v72, v45
    v_add_f32 v72, v72, v46
    v_add_f32 v72, v72, v47
    v_add_f32 v72, v72, v48
    v_add_f32 v72, v72, v49
    v_add_f32 v72, v72, v50
    v_add_f32 v72, v72, v51
    v_add_f32 v72, v72, v52
    v_add_f32 v72, v72, v53
    v_add_f32 v72, v72, v54
    v_add_f32 v72, v72, v55
    v_add_f32 v72, v72, v56
    v_add_f32 v72, v72, v57
    v_add_f32 v72, v72, v58
    v_add_f32 v72, v72, v59
    v_add_f32 v72, v72, v60
    v_add_f32 v72, v72, v61
    v_add_f32 v72, v72, v62
    v_add_f32 v72, v72, v63
    v_add_f32 v72, v72, v64
    v_add_f32 v72, v72, v65
    v_add_f32 v72, v72, v66
    v_add_f32 v72, v72, v67
    v_add_f32 v72, v72, v68
    v_add_f32 v72, v72, v69
    v_add_f32 v72, v72, v70
    v_add_f32 v72, v72, v71
    v_lshlrev_b32 v77, 4, v4
    s_lshl_b32 s35, s33, 2
    v_add_u32 v76, s35, v77
    v_mov_b32 v73, v72
    s_nop 1
    v_permlane16_swap_b32 v72, v73
    v_add_f32 v72, v72, v73
    v_mov_b32 v73, v72
    s_nop 1
    v_permlane32_swap_b32 v72, v73
    v_add_f32 v72, v72, v73
    ds_write_b32 v76, v72 offset:0
    s_waitcnt lgkmcnt(0)
    s_barrier
    ds_read_b128 v[80:83], v77 offset:0
    s_waitcnt lgkmcnt(0)
    v_add_f32 v80, v80, v81
    v_add_f32 v82, v82, v83
    v_add_f32 v72, v80, v82
    v_mul_f32 v72, 0x3acccccd, v72
    v_sub_f32 v32, v32, v72
    v_sub_f32 v33, v33, v72
    v_sub_f32 v34, v34, v72
    v_sub_f32 v35, v35, v72
    v_sub_f32 v36, v36, v72
    v_sub_f32 v37, v37, v72
    v_sub_f32 v38, v38, v72
    v_sub_f32 v39, v39, v72
    v_sub_f32 v40, v40, v72
    v_sub_f32 v41, v41, v72
    v_sub_f32 v42, v42, v72
    v_sub_f32 v43, v43, v72
    v_sub_f32 v44, v44, v72
    v_sub_f32 v45, v45, v72
    v_sub_f32 v46, v46, v72
    v_sub_f32 v47, v47, v72
    v_sub_f32 v48, v48, v72
    v_sub_f32 v49, v49, v72
    v_sub_f32 v50, v50, v72
    v_sub_f32 v51, v51, v72
    v_sub_f32 v52, v52, v72
    v_sub_f32 v53, v53, v72
    v_sub_f32 v54, v54, v72
    v_sub_f32 v55, v55, v72
    v_sub_f32 v56, v56, v72
    v_sub_f32 v57, v57, v72
    v_sub_f32 v58, v58, v72
    v_sub_f32 v59, v59, v72
    v_sub_f32 v60, v60, v72
    v_sub_f32 v61, v61, v72
    v_sub_f32 v62, v62, v72
    v_sub_f32 v63, v63, v72
    v_sub_f32 v64, v64, v72
    v_sub_f32 v65, v65, v72
    v_sub_f32 v66, v66, v72
    v_sub_f32 v67, v67, v72
    v_sub_f32 v68, v68, v72
    v_sub_f32 v69, v69, v72
    v_sub_f32 v70, v70, v72
    v_sub_f32 v71, v71, v72
    v_mul_f32 v74, v32, v32
    v_fmac_f32 v74, v33, v33
    v_fmac_f32 v74, v34, v34
    v_fmac_f32 v74, v35, v35
    v_fmac_f32 v74, v36, v36
    v_fmac_f32 v74, v37, v37
    v_fmac_f32 v74, v38, v38
    v_fmac_f32 v74, v39, v39
    v_fmac_f32 v74, v40, v40
    v_fmac_f32 v74, v41, v41
    v_fmac_f32 v74, v42, v42
    v_fmac_f32 v74, v43, v43
    v_fmac_f32 v74, v44, v44
    v_fmac_f32 v74, v45, v45
    v_fmac_f32 v74, v46, v46
    v_fmac_f32 v74, v47, v47
    v_fmac_f32 v74, v48, v48
    v_fmac_f32 v74, v49, v49
    v_fmac_f32 v74, v50, v50
    v_fmac_f32 v74, v51, v51
    v_fmac_f32 v74, v52, v52
    v_fmac_f32 v74, v53, v53
    v_fmac_f32 v74, v54, v54
    v_fmac_f32 v74, v55, v55
    v_fmac_f32 v74, v56, v56
    v_fmac_f32 v74, v57, v57
    v_fmac_f32 v74, v58, v58
    v_fmac_f32 v74, v59, v59
    v_fmac_f32 v74, v60, v60
    v_fmac_f32 v74, v61, v61
    v_fmac_f32 v74, v62, v62
    v_fmac_f32 v74, v63, v63
    v_fmac_f32 v74, v64, v64
    v_fmac_f32 v74, v65, v65
    v_fmac_f32 v74, v66, v66
    v_fmac_f32 v74, v67, v67
    v_fmac_f32 v74, v68, v68
    v_fmac_f32 v74, v69, v69
    v_fmac_f32 v74, v70, v70
    v_fmac_f32 v74, v71, v71
    v_mov_b32 v73, v74
    s_nop 1
    v_permlane16_swap_b32 v74, v73
    v_add_f32 v74, v74, v73
    v_mov_b32 v73, v74
    s_nop 1
    v_permlane32_swap_b32 v74, v73
    v_add_f32 v74, v74, v73
    ds_write_b32 v76, v74 offset:512
    s_waitcnt lgkmcnt(0)
    s_barrier
    ds_read_b128 v[80:83], v77 offset:512
    s_waitcnt lgkmcnt(0)
    v_add_f32 v80, v80, v81
    v_add_f32 v82, v82, v83
    v_add_f32 v74, v80, v82
    v_mov_b32 v75, 0x3727c5ac
    v_fmac_f32 v75, 0x3acccccd, v74
    v_rsq_f32 v75, v75
    s_nop 0
    v_mul_f32 v32, v32, v75
    v_mul_f32 v33, v33, v75
    v_mul_f32 v34, v34, v75
    v_mul_f32 v35, v35, v75
    v_mul_f32 v36, v36, v75
    v_mul_f32 v37, v37, v75
    v_mul_f32 v38, v38, v75
    v_mul_f32 v39, v39, v75
    v_mul_f32 v40, v40, v75
    v_mul_f32 v41, v41, v75
    v_mul_f32 v42, v42, v75
    v_mul_f32 v43, v43, v75
    v_mul_f32 v44, v44, v75
    v_mul_f32 v45, v45, v75
    v_mul_f32 v46, v46, v75
    v_mul_f32 v47, v47, v75
    v_mul_f32 v48, v48, v75
    v_mul_f32 v49, v49, v75
    v_mul_f32 v50, v50, v75
    v_mul_f32 v51, v51, v75
    v_mul_f32 v52, v52, v75
    v_mul_f32 v53, v53, v75
    v_mul_f32 v54, v54, v75
    v_mul_f32 v55, v55, v75
    v_mul_f32 v56, v56, v75
    v_mul_f32 v57, v57, v75
    v_mul_f32 v58, v58, v75
    v_mul_f32 v59, v59, v75
    v_mul_f32 v60, v60, v75
    v_mul_f32 v61, v61, v75
    v_mul_f32 v62, v62, v75
    v_mul_f32 v63, v63, v75
    v_mul_f32 v64, v64, v75
    v_mul_f32 v65, v65, v75
    v_mul_f32 v66, v66, v75
    v_mul_f32 v67, v67, v75
    v_mul_f32 v68, v68, v75
    v_mul_f32 v69, v69, v75
    v_mul_f32 v70, v70, v75
    v_mul_f32 v71, v71, v75
    v_cvt_pk_bf16_f32 v8, v32, v33
    v_cvt_pk_bf16_f32 v9, v34, v35
    v_cvt_pk_bf16_f32 v10, v36, v37
    v_cvt_pk_bf16_f32 v11, v38, v39
    v_cvt_pk_bf16_f32 v12, v40, v41
    v_cvt_pk_bf16_f32 v13, v42, v43
    v_cvt_pk_bf16_f32 v14, v44, v45
    v_cvt_pk_bf16_f32 v15, v46, v47
    v_cvt_pk_bf16_f32 v16, v48, v49
    v_cvt_pk_bf16_f32 v17, v50, v51
    v_cvt_pk_bf16_f32 v18, v52, v53
    v_cvt_pk_bf16_f32 v19, v54, v55
    v_cvt_pk_bf16_f32 v20, v56, v57
    v_cvt_pk_bf16_f32 v21, v58, v59
    v_cvt_pk_bf16_f32 v22, v60, v61
    v_cvt_pk_bf16_f32 v23, v62, v63
    v_cvt_pk_bf16_f32 v24, v64, v65
    v_cvt_pk_bf16_f32 v25, v66, v67
    v_cvt_pk_bf16_f32 v26, v68, v69
    v_cvt_pk_bf16_f32 v27, v70, v71
    s_mul_i32 s36, s34, 20480
    s_mul_i32 s35, s33, 5120
    s_add_u32 s36, s36, s35
    s_add_u32 s36, s36, 29360128
    s_add_u32 s35, s36, 4096
    buffer_store_dwordx4 v[8:11], v5, s[8:11], s36 offen offset:0
    buffer_store_dwordx4 v[12:15], v5, s[8:11], s36 offen offset:1024
    buffer_store_dwordx4 v[16:19], v5, s[8:11], s36 offen offset:2048
    buffer_store_dwordx4 v[20:23], v5, s[8:11], s36 offen offset:3072
    buffer_store_dwordx4 v[24:27], v5, s[8:11], s35 offen offset:0
    s_branch Lp_end
Lp_b:
    s_cmp_ge_u32 s2, 160
    s_cselect_b32 s49, 160, 0
    s_sub_u32 s35, s2, s49
    s_lshl_b32 s35, s35, 2
    s_add_u32 s35, s35, s33
    s_mul_hi_u32 s36, s35, 0x33333334
    s_mul_i32 s37, s36, 5
    s_sub_u32 s37, s35, s37
    s_lshr_b32 s38, s36, 2
    s_and_b32 s39, s36, 3
    s_lshl_b32 s41, s37, 4
    v_add_u32 v7, s41, v4
    v_lshlrev_b32 v8, 8, v3
    s_mul_i32 s42, s38, 163840
    s_lshl_b32 s41, s39, 10
    s_add_u32 s42, s42, s41
    s_mov_b32 s44, 0x05040100
    s_mov_b32 s45, 0x07060302
    s_cmp_lg_u32 s49, 0
    s_cbranch_scc1 Lp_bc
    v_mul_u32_u24 v6, 40960, v3
    v_lshl_add_u32 v6, v4, 4, v6
    s_lshl_b32 s40, s38, 6
    s_add_u32 s40, s40, s39
    s_mul_i32 s40, s40, 2560
    s_lshl_b32 s41, s37, 8
    s_add_u32 s40, s40, s41
    s_add_u32 s43, s40, 0
    buffer_load_dwordx4 v[16:19], v6, s[24:27], s43 offen
    s_add_u32 s43, s40, 1280
    buffer_load_dwordx4 v[20:23], v6, s[24:27], s43 offen
    s_add_u32 s43, s40, 10240
    buffer_load_dwordx4 v[24:27], v6, s[24:27], s43 offen
    s_add_u32 s43, s40, 11520
    buffer_load_dwordx4 v[28:31], v6, s[24:27], s43 offen
    s_add_u32 s43, s40, 20480
    buffer_load_dwordx4 v[32:35], v6, s[24:27], s43 offen
    s_add_u32 s43, s40, 21760
    buffer_load_dwordx4 v[36:39], v6, s[24:27], s43 offen
    s_add_u32 s43, s40, 30720
    buffer_load_dwordx4 v[40:43], v6, s[24:27], s43 offen
    s_add_u32 s43, s40, 32000
    buffer_load_dwordx4 v[44:47], v6, s[24:27], s43 offen
    v_lshrrev_b32 v9, 2, v7
    v_lshl_add_u32 v9, v9, 13, v8
    v_and_b32 v10, 3, v7
    v_lshl_add_u32 v9, v10, 6, v9
    s_add_u32 s47, s42, 23068672
    s_add_u32 s48, s47, 4096
    s_waitcnt vmcnt(0)
    v_perm_b32 v48, v20, v16, s44
    v_perm_b32 v49, v28, v24, s44
    v_perm_b32 v50, v36, v32, s44
    v_perm_b32 v51, v44, v40, s44
    v_perm_b32 v52, v20, v16, s45
    v_perm_b32 v53, v28, v24, s45
    v_perm_b32 v54, v36, v32, s45
    v_perm_b32 v55, v44, v40, s45
    v_perm_b32 v56, v21, v17, s44
    v_perm_b32 v57, v29, v25, s44
    v_perm_b32 v58, v37, v33, s44
    v_perm_b32 v59, v45, v41, s44
    v_perm_b32 v60, v21, v17, s45
    v_perm_b32 v61, v29, v25, s45
    v_perm_b32 v62, v37, v33, s45
    v_perm_b32 v63, v45, v41, s45
    v_perm_b32 v64, v22, v18, s44
    v_perm_b32 v65, v30, v26, s44
    v_perm_b32 v66, v38, v34, s44
    v_perm_b32 v67, v46, v42, s44
    v_perm_b32 v68, v22, v18, s45
    v_perm_b32 v69, v30, v26, s45
    v_perm_b32 v70, v38, v34, s45
    v_perm_b32 v71, v46, v42, s45
    v_perm_b32 v72, v23, v19, s44
    v_perm_b32 v73, v31, v27, s44
    v_perm_b32 v74, v39, v35, s44
    v_perm_b32 v75, v47, v43, s44
    v_perm_b32 v76, v23, v19, s45
    v_perm_b32 v77, v31, v27, s45
    v_perm_b32 v78, v39, v35, s45
    v_perm_b32 v79, v47, v43, s45
    buffer_store_dwordx4 v[48:51], v9, s[8:11], s47 offen offset:0
    buffer_store_dwordx4 v[52:55], v9, s[8:11], s47 offen offset:16
    buffer_store_dwordx4 v[56:59], v9, s[8:11], s47 offen offset:32
    buffer_store_dwordx4 v[60:63], v9, s[8:11], s47 offen offset:48
    buffer_store_dwordx4 v[64:67], v9, s[8:11], s48 offen offset:0
    buffer_store_dwordx4 v[68:71], v9, s[8:11], s48 offen offset:16
    buffer_store_dwordx4 v[72:75], v9, s[8:11], s48 offen offset:32
    buffer_store_dwordx4 v[76:79], v9, s[8:11], s48 offen offset:48
    s_branch Lp_end
Lp_bc:
    v_lshrrev_b32 v6, 1, v3
    v_lshlrev_b32 v6, 4, v6
    v_and_b32 v9, 1, v3
    v_add_u32 v6, v6, v9
    v_mul_u32_u24 v6, 2560, v6
    v_lshl_add_u32 v6, v4, 4, v6
    s_and_b32 s40, s39, 1
    s_lshl_b32 s40, s40, 6
    s_lshr_b32 s41, s39, 1
    s_lshl_b32 s41, s41, 2
    s_add_u32 s40, s40, s41
    s_lshl_b32 s41, s38, 7
    s_add_u32 s40, s40, s41
    s_mul_i32 s40, s40, 1280
    s_lshl_b32 s41, s37, 8
    s_add_u32 s40, s40, s41
    s_add_u32 s43, s40, 0
    buffer_load_dwordx4 v[16:19], v6, s[24:27], s43 offen
    s_add_u32 s43, s40, 10240
    buffer_load_dwordx4 v[20:23], v6, s[24:27], s43 offen
    s_add_u32 s43, s40, 1280
    buffer_load_dwordx4 v[24:27], v6, s[24:27], s43 offen
    s_add_u32 s43, s40, 11520
    buffer_load_dwordx4 v[28:31], v6, s[24:27], s43 offen
    s_add_u32 s43, s40, 20480
    buffer_load_dwordx4 v[32:35], v6, s[24:27], s43 offen
    s_add_u32 s43, s40, 30720
    buffer_load_dwordx4 v[36:39], v6, s[24:27], s43 offen
    s_add_u32 s43, s40, 21760
    buffer_load_dwordx4 v[40:43], v6, s[24:27], s43 offen
    s_add_u32 s43, s40, 32000
    buffer_load_dwordx4 v[44:47], v6, s[24:27], s43 offen
    v_cmp_le_u32 vcc, 40, v7
    v_subrev_u32 v9, 40, v7
    v_mov_b32 v11, 0
    v_mov_b32 v12, 81920
    v_cndmask_b32 v9, v7, v9, vcc
    v_cndmask_b32 v11, v11, v12, vcc
    v_add_u32 v8, v8, v11
    v_and_b32 v10, 1, v9
    v_lshrrev_b32 v11, 3, v9
    v_mul_u32_u24 v11, 20480, v11
    v_bfe_u32 v12, v9, 1, 2
    v_lshl_add_u32 v11, v12, 6, v11
    v_lshl_add_u32 v11, v10, 4, v11
    v_mul_u32_u24 v12, 20480, v12
    v_lshl_add_u32 v12, v10, 6, v12
    v_add_u32 v12, 16384, v12
    v_cmp_le_u32 vcc, 32, v9
    s_nop 1
    v_cndmask_b32 v11, v11, v12, vcc
    v_add_u32 v8, v8, v11
    v_mov_b32 v13, 8192
    v_mov_b32 v12, 32
    v_cndmask_b32 v13, v13, v12, vcc
    v_mov_b32 v14, 32
    v_mov_b32 v12, 128
    v_cndmask_b32 v14, v14, v12, vcc
    v_mov_b32 v15, 4096
    v_mov_b32 v12, 16
    v_cndmask_b32 v15, v15, v12, vcc
    s_add_u32 s46, s42, 16777216
    s_waitcnt vmcnt(0)
    v_perm_b32 v48, v20, v16, s44
    v_perm_b32 v49, v28, v24, s44
    v_perm_b32 v50, v36, v32, s44
    v_perm_b32 v51, v44, v40, s44
    v_perm_b32 v52, v20, v16, s45
    v_perm_b32 v53, v28, v24, s45
    v_perm_b32 v54, v36, v32, s45
    v_perm_b32 v55, v44, v40, s45
    v_perm_b32 v56, v21, v17, s44
    v_perm_b32 v57, v29, v25, s44
    v_perm_b32 v58, v37, v33, s44
    v_perm_b32 v59, v45, v41, s44
    v_perm_b32 v60, v21, v17, s45
    v_perm_b32 v61, v29, v25, s45
    v_perm_b32 v62, v37, v33, s45
    v_perm_b32 v63, v45, v41, s45
    v_perm_b32 v64, v22, v18, s44
    v_perm_b32 v65, v30, v26, s44
    v_perm_b32 v66, v38, v34, s44
    v_perm_b32 v67, v46, v42, s44
    v_perm_b32 v68, v22, v18, s45
    v_perm_b32 v69, v30, v26, s45
    v_perm_b32 v70, v38, v34, s45
    v_perm_b32 v71, v46, v42, s45
    v_perm_b32 v72, v23, v19, s44
    v_perm_b32 v73, v31, v27, s44
    v_perm_b32 v74, v39, v35, s44
    v_perm_b32 v75, v47, v43, s44
    v_perm_b32 v76, v23, v19, s45
    v_perm_b32 v77, v31, v27, s45
    v_perm_b32 v78, v39, v35, s45
    v_perm_b32 v79, v47, v43, s45
    v_mov_b32 v80, v8
    buffer_store_dwordx4 v[48:51], v80, s[8:11], s46 offen
    v_mov_b32 v81, v8
    v_add_u32 v81, v81, v15
    buffer_store_dwordx4 v[52:55], v81, s[8:11], s46 offen
    v_mov_b32 v82, v8
    v_add_u32 v82, v82, v14
    buffer_store_dwordx4 v[56:59], v82, s[8:11], s46 offen
    v_mov_b32 v83, v8
    v_add_u32 v83, v83, v14
    v_add_u32 v83, v83, v15
    buffer_store_dwordx4 v[60:63], v83, s[8:11], s46 offen
    v_mov_b32 v84, v8
    v_add_u32 v84, v84, v13
    buffer_store_dwordx4 v[64:67], v84, s[8:11], s46 offen
    v_mov_b32 v85, v8
    v_add_u32 v85, v85, v13
    v_add_u32 v85, v85, v15
    buffer_store_dwordx4 v[68:71], v85, s[8:11], s46 offen
    v_mov_b32 v86, v8
    v_add_u32 v86, v86, v13
    v_add_u32 v86, v86, v14
    buffer_store_dwordx4 v[72:75], v86, s[8:11], s46 offen
    v_mov_b32 v87, v8
    v_add_u32 v87, v87, v13
    v_add_u32 v87, v87, v14
    v_add_u32 v87, v87, v15
    buffer_store_dwordx4 v[76:79], v87, s[8:11], s46 offen
Lp_end:
    s_endpgm

.globl main_kernel
.p2align 8
.type main_kernel,@function
main_kernel:
    s_cmp_ge_u32 s2, 256
    s_cbranch_scc1 main_kernel_end
    s_load_dwordx2 s[16:17], s[0:1], 0
    s_load_dwordx2 s[8:9], s[0:1], 96
    s_load_dwordx2 s[12:13], s[0:1], 88
    s_getreg_b32 s24, hwreg(HW_REG_XCC_ID)
    s_and_b32 s24, s24, 7
    s_getpc_b64 s[26:27]
main_kernel_cpf:
    s_lshr_b32 s28, s2, 3
    s_lshl_b32 s28, s28, 8
    v_add_u32 v13, s28, v0
    v_lshlrev_b32 v13, 6, v13
    v_cmp_gt_u32 vcc, main_kernel_end - main_kernel_cpf, v13
    s_and_saveexec_b64 s[28:29], vcc
    s_cbranch_execz main_kernel_cpfd
    global_load_dword v14, v13, s[26:27]
main_kernel_cpfd:
    s_mov_b64 exec, s[28:29]
    v_lshrrev_b32 v12, 6, v0
    v_and_b32 v0, 63, v0
    v_readfirstlane_b32 s21, v12
    v_lshlrev_b32 v0, 4, v0
    s_waitcnt lgkmcnt(0)
    s_and_b32 s9, s9, 0xffff
    s_mov_b32 s10, 268435456
    s_mov_b32 s11, 0x00020000
    s_and_b32 s13, s13, 0xffff
    s_mov_b32 s14, 256
    s_mov_b32 s15, 0x00020000
    s_and_b32 s17, s17, 0xffff
    s_mov_b32 s18, 2621440
    s_mov_b32 s19, 0x00020000
    s_mov_b32 s5, 0
    s_mov_b32 s101, 0
    s_cmp_lg_u32 s21, 0
    s_cbranch_scc1 main_kernel_notick
    s_and_b32 s25, s24, 5
    s_cmp_lg_u32 s25, 1
    s_cbranch_scc1 main_kernel_nocal
    s_bfe_u32 s25, s2, 0x20003
    s_lshl_b32 s26, s25, 13
    s_lshr_b32 s27, s2, 5
    s_lshl_b32 s27, s27, 15
    s_add_u32 s26, s26, s27
    s_lshl_b32 s27, s24, 8
    s_add_u32 s26, s26, s27
    s_add_u32 s26, s26, 171966464
    v_mov_b32 v28, -1
    v_mov_b32 v29, -1
    v_mov_b32 v30, -1
    v_mov_b32 v31, -1
    s_mov_b64 exec, 0xff
    s_mov_b32 s27, -1
    s_waitcnt vmcnt(0)
    s_memtime s[28:29]
    buffer_store_dwordx4 v[28:31], v0, s[8:11], s26 offen sc1
    s_waitcnt vmcnt(0)
    s_memtime s[30:31]
    s_waitcnt lgkmcnt(0)
    s_sub_u32 s28, s30, s28
    s_min_u32 s27, s27, s28
    s_memtime s[28:29]
    buffer_store_dwordx4 v[28:31], v0, s[8:11], s26 offen sc1
    s_waitcnt vmcnt(0)
    s_memtime s[30:31]
    s_waitcnt lgkmcnt(0)
    s_sub_u32 s28, s30, s28
    s_min_u32 s27, s27, s28
    s_memtime s[28:29]
    buffer_store_dwordx4 v[28:31], v0, s[8:11], s26 offen sc1
    s_waitcnt vmcnt(0)
    s_memtime s[30:31]
    s_waitcnt lgkmcnt(0)
    s_sub_u32 s28, s30, s28
    s_min_u32 s27, s27, s28
    s_mov_b64 exec, 1
    v_mov_b32 v28, s27
    s_lshl_b32 s25, s25, 2
    s_add_u32 s25, s25, 173621248
    v_mov_b32 v29, s25
    buffer_atomic_umin v28, v29, s[8:11], 0 offen
main_kernel_nocal:
    s_mov_b64 exec, 1
    v_mov_b32 v28, 1
    s_lshl_b32 s25, s24, 2
    v_mov_b32 v29, s25
    buffer_atomic_add v28, v29, s[12:15], 0 offen sc0
    s_waitcnt vmcnt(0)
    v_mov_b32 v30, 1
    v_mov_b32 v29, 32
    buffer_atomic_add v30, v29, s[12:15], 0 offen
    v_mov_b32 v29, 31488
    ds_write_b32 v29, v28
    s_waitcnt lgkmcnt(0)
    s_mov_b64 exec, -1
main_kernel_notick:
    s_barrier
    v_mov_b32 v29, 31488
    ds_read_b32 v28, v29
    s_waitcnt lgkmcnt(0)
    v_readfirstlane_b32 s25, v28
    s_lshl_b32 s20, s24, 2
    s_lshr_b32 s20, 0x76325140, s20
    s_and_b32 s20, s20, 7
    s_and_b32 s22, s25, 31
    s_mov_b32 s23, 0
    s_mov_b32 s32, 0
main_kernel_loadw:
    s_cmp_lt_u32 s20, 2
    s_cbranch_scc1 main_kernel_lw_chain
    s_sub_u32 s26, s20, 1
    s_cmp_ge_u32 s20, 4
    s_cselect_b32 s26, 0, s26
    s_mul_i32 s26, s26, 40960
    s_mul_i32 s29, s22, 491520
    s_mul_i32 s28, s21, 122880
    s_add_u32 s29, s29, s28
    s_add_u32 s29, s29, s26
    buffer_load_dwordx4 a[0:3], v0, s[8:11], s29 offen offset:0
    buffer_load_dwordx4 a[4:7], v0, s[8:11], s29 offen offset:1024
    buffer_load_dwordx4 a[8:11], v0, s[8:11], s29 offen offset:2048
    buffer_load_dwordx4 a[12:15], v0, s[8:11], s29 offen offset:3072
    s_add_u32 s29, s29, 4096
    buffer_load_dwordx4 a[16:19], v0, s[8:11], s29 offen offset:0
    buffer_load_dwordx4 a[20:23], v0, s[8:11], s29 offen offset:1024
    buffer_load_dwordx4 a[24:27], v0, s[8:11], s29 offen offset:2048
    buffer_load_dwordx4 a[28:31], v0, s[8:11], s29 offen offset:3072
    s_add_u32 s29, s29, 4096
    buffer_load_dwordx4 a[32:35], v0, s[8:11], s29 offen offset:0
    buffer_load_dwordx4 a[36:39], v0, s[8:11], s29 offen offset:1024
    buffer_load_dwordx4 a[40:43], v0, s[8:11], s29 offen offset:2048
    buffer_load_dwordx4 a[44:47], v0, s[8:11], s29 offen offset:3072
    s_add_u32 s29, s29, 4096
    buffer_load_dwordx4 a[48:51], v0, s[8:11], s29 offen offset:0
    buffer_load_dwordx4 a[52:55], v0, s[8:11], s29 offen offset:1024
    buffer_load_dwordx4 a[56:59], v0, s[8:11], s29 offen offset:2048
    buffer_load_dwordx4 a[60:63], v0, s[8:11], s29 offen offset:3072
    s_add_u32 s29, s29, 4096
    buffer_load_dwordx4 a[64:67], v0, s[8:11], s29 offen offset:0
    buffer_load_dwordx4 a[68:71], v0, s[8:11], s29 offen offset:1024
    buffer_load_dwordx4 a[72:75], v0, s[8:11], s29 offen offset:2048
    buffer_load_dwordx4 a[76:79], v0, s[8:11], s29 offen offset:3072
    s_add_u32 s29, s29, 4096
    buffer_load_dwordx4 a[80:83], v0, s[8:11], s29 offen offset:0
    buffer_load_dwordx4 a[84:87], v0, s[8:11], s29 offen offset:1024
    buffer_load_dwordx4 a[88:91], v0, s[8:11], s29 offen offset:2048
    buffer_load_dwordx4 a[92:95], v0, s[8:11], s29 offen offset:3072
    s_add_u32 s29, s29, 4096
    buffer_load_dwordx4 a[96:99], v0, s[8:11], s29 offen offset:0
    buffer_load_dwordx4 a[100:103], v0, s[8:11], s29 offen offset:1024
    buffer_load_dwordx4 a[104:107], v0, s[8:11], s29 offen offset:2048
    buffer_load_dwordx4 a[108:111], v0, s[8:11], s29 offen offset:3072
    s_add_u32 s29, s29, 4096
    buffer_load_dwordx4 a[112:115], v0, s[8:11], s29 offen offset:0
    buffer_load_dwordx4 a[116:119], v0, s[8:11], s29 offen offset:1024
    buffer_load_dwordx4 a[120:123], v0, s[8:11], s29 offen offset:2048
    buffer_load_dwordx4 a[124:127], v0, s[8:11], s29 offen offset:3072
    s_add_u32 s29, s29, 4096
    buffer_load_dwordx4 a[128:131], v0, s[8:11], s29 offen offset:0
    buffer_load_dwordx4 a[132:135], v0, s[8:11], s29 offen offset:1024
    buffer_load_dwordx4 a[136:139], v0, s[8:11], s29 offen offset:2048
    buffer_load_dwordx4 a[140:143], v0, s[8:11], s29 offen offset:3072
    s_add_u32 s29, s29, 4096
    buffer_load_dwordx4 a[144:147], v0, s[8:11], s29 offen offset:0
    buffer_load_dwordx4 a[148:151], v0, s[8:11], s29 offen offset:1024
    buffer_load_dwordx4 a[152:155], v0, s[8:11], s29 offen offset:2048
    buffer_load_dwordx4 a[156:159], v0, s[8:11], s29 offen offset:3072
    s_add_u32 s29, s29, 4096
    s_cmp_lt_u32 s20, 4
    s_cbranch_scc1 main_kernel_lw_done
    s_mul_i32 s29, s22, 163840
    s_mul_i32 s28, s21, 40960
    s_add_u32 s29, s29, s28
    s_add_u32 s29, s29, 23068672
    buffer_load_dwordx4 a[160:163], v0, s[8:11], s29 offen offset:0
    buffer_load_dwordx4 a[164:167], v0, s[8:11], s29 offen offset:1024
    buffer_load_dwordx4 a[168:171], v0, s[8:11], s29 offen offset:2048
    buffer_load_dwordx4 a[172:175], v0, s[8:11], s29 offen offset:3072
    s_add_u32 s29, s29, 4096
    buffer_load_dwordx4 a[176:179], v0, s[8:11], s29 offen offset:0
    buffer_load_dwordx4 a[180:183], v0, s[8:11], s29 offen offset:1024
    buffer_load_dwordx4 a[184:187], v0, s[8:11], s29 offen offset:2048
    buffer_load_dwordx4 a[188:191], v0, s[8:11], s29 offen offset:3072
    s_add_u32 s29, s29, 4096
    buffer_load_dwordx4 a[192:195], v0, s[8:11], s29 offen offset:0
    buffer_load_dwordx4 a[196:199], v0, s[8:11], s29 offen offset:1024
    buffer_load_dwordx4 a[200:203], v0, s[8:11], s29 offen offset:2048
    buffer_load_dwordx4 a[204:207], v0, s[8:11], s29 offen offset:3072
    s_add_u32 s29, s29, 4096
    buffer_load_dwordx4 a[208:211], v0, s[8:11], s29 offen offset:0
    buffer_load_dwordx4 a[212:215], v0, s[8:11], s29 offen offset:1024
    buffer_load_dwordx4 a[216:219], v0, s[8:11], s29 offen offset:2048
    buffer_load_dwordx4 a[220:223], v0, s[8:11], s29 offen offset:3072
    s_add_u32 s29, s29, 4096
    buffer_load_dwordx4 a[224:227], v0, s[8:11], s29 offen offset:0
    buffer_load_dwordx4 a[228:231], v0, s[8:11], s29 offen offset:1024
    buffer_load_dwordx4 a[232:235], v0, s[8:11], s29 offen offset:2048
    buffer_load_dwordx4 a[236:239], v0, s[8:11], s29 offen offset:3072
    s_add_u32 s29, s29, 4096
    buffer_load_dwordx4 a[240:243], v0, s[8:11], s29 offen offset:0
    buffer_load_dwordx4 a[244:247], v0, s[8:11], s29 offen offset:1024
    buffer_load_dwordx4 a[248:251], v0, s[8:11], s29 offen offset:2048
    buffer_load_dwordx4 a[252:255], v0, s[8:11], s29 offen offset:3072
    s_add_u32 s29, s29, 4096
    buffer_load_dwordx4 v[192:195], v0, s[8:11], s29 offen offset:0
    buffer_load_dwordx4 v[196:199], v0, s[8:11], s29 offen offset:1024
    buffer_load_dwordx4 v[200:203], v0, s[8:11], s29 offen offset:2048
    buffer_load_dwordx4 v[204:207], v0, s[8:11], s29 offen offset:3072
    s_add_u32 s29, s29, 4096
    buffer_load_dwordx4 v[208:211], v0, s[8:11], s29 offen offset:0
    buffer_load_dwordx4 v[212:215], v0, s[8:11], s29 offen offset:1024
    buffer_load_dwordx4 v[216:219], v0, s[8:11], s29 offen offset:2048
    buffer_load_dwordx4 v[220:223], v0, s[8:11], s29 offen offset:3072
    s_add_u32 s29, s29, 4096
    buffer_load_dwordx4 v[224:227], v0, s[8:11], s29 offen offset:0
    buffer_load_dwordx4 v[228:231], v0, s[8:11], s29 offen offset:1024
    buffer_load_dwordx4 v[232:235], v0, s[8:11], s29 offen offset:2048
    buffer_load_dwordx4 v[236:239], v0, s[8:11], s29 offen offset:3072
    s_add_u32 s29, s29, 4096
    buffer_load_dwordx4 v[240:243], v0, s[8:11], s29 offen offset:0
    buffer_load_dwordx4 v[244:247], v0, s[8:11], s29 offen offset:1024
    buffer_load_dwordx4 v[248:251], v0, s[8:11], s29 offen offset:2048
    buffer_load_dwordx4 v[252:255], v0, s[8:11], s29 offen offset:3072
    s_add_u32 s29, s29, 4096
    s_branch main_kernel_lw_done
main_kernel_lw_chain:
    s_mul_i32 s29, s22, 491520
    s_mul_i32 s28, s21, 122880
    s_add_u32 s29, s29, s28
    s_mul_i32 s28, s20, 10240
    s_add_u32 s30, s29, s28
    s_sub_u32 s31, s29, s28
    s_add_u32 s31, s31, 10240
    s_mul_i32 s26, s21, 32768
    s_add_u32 s26, s26, 32768
    s_add_u32 s27, s30, 0
    s_add_u32 m0, s26, 0
    s_nop 0
    buffer_load_dwordx4 v0, s[8:11], s27 offen offset:0 lds
    buffer_load_dwordx4 v0, s[8:11], s27 offen offset:1024 lds
    s_add_u32 s27, s30, 20480
    buffer_load_dwordx4 a[248:251], v0, s[8:11], s27 offen offset:0
    buffer_load_dwordx4 a[252:255], v0, s[8:11], s27 offen offset:1024
    s_add_u32 s27, s30, 40960
    buffer_load_dwordx4 a[240:243], v0, s[8:11], s27 offen offset:0
    buffer_load_dwordx4 a[244:247], v0, s[8:11], s27 offen offset:1024
    s_add_u32 s27, s30, 61440
    s_add_u32 m0, s26, 2048
    s_nop 0
    buffer_load_dwordx4 v0, s[8:11], s27 offen offset:0 lds
    buffer_load_dwordx4 v0, s[8:11], s27 offen offset:1024 lds
    s_add_u32 s27, s30, 81920
    buffer_load_dwordx4 a[232:235], v0, s[8:11], s27 offen offset:0
    buffer_load_dwordx4 a[236:239], v0, s[8:11], s27 offen offset:1024
    s_add_u32 s27, s30, 102400
    buffer_load_dwordx4 a[224:227], v0, s[8:11], s27 offen offset:0
    buffer_load_dwordx4 a[228:231], v0, s[8:11], s27 offen offset:1024
    s_add_u32 s27, s30, 2048
    s_add_u32 m0, s26, 4096
    s_nop 0
    buffer_load_dwordx4 v0, s[8:11], s27 offen offset:0 lds
    buffer_load_dwordx4 v0, s[8:11], s27 offen offset:1024 lds
    s_add_u32 s27, s30, 22528
    buffer_load_dwordx4 a[216:219], v0, s[8:11], s27 offen offset:0
    buffer_load_dwordx4 a[220:223], v0, s[8:11], s27 offen offset:1024
    s_add_u32 s27, s30, 43008
    buffer_load_dwordx4 a[208:211], v0, s[8:11], s27 offen offset:0
    buffer_load_dwordx4 a[212:215], v0, s[8:11], s27 offen offset:1024
    s_add_u32 s27, s30, 63488
    s_add_u32 m0, s26, 6144
    s_nop 0
    buffer_load_dwordx4 v0, s[8:11], s27 offen offset:0 lds
    buffer_load_dwordx4 v0, s[8:11], s27 offen offset:1024 lds
    s_add_u32 s27, s30, 4096
    buffer_load_dwordx4 a[200:203], v0, s[8:11], s27 offen offset:0
    buffer_load_dwordx4 a[204:207], v0, s[8:11], s27 offen offset:1024
    s_add_u32 s27, s30, 24576
    buffer_load_dwordx4 a[192:195], v0, s[8:11], s27 offen offset:0
    buffer_load_dwordx4 a[196:199], v0, s[8:11], s27 offen offset:1024
    s_add_u32 s27, s30, 45056
    s_add_u32 m0, s26, 8192
    s_nop 0
    buffer_load_dwordx4 v0, s[8:11], s27 offen offset:0 lds
    buffer_load_dwordx4 v0, s[8:11], s27 offen offset:1024 lds
    s_add_u32 s27, s30, 65536
    buffer_load_dwordx4 a[184:187], v0, s[8:11], s27 offen offset:0
    buffer_load_dwordx4 a[188:191], v0, s[8:11], s27 offen offset:1024
    s_add_u32 s27, s30, 6144
    buffer_load_dwordx4 a[176:179], v0, s[8:11], s27 offen offset:0
    buffer_load_dwordx4 a[180:183], v0, s[8:11], s27 offen offset:1024
    s_add_u32 s27, s30, 26624
    s_add_u32 m0, s26, 10240
    s_nop 0
    buffer_load_dwordx4 v0, s[8:11], s27 offen offset:0 lds
    buffer_load_dwordx4 v0, s[8:11], s27 offen offset:1024 lds
    s_add_u32 s27, s30, 47104
    buffer_load_dwordx4 a[168:171], v0, s[8:11], s27 offen offset:0
    buffer_load_dwordx4 a[172:175], v0, s[8:11], s27 offen offset:1024
    s_add_u32 s27, s30, 67584
    buffer_load_dwordx4 a[160:163], v0, s[8:11], s27 offen offset:0
    buffer_load_dwordx4 a[164:167], v0, s[8:11], s27 offen offset:1024
    s_add_u32 s27, s30, 8192
    s_add_u32 m0, s26, 12288
    s_nop 0
    buffer_load_dwordx4 v0, s[8:11], s27 offen offset:0 lds
    buffer_load_dwordx4 v0, s[8:11], s27 offen offset:1024 lds
    s_add_u32 s27, s30, 28672
    buffer_load_dwordx4 a[152:155], v0, s[8:11], s27 offen offset:0
    buffer_load_dwordx4 a[156:159], v0, s[8:11], s27 offen offset:1024
    s_add_u32 s27, s30, 49152
    buffer_load_dwordx4 a[144:147], v0, s[8:11], s27 offen offset:0
    buffer_load_dwordx4 a[148:151], v0, s[8:11], s27 offen offset:1024
    s_add_u32 s27, s30, 69632
    s_add_u32 m0, s26, 14336
    s_nop 0
    buffer_load_dwordx4 v0, s[8:11], s27 offen offset:0 lds
    buffer_load_dwordx4 v0, s[8:11], s27 offen offset:1024 lds
    s_add_u32 s27, s31, 0
    buffer_load_dwordx4 a[136:139], v0, s[8:11], s27 offen offset:0
    buffer_load_dwordx4 a[140:143], v0, s[8:11], s27 offen offset:1024
    s_add_u32 s27, s31, 20480
    buffer_load_dwordx4 a[128:131], v0, s[8:11], s27 offen offset:0
    buffer_load_dwordx4 a[132:135], v0, s[8:11], s27 offen offset:1024
    s_add_u32 s27, s31, 2048
    s_add_u32 m0, s26, 16384
    s_nop 0
    buffer_load_dwordx4 v0, s[8:11], s27 offen offset:0 lds
    buffer_load_dwordx4 v0, s[8:11], s27 offen offset:1024 lds
    s_add_u32 s27, s31, 22528
    buffer_load_dwordx4 a[120:123], v0, s[8:11], s27 offen offset:0
    buffer_load_dwordx4 a[124:127], v0, s[8:11], s27 offen offset:1024
    s_add_u32 s27, s31, 4096
    buffer_load_dwordx4 a[112:115], v0, s[8:11], s27 offen offset:0
    buffer_load_dwordx4 a[116:119], v0, s[8:11], s27 offen offset:1024
    s_add_u32 s27, s31, 24576
    s_add_u32 m0, s26, 18432
    s_nop 0
    buffer_load_dwordx4 v0, s[8:11], s27 offen offset:0 lds
    buffer_load_dwordx4 v0, s[8:11], s27 offen offset:1024 lds
    s_add_u32 s27, s31, 6144
    buffer_load_dwordx4 a[104:107], v0, s[8:11], s27 offen offset:0
    buffer_load_dwordx4 a[108:111], v0, s[8:11], s27 offen offset:1024
    s_add_u32 s27, s31, 26624
    buffer_load_dwordx4 a[96:99], v0, s[8:11], s27 offen offset:0
    buffer_load_dwordx4 a[100:103], v0, s[8:11], s27 offen offset:1024
    s_add_u32 s27, s31, 8192
    s_add_u32 m0, s26, 20480
    s_nop 0
    buffer_load_dwordx4 v0, s[8:11], s27 offen offset:0 lds
    buffer_load_dwordx4 v0, s[8:11], s27 offen offset:1024 lds
    s_add_u32 s27, s31, 28672
    buffer_load_dwordx4 a[88:91], v0, s[8:11], s27 offen offset:0
    buffer_load_dwordx4 a[92:95], v0, s[8:11], s27 offen offset:1024
    s_add_u32 s27, s31, 40960
    buffer_load_dwordx4 a[80:83], v0, s[8:11], s27 offen offset:0
    buffer_load_dwordx4 a[84:87], v0, s[8:11], s27 offen offset:1024
    s_add_u32 s27, s31, 61440
    s_add_u32 m0, s26, 22528
    s_nop 0
    buffer_load_dwordx4 v0, s[8:11], s27 offen offset:0 lds
    buffer_load_dwordx4 v0, s[8:11], s27 offen offset:1024 lds
    s_add_u32 s27, s31, 43008
    buffer_load_dwordx4 a[72:75], v0, s[8:11], s27 offen offset:0
    buffer_load_dwordx4 a[76:79], v0, s[8:11], s27 offen offset:1024
    s_add_u32 s27, s31, 63488
    buffer_load_dwordx4 a[64:67], v0, s[8:11], s27 offen offset:0
    buffer_load_dwordx4 a[68:71], v0, s[8:11], s27 offen offset:1024
    s_add_u32 s27, s31, 45056
    s_add_u32 m0, s26, 24576
    s_nop 0
    buffer_load_dwordx4 v0, s[8:11], s27 offen offset:0 lds
    buffer_load_dwordx4 v0, s[8:11], s27 offen offset:1024 lds
    s_add_u32 s27, s31, 65536
    buffer_load_dwordx4 a[56:59], v0, s[8:11], s27 offen offset:0
    buffer_load_dwordx4 a[60:63], v0, s[8:11], s27 offen offset:1024
    s_add_u32 s27, s31, 47104
    buffer_load_dwordx4 a[48:51], v0, s[8:11], s27 offen offset:0
    buffer_load_dwordx4 a[52:55], v0, s[8:11], s27 offen offset:1024
    s_add_u32 s27, s31, 67584
    s_add_u32 m0, s26, 26624
    s_nop 0
    buffer_load_dwordx4 v0, s[8:11], s27 offen offset:0 lds
    buffer_load_dwordx4 v0, s[8:11], s27 offen offset:1024 lds
    s_add_u32 s27, s31, 49152
    buffer_load_dwordx4 a[40:43], v0, s[8:11], s27 offen offset:0
    buffer_load_dwordx4 a[44:47], v0, s[8:11], s27 offen offset:1024
    s_add_u32 s27, s31, 69632
    buffer_load_dwordx4 a[32:35], v0, s[8:11], s27 offen offset:0
    buffer_load_dwordx4 a[36:39], v0, s[8:11], s27 offen offset:1024
    s_add_u32 s27, s31, 81920
    s_add_u32 m0, s26, 28672
    s_nop 0
    buffer_load_dwordx4 v0, s[8:11], s27 offen offset:0 lds
    buffer_load_dwordx4 v0, s[8:11], s27 offen offset:1024 lds
    s_add_u32 s27, s31, 102400
    buffer_load_dwordx4 a[24:27], v0, s[8:11], s27 offen offset:0
    buffer_load_dwordx4 a[28:31], v0, s[8:11], s27 offen offset:1024
    s_add_u32 s27, s31, 83968
    buffer_load_dwordx4 a[16:19], v0, s[8:11], s27 offen offset:0
    buffer_load_dwordx4 a[20:23], v0, s[8:11], s27 offen offset:1024
    s_add_u32 s27, s31, 104448
    s_add_u32 m0, s26, 30720
    s_nop 0
    buffer_load_dwordx4 v0, s[8:11], s27 offen offset:0 lds
    buffer_load_dwordx4 v0, s[8:11], s27 offen offset:1024 lds
    s_add_u32 s27, s31, 86016
    buffer_load_dwordx4 a[8:11], v0, s[8:11], s27 offen offset:0
    buffer_load_dwordx4 a[12:15], v0, s[8:11], s27 offen offset:1024
    s_add_u32 s27, s31, 106496
    buffer_load_dwordx4 a[0:3], v0, s[8:11], s27 offen offset:0
    buffer_load_dwordx4 a[4:7], v0, s[8:11], s27 offen offset:1024
    s_add_u32 s27, s31, 88064
    buffer_load_dwordx4 v[248:251], v0, s[8:11], s27 offen offset:0
    buffer_load_dwordx4 v[252:255], v0, s[8:11], s27 offen offset:1024
    s_add_u32 s27, s31, 108544
    buffer_load_dwordx4 v[240:243], v0, s[8:11], s27 offen offset:0
    buffer_load_dwordx4 v[244:247], v0, s[8:11], s27 offen offset:1024
    s_add_u32 s27, s31, 90112
    buffer_load_dwordx4 v[232:235], v0, s[8:11], s27 offen offset:0
    buffer_load_dwordx4 v[236:239], v0, s[8:11], s27 offen offset:1024
    s_add_u32 s27, s31, 110592
    buffer_load_dwordx4 v[224:227], v0, s[8:11], s27 offen offset:0
    buffer_load_dwordx4 v[228:231], v0, s[8:11], s27 offen offset:1024
    s_add_u32 s27, s30, 83968
    buffer_load_dwordx4 v[216:219], v0, s[8:11], s27 offen offset:0
    buffer_load_dwordx4 v[220:223], v0, s[8:11], s27 offen offset:1024
    s_add_u32 s27, s30, 104448
    buffer_load_dwordx4 v[208:211], v0, s[8:11], s27 offen offset:0
    buffer_load_dwordx4 v[212:215], v0, s[8:11], s27 offen offset:1024
    s_add_u32 s27, s30, 86016
    buffer_load_dwordx4 v[200:203], v0, s[8:11], s27 offen offset:0
    buffer_load_dwordx4 v[204:207], v0, s[8:11], s27 offen offset:1024
    s_add_u32 s27, s30, 106496
    buffer_load_dwordx4 v[192:195], v0, s[8:11], s27 offen offset:0
    buffer_load_dwordx4 v[196:199], v0, s[8:11], s27 offen offset:1024
    s_add_u32 s27, s30, 88064
    buffer_load_dwordx4 v[184:187], v0, s[8:11], s27 offen offset:0
    buffer_load_dwordx4 v[188:191], v0, s[8:11], s27 offen offset:1024
    s_add_u32 s27, s30, 108544
    buffer_load_dwordx4 v[176:179], v0, s[8:11], s27 offen offset:0
    buffer_load_dwordx4 v[180:183], v0, s[8:11], s27 offen offset:1024
    s_add_u32 s27, s30, 90112
    buffer_load_dwordx4 v[168:171], v0, s[8:11], s27 offen offset:0
    buffer_load_dwordx4 v[172:175], v0, s[8:11], s27 offen offset:1024
    s_add_u32 s27, s30, 110592
    buffer_load_dwordx4 v[160:163], v0, s[8:11], s27 offen offset:0
    buffer_load_dwordx4 v[164:167], v0, s[8:11], s27 offen offset:1024
    s_lshl_b32 s28, s20, 2
    s_add_u32 s28, s28, s21
    s_mul_i32 s28, s28, 20480
    s_mul_i32 s29, s22, 163840
    s_add_u32 s29, s29, s28
    s_add_u32 s27, s29, 16777216
    buffer_load_dwordx4 v[152:155], v0, s[8:11], s27 offen offset:0
    buffer_load_dwordx4 v[156:159], v0, s[8:11], s27 offen offset:1024
    buffer_load_dwordx4 v[144:147], v0, s[8:11], s27 offen offset:2048
    buffer_load_dwordx4 v[148:151], v0, s[8:11], s27 offen offset:3072
    s_add_u32 s27, s29, 16781312
    buffer_load_dwordx4 v[136:139], v0, s[8:11], s27 offen offset:0
    buffer_load_dwordx4 v[140:143], v0, s[8:11], s27 offen offset:1024
    buffer_load_dwordx4 v[128:131], v0, s[8:11], s27 offen offset:2048
    buffer_load_dwordx4 v[132:135], v0, s[8:11], s27 offen offset:3072
    s_add_u32 s27, s29, 16785408
    buffer_load_dwordx4 v[120:123], v0, s[8:11], s27 offen offset:0
    buffer_load_dwordx4 v[124:127], v0, s[8:11], s27 offen offset:1024
    buffer_load_dwordx4 v[112:115], v0, s[8:11], s27 offen offset:2048
    buffer_load_dwordx4 v[116:119], v0, s[8:11], s27 offen offset:3072
    s_add_u32 s27, s29, 16789504
    buffer_load_dwordx4 v[104:107], v0, s[8:11], s27 offen offset:0
    buffer_load_dwordx4 v[108:111], v0, s[8:11], s27 offen offset:1024
    buffer_load_dwordx4 v[96:99], v0, s[8:11], s27 offen offset:2048
    buffer_load_dwordx4 v[100:103], v0, s[8:11], s27 offen offset:3072
    s_add_u32 s27, s29, 16793600
    buffer_load_dwordx4 v[88:91], v0, s[8:11], s27 offen offset:0
    buffer_load_dwordx4 v[92:95], v0, s[8:11], s27 offen offset:1024
    buffer_load_dwordx4 v[80:83], v0, s[8:11], s27 offen offset:2048
    buffer_load_dwordx4 v[84:87], v0, s[8:11], s27 offen offset:3072
main_kernel_lw_done:
    s_cmp_lg_u32 s32, 0
    s_cbranch_scc1 main_kernel_role_ok
    s_mov_b32 s32, 1
    s_mov_b32 s30, 0
    v_bfe_u32 v12, v0, 4, 4
    v_lshlrev_b32 v12, 2, v12
main_kernel_modepoll:
    buffer_load_dword v13, v12, s[12:15], 0 offen sc1
    s_waitcnt vmcnt(0)
    v_readlane_b32 s31, v13, 8
    s_cmp_eq_u32 s31, 256
    s_cbranch_scc1 main_kernel_modegot
    s_sleep 2
    s_add_u32 s30, s30, 1
    s_cmp_lt_u32 s30, 60000
    s_cbranch_scc1 main_kernel_modepoll
    s_branch main_kernel_fail
main_kernel_modegot:
    s_mov_b32 s27, 173621248
    buffer_load_dword v13, v12, s[12:15], 0 offen sc1
    buffer_load_dword v14, v12, s[8:11], s27 offen sc1
    s_waitcnt vmcnt(0)
    v_readlane_b32 s26, v14, 0
    s_mov_b32 s33, 0
    v_readlane_b32 s27, v14, 1
    s_nop 0
    s_cmp_lt_u32 s27, s26
    s_cselect_b32 s33, 8192, s33
    s_min_u32 s26, s26, s27
    v_readlane_b32 s27, v14, 2
    s_nop 0
    s_cmp_lt_u32 s27, s26
    s_cselect_b32 s33, 16384, s33
    s_min_u32 s26, s26, s27
    v_readlane_b32 s27, v14, 3
    s_nop 0
    s_cmp_lt_u32 s27, s26
    s_cselect_b32 s33, 24576, s33
    s_min_u32 s26, s26, s27
    s_xor_b32 s33, s33, 16384
    v_cmp_ne_u32 vcc, 32, v13
    s_and_b32 s31, vcc_lo, 0xff
    s_cmp_eq_u32 s31, 0
    s_cbranch_scc1 main_kernel_role_ok
    s_mov_b32 s23, 1
    s_mov_b32 s31, s25
    v_readlane_b32 s30, v13, 0
    s_cmp_gt_u32 s24, 0
    s_cselect_b32 s30, s30, 0
    s_add_u32 s31, s31, s30
    v_readlane_b32 s30, v13, 1
    s_cmp_gt_u32 s24, 1
    s_cselect_b32 s30, s30, 0
    s_add_u32 s31, s31, s30
    v_readlane_b32 s30, v13, 2
    s_cmp_gt_u32 s24, 2
    s_cselect_b32 s30, s30, 0
    s_add_u32 s31, s31, s30
    v_readlane_b32 s30, v13, 3
    s_cmp_gt_u32 s24, 3
    s_cselect_b32 s30, s30, 0
    s_add_u32 s31, s31, s30
    v_readlane_b32 s30, v13, 4
    s_cmp_gt_u32 s24, 4
    s_cselect_b32 s30, s30, 0
    s_add_u32 s31, s31, s30
    v_readlane_b32 s30, v13, 5
    s_cmp_gt_u32 s24, 5
    s_cselect_b32 s30, s30, 0
    s_add_u32 s31, s31, s30
    v_readlane_b32 s30, v13, 6
    s_cmp_gt_u32 s24, 6
    s_cselect_b32 s30, s30, 0
    s_add_u32 s31, s31, s30
    s_lshr_b32 s20, s31, 5
    s_and_b32 s22, s31, 31
    s_and_b32 s20, s20, 7
    s_and_b32 s22, s22, 31
    s_branch main_kernel_loadw
main_kernel_role_ok:
    s_mov_b32 s25, s33
    s_cmp_ge_u32 s20, 2
    s_cbranch_scc1 main_kernel_bulk
    v_lshrrev_b32 v36, 8, v0
    v_bfe_u32 v37, v0, 4, 4
    v_bfe_u32 v38, v0, 4, 3
    v_bfe_u32 v39, v0, 7, 1
    s_mov_b32 s36, 0x00ff00ff
    s_mov_b32 s37, 0x00ff00ff
    s_not_b64 s[18:19], s[36:37]
    v_mov_b32 v1, 0x4444
    v_mov_b32 v40, 0xeeee
    v_cndmask_b32_e64 v1, v1, v40, s[18:19]
    v_and_b32 v40, 1, v36
    v_lshlrev_b32 v40, 2, v40
    v_lshrrev_b32 v41, 1, v36
    v_add_u32 v40, v40, v41
    v_mul_u32_u24 v40, 288, v40
    v_lshl_add_u32 v40, v37, 2, v40
    s_lshl_b32 s27, s21, 6
    v_add_u32 v2, s27, v40
    v_mul_u32_u24 v40, 288, v38
    v_lshl_add_u32 v3, v36, 4, v40
    v_cndmask_b32_e64 v4, v3, 2.0, s[18:19]
    s_mul_i32 s27, s21, 32768
    s_add_u32 s27, s27, 32768
    v_add_u32 v5, s27, v0
    v_and_b32 v6, 0x200, v0
    v_bfe_u32 v40, v0, 6, 1
    v_lshl_or_b32 v6, v40, 8, v6
    v_bfe_u32 v40, v0, 4, 1
    v_lshl_or_b32 v6, v40, 7, v6
    v_bfe_u32 v40, v0, 5, 1
    v_lshl_or_b32 v6, v40, 6, v6
    v_bfe_u32 v40, v0, 8, 1
    v_lshl_or_b32 v6, v40, 5, v6
    v_bfe_u32 v40, v0, 7, 1
    v_lshl_or_b32 v6, v40, 4, v6
    s_lshl_b32 s27, s21, 13
    s_lshl_b32 s28, s22, 5
    s_add_u32 s27, s27, s28
    s_add_u32 s27, s27, 135168
    v_lshrrev_b32 v40, 7, v0
    v_lshlrev_b32 v40, 10, v40
    v_lshl_add_u32 v40, v38, 2, v40
    v_add_u32 v7, s27, v40
    v_lshlrev_b32 v8, 3, v0
    v_lshrrev_b32 v40, 7, v0
    v_mul_u32_u24 v40, 4224, v40
    v_lshl_add_u32 v9, v38, 4, v40
    s_mul_i32 s34, s20, 671744
    s_add_u32 s34, s34, 172228608
    s_lshl_b32 s35, s21, 10
    s_mul_i32 s27, s22, 4224
    s_add_u32 s35, s35, s27
    s_and_b32 s27, s22, 1
    s_bfe_u32 s28, s22, 0x10001
    s_bfe_u32 s29, s22, 0x10002
    s_lshl_b32 s30, s27, 2
    s_lshl_b32 s31, s28, 1
    s_or_b32 s30, s30, s31
    s_or_b32 s30, s30, s29
    s_and_b32 s31, s22, 0x18
    s_or_b32 s30, s30, s31
    s_lshl_b32 s33, s30, 7
    s_lshl_b32 s32, s22, 7
    s_cmp_eq_u32 s21, 0
    s_cbranch_scc1 main_kernel_c_r0
    s_lshl_b32 s32, s22, 10
    s_add_u32 s32, s32, 135168
    s_lshl_b32 s33, s27, 4
    s_lshl_b32 s28, s28, 8
    s_or_b32 s33, s33, s28
    s_lshl_b32 s29, s29, 7
    s_or_b32 s33, s33, s29
    s_bfe_u32 s28, s22, 0x10003
    s_lshl_b32 s28, s28, 5
    s_or_b32 s33, s33, s28
    s_bfe_u32 s28, s22, 0x10004
    s_lshl_b32 s28, s28, 9
    s_or_b32 s33, s33, s28
    s_add_u32 s33, s33, 4096
main_kernel_c_r0:
    s_mul_i32 s41, s20, 20480
    s_add_u32 s41, s41, 173572736
    s_lshl_b32 s46, s20, 17
    s_add_u32 s46, s46, 171966464
    s_add_u32 s46, s46, s25
    s_xor_b32 s47, s46, 0x20000
    s_mov_b32 s38, 0x00ff00ff
    s_mov_b32 s39, 0
    s_mov_b32 s62, 0x00030003
    s_mov_b32 s63, 0x00030003
    s_mov_b32 s40, 0x3e0293ee
    s_movk_i32 s45, 0x3f80
    s_mov_b32 s68, 0x33800000
    s_mov_b32 s69, 0x18000000
    s_lshl_b32 s51, s22, 7
    s_add_u32 s52, s51, 167895040
    s_lshl_b32 s51, s22, 8
    s_add_u32 s51, s51, 167886848
    s_mov_b32 s24, 0x3f803f80
    s_mov_b32 s25, 0x3f803f80
    s_mov_b32 s16, 0x3f003f00
    s_mov_b32 s17, 0x3f003f00
    s_lshl_b32 s53, s22, 13
    s_add_u32 s53, s53, 218103808
    s_lshl_b32 s27, s20, 12
    s_add_u32 s53, s53, s27
    s_lshl_b32 s27, s20, 2
    s_add_u32 s52, s52, s27
    s_cmp_eq_u32 s20, 0
    s_cselect_b64 s[42:43], -1, 0
    s_mov_b32 s44, 0
    s_mov_b32 s54, 0
    s_mov_b32 s71, 0
    s_mov_b32 s4, 0x10000000
    s_mov_b32 s60, 0x10000000
    s_mov_b32 s64, 0x10000000
    s_mov_b32 s65, 0x10000000
    s_waitcnt vmcnt(0) lgkmcnt(0)
    s_barrier
    s_cmp_lg_u32 s23, 0
    s_cbranch_scc1 main_kernel_c_slow
    s_cmp_eq_u32 s21, 1
    s_cbranch_scc1 main_kernel_c0_1_layer
    s_cmp_eq_u32 s21, 2
    s_cbranch_scc1 main_kernel_c0_2_layer
    s_cmp_eq_u32 s21, 3
    s_cbranch_scc1 main_kernel_c0_3_layer
main_kernel_c0_0_layer:
    s_lshr_b32 s27, s44, 6
    s_mul_i32 s50, s27, 33554432
    s_lshl_b32 s27, s22, 13
    s_add_u32 s50, s50, s27
    s_add_u32 s50, s50, 37748736
    s_add_u32 s27, s44, 1
    s_or_b32 s28, s44, 63
    s_add_u32 s28, s28, 1
    s_min_u32 s27, s27, s28
    s_cmp_lt_u32 s54, s27
    s_cbranch_scc1 main_kernel_c0_0_p1
main_kernel_c0_0_p1_r:
    s_barrier
    s_and_b32 s26, s44, 63
    s_lshl_b32 s26, s26, 18
    s_add_u32 s26, s26, s50
    s_mul_i32 s27, s20, 5120
    s_add_u32 s48, s27, 167772160
    s_sub_u32 s49, 167777280, s27
    s_and_b32 s2, s44, 63
    s_add_u32 s2, s2, 1
    s_min_u32 s2, s2, 63
    s_lshl_b32 s2, s2, 18
    s_add_u32 s2, s2, s50
    s_add_u32 s27, s44, 2
    s_cmp_ge_u32 s54, s27
    s_cselect_b32 s2, s2, 0x10000000
    s_add_u32 s3, s2, 16777216
    ds_read_b128 v[56:59], v5 offset:0
    ds_read_b128 v[60:63], v5 offset:1024
    ds_read_b128 v[64:67], v5 offset:2048
    ds_read_b128 v[68:71], v5 offset:3072
    v_mov_b64 v[12:13], 0
    v_mov_b64 v[14:15], 0
    v_mov_b64 v[16:17], 0
    v_mov_b64 v[18:19], 0
    v_mov_b64 v[20:21], 0
    v_mov_b64 v[22:23], 0
    v_mov_b64 v[24:25], 0
    v_mov_b64 v[26:27], 0
    v_mov_b64 v[28:29], 0
    v_mov_b64 v[30:31], 0
    v_mov_b64 v[32:33], 0
    v_mov_b64 v[34:35], 0
    s_mov_b32 s70, 0
    s_waitcnt lgkmcnt(0)
main_kernel_c0_0_top:
    s_barrier
    ds_read_b128 v[36:39], v6 offset:21504
    ds_read_b128 v[40:43], v6 offset:22528
    ds_read_b128 v[44:47], v6 offset:23552
    ds_read_b128 v[48:51], v6 offset:24576
    ds_read_b128 v[52:55], v6 offset:25600
    s_mov_b32 m0, 16384
    s_nop 0
    buffer_load_dwordx4 v0, s[8:11], s49 offen offset:0 sc1 lds
    buffer_load_dwordx4 v0, s[8:11], s49 offen offset:1024 sc1 lds
main_kernel_c0_0_lr_r:
    s_waitcnt lgkmcnt(4)
    v_smfmac_f32_16x16x64_bf16 v[20:23], v[36:39], v[56:63], v1
    ds_read_b128 v[56:59], v5 offset:4096
    v_smfmac_f32_16x16x64_bf16 v[24:27], v[36:39], a[248:255], v1
    ds_read_b128 v[60:63], v5 offset:5120
    v_smfmac_f32_16x16x64_bf16 v[28:31], v[36:39], a[240:247], v1
    v_smfmac_f32_16x16x64_bf16 v[32:35], v[36:39], v[64:71], v1
    ds_read_b128 v[64:67], v5 offset:6144
    v_smfmac_f32_16x16x64_bf16 v[12:15], v[36:39], a[232:239], v1
    ds_read_b128 v[68:71], v5 offset:7168
    s_waitcnt lgkmcnt(6)
    v_max3_u32 v10, v36, v40, v44
    v_smfmac_f32_16x16x64_bf16 v[16:19], v[36:39], a[224:231], v1
    s_waitcnt lgkmcnt(4)
    s_waitcnt lgkmcnt(2)
    v_max3_u32 v10, v10, v48, v52
    v_smfmac_f32_16x16x64_bf16 v[20:23], v[40:43], v[56:63], v1
    ds_read_b128 v[56:59], v5 offset:8192
    v_cmp_eq_u32 vcc, -1, v10
    v_smfmac_f32_16x16x64_bf16 v[24:27], v[40:43], a[216:223], v1
    ds_read_b128 v[60:63], v5 offset:9216
    s_cbranch_vccnz main_kernel_c0_0_lr
    v_smfmac_f32_16x16x64_bf16 v[28:31], v[40:43], a[208:215], v1
    s_and_b32 s55, s44, 3
    s_mul_i32 s55, s55, 167936
    s_waitcnt lgkmcnt(2)
    v_smfmac_f32_16x16x64_bf16 v[32:35], v[40:43], v[64:71], v1
    ds_read_b128 v[64:67], v5 offset:10240
    s_add_u32 s55, s55, s34
    s_add_u32 s56, s55, s35
    v_smfmac_f32_16x16x64_bf16 v[20:23], v[44:47], a[200:207], v1
    ds_read_b128 v[68:71], v5 offset:11264
    s_and_b32 s57, s44, 63
    v_smfmac_f32_16x16x64_bf16 v[24:27], v[44:47], a[192:199], v1
    s_add_u32 s43, s55, s32
    s_waitcnt lgkmcnt(2)
    v_smfmac_f32_16x16x64_bf16 v[28:31], v[44:47], v[56:63], v1
    ds_read_b128 v[56:59], v5 offset:12288
    s_add_u32 s61, s43, 33792
    s_add_u32 s100, s43, 67584
    v_smfmac_f32_16x16x64_bf16 v[32:35], v[44:47], a[184:191], v1
    ds_read_b128 v[60:63], v5 offset:13312
    s_add_u32 s101, s43, 101376
    v_smfmac_f32_16x16x64_bf16 v[20:23], v[48:51], a[176:183], v1
    s_waitcnt lgkmcnt(2)
    v_smfmac_f32_16x16x64_bf16 v[24:27], v[48:51], v[64:71], v1
    ds_read_b128 v[64:67], v5 offset:14336
    v_smfmac_f32_16x16x64_bf16 v[28:31], v[48:51], a[168:175], v1
    ds_read_b128 v[68:71], v5 offset:15360
    v_smfmac_f32_16x16x64_bf16 v[32:35], v[48:51], a[160:167], v1
    s_mov_b32 m0, 0
    s_nop 0
    buffer_load_dwordx4 v0, s[8:11], s26 offen offset:0 sc1 lds
    buffer_load_dwordx4 v0, s[8:11], s26 offen offset:1024 sc1 lds
    buffer_store_dwordx4 v[72:75], v0, s[8:11], s64 offen offset:0
    buffer_store_dwordx4 v[72:75], v0, s[8:11], s64 offen offset:1024
    s_mov_b64 exec, 0x3ff
    buffer_store_dwordx4 v[72:75], v0, s[8:11], s60 offen
    s_mov_b64 exec, -1
    s_mov_b32 s60, 0x10000000
    s_mov_b32 s64, 0x10000000
    s_waitcnt vmcnt(5)
    s_barrier
    ds_read_b128 v[36:39], v6 offset:16384
    ds_read_b128 v[40:43], v6 offset:17408
    ds_read_b128 v[44:47], v6 offset:18432
    ds_read_b128 v[48:51], v6 offset:19456
    ds_read_b32 v11, v6 offset:20480
    s_waitcnt lgkmcnt(7)
    v_smfmac_f32_16x16x64_bf16 v[20:23], v[52:55], v[56:63], v1
    ds_read_b128 v[56:59], v5 offset:16384
    v_smfmac_f32_16x16x64_bf16 v[24:27], v[52:55], a[152:159], v1
    ds_read_b128 v[60:63], v5 offset:17408
    v_smfmac_f32_16x16x64_bf16 v[28:31], v[52:55], a[144:151], v1
    s_waitcnt lgkmcnt(4)
    v_max3_u32 v10, v36, v40, v44
    v_smfmac_f32_16x16x64_bf16 v[32:35], v[52:55], v[64:71], v1
    s_waitcnt lgkmcnt(2)
    v_max3_u32 v10, v10, v48, v11
    v_cmp_eq_u32 vcc, -1, v10
    s_cbranch_vccnz main_kernel_c0_0_rr
main_kernel_c0_0_rr_r:
    ds_read_b128 v[52:55], v6 offset:20480
    v_smfmac_f32_16x16x64_bf16 v[20:23], v[36:39], a[136:143], v1
    ds_read_b128 v[64:67], v5 offset:18432
    v_smfmac_f32_16x16x64_bf16 v[24:27], v[36:39], a[128:135], v1
    ds_read_b128 v[68:71], v5 offset:19456
    s_waitcnt lgkmcnt(3)
    v_smfmac_f32_16x16x64_bf16 v[20:23], v[40:43], v[56:63], v1
    ds_read_b128 v[56:59], v5 offset:20480
    v_smfmac_f32_16x16x64_bf16 v[24:27], v[40:43], a[120:127], v1
    ds_read_b128 v[60:63], v5 offset:21504
    s_mov_b32 m0, 31488
    s_mov_b64 exec, 3
    buffer_load_dword v8, s[8:11], s51 offen sc1 lds
    s_mov_b64 exec, -1
    s_mov_b32 m0, 31232
    s_nop 0
    buffer_load_dword v8, s[8:11], s2 offen sc1 lds
    buffer_load_dword v8, s[8:11], s3 offen sc1 lds
    v_smfmac_f32_16x16x64_bf16 v[20:23], v[44:47], a[112:119], v1
    s_waitcnt lgkmcnt(2)
    v_smfmac_f32_16x16x64_bf16 v[24:27], v[44:47], v[64:71], v1
    ds_read_b128 v[64:67], v5 offset:22528
    v_smfmac_f32_16x16x64_bf16 v[20:23], v[48:51], a[104:111], v1
    ds_read_b128 v[68:71], v5 offset:23552
    v_smfmac_f32_16x16x64_bf16 v[24:27], v[48:51], a[96:103], v1
    s_waitcnt lgkmcnt(2)
    v_smfmac_f32_16x16x64_bf16 v[20:23], v[52:55], v[56:63], v1
    ds_read_b128 v[56:59], v5 offset:24576
    v_smfmac_f32_16x16x64_bf16 v[24:27], v[52:55], a[88:95], v1
    ds_read_b128 v[60:63], v5 offset:25600
    v_smfmac_f32_16x16x64_bf16 v[28:31], v[36:39], a[80:87], v1
    s_waitcnt lgkmcnt(2)
    v_smfmac_f32_16x16x64_bf16 v[32:35], v[36:39], v[64:71], v1
    ds_read_b128 v[64:67], v5 offset:26624
    s_nop 0
    v_permlane32_swap_b32 v20, v21
    v_smfmac_f32_16x16x64_bf16 v[28:31], v[40:43], a[72:79], v1
    ds_read_b128 v[68:71], v5 offset:27648
    v_permlane32_swap_b32 v22, v23
    v_smfmac_f32_16x16x64_bf16 v[32:35], v[40:43], a[64:71], v1
    s_waitcnt lgkmcnt(2)
    v_permlane32_swap_b32 v24, v25
    v_smfmac_f32_16x16x64_bf16 v[28:31], v[44:47], v[56:63], v1
    ds_read_b128 v[56:59], v5 offset:28672
    v_permlane32_swap_b32 v26, v27
    v_smfmac_f32_16x16x64_bf16 v[32:35], v[44:47], a[56:63], v1
    ds_read_b128 v[60:63], v5 offset:29696
    v_add_f32 v20, v20, v21
    v_add_f32 v22, v22, v23
    v_smfmac_f32_16x16x64_bf16 v[28:31], v[48:51], a[48:55], v1
    s_waitcnt lgkmcnt(2)
    v_add_f32 v24, v24, v25
    v_add_f32 v26, v26, v27
    v_smfmac_f32_16x16x64_bf16 v[32:35], v[48:51], v[64:71], v1
    ds_read_b128 v[64:67], v5 offset:30720
    v_mul_f32 v20, s40, v20
    v_mul_f32 v24, s40, v24
    v_smfmac_f32_16x16x64_bf16 v[28:31], v[52:55], a[40:47], v1
    ds_read_b128 v[68:71], v5 offset:31744
    v_mul_f32 v22, s40, v22
    v_mul_f32 v26, s40, v26
    v_smfmac_f32_16x16x64_bf16 v[32:35], v[52:55], a[32:39], v1
    s_waitcnt lgkmcnt(2)
    v_cvt_pk_bf16_f32 v20, v20, v24
    v_cvt_pk_bf16_f32 v21, v22, v26
    v_smfmac_f32_16x16x64_bf16 v[12:15], v[36:39], v[56:63], v1
    ds_write_b32 v2, v20 offset:26624
    ds_write_b32 v2, v21 offset:27200
    v_smfmac_f32_16x16x64_bf16 v[16:19], v[36:39], a[24:31], v1
    v_permlane32_swap_b32 v28, v29
    v_smfmac_f32_16x16x64_bf16 v[12:15], v[40:43], a[16:23], v1
    s_waitcnt lgkmcnt(2)
    v_permlane32_swap_b32 v30, v31
    v_smfmac_f32_16x16x64_bf16 v[16:19], v[40:43], v[64:71], v1
    ds_read_b128 v[40:43], v6 offset:22528
    v_permlane32_swap_b32 v32, v33
    v_smfmac_f32_16x16x64_bf16 v[12:15], v[44:47], a[8:15], v1
    v_permlane32_swap_b32 v34, v35
    v_smfmac_f32_16x16x64_bf16 v[16:19], v[44:47], a[0:7], v1
    ds_read_b128 v[44:47], v6 offset:23552
    v_add_f32 v28, v28, v29
    v_add_f32 v30, v30, v31
    v_smfmac_f32_16x16x64_bf16 v[12:15], v[48:51], v[248:255], v1
    v_add_f32 v32, v32, v33
    v_add_f32 v34, v34, v35
    v_smfmac_f32_16x16x64_bf16 v[16:19], v[48:51], v[240:247], v1
    ds_read_b128 v[48:51], v6 offset:24576
    v_cvt_pk_bf16_f32 v28, v28, v32
    v_cvt_pk_bf16_f32 v29, v30, v34
    v_smfmac_f32_16x16x64_bf16 v[12:15], v[52:55], v[232:239], v1
    ds_write_b32 v2, v28 offset:28928
    ds_write_b32 v2, v29 offset:29504
    v_smfmac_f32_16x16x64_bf16 v[16:19], v[52:55], v[224:231], v1
    ds_read_b128 v[52:55], v6 offset:25600
    s_waitcnt lgkmcnt(5)
    v_smfmac_f32_16x16x64_bf16 v[12:15], v[40:43], v[216:223], v1
    v_smfmac_f32_16x16x64_bf16 v[16:19], v[40:43], v[208:215], v1
    s_waitcnt vmcnt(3) lgkmcnt(1)
    s_barrier
    ds_read_b128 v[56:59], v0 offset:0
    ds_read_b128 v[20:23], v4 offset:26624
    v_smfmac_f32_16x16x64_bf16 v[12:15], v[44:47], v[200:207], v1
    ds_read_b128 v[60:63], v0 offset:1024
    ds_read_b128 v[24:27], v4 offset:26688
    v_smfmac_f32_16x16x64_bf16 v[16:19], v[44:47], v[192:199], v1
    ds_read_b128 v[64:67], v0 offset:2048
    ds_read_b128 v[72:75], v4 offset:26752
    v_smfmac_f32_16x16x64_bf16 v[12:15], v[48:51], v[184:191], v1
    ds_read_b128 v[68:71], v0 offset:3072
    ds_read_b128 v[76:79], v4 offset:26816
    v_smfmac_f32_16x16x64_bf16 v[16:19], v[48:51], v[176:183], v1
    ds_read_b128 v[36:39], v0 offset:4096
    ds_read_b128 v[40:43], v0 offset:5120
    s_waitcnt lgkmcnt(10)
    v_smfmac_f32_16x16x64_bf16 v[12:15], v[52:55], v[168:175], v1
    ds_read_b128 v[44:47], v0 offset:6144
    ds_read_b128 v[48:51], v0 offset:7168
    v_smfmac_f32_16x16x64_bf16 v[16:19], v[52:55], v[160:167], v1
    s_waitcnt lgkmcnt(10)
    v_mfma_f32_16x16x32_bf16 v[28:31], v[56:59], v[20:23], 0
    s_waitcnt lgkmcnt(8)
    v_mfma_f32_16x16x32_bf16 v[28:31], v[60:63], v[24:27], v[28:31]
    s_nop 0
    s_waitcnt lgkmcnt(6)
    v_cvt_pk_bf16_f32 v12, v12, v13
    v_cvt_pk_bf16_f32 v13, v14, v15
    v_mfma_f32_16x16x32_bf16 v[28:31], v[64:67], v[72:75], v[28:31]
    s_waitcnt lgkmcnt(4)
    v_cvt_pk_bf16_f32 v14, v16, v17
    v_cvt_pk_bf16_f32 v15, v18, v19
    v_mfma_f32_16x16x32_bf16 v[28:31], v[68:71], v[76:79], v[28:31]
    ds_write_b128 v0, v[12:15] offset:16384
    s_waitcnt lgkmcnt(4)
    v_mfma_f32_16x16x32_bf16 v[32:35], v[36:39], v[20:23], 0
    ds_read_b128 v[56:59], v3 offset:28928
    ds_read_b128 v[60:63], v3 offset:28992
    s_waitcnt lgkmcnt(5)
    v_mfma_f32_16x16x32_bf16 v[32:35], v[40:43], v[24:27], v[32:35]
    ds_read_b128 v[64:67], v3 offset:29056
    ds_read_b128 v[68:71], v3 offset:29120
    s_waitcnt lgkmcnt(6)
    v_mfma_f32_16x16x32_bf16 v[32:35], v[44:47], v[72:75], v[32:35]
    s_mov_b64 exec, s[36:37]
    v_exp_f32 v28, v28
    v_exp_f32 v29, v29
    s_mov_b64 exec, -1
    s_waitcnt lgkmcnt(5)
    v_mfma_f32_16x16x32_bf16 v[32:35], v[48:51], v[76:79], v[32:35]
    s_mov_b64 exec, s[36:37]
    v_exp_f32 v30, v30
    v_exp_f32 v31, v31
    s_mov_b64 exec, -1
    s_waitcnt lgkmcnt(4)
    s_barrier
    s_waitcnt lgkmcnt(3)
    v_mfma_f32_16x16x32_bf16 v[52:55], v[56:59], v[20:23], 0
    ds_read_b128 v[36:39], v0 offset:8192
    s_waitcnt lgkmcnt(3)
    v_cvt_pk_bf16_f32 v28, v28, v29
    v_cvt_pk_bf16_f32 v29, v30, v31
    v_mfma_f32_16x16x32_bf16 v[52:55], v[60:63], v[24:27], v[52:55]
    ds_read_b128 v[40:43], v0 offset:10240
    s_mov_b64 exec, s[36:37]
    v_exp_f32 v32, v32
    v_exp_f32 v33, v33
    s_mov_b64 exec, -1
    s_waitcnt lgkmcnt(3)
    v_mfma_f32_16x16x32_bf16 v[52:55], v[64:67], v[72:75], v[52:55]
    ds_read_b128 v[44:47], v0 offset:12288
    s_mov_b64 exec, s[36:37]
    v_exp_f32 v34, v34
    v_exp_f32 v35, v35
    s_mov_b64 exec, -1
    s_waitcnt lgkmcnt(3)
    v_mfma_f32_16x16x32_bf16 v[52:55], v[68:71], v[76:79], v[52:55]
    ds_read_b128 v[48:51], v0 offset:14336
    v_cvt_pk_bf16_f32 v30, v32, v33
    v_cvt_pk_bf16_f32 v31, v34, v35
    s_cmp_eq_u32 s57, 63
    s_cbranch_scc1 main_kernel_c0_0_last
    s_waitcnt lgkmcnt(3)
    v_mfma_f32_16x16x32_bf16 v[20:23], v[36:39], v[28:31], 0
    ds_read_b128 v[56:59], v0 offset:9216
    s_waitcnt lgkmcnt(3)
    v_mov_b32_dpp v32, v28 row_ror:8 row_mask:0xf bank_mask:0xf
    v_mov_b32_dpp v33, v29 row_ror:8 row_mask:0xf bank_mask:0xf
    v_mfma_f32_16x16x32_bf16 v[24:27], v[40:43], v[28:31], 0
    ds_read_b128 v[60:63], v0 offset:11264
    s_waitcnt lgkmcnt(3)
    v_mov_b32_dpp v34, v30 row_ror:8 row_mask:0xf bank_mask:0xf
    v_mov_b32_dpp v35, v31 row_ror:8 row_mask:0xf bank_mask:0xf
    v_mfma_f32_16x16x32_bf16 v[72:75], v[44:47], v[28:31], 0
    ds_read_b128 v[64:67], v0 offset:13312
    s_waitcnt lgkmcnt(3)
    v_mov_b64 v[16:17], s[24:25]
    v_mov_b64 v[18:19], s[24:25]
    v_mfma_f32_16x16x32_bf16 v[76:79], v[48:51], v[28:31], 0
    ds_read_b128 v[68:71], v0 offset:15360
    s_mov_b64 exec, s[36:37]
    v_exp_f32 v52, v52
    s_mov_b64 exec, -1
    v_mfma_f32_16x16x32_bf16 v[12:15], v[16:19], v[28:31], 0
    ds_read_b128 v[36:39], v0 offset:16384
    s_mov_b64 exec, s[36:37]
    v_exp_f32 v53, v53
    s_mov_b64 exec, -1
    s_waitcnt lgkmcnt(4)
    v_mfma_f32_16x16x32_bf16 v[20:23], v[56:59], v[32:35], v[20:23]
    ds_read_b128 v[40:43], v0 offset:17408
    s_mov_b64 exec, s[36:37]
    v_exp_f32 v54, v54
    s_mov_b64 exec, -1
    s_waitcnt lgkmcnt(4)
    v_mfma_f32_16x16x32_bf16 v[24:27], v[60:63], v[32:35], v[24:27]
    ds_read_b128 v[44:47], v0 offset:18432
    s_mov_b64 exec, s[36:37]
    v_exp_f32 v55, v55
    s_mov_b64 exec, -1
    s_waitcnt lgkmcnt(4)
    v_mfma_f32_16x16x32_bf16 v[72:75], v[64:67], v[32:35], v[72:75]
    ds_read_b128 v[48:51], v0 offset:19456
    s_waitcnt lgkmcnt(4)
    v_cvt_pk_bf16_f32 v52, v52, v53
    v_cvt_pk_bf16_f32 v53, v54, v55
    v_mfma_f32_16x16x32_bf16 v[76:79], v[68:71], v[32:35], v[76:79]
    v_mov_b64 v[10:11], s[16:17]
    v_mov_b32_dpp v54, v52 row_ror:8 row_mask:0xf bank_mask:0xf
main_kernel_c0_0_fin:
    s_waitcnt lgkmcnt(3)
    v_mfma_f32_16x16x16_bf16 v[20:23], v[36:37], v[52:53], v[20:23]
    v_mov_b32_dpp v55, v53 row_ror:8 row_mask:0xf bank_mask:0xf
    v_mov_b64 v[56:57], 0
    v_mfma_f32_16x16x16_bf16 v[12:15], v[10:11], v[52:53], v[12:15]
    s_waitcnt lgkmcnt(2)
    v_mov_b64 v[58:59], 0
    v_mov_b64 v[60:61], 0
    v_mfma_f32_16x16x16_bf16 v[24:27], v[40:41], v[52:53], v[24:27]
    v_mov_b64 v[62:63], 0
    v_mov_b64 v[64:65], 0
    v_mfma_f32_16x16x16_bf16 v[20:23], v[38:39], v[54:55], v[20:23]
    v_mov_b64 v[66:67], 0
    v_mov_b64 v[68:69], 0
    v_mfma_f32_16x16x16_bf16 v[24:27], v[42:43], v[54:55], v[24:27]
    s_waitcnt lgkmcnt(1)
    v_add_f32_dpp v12, v12, v12 row_ror:8 row_mask:0xf bank_mask:0xf
    v_mov_b64 v[70:71], 0
    v_mfma_f32_16x16x16_bf16 v[72:75], v[44:45], v[52:53], v[72:75]
    s_waitcnt lgkmcnt(0)
    v_rcp_f32 v14, v12
    v_mfma_f32_16x16x16_bf16 v[76:79], v[48:49], v[52:53], v[76:79]
    v_subrev_u32 v13, s68, v12
    v_cmp_lt_u32 vcc, s69, v13
    v_mfma_f32_16x16x16_bf16 v[72:75], v[46:47], v[54:55], v[72:75]
    s_cbranch_vccnz main_kernel_c0_0_zbad
main_kernel_c0_0_zok:
    v_mov_b64 v[28:29], 0
    v_mov_b64 v[30:31], 0
    v_mfma_f32_16x16x16_bf16 v[76:79], v[50:51], v[54:55], v[76:79]
    v_mul_f32 v20, v20, v14
    v_mul_f32 v21, v21, v14
    v_mul_f32 v22, v22, v14
    v_mul_f32 v23, v23, v14
    v_mul_f32 v24, v24, v14
    v_mul_f32 v25, v25, v14
    v_mul_f32 v26, v26, v14
    v_mul_f32 v27, v27, v14
    v_cvt_pk_bf16_f32 v20, v20, v21
    v_cvt_pk_bf16_f32 v21, v22, v23
    v_cvt_pk_bf16_f32 v22, v24, v25
    v_cvt_pk_bf16_f32 v23, v26, v27
    v_mul_f32 v72, v72, v14
    v_mul_f32 v73, v73, v14
    v_smfmac_f32_16x16x64_bf16 v[56:59], v[20:23], v[152:159], v1
    v_mul_f32 v74, v74, v14
    v_mul_f32 v75, v75, v14
    v_mul_f32 v76, v76, v14
    v_smfmac_f32_16x16x64_bf16 v[60:63], v[20:23], v[136:143], v1
    v_mul_f32 v77, v77, v14
    v_mul_f32 v78, v78, v14
    v_mul_f32 v79, v79, v14
    v_smfmac_f32_16x16x64_bf16 v[64:67], v[20:23], v[120:127], v1
    v_cvt_pk_bf16_f32 v72, v72, v73
    v_cvt_pk_bf16_f32 v73, v74, v75
    v_cvt_pk_bf16_f32 v74, v76, v77
    v_smfmac_f32_16x16x64_bf16 v[68:71], v[20:23], v[104:111], v1
    v_cvt_pk_bf16_f32 v75, v78, v79
    v_smfmac_f32_16x16x64_bf16 v[28:31], v[20:23], v[88:95], v1
    s_nop 0
    v_smfmac_f32_16x16x64_bf16 v[56:59], v[72:75], v[144:151], v1
    v_smfmac_f32_16x16x64_bf16 v[60:63], v[72:75], v[128:135], v1
    v_smfmac_f32_16x16x64_bf16 v[64:67], v[72:75], v[112:119], v1
    v_mov_b32 v5, v5
    v_mov_b32 v5, v5
    v_permlane32_swap_b32 v56, v57
    v_smfmac_f32_16x16x64_bf16 v[68:71], v[72:75], v[96:103], v1
    v_permlane32_swap_b32 v58, v59
    v_smfmac_f32_16x16x64_bf16 v[28:31], v[72:75], v[80:87], v1
    v_add_f32 v56, v56, v57
    v_add_f32 v58, v58, v59
    v_permlane32_swap_b32 v60, v61
    v_permlane32_swap_b32 v62, v63
    v_add_f32 v60, v60, v61
    v_add_f32 v62, v62, v63
    v_cvt_pk_bf16_f32 v36, v56, v60
    v_cvt_pk_bf16_f32 v38, v58, v62
    v_permlane32_swap_b32 v64, v65
    v_permlane32_swap_b32 v66, v67
    v_add_f32 v64, v64, v65
    v_add_f32 v66, v66, v67
    v_permlane32_swap_b32 v68, v69
    v_permlane32_swap_b32 v70, v71
    v_add_f32 v68, v68, v69
    v_add_f32 v70, v70, v71
    v_cvt_pk_bf16_f32 v37, v64, v68
    v_cvt_pk_bf16_f32 v39, v66, v70
    buffer_store_dwordx4 v[36:39], v0, s[8:11], s56 offen
    v_permlane32_swap_b32 v28, v29
    v_permlane32_swap_b32 v30, v31
    v_add_f32 v28, v28, v29
    v_add_f32 v30, v30, v31
    v_cvt_pk_bf16_f32 v28, v28, v30
    buffer_store_dword v28, v7, s[8:11], s55 offen
    v_and_b32 v32, 16, v0
    v_bfe_u32 v33, v0, 5, 2
    v_lshlrev_b32_e64 v32, v32, s45
    v_cmp_eq_u32_e64 s[64:65], 0, v33
    v_cmp_eq_u32_e64 s[66:67], 1, v33
    s_add_u32 s27, s44, 1
    s_and_b32 s27, s27, 3
    v_cndmask_b32_e64 v72, 0, v32, s[64:65]
    v_cndmask_b32_e64 v73, 0, v32, s[66:67]
    v_cmp_eq_u32_e64 s[64:65], 2, v33
    v_cmp_eq_u32_e64 s[66:67], 3, v33
    s_mul_i32 s48, s27, 5120
    s_add_u32 s48, s48, s41
    v_cndmask_b32_e64 v74, 0, v32, s[64:65]
    v_cndmask_b32_e64 v75, 0, v32, s[66:67]
    s_lshl_b32 s27, s27, 15
    s_add_u32 s49, s27, s47
    v_bfe_u32 v11, v0, 4, 3
    v_lshlrev_b32 v11, 3, v11
    v_lshrrev_b32 v32, 8, v0
    v_lshl_add_u32 v11, v32, 6, v11
    s_add_u32 s56, s27, s46
    s_add_u32 s56, s56, s33
    s_add_u32 s58, s48, s33
    v_mov_b32 v5, v5
    s_nop 1
    v_mov_b32 v5, v5
    s_nop 1
    v_mov_b32 v5, v5
    s_nop 1
    v_mov_b32 v5, v5
    s_nop 1
    v_mov_b32 v5, v5
    s_nop 1
    v_mov_b32 v5, v5
    s_nop 1
    v_mov_b32 v5, v5
    s_nop 1
    v_mov_b32 v5, v5
    s_nop 1
    buffer_load_dwordx4 v[40:43], v9, s[8:11], s43 offen sc1
    buffer_load_dwordx4 v[44:47], v9, s[8:11], s61 offen sc1
    buffer_load_dwordx4 v[48:51], v9, s[8:11], s100 offen sc1
    buffer_load_dwordx4 v[52:55], v9, s[8:11], s101 offen sc1
    v_mov_b32 v5, v5
    s_nop 1
    v_mov_b32 v5, v5
    s_nop 1
    v_mov_b32 v5, v5
    s_nop 1
    v_mov_b32 v5, v5
    s_nop 1
    v_mov_b32 v5, v5
    s_nop 1
    v_mov_b32 v5, v5
    s_nop 1
    v_mov_b32 v5, v5
    s_nop 1
    v_mov_b32 v5, v5
    s_nop 1
    buffer_load_dwordx4 v[12:15], v9, s[8:11], s43 offen sc1
    buffer_load_dwordx4 v[16:19], v9, s[8:11], s61 offen sc1
    buffer_load_dwordx4 v[20:23], v9, s[8:11], s100 offen sc1
    buffer_load_dwordx4 v[24:27], v9, s[8:11], s101 offen sc1
    v_mov_b32 v5, v5
    s_nop 1
    v_mov_b32 v5, v5
    s_nop 1
    s_waitcnt vmcnt(7)
    v_mov_b32 v5, v5
    v_mov_b32 v5, v5
    v_mfma_f32_16x16x32_bf16 v[76:79], v[72:75], v[40:43], 0
    s_waitcnt vmcnt(6)
    v_mfma_f32_16x16x32_bf16 v[76:79], v[72:75], v[44:47], v[76:79]
    s_waitcnt vmcnt(5)
    v_mfma_f32_16x16x32_bf16 v[76:79], v[72:75], v[48:51], v[76:79]
    s_waitcnt vmcnt(4)
    v_mfma_f32_16x16x32_bf16 v[76:79], v[72:75], v[52:55], v[76:79]
    v_max3_u32 v32, v40, v44, v48
    v_max_u32 v32, v32, v52
    v_cmp_eq_u32 vcc, -1, v32
    s_cbranch_vccnz main_kernel_c0_0_wrb_i0
    v_mov_b32 v5, v5
    v_mov_b32 v5, v5
    v_mov_b32 v5, v5
    v_mov_b32 v5, v5
    v_add_f32_dpp v76, v76, v76 row_ror:8 row_mask:0xf bank_mask:0xf
    v_add_f32_dpp v77, v77, v77 row_ror:8 row_mask:0xf bank_mask:0xf
    v_add_f32_dpp v78, v78, v78 row_ror:8 row_mask:0xf bank_mask:0xf
    v_add_f32_dpp v79, v79, v79 row_ror:8 row_mask:0xf bank_mask:0xf
    v_cmp_u_f32 vcc, v76, v76
    v_cvt_pk_bf16_f32 v76, v76, v77
    v_cvt_pk_bf16_f32 v77, v78, v79
    s_cbranch_vccnz main_kernel_c0_0_wrb_e0
    s_mov_b64 exec, s[38:39]
    buffer_store_dwordx2 v[76:77], v11, s[8:11], s58 offen
main_kernel_c0_0_wrb_d:
    s_barrier
    buffer_store_dwordx2 v[76:77], v11, s[8:11], s56 offen sc1
    s_mov_b64 exec, -1
    s_waitcnt vmcnt(2)
    ds_read_b128 v[56:59], v5 offset:0
    ds_read_b128 v[60:63], v5 offset:1024
    ds_read_b128 v[64:67], v5 offset:2048
    ds_read_b128 v[68:71], v5 offset:3072
    v_mov_b64 v[12:13], 0
    v_mov_b64 v[14:15], 0
    v_mov_b64 v[16:17], 0
    v_mov_b64 v[18:19], 0
    v_mov_b64 v[20:21], 0
    v_mov_b64 v[22:23], 0
    v_mov_b64 v[24:25], 0
    v_mov_b64 v[26:27], 0
    v_mov_b64 v[28:29], 0
    v_mov_b64 v[30:31], 0
    v_mov_b64 v[32:33], 0
    v_mov_b64 v[34:35], 0
    ds_read_b64 v[72:73], v0 offset:31488
    s_waitcnt lgkmcnt(0)
    v_min_u32 v72, v72, v73
    s_nop 0
    v_readfirstlane_b32 s28, v72
    s_nop 0
    s_max_u32 s54, s54, s28
    s_add_u32 s27, s44, 2
    s_or_b32 s28, s44, 63
    s_add_u32 s28, s28, 1
    s_min_u32 s27, s27, s28
    s_cmp_lt_u32 s54, s27
    s_cbranch_scc1 main_kernel_c0_0_wkw
main_kernel_c0_0_wkw_r:
    s_and_b32 s2, s44, 63
    s_add_u32 s2, s2, 2
    s_min_u32 s2, s2, 63
    s_lshl_b32 s2, s2, 18
    s_add_u32 s2, s2, s50
    s_add_u32 s27, s44, 3
    s_cmp_ge_u32 s54, s27
    s_cselect_b32 s2, s2, 0x10000000
    s_add_u32 s3, s2, 16777216
    v_mov_b64 v[72:73], -1
    v_mov_b64 v[74:75], -1
    s_add_u32 s28, s44, 3
    s_and_b32 s29, s28, 3
    s_mul_i32 s31, s22, 160
    s_mul_i32 s28, s29, 167936
    s_add_u32 s28, s28, s34
    s_add_u32 s64, s28, s35
    s_mul_i32 s60, s29, 5120
    s_add_u32 s60, s60, s41
    s_add_u32 s60, s60, s31
    s_and_b32 s26, s44, 63
    s_add_u32 s26, s26, 1
    s_min_u32 s26, s26, 63
    s_lshl_b32 s26, s26, 18
    s_add_u32 s26, s26, s50
    s_nop 15
    s_nop 15
    s_nop 14
    s_mov_b32 m0, 21504
    s_nop 0
    buffer_load_dwordx4 v0, s[8:11], s48 offen offset:0 sc1 lds
    buffer_load_dwordx4 v0, s[8:11], s48 offen offset:1024 sc1 lds
    buffer_load_dwordx4 v0, s[8:11], s48 offen offset:2048 sc1 lds
    buffer_load_dwordx4 v0, s[8:11], s48 offen offset:3072 sc1 lds
    s_mov_b32 m0, 25600
    s_add_u32 s59, s48, 4096
    buffer_load_dwordx4 v0, s[8:11], s59 offen offset:0 sc1 lds
    s_add_u32 s44, s44, 1
    s_mov_b32 s70, 0
    s_branch main_kernel_c0_0_top
main_kernel_c0_0_restart:
    s_waitcnt vmcnt(0) lgkmcnt(0)
    s_nop 7
    s_barrier
    ds_read_b128 v[56:59], v5 offset:0
    ds_read_b128 v[60:63], v5 offset:1024
    ds_read_b128 v[64:67], v5 offset:2048
    ds_read_b128 v[68:71], v5 offset:3072
    v_mov_b64 v[12:13], 0
    v_mov_b64 v[14:15], 0
    v_mov_b64 v[16:17], 0
    v_mov_b64 v[18:19], 0
    v_mov_b64 v[20:21], 0
    v_mov_b64 v[22:23], 0
    v_mov_b64 v[24:25], 0
    v_mov_b64 v[26:27], 0
    v_mov_b64 v[28:29], 0
    v_mov_b64 v[30:31], 0
    v_mov_b64 v[32:33], 0
    v_mov_b64 v[34:35], 0
    s_waitcnt vmcnt(0) lgkmcnt(0)
    s_branch main_kernel_c0_0_top
main_kernel_c0_0_zbad:
    s_cmp_eq_u32 s70, 2
    s_cbranch_scc1 main_kernel_c0_0_zok
    v_cmp_u_f32 vcc, v12, v12
    s_cbranch_vccz main_kernel_c0_0_exact
    s_cmp_eq_u32 s70, 1
    s_cbranch_scc1 main_kernel_c0_0_exact
main_kernel_c0_0_vfy0:
    s_mov_b32 s70, 1
    s_mov_b32 s30, 0
    s_waitcnt vmcnt(0) lgkmcnt(0)
    s_nop 7
main_kernel_c0_0_vfy:
    v_mov_b32 v10, 0
    s_add_u32 s59, s48, 4096
    buffer_load_dwordx4 v[36:39], v0, s[8:11], s48 offen offset:0 sc1
    buffer_load_dwordx4 v[40:43], v0, s[8:11], s48 offen offset:1024 sc1
    buffer_load_dwordx4 v[44:47], v0, s[8:11], s48 offen offset:2048 sc1
    buffer_load_dwordx4 v[48:51], v0, s[8:11], s48 offen offset:3072 sc1
    buffer_load_dwordx4 v[52:55], v0, s[8:11], s59 offen offset:0 sc1
    s_waitcnt vmcnt(4)
    v_max3_u32 v10, v10, v36, v37
    v_max3_u32 v10, v10, v38, v39
    s_waitcnt vmcnt(3)
    v_max3_u32 v10, v10, v40, v41
    v_max3_u32 v10, v10, v42, v43
    s_waitcnt vmcnt(2)
    v_max3_u32 v10, v10, v44, v45
    v_max3_u32 v10, v10, v46, v47
    s_waitcnt vmcnt(1)
    v_max3_u32 v10, v10, v48, v49
    v_max3_u32 v10, v10, v50, v51
    s_waitcnt vmcnt(0)
    v_max3_u32 v10, v10, v52, v53
    v_max3_u32 v10, v10, v54, v55
    s_add_u32 s59, s49, 4096
    buffer_load_dwordx4 v[36:39], v0, s[8:11], s49 offen offset:0 sc1
    buffer_load_dwordx4 v[40:43], v0, s[8:11], s49 offen offset:1024 sc1
    buffer_load_dwordx4 v[44:47], v0, s[8:11], s49 offen offset:2048 sc1
    buffer_load_dwordx4 v[48:51], v0, s[8:11], s49 offen offset:3072 sc1
    buffer_load_dwordx4 v[52:55], v0, s[8:11], s59 offen offset:0 sc1
    s_waitcnt vmcnt(4)
    v_max3_u32 v10, v10, v36, v37
    v_max3_u32 v10, v10, v38, v39
    s_waitcnt vmcnt(3)
    v_max3_u32 v10, v10, v40, v41
    v_max3_u32 v10, v10, v42, v43
    s_waitcnt vmcnt(2)
    v_max3_u32 v10, v10, v44, v45
    v_max3_u32 v10, v10, v46, v47
    s_waitcnt vmcnt(1)
    v_max3_u32 v10, v10, v48, v49
    v_max3_u32 v10, v10, v50, v51
    s_waitcnt vmcnt(0)
    v_max3_u32 v10, v10, v52, v53
    v_max3_u32 v10, v10, v54, v55
    v_cmp_eq_u32 vcc, -1, v10
    s_cbranch_vccz main_kernel_c0_0_restart
    s_add_u32 s30, s30, 1
    s_cmp_ge_u32 s30, 60000
    s_cbranch_scc1 main_kernel_fail
    s_branch main_kernel_c0_0_vfy
main_kernel_c0_0_exact:
    s_nop 7
    s_mov_b32 s70, 2
    ds_read_b128 v[20:23], v3 offset:26624
    ds_read_b128 v[24:27], v3 offset:26688
    ds_read_b128 v[72:75], v3 offset:26752
    ds_read_b128 v[76:79], v3 offset:26816
    ds_read_b128 v[56:59], v0 offset:0
    s_waitcnt lgkmcnt(0)
    v_mfma_f32_16x16x32_bf16 v[28:31], v[56:59], v[20:23], 0
    s_nop 3
    ds_read_b128 v[60:63], v0 offset:1024
    s_waitcnt lgkmcnt(0)
    v_mfma_f32_16x16x32_bf16 v[28:31], v[60:63], v[24:27], v[28:31]
    s_nop 3
    ds_read_b128 v[56:59], v0 offset:2048
    s_waitcnt lgkmcnt(0)
    v_mfma_f32_16x16x32_bf16 v[28:31], v[56:59], v[72:75], v[28:31]
    s_nop 3
    ds_read_b128 v[60:63], v0 offset:3072
    s_waitcnt lgkmcnt(0)
    v_mfma_f32_16x16x32_bf16 v[28:31], v[60:63], v[76:79], v[28:31]
    s_nop 3
    ds_read_b128 v[56:59], v0 offset:4096
    s_waitcnt lgkmcnt(0)
    v_mfma_f32_16x16x32_bf16 v[32:35], v[56:59], v[20:23], 0
    s_nop 3
    ds_read_b128 v[60:63], v0 offset:5120
    s_waitcnt lgkmcnt(0)
    v_mfma_f32_16x16x32_bf16 v[32:35], v[60:63], v[24:27], v[32:35]
    s_nop 3
    ds_read_b128 v[56:59], v0 offset:6144
    s_waitcnt lgkmcnt(0)
    v_mfma_f32_16x16x32_bf16 v[32:35], v[56:59], v[72:75], v[32:35]
    s_nop 3
    ds_read_b128 v[60:63], v0 offset:7168
    s_waitcnt lgkmcnt(0)
    v_mfma_f32_16x16x32_bf16 v[32:35], v[60:63], v[76:79], v[32:35]
    s_nop 3
    ds_read_b128 v[56:59], v3 offset:28928
    s_waitcnt lgkmcnt(0)
    v_mfma_f32_16x16x32_bf16 v[52:55], v[56:59], v[20:23], 0
    s_nop 3
    ds_read_b128 v[60:63], v3 offset:28992
    s_waitcnt lgkmcnt(0)
    v_mfma_f32_16x16x32_bf16 v[52:55], v[60:63], v[24:27], v[52:55]
    s_nop 3
    ds_read_b128 v[56:59], v3 offset:29056
    s_waitcnt lgkmcnt(0)
    v_mfma_f32_16x16x32_bf16 v[52:55], v[56:59], v[72:75], v[52:55]
    s_nop 3
    ds_read_b128 v[60:63], v3 offset:29120
    s_waitcnt lgkmcnt(0)
    v_mfma_f32_16x16x32_bf16 v[52:55], v[60:63], v[76:79], v[52:55]
    s_nop 3
    v_max3_f32 v64, v28, v29, v30
    v_max3_f32 v64, v64, v31, v32
    v_max3_f32 v64, v64, v33, v34
    s_nop 0
    v_max3_f32 v64, v64, v35, v52
    v_max3_f32 v64, v64, v53, v54
    v_max_f32 v64, v64, v55
    v_mov_b32 v65, v64
    s_nop 1
    v_permlane16_swap_b32 v64, v65
    v_max_f32 v64, v64, v65
    v_mov_b32 v65, v64
    s_nop 1
    v_permlane32_swap_b32 v64, v65
    v_max_f32 v64, v64, v65
    v_sub_f32 v28, v28, v64
    v_exp_f32 v28, v28
    s_nop 0
    v_cndmask_b32_e64 v28, 0, v28, s[36:37]
    v_sub_f32 v29, v29, v64
    v_exp_f32 v29, v29
    s_nop 0
    v_cndmask_b32_e64 v29, 0, v29, s[36:37]
    v_sub_f32 v30, v30, v64
    v_exp_f32 v30, v30
    s_nop 0
    v_cndmask_b32_e64 v30, 0, v30, s[36:37]
    v_sub_f32 v31, v31, v64
    v_exp_f32 v31, v31
    s_nop 0
    v_cndmask_b32_e64 v31, 0, v31, s[36:37]
    v_sub_f32 v32, v32, v64
    v_exp_f32 v32, v32
    s_nop 0
    v_cndmask_b32_e64 v32, 0, v32, s[36:37]
    v_sub_f32 v33, v33, v64
    v_exp_f32 v33, v33
    s_nop 0
    v_cndmask_b32_e64 v33, 0, v33, s[36:37]
    v_sub_f32 v34, v34, v64
    v_exp_f32 v34, v34
    s_nop 0
    v_cndmask_b32_e64 v34, 0, v34, s[36:37]
    v_sub_f32 v35, v35, v64
    v_exp_f32 v35, v35
    s_nop 0
    v_cndmask_b32_e64 v35, 0, v35, s[36:37]
    v_sub_f32 v52, v52, v64
    v_exp_f32 v52, v52
    s_nop 0
    v_cndmask_b32_e64 v52, 0, v52, s[36:37]
    v_sub_f32 v53, v53, v64
    v_exp_f32 v53, v53
    s_nop 0
    v_cndmask_b32_e64 v53, 0, v53, s[36:37]
    v_sub_f32 v54, v54, v64
    v_exp_f32 v54, v54
    s_nop 0
    v_cndmask_b32_e64 v54, 0, v54, s[36:37]
    v_sub_f32 v55, v55, v64
    v_exp_f32 v55, v55
    s_nop 0
    v_cndmask_b32_e64 v55, 0, v55, s[36:37]
    v_cvt_pk_bf16_f32 v28, v28, v29
    v_cvt_pk_bf16_f32 v29, v30, v31
    v_cvt_pk_bf16_f32 v30, v32, v33
    v_cvt_pk_bf16_f32 v31, v34, v35
    v_mov_b32_dpp v32, v28 row_ror:8 row_mask:0xf bank_mask:0xf
    v_mov_b32_dpp v33, v29 row_ror:8 row_mask:0xf bank_mask:0xf
    v_mov_b32_dpp v34, v30 row_ror:8 row_mask:0xf bank_mask:0xf
    v_mov_b32_dpp v35, v31 row_ror:8 row_mask:0xf bank_mask:0xf
    v_cvt_pk_bf16_f32 v52, v52, v53
    v_cvt_pk_bf16_f32 v53, v54, v55
    s_nop 0
    v_mov_b32_dpp v54, v52 row_ror:8 row_mask:0xf bank_mask:0xf
    v_mfma_f32_16x16x32_bf16 v[12:15], v[16:19], v[28:31], 0
    ds_read_b128 v[56:59], v0 offset:8192
    s_waitcnt lgkmcnt(0)
    v_mfma_f32_16x16x32_bf16 v[20:23], v[56:59], v[28:31], 0
    s_nop 3
    ds_read_b128 v[60:63], v0 offset:9216
    s_waitcnt lgkmcnt(0)
    v_mfma_f32_16x16x32_bf16 v[20:23], v[60:63], v[32:35], v[20:23]
    s_nop 3
    ds_read_b128 v[56:59], v0 offset:10240
    s_waitcnt lgkmcnt(0)
    v_mfma_f32_16x16x32_bf16 v[24:27], v[56:59], v[28:31], 0
    s_nop 3
    ds_read_b128 v[60:63], v0 offset:11264
    s_waitcnt lgkmcnt(0)
    v_mfma_f32_16x16x32_bf16 v[24:27], v[60:63], v[32:35], v[24:27]
    s_nop 3
    ds_read_b128 v[56:59], v0 offset:12288
    s_waitcnt lgkmcnt(0)
    v_mfma_f32_16x16x32_bf16 v[72:75], v[56:59], v[28:31], 0
    s_nop 3
    ds_read_b128 v[60:63], v0 offset:13312
    s_waitcnt lgkmcnt(0)
    v_mfma_f32_16x16x32_bf16 v[72:75], v[60:63], v[32:35], v[72:75]
    s_nop 3
    ds_read_b128 v[56:59], v0 offset:14336
    s_waitcnt lgkmcnt(0)
    v_mfma_f32_16x16x32_bf16 v[76:79], v[56:59], v[28:31], 0
    s_nop 3
    ds_read_b128 v[60:63], v0 offset:15360
    s_waitcnt lgkmcnt(0)
    v_mfma_f32_16x16x32_bf16 v[76:79], v[60:63], v[32:35], v[76:79]
    s_nop 3
    s_nop 7
    s_branch main_kernel_c0_0_fin
main_kernel_c0_0_last:
    s_cmp_lg_u32 s70, 0
    s_cbranch_scc1 main_kernel_c0_0_last2
    v_cmp_u_f32 vcc, v32, v32
    s_cbranch_vccnz main_kernel_c0_0_vfy0
main_kernel_c0_0_last2:
    s_waitcnt vmcnt(0) lgkmcnt(0)
    s_barrier
    s_nop 7
    v_mov_b64 v[72:73], -1
    v_mov_b64 v[74:75], -1
    s_add_u32 s28, s44, 3
    s_and_b32 s29, s28, 3
    s_mul_i32 s31, s22, 160
    s_mul_i32 s28, s29, 167936
    s_add_u32 s28, s28, s34
    s_add_u32 s64, s28, s35
    s_mul_i32 s60, s29, 5120
    s_add_u32 s60, s60, s41
    s_add_u32 s60, s60, s31
    buffer_store_dwordx4 v[72:75], v0, s[8:11], s64 offen offset:0
    buffer_store_dwordx4 v[72:75], v0, s[8:11], s64 offen offset:1024
    s_mov_b64 exec, 0x3ff
    buffer_store_dwordx4 v[72:75], v0, s[8:11], s60 offen
    s_mov_b64 exec, -1
    s_mov_b32 s60, 0x10000000
    s_mov_b32 s64, 0x10000000
    s_waitcnt vmcnt(0)
    s_add_u32 s44, s44, 1
    s_cmp_eq_u32 s44, 128
    s_cbranch_scc1 main_kernel_end
    s_branch main_kernel_c0_0_layer
main_kernel_c0_0_p1:
    s_mov_b32 s30, 0
main_kernel_c0_0_p1_l:
    s_waitcnt lgkmcnt(0)
    s_mov_b64 exec, 3
    buffer_load_dword v11, v8, s[8:11], s51 offen sc1
    s_waitcnt vmcnt(0)
    s_mov_b64 exec, -1
    v_readlane_b32 s54, v11, 0
    v_readlane_b32 s28, v11, 1
    s_nop 3
    s_min_u32 s54, s54, s28
    s_cmp_ge_u32 s54, s27
    s_cbranch_scc1 main_kernel_c0_0_p1_r
    s_sleep 1
    s_add_u32 s30, s30, 1
    s_cmp_ge_u32 s30, 60000
    s_cbranch_scc1 main_kernel_fail
    s_branch main_kernel_c0_0_p1_l
main_kernel_c0_0_lr:
    s_mov_b32 s30, 0
main_kernel_c0_0_lr_l:
    s_waitcnt lgkmcnt(0)
    ds_read_b128 v[36:39], v6 offset:21504
    ds_read_b128 v[40:43], v6 offset:22528
    ds_read_b128 v[44:47], v6 offset:23552
    ds_read_b128 v[48:51], v6 offset:24576
    ds_read_b128 v[52:55], v6 offset:25600
    s_waitcnt lgkmcnt(2)
    v_max3_u32 v10, v36, v40, v44
    s_waitcnt lgkmcnt(0)
    v_max3_u32 v10, v10, v48, v52
    v_cmp_eq_u32 vcc, -1, v10
    s_cbranch_vccz main_kernel_c0_0_lr_d
    s_add_u32 s30, s30, 1
    s_cmp_ge_u32 s30, 480000
    s_cbranch_scc1 main_kernel_fail
    s_branch main_kernel_c0_0_lr_l
main_kernel_c0_0_lr_d:
    ds_read_b128 v[56:59], v5 offset:0
    ds_read_b128 v[60:63], v5 offset:1024
    ds_read_b128 v[64:67], v5 offset:2048
    ds_read_b128 v[68:71], v5 offset:3072
    v_mov_b64 v[12:13], 0
    v_mov_b64 v[14:15], 0
    v_mov_b64 v[16:17], 0
    v_mov_b64 v[18:19], 0
    v_mov_b64 v[20:21], 0
    v_mov_b64 v[22:23], 0
    v_mov_b64 v[24:25], 0
    v_mov_b64 v[26:27], 0
    v_mov_b64 v[28:29], 0
    v_mov_b64 v[30:31], 0
    v_mov_b64 v[32:33], 0
    v_mov_b64 v[34:35], 0
    s_waitcnt lgkmcnt(0)
    s_branch main_kernel_c0_0_lr_r
main_kernel_c0_0_rr:
    s_mov_b32 s30, 0
main_kernel_c0_0_rr_l:
    s_waitcnt lgkmcnt(0)
    s_and_b32 s27, s30, 1
    s_cbranch_scc1 main_kernel_c0_0_rr_n
    s_waitcnt vmcnt(2)
    s_mov_b32 m0, 16384
    s_nop 0
    buffer_load_dwordx4 v0, s[8:11], s49 offen offset:0 sc1 lds
    buffer_load_dwordx4 v0, s[8:11], s49 offen offset:1024 sc1 lds
main_kernel_c0_0_rr_n:
    ds_read_b128 v[36:39], v6 offset:16384
    ds_read_b128 v[40:43], v6 offset:17408
    ds_read_b128 v[44:47], v6 offset:18432
    ds_read_b128 v[48:51], v6 offset:19456
    ds_read_b32 v11, v6 offset:20480
    s_waitcnt lgkmcnt(2)
    v_max3_u32 v10, v36, v40, v44
    s_waitcnt lgkmcnt(0)
    v_max3_u32 v10, v10, v48, v11
    v_cmp_eq_u32 vcc, -1, v10
    s_cbranch_vccz main_kernel_c0_0_rr_d
    s_add_u32 s30, s30, 1
    s_cmp_ge_u32 s30, 480000
    s_cbranch_scc1 main_kernel_fail
    s_branch main_kernel_c0_0_rr_l
main_kernel_c0_0_rr_d:
    s_branch main_kernel_c0_0_rr_r
main_kernel_c0_0_wrb_l:
    s_waitcnt vmcnt(4)
    v_mfma_f32_16x16x32_bf16 v[76:79], v[72:75], v[40:43], 0
    v_mfma_f32_16x16x32_bf16 v[76:79], v[72:75], v[44:47], v[76:79]
    v_mfma_f32_16x16x32_bf16 v[76:79], v[72:75], v[48:51], v[76:79]
    v_mfma_f32_16x16x32_bf16 v[76:79], v[72:75], v[52:55], v[76:79]
    v_max3_u32 v32, v40, v44, v48
    v_max_u32 v32, v32, v52
    v_cmp_eq_u32 vcc, -1, v32
    s_cbranch_vccz main_kernel_c0_0_wrb_x0
main_kernel_c0_0_wrb_i0:
    buffer_load_dwordx4 v[40:43], v9, s[8:11], s43 offen sc1
    buffer_load_dwordx4 v[44:47], v9, s[8:11], s61 offen sc1
    buffer_load_dwordx4 v[48:51], v9, s[8:11], s100 offen sc1
    buffer_load_dwordx4 v[52:55], v9, s[8:11], s101 offen sc1
    s_waitcnt vmcnt(4)
    v_mfma_f32_16x16x32_bf16 v[76:79], v[72:75], v[12:15], 0
    v_mfma_f32_16x16x32_bf16 v[76:79], v[72:75], v[16:19], v[76:79]
    v_mfma_f32_16x16x32_bf16 v[76:79], v[72:75], v[20:23], v[76:79]
    v_mfma_f32_16x16x32_bf16 v[76:79], v[72:75], v[24:27], v[76:79]
    v_max3_u32 v32, v12, v16, v20
    v_max_u32 v32, v32, v24
    v_cmp_eq_u32 vcc, -1, v32
    s_cbranch_vccz main_kernel_c0_0_wrb_x1
main_kernel_c0_0_wrb_i1:
    buffer_load_dwordx4 v[12:15], v9, s[8:11], s43 offen sc1
    buffer_load_dwordx4 v[16:19], v9, s[8:11], s61 offen sc1
    buffer_load_dwordx4 v[20:23], v9, s[8:11], s100 offen sc1
    buffer_load_dwordx4 v[24:27], v9, s[8:11], s101 offen sc1
    s_add_u32 s71, s71, 1
    s_cmp_lt_u32 s71, 240000
    s_cbranch_scc1 main_kernel_c0_0_wrb_l
    s_branch main_kernel_fail
main_kernel_c0_0_wrb_x0:
    s_nop 3
    v_add_f32_dpp v76, v76, v76 row_ror:8 row_mask:0xf bank_mask:0xf
    v_add_f32_dpp v77, v77, v77 row_ror:8 row_mask:0xf bank_mask:0xf
    v_add_f32_dpp v78, v78, v78 row_ror:8 row_mask:0xf bank_mask:0xf
    v_add_f32_dpp v79, v79, v79 row_ror:8 row_mask:0xf bank_mask:0xf
    v_cmp_u_f32 vcc, v76, v76
    v_cvt_pk_bf16_f32 v76, v76, v77
    v_cvt_pk_bf16_f32 v77, v78, v79
    s_cbranch_vccz main_kernel_c0_0_wrb_n
main_kernel_c0_0_wrb_e0:
    v_max3_u32 v32, v40, v41, v42
    v_max3_u32 v32, v32, v43, v44
    v_max3_u32 v32, v32, v45, v46
    v_max3_u32 v32, v32, v47, v48
    v_max3_u32 v32, v32, v49, v50
    v_max3_u32 v32, v32, v51, v52
    v_max3_u32 v32, v32, v53, v54
    v_max_u32 v32, v32, v55
    v_cmp_eq_u32 vcc, -1, v32
    s_cbranch_vccnz main_kernel_c0_0_wrb_i0
    v_min_u32 v76, -2, v76
    v_min_u32 v77, -2, v77
    s_branch main_kernel_c0_0_wrb_n
main_kernel_c0_0_wrb_x1:
    s_nop 3
    v_add_f32_dpp v76, v76, v76 row_ror:8 row_mask:0xf bank_mask:0xf
    v_add_f32_dpp v77, v77, v77 row_ror:8 row_mask:0xf bank_mask:0xf
    v_add_f32_dpp v78, v78, v78 row_ror:8 row_mask:0xf bank_mask:0xf
    v_add_f32_dpp v79, v79, v79 row_ror:8 row_mask:0xf bank_mask:0xf
    v_cmp_u_f32 vcc, v76, v76
    v_cvt_pk_bf16_f32 v76, v76, v77
    v_cvt_pk_bf16_f32 v77, v78, v79
    s_cbranch_vccz main_kernel_c0_0_wrb_n
main_kernel_c0_0_wrb_e1:
    v_max3_u32 v32, v12, v13, v14
    v_max3_u32 v32, v32, v15, v16
    v_max3_u32 v32, v32, v17, v18
    v_max3_u32 v32, v32, v19, v20
    v_max3_u32 v32, v32, v21, v22
    v_max3_u32 v32, v32, v23, v24
    v_max3_u32 v32, v32, v25, v26
    v_max_u32 v32, v32, v27
    v_cmp_eq_u32 vcc, -1, v32
    s_cbranch_vccnz main_kernel_c0_0_wrb_i1
    v_min_u32 v76, -2, v76
    v_min_u32 v77, -2, v77
main_kernel_c0_0_wrb_n:
    s_mov_b64 exec, s[38:39]
    buffer_store_dwordx2 v[76:77], v11, s[8:11], s58 offen
    s_branch main_kernel_c0_0_wrb_d
main_kernel_c0_0_wkw:
    s_mov_b32 s30, 0
main_kernel_c0_0_wkw_l:
    s_waitcnt lgkmcnt(0)
    s_mov_b64 exec, 3
    buffer_load_dword v11, v8, s[8:11], s51 offen sc1
    s_waitcnt vmcnt(0)
    s_mov_b64 exec, -1
    v_readlane_b32 s54, v11, 0
    v_readlane_b32 s28, v11, 1
    s_nop 3
    s_min_u32 s54, s54, s28
    s_cmp_ge_u32 s54, s27
    s_cbranch_scc1 main_kernel_c0_0_wkw_r
    s_sleep 1
    s_add_u32 s30, s30, 1
    s_cmp_ge_u32 s30, 60000
    s_cbranch_scc1 main_kernel_fail
    s_branch main_kernel_c0_0_wkw_l
main_kernel_c0_1_layer:
    s_lshr_b32 s27, s44, 6
    s_mul_i32 s50, s27, 33554432
    s_lshl_b32 s27, s22, 13
    s_add_u32 s50, s50, s27
    s_add_u32 s50, s50, 37748736
    s_barrier
    s_and_b32 s26, s44, 63
    s_lshl_b32 s26, s26, 18
    s_add_u32 s26, s26, s50
    s_mul_i32 s27, s20, 5120
    s_add_u32 s48, s27, 167772160
    s_sub_u32 s49, 167777280, s27
    ds_read_b128 v[56:59], v5 offset:0
    ds_read_b128 v[60:63], v5 offset:1024
    ds_read_b128 v[64:67], v5 offset:2048
    ds_read_b128 v[68:71], v5 offset:3072
    v_mov_b64 v[12:13], 0
    v_mov_b64 v[14:15], 0
    v_mov_b64 v[16:17], 0
    v_mov_b64 v[18:19], 0
    v_mov_b64 v[20:21], 0
    v_mov_b64 v[22:23], 0
    v_mov_b64 v[24:25], 0
    v_mov_b64 v[26:27], 0
    v_mov_b64 v[28:29], 0
    v_mov_b64 v[30:31], 0
    v_mov_b64 v[32:33], 0
    v_mov_b64 v[34:35], 0
    s_mov_b32 s70, 0
    s_waitcnt lgkmcnt(0)
main_kernel_c0_1_top:
    s_barrier
    ds_read_b128 v[36:39], v6 offset:21504
    ds_read_b128 v[40:43], v6 offset:22528
    ds_read_b128 v[44:47], v6 offset:23552
    ds_read_b128 v[48:51], v6 offset:24576
    ds_read_b128 v[52:55], v6 offset:25600
    s_mov_b32 m0, 16384
    s_nop 0
    buffer_load_dwordx4 v0, s[8:11], s49 offen offset:2048 sc1 lds
main_kernel_c0_1_lr_r:
    s_waitcnt lgkmcnt(4)
    v_smfmac_f32_16x16x64_bf16 v[20:23], v[36:39], v[56:63], v1
    ds_read_b128 v[56:59], v5 offset:4096
    v_smfmac_f32_16x16x64_bf16 v[24:27], v[36:39], a[248:255], v1
    ds_read_b128 v[60:63], v5 offset:5120
    v_smfmac_f32_16x16x64_bf16 v[28:31], v[36:39], a[240:247], v1
    v_smfmac_f32_16x16x64_bf16 v[32:35], v[36:39], v[64:71], v1
    ds_read_b128 v[64:67], v5 offset:6144
    v_smfmac_f32_16x16x64_bf16 v[12:15], v[36:39], a[232:239], v1
    ds_read_b128 v[68:71], v5 offset:7168
    s_waitcnt lgkmcnt(6)
    v_max3_u32 v10, v36, v40, v44
    v_smfmac_f32_16x16x64_bf16 v[16:19], v[36:39], a[224:231], v1
    s_waitcnt lgkmcnt(4)
    s_waitcnt lgkmcnt(2)
    v_max3_u32 v10, v10, v48, v52
    v_smfmac_f32_16x16x64_bf16 v[20:23], v[40:43], v[56:63], v1
    ds_read_b128 v[56:59], v5 offset:8192
    v_cmp_eq_u32 vcc, -1, v10
    v_smfmac_f32_16x16x64_bf16 v[24:27], v[40:43], a[216:223], v1
    ds_read_b128 v[60:63], v5 offset:9216
    s_cbranch_vccnz main_kernel_c0_1_lr
    v_smfmac_f32_16x16x64_bf16 v[28:31], v[40:43], a[208:215], v1
    s_and_b32 s55, s44, 3
    s_mul_i32 s55, s55, 167936
    s_waitcnt lgkmcnt(2)
    v_smfmac_f32_16x16x64_bf16 v[32:35], v[40:43], v[64:71], v1
    ds_read_b128 v[64:67], v5 offset:10240
    s_add_u32 s55, s55, s34
    s_add_u32 s56, s55, s35
    v_smfmac_f32_16x16x64_bf16 v[20:23], v[44:47], a[200:207], v1
    ds_read_b128 v[68:71], v5 offset:11264
    s_and_b32 s57, s44, 63
    v_smfmac_f32_16x16x64_bf16 v[24:27], v[44:47], a[192:199], v1
    s_add_u32 s43, s55, s32
    s_waitcnt lgkmcnt(2)
    v_smfmac_f32_16x16x64_bf16 v[28:31], v[44:47], v[56:63], v1
    ds_read_b128 v[56:59], v5 offset:12288
    s_sub_u32 s27, s57, 1
    s_max_i32 s27, s27, 0
    v_smfmac_f32_16x16x64_bf16 v[32:35], v[44:47], a[184:191], v1
    ds_read_b128 v[60:63], v5 offset:13312
    s_lshl_b64 s[28:29], 1, s27
    s_lshl_b32 s27, s27, 7
    s_sub_u32 s31, s52, s27
    v_smfmac_f32_16x16x64_bf16 v[20:23], v[48:51], a[176:183], v1
    s_waitcnt lgkmcnt(2)
    v_smfmac_f32_16x16x64_bf16 v[24:27], v[48:51], v[64:71], v1
    ds_read_b128 v[64:67], v5 offset:14336
    v_smfmac_f32_16x16x64_bf16 v[28:31], v[48:51], a[168:175], v1
    ds_read_b128 v[68:71], v5 offset:15360
    v_smfmac_f32_16x16x64_bf16 v[32:35], v[48:51], a[160:167], v1
    s_mov_b32 m0, 0
    s_nop 0
    buffer_load_dwordx4 v0, s[8:11], s26 offen offset:2048 sc1 lds
    buffer_load_dwordx4 v0, s[8:11], s26 offen offset:3072 sc1 lds
    buffer_store_dwordx4 v[72:75], v0, s[8:11], s64 offen offset:1024
    buffer_store_dwordx4 v[72:75], v0, s[8:11], s64 offen offset:2048
    buffer_store_dwordx4 v[72:75], v0, s[8:11], s65 offen
    s_mov_b32 s65, 0x10000000
    s_mov_b32 s64, 0x10000000
    s_waitcnt vmcnt(5)
    s_barrier
    ds_read_b128 v[36:39], v6 offset:16384
    ds_read_b128 v[40:43], v6 offset:17408
    ds_read_b128 v[44:47], v6 offset:18432
    ds_read_b128 v[48:51], v6 offset:19456
    ds_read_b32 v11, v6 offset:20480
    s_waitcnt lgkmcnt(7)
    v_smfmac_f32_16x16x64_bf16 v[20:23], v[52:55], v[56:63], v1
    ds_read_b128 v[56:59], v5 offset:16384
    v_smfmac_f32_16x16x64_bf16 v[24:27], v[52:55], a[152:159], v1
    ds_read_b128 v[60:63], v5 offset:17408
    v_smfmac_f32_16x16x64_bf16 v[28:31], v[52:55], a[144:151], v1
    s_waitcnt lgkmcnt(4)
    v_max3_u32 v10, v36, v40, v44
    v_smfmac_f32_16x16x64_bf16 v[32:35], v[52:55], v[64:71], v1
    s_waitcnt lgkmcnt(2)
    v_max3_u32 v10, v10, v48, v11
    v_cmp_eq_u32 vcc, -1, v10
    s_cbranch_vccnz main_kernel_c0_1_rr
main_kernel_c0_1_rr_r:
    ds_read_b128 v[52:55], v6 offset:20480
    v_smfmac_f32_16x16x64_bf16 v[20:23], v[36:39], a[136:143], v1
    ds_read_b128 v[64:67], v5 offset:18432
    v_smfmac_f32_16x16x64_bf16 v[24:27], v[36:39], a[128:135], v1
    ds_read_b128 v[68:71], v5 offset:19456
    s_waitcnt lgkmcnt(3)
    v_smfmac_f32_16x16x64_bf16 v[20:23], v[40:43], v[56:63], v1
    ds_read_b128 v[56:59], v5 offset:20480
    v_smfmac_f32_16x16x64_bf16 v[24:27], v[40:43], a[120:127], v1
    ds_read_b128 v[60:63], v5 offset:21504
    s_mov_b64 exec, s[28:29]
    buffer_store_dword v8, v8, s[8:11], s31 offen sc1
    s_mov_b64 exec, 0x3ff
    buffer_store_dwordx4 v[72:75], v0, s[8:11], s60 offen sc1
    s_mov_b64 exec, -1
    s_mov_b32 s60, 0x10000000
    v_smfmac_f32_16x16x64_bf16 v[20:23], v[44:47], a[112:119], v1
    s_waitcnt lgkmcnt(2)
    v_smfmac_f32_16x16x64_bf16 v[24:27], v[44:47], v[64:71], v1
    ds_read_b128 v[64:67], v5 offset:22528
    v_smfmac_f32_16x16x64_bf16 v[20:23], v[48:51], a[104:111], v1
    ds_read_b128 v[68:71], v5 offset:23552
    v_smfmac_f32_16x16x64_bf16 v[24:27], v[48:51], a[96:103], v1
    s_waitcnt lgkmcnt(2)
    v_smfmac_f32_16x16x64_bf16 v[20:23], v[52:55], v[56:63], v1
    ds_read_b128 v[56:59], v5 offset:24576
    v_smfmac_f32_16x16x64_bf16 v[24:27], v[52:55], a[88:95], v1
    ds_read_b128 v[60:63], v5 offset:25600
    v_smfmac_f32_16x16x64_bf16 v[28:31], v[36:39], a[80:87], v1
    s_waitcnt lgkmcnt(2)
    v_smfmac_f32_16x16x64_bf16 v[32:35], v[36:39], v[64:71], v1
    ds_read_b128 v[64:67], v5 offset:26624
    s_nop 0
    v_permlane32_swap_b32 v20, v21
    v_smfmac_f32_16x16x64_bf16 v[28:31], v[40:43], a[72:79], v1
    ds_read_b128 v[68:71], v5 offset:27648
    v_permlane32_swap_b32 v22, v23
    v_smfmac_f32_16x16x64_bf16 v[32:35], v[40:43], a[64:71], v1
    s_waitcnt lgkmcnt(2)
    v_permlane32_swap_b32 v24, v25
    v_smfmac_f32_16x16x64_bf16 v[28:31], v[44:47], v[56:63], v1
    ds_read_b128 v[56:59], v5 offset:28672
    v_permlane32_swap_b32 v26, v27
    v_smfmac_f32_16x16x64_bf16 v[32:35], v[44:47], a[56:63], v1
    ds_read_b128 v[60:63], v5 offset:29696
    v_add_f32 v20, v20, v21
    v_add_f32 v22, v22, v23
    v_smfmac_f32_16x16x64_bf16 v[28:31], v[48:51], a[48:55], v1
    s_waitcnt lgkmcnt(2)
    v_add_f32 v24, v24, v25
    v_add_f32 v26, v26, v27
    v_smfmac_f32_16x16x64_bf16 v[32:35], v[48:51], v[64:71], v1
    ds_read_b128 v[64:67], v5 offset:30720
    v_mul_f32 v20, s40, v20
    v_mul_f32 v24, s40, v24
    v_smfmac_f32_16x16x64_bf16 v[28:31], v[52:55], a[40:47], v1
    ds_read_b128 v[68:71], v5 offset:31744
    v_mul_f32 v22, s40, v22
    v_mul_f32 v26, s40, v26
    v_smfmac_f32_16x16x64_bf16 v[32:35], v[52:55], a[32:39], v1
    s_waitcnt lgkmcnt(2)
    v_cvt_pk_bf16_f32 v20, v20, v24
    v_cvt_pk_bf16_f32 v21, v22, v26
    v_smfmac_f32_16x16x64_bf16 v[12:15], v[36:39], v[56:63], v1
    ds_write_b32 v2, v20 offset:26624
    ds_write_b32 v2, v21 offset:27200
    v_smfmac_f32_16x16x64_bf16 v[16:19], v[36:39], a[24:31], v1
    v_permlane32_swap_b32 v28, v29
    v_smfmac_f32_16x16x64_bf16 v[12:15], v[40:43], a[16:23], v1
    s_waitcnt lgkmcnt(2)
    v_permlane32_swap_b32 v30, v31
    v_smfmac_f32_16x16x64_bf16 v[16:19], v[40:43], v[64:71], v1
    ds_read_b128 v[40:43], v6 offset:22528
    v_permlane32_swap_b32 v32, v33
    v_smfmac_f32_16x16x64_bf16 v[12:15], v[44:47], a[8:15], v1
    v_permlane32_swap_b32 v34, v35
    v_smfmac_f32_16x16x64_bf16 v[16:19], v[44:47], a[0:7], v1
    ds_read_b128 v[44:47], v6 offset:23552
    v_add_f32 v28, v28, v29
    v_add_f32 v30, v30, v31
    v_smfmac_f32_16x16x64_bf16 v[12:15], v[48:51], v[248:255], v1
    v_add_f32 v32, v32, v33
    v_add_f32 v34, v34, v35
    v_smfmac_f32_16x16x64_bf16 v[16:19], v[48:51], v[240:247], v1
    ds_read_b128 v[48:51], v6 offset:24576
    v_cvt_pk_bf16_f32 v28, v28, v32
    v_cvt_pk_bf16_f32 v29, v30, v34
    v_smfmac_f32_16x16x64_bf16 v[12:15], v[52:55], v[232:239], v1
    ds_write_b32 v2, v28 offset:28928
    ds_write_b32 v2, v29 offset:29504
    v_smfmac_f32_16x16x64_bf16 v[16:19], v[52:55], v[224:231], v1
    ds_read_b128 v[52:55], v6 offset:25600
    s_waitcnt lgkmcnt(5)
    v_smfmac_f32_16x16x64_bf16 v[12:15], v[40:43], v[216:223], v1
    v_smfmac_f32_16x16x64_bf16 v[16:19], v[40:43], v[208:215], v1
    s_waitcnt vmcnt(2) lgkmcnt(1)
    s_barrier
    ds_read_b128 v[56:59], v0 offset:0
    ds_read_b128 v[20:23], v4 offset:26624
    v_smfmac_f32_16x16x64_bf16 v[12:15], v[44:47], v[200:207], v1
    ds_read_b128 v[60:63], v0 offset:1024
    ds_read_b128 v[24:27], v4 offset:26688
    v_smfmac_f32_16x16x64_bf16 v[16:19], v[44:47], v[192:199], v1
    ds_read_b128 v[64:67], v0 offset:2048
    ds_read_b128 v[72:75], v4 offset:26752
    v_smfmac_f32_16x16x64_bf16 v[12:15], v[48:51], v[184:191], v1
    ds_read_b128 v[68:71], v0 offset:3072
    ds_read_b128 v[76:79], v4 offset:26816
    v_smfmac_f32_16x16x64_bf16 v[16:19], v[48:51], v[176:183], v1
    ds_read_b128 v[36:39], v0 offset:4096
    ds_read_b128 v[40:43], v0 offset:5120
    s_waitcnt lgkmcnt(10)
    v_smfmac_f32_16x16x64_bf16 v[12:15], v[52:55], v[168:175], v1
    ds_read_b128 v[44:47], v0 offset:6144
    ds_read_b128 v[48:51], v0 offset:7168
    v_smfmac_f32_16x16x64_bf16 v[16:19], v[52:55], v[160:167], v1
    s_waitcnt lgkmcnt(10)
    v_mfma_f32_16x16x32_bf16 v[28:31], v[56:59], v[20:23], 0
    s_waitcnt lgkmcnt(8)
    v_mfma_f32_16x16x32_bf16 v[28:31], v[60:63], v[24:27], v[28:31]
    s_nop 0
    s_waitcnt lgkmcnt(6)
    v_cvt_pk_bf16_f32 v12, v12, v13
    v_cvt_pk_bf16_f32 v13, v14, v15
    v_mfma_f32_16x16x32_bf16 v[28:31], v[64:67], v[72:75], v[28:31]
    s_waitcnt lgkmcnt(4)
    v_cvt_pk_bf16_f32 v14, v16, v17
    v_cvt_pk_bf16_f32 v15, v18, v19
    v_mfma_f32_16x16x32_bf16 v[28:31], v[68:71], v[76:79], v[28:31]
    ds_write_b128 v0, v[12:15] offset:17408
    s_waitcnt lgkmcnt(4)
    v_mfma_f32_16x16x32_bf16 v[32:35], v[36:39], v[20:23], 0
    ds_read_b128 v[56:59], v3 offset:28928
    ds_read_b128 v[60:63], v3 offset:28992
    s_waitcnt lgkmcnt(5)
    v_mfma_f32_16x16x32_bf16 v[32:35], v[40:43], v[24:27], v[32:35]
    ds_read_b128 v[64:67], v3 offset:29056
    ds_read_b128 v[68:71], v3 offset:29120
    s_waitcnt lgkmcnt(6)
    v_mfma_f32_16x16x32_bf16 v[32:35], v[44:47], v[72:75], v[32:35]
    s_mov_b64 exec, s[36:37]
    v_exp_f32 v28, v28
    v_exp_f32 v29, v29
    s_mov_b64 exec, -1
    s_waitcnt lgkmcnt(5)
    v_mfma_f32_16x16x32_bf16 v[32:35], v[48:51], v[76:79], v[32:35]
    s_mov_b64 exec, s[36:37]
    v_exp_f32 v30, v30
    v_exp_f32 v31, v31
    s_mov_b64 exec, -1
    s_waitcnt lgkmcnt(4)
    s_barrier
    s_waitcnt lgkmcnt(3)
    v_mfma_f32_16x16x32_bf16 v[52:55], v[56:59], v[20:23], 0
    ds_read_b128 v[36:39], v0 offset:8192
    s_waitcnt lgkmcnt(3)
    v_cvt_pk_bf16_f32 v28, v28, v29
    v_cvt_pk_bf16_f32 v29, v30, v31
    v_mfma_f32_16x16x32_bf16 v[52:55], v[60:63], v[24:27], v[52:55]
    ds_read_b128 v[40:43], v0 offset:10240
    s_mov_b64 exec, s[36:37]
    v_exp_f32 v32, v32
    v_exp_f32 v33, v33
    s_mov_b64 exec, -1
    s_waitcnt lgkmcnt(3)
    v_mfma_f32_16x16x32_bf16 v[52:55], v[64:67], v[72:75], v[52:55]
    ds_read_b128 v[44:47], v0 offset:12288
    s_mov_b64 exec, s[36:37]
    v_exp_f32 v34, v34
    v_exp_f32 v35, v35
    s_mov_b64 exec, -1
    s_waitcnt lgkmcnt(3)
    v_mfma_f32_16x16x32_bf16 v[52:55], v[68:71], v[76:79], v[52:55]
    ds_read_b128 v[48:51], v0 offset:14336
    v_cvt_pk_bf16_f32 v30, v32, v33
    v_cvt_pk_bf16_f32 v31, v34, v35
    s_cmp_eq_u32 s57, 63
    s_cbranch_scc1 main_kernel_c0_1_last
    s_waitcnt lgkmcnt(3)
    v_mfma_f32_16x16x32_bf16 v[20:23], v[36:39], v[28:31], 0
    ds_read_b128 v[56:59], v0 offset:9216
    s_waitcnt lgkmcnt(3)
    v_mov_b32_dpp v32, v28 row_ror:8 row_mask:0xf bank_mask:0xf
    v_mov_b32_dpp v33, v29 row_ror:8 row_mask:0xf bank_mask:0xf
    v_mfma_f32_16x16x32_bf16 v[24:27], v[40:43], v[28:31], 0
    ds_read_b128 v[60:63], v0 offset:11264
    s_waitcnt lgkmcnt(3)
    v_mov_b32_dpp v34, v30 row_ror:8 row_mask:0xf bank_mask:0xf
    v_mov_b32_dpp v35, v31 row_ror:8 row_mask:0xf bank_mask:0xf
    v_mfma_f32_16x16x32_bf16 v[72:75], v[44:47], v[28:31], 0
    ds_read_b128 v[64:67], v0 offset:13312
    s_waitcnt lgkmcnt(3)
    v_mov_b64 v[16:17], s[24:25]
    v_mov_b64 v[18:19], s[24:25]
    v_mfma_f32_16x16x32_bf16 v[76:79], v[48:51], v[28:31], 0
    ds_read_b128 v[68:71], v0 offset:15360
    s_mov_b64 exec, s[36:37]
    v_exp_f32 v52, v52
    s_mov_b64 exec, -1
    v_mfma_f32_16x16x32_bf16 v[12:15], v[16:19], v[28:31], 0
    ds_read_b128 v[36:39], v0 offset:16384
    s_mov_b64 exec, s[36:37]
    v_exp_f32 v53, v53
    s_mov_b64 exec, -1
    s_waitcnt lgkmcnt(4)
    v_mfma_f32_16x16x32_bf16 v[20:23], v[56:59], v[32:35], v[20:23]
    ds_read_b128 v[40:43], v0 offset:17408
    s_mov_b64 exec, s[36:37]
    v_exp_f32 v54, v54
    s_mov_b64 exec, -1
    s_waitcnt lgkmcnt(4)
    v_mfma_f32_16x16x32_bf16 v[24:27], v[60:63], v[32:35], v[24:27]
    ds_read_b128 v[44:47], v0 offset:18432
    s_mov_b64 exec, s[36:37]
    v_exp_f32 v55, v55
    s_mov_b64 exec, -1
    s_waitcnt lgkmcnt(4)
    v_mfma_f32_16x16x32_bf16 v[72:75], v[64:67], v[32:35], v[72:75]
    ds_read_b128 v[48:51], v0 offset:19456
    s_waitcnt lgkmcnt(4)
    v_cvt_pk_bf16_f32 v52, v52, v53
    v_cvt_pk_bf16_f32 v53, v54, v55
    v_mfma_f32_16x16x32_bf16 v[76:79], v[68:71], v[32:35], v[76:79]
    v_mov_b64 v[10:11], s[16:17]
    v_mov_b32_dpp v54, v52 row_ror:8 row_mask:0xf bank_mask:0xf
main_kernel_c0_1_fin:
    s_waitcnt lgkmcnt(3)
    v_mfma_f32_16x16x16_bf16 v[20:23], v[36:37], v[52:53], v[20:23]
    v_mov_b32_dpp v55, v53 row_ror:8 row_mask:0xf bank_mask:0xf
    v_mov_b64 v[56:57], 0
    v_mfma_f32_16x16x16_bf16 v[12:15], v[10:11], v[52:53], v[12:15]
    s_waitcnt lgkmcnt(2)
    v_mov_b64 v[58:59], 0
    v_mov_b64 v[60:61], 0
    v_mfma_f32_16x16x16_bf16 v[24:27], v[40:41], v[52:53], v[24:27]
    v_mov_b64 v[62:63], 0
    v_mov_b64 v[64:65], 0
    v_mfma_f32_16x16x16_bf16 v[20:23], v[38:39], v[54:55], v[20:23]
    v_mov_b64 v[66:67], 0
    v_mov_b64 v[68:69], 0
    v_mfma_f32_16x16x16_bf16 v[24:27], v[42:43], v[54:55], v[24:27]
    s_waitcnt lgkmcnt(1)
    v_add_f32_dpp v12, v12, v12 row_ror:8 row_mask:0xf bank_mask:0xf
    v_mov_b64 v[70:71], 0
    v_mfma_f32_16x16x16_bf16 v[72:75], v[44:45], v[52:53], v[72:75]
    s_waitcnt lgkmcnt(0)
    v_rcp_f32 v14, v12
    v_mfma_f32_16x16x16_bf16 v[76:79], v[48:49], v[52:53], v[76:79]
    v_subrev_u32 v13, s68, v12
    v_cmp_lt_u32 vcc, s69, v13
    v_mfma_f32_16x16x16_bf16 v[72:75], v[46:47], v[54:55], v[72:75]
    s_cbranch_vccnz main_kernel_c0_1_zbad
main_kernel_c0_1_zok:
    v_mov_b64 v[28:29], 0
    v_mov_b64 v[30:31], 0
    v_mfma_f32_16x16x16_bf16 v[76:79], v[50:51], v[54:55], v[76:79]
    v_mul_f32 v20, v20, v14
    v_mul_f32 v21, v21, v14
    v_mul_f32 v22, v22, v14
    v_mul_f32 v23, v23, v14
    v_mul_f32 v24, v24, v14
    v_mul_f32 v25, v25, v14
    v_mul_f32 v26, v26, v14
    v_mul_f32 v27, v27, v14
    v_cvt_pk_bf16_f32 v20, v20, v21
    v_cvt_pk_bf16_f32 v21, v22, v23
    v_cvt_pk_bf16_f32 v22, v24, v25
    v_cvt_pk_bf16_f32 v23, v26, v27
    v_mul_f32 v72, v72, v14
    v_mul_f32 v73, v73, v14
    v_smfmac_f32_16x16x64_bf16 v[56:59], v[20:23], v[152:159], v1
    v_mul_f32 v74, v74, v14
    v_mul_f32 v75, v75, v14
    v_mul_f32 v76, v76, v14
    v_smfmac_f32_16x16x64_bf16 v[60:63], v[20:23], v[136:143], v1
    v_mul_f32 v77, v77, v14
    v_mul_f32 v78, v78, v14
    v_mul_f32 v79, v79, v14
    v_smfmac_f32_16x16x64_bf16 v[64:67], v[20:23], v[120:127], v1
    v_cvt_pk_bf16_f32 v72, v72, v73
    v_cvt_pk_bf16_f32 v73, v74, v75
    v_cvt_pk_bf16_f32 v74, v76, v77
    v_smfmac_f32_16x16x64_bf16 v[68:71], v[20:23], v[104:111], v1
    v_cvt_pk_bf16_f32 v75, v78, v79
    v_smfmac_f32_16x16x64_bf16 v[28:31], v[20:23], v[88:95], v1
    s_nop 0
    v_smfmac_f32_16x16x64_bf16 v[56:59], v[72:75], v[144:151], v1
    s_waitcnt vmcnt(0)
    v_smfmac_f32_16x16x64_bf16 v[60:63], v[72:75], v[128:135], v1
    v_smfmac_f32_16x16x64_bf16 v[64:67], v[72:75], v[112:119], v1
    v_mov_b32 v5, v5
    v_mov_b32 v5, v5
    v_mov_b32 v5, v5
    v_permlane32_swap_b32 v56, v57
    v_smfmac_f32_16x16x64_bf16 v[68:71], v[72:75], v[96:103], v1
    v_permlane32_swap_b32 v58, v59
    v_smfmac_f32_16x16x64_bf16 v[28:31], v[72:75], v[80:87], v1
    v_add_f32 v56, v56, v57
    v_add_f32 v58, v58, v59
    v_permlane32_swap_b32 v60, v61
    v_permlane32_swap_b32 v62, v63
    v_add_f32 v60, v60, v61
    v_add_f32 v62, v62, v63
    v_cvt_pk_bf16_f32 v36, v56, v60
    v_cvt_pk_bf16_f32 v38, v58, v62
    v_permlane32_swap_b32 v64, v65
    v_permlane32_swap_b32 v66, v67
    v_add_f32 v64, v64, v65
    v_add_f32 v66, v66, v67
    v_permlane32_swap_b32 v68, v69
    v_permlane32_swap_b32 v70, v71
    v_add_f32 v68, v68, v69
    v_add_f32 v70, v70, v71
    v_cvt_pk_bf16_f32 v37, v64, v68
    v_cvt_pk_bf16_f32 v39, v66, v70
    buffer_store_dwordx4 v[36:39], v0, s[8:11], s56 offen
    v_permlane32_swap_b32 v28, v29
    v_permlane32_swap_b32 v30, v31
    v_add_f32 v28, v28, v29
    v_add_f32 v30, v30, v31
    v_cvt_pk_bf16_f32 v28, v28, v30
    buffer_store_dword v28, v7, s[8:11], s55 offen
    v_bfe_u32 v34, v0, 4, 1
    v_bfe_u32 v33, v0, 7, 1
    v_lshl_add_u32 v33, v33, 1, v34
    v_bfe_u32 v32, v0, 6, 1
    v_lshlrev_b32 v32, 4, v32
    v_lshlrev_b32_e64 v32, v32, s45
    v_cmp_eq_u32_e64 s[64:65], 0, v33
    v_cmp_eq_u32_e64 s[66:67], 1, v33
    s_add_u32 s27, s44, 1
    s_and_b32 s27, s27, 3
    v_cndmask_b32_e64 v72, 0, v32, s[64:65]
    v_cndmask_b32_e64 v73, 0, v32, s[66:67]
    v_cmp_eq_u32_e64 s[64:65], 2, v33
    v_cmp_eq_u32_e64 s[66:67], 3, v33
    s_mul_i32 s48, s27, 5120
    s_add_u32 s48, s48, s41
    v_cndmask_b32_e64 v74, 0, v32, s[64:65]
    v_cndmask_b32_e64 v75, 0, v32, s[66:67]
    s_lshl_b32 s27, s27, 15
    s_add_u32 s49, s27, s47
    v_bfe_u32 v32, v0, 8, 1
    v_lshlrev_b32 v11, 6, v32
    v_lshl_add_u32 v11, v34, 3, v11
    v_lshrrev_b32 v33, 9, v0
    v_lshl_add_u32 v11, v33, 2, v11
    s_add_u32 s56, s27, s46
    s_add_u32 s56, s56, s33
    s_add_u32 s58, s48, s33
    v_mov_b32 v5, v5
    s_nop 1
    v_mov_b32 v5, v5
    s_nop 1
    v_mov_b32 v5, v5
    s_nop 1
    v_mov_b32 v5, v5
    s_nop 1
    v_mov_b32 v5, v5
    s_nop 1
    v_mov_b32 v5, v5
    s_nop 1
    v_mov_b32 v5, v5
    s_nop 1
    v_mov_b32 v5, v5
    s_nop 1
    buffer_load_dwordx4 v[40:43], v0, s[8:11], s43 offen sc1
    v_mov_b32 v5, v5
    s_nop 1
    v_mov_b32 v5, v5
    s_nop 1
    v_mov_b32 v5, v5
    s_nop 1
    v_mov_b32 v5, v5
    s_nop 1
    v_mov_b32 v5, v5
    s_nop 1
    v_mov_b32 v5, v5
    s_nop 1
    v_mov_b32 v5, v5
    s_nop 1
    v_mov_b32 v5, v5
    s_nop 1
    v_mov_b32 v5, v5
    s_nop 1
    v_mov_b32 v5, v5
    s_nop 1
    v_mov_b32 v5, v5
    s_nop 1
    v_mov_b32 v5, v5
    s_nop 1
    v_mov_b32 v5, v5
    v_mov_b32 v5, v5
    buffer_load_dwordx4 v[44:47], v0, s[8:11], s43 offen sc1
    v_mov_b32 v5, v5
    s_nop 1
    v_mov_b32 v5, v5
    s_nop 1
    s_waitcnt vmcnt(1)
    v_mov_b32 v5, v5
    v_mov_b32 v5, v5
    v_mfma_f32_16x16x32_bf16 v[76:79], v[72:75], v[40:43], 0
    v_cmp_eq_u32 vcc, -1, v40
    s_cbranch_vccnz main_kernel_c0_1_wrb_i0
    v_mov_b32 v5, v5
    v_mov_b32 v5, v5
    v_mov_b32 v5, v5
    v_mov_b32 v5, v5
    v_mov_b32 v5, v5
    v_mov_b32 v5, v5
    v_add_f32_dpp v76, v76, v76 row_ror:8 row_mask:0xf bank_mask:0xf
    v_add_f32_dpp v77, v77, v77 row_ror:8 row_mask:0xf bank_mask:0xf
    s_nop 0
    v_add_f32_dpp v76, v76, v76 row_ror:4 row_mask:0xf bank_mask:0xf
    v_add_f32_dpp v77, v77, v77 row_ror:4 row_mask:0xf bank_mask:0xf
    s_nop 0
    v_add_f32_dpp v76, v76, v76 row_ror:2 row_mask:0xf bank_mask:0xf
    v_add_f32_dpp v77, v77, v77 row_ror:2 row_mask:0xf bank_mask:0xf
    v_cmp_u_f32 vcc, v76, v76
    v_cvt_pk_bf16_f32 v76, v76, v77
    s_cbranch_vccnz main_kernel_c0_1_wrb_e0
    s_mov_b64 exec, s[62:63]
    buffer_store_dword v76, v11, s[8:11], s58 offen
main_kernel_c0_1_wrb_d:
    s_barrier
    buffer_store_dword v76, v11, s[8:11], s56 offen sc1
    s_mov_b64 exec, -1
    s_waitcnt vmcnt(2)
    ds_read_b128 v[56:59], v5 offset:0
    ds_read_b128 v[60:63], v5 offset:1024
    ds_read_b128 v[64:67], v5 offset:2048
    ds_read_b128 v[68:71], v5 offset:3072
    v_mov_b64 v[12:13], 0
    v_mov_b64 v[14:15], 0
    v_mov_b64 v[16:17], 0
    v_mov_b64 v[18:19], 0
    v_mov_b64 v[20:21], 0
    v_mov_b64 v[22:23], 0
    v_mov_b64 v[24:25], 0
    v_mov_b64 v[26:27], 0
    v_mov_b64 v[28:29], 0
    v_mov_b64 v[30:31], 0
    v_mov_b64 v[32:33], 0
    v_mov_b64 v[34:35], 0
    v_mov_b64 v[72:73], -1
    v_mov_b64 v[74:75], -1
    s_add_u32 s28, s44, 3
    s_and_b32 s29, s28, 3
    s_mul_i32 s31, s22, 160
    s_mul_i32 s28, s29, 167936
    s_add_u32 s28, s28, s34
    s_add_u32 s64, s28, s35
    s_add_u32 s65, s28, s32
    s_lshl_b32 s60, s29, 15
    s_add_u32 s60, s60, s47
    s_add_u32 s60, s60, s31
    s_and_b32 s26, s44, 63
    s_add_u32 s26, s26, 1
    s_min_u32 s26, s26, 63
    s_lshl_b32 s26, s26, 18
    s_add_u32 s26, s26, s50
    s_nop 15
    s_nop 15
    s_nop 9
    s_mov_b32 m0, 21504
    s_nop 0
    buffer_load_dwordx4 v0, s[8:11], s48 offen offset:0 sc1 lds
    buffer_load_dwordx4 v0, s[8:11], s48 offen offset:1024 sc1 lds
    buffer_load_dwordx4 v0, s[8:11], s48 offen offset:2048 sc1 lds
    buffer_load_dwordx4 v0, s[8:11], s48 offen offset:3072 sc1 lds
    s_mov_b32 m0, 25600
    s_add_u32 s59, s48, 4096
    buffer_load_dwordx4 v0, s[8:11], s59 offen offset:0 sc1 lds
    s_add_u32 s44, s44, 1
    s_mov_b32 s70, 0
    s_waitcnt lgkmcnt(0)
    s_branch main_kernel_c0_1_top
main_kernel_c0_1_restart:
    s_waitcnt vmcnt(0) lgkmcnt(0)
    s_nop 7
    s_barrier
    ds_read_b128 v[56:59], v5 offset:0
    ds_read_b128 v[60:63], v5 offset:1024
    ds_read_b128 v[64:67], v5 offset:2048
    ds_read_b128 v[68:71], v5 offset:3072
    v_mov_b64 v[12:13], 0
    v_mov_b64 v[14:15], 0
    v_mov_b64 v[16:17], 0
    v_mov_b64 v[18:19], 0
    v_mov_b64 v[20:21], 0
    v_mov_b64 v[22:23], 0
    v_mov_b64 v[24:25], 0
    v_mov_b64 v[26:27], 0
    v_mov_b64 v[28:29], 0
    v_mov_b64 v[30:31], 0
    v_mov_b64 v[32:33], 0
    v_mov_b64 v[34:35], 0
    s_waitcnt vmcnt(0) lgkmcnt(0)
    s_branch main_kernel_c0_1_top
main_kernel_c0_1_zbad:
    s_cmp_eq_u32 s70, 2
    s_cbranch_scc1 main_kernel_c0_1_zok
    v_cmp_u_f32 vcc, v12, v12
    s_cbranch_vccz main_kernel_c0_1_exact
    s_cmp_eq_u32 s70, 1
    s_cbranch_scc1 main_kernel_c0_1_exact
main_kernel_c0_1_vfy0:
    s_mov_b32 s70, 1
    s_mov_b32 s30, 0
    s_waitcnt vmcnt(0) lgkmcnt(0)
    s_nop 7
main_kernel_c0_1_vfy:
    v_mov_b32 v10, 0
    s_add_u32 s59, s48, 4096
    buffer_load_dwordx4 v[36:39], v0, s[8:11], s48 offen offset:0 sc1
    buffer_load_dwordx4 v[40:43], v0, s[8:11], s48 offen offset:1024 sc1
    buffer_load_dwordx4 v[44:47], v0, s[8:11], s48 offen offset:2048 sc1
    buffer_load_dwordx4 v[48:51], v0, s[8:11], s48 offen offset:3072 sc1
    buffer_load_dwordx4 v[52:55], v0, s[8:11], s59 offen offset:0 sc1
    s_waitcnt vmcnt(4)
    v_max3_u32 v10, v10, v36, v37
    v_max3_u32 v10, v10, v38, v39
    s_waitcnt vmcnt(3)
    v_max3_u32 v10, v10, v40, v41
    v_max3_u32 v10, v10, v42, v43
    s_waitcnt vmcnt(2)
    v_max3_u32 v10, v10, v44, v45
    v_max3_u32 v10, v10, v46, v47
    s_waitcnt vmcnt(1)
    v_max3_u32 v10, v10, v48, v49
    v_max3_u32 v10, v10, v50, v51
    s_waitcnt vmcnt(0)
    v_max3_u32 v10, v10, v52, v53
    v_max3_u32 v10, v10, v54, v55
    s_add_u32 s59, s49, 4096
    buffer_load_dwordx4 v[36:39], v0, s[8:11], s49 offen offset:0 sc1
    buffer_load_dwordx4 v[40:43], v0, s[8:11], s49 offen offset:1024 sc1
    buffer_load_dwordx4 v[44:47], v0, s[8:11], s49 offen offset:2048 sc1
    buffer_load_dwordx4 v[48:51], v0, s[8:11], s49 offen offset:3072 sc1
    buffer_load_dwordx4 v[52:55], v0, s[8:11], s59 offen offset:0 sc1
    s_waitcnt vmcnt(4)
    v_max3_u32 v10, v10, v36, v37
    v_max3_u32 v10, v10, v38, v39
    s_waitcnt vmcnt(3)
    v_max3_u32 v10, v10, v40, v41
    v_max3_u32 v10, v10, v42, v43
    s_waitcnt vmcnt(2)
    v_max3_u32 v10, v10, v44, v45
    v_max3_u32 v10, v10, v46, v47
    s_waitcnt vmcnt(1)
    v_max3_u32 v10, v10, v48, v49
    v_max3_u32 v10, v10, v50, v51
    s_waitcnt vmcnt(0)
    v_max3_u32 v10, v10, v52, v53
    v_max3_u32 v10, v10, v54, v55
    v_cmp_eq_u32 vcc, -1, v10
    s_cbranch_vccz main_kernel_c0_1_restart
    s_add_u32 s30, s30, 1
    s_cmp_ge_u32 s30, 60000
    s_cbranch_scc1 main_kernel_fail
    s_branch main_kernel_c0_1_vfy
main_kernel_c0_1_exact:
    s_nop 7
    s_mov_b32 s70, 2
    ds_read_b128 v[20:23], v3 offset:26624
    ds_read_b128 v[24:27], v3 offset:26688
    ds_read_b128 v[72:75], v3 offset:26752
    ds_read_b128 v[76:79], v3 offset:26816
    ds_read_b128 v[56:59], v0 offset:0
    s_waitcnt lgkmcnt(0)
    v_mfma_f32_16x16x32_bf16 v[28:31], v[56:59], v[20:23], 0
    s_nop 3
    ds_read_b128 v[60:63], v0 offset:1024
    s_waitcnt lgkmcnt(0)
    v_mfma_f32_16x16x32_bf16 v[28:31], v[60:63], v[24:27], v[28:31]
    s_nop 3
    ds_read_b128 v[56:59], v0 offset:2048
    s_waitcnt lgkmcnt(0)
    v_mfma_f32_16x16x32_bf16 v[28:31], v[56:59], v[72:75], v[28:31]
    s_nop 3
    ds_read_b128 v[60:63], v0 offset:3072
    s_waitcnt lgkmcnt(0)
    v_mfma_f32_16x16x32_bf16 v[28:31], v[60:63], v[76:79], v[28:31]
    s_nop 3
    ds_read_b128 v[56:59], v0 offset:4096
    s_waitcnt lgkmcnt(0)
    v_mfma_f32_16x16x32_bf16 v[32:35], v[56:59], v[20:23], 0
    s_nop 3
    ds_read_b128 v[60:63], v0 offset:5120
    s_waitcnt lgkmcnt(0)
    v_mfma_f32_16x16x32_bf16 v[32:35], v[60:63], v[24:27], v[32:35]
    s_nop 3
    ds_read_b128 v[56:59], v0 offset:6144
    s_waitcnt lgkmcnt(0)
    v_mfma_f32_16x16x32_bf16 v[32:35], v[56:59], v[72:75], v[32:35]
    s_nop 3
    ds_read_b128 v[60:63], v0 offset:7168
    s_waitcnt lgkmcnt(0)
    v_mfma_f32_16x16x32_bf16 v[32:35], v[60:63], v[76:79], v[32:35]
    s_nop 3
    ds_read_b128 v[56:59], v3 offset:28928
    s_waitcnt lgkmcnt(0)
    v_mfma_f32_16x16x32_bf16 v[52:55], v[56:59], v[20:23], 0
    s_nop 3
    ds_read_b128 v[60:63], v3 offset:28992
    s_waitcnt lgkmcnt(0)
    v_mfma_f32_16x16x32_bf16 v[52:55], v[60:63], v[24:27], v[52:55]
    s_nop 3
    ds_read_b128 v[56:59], v3 offset:29056
    s_waitcnt lgkmcnt(0)
    v_mfma_f32_16x16x32_bf16 v[52:55], v[56:59], v[72:75], v[52:55]
    s_nop 3
    ds_read_b128 v[60:63], v3 offset:29120
    s_waitcnt lgkmcnt(0)
    v_mfma_f32_16x16x32_bf16 v[52:55], v[60:63], v[76:79], v[52:55]
    s_nop 3
    v_max3_f32 v64, v28, v29, v30
    v_max3_f32 v64, v64, v31, v32
    v_max3_f32 v64, v64, v33, v34
    s_nop 0
    v_max3_f32 v64, v64, v35, v52
    v_max3_f32 v64, v64, v53, v54
    v_max_f32 v64, v64, v55
    v_mov_b32 v65, v64
    s_nop 1
    v_permlane16_swap_b32 v64, v65
    v_max_f32 v64, v64, v65
    v_mov_b32 v65, v64
    s_nop 1
    v_permlane32_swap_b32 v64, v65
    v_max_f32 v64, v64, v65
    v_sub_f32 v28, v28, v64
    v_exp_f32 v28, v28
    s_nop 0
    v_cndmask_b32_e64 v28, 0, v28, s[36:37]
    v_sub_f32 v29, v29, v64
    v_exp_f32 v29, v29
    s_nop 0
    v_cndmask_b32_e64 v29, 0, v29, s[36:37]
    v_sub_f32 v30, v30, v64
    v_exp_f32 v30, v30
    s_nop 0
    v_cndmask_b32_e64 v30, 0, v30, s[36:37]
    v_sub_f32 v31, v31, v64
    v_exp_f32 v31, v31
    s_nop 0
    v_cndmask_b32_e64 v31, 0, v31, s[36:37]
    v_sub_f32 v32, v32, v64
    v_exp_f32 v32, v32
    s_nop 0
    v_cndmask_b32_e64 v32, 0, v32, s[36:37]
    v_sub_f32 v33, v33, v64
    v_exp_f32 v33, v33
    s_nop 0
    v_cndmask_b32_e64 v33, 0, v33, s[36:37]
    v_sub_f32 v34, v34, v64
    v_exp_f32 v34, v34
    s_nop 0
    v_cndmask_b32_e64 v34, 0, v34, s[36:37]
    v_sub_f32 v35, v35, v64
    v_exp_f32 v35, v35
    s_nop 0
    v_cndmask_b32_e64 v35, 0, v35, s[36:37]
    v_sub_f32 v52, v52, v64
    v_exp_f32 v52, v52
    s_nop 0
    v_cndmask_b32_e64 v52, 0, v52, s[36:37]
    v_sub_f32 v53, v53, v64
    v_exp_f32 v53, v53
    s_nop 0
    v_cndmask_b32_e64 v53, 0, v53, s[36:37]
    v_sub_f32 v54, v54, v64
    v_exp_f32 v54, v54
    s_nop 0
    v_cndmask_b32_e64 v54, 0, v54, s[36:37]
    v_sub_f32 v55, v55, v64
    v_exp_f32 v55, v55
    s_nop 0
    v_cndmask_b32_e64 v55, 0, v55, s[36:37]
    v_cvt_pk_bf16_f32 v28, v28, v29
    v_cvt_pk_bf16_f32 v29, v30, v31
    v_cvt_pk_bf16_f32 v30, v32, v33
    v_cvt_pk_bf16_f32 v31, v34, v35
    v_mov_b32_dpp v32, v28 row_ror:8 row_mask:0xf bank_mask:0xf
    v_mov_b32_dpp v33, v29 row_ror:8 row_mask:0xf bank_mask:0xf
    v_mov_b32_dpp v34, v30 row_ror:8 row_mask:0xf bank_mask:0xf
    v_mov_b32_dpp v35, v31 row_ror:8 row_mask:0xf bank_mask:0xf
    v_cvt_pk_bf16_f32 v52, v52, v53
    v_cvt_pk_bf16_f32 v53, v54, v55
    s_nop 0
    v_mov_b32_dpp v54, v52 row_ror:8 row_mask:0xf bank_mask:0xf
    v_mfma_f32_16x16x32_bf16 v[12:15], v[16:19], v[28:31], 0
    ds_read_b128 v[56:59], v0 offset:8192
    s_waitcnt lgkmcnt(0)
    v_mfma_f32_16x16x32_bf16 v[20:23], v[56:59], v[28:31], 0
    s_nop 3
    ds_read_b128 v[60:63], v0 offset:9216
    s_waitcnt lgkmcnt(0)
    v_mfma_f32_16x16x32_bf16 v[20:23], v[60:63], v[32:35], v[20:23]
    s_nop 3
    ds_read_b128 v[56:59], v0 offset:10240
    s_waitcnt lgkmcnt(0)
    v_mfma_f32_16x16x32_bf16 v[24:27], v[56:59], v[28:31], 0
    s_nop 3
    ds_read_b128 v[60:63], v0 offset:11264
    s_waitcnt lgkmcnt(0)
    v_mfma_f32_16x16x32_bf16 v[24:27], v[60:63], v[32:35], v[24:27]
    s_nop 3
    ds_read_b128 v[56:59], v0 offset:12288
    s_waitcnt lgkmcnt(0)
    v_mfma_f32_16x16x32_bf16 v[72:75], v[56:59], v[28:31], 0
    s_nop 3
    ds_read_b128 v[60:63], v0 offset:13312
    s_waitcnt lgkmcnt(0)
    v_mfma_f32_16x16x32_bf16 v[72:75], v[60:63], v[32:35], v[72:75]
    s_nop 3
    ds_read_b128 v[56:59], v0 offset:14336
    s_waitcnt lgkmcnt(0)
    v_mfma_f32_16x16x32_bf16 v[76:79], v[56:59], v[28:31], 0
    s_nop 3
    ds_read_b128 v[60:63], v0 offset:15360
    s_waitcnt lgkmcnt(0)
    v_mfma_f32_16x16x32_bf16 v[76:79], v[60:63], v[32:35], v[76:79]
    s_nop 3
    s_nop 7
    s_branch main_kernel_c0_1_fin
main_kernel_c0_1_last:
    s_cmp_lg_u32 s70, 0
    s_cbranch_scc1 main_kernel_c0_1_last2
    v_cmp_u_f32 vcc, v32, v32
    s_cbranch_vccnz main_kernel_c0_1_vfy0
main_kernel_c0_1_last2:
    s_waitcnt vmcnt(0) lgkmcnt(0)
    s_barrier
    v_mov_b32 v11, 8192
    s_mov_b64 exec, 1
    buffer_store_dword v11, v0, s[8:11], s52 offen sc1
    s_mov_b64 exec, -1
    s_add_u32 s52, s52, 4096
    s_nop 7
    v_mov_b64 v[72:73], -1
    v_mov_b64 v[74:75], -1
    s_add_u32 s28, s44, 3
    s_and_b32 s29, s28, 3
    s_mul_i32 s31, s22, 160
    s_mul_i32 s28, s29, 167936
    s_add_u32 s28, s28, s34
    s_add_u32 s64, s28, s35
    s_add_u32 s65, s28, s32
    s_lshl_b32 s60, s29, 15
    s_add_u32 s60, s60, s47
    s_add_u32 s60, s60, s31
    buffer_store_dwordx4 v[72:75], v0, s[8:11], s64 offen offset:1024
    buffer_store_dwordx4 v[72:75], v0, s[8:11], s64 offen offset:2048
    buffer_store_dwordx4 v[72:75], v0, s[8:11], s65 offen
    s_mov_b32 s65, 0x10000000
    s_mov_b32 s64, 0x10000000
    s_mov_b64 exec, 0x3ff
    buffer_store_dwordx4 v[72:75], v0, s[8:11], s60 offen sc1
    s_mov_b64 exec, -1
    s_mov_b32 s60, 0x10000000
    s_waitcnt vmcnt(0)
    s_add_u32 s44, s44, 1
    s_cmp_eq_u32 s44, 128
    s_cbranch_scc1 main_kernel_end
    s_branch main_kernel_c0_1_layer
main_kernel_c0_1_lr:
    s_mov_b32 s30, 0
main_kernel_c0_1_lr_l:
    s_waitcnt lgkmcnt(0)
    ds_read_b128 v[36:39], v6 offset:21504
    ds_read_b128 v[40:43], v6 offset:22528
    ds_read_b128 v[44:47], v6 offset:23552
    ds_read_b128 v[48:51], v6 offset:24576
    ds_read_b128 v[52:55], v6 offset:25600
    s_waitcnt lgkmcnt(2)
    v_max3_u32 v10, v36, v40, v44
    s_waitcnt lgkmcnt(0)
    v_max3_u32 v10, v10, v48, v52
    v_cmp_eq_u32 vcc, -1, v10
    s_cbranch_vccz main_kernel_c0_1_lr_d
    s_add_u32 s30, s30, 1
    s_cmp_ge_u32 s30, 480000
    s_cbranch_scc1 main_kernel_fail
    s_branch main_kernel_c0_1_lr_l
main_kernel_c0_1_lr_d:
    ds_read_b128 v[56:59], v5 offset:0
    ds_read_b128 v[60:63], v5 offset:1024
    ds_read_b128 v[64:67], v5 offset:2048
    ds_read_b128 v[68:71], v5 offset:3072
    v_mov_b64 v[12:13], 0
    v_mov_b64 v[14:15], 0
    v_mov_b64 v[16:17], 0
    v_mov_b64 v[18:19], 0
    v_mov_b64 v[20:21], 0
    v_mov_b64 v[22:23], 0
    v_mov_b64 v[24:25], 0
    v_mov_b64 v[26:27], 0
    v_mov_b64 v[28:29], 0
    v_mov_b64 v[30:31], 0
    v_mov_b64 v[32:33], 0
    v_mov_b64 v[34:35], 0
    s_waitcnt lgkmcnt(0)
    s_branch main_kernel_c0_1_lr_r
main_kernel_c0_1_rr:
    s_mov_b32 s30, 0
main_kernel_c0_1_rr_l:
    s_waitcnt lgkmcnt(0)
    s_and_b32 s27, s30, 1
    s_cbranch_scc1 main_kernel_c0_1_rr_n
    s_waitcnt vmcnt(1)
    s_mov_b32 m0, 16384
    s_nop 0
    buffer_load_dwordx4 v0, s[8:11], s49 offen offset:2048 sc1 lds
main_kernel_c0_1_rr_n:
    ds_read_b128 v[36:39], v6 offset:16384
    ds_read_b128 v[40:43], v6 offset:17408
    ds_read_b128 v[44:47], v6 offset:18432
    ds_read_b128 v[48:51], v6 offset:19456
    ds_read_b32 v11, v6 offset:20480
    s_waitcnt lgkmcnt(2)
    v_max3_u32 v10, v36, v40, v44
    s_waitcnt lgkmcnt(0)
    v_max3_u32 v10, v10, v48, v11
    v_cmp_eq_u32 vcc, -1, v10
    s_cbranch_vccz main_kernel_c0_1_rr_d
    s_add_u32 s30, s30, 1
    s_cmp_ge_u32 s30, 480000
    s_cbranch_scc1 main_kernel_fail
    s_branch main_kernel_c0_1_rr_l
main_kernel_c0_1_rr_d:
    s_branch main_kernel_c0_1_rr_r
main_kernel_c0_1_wrb_l:
    s_waitcnt vmcnt(1)
    v_mfma_f32_16x16x32_bf16 v[76:79], v[72:75], v[40:43], 0
    v_cmp_eq_u32 vcc, -1, v40
    s_cbranch_vccz main_kernel_c0_1_wrb_x0
main_kernel_c0_1_wrb_i0:
    buffer_load_dwordx4 v[40:43], v0, s[8:11], s43 offen sc1
    s_waitcnt vmcnt(1)
    v_mfma_f32_16x16x32_bf16 v[76:79], v[72:75], v[44:47], 0
    v_cmp_eq_u32 vcc, -1, v44
    s_cbranch_vccz main_kernel_c0_1_wrb_x1
main_kernel_c0_1_wrb_i1:
    buffer_load_dwordx4 v[44:47], v0, s[8:11], s43 offen sc1
    s_add_u32 s71, s71, 1
    s_cmp_lt_u32 s71, 240000
    s_cbranch_scc1 main_kernel_c0_1_wrb_l
    s_branch main_kernel_fail
main_kernel_c0_1_wrb_x0:
    s_nop 5
    v_add_f32_dpp v76, v76, v76 row_ror:8 row_mask:0xf bank_mask:0xf
    v_add_f32_dpp v77, v77, v77 row_ror:8 row_mask:0xf bank_mask:0xf
    s_nop 0
    v_add_f32_dpp v76, v76, v76 row_ror:4 row_mask:0xf bank_mask:0xf
    v_add_f32_dpp v77, v77, v77 row_ror:4 row_mask:0xf bank_mask:0xf
    s_nop 0
    v_add_f32_dpp v76, v76, v76 row_ror:2 row_mask:0xf bank_mask:0xf
    v_add_f32_dpp v77, v77, v77 row_ror:2 row_mask:0xf bank_mask:0xf
    v_cmp_u_f32 vcc, v76, v76
    v_cvt_pk_bf16_f32 v76, v76, v77
    s_cbranch_vccz main_kernel_c0_1_wrb_n
main_kernel_c0_1_wrb_e0:
    v_max3_u32 v32, v40, v41, v42
    v_max_u32 v32, v32, v43
    v_cmp_eq_u32 vcc, -1, v32
    s_cbranch_vccnz main_kernel_c0_1_wrb_i0
    v_min_u32 v76, -2, v76
    v_min_u32 v77, -2, v77
    s_branch main_kernel_c0_1_wrb_n
main_kernel_c0_1_wrb_x1:
    s_nop 5
    v_add_f32_dpp v76, v76, v76 row_ror:8 row_mask:0xf bank_mask:0xf
    v_add_f32_dpp v77, v77, v77 row_ror:8 row_mask:0xf bank_mask:0xf
    s_nop 0
    v_add_f32_dpp v76, v76, v76 row_ror:4 row_mask:0xf bank_mask:0xf
    v_add_f32_dpp v77, v77, v77 row_ror:4 row_mask:0xf bank_mask:0xf
    s_nop 0
    v_add_f32_dpp v76, v76, v76 row_ror:2 row_mask:0xf bank_mask:0xf
    v_add_f32_dpp v77, v77, v77 row_ror:2 row_mask:0xf bank_mask:0xf
    v_cmp_u_f32 vcc, v76, v76
    v_cvt_pk_bf16_f32 v76, v76, v77
    s_cbranch_vccz main_kernel_c0_1_wrb_n
main_kernel_c0_1_wrb_e1:
    v_max3_u32 v32, v44, v45, v46
    v_max_u32 v32, v32, v47
    v_cmp_eq_u32 vcc, -1, v32
    s_cbranch_vccnz main_kernel_c0_1_wrb_i1
    v_min_u32 v76, -2, v76
    v_min_u32 v77, -2, v77
main_kernel_c0_1_wrb_n:
    s_mov_b64 exec, s[62:63]
    buffer_store_dword v76, v11, s[8:11], s58 offen
    s_branch main_kernel_c0_1_wrb_d
main_kernel_c0_2_layer:
    s_lshr_b32 s27, s44, 6
    s_mul_i32 s50, s27, 33554432
    s_lshl_b32 s27, s22, 13
    s_add_u32 s50, s50, s27
    s_add_u32 s50, s50, 37748736
    s_barrier
    s_and_b32 s26, s44, 63
    s_lshl_b32 s26, s26, 18
    s_add_u32 s26, s26, s50
    s_mul_i32 s27, s20, 5120
    s_add_u32 s48, s27, 167772160
    s_sub_u32 s49, 167777280, s27
    s_mov_b32 m0, 21504
    s_nop 0
    buffer_load_dwordx4 v0, s[8:11], s48 offen offset:0 sc1 lds
    buffer_load_dwordx4 v0, s[8:11], s48 offen offset:1024 sc1 lds
    buffer_load_dwordx4 v0, s[8:11], s48 offen offset:2048 sc1 lds
    ds_read_b128 v[56:59], v5 offset:0
    ds_read_b128 v[60:63], v5 offset:1024
    ds_read_b128 v[64:67], v5 offset:2048
    ds_read_b128 v[68:71], v5 offset:3072
    v_mov_b64 v[12:13], 0
    v_mov_b64 v[14:15], 0
    v_mov_b64 v[16:17], 0
    v_mov_b64 v[18:19], 0
    v_mov_b64 v[20:21], 0
    v_mov_b64 v[22:23], 0
    v_mov_b64 v[24:25], 0
    v_mov_b64 v[26:27], 0
    v_mov_b64 v[28:29], 0
    v_mov_b64 v[30:31], 0
    v_mov_b64 v[32:33], 0
    v_mov_b64 v[34:35], 0
    s_mov_b32 s70, 0
    s_waitcnt vmcnt(0) lgkmcnt(0)
main_kernel_c0_2_top:
    s_barrier
    ds_read_b128 v[36:39], v6 offset:21504
    ds_read_b128 v[40:43], v6 offset:22528
    ds_read_b128 v[44:47], v6 offset:23552
    ds_read_b128 v[48:51], v6 offset:24576
    ds_read_b128 v[52:55], v6 offset:25600
    s_mov_b32 m0, 16384
    s_nop 0
    buffer_load_dwordx4 v0, s[8:11], s49 offen offset:3072 sc1 lds
main_kernel_c0_2_lr_r:
    s_waitcnt lgkmcnt(4)
    v_smfmac_f32_16x16x64_bf16 v[20:23], v[36:39], v[56:63], v1
    ds_read_b128 v[56:59], v5 offset:4096
    v_smfmac_f32_16x16x64_bf16 v[24:27], v[36:39], a[248:255], v1
    ds_read_b128 v[60:63], v5 offset:5120
    v_smfmac_f32_16x16x64_bf16 v[28:31], v[36:39], a[240:247], v1
    v_smfmac_f32_16x16x64_bf16 v[32:35], v[36:39], v[64:71], v1
    ds_read_b128 v[64:67], v5 offset:6144
    v_smfmac_f32_16x16x64_bf16 v[12:15], v[36:39], a[232:239], v1
    ds_read_b128 v[68:71], v5 offset:7168
    s_waitcnt lgkmcnt(6)
    v_max3_u32 v10, v36, v40, v44
    v_smfmac_f32_16x16x64_bf16 v[16:19], v[36:39], a[224:231], v1
    s_waitcnt lgkmcnt(4)
    s_waitcnt lgkmcnt(2)
    v_max3_u32 v10, v10, v48, v52
    v_smfmac_f32_16x16x64_bf16 v[20:23], v[40:43], v[56:63], v1
    ds_read_b128 v[56:59], v5 offset:8192
    v_cmp_eq_u32 vcc, -1, v10
    v_smfmac_f32_16x16x64_bf16 v[24:27], v[40:43], a[216:223], v1
    ds_read_b128 v[60:63], v5 offset:9216
    s_cbranch_vccnz main_kernel_c0_2_lr
    v_smfmac_f32_16x16x64_bf16 v[28:31], v[40:43], a[208:215], v1
    s_and_b32 s55, s44, 3
    s_mul_i32 s55, s55, 167936
    s_waitcnt lgkmcnt(2)
    v_smfmac_f32_16x16x64_bf16 v[32:35], v[40:43], v[64:71], v1
    ds_read_b128 v[64:67], v5 offset:10240
    s_add_u32 s55, s55, s34
    s_add_u32 s56, s55, s35
    v_smfmac_f32_16x16x64_bf16 v[20:23], v[44:47], a[200:207], v1
    ds_read_b128 v[68:71], v5 offset:11264
    s_and_b32 s57, s44, 63
    v_smfmac_f32_16x16x64_bf16 v[24:27], v[44:47], a[192:199], v1
    s_waitcnt lgkmcnt(2)
    v_smfmac_f32_16x16x64_bf16 v[28:31], v[44:47], v[56:63], v1
    ds_read_b128 v[56:59], v5 offset:12288
    v_smfmac_f32_16x16x64_bf16 v[32:35], v[44:47], a[184:191], v1
    ds_read_b128 v[60:63], v5 offset:13312
    v_smfmac_f32_16x16x64_bf16 v[20:23], v[48:51], a[176:183], v1
    s_waitcnt lgkmcnt(2)
    v_smfmac_f32_16x16x64_bf16 v[24:27], v[48:51], v[64:71], v1
    ds_read_b128 v[64:67], v5 offset:14336
    v_smfmac_f32_16x16x64_bf16 v[28:31], v[48:51], a[168:175], v1
    ds_read_b128 v[68:71], v5 offset:15360
    v_smfmac_f32_16x16x64_bf16 v[32:35], v[48:51], a[160:167], v1
    s_mov_b32 m0, 4096
    s_add_u32 s59, s26, 4096
    buffer_load_dwordx4 v0, s[8:11], s59 offen offset:0 sc1 lds
    buffer_load_dwordx4 v0, s[8:11], s59 offen offset:1024 sc1 lds
    buffer_load_dwordx4 v0, s[8:11], s59 offen offset:2048 sc1 lds
    buffer_load_dwordx4 v0, s[8:11], s59 offen offset:3072 sc1 lds
    s_add_u32 s27, s26, 16777216
    s_mov_b32 m0, 8192
    s_nop 0
    buffer_load_dwordx4 v0, s[8:11], s27 offen offset:0 sc1 lds
    buffer_load_dwordx4 v0, s[8:11], s27 offen offset:1024 sc1 lds
    s_waitcnt vmcnt(6)
    s_barrier
    ds_read_b128 v[36:39], v6 offset:16384
    ds_read_b128 v[40:43], v6 offset:17408
    ds_read_b128 v[44:47], v6 offset:18432
    ds_read_b128 v[48:51], v6 offset:19456
    ds_read_b32 v11, v6 offset:20480
    s_waitcnt lgkmcnt(7)
    v_smfmac_f32_16x16x64_bf16 v[20:23], v[52:55], v[56:63], v1
    ds_read_b128 v[56:59], v5 offset:16384
    v_smfmac_f32_16x16x64_bf16 v[24:27], v[52:55], a[152:159], v1
    ds_read_b128 v[60:63], v5 offset:17408
    v_smfmac_f32_16x16x64_bf16 v[28:31], v[52:55], a[144:151], v1
    s_waitcnt lgkmcnt(4)
    v_max3_u32 v10, v36, v40, v44
    v_smfmac_f32_16x16x64_bf16 v[32:35], v[52:55], v[64:71], v1
    s_waitcnt lgkmcnt(2)
    v_max3_u32 v10, v10, v48, v11
    v_cmp_eq_u32 vcc, -1, v10
    s_cbranch_vccnz main_kernel_c0_2_rr
main_kernel_c0_2_rr_r:
    ds_read_b128 v[52:55], v6 offset:20480
    v_smfmac_f32_16x16x64_bf16 v[20:23], v[36:39], a[136:143], v1
    ds_read_b128 v[64:67], v5 offset:18432
    v_smfmac_f32_16x16x64_bf16 v[24:27], v[36:39], a[128:135], v1
    ds_read_b128 v[68:71], v5 offset:19456
    s_waitcnt lgkmcnt(3)
    v_smfmac_f32_16x16x64_bf16 v[20:23], v[40:43], v[56:63], v1
    ds_read_b128 v[56:59], v5 offset:20480
    v_smfmac_f32_16x16x64_bf16 v[24:27], v[40:43], a[120:127], v1
    ds_read_b128 v[60:63], v5 offset:21504
    buffer_store_dwordx4 v[72:75], v0, s[8:11], s4 offen offset:0 sc1
    buffer_store_dwordx4 v[76:79], v0, s[8:11], s4 offen offset:1024 sc1
    s_mov_b32 s4, 0x10000000
    v_smfmac_f32_16x16x64_bf16 v[20:23], v[44:47], a[112:119], v1
    s_waitcnt lgkmcnt(2)
    v_smfmac_f32_16x16x64_bf16 v[24:27], v[44:47], v[64:71], v1
    ds_read_b128 v[64:67], v5 offset:22528
    v_smfmac_f32_16x16x64_bf16 v[20:23], v[48:51], a[104:111], v1
    ds_read_b128 v[68:71], v5 offset:23552
    v_smfmac_f32_16x16x64_bf16 v[24:27], v[48:51], a[96:103], v1
    s_waitcnt lgkmcnt(2)
    v_smfmac_f32_16x16x64_bf16 v[20:23], v[52:55], v[56:63], v1
    ds_read_b128 v[56:59], v5 offset:24576
    v_smfmac_f32_16x16x64_bf16 v[24:27], v[52:55], a[88:95], v1
    ds_read_b128 v[60:63], v5 offset:25600
    v_smfmac_f32_16x16x64_bf16 v[28:31], v[36:39], a[80:87], v1
    s_waitcnt lgkmcnt(2)
    v_smfmac_f32_16x16x64_bf16 v[32:35], v[36:39], v[64:71], v1
    ds_read_b128 v[64:67], v5 offset:26624
    s_nop 0
    v_permlane32_swap_b32 v20, v21
    v_smfmac_f32_16x16x64_bf16 v[28:31], v[40:43], a[72:79], v1
    ds_read_b128 v[68:71], v5 offset:27648
    v_permlane32_swap_b32 v22, v23
    v_smfmac_f32_16x16x64_bf16 v[32:35], v[40:43], a[64:71], v1
    s_waitcnt lgkmcnt(2)
    v_permlane32_swap_b32 v24, v25
    v_smfmac_f32_16x16x64_bf16 v[28:31], v[44:47], v[56:63], v1
    ds_read_b128 v[56:59], v5 offset:28672
    v_permlane32_swap_b32 v26, v27
    v_smfmac_f32_16x16x64_bf16 v[32:35], v[44:47], a[56:63], v1
    ds_read_b128 v[60:63], v5 offset:29696
    v_add_f32 v20, v20, v21
    v_add_f32 v22, v22, v23
    v_smfmac_f32_16x16x64_bf16 v[28:31], v[48:51], a[48:55], v1
    s_waitcnt lgkmcnt(2)
    v_add_f32 v24, v24, v25
    v_add_f32 v26, v26, v27
    v_smfmac_f32_16x16x64_bf16 v[32:35], v[48:51], v[64:71], v1
    ds_read_b128 v[64:67], v5 offset:30720
    v_mul_f32 v20, s40, v20
    v_mul_f32 v24, s40, v24
    v_smfmac_f32_16x16x64_bf16 v[28:31], v[52:55], a[40:47], v1
    ds_read_b128 v[68:71], v5 offset:31744
    v_mul_f32 v22, s40, v22
    v_mul_f32 v26, s40, v26
    v_smfmac_f32_16x16x64_bf16 v[32:35], v[52:55], a[32:39], v1
    s_waitcnt lgkmcnt(2)
    v_cvt_pk_bf16_f32 v20, v20, v24
    v_cvt_pk_bf16_f32 v21, v22, v26
    v_smfmac_f32_16x16x64_bf16 v[12:15], v[36:39], v[56:63], v1
    ds_write_b32 v2, v20 offset:26624
    ds_write_b32 v2, v21 offset:27200
    v_smfmac_f32_16x16x64_bf16 v[16:19], v[36:39], a[24:31], v1
    v_permlane32_swap_b32 v28, v29
    v_smfmac_f32_16x16x64_bf16 v[12:15], v[40:43], a[16:23], v1
    s_waitcnt lgkmcnt(2)
    v_permlane32_swap_b32 v30, v31
    v_smfmac_f32_16x16x64_bf16 v[16:19], v[40:43], v[64:71], v1
    ds_read_b128 v[40:43], v6 offset:22528
    v_permlane32_swap_b32 v32, v33
    v_smfmac_f32_16x16x64_bf16 v[12:15], v[44:47], a[8:15], v1
    v_permlane32_swap_b32 v34, v35
    v_smfmac_f32_16x16x64_bf16 v[16:19], v[44:47], a[0:7], v1
    ds_read_b128 v[44:47], v6 offset:23552
    v_add_f32 v28, v28, v29
    v_add_f32 v30, v30, v31
    v_smfmac_f32_16x16x64_bf16 v[12:15], v[48:51], v[248:255], v1
    v_add_f32 v32, v32, v33
    v_add_f32 v34, v34, v35
    v_smfmac_f32_16x16x64_bf16 v[16:19], v[48:51], v[240:247], v1
    ds_read_b128 v[48:51], v6 offset:24576
    v_cvt_pk_bf16_f32 v28, v28, v32
    v_cvt_pk_bf16_f32 v29, v30, v34
    v_smfmac_f32_16x16x64_bf16 v[12:15], v[52:55], v[232:239], v1
    ds_write_b32 v2, v28 offset:28928
    ds_write_b32 v2, v29 offset:29504
    v_smfmac_f32_16x16x64_bf16 v[16:19], v[52:55], v[224:231], v1
    ds_read_b128 v[52:55], v6 offset:25600
    s_waitcnt lgkmcnt(5)
    v_smfmac_f32_16x16x64_bf16 v[12:15], v[40:43], v[216:223], v1
    v_smfmac_f32_16x16x64_bf16 v[16:19], v[40:43], v[208:215], v1
    s_waitcnt vmcnt(2) lgkmcnt(1)
    s_barrier
    ds_read_b128 v[56:59], v0 offset:0
    ds_read_b128 v[20:23], v4 offset:26624
    v_smfmac_f32_16x16x64_bf16 v[12:15], v[44:47], v[200:207], v1
    ds_read_b128 v[60:63], v0 offset:1024
    ds_read_b128 v[24:27], v4 offset:26688
    v_smfmac_f32_16x16x64_bf16 v[16:19], v[44:47], v[192:199], v1
    ds_read_b128 v[64:67], v0 offset:2048
    ds_read_b128 v[72:75], v4 offset:26752
    v_smfmac_f32_16x16x64_bf16 v[12:15], v[48:51], v[184:191], v1
    ds_read_b128 v[68:71], v0 offset:3072
    ds_read_b128 v[76:79], v4 offset:26816
    v_smfmac_f32_16x16x64_bf16 v[16:19], v[48:51], v[176:183], v1
    ds_read_b128 v[36:39], v0 offset:4096
    ds_read_b128 v[40:43], v0 offset:5120
    s_waitcnt lgkmcnt(10)
    v_smfmac_f32_16x16x64_bf16 v[12:15], v[52:55], v[168:175], v1
    ds_read_b128 v[44:47], v0 offset:6144
    ds_read_b128 v[48:51], v0 offset:7168
    v_smfmac_f32_16x16x64_bf16 v[16:19], v[52:55], v[160:167], v1
    s_waitcnt lgkmcnt(10)
    v_mfma_f32_16x16x32_bf16 v[28:31], v[56:59], v[20:23], 0
    s_waitcnt lgkmcnt(8)
    v_mfma_f32_16x16x32_bf16 v[28:31], v[60:63], v[24:27], v[28:31]
    s_nop 0
    s_waitcnt lgkmcnt(6)
    v_cvt_pk_bf16_f32 v12, v12, v13
    v_cvt_pk_bf16_f32 v13, v14, v15
    v_mfma_f32_16x16x32_bf16 v[28:31], v[64:67], v[72:75], v[28:31]
    s_waitcnt lgkmcnt(4)
    v_cvt_pk_bf16_f32 v14, v16, v17
    v_cvt_pk_bf16_f32 v15, v18, v19
    v_mfma_f32_16x16x32_bf16 v[28:31], v[68:71], v[76:79], v[28:31]
    ds_write_b128 v0, v[12:15] offset:18432
    s_waitcnt lgkmcnt(4)
    v_mfma_f32_16x16x32_bf16 v[32:35], v[36:39], v[20:23], 0
    ds_read_b128 v[56:59], v3 offset:28928
    ds_read_b128 v[60:63], v3 offset:28992
    s_waitcnt lgkmcnt(5)
    v_mfma_f32_16x16x32_bf16 v[32:35], v[40:43], v[24:27], v[32:35]
    ds_read_b128 v[64:67], v3 offset:29056
    ds_read_b128 v[68:71], v3 offset:29120
    s_waitcnt lgkmcnt(6)
    v_mfma_f32_16x16x32_bf16 v[32:35], v[44:47], v[72:75], v[32:35]
    s_mov_b64 exec, s[36:37]
    v_exp_f32 v28, v28
    v_exp_f32 v29, v29
    s_mov_b64 exec, -1
    s_waitcnt lgkmcnt(5)
    v_mfma_f32_16x16x32_bf16 v[32:35], v[48:51], v[76:79], v[32:35]
    s_mov_b64 exec, s[36:37]
    v_exp_f32 v30, v30
    v_exp_f32 v31, v31
    s_mov_b64 exec, -1
    s_waitcnt lgkmcnt(4)
    s_barrier
    s_waitcnt lgkmcnt(3)
    v_mfma_f32_16x16x32_bf16 v[52:55], v[56:59], v[20:23], 0
    ds_read_b128 v[36:39], v0 offset:8192
    s_waitcnt lgkmcnt(3)
    v_cvt_pk_bf16_f32 v28, v28, v29
    v_cvt_pk_bf16_f32 v29, v30, v31
    v_mfma_f32_16x16x32_bf16 v[52:55], v[60:63], v[24:27], v[52:55]
    ds_read_b128 v[40:43], v0 offset:10240
    s_mov_b64 exec, s[36:37]
    v_exp_f32 v32, v32
    v_exp_f32 v33, v33
    s_mov_b64 exec, -1
    s_waitcnt lgkmcnt(3)
    v_mfma_f32_16x16x32_bf16 v[52:55], v[64:67], v[72:75], v[52:55]
    ds_read_b128 v[44:47], v0 offset:12288
    s_mov_b64 exec, s[36:37]
    v_exp_f32 v34, v34
    v_exp_f32 v35, v35
    s_mov_b64 exec, -1
    s_waitcnt lgkmcnt(3)
    v_mfma_f32_16x16x32_bf16 v[52:55], v[68:71], v[76:79], v[52:55]
    ds_read_b128 v[48:51], v0 offset:14336
    v_cvt_pk_bf16_f32 v30, v32, v33
    v_cvt_pk_bf16_f32 v31, v34, v35
    s_cmp_eq_u32 s57, 63
    s_cbranch_scc1 main_kernel_c0_2_last
    s_waitcnt lgkmcnt(3)
    v_mfma_f32_16x16x32_bf16 v[20:23], v[36:39], v[28:31], 0
    ds_read_b128 v[56:59], v0 offset:9216
    s_waitcnt lgkmcnt(3)
    v_mov_b32_dpp v32, v28 row_ror:8 row_mask:0xf bank_mask:0xf
    v_mov_b32_dpp v33, v29 row_ror:8 row_mask:0xf bank_mask:0xf
    v_mfma_f32_16x16x32_bf16 v[24:27], v[40:43], v[28:31], 0
    ds_read_b128 v[60:63], v0 offset:11264
    s_waitcnt lgkmcnt(3)
    v_mov_b32_dpp v34, v30 row_ror:8 row_mask:0xf bank_mask:0xf
    v_mov_b32_dpp v35, v31 row_ror:8 row_mask:0xf bank_mask:0xf
    v_mfma_f32_16x16x32_bf16 v[72:75], v[44:47], v[28:31], 0
    ds_read_b128 v[64:67], v0 offset:13312
    s_waitcnt lgkmcnt(3)
    v_mov_b64 v[16:17], s[24:25]
    v_mov_b64 v[18:19], s[24:25]
    v_mfma_f32_16x16x32_bf16 v[76:79], v[48:51], v[28:31], 0
    ds_read_b128 v[68:71], v0 offset:15360
    s_mov_b64 exec, s[36:37]
    v_exp_f32 v52, v52
    s_mov_b64 exec, -1
    v_mfma_f32_16x16x32_bf16 v[12:15], v[16:19], v[28:31], 0
    ds_read_b128 v[36:39], v0 offset:16384
    s_mov_b64 exec, s[36:37]
    v_exp_f32 v53, v53
    s_mov_b64 exec, -1
    s_waitcnt lgkmcnt(4)
    v_mfma_f32_16x16x32_bf16 v[20:23], v[56:59], v[32:35], v[20:23]
    ds_read_b128 v[40:43], v0 offset:17408
    s_mov_b64 exec, s[36:37]
    v_exp_f32 v54, v54
    s_mov_b64 exec, -1
    s_waitcnt lgkmcnt(4)
    v_mfma_f32_16x16x32_bf16 v[24:27], v[60:63], v[32:35], v[24:27]
    ds_read_b128 v[44:47], v0 offset:18432
    s_mov_b64 exec, s[36:37]
    v_exp_f32 v55, v55
    s_mov_b64 exec, -1
    s_waitcnt lgkmcnt(4)
    v_mfma_f32_16x16x32_bf16 v[72:75], v[64:67], v[32:35], v[72:75]
    ds_read_b128 v[48:51], v0 offset:19456
    s_waitcnt lgkmcnt(4)
    v_cvt_pk_bf16_f32 v52, v52, v53
    v_cvt_pk_bf16_f32 v53, v54, v55
    v_mfma_f32_16x16x32_bf16 v[76:79], v[68:71], v[32:35], v[76:79]
    v_mov_b64 v[10:11], s[16:17]
    v_mov_b32_dpp v54, v52 row_ror:8 row_mask:0xf bank_mask:0xf
main_kernel_c0_2_fin:
    s_waitcnt lgkmcnt(3)
    v_mfma_f32_16x16x16_bf16 v[20:23], v[36:37], v[52:53], v[20:23]
    v_mov_b32_dpp v55, v53 row_ror:8 row_mask:0xf bank_mask:0xf
    v_mov_b64 v[56:57], 0
    v_mfma_f32_16x16x16_bf16 v[12:15], v[10:11], v[52:53], v[12:15]
    s_waitcnt lgkmcnt(2)
    v_mov_b64 v[58:59], 0
    v_mov_b64 v[60:61], 0
    v_mfma_f32_16x16x16_bf16 v[24:27], v[40:41], v[52:53], v[24:27]
    v_mov_b64 v[62:63], 0
    v_mov_b64 v[64:65], 0
    v_mfma_f32_16x16x16_bf16 v[20:23], v[38:39], v[54:55], v[20:23]
    v_mov_b64 v[66:67], 0
    v_mov_b64 v[68:69], 0
    v_mfma_f32_16x16x16_bf16 v[24:27], v[42:43], v[54:55], v[24:27]
    s_waitcnt lgkmcnt(1)
    v_add_f32_dpp v12, v12, v12 row_ror:8 row_mask:0xf bank_mask:0xf
    v_mov_b64 v[70:71], 0
    v_mfma_f32_16x16x16_bf16 v[72:75], v[44:45], v[52:53], v[72:75]
    s_waitcnt lgkmcnt(0)
    v_rcp_f32 v14, v12
    v_mfma_f32_16x16x16_bf16 v[76:79], v[48:49], v[52:53], v[76:79]
    v_subrev_u32 v13, s68, v12
    v_cmp_lt_u32 vcc, s69, v13
    v_mfma_f32_16x16x16_bf16 v[72:75], v[46:47], v[54:55], v[72:75]
    s_cbranch_vccnz main_kernel_c0_2_zbad
main_kernel_c0_2_zok:
    v_mov_b64 v[28:29], 0
    v_mov_b64 v[30:31], 0
    v_mfma_f32_16x16x16_bf16 v[76:79], v[50:51], v[54:55], v[76:79]
    v_mul_f32 v20, v20, v14
    v_mul_f32 v21, v21, v14
    v_mul_f32 v22, v22, v14
    v_mul_f32 v23, v23, v14
    v_mul_f32 v24, v24, v14
    v_mul_f32 v25, v25, v14
    v_mul_f32 v26, v26, v14
    v_mul_f32 v27, v27, v14
    v_cvt_pk_bf16_f32 v20, v20, v21
    v_cvt_pk_bf16_f32 v21, v22, v23
    v_cvt_pk_bf16_f32 v22, v24, v25
    v_cvt_pk_bf16_f32 v23, v26, v27
    v_mul_f32 v72, v72, v14
    v_mul_f32 v73, v73, v14
    v_smfmac_f32_16x16x64_bf16 v[56:59], v[20:23], v[152:159], v1
    v_mul_f32 v74, v74, v14
    v_mul_f32 v75, v75, v14
    v_mul_f32 v76, v76, v14
    v_smfmac_f32_16x16x64_bf16 v[60:63], v[20:23], v[136:143], v1
    v_mul_f32 v77, v77, v14
    v_mul_f32 v78, v78, v14
    v_mul_f32 v79, v79, v14
    v_smfmac_f32_16x16x64_bf16 v[64:67], v[20:23], v[120:127], v1
    v_cvt_pk_bf16_f32 v72, v72, v73
    v_cvt_pk_bf16_f32 v73, v74, v75
    v_cvt_pk_bf16_f32 v74, v76, v77
    v_smfmac_f32_16x16x64_bf16 v[68:71], v[20:23], v[104:111], v1
    v_cvt_pk_bf16_f32 v75, v78, v79
    v_smfmac_f32_16x16x64_bf16 v[28:31], v[20:23], v[88:95], v1
    s_nop 0
    v_smfmac_f32_16x16x64_bf16 v[56:59], v[72:75], v[144:151], v1
    v_smfmac_f32_16x16x64_bf16 v[60:63], v[72:75], v[128:135], v1
    v_smfmac_f32_16x16x64_bf16 v[64:67], v[72:75], v[112:119], v1
    v_mov_b32 v5, v5
    v_mov_b32 v5, v5
    v_permlane32_swap_b32 v56, v57
    v_smfmac_f32_16x16x64_bf16 v[68:71], v[72:75], v[96:103], v1
    v_permlane32_swap_b32 v58, v59
    v_smfmac_f32_16x16x64_bf16 v[28:31], v[72:75], v[80:87], v1
    v_add_f32 v56, v56, v57
    v_add_f32 v58, v58, v59
    v_permlane32_swap_b32 v60, v61
    v_permlane32_swap_b32 v62, v63
    v_add_f32 v60, v60, v61
    v_add_f32 v62, v62, v63
    v_cvt_pk_bf16_f32 v36, v56, v60
    v_cvt_pk_bf16_f32 v38, v58, v62
    v_permlane32_swap_b32 v64, v65
    v_permlane32_swap_b32 v66, v67
    v_add_f32 v64, v64, v65
    v_add_f32 v66, v66, v67
    v_permlane32_swap_b32 v68, v69
    v_permlane32_swap_b32 v70, v71
    v_add_f32 v68, v68, v69
    v_add_f32 v70, v70, v71
    v_cvt_pk_bf16_f32 v37, v64, v68
    v_cvt_pk_bf16_f32 v39, v66, v70
    buffer_store_dwordx4 v[36:39], v0, s[8:11], s56 offen
    v_permlane32_swap_b32 v28, v29
    v_permlane32_swap_b32 v30, v31
    v_add_f32 v28, v28, v29
    v_add_f32 v30, v30, v31
    v_cvt_pk_bf16_f32 v28, v28, v30
    buffer_store_dword v28, v7, s[8:11], s55 offen
    s_add_u32 s27, s44, 1
    s_and_b32 s27, s27, 3
    s_mul_i32 s48, s27, 5120
    s_add_u32 s48, s48, s41
    s_lshl_b32 s27, s27, 15
    s_add_u32 s49, s27, s47
    v_add_u32 v10, 16384, v0
    v_add_u32 v11, 28928, v3
    v_cndmask_b32_e64 v10, v10, v11, s[42:43]
    ds_read_b128 v[72:75], v10 offset:0
    v_add_u32 v10, 17408, v0
    v_add_u32 v11, 28992, v3
    v_cndmask_b32_e64 v10, v10, v11, s[42:43]
    ds_read_b128 v[76:79], v10 offset:0
    s_lshl_b32 s4, s44, 18
    s_add_u32 s4, s4, s53
    ds_read_b128 v[56:59], v5 offset:0
    ds_read_b128 v[60:63], v5 offset:1024
    ds_read_b128 v[64:67], v5 offset:2048
    ds_read_b128 v[68:71], v5 offset:3072
    v_mov_b64 v[12:13], 0
    v_mov_b64 v[14:15], 0
    v_mov_b64 v[16:17], 0
    v_mov_b64 v[18:19], 0
    v_mov_b64 v[20:21], 0
    v_mov_b64 v[22:23], 0
    v_mov_b64 v[24:25], 0
    v_mov_b64 v[26:27], 0
    v_mov_b64 v[28:29], 0
    v_mov_b64 v[30:31], 0
    v_mov_b64 v[32:33], 0
    v_mov_b64 v[34:35], 0
    s_barrier
    s_and_b32 s26, s44, 63
    s_add_u32 s26, s26, 1
    s_min_u32 s26, s26, 63
    s_lshl_b32 s26, s26, 18
    s_add_u32 s26, s26, s50
    s_nop 15
    s_nop 15
    s_nop 14
    s_mov_b32 m0, 21504
    s_nop 0
    buffer_load_dwordx4 v0, s[8:11], s48 offen offset:0 sc1 lds
    buffer_load_dwordx4 v0, s[8:11], s48 offen offset:1024 sc1 lds
    buffer_load_dwordx4 v0, s[8:11], s48 offen offset:2048 sc1 lds
    s_add_u32 s44, s44, 1
    s_mov_b32 s70, 0
    s_waitcnt vmcnt(0) lgkmcnt(0)
    s_branch main_kernel_c0_2_top
main_kernel_c0_2_restart:
    s_waitcnt vmcnt(0) lgkmcnt(0)
    s_nop 7
    s_barrier
    s_mov_b32 m0, 21504
    s_nop 0
    buffer_load_dwordx4 v0, s[8:11], s48 offen offset:0 sc1 lds
    buffer_load_dwordx4 v0, s[8:11], s48 offen offset:1024 sc1 lds
    buffer_load_dwordx4 v0, s[8:11], s48 offen offset:2048 sc1 lds
    ds_read_b128 v[56:59], v5 offset:0
    ds_read_b128 v[60:63], v5 offset:1024
    ds_read_b128 v[64:67], v5 offset:2048
    ds_read_b128 v[68:71], v5 offset:3072
    v_mov_b64 v[12:13], 0
    v_mov_b64 v[14:15], 0
    v_mov_b64 v[16:17], 0
    v_mov_b64 v[18:19], 0
    v_mov_b64 v[20:21], 0
    v_mov_b64 v[22:23], 0
    v_mov_b64 v[24:25], 0
    v_mov_b64 v[26:27], 0
    v_mov_b64 v[28:29], 0
    v_mov_b64 v[30:31], 0
    v_mov_b64 v[32:33], 0
    v_mov_b64 v[34:35], 0
    s_waitcnt vmcnt(0) lgkmcnt(0)
    s_branch main_kernel_c0_2_top
main_kernel_c0_2_zbad:
    s_cmp_eq_u32 s70, 2
    s_cbranch_scc1 main_kernel_c0_2_zok
    v_cmp_u_f32 vcc, v12, v12
    s_cbranch_vccz main_kernel_c0_2_exact
    s_cmp_eq_u32 s70, 1
    s_cbranch_scc1 main_kernel_c0_2_exact
main_kernel_c0_2_vfy0:
    s_mov_b32 s70, 1
    s_mov_b32 s30, 0
    s_waitcnt vmcnt(0) lgkmcnt(0)
    s_nop 7
main_kernel_c0_2_vfy:
    v_mov_b32 v10, 0
    s_add_u32 s59, s48, 4096
    buffer_load_dwordx4 v[36:39], v0, s[8:11], s48 offen offset:0 sc1
    buffer_load_dwordx4 v[40:43], v0, s[8:11], s48 offen offset:1024 sc1
    buffer_load_dwordx4 v[44:47], v0, s[8:11], s48 offen offset:2048 sc1
    buffer_load_dwordx4 v[48:51], v0, s[8:11], s48 offen offset:3072 sc1
    buffer_load_dwordx4 v[52:55], v0, s[8:11], s59 offen offset:0 sc1
    s_waitcnt vmcnt(4)
    v_max3_u32 v10, v10, v36, v37
    v_max3_u32 v10, v10, v38, v39
    s_waitcnt vmcnt(3)
    v_max3_u32 v10, v10, v40, v41
    v_max3_u32 v10, v10, v42, v43
    s_waitcnt vmcnt(2)
    v_max3_u32 v10, v10, v44, v45
    v_max3_u32 v10, v10, v46, v47
    s_waitcnt vmcnt(1)
    v_max3_u32 v10, v10, v48, v49
    v_max3_u32 v10, v10, v50, v51
    s_waitcnt vmcnt(0)
    v_max3_u32 v10, v10, v52, v53
    v_max3_u32 v10, v10, v54, v55
    s_add_u32 s59, s49, 4096
    buffer_load_dwordx4 v[36:39], v0, s[8:11], s49 offen offset:0 sc1
    buffer_load_dwordx4 v[40:43], v0, s[8:11], s49 offen offset:1024 sc1
    buffer_load_dwordx4 v[44:47], v0, s[8:11], s49 offen offset:2048 sc1
    buffer_load_dwordx4 v[48:51], v0, s[8:11], s49 offen offset:3072 sc1
    buffer_load_dwordx4 v[52:55], v0, s[8:11], s59 offen offset:0 sc1
    s_waitcnt vmcnt(4)
    v_max3_u32 v10, v10, v36, v37
    v_max3_u32 v10, v10, v38, v39
    s_waitcnt vmcnt(3)
    v_max3_u32 v10, v10, v40, v41
    v_max3_u32 v10, v10, v42, v43
    s_waitcnt vmcnt(2)
    v_max3_u32 v10, v10, v44, v45
    v_max3_u32 v10, v10, v46, v47
    s_waitcnt vmcnt(1)
    v_max3_u32 v10, v10, v48, v49
    v_max3_u32 v10, v10, v50, v51
    s_waitcnt vmcnt(0)
    v_max3_u32 v10, v10, v52, v53
    v_max3_u32 v10, v10, v54, v55
    v_cmp_eq_u32 vcc, -1, v10
    s_cbranch_vccz main_kernel_c0_2_restart
    s_add_u32 s30, s30, 1
    s_cmp_ge_u32 s30, 60000
    s_cbranch_scc1 main_kernel_fail
    s_branch main_kernel_c0_2_vfy
main_kernel_c0_2_exact:
    s_nop 7
    s_mov_b32 s70, 2
    ds_read_b128 v[20:23], v3 offset:26624
    ds_read_b128 v[24:27], v3 offset:26688
    ds_read_b128 v[72:75], v3 offset:26752
    ds_read_b128 v[76:79], v3 offset:26816
    ds_read_b128 v[56:59], v0 offset:0
    s_waitcnt lgkmcnt(0)
    v_mfma_f32_16x16x32_bf16 v[28:31], v[56:59], v[20:23], 0
    s_nop 3
    ds_read_b128 v[60:63], v0 offset:1024
    s_waitcnt lgkmcnt(0)
    v_mfma_f32_16x16x32_bf16 v[28:31], v[60:63], v[24:27], v[28:31]
    s_nop 3
    ds_read_b128 v[56:59], v0 offset:2048
    s_waitcnt lgkmcnt(0)
    v_mfma_f32_16x16x32_bf16 v[28:31], v[56:59], v[72:75], v[28:31]
    s_nop 3
    ds_read_b128 v[60:63], v0 offset:3072
    s_waitcnt lgkmcnt(0)
    v_mfma_f32_16x16x32_bf16 v[28:31], v[60:63], v[76:79], v[28:31]
    s_nop 3
    ds_read_b128 v[56:59], v0 offset:4096
    s_waitcnt lgkmcnt(0)
    v_mfma_f32_16x16x32_bf16 v[32:35], v[56:59], v[20:23], 0
    s_nop 3
    ds_read_b128 v[60:63], v0 offset:5120
    s_waitcnt lgkmcnt(0)
    v_mfma_f32_16x16x32_bf16 v[32:35], v[60:63], v[24:27], v[32:35]
    s_nop 3
    ds_read_b128 v[56:59], v0 offset:6144
    s_waitcnt lgkmcnt(0)
    v_mfma_f32_16x16x32_bf16 v[32:35], v[56:59], v[72:75], v[32:35]
    s_nop 3
    ds_read_b128 v[60:63], v0 offset:7168
    s_waitcnt lgkmcnt(0)
    v_mfma_f32_16x16x32_bf16 v[32:35], v[60:63], v[76:79], v[32:35]
    s_nop 3
    ds_read_b128 v[56:59], v3 offset:28928
    s_waitcnt lgkmcnt(0)
    v_mfma_f32_16x16x32_bf16 v[52:55], v[56:59], v[20:23], 0
    s_nop 3
    ds_read_b128 v[60:63], v3 offset:28992
    s_waitcnt lgkmcnt(0)
    v_mfma_f32_16x16x32_bf16 v[52:55], v[60:63], v[24:27], v[52:55]
    s_nop 3
    ds_read_b128 v[56:59], v3 offset:29056
    s_waitcnt lgkmcnt(0)
    v_mfma_f32_16x16x32_bf16 v[52:55], v[56:59], v[72:75], v[52:55]
    s_nop 3
    ds_read_b128 v[60:63], v3 offset:29120
    s_waitcnt lgkmcnt(0)
    v_mfma_f32_16x16x32_bf16 v[52:55], v[60:63], v[76:79], v[52:55]
    s_nop 3
    v_max3_f32 v64, v28, v29, v30
    v_max3_f32 v64, v64, v31, v32
    v_max3_f32 v64, v64, v33, v34
    s_nop 0
    v_max3_f32 v64, v64, v35, v52
    v_max3_f32 v64, v64, v53, v54
    v_max_f32 v64, v64, v55
    v_mov_b32 v65, v64
    s_nop 1
    v_permlane16_swap_b32 v64, v65
    v_max_f32 v64, v64, v65
    v_mov_b32 v65, v64
    s_nop 1
    v_permlane32_swap_b32 v64, v65
    v_max_f32 v64, v64, v65
    v_sub_f32 v28, v28, v64
    v_exp_f32 v28, v28
    s_nop 0
    v_cndmask_b32_e64 v28, 0, v28, s[36:37]
    v_sub_f32 v29, v29, v64
    v_exp_f32 v29, v29
    s_nop 0
    v_cndmask_b32_e64 v29, 0, v29, s[36:37]
    v_sub_f32 v30, v30, v64
    v_exp_f32 v30, v30
    s_nop 0
    v_cndmask_b32_e64 v30, 0, v30, s[36:37]
    v_sub_f32 v31, v31, v64
    v_exp_f32 v31, v31
    s_nop 0
    v_cndmask_b32_e64 v31, 0, v31, s[36:37]
    v_sub_f32 v32, v32, v64
    v_exp_f32 v32, v32
    s_nop 0
    v_cndmask_b32_e64 v32, 0, v32, s[36:37]
    v_sub_f32 v33, v33, v64
    v_exp_f32 v33, v33
    s_nop 0
    v_cndmask_b32_e64 v33, 0, v33, s[36:37]
    v_sub_f32 v34, v34, v64
    v_exp_f32 v34, v34
    s_nop 0
    v_cndmask_b32_e64 v34, 0, v34, s[36:37]
    v_sub_f32 v35, v35, v64
    v_exp_f32 v35, v35
    s_nop 0
    v_cndmask_b32_e64 v35, 0, v35, s[36:37]
    v_sub_f32 v52, v52, v64
    v_exp_f32 v52, v52
    s_nop 0
    v_cndmask_b32_e64 v52, 0, v52, s[36:37]
    v_sub_f32 v53, v53, v64
    v_exp_f32 v53, v53
    s_nop 0
    v_cndmask_b32_e64 v53, 0, v53, s[36:37]
    v_sub_f32 v54, v54, v64
    v_exp_f32 v54, v54
    s_nop 0
    v_cndmask_b32_e64 v54, 0, v54, s[36:37]
    v_sub_f32 v55, v55, v64
    v_exp_f32 v55, v55
    s_nop 0
    v_cndmask_b32_e64 v55, 0, v55, s[36:37]
    v_cvt_pk_bf16_f32 v28, v28, v29
    v_cvt_pk_bf16_f32 v29, v30, v31
    v_cvt_pk_bf16_f32 v30, v32, v33
    v_cvt_pk_bf16_f32 v31, v34, v35
    v_mov_b32_dpp v32, v28 row_ror:8 row_mask:0xf bank_mask:0xf
    v_mov_b32_dpp v33, v29 row_ror:8 row_mask:0xf bank_mask:0xf
    v_mov_b32_dpp v34, v30 row_ror:8 row_mask:0xf bank_mask:0xf
    v_mov_b32_dpp v35, v31 row_ror:8 row_mask:0xf bank_mask:0xf
    v_cvt_pk_bf16_f32 v52, v52, v53
    v_cvt_pk_bf16_f32 v53, v54, v55
    s_nop 0
    v_mov_b32_dpp v54, v52 row_ror:8 row_mask:0xf bank_mask:0xf
    v_mfma_f32_16x16x32_bf16 v[12:15], v[16:19], v[28:31], 0
    ds_read_b128 v[56:59], v0 offset:8192
    s_waitcnt lgkmcnt(0)
    v_mfma_f32_16x16x32_bf16 v[20:23], v[56:59], v[28:31], 0
    s_nop 3
    ds_read_b128 v[60:63], v0 offset:9216
    s_waitcnt lgkmcnt(0)
    v_mfma_f32_16x16x32_bf16 v[20:23], v[60:63], v[32:35], v[20:23]
    s_nop 3
    ds_read_b128 v[56:59], v0 offset:10240
    s_waitcnt lgkmcnt(0)
    v_mfma_f32_16x16x32_bf16 v[24:27], v[56:59], v[28:31], 0
    s_nop 3
    ds_read_b128 v[60:63], v0 offset:11264
    s_waitcnt lgkmcnt(0)
    v_mfma_f32_16x16x32_bf16 v[24:27], v[60:63], v[32:35], v[24:27]
    s_nop 3
    ds_read_b128 v[56:59], v0 offset:12288
    s_waitcnt lgkmcnt(0)
    v_mfma_f32_16x16x32_bf16 v[72:75], v[56:59], v[28:31], 0
    s_nop 3
    ds_read_b128 v[60:63], v0 offset:13312
    s_waitcnt lgkmcnt(0)
    v_mfma_f32_16x16x32_bf16 v[72:75], v[60:63], v[32:35], v[72:75]
    s_nop 3
    ds_read_b128 v[56:59], v0 offset:14336
    s_waitcnt lgkmcnt(0)
    v_mfma_f32_16x16x32_bf16 v[76:79], v[56:59], v[28:31], 0
    s_nop 3
    ds_read_b128 v[60:63], v0 offset:15360
    s_waitcnt lgkmcnt(0)
    v_mfma_f32_16x16x32_bf16 v[76:79], v[60:63], v[32:35], v[76:79]
    s_nop 3
    s_nop 7
    s_branch main_kernel_c0_2_fin
main_kernel_c0_2_last:
    s_cmp_lg_u32 s70, 0
    s_cbranch_scc1 main_kernel_c0_2_last2
    v_cmp_u_f32 vcc, v32, v32
    s_cbranch_vccnz main_kernel_c0_2_vfy0
main_kernel_c0_2_last2:
    s_waitcnt vmcnt(0) lgkmcnt(0)
    s_nop 7
    v_add_u32 v10, 16384, v0
    v_add_u32 v11, 28928, v3
    v_cndmask_b32_e64 v10, v10, v11, s[42:43]
    ds_read_b128 v[72:75], v10 offset:0
    v_add_u32 v10, 17408, v0
    v_add_u32 v11, 28992, v3
    v_cndmask_b32_e64 v10, v10, v11, s[42:43]
    ds_read_b128 v[76:79], v10 offset:0
    s_lshl_b32 s4, s44, 18
    s_add_u32 s4, s4, s53
    s_waitcnt lgkmcnt(1)
    buffer_store_dwordx4 v[72:75], v0, s[8:11], s4 offen offset:0 sc1
    s_waitcnt lgkmcnt(0)
    buffer_store_dwordx4 v[76:79], v0, s[8:11], s4 offen offset:1024 sc1
    s_mov_b32 s4, 0x10000000
    s_waitcnt vmcnt(0)
    s_barrier
    s_add_u32 s44, s44, 1
    s_cmp_eq_u32 s44, 128
    s_cbranch_scc1 main_kernel_end
    s_branch main_kernel_c0_2_layer
main_kernel_c0_2_lr:
    s_mov_b32 s30, 0
main_kernel_c0_2_lr_l:
    s_waitcnt lgkmcnt(0)
    s_and_b32 s27, s30, 1
    s_cbranch_scc0 main_kernel_c0_2_lr_n
    s_waitcnt vmcnt(3)
    s_mov_b32 m0, 21504
    s_nop 0
    buffer_load_dwordx4 v0, s[8:11], s48 offen offset:0 sc1 lds
    buffer_load_dwordx4 v0, s[8:11], s48 offen offset:1024 sc1 lds
    buffer_load_dwordx4 v0, s[8:11], s48 offen offset:2048 sc1 lds
main_kernel_c0_2_lr_n:
    ds_read_b128 v[36:39], v6 offset:21504
    ds_read_b128 v[40:43], v6 offset:22528
    ds_read_b128 v[44:47], v6 offset:23552
    ds_read_b128 v[48:51], v6 offset:24576
    ds_read_b128 v[52:55], v6 offset:25600
    s_waitcnt lgkmcnt(2)
    v_max3_u32 v10, v36, v40, v44
    s_waitcnt lgkmcnt(0)
    v_max3_u32 v10, v10, v48, v52
    v_cmp_eq_u32 vcc, -1, v10
    s_cbranch_vccz main_kernel_c0_2_lr_d
    s_add_u32 s30, s30, 1
    s_cmp_ge_u32 s30, 480000
    s_cbranch_scc1 main_kernel_fail
    s_branch main_kernel_c0_2_lr_l
main_kernel_c0_2_lr_d:
    ds_read_b128 v[56:59], v5 offset:0
    ds_read_b128 v[60:63], v5 offset:1024
    ds_read_b128 v[64:67], v5 offset:2048
    ds_read_b128 v[68:71], v5 offset:3072
    v_mov_b64 v[12:13], 0
    v_mov_b64 v[14:15], 0
    v_mov_b64 v[16:17], 0
    v_mov_b64 v[18:19], 0
    v_mov_b64 v[20:21], 0
    v_mov_b64 v[22:23], 0
    v_mov_b64 v[24:25], 0
    v_mov_b64 v[26:27], 0
    v_mov_b64 v[28:29], 0
    v_mov_b64 v[30:31], 0
    v_mov_b64 v[32:33], 0
    v_mov_b64 v[34:35], 0
    s_waitcnt lgkmcnt(0)
    s_branch main_kernel_c0_2_lr_r
main_kernel_c0_2_rr:
    s_mov_b32 s30, 0
main_kernel_c0_2_rr_l:
    s_waitcnt lgkmcnt(0)
    s_and_b32 s27, s30, 1
    s_cbranch_scc1 main_kernel_c0_2_rr_n
    s_waitcnt vmcnt(1)
    s_mov_b32 m0, 16384
    s_nop 0
    buffer_load_dwordx4 v0, s[8:11], s49 offen offset:3072 sc1 lds
main_kernel_c0_2_rr_n:
    ds_read_b128 v[36:39], v6 offset:16384
    ds_read_b128 v[40:43], v6 offset:17408
    ds_read_b128 v[44:47], v6 offset:18432
    ds_read_b128 v[48:51], v6 offset:19456
    ds_read_b32 v11, v6 offset:20480
    s_waitcnt lgkmcnt(2)
    v_max3_u32 v10, v36, v40, v44
    s_waitcnt lgkmcnt(0)
    v_max3_u32 v10, v10, v48, v11
    v_cmp_eq_u32 vcc, -1, v10
    s_cbranch_vccz main_kernel_c0_2_rr_d
    s_add_u32 s30, s30, 1
    s_cmp_ge_u32 s30, 480000
    s_cbranch_scc1 main_kernel_fail
    s_branch main_kernel_c0_2_rr_l
main_kernel_c0_2_rr_d:
    s_branch main_kernel_c0_2_rr_r
main_kernel_c0_3_layer:
    s_lshr_b32 s27, s44, 6
    s_mul_i32 s50, s27, 33554432
    s_lshl_b32 s27, s22, 13
    s_add_u32 s50, s50, s27
    s_add_u32 s50, s50, 37748736
    s_barrier
    s_and_b32 s26, s44, 63
    s_lshl_b32 s26, s26, 18
    s_add_u32 s26, s26, s50
    s_mul_i32 s27, s20, 5120
    s_add_u32 s48, s27, 167772160
    s_sub_u32 s49, 167777280, s27
    s_mov_b32 m0, 21504
    s_nop 0
    buffer_load_dwordx4 v0, s[8:11], s48 offen offset:3072 sc1 lds
    s_mov_b32 m0, 25600
    s_add_u32 s59, s48, 4096
    buffer_load_dwordx4 v0, s[8:11], s59 offen offset:0 sc1 lds
    ds_read_b128 v[56:59], v5 offset:0
    ds_read_b128 v[60:63], v5 offset:1024
    ds_read_b128 v[64:67], v5 offset:2048
    ds_read_b128 v[68:71], v5 offset:3072
    v_mov_b64 v[12:13], 0
    v_mov_b64 v[14:15], 0
    v_mov_b64 v[16:17], 0
    v_mov_b64 v[18:19], 0
    v_mov_b64 v[20:21], 0
    v_mov_b64 v[22:23], 0
    v_mov_b64 v[24:25], 0
    v_mov_b64 v[26:27], 0
    v_mov_b64 v[28:29], 0
    v_mov_b64 v[30:31], 0
    v_mov_b64 v[32:33], 0
    v_mov_b64 v[34:35], 0
    s_mov_b32 s70, 0
    s_waitcnt vmcnt(0) lgkmcnt(0)
main_kernel_c0_3_top:
    s_barrier
    ds_read_b128 v[36:39], v6 offset:21504
    ds_read_b128 v[40:43], v6 offset:22528
    ds_read_b128 v[44:47], v6 offset:23552
    ds_read_b128 v[48:51], v6 offset:24576
    ds_read_b128 v[52:55], v6 offset:25600
    s_mov_b32 m0, 20480
    s_add_u32 s59, s49, 4096
    buffer_load_dwordx4 v0, s[8:11], s59 offen offset:0 sc1 lds
main_kernel_c0_3_lr_r:
    s_waitcnt lgkmcnt(4)
    v_smfmac_f32_16x16x64_bf16 v[20:23], v[36:39], v[56:63], v1
    ds_read_b128 v[56:59], v5 offset:4096
    v_smfmac_f32_16x16x64_bf16 v[24:27], v[36:39], a[248:255], v1
    ds_read_b128 v[60:63], v5 offset:5120
    v_smfmac_f32_16x16x64_bf16 v[28:31], v[36:39], a[240:247], v1
    v_smfmac_f32_16x16x64_bf16 v[32:35], v[36:39], v[64:71], v1
    ds_read_b128 v[64:67], v5 offset:6144
    v_smfmac_f32_16x16x64_bf16 v[12:15], v[36:39], a[232:239], v1
    ds_read_b128 v[68:71], v5 offset:7168
    s_waitcnt lgkmcnt(6)
    v_max3_u32 v10, v36, v40, v44
    v_smfmac_f32_16x16x64_bf16 v[16:19], v[36:39], a[224:231], v1
    s_waitcnt lgkmcnt(4)
    s_waitcnt lgkmcnt(2)
    v_max3_u32 v10, v10, v48, v52
    v_smfmac_f32_16x16x64_bf16 v[20:23], v[40:43], v[56:63], v1
    ds_read_b128 v[56:59], v5 offset:8192
    v_cmp_eq_u32 vcc, -1, v10
    v_smfmac_f32_16x16x64_bf16 v[24:27], v[40:43], a[216:223], v1
    ds_read_b128 v[60:63], v5 offset:9216
    s_cbranch_vccnz main_kernel_c0_3_lr
    v_smfmac_f32_16x16x64_bf16 v[28:31], v[40:43], a[208:215], v1
    s_and_b32 s55, s44, 3
    s_mul_i32 s55, s55, 167936
    s_waitcnt lgkmcnt(2)
    v_smfmac_f32_16x16x64_bf16 v[32:35], v[40:43], v[64:71], v1
    ds_read_b128 v[64:67], v5 offset:10240
    s_add_u32 s55, s55, s34
    s_add_u32 s56, s55, s35
    v_smfmac_f32_16x16x64_bf16 v[20:23], v[44:47], a[200:207], v1
    ds_read_b128 v[68:71], v5 offset:11264
    s_and_b32 s57, s44, 63
    v_smfmac_f32_16x16x64_bf16 v[24:27], v[44:47], a[192:199], v1
    s_waitcnt lgkmcnt(2)
    v_smfmac_f32_16x16x64_bf16 v[28:31], v[44:47], v[56:63], v1
    ds_read_b128 v[56:59], v5 offset:12288
    v_smfmac_f32_16x16x64_bf16 v[32:35], v[44:47], a[184:191], v1
    ds_read_b128 v[60:63], v5 offset:13312
    v_smfmac_f32_16x16x64_bf16 v[20:23], v[48:51], a[176:183], v1
    s_waitcnt lgkmcnt(2)
    v_smfmac_f32_16x16x64_bf16 v[24:27], v[48:51], v[64:71], v1
    ds_read_b128 v[64:67], v5 offset:14336
    v_smfmac_f32_16x16x64_bf16 v[28:31], v[48:51], a[168:175], v1
    ds_read_b128 v[68:71], v5 offset:15360
    v_smfmac_f32_16x16x64_bf16 v[32:35], v[48:51], a[160:167], v1
    s_add_u32 s27, s26, 16777216
    s_mov_b32 m0, 8192
    s_nop 0
    buffer_load_dwordx4 v0, s[8:11], s27 offen offset:2048 sc1 lds
    buffer_load_dwordx4 v0, s[8:11], s27 offen offset:3072 sc1 lds
    s_mov_b32 m0, 12288
    s_add_u32 s59, s27, 4096
    buffer_load_dwordx4 v0, s[8:11], s59 offen offset:0 sc1 lds
    buffer_load_dwordx4 v0, s[8:11], s59 offen offset:1024 sc1 lds
    buffer_load_dwordx4 v0, s[8:11], s59 offen offset:2048 sc1 lds
    buffer_load_dwordx4 v0, s[8:11], s59 offen offset:3072 sc1 lds
    s_waitcnt vmcnt(6)
    s_barrier
    ds_read_b128 v[36:39], v6 offset:16384
    ds_read_b128 v[40:43], v6 offset:17408
    ds_read_b128 v[44:47], v6 offset:18432
    ds_read_b128 v[48:51], v6 offset:19456
    ds_read_b32 v11, v6 offset:20480
    s_waitcnt lgkmcnt(7)
    v_smfmac_f32_16x16x64_bf16 v[20:23], v[52:55], v[56:63], v1
    ds_read_b128 v[56:59], v5 offset:16384
    v_smfmac_f32_16x16x64_bf16 v[24:27], v[52:55], a[152:159], v1
    ds_read_b128 v[60:63], v5 offset:17408
    v_smfmac_f32_16x16x64_bf16 v[28:31], v[52:55], a[144:151], v1
    s_waitcnt lgkmcnt(4)
    v_max3_u32 v10, v36, v40, v44
    v_smfmac_f32_16x16x64_bf16 v[32:35], v[52:55], v[64:71], v1
    s_waitcnt lgkmcnt(2)
    v_max3_u32 v10, v10, v48, v11
    v_cmp_eq_u32 vcc, -1, v10
    s_cbranch_vccnz main_kernel_c0_3_rr
main_kernel_c0_3_rr_r:
    ds_read_b128 v[52:55], v6 offset:20480
    v_smfmac_f32_16x16x64_bf16 v[20:23], v[36:39], a[136:143], v1
    ds_read_b128 v[64:67], v5 offset:18432
    v_smfmac_f32_16x16x64_bf16 v[24:27], v[36:39], a[128:135], v1
    ds_read_b128 v[68:71], v5 offset:19456
    s_waitcnt lgkmcnt(3)
    v_smfmac_f32_16x16x64_bf16 v[20:23], v[40:43], v[56:63], v1
    ds_read_b128 v[56:59], v5 offset:20480
    v_smfmac_f32_16x16x64_bf16 v[24:27], v[40:43], a[120:127], v1
    ds_read_b128 v[60:63], v5 offset:21504
    buffer_store_dwordx4 v[72:75], v0, s[8:11], s4 offen offset:2048 sc1
    buffer_store_dwordx4 v[76:79], v0, s[8:11], s4 offen offset:3072 sc1
    s_mov_b32 s4, 0x10000000
    v_smfmac_f32_16x16x64_bf16 v[20:23], v[44:47], a[112:119], v1
    s_waitcnt lgkmcnt(2)
    v_smfmac_f32_16x16x64_bf16 v[24:27], v[44:47], v[64:71], v1
    ds_read_b128 v[64:67], v5 offset:22528
    v_smfmac_f32_16x16x64_bf16 v[20:23], v[48:51], a[104:111], v1
    ds_read_b128 v[68:71], v5 offset:23552
    v_smfmac_f32_16x16x64_bf16 v[24:27], v[48:51], a[96:103], v1
    s_waitcnt lgkmcnt(2)
    v_smfmac_f32_16x16x64_bf16 v[20:23], v[52:55], v[56:63], v1
    ds_read_b128 v[56:59], v5 offset:24576
    v_smfmac_f32_16x16x64_bf16 v[24:27], v[52:55], a[88:95], v1
    ds_read_b128 v[60:63], v5 offset:25600
    v_smfmac_f32_16x16x64_bf16 v[28:31], v[36:39], a[80:87], v1
    s_waitcnt lgkmcnt(2)
    v_smfmac_f32_16x16x64_bf16 v[32:35], v[36:39], v[64:71], v1
    ds_read_b128 v[64:67], v5 offset:26624
    s_nop 0
    v_permlane32_swap_b32 v20, v21
    v_smfmac_f32_16x16x64_bf16 v[28:31], v[40:43], a[72:79], v1
    ds_read_b128 v[68:71], v5 offset:27648
    v_permlane32_swap_b32 v22, v23
    v_smfmac_f32_16x16x64_bf16 v[32:35], v[40:43], a[64:71], v1
    s_waitcnt lgkmcnt(2)
    v_permlane32_swap_b32 v24, v25
    v_smfmac_f32_16x16x64_bf16 v[28:31], v[44:47], v[56:63], v1
    ds_read_b128 v[56:59], v5 offset:28672
    v_permlane32_swap_b32 v26, v27
    v_smfmac_f32_16x16x64_bf16 v[32:35], v[44:47], a[56:63], v1
    ds_read_b128 v[60:63], v5 offset:29696
    v_add_f32 v20, v20, v21
    v_add_f32 v22, v22, v23
    v_smfmac_f32_16x16x64_bf16 v[28:31], v[48:51], a[48:55], v1
    s_waitcnt lgkmcnt(2)
    v_add_f32 v24, v24, v25
    v_add_f32 v26, v26, v27
    v_smfmac_f32_16x16x64_bf16 v[32:35], v[48:51], v[64:71], v1
    ds_read_b128 v[64:67], v5 offset:30720
    v_mul_f32 v20, s40, v20
    v_mul_f32 v24, s40, v24
    v_smfmac_f32_16x16x64_bf16 v[28:31], v[52:55], a[40:47], v1
    ds_read_b128 v[68:71], v5 offset:31744
    v_mul_f32 v22, s40, v22
    v_mul_f32 v26, s40, v26
    v_smfmac_f32_16x16x64_bf16 v[32:35], v[52:55], a[32:39], v1
    s_waitcnt lgkmcnt(2)
    v_cvt_pk_bf16_f32 v20, v20, v24
    v_cvt_pk_bf16_f32 v21, v22, v26
    v_smfmac_f32_16x16x64_bf16 v[12:15], v[36:39], v[56:63], v1
    ds_write_b32 v2, v20 offset:26624
    ds_write_b32 v2, v21 offset:27200
    v_smfmac_f32_16x16x64_bf16 v[16:19], v[36:39], a[24:31], v1
    v_permlane32_swap_b32 v28, v29
    v_smfmac_f32_16x16x64_bf16 v[12:15], v[40:43], a[16:23], v1
    s_waitcnt lgkmcnt(2)
    v_permlane32_swap_b32 v30, v31
    v_smfmac_f32_16x16x64_bf16 v[16:19], v[40:43], v[64:71], v1
    ds_read_b128 v[40:43], v6 offset:22528
    v_permlane32_swap_b32 v32, v33
    v_smfmac_f32_16x16x64_bf16 v[12:15], v[44:47], a[8:15], v1
    v_permlane32_swap_b32 v34, v35
    v_smfmac_f32_16x16x64_bf16 v[16:19], v[44:47], a[0:7], v1
    ds_read_b128 v[44:47], v6 offset:23552
    v_add_f32 v28, v28, v29
    v_add_f32 v30, v30, v31
    v_smfmac_f32_16x16x64_bf16 v[12:15], v[48:51], v[248:255], v1
    v_add_f32 v32, v32, v33
    v_add_f32 v34, v34, v35
    v_smfmac_f32_16x16x64_bf16 v[16:19], v[48:51], v[240:247], v1
    ds_read_b128 v[48:51], v6 offset:24576
    v_cvt_pk_bf16_f32 v28, v28, v32
    v_cvt_pk_bf16_f32 v29, v30, v34
    v_smfmac_f32_16x16x64_bf16 v[12:15], v[52:55], v[232:239], v1
    ds_write_b32 v2, v28 offset:28928
    ds_write_b32 v2, v29 offset:29504
    v_smfmac_f32_16x16x64_bf16 v[16:19], v[52:55], v[224:231], v1
    ds_read_b128 v[52:55], v6 offset:25600
    s_waitcnt lgkmcnt(5)
    v_smfmac_f32_16x16x64_bf16 v[12:15], v[40:43], v[216:223], v1
    v_smfmac_f32_16x16x64_bf16 v[16:19], v[40:43], v[208:215], v1
    s_waitcnt vmcnt(2) lgkmcnt(1)
    s_barrier
    ds_read_b128 v[56:59], v0 offset:0
    ds_read_b128 v[20:23], v4 offset:26624
    v_smfmac_f32_16x16x64_bf16 v[12:15], v[44:47], v[200:207], v1
    ds_read_b128 v[60:63], v0 offset:1024
    ds_read_b128 v[24:27], v4 offset:26688
    v_smfmac_f32_16x16x64_bf16 v[16:19], v[44:47], v[192:199], v1
    ds_read_b128 v[64:67], v0 offset:2048
    ds_read_b128 v[72:75], v4 offset:26752
    v_smfmac_f32_16x16x64_bf16 v[12:15], v[48:51], v[184:191], v1
    ds_read_b128 v[68:71], v0 offset:3072
    ds_read_b128 v[76:79], v4 offset:26816
    v_smfmac_f32_16x16x64_bf16 v[16:19], v[48:51], v[176:183], v1
    ds_read_b128 v[36:39], v0 offset:4096
    ds_read_b128 v[40:43], v0 offset:5120
    s_waitcnt lgkmcnt(10)
    v_smfmac_f32_16x16x64_bf16 v[12:15], v[52:55], v[168:175], v1
    ds_read_b128 v[44:47], v0 offset:6144
    ds_read_b128 v[48:51], v0 offset:7168
    v_smfmac_f32_16x16x64_bf16 v[16:19], v[52:55], v[160:167], v1
    s_waitcnt lgkmcnt(10)
    v_mfma_f32_16x16x32_bf16 v[28:31], v[56:59], v[20:23], 0
    s_waitcnt lgkmcnt(8)
    v_mfma_f32_16x16x32_bf16 v[28:31], v[60:63], v[24:27], v[28:31]
    s_nop 0
    s_waitcnt lgkmcnt(6)
    v_cvt_pk_bf16_f32 v12, v12, v13
    v_cvt_pk_bf16_f32 v13, v14, v15
    v_mfma_f32_16x16x32_bf16 v[28:31], v[64:67], v[72:75], v[28:31]
    s_waitcnt lgkmcnt(4)
    v_cvt_pk_bf16_f32 v14, v16, v17
    v_cvt_pk_bf16_f32 v15, v18, v19
    v_mfma_f32_16x16x32_bf16 v[28:31], v[68:71], v[76:79], v[28:31]
    ds_write_b128 v0, v[12:15] offset:19456
    s_waitcnt lgkmcnt(4)
    v_mfma_f32_16x16x32_bf16 v[32:35], v[36:39], v[20:23], 0
    ds_read_b128 v[56:59], v3 offset:28928
    ds_read_b128 v[60:63], v3 offset:28992
    s_waitcnt lgkmcnt(5)
    v_mfma_f32_16x16x32_bf16 v[32:35], v[40:43], v[24:27], v[32:35]
    ds_read_b128 v[64:67], v3 offset:29056
    ds_read_b128 v[68:71], v3 offset:29120
    s_waitcnt lgkmcnt(6)
    v_mfma_f32_16x16x32_bf16 v[32:35], v[44:47], v[72:75], v[32:35]
    s_mov_b64 exec, s[36:37]
    v_exp_f32 v28, v28
    v_exp_f32 v29, v29
    s_mov_b64 exec, -1
    s_waitcnt lgkmcnt(5)
    v_mfma_f32_16x16x32_bf16 v[32:35], v[48:51], v[76:79], v[32:35]
    s_mov_b64 exec, s[36:37]
    v_exp_f32 v30, v30
    v_exp_f32 v31, v31
    s_mov_b64 exec, -1
    s_waitcnt lgkmcnt(4)
    s_barrier
    s_waitcnt lgkmcnt(3)
    v_mfma_f32_16x16x32_bf16 v[52:55], v[56:59], v[20:23], 0
    ds_read_b128 v[36:39], v0 offset:8192
    s_waitcnt lgkmcnt(3)
    v_cvt_pk_bf16_f32 v28, v28, v29
    v_cvt_pk_bf16_f32 v29, v30, v31
    v_mfma_f32_16x16x32_bf16 v[52:55], v[60:63], v[24:27], v[52:55]
    ds_read_b128 v[40:43], v0 offset:10240
    s_mov_b64 exec, s[36:37]
    v_exp_f32 v32, v32
    v_exp_f32 v33, v33
    s_mov_b64 exec, -1
    s_waitcnt lgkmcnt(3)
    v_mfma_f32_16x16x32_bf16 v[52:55], v[64:67], v[72:75], v[52:55]
    ds_read_b128 v[44:47], v0 offset:12288
    s_mov_b64 exec, s[36:37]
    v_exp_f32 v34, v34
    v_exp_f32 v35, v35
    s_mov_b64 exec, -1
    s_waitcnt lgkmcnt(3)
    v_mfma_f32_16x16x32_bf16 v[52:55], v[68:71], v[76:79], v[52:55]
    ds_read_b128 v[48:51], v0 offset:14336
    v_cvt_pk_bf16_f32 v30, v32, v33
    v_cvt_pk_bf16_f32 v31, v34, v35
    s_cmp_eq_u32 s57, 63
    s_cbranch_scc1 main_kernel_c0_3_last
    s_waitcnt lgkmcnt(3)
    v_mfma_f32_16x16x32_bf16 v[20:23], v[36:39], v[28:31], 0
    ds_read_b128 v[56:59], v0 offset:9216
    s_waitcnt lgkmcnt(3)
    v_mov_b32_dpp v32, v28 row_ror:8 row_mask:0xf bank_mask:0xf
    v_mov_b32_dpp v33, v29 row_ror:8 row_mask:0xf bank_mask:0xf
    v_mfma_f32_16x16x32_bf16 v[24:27], v[40:43], v[28:31], 0
    ds_read_b128 v[60:63], v0 offset:11264
    s_waitcnt lgkmcnt(3)
    v_mov_b32_dpp v34, v30 row_ror:8 row_mask:0xf bank_mask:0xf
    v_mov_b32_dpp v35, v31 row_ror:8 row_mask:0xf bank_mask:0xf
    v_mfma_f32_16x16x32_bf16 v[72:75], v[44:47], v[28:31], 0
    ds_read_b128 v[64:67], v0 offset:13312
    s_waitcnt lgkmcnt(3)
    v_mov_b64 v[16:17], s[24:25]
    v_mov_b64 v[18:19], s[24:25]
    v_mfma_f32_16x16x32_bf16 v[76:79], v[48:51], v[28:31], 0
    ds_read_b128 v[68:71], v0 offset:15360
    s_mov_b64 exec, s[36:37]
    v_exp_f32 v52, v52
    s_mov_b64 exec, -1
    v_mfma_f32_16x16x32_bf16 v[12:15], v[16:19], v[28:31], 0
    ds_read_b128 v[36:39], v0 offset:16384
    s_mov_b64 exec, s[36:37]
    v_exp_f32 v53, v53
    s_mov_b64 exec, -1
    s_waitcnt lgkmcnt(4)
    v_mfma_f32_16x16x32_bf16 v[20:23], v[56:59], v[32:35], v[20:23]
    ds_read_b128 v[40:43], v0 offset:17408
    s_mov_b64 exec, s[36:37]
    v_exp_f32 v54, v54
    s_mov_b64 exec, -1
    s_waitcnt lgkmcnt(4)
    v_mfma_f32_16x16x32_bf16 v[24:27], v[60:63], v[32:35], v[24:27]
    ds_read_b128 v[44:47], v0 offset:18432
    s_mov_b64 exec, s[36:37]
    v_exp_f32 v55, v55
    s_mov_b64 exec, -1
    s_waitcnt lgkmcnt(4)
    v_mfma_f32_16x16x32_bf16 v[72:75], v[64:67], v[32:35], v[72:75]
    ds_read_b128 v[48:51], v0 offset:19456
    s_waitcnt lgkmcnt(4)
    v_cvt_pk_bf16_f32 v52, v52, v53
    v_cvt_pk_bf16_f32 v53, v54, v55
    v_mfma_f32_16x16x32_bf16 v[76:79], v[68:71], v[32:35], v[76:79]
    v_mov_b64 v[10:11], s[16:17]
    v_mov_b32_dpp v54, v52 row_ror:8 row_mask:0xf bank_mask:0xf
main_kernel_c0_3_fin:
    s_waitcnt lgkmcnt(3)
    v_mfma_f32_16x16x16_bf16 v[20:23], v[36:37], v[52:53], v[20:23]
    v_mov_b32_dpp v55, v53 row_ror:8 row_mask:0xf bank_mask:0xf
    v_mov_b64 v[56:57], 0
    v_mfma_f32_16x16x16_bf16 v[12:15], v[10:11], v[52:53], v[12:15]
    s_waitcnt lgkmcnt(2)
    v_mov_b64 v[58:59], 0
    v_mov_b64 v[60:61], 0
    v_mfma_f32_16x16x16_bf16 v[24:27], v[40:41], v[52:53], v[24:27]
    v_mov_b64 v[62:63], 0
    v_mov_b64 v[64:65], 0
    v_mfma_f32_16x16x16_bf16 v[20:23], v[38:39], v[54:55], v[20:23]
    v_mov_b64 v[66:67], 0
    v_mov_b64 v[68:69], 0
    v_mfma_f32_16x16x16_bf16 v[24:27], v[42:43], v[54:55], v[24:27]
    s_waitcnt lgkmcnt(1)
    v_add_f32_dpp v12, v12, v12 row_ror:8 row_mask:0xf bank_mask:0xf
    v_mov_b64 v[70:71], 0
    v_mfma_f32_16x16x16_bf16 v[72:75], v[44:45], v[52:53], v[72:75]
    s_waitcnt lgkmcnt(0)
    v_rcp_f32 v14, v12
    v_mfma_f32_16x16x16_bf16 v[76:79], v[48:49], v[52:53], v[76:79]
    v_subrev_u32 v13, s68, v12
    v_cmp_lt_u32 vcc, s69, v13
    v_mfma_f32_16x16x16_bf16 v[72:75], v[46:47], v[54:55], v[72:75]
    s_cbranch_vccnz main_kernel_c0_3_zbad
main_kernel_c0_3_zok:
    v_mov_b64 v[28:29], 0
    v_mov_b64 v[30:31], 0
    v_mfma_f32_16x16x16_bf16 v[76:79], v[50:51], v[54:55], v[76:79]
    v_mul_f32 v20, v20, v14
    v_mul_f32 v21, v21, v14
    v_mul_f32 v22, v22, v14
    v_mul_f32 v23, v23, v14
    v_mul_f32 v24, v24, v14
    v_mul_f32 v25, v25, v14
    v_mul_f32 v26, v26, v14
    v_mul_f32 v27, v27, v14
    v_cvt_pk_bf16_f32 v20, v20, v21
    v_cvt_pk_bf16_f32 v21, v22, v23
    v_cvt_pk_bf16_f32 v22, v24, v25
    v_cvt_pk_bf16_f32 v23, v26, v27
    v_mul_f32 v72, v72, v14
    v_mul_f32 v73, v73, v14
    v_smfmac_f32_16x16x64_bf16 v[56:59], v[20:23], v[152:159], v1
    v_mul_f32 v74, v74, v14
    v_mul_f32 v75, v75, v14
    v_mul_f32 v76, v76, v14
    v_smfmac_f32_16x16x64_bf16 v[60:63], v[20:23], v[136:143], v1
    v_mul_f32 v77, v77, v14
    v_mul_f32 v78, v78, v14
    v_mul_f32 v79, v79, v14
    v_smfmac_f32_16x16x64_bf16 v[64:67], v[20:23], v[120:127], v1
    v_cvt_pk_bf16_f32 v72, v72, v73
    v_cvt_pk_bf16_f32 v73, v74, v75
    v_cvt_pk_bf16_f32 v74, v76, v77
    v_smfmac_f32_16x16x64_bf16 v[68:71], v[20:23], v[104:111], v1
    v_cvt_pk_bf16_f32 v75, v78, v79
    v_smfmac_f32_16x16x64_bf16 v[28:31], v[20:23], v[88:95], v1
    s_nop 0
    v_smfmac_f32_16x16x64_bf16 v[56:59], v[72:75], v[144:151], v1
    v_smfmac_f32_16x16x64_bf16 v[60:63], v[72:75], v[128:135], v1
    v_smfmac_f32_16x16x64_bf16 v[64:67], v[72:75], v[112:119], v1
    v_mov_b32 v5, v5
    v_mov_b32 v5, v5
    v_permlane32_swap_b32 v56, v57
    v_smfmac_f32_16x16x64_bf16 v[68:71], v[72:75], v[96:103], v1
    v_permlane32_swap_b32 v58, v59
    v_smfmac_f32_16x16x64_bf16 v[28:31], v[72:75], v[80:87], v1
    v_add_f32 v56, v56, v57
    v_add_f32 v58, v58, v59
    v_permlane32_swap_b32 v60, v61
    v_permlane32_swap_b32 v62, v63
    v_add_f32 v60, v60, v61
    v_add_f32 v62, v62, v63
    v_cvt_pk_bf16_f32 v36, v56, v60
    v_cvt_pk_bf16_f32 v38, v58, v62
    v_permlane32_swap_b32 v64, v65
    v_permlane32_swap_b32 v66, v67
    v_add_f32 v64, v64, v65
    v_add_f32 v66, v66, v67
    v_permlane32_swap_b32 v68, v69
    v_permlane32_swap_b32 v70, v71
    v_add_f32 v68, v68, v69
    v_add_f32 v70, v70, v71
    v_cvt_pk_bf16_f32 v37, v64, v68
    v_cvt_pk_bf16_f32 v39, v66, v70
    buffer_store_dwordx4 v[36:39], v0, s[8:11], s56 offen
    v_permlane32_swap_b32 v28, v29
    v_permlane32_swap_b32 v30, v31
    v_add_f32 v28, v28, v29
    v_add_f32 v30, v30, v31
    v_cvt_pk_bf16_f32 v28, v28, v30
    buffer_store_dword v28, v7, s[8:11], s55 offen
    s_add_u32 s27, s44, 1
    s_and_b32 s27, s27, 3
    s_mul_i32 s48, s27, 5120
    s_add_u32 s48, s48, s41
    s_lshl_b32 s27, s27, 15
    s_add_u32 s49, s27, s47
    v_add_u32 v10, 18432, v0
    v_add_u32 v11, 29056, v3
    v_cndmask_b32_e64 v10, v10, v11, s[42:43]
    ds_read_b128 v[72:75], v10 offset:0
    v_add_u32 v10, 19456, v0
    v_add_u32 v11, 29120, v3
    v_cndmask_b32_e64 v10, v10, v11, s[42:43]
    ds_read_b128 v[76:79], v10 offset:0
    s_lshl_b32 s4, s44, 18
    s_add_u32 s4, s4, s53
    ds_read_b128 v[56:59], v5 offset:0
    ds_read_b128 v[60:63], v5 offset:1024
    ds_read_b128 v[64:67], v5 offset:2048
    ds_read_b128 v[68:71], v5 offset:3072
    v_mov_b64 v[12:13], 0
    v_mov_b64 v[14:15], 0
    v_mov_b64 v[16:17], 0
    v_mov_b64 v[18:19], 0
    v_mov_b64 v[20:21], 0
    v_mov_b64 v[22:23], 0
    v_mov_b64 v[24:25], 0
    v_mov_b64 v[26:27], 0
    v_mov_b64 v[28:29], 0
    v_mov_b64 v[30:31], 0
    v_mov_b64 v[32:33], 0
    v_mov_b64 v[34:35], 0
    s_barrier
    s_and_b32 s26, s44, 63
    s_add_u32 s26, s26, 1
    s_min_u32 s26, s26, 63
    s_lshl_b32 s26, s26, 18
    s_add_u32 s26, s26, s50
    s_nop 15
    s_nop 15
    s_nop 14
    s_mov_b32 m0, 21504
    s_nop 0
    buffer_load_dwordx4 v0, s[8:11], s48 offen offset:3072 sc1 lds
    s_mov_b32 m0, 25600
    s_add_u32 s59, s48, 4096
    buffer_load_dwordx4 v0, s[8:11], s59 offen offset:0 sc1 lds
    s_add_u32 s44, s44, 1
    s_mov_b32 s70, 0
    s_waitcnt vmcnt(0) lgkmcnt(0)
    s_branch main_kernel_c0_3_top
main_kernel_c0_3_restart:
    s_waitcnt vmcnt(0) lgkmcnt(0)
    s_nop 7
    s_barrier
    s_mov_b32 m0, 21504
    s_nop 0
    buffer_load_dwordx4 v0, s[8:11], s48 offen offset:3072 sc1 lds
    s_mov_b32 m0, 25600
    s_add_u32 s59, s48, 4096
    buffer_load_dwordx4 v0, s[8:11], s59 offen offset:0 sc1 lds
    ds_read_b128 v[56:59], v5 offset:0
    ds_read_b128 v[60:63], v5 offset:1024
    ds_read_b128 v[64:67], v5 offset:2048
    ds_read_b128 v[68:71], v5 offset:3072
    v_mov_b64 v[12:13], 0
    v_mov_b64 v[14:15], 0
    v_mov_b64 v[16:17], 0
    v_mov_b64 v[18:19], 0
    v_mov_b64 v[20:21], 0
    v_mov_b64 v[22:23], 0
    v_mov_b64 v[24:25], 0
    v_mov_b64 v[26:27], 0
    v_mov_b64 v[28:29], 0
    v_mov_b64 v[30:31], 0
    v_mov_b64 v[32:33], 0
    v_mov_b64 v[34:35], 0
    s_waitcnt vmcnt(0) lgkmcnt(0)
    s_branch main_kernel_c0_3_top
main_kernel_c0_3_zbad:
    s_cmp_eq_u32 s70, 2
    s_cbranch_scc1 main_kernel_c0_3_zok
    v_cmp_u_f32 vcc, v12, v12
    s_cbranch_vccz main_kernel_c0_3_exact
    s_cmp_eq_u32 s70, 1
    s_cbranch_scc1 main_kernel_c0_3_exact
main_kernel_c0_3_vfy0:
    s_mov_b32 s70, 1
    s_mov_b32 s30, 0
    s_waitcnt vmcnt(0) lgkmcnt(0)
    s_nop 7
main_kernel_c0_3_vfy:
    v_mov_b32 v10, 0
    s_add_u32 s59, s48, 4096
    buffer_load_dwordx4 v[36:39], v0, s[8:11], s48 offen offset:0 sc1
    buffer_load_dwordx4 v[40:43], v0, s[8:11], s48 offen offset:1024 sc1
    buffer_load_dwordx4 v[44:47], v0, s[8:11], s48 offen offset:2048 sc1
    buffer_load_dwordx4 v[48:51], v0, s[8:11], s48 offen offset:3072 sc1
    buffer_load_dwordx4 v[52:55], v0, s[8:11], s59 offen offset:0 sc1
    s_waitcnt vmcnt(4)
    v_max3_u32 v10, v10, v36, v37
    v_max3_u32 v10, v10, v38, v39
    s_waitcnt vmcnt(3)
    v_max3_u32 v10, v10, v40, v41
    v_max3_u32 v10, v10, v42, v43
    s_waitcnt vmcnt(2)
    v_max3_u32 v10, v10, v44, v45
    v_max3_u32 v10, v10, v46, v47
    s_waitcnt vmcnt(1)
    v_max3_u32 v10, v10, v48, v49
    v_max3_u32 v10, v10, v50, v51
    s_waitcnt vmcnt(0)
    v_max3_u32 v10, v10, v52, v53
    v_max3_u32 v10, v10, v54, v55
    s_add_u32 s59, s49, 4096
    buffer_load_dwordx4 v[36:39], v0, s[8:11], s49 offen offset:0 sc1
    buffer_load_dwordx4 v[40:43], v0, s[8:11], s49 offen offset:1024 sc1
    buffer_load_dwordx4 v[44:47], v0, s[8:11], s49 offen offset:2048 sc1
    buffer_load_dwordx4 v[48:51], v0, s[8:11], s49 offen offset:3072 sc1
    buffer_load_dwordx4 v[52:55], v0, s[8:11], s59 offen offset:0 sc1
    s_waitcnt vmcnt(4)
    v_max3_u32 v10, v10, v36, v37
    v_max3_u32 v10, v10, v38, v39
    s_waitcnt vmcnt(3)
    v_max3_u32 v10, v10, v40, v41
    v_max3_u32 v10, v10, v42, v43
    s_waitcnt vmcnt(2)
    v_max3_u32 v10, v10, v44, v45
    v_max3_u32 v10, v10, v46, v47
    s_waitcnt vmcnt(1)
    v_max3_u32 v10, v10, v48, v49
    v_max3_u32 v10, v10, v50, v51
    s_waitcnt vmcnt(0)
    v_max3_u32 v10, v10, v52, v53
    v_max3_u32 v10, v10, v54, v55
    v_cmp_eq_u32 vcc, -1, v10
    s_cbranch_vccz main_kernel_c0_3_restart
    s_add_u32 s30, s30, 1
    s_cmp_ge_u32 s30, 60000
    s_cbranch_scc1 main_kernel_fail
    s_branch main_kernel_c0_3_vfy
main_kernel_c0_3_exact:
    s_nop 7
    s_mov_b32 s70, 2
    ds_read_b128 v[20:23], v3 offset:26624
    ds_read_b128 v[24:27], v3 offset:26688
    ds_read_b128 v[72:75], v3 offset:26752
    ds_read_b128 v[76:79], v3 offset:26816
    ds_read_b128 v[56:59], v0 offset:0
    s_waitcnt lgkmcnt(0)
    v_mfma_f32_16x16x32_bf16 v[28:31], v[56:59], v[20:23], 0
    s_nop 3
    ds_read_b128 v[60:63], v0 offset:1024
    s_waitcnt lgkmcnt(0)
    v_mfma_f32_16x16x32_bf16 v[28:31], v[60:63], v[24:27], v[28:31]
    s_nop 3
    ds_read_b128 v[56:59], v0 offset:2048
    s_waitcnt lgkmcnt(0)
    v_mfma_f32_16x16x32_bf16 v[28:31], v[56:59], v[72:75], v[28:31]
    s_nop 3
    ds_read_b128 v[60:63], v0 offset:3072
    s_waitcnt lgkmcnt(0)
    v_mfma_f32_16x16x32_bf16 v[28:31], v[60:63], v[76:79], v[28:31]
    s_nop 3
    ds_read_b128 v[56:59], v0 offset:4096
    s_waitcnt lgkmcnt(0)
    v_mfma_f32_16x16x32_bf16 v[32:35], v[56:59], v[20:23], 0
    s_nop 3
    ds_read_b128 v[60:63], v0 offset:5120
    s_waitcnt lgkmcnt(0)
    v_mfma_f32_16x16x32_bf16 v[32:35], v[60:63], v[24:27], v[32:35]
    s_nop 3
    ds_read_b128 v[56:59], v0 offset:6144
    s_waitcnt lgkmcnt(0)
    v_mfma_f32_16x16x32_bf16 v[32:35], v[56:59], v[72:75], v[32:35]
    s_nop 3
    ds_read_b128 v[60:63], v0 offset:7168
    s_waitcnt lgkmcnt(0)
    v_mfma_f32_16x16x32_bf16 v[32:35], v[60:63], v[76:79], v[32:35]
    s_nop 3
    ds_read_b128 v[56:59], v3 offset:28928
    s_waitcnt lgkmcnt(0)
    v_mfma_f32_16x16x32_bf16 v[52:55], v[56:59], v[20:23], 0
    s_nop 3
    ds_read_b128 v[60:63], v3 offset:28992
    s_waitcnt lgkmcnt(0)
    v_mfma_f32_16x16x32_bf16 v[52:55], v[60:63], v[24:27], v[52:55]
    s_nop 3
    ds_read_b128 v[56:59], v3 offset:29056
    s_waitcnt lgkmcnt(0)
    v_mfma_f32_16x16x32_bf16 v[52:55], v[56:59], v[72:75], v[52:55]
    s_nop 3
    ds_read_b128 v[60:63], v3 offset:29120
    s_waitcnt lgkmcnt(0)
    v_mfma_f32_16x16x32_bf16 v[52:55], v[60:63], v[76:79], v[52:55]
    s_nop 3
    v_max3_f32 v64, v28, v29, v30
    v_max3_f32 v64, v64, v31, v32
    v_max3_f32 v64, v64, v33, v34
    s_nop 0
    v_max3_f32 v64, v64, v35, v52
    v_max3_f32 v64, v64, v53, v54
    v_max_f32 v64, v64, v55
    v_mov_b32 v65, v64
    s_nop 1
    v_permlane16_swap_b32 v64, v65
    v_max_f32 v64, v64, v65
    v_mov_b32 v65, v64
    s_nop 1
    v_permlane32_swap_b32 v64, v65
    v_max_f32 v64, v64, v65
    v_sub_f32 v28, v28, v64
    v_exp_f32 v28, v28
    s_nop 0
    v_cndmask_b32_e64 v28, 0, v28, s[36:37]
    v_sub_f32 v29, v29, v64
    v_exp_f32 v29, v29
    s_nop 0
    v_cndmask_b32_e64 v29, 0, v29, s[36:37]
    v_sub_f32 v30, v30, v64
    v_exp_f32 v30, v30
    s_nop 0
    v_cndmask_b32_e64 v30, 0, v30, s[36:37]
    v_sub_f32 v31, v31, v64
    v_exp_f32 v31, v31
    s_nop 0
    v_cndmask_b32_e64 v31, 0, v31, s[36:37]
    v_sub_f32 v32, v32, v64
    v_exp_f32 v32, v32
    s_nop 0
    v_cndmask_b32_e64 v32, 0, v32, s[36:37]
    v_sub_f32 v33, v33, v64
    v_exp_f32 v33, v33
    s_nop 0
    v_cndmask_b32_e64 v33, 0, v33, s[36:37]
    v_sub_f32 v34, v34, v64
    v_exp_f32 v34, v34
    s_nop 0
    v_cndmask_b32_e64 v34, 0, v34, s[36:37]
    v_sub_f32 v35, v35, v64
    v_exp_f32 v35, v35
    s_nop 0
    v_cndmask_b32_e64 v35, 0, v35, s[36:37]
    v_sub_f32 v52, v52, v64
    v_exp_f32 v52, v52
    s_nop 0
    v_cndmask_b32_e64 v52, 0, v52, s[36:37]
    v_sub_f32 v53, v53, v64
    v_exp_f32 v53, v53
    s_nop 0
    v_cndmask_b32_e64 v53, 0, v53, s[36:37]
    v_sub_f32 v54, v54, v64
    v_exp_f32 v54, v54
    s_nop 0
    v_cndmask_b32_e64 v54, 0, v54, s[36:37]
    v_sub_f32 v55, v55, v64
    v_exp_f32 v55, v55
    s_nop 0
    v_cndmask_b32_e64 v55, 0, v55, s[36:37]
    v_cvt_pk_bf16_f32 v28, v28, v29
    v_cvt_pk_bf16_f32 v29, v30, v31
    v_cvt_pk_bf16_f32 v30, v32, v33
    v_cvt_pk_bf16_f32 v31, v34, v35
    v_mov_b32_dpp v32, v28 row_ror:8 row_mask:0xf bank_mask:0xf
    v_mov_b32_dpp v33, v29 row_ror:8 row_mask:0xf bank_mask:0xf
    v_mov_b32_dpp v34, v30 row_ror:8 row_mask:0xf bank_mask:0xf
    v_mov_b32_dpp v35, v31 row_ror:8 row_mask:0xf bank_mask:0xf
    v_cvt_pk_bf16_f32 v52, v52, v53
    v_cvt_pk_bf16_f32 v53, v54, v55
    s_nop 0
    v_mov_b32_dpp v54, v52 row_ror:8 row_mask:0xf bank_mask:0xf
    v_mfma_f32_16x16x32_bf16 v[12:15], v[16:19], v[28:31], 0
    ds_read_b128 v[56:59], v0 offset:8192
    s_waitcnt lgkmcnt(0)
    v_mfma_f32_16x16x32_bf16 v[20:23], v[56:59], v[28:31], 0
    s_nop 3
    ds_read_b128 v[60:63], v0 offset:9216
    s_waitcnt lgkmcnt(0)
    v_mfma_f32_16x16x32_bf16 v[20:23], v[60:63], v[32:35], v[20:23]
    s_nop 3
    ds_read_b128 v[56:59], v0 offset:10240
    s_waitcnt lgkmcnt(0)
    v_mfma_f32_16x16x32_bf16 v[24:27], v[56:59], v[28:31], 0
    s_nop 3
    ds_read_b128 v[60:63], v0 offset:11264
    s_waitcnt lgkmcnt(0)
    v_mfma_f32_16x16x32_bf16 v[24:27], v[60:63], v[32:35], v[24:27]
    s_nop 3
    ds_read_b128 v[56:59], v0 offset:12288
    s_waitcnt lgkmcnt(0)
    v_mfma_f32_16x16x32_bf16 v[72:75], v[56:59], v[28:31], 0
    s_nop 3
    ds_read_b128 v[60:63], v0 offset:13312
    s_waitcnt lgkmcnt(0)
    v_mfma_f32_16x16x32_bf16 v[72:75], v[60:63], v[32:35], v[72:75]
    s_nop 3
    ds_read_b128 v[56:59], v0 offset:14336
    s_waitcnt lgkmcnt(0)
    v_mfma_f32_16x16x32_bf16 v[76:79], v[56:59], v[28:31], 0
    s_nop 3
    ds_read_b128 v[60:63], v0 offset:15360
    s_waitcnt lgkmcnt(0)
    v_mfma_f32_16x16x32_bf16 v[76:79], v[60:63], v[32:35], v[76:79]
    s_nop 3
    s_nop 7
    s_branch main_kernel_c0_3_fin
main_kernel_c0_3_last:
    s_cmp_lg_u32 s70, 0
    s_cbranch_scc1 main_kernel_c0_3_last2
    v_cmp_u_f32 vcc, v32, v32
    s_cbranch_vccnz main_kernel_c0_3_vfy0
main_kernel_c0_3_last2:
    s_waitcnt vmcnt(0) lgkmcnt(0)
    s_nop 7
    v_add_u32 v10, 18432, v0
    v_add_u32 v11, 29056, v3
    v_cndmask_b32_e64 v10, v10, v11, s[42:43]
    ds_read_b128 v[72:75], v10 offset:0
    v_add_u32 v10, 19456, v0
    v_add_u32 v11, 29120, v3
    v_cndmask_b32_e64 v10, v10, v11, s[42:43]
    ds_read_b128 v[76:79], v10 offset:0
    s_lshl_b32 s4, s44, 18
    s_add_u32 s4, s4, s53
    s_waitcnt lgkmcnt(1)
    buffer_store_dwordx4 v[72:75], v0, s[8:11], s4 offen offset:2048 sc1
    s_waitcnt lgkmcnt(0)
    buffer_store_dwordx4 v[76:79], v0, s[8:11], s4 offen offset:3072 sc1
    s_mov_b32 s4, 0x10000000
    s_waitcnt vmcnt(0)
    s_barrier
    s_add_u32 s44, s44, 1
    s_cmp_eq_u32 s44, 128
    s_cbranch_scc1 main_kernel_end
    s_branch main_kernel_c0_3_layer
main_kernel_c0_3_lr:
    s_mov_b32 s30, 0
main_kernel_c0_3_lr_l:
    s_waitcnt lgkmcnt(0)
    s_and_b32 s27, s30, 1
    s_cbranch_scc0 main_kernel_c0_3_lr_n
    s_waitcnt vmcnt(2)
    s_mov_b32 m0, 21504
    s_nop 0
    buffer_load_dwordx4 v0, s[8:11], s48 offen offset:3072 sc1 lds
    s_mov_b32 m0, 25600
    s_add_u32 s59, s48, 4096
    buffer_load_dwordx4 v0, s[8:11], s59 offen offset:0 sc1 lds
main_kernel_c0_3_lr_n:
    ds_read_b128 v[36:39], v6 offset:21504
    ds_read_b128 v[40:43], v6 offset:22528
    ds_read_b128 v[44:47], v6 offset:23552
    ds_read_b128 v[48:51], v6 offset:24576
    ds_read_b128 v[52:55], v6 offset:25600
    s_waitcnt lgkmcnt(2)
    v_max3_u32 v10, v36, v40, v44
    s_waitcnt lgkmcnt(0)
    v_max3_u32 v10, v10, v48, v52
    v_cmp_eq_u32 vcc, -1, v10
    s_cbranch_vccz main_kernel_c0_3_lr_d
    s_add_u32 s30, s30, 1
    s_cmp_ge_u32 s30, 480000
    s_cbranch_scc1 main_kernel_fail
    s_branch main_kernel_c0_3_lr_l
main_kernel_c0_3_lr_d:
    ds_read_b128 v[56:59], v5 offset:0
    ds_read_b128 v[60:63], v5 offset:1024
    ds_read_b128 v[64:67], v5 offset:2048
    ds_read_b128 v[68:71], v5 offset:3072
    v_mov_b64 v[12:13], 0
    v_mov_b64 v[14:15], 0
    v_mov_b64 v[16:17], 0
    v_mov_b64 v[18:19], 0
    v_mov_b64 v[20:21], 0
    v_mov_b64 v[22:23], 0
    v_mov_b64 v[24:25], 0
    v_mov_b64 v[26:27], 0
    v_mov_b64 v[28:29], 0
    v_mov_b64 v[30:31], 0
    v_mov_b64 v[32:33], 0
    v_mov_b64 v[34:35], 0
    s_waitcnt lgkmcnt(0)
    s_branch main_kernel_c0_3_lr_r
main_kernel_c0_3_rr:
    s_mov_b32 s30, 0
main_kernel_c0_3_rr_l:
    s_waitcnt lgkmcnt(0)
    s_and_b32 s27, s30, 1
    s_cbranch_scc1 main_kernel_c0_3_rr_n
    s_waitcnt vmcnt(1)
    s_mov_b32 m0, 20480
    s_add_u32 s59, s49, 4096
    buffer_load_dwordx4 v0, s[8:11], s59 offen offset:0 sc1 lds
main_kernel_c0_3_rr_n:
    ds_read_b128 v[36:39], v6 offset:16384
    ds_read_b128 v[40:43], v6 offset:17408
    ds_read_b128 v[44:47], v6 offset:18432
    ds_read_b128 v[48:51], v6 offset:19456
    ds_read_b32 v11, v6 offset:20480
    s_waitcnt lgkmcnt(2)
    v_max3_u32 v10, v36, v40, v44
    s_waitcnt lgkmcnt(0)
    v_max3_u32 v10, v10, v48, v11
    v_cmp_eq_u32 vcc, -1, v10
    s_cbranch_vccz main_kernel_c0_3_rr_d
    s_add_u32 s30, s30, 1
    s_cmp_ge_u32 s30, 480000
    s_cbranch_scc1 main_kernel_fail
    s_branch main_kernel_c0_3_rr_l
main_kernel_c0_3_rr_d:
    s_branch main_kernel_c0_3_rr_r
main_kernel_c_slow:
    s_cmp_eq_u32 s21, 1
    s_cbranch_scc1 main_kernel_c1_1_layer
    s_cmp_eq_u32 s21, 2
    s_cbranch_scc1 main_kernel_c1_2_layer
    s_cmp_eq_u32 s21, 3
    s_cbranch_scc1 main_kernel_c1_3_layer
main_kernel_c1_0_layer:
    s_lshr_b32 s27, s44, 6
    s_mul_i32 s50, s27, 33554432
    s_lshl_b32 s27, s22, 13
    s_add_u32 s50, s50, s27
    s_add_u32 s50, s50, 37748736
    s_add_u32 s27, s44, 1
    s_or_b32 s28, s44, 63
    s_add_u32 s28, s28, 1
    s_min_u32 s27, s27, s28
    s_cmp_lt_u32 s54, s27
    s_cbranch_scc1 main_kernel_c1_0_p1
main_kernel_c1_0_p1_r:
    s_barrier
    s_and_b32 s26, s44, 63
    s_lshl_b32 s26, s26, 18
    s_add_u32 s26, s26, s50
    s_mul_i32 s27, s20, 5120
    s_add_u32 s48, s27, 167772160
    s_sub_u32 s49, 167777280, s27
    s_and_b32 s2, s44, 63
    s_add_u32 s2, s2, 1
    s_min_u32 s2, s2, 63
    s_lshl_b32 s2, s2, 18
    s_add_u32 s2, s2, s50
    s_add_u32 s27, s44, 2
    s_cmp_ge_u32 s54, s27
    s_cselect_b32 s2, s2, 0x10000000
    s_add_u32 s3, s2, 16777216
    ds_read_b128 v[56:59], v5 offset:0
    ds_read_b128 v[60:63], v5 offset:1024
    ds_read_b128 v[64:67], v5 offset:2048
    ds_read_b128 v[68:71], v5 offset:3072
    v_mov_b64 v[12:13], 0
    v_mov_b64 v[14:15], 0
    v_mov_b64 v[16:17], 0
    v_mov_b64 v[18:19], 0
    v_mov_b64 v[20:21], 0
    v_mov_b64 v[22:23], 0
    v_mov_b64 v[24:25], 0
    v_mov_b64 v[26:27], 0
    v_mov_b64 v[28:29], 0
    v_mov_b64 v[30:31], 0
    v_mov_b64 v[32:33], 0
    v_mov_b64 v[34:35], 0
    s_mov_b32 s70, 0
    s_waitcnt lgkmcnt(0)
main_kernel_c1_0_top:
    s_barrier
    ds_read_b128 v[36:39], v6 offset:21504
    ds_read_b128 v[40:43], v6 offset:22528
    ds_read_b128 v[44:47], v6 offset:23552
    ds_read_b128 v[48:51], v6 offset:24576
    ds_read_b128 v[52:55], v6 offset:25600
    s_mov_b32 m0, 16384
    s_nop 0
    buffer_load_dwordx4 v0, s[8:11], s49 offen offset:0 sc1 lds
    buffer_load_dwordx4 v0, s[8:11], s49 offen offset:1024 sc1 lds
main_kernel_c1_0_lr_r:
    s_waitcnt lgkmcnt(4)
    v_smfmac_f32_16x16x64_bf16 v[20:23], v[36:39], v[56:63], v1
    ds_read_b128 v[56:59], v5 offset:4096
    v_smfmac_f32_16x16x64_bf16 v[24:27], v[36:39], a[248:255], v1
    ds_read_b128 v[60:63], v5 offset:5120
    v_smfmac_f32_16x16x64_bf16 v[28:31], v[36:39], a[240:247], v1
    v_smfmac_f32_16x16x64_bf16 v[32:35], v[36:39], v[64:71], v1
    ds_read_b128 v[64:67], v5 offset:6144
    v_smfmac_f32_16x16x64_bf16 v[12:15], v[36:39], a[232:239], v1
    ds_read_b128 v[68:71], v5 offset:7168
    s_waitcnt lgkmcnt(6)
    v_max3_u32 v10, v36, v40, v44
    v_smfmac_f32_16x16x64_bf16 v[16:19], v[36:39], a[224:231], v1
    s_waitcnt lgkmcnt(4)
    s_waitcnt lgkmcnt(2)
    v_max3_u32 v10, v10, v48, v52
    v_smfmac_f32_16x16x64_bf16 v[20:23], v[40:43], v[56:63], v1
    ds_read_b128 v[56:59], v5 offset:8192
    v_cmp_eq_u32 vcc, -1, v10
    v_smfmac_f32_16x16x64_bf16 v[24:27], v[40:43], a[216:223], v1
    ds_read_b128 v[60:63], v5 offset:9216
    s_cbranch_vccnz main_kernel_c1_0_lr
    v_smfmac_f32_16x16x64_bf16 v[28:31], v[40:43], a[208:215], v1
    s_and_b32 s55, s44, 3
    s_mul_i32 s55, s55, 167936
    s_waitcnt lgkmcnt(2)
    v_smfmac_f32_16x16x64_bf16 v[32:35], v[40:43], v[64:71], v1
    ds_read_b128 v[64:67], v5 offset:10240
    s_add_u32 s55, s55, s34
    s_add_u32 s56, s55, s35
    v_smfmac_f32_16x16x64_bf16 v[20:23], v[44:47], a[200:207], v1
    ds_read_b128 v[68:71], v5 offset:11264
    s_and_b32 s57, s44, 63
    v_smfmac_f32_16x16x64_bf16 v[24:27], v[44:47], a[192:199], v1
    s_add_u32 s43, s55, s32
    s_waitcnt lgkmcnt(2)
    v_smfmac_f32_16x16x64_bf16 v[28:31], v[44:47], v[56:63], v1
    ds_read_b128 v[56:59], v5 offset:12288
    s_add_u32 s61, s43, 33792
    s_add_u32 s100, s43, 67584
    v_smfmac_f32_16x16x64_bf16 v[32:35], v[44:47], a[184:191], v1
    ds_read_b128 v[60:63], v5 offset:13312
    s_add_u32 s101, s43, 101376
    v_smfmac_f32_16x16x64_bf16 v[20:23], v[48:51], a[176:183], v1
    s_waitcnt lgkmcnt(2)
    v_smfmac_f32_16x16x64_bf16 v[24:27], v[48:51], v[64:71], v1
    ds_read_b128 v[64:67], v5 offset:14336
    v_smfmac_f32_16x16x64_bf16 v[28:31], v[48:51], a[168:175], v1
    ds_read_b128 v[68:71], v5 offset:15360
    v_smfmac_f32_16x16x64_bf16 v[32:35], v[48:51], a[160:167], v1
    s_mov_b32 m0, 0
    s_nop 0
    buffer_load_dwordx4 v0, s[8:11], s26 offen offset:0 sc1 lds
    buffer_load_dwordx4 v0, s[8:11], s26 offen offset:1024 sc1 lds
    buffer_store_dwordx4 v[72:75], v0, s[8:11], s64 offen offset:0 sc1
    buffer_store_dwordx4 v[72:75], v0, s[8:11], s64 offen offset:1024 sc1
    s_mov_b64 exec, 0x3ff
    buffer_store_dwordx4 v[72:75], v0, s[8:11], s60 offen sc1
    s_mov_b64 exec, -1
    s_mov_b32 s60, 0x10000000
    s_mov_b32 s64, 0x10000000
    s_waitcnt vmcnt(5)
    s_barrier
    ds_read_b128 v[36:39], v6 offset:16384
    ds_read_b128 v[40:43], v6 offset:17408
    ds_read_b128 v[44:47], v6 offset:18432
    ds_read_b128 v[48:51], v6 offset:19456
    ds_read_b32 v11, v6 offset:20480
    s_waitcnt lgkmcnt(7)
    v_smfmac_f32_16x16x64_bf16 v[20:23], v[52:55], v[56:63], v1
    ds_read_b128 v[56:59], v5 offset:16384
    v_smfmac_f32_16x16x64_bf16 v[24:27], v[52:55], a[152:159], v1
    ds_read_b128 v[60:63], v5 offset:17408
    v_smfmac_f32_16x16x64_bf16 v[28:31], v[52:55], a[144:151], v1
    s_waitcnt lgkmcnt(4)
    v_max3_u32 v10, v36, v40, v44
    v_smfmac_f32_16x16x64_bf16 v[32:35], v[52:55], v[64:71], v1
    s_waitcnt lgkmcnt(2)
    v_max3_u32 v10, v10, v48, v11
    v_cmp_eq_u32 vcc, -1, v10
    s_cbranch_vccnz main_kernel_c1_0_rr
main_kernel_c1_0_rr_r:
    ds_read_b128 v[52:55], v6 offset:20480
    v_smfmac_f32_16x16x64_bf16 v[20:23], v[36:39], a[136:143], v1
    ds_read_b128 v[64:67], v5 offset:18432
    v_smfmac_f32_16x16x64_bf16 v[24:27], v[36:39], a[128:135], v1
    ds_read_b128 v[68:71], v5 offset:19456
    s_waitcnt lgkmcnt(3)
    v_smfmac_f32_16x16x64_bf16 v[20:23], v[40:43], v[56:63], v1
    ds_read_b128 v[56:59], v5 offset:20480
    v_smfmac_f32_16x16x64_bf16 v[24:27], v[40:43], a[120:127], v1
    ds_read_b128 v[60:63], v5 offset:21504
    s_mov_b32 m0, 31488
    s_mov_b64 exec, 3
    buffer_load_dword v8, s[8:11], s51 offen sc1 lds
    s_mov_b64 exec, -1
    s_mov_b32 m0, 31232
    s_nop 0
    buffer_load_dword v8, s[8:11], s2 offen sc1 lds
    buffer_load_dword v8, s[8:11], s3 offen sc1 lds
    v_smfmac_f32_16x16x64_bf16 v[20:23], v[44:47], a[112:119], v1
    s_waitcnt lgkmcnt(2)
    v_smfmac_f32_16x16x64_bf16 v[24:27], v[44:47], v[64:71], v1
    ds_read_b128 v[64:67], v5 offset:22528
    v_smfmac_f32_16x16x64_bf16 v[20:23], v[48:51], a[104:111], v1
    ds_read_b128 v[68:71], v5 offset:23552
    v_smfmac_f32_16x16x64_bf16 v[24:27], v[48:51], a[96:103], v1
    s_waitcnt lgkmcnt(2)
    v_smfmac_f32_16x16x64_bf16 v[20:23], v[52:55], v[56:63], v1
    ds_read_b128 v[56:59], v5 offset:24576
    v_smfmac_f32_16x16x64_bf16 v[24:27], v[52:55], a[88:95], v1
    ds_read_b128 v[60:63], v5 offset:25600
    v_smfmac_f32_16x16x64_bf16 v[28:31], v[36:39], a[80:87], v1
    s_waitcnt lgkmcnt(2)
    v_smfmac_f32_16x16x64_bf16 v[32:35], v[36:39], v[64:71], v1
    ds_read_b128 v[64:67], v5 offset:26624
    s_nop 0
    v_permlane32_swap_b32 v20, v21
    v_smfmac_f32_16x16x64_bf16 v[28:31], v[40:43], a[72:79], v1
    ds_read_b128 v[68:71], v5 offset:27648
    v_permlane32_swap_b32 v22, v23
    v_smfmac_f32_16x16x64_bf16 v[32:35], v[40:43], a[64:71], v1
    s_waitcnt lgkmcnt(2)
    v_permlane32_swap_b32 v24, v25
    v_smfmac_f32_16x16x64_bf16 v[28:31], v[44:47], v[56:63], v1
    ds_read_b128 v[56:59], v5 offset:28672
    v_permlane32_swap_b32 v26, v27
    v_smfmac_f32_16x16x64_bf16 v[32:35], v[44:47], a[56:63], v1
    ds_read_b128 v[60:63], v5 offset:29696
    v_add_f32 v20, v20, v21
    v_add_f32 v22, v22, v23
    v_smfmac_f32_16x16x64_bf16 v[28:31], v[48:51], a[48:55], v1
    s_waitcnt lgkmcnt(2)
    v_add_f32 v24, v24, v25
    v_add_f32 v26, v26, v27
    v_smfmac_f32_16x16x64_bf16 v[32:35], v[48:51], v[64:71], v1
    ds_read_b128 v[64:67], v5 offset:30720
    v_mul_f32 v20, s40, v20
    v_mul_f32 v24, s40, v24
    v_smfmac_f32_16x16x64_bf16 v[28:31], v[52:55], a[40:47], v1
    ds_read_b128 v[68:71], v5 offset:31744
    v_mul_f32 v22, s40, v22
    v_mul_f32 v26, s40, v26
    v_smfmac_f32_16x16x64_bf16 v[32:35], v[52:55], a[32:39], v1
    s_waitcnt lgkmcnt(2)
    v_cvt_pk_bf16_f32 v20, v20, v24
    v_cvt_pk_bf16_f32 v21, v22, v26
    v_smfmac_f32_16x16x64_bf16 v[12:15], v[36:39], v[56:63], v1
    ds_write_b32 v2, v20 offset:26624
    ds_write_b32 v2, v21 offset:27200
    v_smfmac_f32_16x16x64_bf16 v[16:19], v[36:39], a[24:31], v1
    v_permlane32_swap_b32 v28, v29
    v_smfmac_f32_16x16x64_bf16 v[12:15], v[40:43], a[16:23], v1
    s_waitcnt lgkmcnt(2)
    v_permlane32_swap_b32 v30, v31
    v_smfmac_f32_16x16x64_bf16 v[16:19], v[40:43], v[64:71], v1
    ds_read_b128 v[40:43], v6 offset:22528
    v_permlane32_swap_b32 v32, v33
    v_smfmac_f32_16x16x64_bf16 v[12:15], v[44:47], a[8:15], v1
    v_permlane32_swap_b32 v34, v35
    v_smfmac_f32_16x16x64_bf16 v[16:19], v[44:47], a[0:7], v1
    ds_read_b128 v[44:47], v6 offset:23552
    v_add_f32 v28, v28, v29
    v_add_f32 v30, v30, v31
    v_smfmac_f32_16x16x64_bf16 v[12:15], v[48:51], v[248:255], v1
    v_add_f32 v32, v32, v33
    v_add_f32 v34, v34, v35
    v_smfmac_f32_16x16x64_bf16 v[16:19], v[48:51], v[240:247], v1
    ds_read_b128 v[48:51], v6 offset:24576
    v_cvt_pk_bf16_f32 v28, v28, v32
    v_cvt_pk_bf16_f32 v29, v30, v34
    v_smfmac_f32_16x16x64_bf16 v[12:15], v[52:55], v[232:239], v1
    ds_write_b32 v2, v28 offset:28928
    ds_write_b32 v2, v29 offset:29504
    v_smfmac_f32_16x16x64_bf16 v[16:19], v[52:55], v[224:231], v1
    ds_read_b128 v[52:55], v6 offset:25600
    s_waitcnt lgkmcnt(5)
    v_smfmac_f32_16x16x64_bf16 v[12:15], v[40:43], v[216:223], v1
    v_smfmac_f32_16x16x64_bf16 v[16:19], v[40:43], v[208:215], v1
    s_waitcnt vmcnt(3) lgkmcnt(1)
    s_barrier
    ds_read_b128 v[56:59], v0 offset:0
    ds_read_b128 v[20:23], v4 offset:26624
    v_smfmac_f32_16x16x64_bf16 v[12:15], v[44:47], v[200:207], v1
    ds_read_b128 v[60:63], v0 offset:1024
    ds_read_b128 v[24:27], v4 offset:26688
    v_smfmac_f32_16x16x64_bf16 v[16:19], v[44:47], v[192:199], v1
    ds_read_b128 v[64:67], v0 offset:2048
    ds_read_b128 v[72:75], v4 offset:26752
    v_smfmac_f32_16x16x64_bf16 v[12:15], v[48:51], v[184:191], v1
    ds_read_b128 v[68:71], v0 offset:3072
    ds_read_b128 v[76:79], v4 offset:26816
    v_smfmac_f32_16x16x64_bf16 v[16:19], v[48:51], v[176:183], v1
    ds_read_b128 v[36:39], v0 offset:4096
    ds_read_b128 v[40:43], v0 offset:5120
    s_waitcnt lgkmcnt(10)
    v_smfmac_f32_16x16x64_bf16 v[12:15], v[52:55], v[168:175], v1
    ds_read_b128 v[44:47], v0 offset:6144
    ds_read_b128 v[48:51], v0 offset:7168
    v_smfmac_f32_16x16x64_bf16 v[16:19], v[52:55], v[160:167], v1
    s_waitcnt lgkmcnt(10)
    v_mfma_f32_16x16x32_bf16 v[28:31], v[56:59], v[20:23], 0
    s_waitcnt lgkmcnt(8)
    v_mfma_f32_16x16x32_bf16 v[28:31], v[60:63], v[24:27], v[28:31]
    s_nop 0
    s_waitcnt lgkmcnt(6)
    v_cvt_pk_bf16_f32 v12, v12, v13
    v_cvt_pk_bf16_f32 v13, v14, v15
    v_mfma_f32_16x16x32_bf16 v[28:31], v[64:67], v[72:75], v[28:31]
    s_waitcnt lgkmcnt(4)
    v_cvt_pk_bf16_f32 v14, v16, v17
    v_cvt_pk_bf16_f32 v15, v18, v19
    v_mfma_f32_16x16x32_bf16 v[28:31], v[68:71], v[76:79], v[28:31]
    ds_write_b128 v0, v[12:15] offset:16384
    s_waitcnt lgkmcnt(4)
    v_mfma_f32_16x16x32_bf16 v[32:35], v[36:39], v[20:23], 0
    ds_read_b128 v[56:59], v3 offset:28928
    ds_read_b128 v[60:63], v3 offset:28992
    s_waitcnt lgkmcnt(5)
    v_mfma_f32_16x16x32_bf16 v[32:35], v[40:43], v[24:27], v[32:35]
    ds_read_b128 v[64:67], v3 offset:29056
    ds_read_b128 v[68:71], v3 offset:29120
    s_waitcnt lgkmcnt(6)
    v_mfma_f32_16x16x32_bf16 v[32:35], v[44:47], v[72:75], v[32:35]
    s_mov_b64 exec, s[36:37]
    v_exp_f32 v28, v28
    v_exp_f32 v29, v29
    s_mov_b64 exec, -1
    s_waitcnt lgkmcnt(5)
    v_mfma_f32_16x16x32_bf16 v[32:35], v[48:51], v[76:79], v[32:35]
    s_mov_b64 exec, s[36:37]
    v_exp_f32 v30, v30
    v_exp_f32 v31, v31
    s_mov_b64 exec, -1
    s_waitcnt lgkmcnt(4)
    s_barrier
    s_waitcnt lgkmcnt(3)
    v_mfma_f32_16x16x32_bf16 v[52:55], v[56:59], v[20:23], 0
    ds_read_b128 v[36:39], v0 offset:8192
    s_waitcnt lgkmcnt(3)
    v_cvt_pk_bf16_f32 v28, v28, v29
    v_cvt_pk_bf16_f32 v29, v30, v31
    v_mfma_f32_16x16x32_bf16 v[52:55], v[60:63], v[24:27], v[52:55]
    ds_read_b128 v[40:43], v0 offset:10240
    s_mov_b64 exec, s[36:37]
    v_exp_f32 v32, v32
    v_exp_f32 v33, v33
    s_mov_b64 exec, -1
    s_waitcnt lgkmcnt(3)
    v_mfma_f32_16x16x32_bf16 v[52:55], v[64:67], v[72:75], v[52:55]
    ds_read_b128 v[44:47], v0 offset:12288
    s_mov_b64 exec, s[36:37]
    v_exp_f32 v34, v34
    v_exp_f32 v35, v35
    s_mov_b64 exec, -1
    s_waitcnt lgkmcnt(3)
    v_mfma_f32_16x16x32_bf16 v[52:55], v[68:71], v[76:79], v[52:55]
    ds_read_b128 v[48:51], v0 offset:14336
    v_cvt_pk_bf16_f32 v30, v32, v33
    v_cvt_pk_bf16_f32 v31, v34, v35
    s_cmp_eq_u32 s57, 63
    s_cbranch_scc1 main_kernel_c1_0_last
    s_waitcnt lgkmcnt(3)
    v_mfma_f32_16x16x32_bf16 v[20:23], v[36:39], v[28:31], 0
    ds_read_b128 v[56:59], v0 offset:9216
    s_waitcnt lgkmcnt(3)
    v_mov_b32_dpp v32, v28 row_ror:8 row_mask:0xf bank_mask:0xf
    v_mov_b32_dpp v33, v29 row_ror:8 row_mask:0xf bank_mask:0xf
    v_mfma_f32_16x16x32_bf16 v[24:27], v[40:43], v[28:31], 0
    ds_read_b128 v[60:63], v0 offset:11264
    s_waitcnt lgkmcnt(3)
    v_mov_b32_dpp v34, v30 row_ror:8 row_mask:0xf bank_mask:0xf
    v_mov_b32_dpp v35, v31 row_ror:8 row_mask:0xf bank_mask:0xf
    v_mfma_f32_16x16x32_bf16 v[72:75], v[44:47], v[28:31], 0
    ds_read_b128 v[64:67], v0 offset:13312
    s_waitcnt lgkmcnt(3)
    v_mov_b64 v[16:17], s[24:25]
    v_mov_b64 v[18:19], s[24:25]
    v_mfma_f32_16x16x32_bf16 v[76:79], v[48:51], v[28:31], 0
    ds_read_b128 v[68:71], v0 offset:15360
    s_mov_b64 exec, s[36:37]
    v_exp_f32 v52, v52
    s_mov_b64 exec, -1
    v_mfma_f32_16x16x32_bf16 v[12:15], v[16:19], v[28:31], 0
    ds_read_b128 v[36:39], v0 offset:16384
    s_mov_b64 exec, s[36:37]
    v_exp_f32 v53, v53
    s_mov_b64 exec, -1
    s_waitcnt lgkmcnt(4)
    v_mfma_f32_16x16x32_bf16 v[20:23], v[56:59], v[32:35], v[20:23]
    ds_read_b128 v[40:43], v0 offset:17408
    s_mov_b64 exec, s[36:37]
    v_exp_f32 v54, v54
    s_mov_b64 exec, -1
    s_waitcnt lgkmcnt(4)
    v_mfma_f32_16x16x32_bf16 v[24:27], v[60:63], v[32:35], v[24:27]
    ds_read_b128 v[44:47], v0 offset:18432
    s_mov_b64 exec, s[36:37]
    v_exp_f32 v55, v55
    s_mov_b64 exec, -1
    s_waitcnt lgkmcnt(4)
    v_mfma_f32_16x16x32_bf16 v[72:75], v[64:67], v[32:35], v[72:75]
    ds_read_b128 v[48:51], v0 offset:19456
    s_waitcnt lgkmcnt(4)
    v_cvt_pk_bf16_f32 v52, v52, v53
    v_cvt_pk_bf16_f32 v53, v54, v55
    v_mfma_f32_16x16x32_bf16 v[76:79], v[68:71], v[32:35], v[76:79]
    v_mov_b64 v[10:11], s[16:17]
    v_mov_b32_dpp v54, v52 row_ror:8 row_mask:0xf bank_mask:0xf
main_kernel_c1_0_fin:
    s_waitcnt lgkmcnt(3)
    v_mfma_f32_16x16x16_bf16 v[20:23], v[36:37], v[52:53], v[20:23]
    v_mov_b32_dpp v55, v53 row_ror:8 row_mask:0xf bank_mask:0xf
    v_mov_b64 v[56:57], 0
    v_mfma_f32_16x16x16_bf16 v[12:15], v[10:11], v[52:53], v[12:15]
    s_waitcnt lgkmcnt(2)
    v_mov_b64 v[58:59], 0
    v_mov_b64 v[60:61], 0
    v_mfma_f32_16x16x16_bf16 v[24:27], v[40:41], v[52:53], v[24:27]
    v_mov_b64 v[62:63], 0
    v_mov_b64 v[64:65], 0
    v_mfma_f32_16x16x16_bf16 v[20:23], v[38:39], v[54:55], v[20:23]
    v_mov_b64 v[66:67], 0
    v_mov_b64 v[68:69], 0
    v_mfma_f32_16x16x16_bf16 v[24:27], v[42:43], v[54:55], v[24:27]
    s_waitcnt lgkmcnt(1)
    v_add_f32_dpp v12, v12, v12 row_ror:8 row_mask:0xf bank_mask:0xf
    v_mov_b64 v[70:71], 0
    v_mfma_f32_16x16x16_bf16 v[72:75], v[44:45], v[52:53], v[72:75]
    s_waitcnt lgkmcnt(0)
    v_rcp_f32 v14, v12
    v_mfma_f32_16x16x16_bf16 v[76:79], v[48:49], v[52:53], v[76:79]
    v_subrev_u32 v13, s68, v12
    v_cmp_lt_u32 vcc, s69, v13
    v_mfma_f32_16x16x16_bf16 v[72:75], v[46:47], v[54:55], v[72:75]
    s_cbranch_vccnz main_kernel_c1_0_zbad
main_kernel_c1_0_zok:
    v_mov_b64 v[28:29], 0
    v_mov_b64 v[30:31], 0
    v_mfma_f32_16x16x16_bf16 v[76:79], v[50:51], v[54:55], v[76:79]
    v_mul_f32 v20, v20, v14
    v_mul_f32 v21, v21, v14
    v_mul_f32 v22, v22, v14
    v_mul_f32 v23, v23, v14
    v_mul_f32 v24, v24, v14
    v_mul_f32 v25, v25, v14
    v_mul_f32 v26, v26, v14
    v_mul_f32 v27, v27, v14
    v_cvt_pk_bf16_f32 v20, v20, v21
    v_cvt_pk_bf16_f32 v21, v22, v23
    v_cvt_pk_bf16_f32 v22, v24, v25
    v_cvt_pk_bf16_f32 v23, v26, v27
    v_mul_f32 v72, v72, v14
    v_mul_f32 v73, v73, v14
    v_smfmac_f32_16x16x64_bf16 v[56:59], v[20:23], v[152:159], v1
    v_mul_f32 v74, v74, v14
    v_mul_f32 v75, v75, v14
    v_mul_f32 v76, v76, v14
    v_smfmac_f32_16x16x64_bf16 v[60:63], v[20:23], v[136:143], v1
    v_mul_f32 v77, v77, v14
    v_mul_f32 v78, v78, v14
    v_mul_f32 v79, v79, v14
    v_smfmac_f32_16x16x64_bf16 v[64:67], v[20:23], v[120:127], v1
    v_cvt_pk_bf16_f32 v72, v72, v73
    v_cvt_pk_bf16_f32 v73, v74, v75
    v_cvt_pk_bf16_f32 v74, v76, v77
    v_smfmac_f32_16x16x64_bf16 v[68:71], v[20:23], v[104:111], v1
    v_cvt_pk_bf16_f32 v75, v78, v79
    v_smfmac_f32_16x16x64_bf16 v[28:31], v[20:23], v[88:95], v1
    s_nop 0
    v_smfmac_f32_16x16x64_bf16 v[56:59], v[72:75], v[144:151], v1
    v_smfmac_f32_16x16x64_bf16 v[60:63], v[72:75], v[128:135], v1
    v_smfmac_f32_16x16x64_bf16 v[64:67], v[72:75], v[112:119], v1
    v_mov_b32 v5, v5
    v_mov_b32 v5, v5
    v_permlane32_swap_b32 v56, v57
    v_smfmac_f32_16x16x64_bf16 v[68:71], v[72:75], v[96:103], v1
    v_permlane32_swap_b32 v58, v59
    v_smfmac_f32_16x16x64_bf16 v[28:31], v[72:75], v[80:87], v1
    v_add_f32 v56, v56, v57
    v_add_f32 v58, v58, v59
    v_permlane32_swap_b32 v60, v61
    v_permlane32_swap_b32 v62, v63
    v_add_f32 v60, v60, v61
    v_add_f32 v62, v62, v63
    v_cvt_pk_bf16_f32 v36, v56, v60
    v_cvt_pk_bf16_f32 v38, v58, v62
    v_permlane32_swap_b32 v64, v65
    v_permlane32_swap_b32 v66, v67
    v_add_f32 v64, v64, v65
    v_add_f32 v66, v66, v67
    v_permlane32_swap_b32 v68, v69
    v_permlane32_swap_b32 v70, v71
    v_add_f32 v68, v68, v69
    v_add_f32 v70, v70, v71
    v_cvt_pk_bf16_f32 v37, v64, v68
    v_cvt_pk_bf16_f32 v39, v66, v70
    buffer_store_dwordx4 v[36:39], v0, s[8:11], s56 offen sc1
    v_permlane32_swap_b32 v28, v29
    v_permlane32_swap_b32 v30, v31
    v_add_f32 v28, v28, v29
    v_add_f32 v30, v30, v31
    v_cvt_pk_bf16_f32 v28, v28, v30
    buffer_store_dword v28, v7, s[8:11], s55 offen sc1
    v_and_b32 v32, 16, v0
    v_bfe_u32 v33, v0, 5, 2
    v_lshlrev_b32_e64 v32, v32, s45
    v_cmp_eq_u32_e64 s[64:65], 0, v33
    v_cmp_eq_u32_e64 s[66:67], 1, v33
    s_add_u32 s27, s44, 1
    s_and_b32 s27, s27, 3
    v_cndmask_b32_e64 v72, 0, v32, s[64:65]
    v_cndmask_b32_e64 v73, 0, v32, s[66:67]
    v_cmp_eq_u32_e64 s[64:65], 2, v33
    v_cmp_eq_u32_e64 s[66:67], 3, v33
    s_mul_i32 s48, s27, 5120
    s_add_u32 s48, s48, s41
    v_cndmask_b32_e64 v74, 0, v32, s[64:65]
    v_cndmask_b32_e64 v75, 0, v32, s[66:67]
    s_lshl_b32 s27, s27, 15
    s_add_u32 s49, s27, s47
    v_bfe_u32 v11, v0, 4, 3
    v_lshlrev_b32 v11, 3, v11
    v_lshrrev_b32 v32, 8, v0
    v_lshl_add_u32 v11, v32, 6, v11
    s_add_u32 s56, s27, s46
    s_add_u32 s56, s56, s33
    s_add_u32 s58, s48, s33
    v_mov_b32 v5, v5
    s_nop 1
    v_mov_b32 v5, v5
    s_nop 1
    v_mov_b32 v5, v5
    s_nop 1
    v_mov_b32 v5, v5
    s_nop 1
    v_mov_b32 v5, v5
    s_nop 1
    v_mov_b32 v5, v5
    s_nop 1
    v_mov_b32 v5, v5
    s_nop 1
    v_mov_b32 v5, v5
    s_nop 1
    buffer_load_dwordx4 v[40:43], v9, s[8:11], s43 offen sc1
    buffer_load_dwordx4 v[44:47], v9, s[8:11], s61 offen sc1
    buffer_load_dwordx4 v[48:51], v9, s[8:11], s100 offen sc1
    buffer_load_dwordx4 v[52:55], v9, s[8:11], s101 offen sc1
    v_mov_b32 v5, v5
    s_nop 1
    v_mov_b32 v5, v5
    s_nop 1
    v_mov_b32 v5, v5
    s_nop 1
    v_mov_b32 v5, v5
    s_nop 1
    v_mov_b32 v5, v5
    s_nop 1
    v_mov_b32 v5, v5
    s_nop 1
    v_mov_b32 v5, v5
    s_nop 1
    v_mov_b32 v5, v5
    s_nop 1
    buffer_load_dwordx4 v[12:15], v9, s[8:11], s43 offen sc1
    buffer_load_dwordx4 v[16:19], v9, s[8:11], s61 offen sc1
    buffer_load_dwordx4 v[20:23], v9, s[8:11], s100 offen sc1
    buffer_load_dwordx4 v[24:27], v9, s[8:11], s101 offen sc1
    v_mov_b32 v5, v5
    s_nop 1
    v_mov_b32 v5, v5
    s_nop 1
    s_waitcnt vmcnt(7)
    v_mov_b32 v5, v5
    v_mov_b32 v5, v5
    v_mfma_f32_16x16x32_bf16 v[76:79], v[72:75], v[40:43], 0
    s_waitcnt vmcnt(6)
    v_mfma_f32_16x16x32_bf16 v[76:79], v[72:75], v[44:47], v[76:79]
    s_waitcnt vmcnt(5)
    v_mfma_f32_16x16x32_bf16 v[76:79], v[72:75], v[48:51], v[76:79]
    s_waitcnt vmcnt(4)
    v_mfma_f32_16x16x32_bf16 v[76:79], v[72:75], v[52:55], v[76:79]
    v_max3_u32 v32, v40, v44, v48
    v_max_u32 v32, v32, v52
    v_cmp_eq_u32 vcc, -1, v32
    s_cbranch_vccnz main_kernel_c1_0_wrb_i0
    v_mov_b32 v5, v5
    v_mov_b32 v5, v5
    v_mov_b32 v5, v5
    v_mov_b32 v5, v5
    v_add_f32_dpp v76, v76, v76 row_ror:8 row_mask:0xf bank_mask:0xf
    v_add_f32_dpp v77, v77, v77 row_ror:8 row_mask:0xf bank_mask:0xf
    v_add_f32_dpp v78, v78, v78 row_ror:8 row_mask:0xf bank_mask:0xf
    v_add_f32_dpp v79, v79, v79 row_ror:8 row_mask:0xf bank_mask:0xf
    v_cmp_u_f32 vcc, v76, v76
    v_cvt_pk_bf16_f32 v76, v76, v77
    v_cvt_pk_bf16_f32 v77, v78, v79
    s_cbranch_vccnz main_kernel_c1_0_wrb_e0
    s_mov_b64 exec, s[38:39]
    buffer_store_dwordx2 v[76:77], v11, s[8:11], s58 offen sc1
main_kernel_c1_0_wrb_d:
    s_barrier
    buffer_store_dwordx2 v[76:77], v11, s[8:11], s56 offen sc1
    s_mov_b64 exec, -1
    s_waitcnt vmcnt(2)
    ds_read_b128 v[56:59], v5 offset:0
    ds_read_b128 v[60:63], v5 offset:1024
    ds_read_b128 v[64:67], v5 offset:2048
    ds_read_b128 v[68:71], v5 offset:3072
    v_mov_b64 v[12:13], 0
    v_mov_b64 v[14:15], 0
    v_mov_b64 v[16:17], 0
    v_mov_b64 v[18:19], 0
    v_mov_b64 v[20:21], 0
    v_mov_b64 v[22:23], 0
    v_mov_b64 v[24:25], 0
    v_mov_b64 v[26:27], 0
    v_mov_b64 v[28:29], 0
    v_mov_b64 v[30:31], 0
    v_mov_b64 v[32:33], 0
    v_mov_b64 v[34:35], 0
    ds_read_b64 v[72:73], v0 offset:31488
    s_waitcnt lgkmcnt(0)
    v_min_u32 v72, v72, v73
    s_nop 0
    v_readfirstlane_b32 s28, v72
    s_nop 0
    s_max_u32 s54, s54, s28
    s_add_u32 s27, s44, 2
    s_or_b32 s28, s44, 63
    s_add_u32 s28, s28, 1
    s_min_u32 s27, s27, s28
    s_cmp_lt_u32 s54, s27
    s_cbranch_scc1 main_kernel_c1_0_wkw
main_kernel_c1_0_wkw_r:
    s_and_b32 s2, s44, 63
    s_add_u32 s2, s2, 2
    s_min_u32 s2, s2, 63
    s_lshl_b32 s2, s2, 18
    s_add_u32 s2, s2, s50
    s_add_u32 s27, s44, 3
    s_cmp_ge_u32 s54, s27
    s_cselect_b32 s2, s2, 0x10000000
    s_add_u32 s3, s2, 16777216
    v_mov_b64 v[72:73], -1
    v_mov_b64 v[74:75], -1
    s_add_u32 s28, s44, 3
    s_and_b32 s29, s28, 3
    s_mul_i32 s31, s22, 160
    s_mul_i32 s28, s29, 167936
    s_add_u32 s28, s28, s34
    s_add_u32 s64, s28, s35
    s_mul_i32 s60, s29, 5120
    s_add_u32 s60, s60, s41
    s_add_u32 s60, s60, s31
    s_and_b32 s26, s44, 63
    s_add_u32 s26, s26, 1
    s_min_u32 s26, s26, 63
    s_lshl_b32 s26, s26, 18
    s_add_u32 s26, s26, s50
    s_nop 15
    s_nop 15
    s_nop 14
    s_mov_b32 m0, 21504
    s_nop 0
    buffer_load_dwordx4 v0, s[8:11], s48 offen offset:0 sc1 lds
    buffer_load_dwordx4 v0, s[8:11], s48 offen offset:1024 sc1 lds
    buffer_load_dwordx4 v0, s[8:11], s48 offen offset:2048 sc1 lds
    buffer_load_dwordx4 v0, s[8:11], s48 offen offset:3072 sc1 lds
    s_mov_b32 m0, 25600
    s_add_u32 s59, s48, 4096
    buffer_load_dwordx4 v0, s[8:11], s59 offen offset:0 sc1 lds
    s_add_u32 s44, s44, 1
    s_mov_b32 s70, 0
    s_branch main_kernel_c1_0_top
main_kernel_c1_0_restart:
    s_waitcnt vmcnt(0) lgkmcnt(0)
    s_nop 7
    s_barrier
    ds_read_b128 v[56:59], v5 offset:0
    ds_read_b128 v[60:63], v5 offset:1024
    ds_read_b128 v[64:67], v5 offset:2048
    ds_read_b128 v[68:71], v5 offset:3072
    v_mov_b64 v[12:13], 0
    v_mov_b64 v[14:15], 0
    v_mov_b64 v[16:17], 0
    v_mov_b64 v[18:19], 0
    v_mov_b64 v[20:21], 0
    v_mov_b64 v[22:23], 0
    v_mov_b64 v[24:25], 0
    v_mov_b64 v[26:27], 0
    v_mov_b64 v[28:29], 0
    v_mov_b64 v[30:31], 0
    v_mov_b64 v[32:33], 0
    v_mov_b64 v[34:35], 0
    s_waitcnt vmcnt(0) lgkmcnt(0)
    s_branch main_kernel_c1_0_top
main_kernel_c1_0_zbad:
    s_cmp_eq_u32 s70, 2
    s_cbranch_scc1 main_kernel_c1_0_zok
    v_cmp_u_f32 vcc, v12, v12
    s_cbranch_vccz main_kernel_c1_0_exact
    s_cmp_eq_u32 s70, 1
    s_cbranch_scc1 main_kernel_c1_0_exact
main_kernel_c1_0_vfy0:
    s_mov_b32 s70, 1
    s_mov_b32 s30, 0
    s_waitcnt vmcnt(0) lgkmcnt(0)
    s_nop 7
main_kernel_c1_0_vfy:
    v_mov_b32 v10, 0
    s_add_u32 s59, s48, 4096
    buffer_load_dwordx4 v[36:39], v0, s[8:11], s48 offen offset:0 sc1
    buffer_load_dwordx4 v[40:43], v0, s[8:11], s48 offen offset:1024 sc1
    buffer_load_dwordx4 v[44:47], v0, s[8:11], s48 offen offset:2048 sc1
    buffer_load_dwordx4 v[48:51], v0, s[8:11], s48 offen offset:3072 sc1
    buffer_load_dwordx4 v[52:55], v0, s[8:11], s59 offen offset:0 sc1
    s_waitcnt vmcnt(4)
    v_max3_u32 v10, v10, v36, v37
    v_max3_u32 v10, v10, v38, v39
    s_waitcnt vmcnt(3)
    v_max3_u32 v10, v10, v40, v41
    v_max3_u32 v10, v10, v42, v43
    s_waitcnt vmcnt(2)
    v_max3_u32 v10, v10, v44, v45
    v_max3_u32 v10, v10, v46, v47
    s_waitcnt vmcnt(1)
    v_max3_u32 v10, v10, v48, v49
    v_max3_u32 v10, v10, v50, v51
    s_waitcnt vmcnt(0)
    v_max3_u32 v10, v10, v52, v53
    v_max3_u32 v10, v10, v54, v55
    s_add_u32 s59, s49, 4096
    buffer_load_dwordx4 v[36:39], v0, s[8:11], s49 offen offset:0 sc1
    buffer_load_dwordx4 v[40:43], v0, s[8:11], s49 offen offset:1024 sc1
    buffer_load_dwordx4 v[44:47], v0, s[8:11], s49 offen offset:2048 sc1
    buffer_load_dwordx4 v[48:51], v0, s[8:11], s49 offen offset:3072 sc1
    buffer_load_dwordx4 v[52:55], v0, s[8:11], s59 offen offset:0 sc1
    s_waitcnt vmcnt(4)
    v_max3_u32 v10, v10, v36, v37
    v_max3_u32 v10, v10, v38, v39
    s_waitcnt vmcnt(3)
    v_max3_u32 v10, v10, v40, v41
    v_max3_u32 v10, v10, v42, v43
    s_waitcnt vmcnt(2)
    v_max3_u32 v10, v10, v44, v45
    v_max3_u32 v10, v10, v46, v47
    s_waitcnt vmcnt(1)
    v_max3_u32 v10, v10, v48, v49
    v_max3_u32 v10, v10, v50, v51
    s_waitcnt vmcnt(0)
    v_max3_u32 v10, v10, v52, v53
    v_max3_u32 v10, v10, v54, v55
    v_cmp_eq_u32 vcc, -1, v10
    s_cbranch_vccz main_kernel_c1_0_restart
    s_add_u32 s30, s30, 1
    s_cmp_ge_u32 s30, 60000
    s_cbranch_scc1 main_kernel_fail
    s_branch main_kernel_c1_0_vfy
main_kernel_c1_0_exact:
    s_nop 7
    s_mov_b32 s70, 2
    ds_read_b128 v[20:23], v3 offset:26624
    ds_read_b128 v[24:27], v3 offset:26688
    ds_read_b128 v[72:75], v3 offset:26752
    ds_read_b128 v[76:79], v3 offset:26816
    ds_read_b128 v[56:59], v0 offset:0
    s_waitcnt lgkmcnt(0)
    v_mfma_f32_16x16x32_bf16 v[28:31], v[56:59], v[20:23], 0
    s_nop 3
    ds_read_b128 v[60:63], v0 offset:1024
    s_waitcnt lgkmcnt(0)
    v_mfma_f32_16x16x32_bf16 v[28:31], v[60:63], v[24:27], v[28:31]
    s_nop 3
    ds_read_b128 v[56:59], v0 offset:2048
    s_waitcnt lgkmcnt(0)
    v_mfma_f32_16x16x32_bf16 v[28:31], v[56:59], v[72:75], v[28:31]
    s_nop 3
    ds_read_b128 v[60:63], v0 offset:3072
    s_waitcnt lgkmcnt(0)
    v_mfma_f32_16x16x32_bf16 v[28:31], v[60:63], v[76:79], v[28:31]
    s_nop 3
    ds_read_b128 v[56:59], v0 offset:4096
    s_waitcnt lgkmcnt(0)
    v_mfma_f32_16x16x32_bf16 v[32:35], v[56:59], v[20:23], 0
    s_nop 3
    ds_read_b128 v[60:63], v0 offset:5120
    s_waitcnt lgkmcnt(0)
    v_mfma_f32_16x16x32_bf16 v[32:35], v[60:63], v[24:27], v[32:35]
    s_nop 3
    ds_read_b128 v[56:59], v0 offset:6144
    s_waitcnt lgkmcnt(0)
    v_mfma_f32_16x16x32_bf16 v[32:35], v[56:59], v[72:75], v[32:35]
    s_nop 3
    ds_read_b128 v[60:63], v0 offset:7168
    s_waitcnt lgkmcnt(0)
    v_mfma_f32_16x16x32_bf16 v[32:35], v[60:63], v[76:79], v[32:35]
    s_nop 3
    ds_read_b128 v[56:59], v3 offset:28928
    s_waitcnt lgkmcnt(0)
    v_mfma_f32_16x16x32_bf16 v[52:55], v[56:59], v[20:23], 0
    s_nop 3
    ds_read_b128 v[60:63], v3 offset:28992
    s_waitcnt lgkmcnt(0)
    v_mfma_f32_16x16x32_bf16 v[52:55], v[60:63], v[24:27], v[52:55]
    s_nop 3
    ds_read_b128 v[56:59], v3 offset:29056
    s_waitcnt lgkmcnt(0)
    v_mfma_f32_16x16x32_bf16 v[52:55], v[56:59], v[72:75], v[52:55]
    s_nop 3
    ds_read_b128 v[60:63], v3 offset:29120
    s_waitcnt lgkmcnt(0)
    v_mfma_f32_16x16x32_bf16 v[52:55], v[60:63], v[76:79], v[52:55]
    s_nop 3
    v_max3_f32 v64, v28, v29, v30
    v_max3_f32 v64, v64, v31, v32
    v_max3_f32 v64, v64, v33, v34
    s_nop 0
    v_max3_f32 v64, v64, v35, v52
    v_max3_f32 v64, v64, v53, v54
    v_max_f32 v64, v64, v55
    v_mov_b32 v65, v64
    s_nop 1
    v_permlane16_swap_b32 v64, v65
    v_max_f32 v64, v64, v65
    v_mov_b32 v65, v64
    s_nop 1
    v_permlane32_swap_b32 v64, v65
    v_max_f32 v64, v64, v65
    v_sub_f32 v28, v28, v64
    v_exp_f32 v28, v28
    s_nop 0
    v_cndmask_b32_e64 v28, 0, v28, s[36:37]
    v_sub_f32 v29, v29, v64
    v_exp_f32 v29, v29
    s_nop 0
    v_cndmask_b32_e64 v29, 0, v29, s[36:37]
    v_sub_f32 v30, v30, v64
    v_exp_f32 v30, v30
    s_nop 0
    v_cndmask_b32_e64 v30, 0, v30, s[36:37]
    v_sub_f32 v31, v31, v64
    v_exp_f32 v31, v31
    s_nop 0
    v_cndmask_b32_e64 v31, 0, v31, s[36:37]
    v_sub_f32 v32, v32, v64
    v_exp_f32 v32, v32
    s_nop 0
    v_cndmask_b32_e64 v32, 0, v32, s[36:37]
    v_sub_f32 v33, v33, v64
    v_exp_f32 v33, v33
    s_nop 0
    v_cndmask_b32_e64 v33, 0, v33, s[36:37]
    v_sub_f32 v34, v34, v64
    v_exp_f32 v34, v34
    s_nop 0
    v_cndmask_b32_e64 v34, 0, v34, s[36:37]
    v_sub_f32 v35, v35, v64
    v_exp_f32 v35, v35
    s_nop 0
    v_cndmask_b32_e64 v35, 0, v35, s[36:37]
    v_sub_f32 v52, v52, v64
    v_exp_f32 v52, v52
    s_nop 0
    v_cndmask_b32_e64 v52, 0, v52, s[36:37]
    v_sub_f32 v53, v53, v64
    v_exp_f32 v53, v53
    s_nop 0
    v_cndmask_b32_e64 v53, 0, v53, s[36:37]
    v_sub_f32 v54, v54, v64
    v_exp_f32 v54, v54
    s_nop 0
    v_cndmask_b32_e64 v54, 0, v54, s[36:37]
    v_sub_f32 v55, v55, v64
    v_exp_f32 v55, v55
    s_nop 0
    v_cndmask_b32_e64 v55, 0, v55, s[36:37]
    v_cvt_pk_bf16_f32 v28, v28, v29
    v_cvt_pk_bf16_f32 v29, v30, v31
    v_cvt_pk_bf16_f32 v30, v32, v33
    v_cvt_pk_bf16_f32 v31, v34, v35
    v_mov_b32_dpp v32, v28 row_ror:8 row_mask:0xf bank_mask:0xf
    v_mov_b32_dpp v33, v29 row_ror:8 row_mask:0xf bank_mask:0xf
    v_mov_b32_dpp v34, v30 row_ror:8 row_mask:0xf bank_mask:0xf
    v_mov_b32_dpp v35, v31 row_ror:8 row_mask:0xf bank_mask:0xf
    v_cvt_pk_bf16_f32 v52, v52, v53
    v_cvt_pk_bf16_f32 v53, v54, v55
    s_nop 0
    v_mov_b32_dpp v54, v52 row_ror:8 row_mask:0xf bank_mask:0xf
    v_mfma_f32_16x16x32_bf16 v[12:15], v[16:19], v[28:31], 0
    ds_read_b128 v[56:59], v0 offset:8192
    s_waitcnt lgkmcnt(0)
    v_mfma_f32_16x16x32_bf16 v[20:23], v[56:59], v[28:31], 0
    s_nop 3
    ds_read_b128 v[60:63], v0 offset:9216
    s_waitcnt lgkmcnt(0)
    v_mfma_f32_16x16x32_bf16 v[20:23], v[60:63], v[32:35], v[20:23]
    s_nop 3
    ds_read_b128 v[56:59], v0 offset:10240
    s_waitcnt lgkmcnt(0)
    v_mfma_f32_16x16x32_bf16 v[24:27], v[56:59], v[28:31], 0
    s_nop 3
    ds_read_b128 v[60:63], v0 offset:11264
    s_waitcnt lgkmcnt(0)
    v_mfma_f32_16x16x32_bf16 v[24:27], v[60:63], v[32:35], v[24:27]
    s_nop 3
    ds_read_b128 v[56:59], v0 offset:12288
    s_waitcnt lgkmcnt(0)
    v_mfma_f32_16x16x32_bf16 v[72:75], v[56:59], v[28:31], 0
    s_nop 3
    ds_read_b128 v[60:63], v0 offset:13312
    s_waitcnt lgkmcnt(0)
    v_mfma_f32_16x16x32_bf16 v[72:75], v[60:63], v[32:35], v[72:75]
    s_nop 3
    ds_read_b128 v[56:59], v0 offset:14336
    s_waitcnt lgkmcnt(0)
    v_mfma_f32_16x16x32_bf16 v[76:79], v[56:59], v[28:31], 0
    s_nop 3
    ds_read_b128 v[60:63], v0 offset:15360
    s_waitcnt lgkmcnt(0)
    v_mfma_f32_16x16x32_bf16 v[76:79], v[60:63], v[32:35], v[76:79]
    s_nop 3
    s_nop 7
    s_branch main_kernel_c1_0_fin
main_kernel_c1_0_last:
    s_cmp_lg_u32 s70, 0
    s_cbranch_scc1 main_kernel_c1_0_last2
    v_cmp_u_f32 vcc, v32, v32
    s_cbranch_vccnz main_kernel_c1_0_vfy0
main_kernel_c1_0_last2:
    s_waitcnt vmcnt(0) lgkmcnt(0)
    s_barrier
    s_nop 7
    v_mov_b64 v[72:73], -1
    v_mov_b64 v[74:75], -1
    s_add_u32 s28, s44, 3
    s_and_b32 s29, s28, 3
    s_mul_i32 s31, s22, 160
    s_mul_i32 s28, s29, 167936
    s_add_u32 s28, s28, s34
    s_add_u32 s64, s28, s35
    s_mul_i32 s60, s29, 5120
    s_add_u32 s60, s60, s41
    s_add_u32 s60, s60, s31
    buffer_store_dwordx4 v[72:75], v0, s[8:11], s64 offen offset:0 sc1
    buffer_store_dwordx4 v[72:75], v0, s[8:11], s64 offen offset:1024 sc1
    s_mov_b64 exec, 0x3ff
    buffer_store_dwordx4 v[72:75], v0, s[8:11], s60 offen sc1
    s_mov_b64 exec, -1
    s_mov_b32 s60, 0x10000000
    s_mov_b32 s64, 0x10000000
    s_waitcnt vmcnt(0)
    s_add_u32 s44, s44, 1
    s_cmp_eq_u32 s44, 128
    s_cbranch_scc1 main_kernel_end
    s_branch main_kernel_c1_0_layer
main_kernel_c1_0_p1:
    s_mov_b32 s30, 0
main_kernel_c1_0_p1_l:
    s_waitcnt lgkmcnt(0)
    s_mov_b64 exec, 3
    buffer_load_dword v11, v8, s[8:11], s51 offen sc1
    s_waitcnt vmcnt(0)
    s_mov_b64 exec, -1
    v_readlane_b32 s54, v11, 0
    v_readlane_b32 s28, v11, 1
    s_nop 3
    s_min_u32 s54, s54, s28
    s_cmp_ge_u32 s54, s27
    s_cbranch_scc1 main_kernel_c1_0_p1_r
    s_sleep 1
    s_add_u32 s30, s30, 1
    s_cmp_ge_u32 s30, 60000
    s_cbranch_scc1 main_kernel_fail
    s_branch main_kernel_c1_0_p1_l
main_kernel_c1_0_lr:
    s_mov_b32 s30, 0
main_kernel_c1_0_lr_l:
    s_waitcnt lgkmcnt(0)
    ds_read_b128 v[36:39], v6 offset:21504
    ds_read_b128 v[40:43], v6 offset:22528
    ds_read_b128 v[44:47], v6 offset:23552
    ds_read_b128 v[48:51], v6 offset:24576
    ds_read_b128 v[52:55], v6 offset:25600
    s_waitcnt lgkmcnt(2)
    v_max3_u32 v10, v36, v40, v44
    s_waitcnt lgkmcnt(0)
    v_max3_u32 v10, v10, v48, v52
    v_cmp_eq_u32 vcc, -1, v10
    s_cbranch_vccz main_kernel_c1_0_lr_d
    s_add_u32 s30, s30, 1
    s_cmp_ge_u32 s30, 480000
    s_cbranch_scc1 main_kernel_fail
    s_branch main_kernel_c1_0_lr_l
main_kernel_c1_0_lr_d:
    ds_read_b128 v[56:59], v5 offset:0
    ds_read_b128 v[60:63], v5 offset:1024
    ds_read_b128 v[64:67], v5 offset:2048
    ds_read_b128 v[68:71], v5 offset:3072
    v_mov_b64 v[12:13], 0
    v_mov_b64 v[14:15], 0
    v_mov_b64 v[16:17], 0
    v_mov_b64 v[18:19], 0
    v_mov_b64 v[20:21], 0
    v_mov_b64 v[22:23], 0
    v_mov_b64 v[24:25], 0
    v_mov_b64 v[26:27], 0
    v_mov_b64 v[28:29], 0
    v_mov_b64 v[30:31], 0
    v_mov_b64 v[32:33], 0
    v_mov_b64 v[34:35], 0
    s_waitcnt lgkmcnt(0)
    s_branch main_kernel_c1_0_lr_r
main_kernel_c1_0_rr:
    s_mov_b32 s30, 0
main_kernel_c1_0_rr_l:
    s_waitcnt lgkmcnt(0)
    s_and_b32 s27, s30, 1
    s_cbranch_scc1 main_kernel_c1_0_rr_n
    s_waitcnt vmcnt(2)
    s_mov_b32 m0, 16384
    s_nop 0
    buffer_load_dwordx4 v0, s[8:11], s49 offen offset:0 sc1 lds
    buffer_load_dwordx4 v0, s[8:11], s49 offen offset:1024 sc1 lds
main_kernel_c1_0_rr_n:
    ds_read_b128 v[36:39], v6 offset:16384
    ds_read_b128 v[40:43], v6 offset:17408
    ds_read_b128 v[44:47], v6 offset:18432
    ds_read_b128 v[48:51], v6 offset:19456
    ds_read_b32 v11, v6 offset:20480
    s_waitcnt lgkmcnt(2)
    v_max3_u32 v10, v36, v40, v44
    s_waitcnt lgkmcnt(0)
    v_max3_u32 v10, v10, v48, v11
    v_cmp_eq_u32 vcc, -1, v10
    s_cbranch_vccz main_kernel_c1_0_rr_d
    s_add_u32 s30, s30, 1
    s_cmp_ge_u32 s30, 480000
    s_cbranch_scc1 main_kernel_fail
    s_branch main_kernel_c1_0_rr_l
main_kernel_c1_0_rr_d:
    s_branch main_kernel_c1_0_rr_r
main_kernel_c1_0_wrb_l:
    s_waitcnt vmcnt(4)
    v_mfma_f32_16x16x32_bf16 v[76:79], v[72:75], v[40:43], 0
    v_mfma_f32_16x16x32_bf16 v[76:79], v[72:75], v[44:47], v[76:79]
    v_mfma_f32_16x16x32_bf16 v[76:79], v[72:75], v[48:51], v[76:79]
    v_mfma_f32_16x16x32_bf16 v[76:79], v[72:75], v[52:55], v[76:79]
    v_max3_u32 v32, v40, v44, v48
    v_max_u32 v32, v32, v52
    v_cmp_eq_u32 vcc, -1, v32
    s_cbranch_vccz main_kernel_c1_0_wrb_x0
main_kernel_c1_0_wrb_i0:
    buffer_load_dwordx4 v[40:43], v9, s[8:11], s43 offen sc1
    buffer_load_dwordx4 v[44:47], v9, s[8:11], s61 offen sc1
    buffer_load_dwordx4 v[48:51], v9, s[8:11], s100 offen sc1
    buffer_load_dwordx4 v[52:55], v9, s[8:11], s101 offen sc1
    s_waitcnt vmcnt(4)
    v_mfma_f32_16x16x32_bf16 v[76:79], v[72:75], v[12:15], 0
    v_mfma_f32_16x16x32_bf16 v[76:79], v[72:75], v[16:19], v[76:79]
    v_mfma_f32_16x16x32_bf16 v[76:79], v[72:75], v[20:23], v[76:79]
    v_mfma_f32_16x16x32_bf16 v[76:79], v[72:75], v[24:27], v[76:79]
    v_max3_u32 v32, v12, v16, v20
    v_max_u32 v32, v32, v24
    v_cmp_eq_u32 vcc, -1, v32
    s_cbranch_vccz main_kernel_c1_0_wrb_x1
main_kernel_c1_0_wrb_i1:
    buffer_load_dwordx4 v[12:15], v9, s[8:11], s43 offen sc1
    buffer_load_dwordx4 v[16:19], v9, s[8:11], s61 offen sc1
    buffer_load_dwordx4 v[20:23], v9, s[8:11], s100 offen sc1
    buffer_load_dwordx4 v[24:27], v9, s[8:11], s101 offen sc1
    s_add_u32 s71, s71, 1
    s_cmp_lt_u32 s71, 240000
    s_cbranch_scc1 main_kernel_c1_0_wrb_l
    s_branch main_kernel_fail
main_kernel_c1_0_wrb_x0:
    s_nop 3
    v_add_f32_dpp v76, v76, v76 row_ror:8 row_mask:0xf bank_mask:0xf
    v_add_f32_dpp v77, v77, v77 row_ror:8 row_mask:0xf bank_mask:0xf
    v_add_f32_dpp v78, v78, v78 row_ror:8 row_mask:0xf bank_mask:0xf
    v_add_f32_dpp v79, v79, v79 row_ror:8 row_mask:0xf bank_mask:0xf
    v_cmp_u_f32 vcc, v76, v76
    v_cvt_pk_bf16_f32 v76, v76, v77
    v_cvt_pk_bf16_f32 v77, v78, v79
    s_cbranch_vccz main_kernel_c1_0_wrb_n
main_kernel_c1_0_wrb_e0:
    v_max3_u32 v32, v40, v41, v42
    v_max3_u32 v32, v32, v43, v44
    v_max3_u32 v32, v32, v45, v46
    v_max3_u32 v32, v32, v47, v48
    v_max3_u32 v32, v32, v49, v50
    v_max3_u32 v32, v32, v51, v52
    v_max3_u32 v32, v32, v53, v54
    v_max_u32 v32, v32, v55
    v_cmp_eq_u32 vcc, -1, v32
    s_cbranch_vccnz main_kernel_c1_0_wrb_i0
    v_min_u32 v76, -2, v76
    v_min_u32 v77, -2, v77
    s_branch main_kernel_c1_0_wrb_n
main_kernel_c1_0_wrb_x1:
    s_nop 3
    v_add_f32_dpp v76, v76, v76 row_ror:8 row_mask:0xf bank_mask:0xf
    v_add_f32_dpp v77, v77, v77 row_ror:8 row_mask:0xf bank_mask:0xf
    v_add_f32_dpp v78, v78, v78 row_ror:8 row_mask:0xf bank_mask:0xf
    v_add_f32_dpp v79, v79, v79 row_ror:8 row_mask:0xf bank_mask:0xf
    v_cmp_u_f32 vcc, v76, v76
    v_cvt_pk_bf16_f32 v76, v76, v77
    v_cvt_pk_bf16_f32 v77, v78, v79
    s_cbranch_vccz main_kernel_c1_0_wrb_n
main_kernel_c1_0_wrb_e1:
    v_max3_u32 v32, v12, v13, v14
    v_max3_u32 v32, v32, v15, v16
    v_max3_u32 v32, v32, v17, v18
    v_max3_u32 v32, v32, v19, v20
    v_max3_u32 v32, v32, v21, v22
    v_max3_u32 v32, v32, v23, v24
    v_max3_u32 v32, v32, v25, v26
    v_max_u32 v32, v32, v27
    v_cmp_eq_u32 vcc, -1, v32
    s_cbranch_vccnz main_kernel_c1_0_wrb_i1
    v_min_u32 v76, -2, v76
    v_min_u32 v77, -2, v77
main_kernel_c1_0_wrb_n:
    s_mov_b64 exec, s[38:39]
    buffer_store_dwordx2 v[76:77], v11, s[8:11], s58 offen sc1
    s_branch main_kernel_c1_0_wrb_d
main_kernel_c1_0_wkw:
    s_mov_b32 s30, 0
main_kernel_c1_0_wkw_l:
    s_waitcnt lgkmcnt(0)
    s_mov_b64 exec, 3
    buffer_load_dword v11, v8, s[8:11], s51 offen sc1
    s_waitcnt vmcnt(0)
    s_mov_b64 exec, -1
    v_readlane_b32 s54, v11, 0
    v_readlane_b32 s28, v11, 1
    s_nop 3
    s_min_u32 s54, s54, s28
    s_cmp_ge_u32 s54, s27
    s_cbranch_scc1 main_kernel_c1_0_wkw_r
    s_sleep 1
    s_add_u32 s30, s30, 1
    s_cmp_ge_u32 s30, 60000
    s_cbranch_scc1 main_kernel_fail
    s_branch main_kernel_c1_0_wkw_l
main_kernel_c1_1_layer:
    s_lshr_b32 s27, s44, 6
    s_mul_i32 s50, s27, 33554432
    s_lshl_b32 s27, s22, 13
    s_add_u32 s50, s50, s27
    s_add_u32 s50, s50, 37748736
    s_barrier
    s_and_b32 s26, s44, 63
    s_lshl_b32 s26, s26, 18
    s_add_u32 s26, s26, s50
    s_mul_i32 s27, s20, 5120
    s_add_u32 s48, s27, 167772160
    s_sub_u32 s49, 167777280, s27
    ds_read_b128 v[56:59], v5 offset:0
    ds_read_b128 v[60:63], v5 offset:1024
    ds_read_b128 v[64:67], v5 offset:2048
    ds_read_b128 v[68:71], v5 offset:3072
    v_mov_b64 v[12:13], 0
    v_mov_b64 v[14:15], 0
    v_mov_b64 v[16:17], 0
    v_mov_b64 v[18:19], 0
    v_mov_b64 v[20:21], 0
    v_mov_b64 v[22:23], 0
    v_mov_b64 v[24:25], 0
    v_mov_b64 v[26:27], 0
    v_mov_b64 v[28:29], 0
    v_mov_b64 v[30:31], 0
    v_mov_b64 v[32:33], 0
    v_mov_b64 v[34:35], 0
    s_mov_b32 s70, 0
    s_waitcnt lgkmcnt(0)
main_kernel_c1_1_top:
    s_barrier
    ds_read_b128 v[36:39], v6 offset:21504
    ds_read_b128 v[40:43], v6 offset:22528
    ds_read_b128 v[44:47], v6 offset:23552
    ds_read_b128 v[48:51], v6 offset:24576
    ds_read_b128 v[52:55], v6 offset:25600
    s_mov_b32 m0, 16384
    s_nop 0
    buffer_load_dwordx4 v0, s[8:11], s49 offen offset:2048 sc1 lds
main_kernel_c1_1_lr_r:
    s_waitcnt lgkmcnt(4)
    v_smfmac_f32_16x16x64_bf16 v[20:23], v[36:39], v[56:63], v1
    ds_read_b128 v[56:59], v5 offset:4096
    v_smfmac_f32_16x16x64_bf16 v[24:27], v[36:39], a[248:255], v1
    ds_read_b128 v[60:63], v5 offset:5120
    v_smfmac_f32_16x16x64_bf16 v[28:31], v[36:39], a[240:247], v1
    v_smfmac_f32_16x16x64_bf16 v[32:35], v[36:39], v[64:71], v1
    ds_read_b128 v[64:67], v5 offset:6144
    v_smfmac_f32_16x16x64_bf16 v[12:15], v[36:39], a[232:239], v1
    ds_read_b128 v[68:71], v5 offset:7168
    s_waitcnt lgkmcnt(6)
    v_max3_u32 v10, v36, v40, v44
    v_smfmac_f32_16x16x64_bf16 v[16:19], v[36:39], a[224:231], v1
    s_waitcnt lgkmcnt(4)
    s_waitcnt lgkmcnt(2)
    v_max3_u32 v10, v10, v48, v52
    v_smfmac_f32_16x16x64_bf16 v[20:23], v[40:43], v[56:63], v1
    ds_read_b128 v[56:59], v5 offset:8192
    v_cmp_eq_u32 vcc, -1, v10
    v_smfmac_f32_16x16x64_bf16 v[24:27], v[40:43], a[216:223], v1
    ds_read_b128 v[60:63], v5 offset:9216
    s_cbranch_vccnz main_kernel_c1_1_lr
    v_smfmac_f32_16x16x64_bf16 v[28:31], v[40:43], a[208:215], v1
    s_and_b32 s55, s44, 3
    s_mul_i32 s55, s55, 167936
    s_waitcnt lgkmcnt(2)
    v_smfmac_f32_16x16x64_bf16 v[32:35], v[40:43], v[64:71], v1
    ds_read_b128 v[64:67], v5 offset:10240
    s_add_u32 s55, s55, s34
    s_add_u32 s56, s55, s35
    v_smfmac_f32_16x16x64_bf16 v[20:23], v[44:47], a[200:207], v1
    ds_read_b128 v[68:71], v5 offset:11264
    s_and_b32 s57, s44, 63
    v_smfmac_f32_16x16x64_bf16 v[24:27], v[44:47], a[192:199], v1
    s_add_u32 s43, s55, s32
    s_waitcnt lgkmcnt(2)
    v_smfmac_f32_16x16x64_bf16 v[28:31], v[44:47], v[56:63], v1
    ds_read_b128 v[56:59], v5 offset:12288
    s_sub_u32 s27, s57, 1
    s_max_i32 s27, s27, 0
    v_smfmac_f32_16x16x64_bf16 v[32:35], v[44:47], a[184:191], v1
    ds_read_b128 v[60:63], v5 offset:13312
    s_lshl_b64 s[28:29], 1, s27
    s_lshl_b32 s27, s27, 7
    s_sub_u32 s31, s52, s27
    v_smfmac_f32_16x16x64_bf16 v[20:23], v[48:51], a[176:183], v1
    s_waitcnt lgkmcnt(2)
    v_smfmac_f32_16x16x64_bf16 v[24:27], v[48:51], v[64:71], v1
    ds_read_b128 v[64:67], v5 offset:14336
    v_smfmac_f32_16x16x64_bf16 v[28:31], v[48:51], a[168:175], v1
    ds_read_b128 v[68:71], v5 offset:15360
    v_smfmac_f32_16x16x64_bf16 v[32:35], v[48:51], a[160:167], v1
    s_mov_b32 m0, 0
    s_nop 0
    buffer_load_dwordx4 v0, s[8:11], s26 offen offset:2048 sc1 lds
    buffer_load_dwordx4 v0, s[8:11], s26 offen offset:3072 sc1 lds
    buffer_store_dwordx4 v[72:75], v0, s[8:11], s64 offen offset:1024 sc1
    buffer_store_dwordx4 v[72:75], v0, s[8:11], s64 offen offset:2048 sc1
    buffer_store_dwordx4 v[72:75], v0, s[8:11], s65 offen sc1
    s_mov_b32 s65, 0x10000000
    s_mov_b32 s64, 0x10000000
    s_waitcnt vmcnt(5)
    s_barrier
    ds_read_b128 v[36:39], v6 offset:16384
    ds_read_b128 v[40:43], v6 offset:17408
    ds_read_b128 v[44:47], v6 offset:18432
    ds_read_b128 v[48:51], v6 offset:19456
    ds_read_b32 v11, v6 offset:20480
    s_waitcnt lgkmcnt(7)
    v_smfmac_f32_16x16x64_bf16 v[20:23], v[52:55], v[56:63], v1
    ds_read_b128 v[56:59], v5 offset:16384
    v_smfmac_f32_16x16x64_bf16 v[24:27], v[52:55], a[152:159], v1
    ds_read_b128 v[60:63], v5 offset:17408
    v_smfmac_f32_16x16x64_bf16 v[28:31], v[52:55], a[144:151], v1
    s_waitcnt lgkmcnt(4)
    v_max3_u32 v10, v36, v40, v44
    v_smfmac_f32_16x16x64_bf16 v[32:35], v[52:55], v[64:71], v1
    s_waitcnt lgkmcnt(2)
    v_max3_u32 v10, v10, v48, v11
    v_cmp_eq_u32 vcc, -1, v10
    s_cbranch_vccnz main_kernel_c1_1_rr
main_kernel_c1_1_rr_r:
    ds_read_b128 v[52:55], v6 offset:20480
    v_smfmac_f32_16x16x64_bf16 v[20:23], v[36:39], a[136:143], v1
    ds_read_b128 v[64:67], v5 offset:18432
    v_smfmac_f32_16x16x64_bf16 v[24:27], v[36:39], a[128:135], v1
    ds_read_b128 v[68:71], v5 offset:19456
    s_waitcnt lgkmcnt(3)
    v_smfmac_f32_16x16x64_bf16 v[20:23], v[40:43], v[56:63], v1
    ds_read_b128 v[56:59], v5 offset:20480
    v_smfmac_f32_16x16x64_bf16 v[24:27], v[40:43], a[120:127], v1
    ds_read_b128 v[60:63], v5 offset:21504
    s_mov_b64 exec, s[28:29]
    buffer_store_dword v8, v8, s[8:11], s31 offen sc1
    s_mov_b64 exec, 0x3ff
    buffer_store_dwordx4 v[72:75], v0, s[8:11], s60 offen sc1
    s_mov_b64 exec, -1
    s_mov_b32 s60, 0x10000000
    v_smfmac_f32_16x16x64_bf16 v[20:23], v[44:47], a[112:119], v1
    s_waitcnt lgkmcnt(2)
    v_smfmac_f32_16x16x64_bf16 v[24:27], v[44:47], v[64:71], v1
    ds_read_b128 v[64:67], v5 offset:22528
    v_smfmac_f32_16x16x64_bf16 v[20:23], v[48:51], a[104:111], v1
    ds_read_b128 v[68:71], v5 offset:23552
    v_smfmac_f32_16x16x64_bf16 v[24:27], v[48:51], a[96:103], v1
    s_waitcnt lgkmcnt(2)
    v_smfmac_f32_16x16x64_bf16 v[20:23], v[52:55], v[56:63], v1
    ds_read_b128 v[56:59], v5 offset:24576
    v_smfmac_f32_16x16x64_bf16 v[24:27], v[52:55], a[88:95], v1
    ds_read_b128 v[60:63], v5 offset:25600
    v_smfmac_f32_16x16x64_bf16 v[28:31], v[36:39], a[80:87], v1
    s_waitcnt lgkmcnt(2)
    v_smfmac_f32_16x16x64_bf16 v[32:35], v[36:39], v[64:71], v1
    ds_read_b128 v[64:67], v5 offset:26624
    s_nop 0
    v_permlane32_swap_b32 v20, v21
    v_smfmac_f32_16x16x64_bf16 v[28:31], v[40:43], a[72:79], v1
    ds_read_b128 v[68:71], v5 offset:27648
    v_permlane32_swap_b32 v22, v23
    v_smfmac_f32_16x16x64_bf16 v[32:35], v[40:43], a[64:71], v1
    s_waitcnt lgkmcnt(2)
    v_permlane32_swap_b32 v24, v25
    v_smfmac_f32_16x16x64_bf16 v[28:31], v[44:47], v[56:63], v1
    ds_read_b128 v[56:59], v5 offset:28672
    v_permlane32_swap_b32 v26, v27
    v_smfmac_f32_16x16x64_bf16 v[32:35], v[44:47], a[56:63], v1
    ds_read_b128 v[60:63], v5 offset:29696
    v_add_f32 v20, v20, v21
    v_add_f32 v22, v22, v23
    v_smfmac_f32_16x16x64_bf16 v[28:31], v[48:51], a[48:55], v1
    s_waitcnt lgkmcnt(2)
    v_add_f32 v24, v24, v25
    v_add_f32 v26, v26, v27
    v_smfmac_f32_16x16x64_bf16 v[32:35], v[48:51], v[64:71], v1
    ds_read_b128 v[64:67], v5 offset:30720
    v_mul_f32 v20, s40, v20
    v_mul_f32 v24, s40, v24
    v_smfmac_f32_16x16x64_bf16 v[28:31], v[52:55], a[40:47], v1
    ds_read_b128 v[68:71], v5 offset:31744
    v_mul_f32 v22, s40, v22
    v_mul_f32 v26, s40, v26
    v_smfmac_f32_16x16x64_bf16 v[32:35], v[52:55], a[32:39], v1
    s_waitcnt lgkmcnt(2)
    v_cvt_pk_bf16_f32 v20, v20, v24
    v_cvt_pk_bf16_f32 v21, v22, v26
    v_smfmac_f32_16x16x64_bf16 v[12:15], v[36:39], v[56:63], v1
    ds_write_b32 v2, v20 offset:26624
    ds_write_b32 v2, v21 offset:27200
    v_smfmac_f32_16x16x64_bf16 v[16:19], v[36:39], a[24:31], v1
    v_permlane32_swap_b32 v28, v29
    v_smfmac_f32_16x16x64_bf16 v[12:15], v[40:43], a[16:23], v1
    s_waitcnt lgkmcnt(2)
    v_permlane32_swap_b32 v30, v31
    v_smfmac_f32_16x16x64_bf16 v[16:19], v[40:43], v[64:71], v1
    ds_read_b128 v[40:43], v6 offset:22528
    v_permlane32_swap_b32 v32, v33
    v_smfmac_f32_16x16x64_bf16 v[12:15], v[44:47], a[8:15], v1
    v_permlane32_swap_b32 v34, v35
    v_smfmac_f32_16x16x64_bf16 v[16:19], v[44:47], a[0:7], v1
    ds_read_b128 v[44:47], v6 offset:23552
    v_add_f32 v28, v28, v29
    v_add_f32 v30, v30, v31
    v_smfmac_f32_16x16x64_bf16 v[12:15], v[48:51], v[248:255], v1
    v_add_f32 v32, v32, v33
    v_add_f32 v34, v34, v35
    v_smfmac_f32_16x16x64_bf16 v[16:19], v[48:51], v[240:247], v1
    ds_read_b128 v[48:51], v6 offset:24576
    v_cvt_pk_bf16_f32 v28, v28, v32
    v_cvt_pk_bf16_f32 v29, v30, v34
    v_smfmac_f32_16x16x64_bf16 v[12:15], v[52:55], v[232:239], v1
    ds_write_b32 v2, v28 offset:28928
    ds_write_b32 v2, v29 offset:29504
    v_smfmac_f32_16x16x64_bf16 v[16:19], v[52:55], v[224:231], v1
    ds_read_b128 v[52:55], v6 offset:25600
    s_waitcnt lgkmcnt(5)
    v_smfmac_f32_16x16x64_bf16 v[12:15], v[40:43], v[216:223], v1
    v_smfmac_f32_16x16x64_bf16 v[16:19], v[40:43], v[208:215], v1
    s_waitcnt vmcnt(2) lgkmcnt(1)
    s_barrier
    ds_read_b128 v[56:59], v0 offset:0
    ds_read_b128 v[20:23], v4 offset:26624
    v_smfmac_f32_16x16x64_bf16 v[12:15], v[44:47], v[200:207], v1
    ds_read_b128 v[60:63], v0 offset:1024
    ds_read_b128 v[24:27], v4 offset:26688
    v_smfmac_f32_16x16x64_bf16 v[16:19], v[44:47], v[192:199], v1
    ds_read_b128 v[64:67], v0 offset:2048
    ds_read_b128 v[72:75], v4 offset:26752
    v_smfmac_f32_16x16x64_bf16 v[12:15], v[48:51], v[184:191], v1
    ds_read_b128 v[68:71], v0 offset:3072
    ds_read_b128 v[76:79], v4 offset:26816
    v_smfmac_f32_16x16x64_bf16 v[16:19], v[48:51], v[176:183], v1
    ds_read_b128 v[36:39], v0 offset:4096
    ds_read_b128 v[40:43], v0 offset:5120
    s_waitcnt lgkmcnt(10)
    v_smfmac_f32_16x16x64_bf16 v[12:15], v[52:55], v[168:175], v1
    ds_read_b128 v[44:47], v0 offset:6144
    ds_read_b128 v[48:51], v0 offset:7168
    v_smfmac_f32_16x16x64_bf16 v[16:19], v[52:55], v[160:167], v1
    s_waitcnt lgkmcnt(10)
    v_mfma_f32_16x16x32_bf16 v[28:31], v[56:59], v[20:23], 0
    s_waitcnt lgkmcnt(8)
    v_mfma_f32_16x16x32_bf16 v[28:31], v[60:63], v[24:27], v[28:31]
    s_nop 0
    s_waitcnt lgkmcnt(6)
    v_cvt_pk_bf16_f32 v12, v12, v13
    v_cvt_pk_bf16_f32 v13, v14, v15
    v_mfma_f32_16x16x32_bf16 v[28:31], v[64:67], v[72:75], v[28:31]
    s_waitcnt lgkmcnt(4)
    v_cvt_pk_bf16_f32 v14, v16, v17
    v_cvt_pk_bf16_f32 v15, v18, v19
    v_mfma_f32_16x16x32_bf16 v[28:31], v[68:71], v[76:79], v[28:31]
    ds_write_b128 v0, v[12:15] offset:17408
    s_waitcnt lgkmcnt(4)
    v_mfma_f32_16x16x32_bf16 v[32:35], v[36:39], v[20:23], 0
    ds_read_b128 v[56:59], v3 offset:28928
    ds_read_b128 v[60:63], v3 offset:28992
    s_waitcnt lgkmcnt(5)
    v_mfma_f32_16x16x32_bf16 v[32:35], v[40:43], v[24:27], v[32:35]
    ds_read_b128 v[64:67], v3 offset:29056
    ds_read_b128 v[68:71], v3 offset:29120
    s_waitcnt lgkmcnt(6)
    v_mfma_f32_16x16x32_bf16 v[32:35], v[44:47], v[72:75], v[32:35]
    s_mov_b64 exec, s[36:37]
    v_exp_f32 v28, v28
    v_exp_f32 v29, v29
    s_mov_b64 exec, -1
    s_waitcnt lgkmcnt(5)
    v_mfma_f32_16x16x32_bf16 v[32:35], v[48:51], v[76:79], v[32:35]
    s_mov_b64 exec, s[36:37]
    v_exp_f32 v30, v30
    v_exp_f32 v31, v31
    s_mov_b64 exec, -1
    s_waitcnt lgkmcnt(4)
    s_barrier
    s_waitcnt lgkmcnt(3)
    v_mfma_f32_16x16x32_bf16 v[52:55], v[56:59], v[20:23], 0
    ds_read_b128 v[36:39], v0 offset:8192
    s_waitcnt lgkmcnt(3)
    v_cvt_pk_bf16_f32 v28, v28, v29
    v_cvt_pk_bf16_f32 v29, v30, v31
    v_mfma_f32_16x16x32_bf16 v[52:55], v[60:63], v[24:27], v[52:55]
    ds_read_b128 v[40:43], v0 offset:10240
    s_mov_b64 exec, s[36:37]
    v_exp_f32 v32, v32
    v_exp_f32 v33, v33
    s_mov_b64 exec, -1
    s_waitcnt lgkmcnt(3)
    v_mfma_f32_16x16x32_bf16 v[52:55], v[64:67], v[72:75], v[52:55]
    ds_read_b128 v[44:47], v0 offset:12288
    s_mov_b64 exec, s[36:37]
    v_exp_f32 v34, v34
    v_exp_f32 v35, v35
    s_mov_b64 exec, -1
    s_waitcnt lgkmcnt(3)
    v_mfma_f32_16x16x32_bf16 v[52:55], v[68:71], v[76:79], v[52:55]
    ds_read_b128 v[48:51], v0 offset:14336
    v_cvt_pk_bf16_f32 v30, v32, v33
    v_cvt_pk_bf16_f32 v31, v34, v35
    s_cmp_eq_u32 s57, 63
    s_cbranch_scc1 main_kernel_c1_1_last
    s_waitcnt lgkmcnt(3)
    v_mfma_f32_16x16x32_bf16 v[20:23], v[36:39], v[28:31], 0
    ds_read_b128 v[56:59], v0 offset:9216
    s_waitcnt lgkmcnt(3)
    v_mov_b32_dpp v32, v28 row_ror:8 row_mask:0xf bank_mask:0xf
    v_mov_b32_dpp v33, v29 row_ror:8 row_mask:0xf bank_mask:0xf
    v_mfma_f32_16x16x32_bf16 v[24:27], v[40:43], v[28:31], 0
    ds_read_b128 v[60:63], v0 offset:11264
    s_waitcnt lgkmcnt(3)
    v_mov_b32_dpp v34, v30 row_ror:8 row_mask:0xf bank_mask:0xf
    v_mov_b32_dpp v35, v31 row_ror:8 row_mask:0xf bank_mask:0xf
    v_mfma_f32_16x16x32_bf16 v[72:75], v[44:47], v[28:31], 0
    ds_read_b128 v[64:67], v0 offset:13312
    s_waitcnt lgkmcnt(3)
    v_mov_b64 v[16:17], s[24:25]
    v_mov_b64 v[18:19], s[24:25]
    v_mfma_f32_16x16x32_bf16 v[76:79], v[48:51], v[28:31], 0
    ds_read_b128 v[68:71], v0 offset:15360
    s_mov_b64 exec, s[36:37]
    v_exp_f32 v52, v52
    s_mov_b64 exec, -1
    v_mfma_f32_16x16x32_bf16 v[12:15], v[16:19], v[28:31], 0
    ds_read_b128 v[36:39], v0 offset:16384
    s_mov_b64 exec, s[36:37]
    v_exp_f32 v53, v53
    s_mov_b64 exec, -1
    s_waitcnt lgkmcnt(4)
    v_mfma_f32_16x16x32_bf16 v[20:23], v[56:59], v[32:35], v[20:23]
    ds_read_b128 v[40:43], v0 offset:17408
    s_mov_b64 exec, s[36:37]
    v_exp_f32 v54, v54
    s_mov_b64 exec, -1
    s_waitcnt lgkmcnt(4)
    v_mfma_f32_16x16x32_bf16 v[24:27], v[60:63], v[32:35], v[24:27]
    ds_read_b128 v[44:47], v0 offset:18432
    s_mov_b64 exec, s[36:37]
    v_exp_f32 v55, v55
    s_mov_b64 exec, -1
    s_waitcnt lgkmcnt(4)
    v_mfma_f32_16x16x32_bf16 v[72:75], v[64:67], v[32:35], v[72:75]
    ds_read_b128 v[48:51], v0 offset:19456
    s_waitcnt lgkmcnt(4)
    v_cvt_pk_bf16_f32 v52, v52, v53
    v_cvt_pk_bf16_f32 v53, v54, v55
    v_mfma_f32_16x16x32_bf16 v[76:79], v[68:71], v[32:35], v[76:79]
    v_mov_b64 v[10:11], s[16:17]
    v_mov_b32_dpp v54, v52 row_ror:8 row_mask:0xf bank_mask:0xf
main_kernel_c1_1_fin:
    s_waitcnt lgkmcnt(3)
    v_mfma_f32_16x16x16_bf16 v[20:23], v[36:37], v[52:53], v[20:23]
    v_mov_b32_dpp v55, v53 row_ror:8 row_mask:0xf bank_mask:0xf
    v_mov_b64 v[56:57], 0
    v_mfma_f32_16x16x16_bf16 v[12:15], v[10:11], v[52:53], v[12:15]
    s_waitcnt lgkmcnt(2)
    v_mov_b64 v[58:59], 0
    v_mov_b64 v[60:61], 0
    v_mfma_f32_16x16x16_bf16 v[24:27], v[40:41], v[52:53], v[24:27]
    v_mov_b64 v[62:63], 0
    v_mov_b64 v[64:65], 0
    v_mfma_f32_16x16x16_bf16 v[20:23], v[38:39], v[54:55], v[20:23]
    v_mov_b64 v[66:67], 0
    v_mov_b64 v[68:69], 0
    v_mfma_f32_16x16x16_bf16 v[24:27], v[42:43], v[54:55], v[24:27]
    s_waitcnt lgkmcnt(1)
    v_add_f32_dpp v12, v12, v12 row_ror:8 row_mask:0xf bank_mask:0xf
    v_mov_b64 v[70:71], 0
    v_mfma_f32_16x16x16_bf16 v[72:75], v[44:45], v[52:53], v[72:75]
    s_waitcnt lgkmcnt(0)
    v_rcp_f32 v14, v12
    v_mfma_f32_16x16x16_bf16 v[76:79], v[48:49], v[52:53], v[76:79]
    v_subrev_u32 v13, s68, v12
    v_cmp_lt_u32 vcc, s69, v13
    v_mfma_f32_16x16x16_bf16 v[72:75], v[46:47], v[54:55], v[72:75]
    s_cbranch_vccnz main_kernel_c1_1_zbad
main_kernel_c1_1_zok:
    v_mov_b64 v[28:29], 0
    v_mov_b64 v[30:31], 0
    v_mfma_f32_16x16x16_bf16 v[76:79], v[50:51], v[54:55], v[76:79]
    v_mul_f32 v20, v20, v14
    v_mul_f32 v21, v21, v14
    v_mul_f32 v22, v22, v14
    v_mul_f32 v23, v23, v14
    v_mul_f32 v24, v24, v14
    v_mul_f32 v25, v25, v14
    v_mul_f32 v26, v26, v14
    v_mul_f32 v27, v27, v14
    v_cvt_pk_bf16_f32 v20, v20, v21
    v_cvt_pk_bf16_f32 v21, v22, v23
    v_cvt_pk_bf16_f32 v22, v24, v25
    v_cvt_pk_bf16_f32 v23, v26, v27
    v_mul_f32 v72, v72, v14
    v_mul_f32 v73, v73, v14
    v_smfmac_f32_16x16x64_bf16 v[56:59], v[20:23], v[152:159], v1
    v_mul_f32 v74, v74, v14
    v_mul_f32 v75, v75, v14
    v_mul_f32 v76, v76, v14
    v_smfmac_f32_16x16x64_bf16 v[60:63], v[20:23], v[136:143], v1
    v_mul_f32 v77, v77, v14
    v_mul_f32 v78, v78, v14
    v_mul_f32 v79, v79, v14
    v_smfmac_f32_16x16x64_bf16 v[64:67], v[20:23], v[120:127], v1
    v_cvt_pk_bf16_f32 v72, v72, v73
    v_cvt_pk_bf16_f32 v73, v74, v75
    v_cvt_pk_bf16_f32 v74, v76, v77
    v_smfmac_f32_16x16x64_bf16 v[68:71], v[20:23], v[104:111], v1
    v_cvt_pk_bf16_f32 v75, v78, v79
    v_smfmac_f32_16x16x64_bf16 v[28:31], v[20:23], v[88:95], v1
    s_nop 0
    v_smfmac_f32_16x16x64_bf16 v[56:59], v[72:75], v[144:151], v1
    s_waitcnt vmcnt(0)
    v_smfmac_f32_16x16x64_bf16 v[60:63], v[72:75], v[128:135], v1
    v_smfmac_f32_16x16x64_bf16 v[64:67], v[72:75], v[112:119], v1
    v_mov_b32 v5, v5
    v_mov_b32 v5, v5
    v_mov_b32 v5, v5
    v_permlane32_swap_b32 v56, v57
    v_smfmac_f32_16x16x64_bf16 v[68:71], v[72:75], v[96:103], v1
    v_permlane32_swap_b32 v58, v59
    v_smfmac_f32_16x16x64_bf16 v[28:31], v[72:75], v[80:87], v1
    v_add_f32 v56, v56, v57
    v_add_f32 v58, v58, v59
    v_permlane32_swap_b32 v60, v61
    v_permlane32_swap_b32 v62, v63
    v_add_f32 v60, v60, v61
    v_add_f32 v62, v62, v63
    v_cvt_pk_bf16_f32 v36, v56, v60
    v_cvt_pk_bf16_f32 v38, v58, v62
    v_permlane32_swap_b32 v64, v65
    v_permlane32_swap_b32 v66, v67
    v_add_f32 v64, v64, v65
    v_add_f32 v66, v66, v67
    v_permlane32_swap_b32 v68, v69
    v_permlane32_swap_b32 v70, v71
    v_add_f32 v68, v68, v69
    v_add_f32 v70, v70, v71
    v_cvt_pk_bf16_f32 v37, v64, v68
    v_cvt_pk_bf16_f32 v39, v66, v70
    buffer_store_dwordx4 v[36:39], v0, s[8:11], s56 offen sc1
    v_permlane32_swap_b32 v28, v29
    v_permlane32_swap_b32 v30, v31
    v_add_f32 v28, v28, v29
    v_add_f32 v30, v30, v31
    v_cvt_pk_bf16_f32 v28, v28, v30
    buffer_store_dword v28, v7, s[8:11], s55 offen sc1
    v_bfe_u32 v34, v0, 4, 1
    v_bfe_u32 v33, v0, 7, 1
    v_lshl_add_u32 v33, v33, 1, v34
    v_bfe_u32 v32, v0, 6, 1
    v_lshlrev_b32 v32, 4, v32
    v_lshlrev_b32_e64 v32, v32, s45
    v_cmp_eq_u32_e64 s[64:65], 0, v33
    v_cmp_eq_u32_e64 s[66:67], 1, v33
    s_add_u32 s27, s44, 1
    s_and_b32 s27, s27, 3
    v_cndmask_b32_e64 v72, 0, v32, s[64:65]
    v_cndmask_b32_e64 v73, 0, v32, s[66:67]
    v_cmp_eq_u32_e64 s[64:65], 2, v33
    v_cmp_eq_u32_e64 s[66:67], 3, v33
    s_mul_i32 s48, s27, 5120
    s_add_u32 s48, s48, s41
    v_cndmask_b32_e64 v74, 0, v32, s[64:65]
    v_cndmask_b32_e64 v75, 0, v32, s[66:67]
    s_lshl_b32 s27, s27, 15
    s_add_u32 s49, s27, s47
    v_bfe_u32 v32, v0, 8, 1
    v_lshlrev_b32 v11, 6, v32
    v_lshl_add_u32 v11, v34, 3, v11
    v_lshrrev_b32 v33, 9, v0
    v_lshl_add_u32 v11, v33, 2, v11
    s_add_u32 s56, s27, s46
    s_add_u32 s56, s56, s33
    s_add_u32 s58, s48, s33
    v_mov_b32 v5, v5
    s_nop 1
    v_mov_b32 v5, v5
    s_nop 1
    v_mov_b32 v5, v5
    s_nop 1
    v_mov_b32 v5, v5
    s_nop 1
    v_mov_b32 v5, v5
    s_nop 1
    v_mov_b32 v5, v5
    s_nop 1
    v_mov_b32 v5, v5
    s_nop 1
    v_mov_b32 v5, v5
    s_nop 1
    buffer_load_dwordx4 v[40:43], v0, s[8:11], s43 offen sc1
    v_mov_b32 v5, v5
    s_nop 1
    v_mov_b32 v5, v5
    s_nop 1
    v_mov_b32 v5, v5
    s_nop 1
    v_mov_b32 v5, v5
    s_nop 1
    v_mov_b32 v5, v5
    s_nop 1
    v_mov_b32 v5, v5
    s_nop 1
    v_mov_b32 v5, v5
    s_nop 1
    v_mov_b32 v5, v5
    s_nop 1
    v_mov_b32 v5, v5
    s_nop 1
    v_mov_b32 v5, v5
    s_nop 1
    v_mov_b32 v5, v5
    s_nop 1
    v_mov_b32 v5, v5
    s_nop 1
    v_mov_b32 v5, v5
    v_mov_b32 v5, v5
    buffer_load_dwordx4 v[44:47], v0, s[8:11], s43 offen sc1
    v_mov_b32 v5, v5
    s_nop 1
    v_mov_b32 v5, v5
    s_nop 1
    s_waitcnt vmcnt(1)
    v_mov_b32 v5, v5
    v_mov_b32 v5, v5
    v_mfma_f32_16x16x32_bf16 v[76:79], v[72:75], v[40:43], 0
    v_cmp_eq_u32 vcc, -1, v40
    s_cbranch_vccnz main_kernel_c1_1_wrb_i0
    v_mov_b32 v5, v5
    v_mov_b32 v5, v5
    v_mov_b32 v5, v5
    v_mov_b32 v5, v5
    v_mov_b32 v5, v5
    v_mov_b32 v5, v5
    v_add_f32_dpp v76, v76, v76 row_ror:8 row_mask:0xf bank_mask:0xf
    v_add_f32_dpp v77, v77, v77 row_ror:8 row_mask:0xf bank_mask:0xf
    s_nop 0
    v_add_f32_dpp v76, v76, v76 row_ror:4 row_mask:0xf bank_mask:0xf
    v_add_f32_dpp v77, v77, v77 row_ror:4 row_mask:0xf bank_mask:0xf
    s_nop 0
    v_add_f32_dpp v76, v76, v76 row_ror:2 row_mask:0xf bank_mask:0xf
    v_add_f32_dpp v77, v77, v77 row_ror:2 row_mask:0xf bank_mask:0xf
    v_cmp_u_f32 vcc, v76, v76
    v_cvt_pk_bf16_f32 v76, v76, v77
    s_cbranch_vccnz main_kernel_c1_1_wrb_e0
    s_mov_b64 exec, s[62:63]
    buffer_store_dword v76, v11, s[8:11], s58 offen sc1
main_kernel_c1_1_wrb_d:
    s_barrier
    buffer_store_dword v76, v11, s[8:11], s56 offen sc1
    s_mov_b64 exec, -1
    s_waitcnt vmcnt(2)
    ds_read_b128 v[56:59], v5 offset:0
    ds_read_b128 v[60:63], v5 offset:1024
    ds_read_b128 v[64:67], v5 offset:2048
    ds_read_b128 v[68:71], v5 offset:3072
    v_mov_b64 v[12:13], 0
    v_mov_b64 v[14:15], 0
    v_mov_b64 v[16:17], 0
    v_mov_b64 v[18:19], 0
    v_mov_b64 v[20:21], 0
    v_mov_b64 v[22:23], 0
    v_mov_b64 v[24:25], 0
    v_mov_b64 v[26:27], 0
    v_mov_b64 v[28:29], 0
    v_mov_b64 v[30:31], 0
    v_mov_b64 v[32:33], 0
    v_mov_b64 v[34:35], 0
    v_mov_b64 v[72:73], -1
    v_mov_b64 v[74:75], -1
    s_add_u32 s28, s44, 3
    s_and_b32 s29, s28, 3
    s_mul_i32 s31, s22, 160
    s_mul_i32 s28, s29, 167936
    s_add_u32 s28, s28, s34
    s_add_u32 s64, s28, s35
    s_add_u32 s65, s28, s32
    s_lshl_b32 s60, s29, 15
    s_add_u32 s60, s60, s47
    s_add_u32 s60, s60, s31
    s_and_b32 s26, s44, 63
    s_add_u32 s26, s26, 1
    s_min_u32 s26, s26, 63
    s_lshl_b32 s26, s26, 18
    s_add_u32 s26, s26, s50
    s_nop 15
    s_nop 15
    s_nop 9
    s_mov_b32 m0, 21504
    s_nop 0
    buffer_load_dwordx4 v0, s[8:11], s48 offen offset:0 sc1 lds
    buffer_load_dwordx4 v0, s[8:11], s48 offen offset:1024 sc1 lds
    buffer_load_dwordx4 v0, s[8:11], s48 offen offset:2048 sc1 lds
    buffer_load_dwordx4 v0, s[8:11], s48 offen offset:3072 sc1 lds
    s_mov_b32 m0, 25600
    s_add_u32 s59, s48, 4096
    buffer_load_dwordx4 v0, s[8:11], s59 offen offset:0 sc1 lds
    s_add_u32 s44, s44, 1
    s_mov_b32 s70, 0
    s_waitcnt lgkmcnt(0)
    s_branch main_kernel_c1_1_top
main_kernel_c1_1_restart:
    s_waitcnt vmcnt(0) lgkmcnt(0)
    s_nop 7
    s_barrier
    ds_read_b128 v[56:59], v5 offset:0
    ds_read_b128 v[60:63], v5 offset:1024
    ds_read_b128 v[64:67], v5 offset:2048
    ds_read_b128 v[68:71], v5 offset:3072
    v_mov_b64 v[12:13], 0
    v_mov_b64 v[14:15], 0
    v_mov_b64 v[16:17], 0
    v_mov_b64 v[18:19], 0
    v_mov_b64 v[20:21], 0
    v_mov_b64 v[22:23], 0
    v_mov_b64 v[24:25], 0
    v_mov_b64 v[26:27], 0
    v_mov_b64 v[28:29], 0
    v_mov_b64 v[30:31], 0
    v_mov_b64 v[32:33], 0
    v_mov_b64 v[34:35], 0
    s_waitcnt vmcnt(0) lgkmcnt(0)
    s_branch main_kernel_c1_1_top
main_kernel_c1_1_zbad:
    s_cmp_eq_u32 s70, 2
    s_cbranch_scc1 main_kernel_c1_1_zok
    v_cmp_u_f32 vcc, v12, v12
    s_cbranch_vccz main_kernel_c1_1_exact
    s_cmp_eq_u32 s70, 1
    s_cbranch_scc1 main_kernel_c1_1_exact
main_kernel_c1_1_vfy0:
    s_mov_b32 s70, 1
    s_mov_b32 s30, 0
    s_waitcnt vmcnt(0) lgkmcnt(0)
    s_nop 7
main_kernel_c1_1_vfy:
    v_mov_b32 v10, 0
    s_add_u32 s59, s48, 4096
    buffer_load_dwordx4 v[36:39], v0, s[8:11], s48 offen offset:0 sc1
    buffer_load_dwordx4 v[40:43], v0, s[8:11], s48 offen offset:1024 sc1
    buffer_load_dwordx4 v[44:47], v0, s[8:11], s48 offen offset:2048 sc1
    buffer_load_dwordx4 v[48:51], v0, s[8:11], s48 offen offset:3072 sc1
    buffer_load_dwordx4 v[52:55], v0, s[8:11], s59 offen offset:0 sc1
    s_waitcnt vmcnt(4)
    v_max3_u32 v10, v10, v36, v37
    v_max3_u32 v10, v10, v38, v39
    s_waitcnt vmcnt(3)
    v_max3_u32 v10, v10, v40, v41
    v_max3_u32 v10, v10, v42, v43
    s_waitcnt vmcnt(2)
    v_max3_u32 v10, v10, v44, v45
    v_max3_u32 v10, v10, v46, v47
    s_waitcnt vmcnt(1)
    v_max3_u32 v10, v10, v48, v49
    v_max3_u32 v10, v10, v50, v51
    s_waitcnt vmcnt(0)
    v_max3_u32 v10, v10, v52, v53
    v_max3_u32 v10, v10, v54, v55
    s_add_u32 s59, s49, 4096
    buffer_load_dwordx4 v[36:39], v0, s[8:11], s49 offen offset:0 sc1
    buffer_load_dwordx4 v[40:43], v0, s[8:11], s49 offen offset:1024 sc1
    buffer_load_dwordx4 v[44:47], v0, s[8:11], s49 offen offset:2048 sc1
    buffer_load_dwordx4 v[48:51], v0, s[8:11], s49 offen offset:3072 sc1
    buffer_load_dwordx4 v[52:55], v0, s[8:11], s59 offen offset:0 sc1
    s_waitcnt vmcnt(4)
    v_max3_u32 v10, v10, v36, v37
    v_max3_u32 v10, v10, v38, v39
    s_waitcnt vmcnt(3)
    v_max3_u32 v10, v10, v40, v41
    v_max3_u32 v10, v10, v42, v43
    s_waitcnt vmcnt(2)
    v_max3_u32 v10, v10, v44, v45
    v_max3_u32 v10, v10, v46, v47
    s_waitcnt vmcnt(1)
    v_max3_u32 v10, v10, v48, v49
    v_max3_u32 v10, v10, v50, v51
    s_waitcnt vmcnt(0)
    v_max3_u32 v10, v10, v52, v53
    v_max3_u32 v10, v10, v54, v55
    v_cmp_eq_u32 vcc, -1, v10
    s_cbranch_vccz main_kernel_c1_1_restart
    s_add_u32 s30, s30, 1
    s_cmp_ge_u32 s30, 60000
    s_cbranch_scc1 main_kernel_fail
    s_branch main_kernel_c1_1_vfy
main_kernel_c1_1_exact:
    s_nop 7
    s_mov_b32 s70, 2
    ds_read_b128 v[20:23], v3 offset:26624
    ds_read_b128 v[24:27], v3 offset:26688
    ds_read_b128 v[72:75], v3 offset:26752
    ds_read_b128 v[76:79], v3 offset:26816
    ds_read_b128 v[56:59], v0 offset:0
    s_waitcnt lgkmcnt(0)
    v_mfma_f32_16x16x32_bf16 v[28:31], v[56:59], v[20:23], 0
    s_nop 3
    ds_read_b128 v[60:63], v0 offset:1024
    s_waitcnt lgkmcnt(0)
    v_mfma_f32_16x16x32_bf16 v[28:31], v[60:63], v[24:27], v[28:31]
    s_nop 3
    ds_read_b128 v[56:59], v0 offset:2048
    s_waitcnt lgkmcnt(0)
    v_mfma_f32_16x16x32_bf16 v[28:31], v[56:59], v[72:75], v[28:31]
    s_nop 3
    ds_read_b128 v[60:63], v0 offset:3072
    s_waitcnt lgkmcnt(0)
    v_mfma_f32_16x16x32_bf16 v[28:31], v[60:63], v[76:79], v[28:31]
    s_nop 3
    ds_read_b128 v[56:59], v0 offset:4096
    s_waitcnt lgkmcnt(0)
    v_mfma_f32_16x16x32_bf16 v[32:35], v[56:59], v[20:23], 0
    s_nop 3
    ds_read_b128 v[60:63], v0 offset:5120
    s_waitcnt lgkmcnt(0)
    v_mfma_f32_16x16x32_bf16 v[32:35], v[60:63], v[24:27], v[32:35]
    s_nop 3
    ds_read_b128 v[56:59], v0 offset:6144
    s_waitcnt lgkmcnt(0)
    v_mfma_f32_16x16x32_bf16 v[32:35], v[56:59], v[72:75], v[32:35]
    s_nop 3
    ds_read_b128 v[60:63], v0 offset:7168
    s_waitcnt lgkmcnt(0)
    v_mfma_f32_16x16x32_bf16 v[32:35], v[60:63], v[76:79], v[32:35]
    s_nop 3
    ds_read_b128 v[56:59], v3 offset:28928
    s_waitcnt lgkmcnt(0)
    v_mfma_f32_16x16x32_bf16 v[52:55], v[56:59], v[20:23], 0
    s_nop 3
    ds_read_b128 v[60:63], v3 offset:28992
    s_waitcnt lgkmcnt(0)
    v_mfma_f32_16x16x32_bf16 v[52:55], v[60:63], v[24:27], v[52:55]
    s_nop 3
    ds_read_b128 v[56:59], v3 offset:29056
    s_waitcnt lgkmcnt(0)
    v_mfma_f32_16x16x32_bf16 v[52:55], v[56:59], v[72:75], v[52:55]
    s_nop 3
    ds_read_b128 v[60:63], v3 offset:29120
    s_waitcnt lgkmcnt(0)
    v_mfma_f32_16x16x32_bf16 v[52:55], v[60:63], v[76:79], v[52:55]
    s_nop 3
    v_max3_f32 v64, v28, v29, v30
    v_max3_f32 v64, v64, v31, v32
    v_max3_f32 v64, v64, v33, v34
    s_nop 0
    v_max3_f32 v64, v64, v35, v52
    v_max3_f32 v64, v64, v53, v54
    v_max_f32 v64, v64, v55
    v_mov_b32 v65, v64
    s_nop 1
    v_permlane16_swap_b32 v64, v65
    v_max_f32 v64, v64, v65
    v_mov_b32 v65, v64
    s_nop 1
    v_permlane32_swap_b32 v64, v65
    v_max_f32 v64, v64, v65
    v_sub_f32 v28, v28, v64
    v_exp_f32 v28, v28
    s_nop 0
    v_cndmask_b32_e64 v28, 0, v28, s[36:37]
    v_sub_f32 v29, v29, v64
    v_exp_f32 v29, v29
    s_nop 0
    v_cndmask_b32_e64 v29, 0, v29, s[36:37]
    v_sub_f32 v30, v30, v64
    v_exp_f32 v30, v30
    s_nop 0
    v_cndmask_b32_e64 v30, 0, v30, s[36:37]
    v_sub_f32 v31, v31, v64
    v_exp_f32 v31, v31
    s_nop 0
    v_cndmask_b32_e64 v31, 0, v31, s[36:37]
    v_sub_f32 v32, v32, v64
    v_exp_f32 v32, v32
    s_nop 0
    v_cndmask_b32_e64 v32, 0, v32, s[36:37]
    v_sub_f32 v33, v33, v64
    v_exp_f32 v33, v33
    s_nop 0
    v_cndmask_b32_e64 v33, 0, v33, s[36:37]
    v_sub_f32 v34, v34, v64
    v_exp_f32 v34, v34
    s_nop 0
    v_cndmask_b32_e64 v34, 0, v34, s[36:37]
    v_sub_f32 v35, v35, v64
    v_exp_f32 v35, v35
    s_nop 0
    v_cndmask_b32_e64 v35, 0, v35, s[36:37]
    v_sub_f32 v52, v52, v64
    v_exp_f32 v52, v52
    s_nop 0
    v_cndmask_b32_e64 v52, 0, v52, s[36:37]
    v_sub_f32 v53, v53, v64
    v_exp_f32 v53, v53
    s_nop 0
    v_cndmask_b32_e64 v53, 0, v53, s[36:37]
    v_sub_f32 v54, v54, v64
    v_exp_f32 v54, v54
    s_nop 0
    v_cndmask_b32_e64 v54, 0, v54, s[36:37]
    v_sub_f32 v55, v55, v64
    v_exp_f32 v55, v55
    s_nop 0
    v_cndmask_b32_e64 v55, 0, v55, s[36:37]
    v_cvt_pk_bf16_f32 v28, v28, v29
    v_cvt_pk_bf16_f32 v29, v30, v31
    v_cvt_pk_bf16_f32 v30, v32, v33
    v_cvt_pk_bf16_f32 v31, v34, v35
    v_mov_b32_dpp v32, v28 row_ror:8 row_mask:0xf bank_mask:0xf
    v_mov_b32_dpp v33, v29 row_ror:8 row_mask:0xf bank_mask:0xf
    v_mov_b32_dpp v34, v30 row_ror:8 row_mask:0xf bank_mask:0xf
    v_mov_b32_dpp v35, v31 row_ror:8 row_mask:0xf bank_mask:0xf
    v_cvt_pk_bf16_f32 v52, v52, v53
    v_cvt_pk_bf16_f32 v53, v54, v55
    s_nop 0
    v_mov_b32_dpp v54, v52 row_ror:8 row_mask:0xf bank_mask:0xf
    v_mfma_f32_16x16x32_bf16 v[12:15], v[16:19], v[28:31], 0
    ds_read_b128 v[56:59], v0 offset:8192
    s_waitcnt lgkmcnt(0)
    v_mfma_f32_16x16x32_bf16 v[20:23], v[56:59], v[28:31], 0
    s_nop 3
    ds_read_b128 v[60:63], v0 offset:9216
    s_waitcnt lgkmcnt(0)
    v_mfma_f32_16x16x32_bf16 v[20:23], v[60:63], v[32:35], v[20:23]
    s_nop 3
    ds_read_b128 v[56:59], v0 offset:10240
    s_waitcnt lgkmcnt(0)
    v_mfma_f32_16x16x32_bf16 v[24:27], v[56:59], v[28:31], 0
    s_nop 3
    ds_read_b128 v[60:63], v0 offset:11264
    s_waitcnt lgkmcnt(0)
    v_mfma_f32_16x16x32_bf16 v[24:27], v[60:63], v[32:35], v[24:27]
    s_nop 3
    ds_read_b128 v[56:59], v0 offset:12288
    s_waitcnt lgkmcnt(0)
    v_mfma_f32_16x16x32_bf16 v[72:75], v[56:59], v[28:31], 0
    s_nop 3
    ds_read_b128 v[60:63], v0 offset:13312
    s_waitcnt lgkmcnt(0)
    v_mfma_f32_16x16x32_bf16 v[72:75], v[60:63], v[32:35], v[72:75]
    s_nop 3
    ds_read_b128 v[56:59], v0 offset:14336
    s_waitcnt lgkmcnt(0)
    v_mfma_f32_16x16x32_bf16 v[76:79], v[56:59], v[28:31], 0
    s_nop 3
    ds_read_b128 v[60:63], v0 offset:15360
    s_waitcnt lgkmcnt(0)
    v_mfma_f32_16x16x32_bf16 v[76:79], v[60:63], v[32:35], v[76:79]
    s_nop 3
    s_nop 7
    s_branch main_kernel_c1_1_fin
main_kernel_c1_1_last:
    s_cmp_lg_u32 s70, 0
    s_cbranch_scc1 main_kernel_c1_1_last2
    v_cmp_u_f32 vcc, v32, v32
    s_cbranch_vccnz main_kernel_c1_1_vfy0
main_kernel_c1_1_last2:
    s_waitcnt vmcnt(0) lgkmcnt(0)
    s_barrier
    v_mov_b32 v11, 8192
    s_mov_b64 exec, 1
    buffer_store_dword v11, v0, s[8:11], s52 offen sc1
    s_mov_b64 exec, -1
    s_add_u32 s52, s52, 4096
    s_nop 7
    v_mov_b64 v[72:73], -1
    v_mov_b64 v[74:75], -1
    s_add_u32 s28, s44, 3
    s_and_b32 s29, s28, 3
    s_mul_i32 s31, s22, 160
    s_mul_i32 s28, s29, 167936
    s_add_u32 s28, s28, s34
    s_add_u32 s64, s28, s35
    s_add_u32 s65, s28, s32
    s_lshl_b32 s60, s29, 15
    s_add_u32 s60, s60, s47
    s_add_u32 s60, s60, s31
    buffer_store_dwordx4 v[72:75], v0, s[8:11], s64 offen offset:1024 sc1
    buffer_store_dwordx4 v[72:75], v0, s[8:11], s64 offen offset:2048 sc1
    buffer_store_dwordx4 v[72:75], v0, s[8:11], s65 offen sc1
    s_mov_b32 s65, 0x10000000
    s_mov_b32 s64, 0x10000000
    s_mov_b64 exec, 0x3ff
    buffer_store_dwordx4 v[72:75], v0, s[8:11], s60 offen sc1
    s_mov_b64 exec, -1
    s_mov_b32 s60, 0x10000000
    s_waitcnt vmcnt(0)
    s_add_u32 s44, s44, 1
    s_cmp_eq_u32 s44, 128
    s_cbranch_scc1 main_kernel_end
    s_branch main_kernel_c1_1_layer
main_kernel_c1_1_lr:
    s_mov_b32 s30, 0
main_kernel_c1_1_lr_l:
    s_waitcnt lgkmcnt(0)
    ds_read_b128 v[36:39], v6 offset:21504
    ds_read_b128 v[40:43], v6 offset:22528
    ds_read_b128 v[44:47], v6 offset:23552
    ds_read_b128 v[48:51], v6 offset:24576
    ds_read_b128 v[52:55], v6 offset:25600
    s_waitcnt lgkmcnt(2)
    v_max3_u32 v10, v36, v40, v44
    s_waitcnt lgkmcnt(0)
    v_max3_u32 v10, v10, v48, v52
    v_cmp_eq_u32 vcc, -1, v10
    s_cbranch_vccz main_kernel_c1_1_lr_d
    s_add_u32 s30, s30, 1
    s_cmp_ge_u32 s30, 480000
    s_cbranch_scc1 main_kernel_fail
    s_branch main_kernel_c1_1_lr_l
main_kernel_c1_1_lr_d:
    ds_read_b128 v[56:59], v5 offset:0
    ds_read_b128 v[60:63], v5 offset:1024
    ds_read_b128 v[64:67], v5 offset:2048
    ds_read_b128 v[68:71], v5 offset:3072
    v_mov_b64 v[12:13], 0
    v_mov_b64 v[14:15], 0
    v_mov_b64 v[16:17], 0
    v_mov_b64 v[18:19], 0
    v_mov_b64 v[20:21], 0
    v_mov_b64 v[22:23], 0
    v_mov_b64 v[24:25], 0
    v_mov_b64 v[26:27], 0
    v_mov_b64 v[28:29], 0
    v_mov_b64 v[30:31], 0
    v_mov_b64 v[32:33], 0
    v_mov_b64 v[34:35], 0
    s_waitcnt lgkmcnt(0)
    s_branch main_kernel_c1_1_lr_r
main_kernel_c1_1_rr:
    s_mov_b32 s30, 0
main_kernel_c1_1_rr_l:
    s_waitcnt lgkmcnt(0)
    s_and_b32 s27, s30, 1
    s_cbranch_scc1 main_kernel_c1_1_rr_n
    s_waitcnt vmcnt(1)
    s_mov_b32 m0, 16384
    s_nop 0
    buffer_load_dwordx4 v0, s[8:11], s49 offen offset:2048 sc1 lds
main_kernel_c1_1_rr_n:
    ds_read_b128 v[36:39], v6 offset:16384
    ds_read_b128 v[40:43], v6 offset:17408
    ds_read_b128 v[44:47], v6 offset:18432
    ds_read_b128 v[48:51], v6 offset:19456
    ds_read_b32 v11, v6 offset:20480
    s_waitcnt lgkmcnt(2)
    v_max3_u32 v10, v36, v40, v44
    s_waitcnt lgkmcnt(0)
    v_max3_u32 v10, v10, v48, v11
    v_cmp_eq_u32 vcc, -1, v10
    s_cbranch_vccz main_kernel_c1_1_rr_d
    s_add_u32 s30, s30, 1
    s_cmp_ge_u32 s30, 480000
    s_cbranch_scc1 main_kernel_fail
    s_branch main_kernel_c1_1_rr_l
main_kernel_c1_1_rr_d:
    s_branch main_kernel_c1_1_rr_r
main_kernel_c1_1_wrb_l:
    s_waitcnt vmcnt(1)
    v_mfma_f32_16x16x32_bf16 v[76:79], v[72:75], v[40:43], 0
    v_cmp_eq_u32 vcc, -1, v40
    s_cbranch_vccz main_kernel_c1_1_wrb_x0
main_kernel_c1_1_wrb_i0:
    buffer_load_dwordx4 v[40:43], v0, s[8:11], s43 offen sc1
    s_waitcnt vmcnt(1)
    v_mfma_f32_16x16x32_bf16 v[76:79], v[72:75], v[44:47], 0
    v_cmp_eq_u32 vcc, -1, v44
    s_cbranch_vccz main_kernel_c1_1_wrb_x1
main_kernel_c1_1_wrb_i1:
    buffer_load_dwordx4 v[44:47], v0, s[8:11], s43 offen sc1
    s_add_u32 s71, s71, 1
    s_cmp_lt_u32 s71, 240000
    s_cbranch_scc1 main_kernel_c1_1_wrb_l
    s_branch main_kernel_fail
main_kernel_c1_1_wrb_x0:
    s_nop 5
    v_add_f32_dpp v76, v76, v76 row_ror:8 row_mask:0xf bank_mask:0xf
    v_add_f32_dpp v77, v77, v77 row_ror:8 row_mask:0xf bank_mask:0xf
    s_nop 0
    v_add_f32_dpp v76, v76, v76 row_ror:4 row_mask:0xf bank_mask:0xf
    v_add_f32_dpp v77, v77, v77 row_ror:4 row_mask:0xf bank_mask:0xf
    s_nop 0
    v_add_f32_dpp v76, v76, v76 row_ror:2 row_mask:0xf bank_mask:0xf
    v_add_f32_dpp v77, v77, v77 row_ror:2 row_mask:0xf bank_mask:0xf
    v_cmp_u_f32 vcc, v76, v76
    v_cvt_pk_bf16_f32 v76, v76, v77
    s_cbranch_vccz main_kernel_c1_1_wrb_n
main_kernel_c1_1_wrb_e0:
    v_max3_u32 v32, v40, v41, v42
    v_max_u32 v32, v32, v43
    v_cmp_eq_u32 vcc, -1, v32
    s_cbranch_vccnz main_kernel_c1_1_wrb_i0
    v_min_u32 v76, -2, v76
    v_min_u32 v77, -2, v77
    s_branch main_kernel_c1_1_wrb_n
main_kernel_c1_1_wrb_x1:
    s_nop 5
    v_add_f32_dpp v76, v76, v76 row_ror:8 row_mask:0xf bank_mask:0xf
    v_add_f32_dpp v77, v77, v77 row_ror:8 row_mask:0xf bank_mask:0xf
    s_nop 0
    v_add_f32_dpp v76, v76, v76 row_ror:4 row_mask:0xf bank_mask:0xf
    v_add_f32_dpp v77, v77, v77 row_ror:4 row_mask:0xf bank_mask:0xf
    s_nop 0
    v_add_f32_dpp v76, v76, v76 row_ror:2 row_mask:0xf bank_mask:0xf
    v_add_f32_dpp v77, v77, v77 row_ror:2 row_mask:0xf bank_mask:0xf
    v_cmp_u_f32 vcc, v76, v76
    v_cvt_pk_bf16_f32 v76, v76, v77
    s_cbranch_vccz main_kernel_c1_1_wrb_n
main_kernel_c1_1_wrb_e1:
    v_max3_u32 v32, v44, v45, v46
    v_max_u32 v32, v32, v47
    v_cmp_eq_u32 vcc, -1, v32
    s_cbranch_vccnz main_kernel_c1_1_wrb_i1
    v_min_u32 v76, -2, v76
    v_min_u32 v77, -2, v77
main_kernel_c1_1_wrb_n:
    s_mov_b64 exec, s[62:63]
    buffer_store_dword v76, v11, s[8:11], s58 offen sc1
    s_branch main_kernel_c1_1_wrb_d
main_kernel_c1_2_layer:
    s_lshr_b32 s27, s44, 6
    s_mul_i32 s50, s27, 33554432
    s_lshl_b32 s27, s22, 13
    s_add_u32 s50, s50, s27
    s_add_u32 s50, s50, 37748736
    s_barrier
    s_and_b32 s26, s44, 63
    s_lshl_b32 s26, s26, 18
    s_add_u32 s26, s26, s50
    s_mul_i32 s27, s20, 5120
    s_add_u32 s48, s27, 167772160
    s_sub_u32 s49, 167777280, s27
    s_mov_b32 m0, 21504
    s_nop 0
    buffer_load_dwordx4 v0, s[8:11], s48 offen offset:0 sc1 lds
    buffer_load_dwordx4 v0, s[8:11], s48 offen offset:1024 sc1 lds
    buffer_load_dwordx4 v0, s[8:11], s48 offen offset:2048 sc1 lds
    ds_read_b128 v[56:59], v5 offset:0
    ds_read_b128 v[60:63], v5 offset:1024
    ds_read_b128 v[64:67], v5 offset:2048
    ds_read_b128 v[68:71], v5 offset:3072
    v_mov_b64 v[12:13], 0
    v_mov_b64 v[14:15], 0
    v_mov_b64 v[16:17], 0
    v_mov_b64 v[18:19], 0
    v_mov_b64 v[20:21], 0
    v_mov_b64 v[22:23], 0
    v_mov_b64 v[24:25], 0
    v_mov_b64 v[26:27], 0
    v_mov_b64 v[28:29], 0
    v_mov_b64 v[30:31], 0
    v_mov_b64 v[32:33], 0
    v_mov_b64 v[34:35], 0
    s_mov_b32 s70, 0
    s_waitcnt vmcnt(0) lgkmcnt(0)
main_kernel_c1_2_top:
    s_barrier
    ds_read_b128 v[36:39], v6 offset:21504
    ds_read_b128 v[40:43], v6 offset:22528
    ds_read_b128 v[44:47], v6 offset:23552
    ds_read_b128 v[48:51], v6 offset:24576
    ds_read_b128 v[52:55], v6 offset:25600
    s_mov_b32 m0, 16384
    s_nop 0
    buffer_load_dwordx4 v0, s[8:11], s49 offen offset:3072 sc1 lds
main_kernel_c1_2_lr_r:
    s_waitcnt lgkmcnt(4)
    v_smfmac_f32_16x16x64_bf16 v[20:23], v[36:39], v[56:63], v1
    ds_read_b128 v[56:59], v5 offset:4096
    v_smfmac_f32_16x16x64_bf16 v[24:27], v[36:39], a[248:255], v1
    ds_read_b128 v[60:63], v5 offset:5120
    v_smfmac_f32_16x16x64_bf16 v[28:31], v[36:39], a[240:247], v1
    v_smfmac_f32_16x16x64_bf16 v[32:35], v[36:39], v[64:71], v1
    ds_read_b128 v[64:67], v5 offset:6144
    v_smfmac_f32_16x16x64_bf16 v[12:15], v[36:39], a[232:239], v1
    ds_read_b128 v[68:71], v5 offset:7168
    s_waitcnt lgkmcnt(6)
    v_max3_u32 v10, v36, v40, v44
    v_smfmac_f32_16x16x64_bf16 v[16:19], v[36:39], a[224:231], v1
    s_waitcnt lgkmcnt(4)
    s_waitcnt lgkmcnt(2)
    v_max3_u32 v10, v10, v48, v52
    v_smfmac_f32_16x16x64_bf16 v[20:23], v[40:43], v[56:63], v1
    ds_read_b128 v[56:59], v5 offset:8192
    v_cmp_eq_u32 vcc, -1, v10
    v_smfmac_f32_16x16x64_bf16 v[24:27], v[40:43], a[216:223], v1
    ds_read_b128 v[60:63], v5 offset:9216
    s_cbranch_vccnz main_kernel_c1_2_lr
    v_smfmac_f32_16x16x64_bf16 v[28:31], v[40:43], a[208:215], v1
    s_and_b32 s55, s44, 3
    s_mul_i32 s55, s55, 167936
    s_waitcnt lgkmcnt(2)
    v_smfmac_f32_16x16x64_bf16 v[32:35], v[40:43], v[64:71], v1
    ds_read_b128 v[64:67], v5 offset:10240
    s_add_u32 s55, s55, s34
    s_add_u32 s56, s55, s35
    v_smfmac_f32_16x16x64_bf16 v[20:23], v[44:47], a[200:207], v1
    ds_read_b128 v[68:71], v5 offset:11264
    s_and_b32 s57, s44, 63
    v_smfmac_f32_16x16x64_bf16 v[24:27], v[44:47], a[192:199], v1
    s_waitcnt lgkmcnt(2)
    v_smfmac_f32_16x16x64_bf16 v[28:31], v[44:47], v[56:63], v1
    ds_read_b128 v[56:59], v5 offset:12288
    v_smfmac_f32_16x16x64_bf16 v[32:35], v[44:47], a[184:191], v1
    ds_read_b128 v[60:63], v5 offset:13312
    v_smfmac_f32_16x16x64_bf16 v[20:23], v[48:51], a[176:183], v1
    s_waitcnt lgkmcnt(2)
    v_smfmac_f32_16x16x64_bf16 v[24:27], v[48:51], v[64:71], v1
    ds_read_b128 v[64:67], v5 offset:14336
    v_smfmac_f32_16x16x64_bf16 v[28:31], v[48:51], a[168:175], v1
    ds_read_b128 v[68:71], v5 offset:15360
    v_smfmac_f32_16x16x64_bf16 v[32:35], v[48:51], a[160:167], v1
    s_mov_b32 m0, 4096
    s_add_u32 s59, s26, 4096
    buffer_load_dwordx4 v0, s[8:11], s59 offen offset:0 sc1 lds
    buffer_load_dwordx4 v0, s[8:11], s59 offen offset:1024 sc1 lds
    buffer_load_dwordx4 v0, s[8:11], s59 offen offset:2048 sc1 lds
    buffer_load_dwordx4 v0, s[8:11], s59 offen offset:3072 sc1 lds
    s_add_u32 s27, s26, 16777216
    s_mov_b32 m0, 8192
    s_nop 0
    buffer_load_dwordx4 v0, s[8:11], s27 offen offset:0 sc1 lds
    buffer_load_dwordx4 v0, s[8:11], s27 offen offset:1024 sc1 lds
    s_waitcnt vmcnt(6)
    s_barrier
    ds_read_b128 v[36:39], v6 offset:16384
    ds_read_b128 v[40:43], v6 offset:17408
    ds_read_b128 v[44:47], v6 offset:18432
    ds_read_b128 v[48:51], v6 offset:19456
    ds_read_b32 v11, v6 offset:20480
    s_waitcnt lgkmcnt(7)
    v_smfmac_f32_16x16x64_bf16 v[20:23], v[52:55], v[56:63], v1
    ds_read_b128 v[56:59], v5 offset:16384
    v_smfmac_f32_16x16x64_bf16 v[24:27], v[52:55], a[152:159], v1
    ds_read_b128 v[60:63], v5 offset:17408
    v_smfmac_f32_16x16x64_bf16 v[28:31], v[52:55], a[144:151], v1
    s_waitcnt lgkmcnt(4)
    v_max3_u32 v10, v36, v40, v44
    v_smfmac_f32_16x16x64_bf16 v[32:35], v[52:55], v[64:71], v1
    s_waitcnt lgkmcnt(2)
    v_max3_u32 v10, v10, v48, v11
    v_cmp_eq_u32 vcc, -1, v10
    s_cbranch_vccnz main_kernel_c1_2_rr
main_kernel_c1_2_rr_r:
    ds_read_b128 v[52:55], v6 offset:20480
    v_smfmac_f32_16x16x64_bf16 v[20:23], v[36:39], a[136:143], v1
    ds_read_b128 v[64:67], v5 offset:18432
    v_smfmac_f32_16x16x64_bf16 v[24:27], v[36:39], a[128:135], v1
    ds_read_b128 v[68:71], v5 offset:19456
    s_waitcnt lgkmcnt(3)
    v_smfmac_f32_16x16x64_bf16 v[20:23], v[40:43], v[56:63], v1
    ds_read_b128 v[56:59], v5 offset:20480
    v_smfmac_f32_16x16x64_bf16 v[24:27], v[40:43], a[120:127], v1
    ds_read_b128 v[60:63], v5 offset:21504
    buffer_store_dwordx4 v[72:75], v0, s[8:11], s4 offen offset:0 sc1
    buffer_store_dwordx4 v[76:79], v0, s[8:11], s4 offen offset:1024 sc1
    s_mov_b32 s4, 0x10000000
    v_smfmac_f32_16x16x64_bf16 v[20:23], v[44:47], a[112:119], v1
    s_waitcnt lgkmcnt(2)
    v_smfmac_f32_16x16x64_bf16 v[24:27], v[44:47], v[64:71], v1
    ds_read_b128 v[64:67], v5 offset:22528
    v_smfmac_f32_16x16x64_bf16 v[20:23], v[48:51], a[104:111], v1
    ds_read_b128 v[68:71], v5 offset:23552
    v_smfmac_f32_16x16x64_bf16 v[24:27], v[48:51], a[96:103], v1
    s_waitcnt lgkmcnt(2)
    v_smfmac_f32_16x16x64_bf16 v[20:23], v[52:55], v[56:63], v1
    ds_read_b128 v[56:59], v5 offset:24576
    v_smfmac_f32_16x16x64_bf16 v[24:27], v[52:55], a[88:95], v1
    ds_read_b128 v[60:63], v5 offset:25600
    v_smfmac_f32_16x16x64_bf16 v[28:31], v[36:39], a[80:87], v1
    s_waitcnt lgkmcnt(2)
    v_smfmac_f32_16x16x64_bf16 v[32:35], v[36:39], v[64:71], v1
    ds_read_b128 v[64:67], v5 offset:26624
    s_nop 0
    v_permlane32_swap_b32 v20, v21
    v_smfmac_f32_16x16x64_bf16 v[28:31], v[40:43], a[72:79], v1
    ds_read_b128 v[68:71], v5 offset:27648
    v_permlane32_swap_b32 v22, v23
    v_smfmac_f32_16x16x64_bf16 v[32:35], v[40:43], a[64:71], v1
    s_waitcnt lgkmcnt(2)
    v_permlane32_swap_b32 v24, v25
    v_smfmac_f32_16x16x64_bf16 v[28:31], v[44:47], v[56:63], v1
    ds_read_b128 v[56:59], v5 offset:28672
    v_permlane32_swap_b32 v26, v27
    v_smfmac_f32_16x16x64_bf16 v[32:35], v[44:47], a[56:63], v1
    ds_read_b128 v[60:63], v5 offset:29696
    v_add_f32 v20, v20, v21
    v_add_f32 v22, v22, v23
    v_smfmac_f32_16x16x64_bf16 v[28:31], v[48:51], a[48:55], v1
    s_waitcnt lgkmcnt(2)
    v_add_f32 v24, v24, v25
    v_add_f32 v26, v26, v27
    v_smfmac_f32_16x16x64_bf16 v[32:35], v[48:51], v[64:71], v1
    ds_read_b128 v[64:67], v5 offset:30720
    v_mul_f32 v20, s40, v20
    v_mul_f32 v24, s40, v24
    v_smfmac_f32_16x16x64_bf16 v[28:31], v[52:55], a[40:47], v1
    ds_read_b128 v[68:71], v5 offset:31744
    v_mul_f32 v22, s40, v22
    v_mul_f32 v26, s40, v26
    v_smfmac_f32_16x16x64_bf16 v[32:35], v[52:55], a[32:39], v1
    s_waitcnt lgkmcnt(2)
    v_cvt_pk_bf16_f32 v20, v20, v24
    v_cvt_pk_bf16_f32 v21, v22, v26
    v_smfmac_f32_16x16x64_bf16 v[12:15], v[36:39], v[56:63], v1
    ds_write_b32 v2, v20 offset:26624
    ds_write_b32 v2, v21 offset:27200
    v_smfmac_f32_16x16x64_bf16 v[16:19], v[36:39], a[24:31], v1
    v_permlane32_swap_b32 v28, v29
    v_smfmac_f32_16x16x64_bf16 v[12:15], v[40:43], a[16:23], v1
    s_waitcnt lgkmcnt(2)
    v_permlane32_swap_b32 v30, v31
    v_smfmac_f32_16x16x64_bf16 v[16:19], v[40:43], v[64:71], v1
    ds_read_b128 v[40:43], v6 offset:22528
    v_permlane32_swap_b32 v32, v33
    v_smfmac_f32_16x16x64_bf16 v[12:15], v[44:47], a[8:15], v1
    v_permlane32_swap_b32 v34, v35
    v_smfmac_f32_16x16x64_bf16 v[16:19], v[44:47], a[0:7], v1
    ds_read_b128 v[44:47], v6 offset:23552
    v_add_f32 v28, v28, v29
    v_add_f32 v30, v30, v31
    v_smfmac_f32_16x16x64_bf16 v[12:15], v[48:51], v[248:255], v1
    v_add_f32 v32, v32, v33
    v_add_f32 v34, v34, v35
    v_smfmac_f32_16x16x64_bf16 v[16:19], v[48:51], v[240:247], v1
    ds_read_b128 v[48:51], v6 offset:24576
    v_cvt_pk_bf16_f32 v28, v28, v32
    v_cvt_pk_bf16_f32 v29, v30, v34
    v_smfmac_f32_16x16x64_bf16 v[12:15], v[52:55], v[232:239], v1
    ds_write_b32 v2, v28 offset:28928
    ds_write_b32 v2, v29 offset:29504
    v_smfmac_f32_16x16x64_bf16 v[16:19], v[52:55], v[224:231], v1
    ds_read_b128 v[52:55], v6 offset:25600
    s_waitcnt lgkmcnt(5)
    v_smfmac_f32_16x16x64_bf16 v[12:15], v[40:43], v[216:223], v1
    v_smfmac_f32_16x16x64_bf16 v[16:19], v[40:43], v[208:215], v1
    s_waitcnt vmcnt(2) lgkmcnt(1)
    s_barrier
    ds_read_b128 v[56:59], v0 offset:0
    ds_read_b128 v[20:23], v4 offset:26624
    v_smfmac_f32_16x16x64_bf16 v[12:15], v[44:47], v[200:207], v1
    ds_read_b128 v[60:63], v0 offset:1024
    ds_read_b128 v[24:27], v4 offset:26688
    v_smfmac_f32_16x16x64_bf16 v[16:19], v[44:47], v[192:199], v1
    ds_read_b128 v[64:67], v0 offset:2048
    ds_read_b128 v[72:75], v4 offset:26752
    v_smfmac_f32_16x16x64_bf16 v[12:15], v[48:51], v[184:191], v1
    ds_read_b128 v[68:71], v0 offset:3072
    ds_read_b128 v[76:79], v4 offset:26816
    v_smfmac_f32_16x16x64_bf16 v[16:19], v[48:51], v[176:183], v1
    ds_read_b128 v[36:39], v0 offset:4096
    ds_read_b128 v[40:43], v0 offset:5120
    s_waitcnt lgkmcnt(10)
    v_smfmac_f32_16x16x64_bf16 v[12:15], v[52:55], v[168:175], v1
    ds_read_b128 v[44:47], v0 offset:6144
    ds_read_b128 v[48:51], v0 offset:7168
    v_smfmac_f32_16x16x64_bf16 v[16:19], v[52:55], v[160:167], v1
    s_waitcnt lgkmcnt(10)
    v_mfma_f32_16x16x32_bf16 v[28:31], v[56:59], v[20:23], 0
    s_waitcnt lgkmcnt(8)
    v_mfma_f32_16x16x32_bf16 v[28:31], v[60:63], v[24:27], v[28:31]
    s_nop 0
    s_waitcnt lgkmcnt(6)
    v_cvt_pk_bf16_f32 v12, v12, v13
    v_cvt_pk_bf16_f32 v13, v14, v15
    v_mfma_f32_16x16x32_bf16 v[28:31], v[64:67], v[72:75], v[28:31]
    s_waitcnt lgkmcnt(4)
    v_cvt_pk_bf16_f32 v14, v16, v17
    v_cvt_pk_bf16_f32 v15, v18, v19
    v_mfma_f32_16x16x32_bf16 v[28:31], v[68:71], v[76:79], v[28:31]
    ds_write_b128 v0, v[12:15] offset:18432
    s_waitcnt lgkmcnt(4)
    v_mfma_f32_16x16x32_bf16 v[32:35], v[36:39], v[20:23], 0
    ds_read_b128 v[56:59], v3 offset:28928
    ds_read_b128 v[60:63], v3 offset:28992
    s_waitcnt lgkmcnt(5)
    v_mfma_f32_16x16x32_bf16 v[32:35], v[40:43], v[24:27], v[32:35]
    ds_read_b128 v[64:67], v3 offset:29056
    ds_read_b128 v[68:71], v3 offset:29120
    s_waitcnt lgkmcnt(6)
    v_mfma_f32_16x16x32_bf16 v[32:35], v[44:47], v[72:75], v[32:35]
    s_mov_b64 exec, s[36:37]
    v_exp_f32 v28, v28
    v_exp_f32 v29, v29
    s_mov_b64 exec, -1
    s_waitcnt lgkmcnt(5)
    v_mfma_f32_16x16x32_bf16 v[32:35], v[48:51], v[76:79], v[32:35]
    s_mov_b64 exec, s[36:37]
    v_exp_f32 v30, v30
    v_exp_f32 v31, v31
    s_mov_b64 exec, -1
    s_waitcnt lgkmcnt(4)
    s_barrier
    s_waitcnt lgkmcnt(3)
    v_mfma_f32_16x16x32_bf16 v[52:55], v[56:59], v[20:23], 0
    ds_read_b128 v[36:39], v0 offset:8192
    s_waitcnt lgkmcnt(3)
    v_cvt_pk_bf16_f32 v28, v28, v29
    v_cvt_pk_bf16_f32 v29, v30, v31
    v_mfma_f32_16x16x32_bf16 v[52:55], v[60:63], v[24:27], v[52:55]
    ds_read_b128 v[40:43], v0 offset:10240
    s_mov_b64 exec, s[36:37]
    v_exp_f32 v32, v32
    v_exp_f32 v33, v33
    s_mov_b64 exec, -1
    s_waitcnt lgkmcnt(3)
    v_mfma_f32_16x16x32_bf16 v[52:55], v[64:67], v[72:75], v[52:55]
    ds_read_b128 v[44:47], v0 offset:12288
    s_mov_b64 exec, s[36:37]
    v_exp_f32 v34, v34
    v_exp_f32 v35, v35
    s_mov_b64 exec, -1
    s_waitcnt lgkmcnt(3)
    v_mfma_f32_16x16x32_bf16 v[52:55], v[68:71], v[76:79], v[52:55]
    ds_read_b128 v[48:51], v0 offset:14336
    v_cvt_pk_bf16_f32 v30, v32, v33
    v_cvt_pk_bf16_f32 v31, v34, v35
    s_cmp_eq_u32 s57, 63
    s_cbranch_scc1 main_kernel_c1_2_last
    s_waitcnt lgkmcnt(3)
    v_mfma_f32_16x16x32_bf16 v[20:23], v[36:39], v[28:31], 0
    ds_read_b128 v[56:59], v0 offset:9216
    s_waitcnt lgkmcnt(3)
    v_mov_b32_dpp v32, v28 row_ror:8 row_mask:0xf bank_mask:0xf
    v_mov_b32_dpp v33, v29 row_ror:8 row_mask:0xf bank_mask:0xf
    v_mfma_f32_16x16x32_bf16 v[24:27], v[40:43], v[28:31], 0
    ds_read_b128 v[60:63], v0 offset:11264
    s_waitcnt lgkmcnt(3)
    v_mov_b32_dpp v34, v30 row_ror:8 row_mask:0xf bank_mask:0xf
    v_mov_b32_dpp v35, v31 row_ror:8 row_mask:0xf bank_mask:0xf
    v_mfma_f32_16x16x32_bf16 v[72:75], v[44:47], v[28:31], 0
    ds_read_b128 v[64:67], v0 offset:13312
    s_waitcnt lgkmcnt(3)
    v_mov_b64 v[16:17], s[24:25]
    v_mov_b64 v[18:19], s[24:25]
    v_mfma_f32_16x16x32_bf16 v[76:79], v[48:51], v[28:31], 0
    ds_read_b128 v[68:71], v0 offset:15360
    s_mov_b64 exec, s[36:37]
    v_exp_f32 v52, v52
    s_mov_b64 exec, -1
    v_mfma_f32_16x16x32_bf16 v[12:15], v[16:19], v[28:31], 0
    ds_read_b128 v[36:39], v0 offset:16384
    s_mov_b64 exec, s[36:37]
    v_exp_f32 v53, v53
    s_mov_b64 exec, -1
    s_waitcnt lgkmcnt(4)
    v_mfma_f32_16x16x32_bf16 v[20:23], v[56:59], v[32:35], v[20:23]
    ds_read_b128 v[40:43], v0 offset:17408
    s_mov_b64 exec, s[36:37]
    v_exp_f32 v54, v54
    s_mov_b64 exec, -1
    s_waitcnt lgkmcnt(4)
    v_mfma_f32_16x16x32_bf16 v[24:27], v[60:63], v[32:35], v[24:27]
    ds_read_b128 v[44:47], v0 offset:18432
    s_mov_b64 exec, s[36:37]
    v_exp_f32 v55, v55
    s_mov_b64 exec, -1
    s_waitcnt lgkmcnt(4)
    v_mfma_f32_16x16x32_bf16 v[72:75], v[64:67], v[32:35], v[72:75]
    ds_read_b128 v[48:51], v0 offset:19456
    s_waitcnt lgkmcnt(4)
    v_cvt_pk_bf16_f32 v52, v52, v53
    v_cvt_pk_bf16_f32 v53, v54, v55
    v_mfma_f32_16x16x32_bf16 v[76:79], v[68:71], v[32:35], v[76:79]
    v_mov_b64 v[10:11], s[16:17]
    v_mov_b32_dpp v54, v52 row_ror:8 row_mask:0xf bank_mask:0xf
main_kernel_c1_2_fin:
    s_waitcnt lgkmcnt(3)
    v_mfma_f32_16x16x16_bf16 v[20:23], v[36:37], v[52:53], v[20:23]
    v_mov_b32_dpp v55, v53 row_ror:8 row_mask:0xf bank_mask:0xf
    v_mov_b64 v[56:57], 0
    v_mfma_f32_16x16x16_bf16 v[12:15], v[10:11], v[52:53], v[12:15]
    s_waitcnt lgkmcnt(2)
    v_mov_b64 v[58:59], 0
    v_mov_b64 v[60:61], 0
    v_mfma_f32_16x16x16_bf16 v[24:27], v[40:41], v[52:53], v[24:27]
    v_mov_b64 v[62:63], 0
    v_mov_b64 v[64:65], 0
    v_mfma_f32_16x16x16_bf16 v[20:23], v[38:39], v[54:55], v[20:23]
    v_mov_b64 v[66:67], 0
    v_mov_b64 v[68:69], 0
    v_mfma_f32_16x16x16_bf16 v[24:27], v[42:43], v[54:55], v[24:27]
    s_waitcnt lgkmcnt(1)
    v_add_f32_dpp v12, v12, v12 row_ror:8 row_mask:0xf bank_mask:0xf
    v_mov_b64 v[70:71], 0
    v_mfma_f32_16x16x16_bf16 v[72:75], v[44:45], v[52:53], v[72:75]
    s_waitcnt lgkmcnt(0)
    v_rcp_f32 v14, v12
    v_mfma_f32_16x16x16_bf16 v[76:79], v[48:49], v[52:53], v[76:79]
    v_subrev_u32 v13, s68, v12
    v_cmp_lt_u32 vcc, s69, v13
    v_mfma_f32_16x16x16_bf16 v[72:75], v[46:47], v[54:55], v[72:75]
    s_cbranch_vccnz main_kernel_c1_2_zbad
main_kernel_c1_2_zok:
    v_mov_b64 v[28:29], 0
    v_mov_b64 v[30:31], 0
    v_mfma_f32_16x16x16_bf16 v[76:79], v[50:51], v[54:55], v[76:79]
    v_mul_f32 v20, v20, v14
    v_mul_f32 v21, v21, v14
    v_mul_f32 v22, v22, v14
    v_mul_f32 v23, v23, v14
    v_mul_f32 v24, v24, v14
    v_mul_f32 v25, v25, v14
    v_mul_f32 v26, v26, v14
    v_mul_f32 v27, v27, v14
    v_cvt_pk_bf16_f32 v20, v20, v21
    v_cvt_pk_bf16_f32 v21, v22, v23
    v_cvt_pk_bf16_f32 v22, v24, v25
    v_cvt_pk_bf16_f32 v23, v26, v27
    v_mul_f32 v72, v72, v14
    v_mul_f32 v73, v73, v14
    v_smfmac_f32_16x16x64_bf16 v[56:59], v[20:23], v[152:159], v1
    v_mul_f32 v74, v74, v14
    v_mul_f32 v75, v75, v14
    v_mul_f32 v76, v76, v14
    v_smfmac_f32_16x16x64_bf16 v[60:63], v[20:23], v[136:143], v1
    v_mul_f32 v77, v77, v14
    v_mul_f32 v78, v78, v14
    v_mul_f32 v79, v79, v14
    v_smfmac_f32_16x16x64_bf16 v[64:67], v[20:23], v[120:127], v1
    v_cvt_pk_bf16_f32 v72, v72, v73
    v_cvt_pk_bf16_f32 v73, v74, v75
    v_cvt_pk_bf16_f32 v74, v76, v77
    v_smfmac_f32_16x16x64_bf16 v[68:71], v[20:23], v[104:111], v1
    v_cvt_pk_bf16_f32 v75, v78, v79
    v_smfmac_f32_16x16x64_bf16 v[28:31], v[20:23], v[88:95], v1
    s_nop 0
    v_smfmac_f32_16x16x64_bf16 v[56:59], v[72:75], v[144:151], v1
    v_smfmac_f32_16x16x64_bf16 v[60:63], v[72:75], v[128:135], v1
    v_smfmac_f32_16x16x64_bf16 v[64:67], v[72:75], v[112:119], v1
    v_mov_b32 v5, v5
    v_mov_b32 v5, v5
    v_permlane32_swap_b32 v56, v57
    v_smfmac_f32_16x16x64_bf16 v[68:71], v[72:75], v[96:103], v1
    v_permlane32_swap_b32 v58, v59
    v_smfmac_f32_16x16x64_bf16 v[28:31], v[72:75], v[80:87], v1
    v_add_f32 v56, v56, v57
    v_add_f32 v58, v58, v59
    v_permlane32_swap_b32 v60, v61
    v_permlane32_swap_b32 v62, v63
    v_add_f32 v60, v60, v61
    v_add_f32 v62, v62, v63
    v_cvt_pk_bf16_f32 v36, v56, v60
    v_cvt_pk_bf16_f32 v38, v58, v62
    v_permlane32_swap_b32 v64, v65
    v_permlane32_swap_b32 v66, v67
    v_add_f32 v64, v64, v65
    v_add_f32 v66, v66, v67
    v_permlane32_swap_b32 v68, v69
    v_permlane32_swap_b32 v70, v71
    v_add_f32 v68, v68, v69
    v_add_f32 v70, v70, v71
    v_cvt_pk_bf16_f32 v37, v64, v68
    v_cvt_pk_bf16_f32 v39, v66, v70
    buffer_store_dwordx4 v[36:39], v0, s[8:11], s56 offen sc1
    v_permlane32_swap_b32 v28, v29
    v_permlane32_swap_b32 v30, v31
    v_add_f32 v28, v28, v29
    v_add_f32 v30, v30, v31
    v_cvt_pk_bf16_f32 v28, v28, v30
    buffer_store_dword v28, v7, s[8:11], s55 offen sc1
    s_add_u32 s27, s44, 1
    s_and_b32 s27, s27, 3
    s_mul_i32 s48, s27, 5120
    s_add_u32 s48, s48, s41
    s_lshl_b32 s27, s27, 15
    s_add_u32 s49, s27, s47
    v_add_u32 v10, 16384, v0
    v_add_u32 v11, 28928, v3
    v_cndmask_b32_e64 v10, v10, v11, s[42:43]
    ds_read_b128 v[72:75], v10 offset:0
    v_add_u32 v10, 17408, v0
    v_add_u32 v11, 28992, v3
    v_cndmask_b32_e64 v10, v10, v11, s[42:43]
    ds_read_b128 v[76:79], v10 offset:0
    s_lshl_b32 s4, s44, 18
    s_add_u32 s4, s4, s53
    ds_read_b128 v[56:59], v5 offset:0
    ds_read_b128 v[60:63], v5 offset:1024
    ds_read_b128 v[64:67], v5 offset:2048
    ds_read_b128 v[68:71], v5 offset:3072
    v_mov_b64 v[12:13], 0
    v_mov_b64 v[14:15], 0
    v_mov_b64 v[16:17], 0
    v_mov_b64 v[18:19], 0
    v_mov_b64 v[20:21], 0
    v_mov_b64 v[22:23], 0
    v_mov_b64 v[24:25], 0
    v_mov_b64 v[26:27], 0
    v_mov_b64 v[28:29], 0
    v_mov_b64 v[30:31], 0
    v_mov_b64 v[32:33], 0
    v_mov_b64 v[34:35], 0
    s_barrier
    s_and_b32 s26, s44, 63
    s_add_u32 s26, s26, 1
    s_min_u32 s26, s26, 63
    s_lshl_b32 s26, s26, 18
    s_add_u32 s26, s26, s50
    s_nop 15
    s_nop 15
    s_nop 14
    s_mov_b32 m0, 21504
    s_nop 0
    buffer_load_dwordx4 v0, s[8:11], s48 offen offset:0 sc1 lds
    buffer_load_dwordx4 v0, s[8:11], s48 offen offset:1024 sc1 lds
    buffer_load_dwordx4 v0, s[8:11], s48 offen offset:2048 sc1 lds
    s_add_u32 s44, s44, 1
    s_mov_b32 s70, 0
    s_waitcnt vmcnt(0) lgkmcnt(0)
    s_branch main_kernel_c1_2_top
main_kernel_c1_2_restart:
    s_waitcnt vmcnt(0) lgkmcnt(0)
    s_nop 7
    s_barrier
    s_mov_b32 m0, 21504
    s_nop 0
    buffer_load_dwordx4 v0, s[8:11], s48 offen offset:0 sc1 lds
    buffer_load_dwordx4 v0, s[8:11], s48 offen offset:1024 sc1 lds
    buffer_load_dwordx4 v0, s[8:11], s48 offen offset:2048 sc1 lds
    ds_read_b128 v[56:59], v5 offset:0
    ds_read_b128 v[60:63], v5 offset:1024
    ds_read_b128 v[64:67], v5 offset:2048
    ds_read_b128 v[68:71], v5 offset:3072
    v_mov_b64 v[12:13], 0
    v_mov_b64 v[14:15], 0
    v_mov_b64 v[16:17], 0
    v_mov_b64 v[18:19], 0
    v_mov_b64 v[20:21], 0
    v_mov_b64 v[22:23], 0
    v_mov_b64 v[24:25], 0
    v_mov_b64 v[26:27], 0
    v_mov_b64 v[28:29], 0
    v_mov_b64 v[30:31], 0
    v_mov_b64 v[32:33], 0
    v_mov_b64 v[34:35], 0
    s_waitcnt vmcnt(0) lgkmcnt(0)
    s_branch main_kernel_c1_2_top
main_kernel_c1_2_zbad:
    s_cmp_eq_u32 s70, 2
    s_cbranch_scc1 main_kernel_c1_2_zok
    v_cmp_u_f32 vcc, v12, v12
    s_cbranch_vccz main_kernel_c1_2_exact
    s_cmp_eq_u32 s70, 1
    s_cbranch_scc1 main_kernel_c1_2_exact
main_kernel_c1_2_vfy0:
    s_mov_b32 s70, 1
    s_mov_b32 s30, 0
    s_waitcnt vmcnt(0) lgkmcnt(0)
    s_nop 7
main_kernel_c1_2_vfy:
    v_mov_b32 v10, 0
    s_add_u32 s59, s48, 4096
    buffer_load_dwordx4 v[36:39], v0, s[8:11], s48 offen offset:0 sc1
    buffer_load_dwordx4 v[40:43], v0, s[8:11], s48 offen offset:1024 sc1
    buffer_load_dwordx4 v[44:47], v0, s[8:11], s48 offen offset:2048 sc1
    buffer_load_dwordx4 v[48:51], v0, s[8:11], s48 offen offset:3072 sc1
    buffer_load_dwordx4 v[52:55], v0, s[8:11], s59 offen offset:0 sc1
    s_waitcnt vmcnt(4)
    v_max3_u32 v10, v10, v36, v37
    v_max3_u32 v10, v10, v38, v39
    s_waitcnt vmcnt(3)
    v_max3_u32 v10, v10, v40, v41
    v_max3_u32 v10, v10, v42, v43
    s_waitcnt vmcnt(2)
    v_max3_u32 v10, v10, v44, v45
    v_max3_u32 v10, v10, v46, v47
    s_waitcnt vmcnt(1)
    v_max3_u32 v10, v10, v48, v49
    v_max3_u32 v10, v10, v50, v51
    s_waitcnt vmcnt(0)
    v_max3_u32 v10, v10, v52, v53
    v_max3_u32 v10, v10, v54, v55
    s_add_u32 s59, s49, 4096
    buffer_load_dwordx4 v[36:39], v0, s[8:11], s49 offen offset:0 sc1
    buffer_load_dwordx4 v[40:43], v0, s[8:11], s49 offen offset:1024 sc1
    buffer_load_dwordx4 v[44:47], v0, s[8:11], s49 offen offset:2048 sc1
    buffer_load_dwordx4 v[48:51], v0, s[8:11], s49 offen offset:3072 sc1
    buffer_load_dwordx4 v[52:55], v0, s[8:11], s59 offen offset:0 sc1
    s_waitcnt vmcnt(4)
    v_max3_u32 v10, v10, v36, v37
    v_max3_u32 v10, v10, v38, v39
    s_waitcnt vmcnt(3)
    v_max3_u32 v10, v10, v40, v41
    v_max3_u32 v10, v10, v42, v43
    s_waitcnt vmcnt(2)
    v_max3_u32 v10, v10, v44, v45
    v_max3_u32 v10, v10, v46, v47
    s_waitcnt vmcnt(1)
    v_max3_u32 v10, v10, v48, v49
    v_max3_u32 v10, v10, v50, v51
    s_waitcnt vmcnt(0)
    v_max3_u32 v10, v10, v52, v53
    v_max3_u32 v10, v10, v54, v55
    v_cmp_eq_u32 vcc, -1, v10
    s_cbranch_vccz main_kernel_c1_2_restart
    s_add_u32 s30, s30, 1
    s_cmp_ge_u32 s30, 60000
    s_cbranch_scc1 main_kernel_fail
    s_branch main_kernel_c1_2_vfy
main_kernel_c1_2_exact:
    s_nop 7
    s_mov_b32 s70, 2
    ds_read_b128 v[20:23], v3 offset:26624
    ds_read_b128 v[24:27], v3 offset:26688
    ds_read_b128 v[72:75], v3 offset:26752
    ds_read_b128 v[76:79], v3 offset:26816
    ds_read_b128 v[56:59], v0 offset:0
    s_waitcnt lgkmcnt(0)
    v_mfma_f32_16x16x32_bf16 v[28:31], v[56:59], v[20:23], 0
    s_nop 3
    ds_read_b128 v[60:63], v0 offset:1024
    s_waitcnt lgkmcnt(0)
    v_mfma_f32_16x16x32_bf16 v[28:31], v[60:63], v[24:27], v[28:31]
    s_nop 3
    ds_read_b128 v[56:59], v0 offset:2048
    s_waitcnt lgkmcnt(0)
    v_mfma_f32_16x16x32_bf16 v[28:31], v[56:59], v[72:75], v[28:31]
    s_nop 3
    ds_read_b128 v[60:63], v0 offset:3072
    s_waitcnt lgkmcnt(0)
    v_mfma_f32_16x16x32_bf16 v[28:31], v[60:63], v[76:79], v[28:31]
    s_nop 3
    ds_read_b128 v[56:59], v0 offset:4096
    s_waitcnt lgkmcnt(0)
    v_mfma_f32_16x16x32_bf16 v[32:35], v[56:59], v[20:23], 0
    s_nop 3
    ds_read_b128 v[60:63], v0 offset:5120
    s_waitcnt lgkmcnt(0)
    v_mfma_f32_16x16x32_bf16 v[32:35], v[60:63], v[24:27], v[32:35]
    s_nop 3
    ds_read_b128 v[56:59], v0 offset:6144
    s_waitcnt lgkmcnt(0)
    v_mfma_f32_16x16x32_bf16 v[32:35], v[56:59], v[72:75], v[32:35]
    s_nop 3
    ds_read_b128 v[60:63], v0 offset:7168
    s_waitcnt lgkmcnt(0)
    v_mfma_f32_16x16x32_bf16 v[32:35], v[60:63], v[76:79], v[32:35]
    s_nop 3
    ds_read_b128 v[56:59], v3 offset:28928
    s_waitcnt lgkmcnt(0)
    v_mfma_f32_16x16x32_bf16 v[52:55], v[56:59], v[20:23], 0
    s_nop 3
    ds_read_b128 v[60:63], v3 offset:28992
    s_waitcnt lgkmcnt(0)
    v_mfma_f32_16x16x32_bf16 v[52:55], v[60:63], v[24:27], v[52:55]
    s_nop 3
    ds_read_b128 v[56:59], v3 offset:29056
    s_waitcnt lgkmcnt(0)
    v_mfma_f32_16x16x32_bf16 v[52:55], v[56:59], v[72:75], v[52:55]
    s_nop 3
    ds_read_b128 v[60:63], v3 offset:29120
    s_waitcnt lgkmcnt(0)
    v_mfma_f32_16x16x32_bf16 v[52:55], v[60:63], v[76:79], v[52:55]
    s_nop 3
    v_max3_f32 v64, v28, v29, v30
    v_max3_f32 v64, v64, v31, v32
    v_max3_f32 v64, v64, v33, v34
    s_nop 0
    v_max3_f32 v64, v64, v35, v52
    v_max3_f32 v64, v64, v53, v54
    v_max_f32 v64, v64, v55
    v_mov_b32 v65, v64
    s_nop 1
    v_permlane16_swap_b32 v64, v65
    v_max_f32 v64, v64, v65
    v_mov_b32 v65, v64
    s_nop 1
    v_permlane32_swap_b32 v64, v65
    v_max_f32 v64, v64, v65
    v_sub_f32 v28, v28, v64
    v_exp_f32 v28, v28
    s_nop 0
    v_cndmask_b32_e64 v28, 0, v28, s[36:37]
    v_sub_f32 v29, v29, v64
    v_exp_f32 v29, v29
    s_nop 0
    v_cndmask_b32_e64 v29, 0, v29, s[36:37]
    v_sub_f32 v30, v30, v64
    v_exp_f32 v30, v30
    s_nop 0
    v_cndmask_b32_e64 v30, 0, v30, s[36:37]
    v_sub_f32 v31, v31, v64
    v_exp_f32 v31, v31
    s_nop 0
    v_cndmask_b32_e64 v31, 0, v31, s[36:37]
    v_sub_f32 v32, v32, v64
    v_exp_f32 v32, v32
    s_nop 0
    v_cndmask_b32_e64 v32, 0, v32, s[36:37]
    v_sub_f32 v33, v33, v64
    v_exp_f32 v33, v33
    s_nop 0
    v_cndmask_b32_e64 v33, 0, v33, s[36:37]
    v_sub_f32 v34, v34, v64
    v_exp_f32 v34, v34
    s_nop 0
    v_cndmask_b32_e64 v34, 0, v34, s[36:37]
    v_sub_f32 v35, v35, v64
    v_exp_f32 v35, v35
    s_nop 0
    v_cndmask_b32_e64 v35, 0, v35, s[36:37]
    v_sub_f32 v52, v52, v64
    v_exp_f32 v52, v52
    s_nop 0
    v_cndmask_b32_e64 v52, 0, v52, s[36:37]
    v_sub_f32 v53, v53, v64
    v_exp_f32 v53, v53
    s_nop 0
    v_cndmask_b32_e64 v53, 0, v53, s[36:37]
    v_sub_f32 v54, v54, v64
    v_exp_f32 v54, v54
    s_nop 0
    v_cndmask_b32_e64 v54, 0, v54, s[36:37]
    v_sub_f32 v55, v55, v64
    v_exp_f32 v55, v55
    s_nop 0
    v_cndmask_b32_e64 v55, 0, v55, s[36:37]
    v_cvt_pk_bf16_f32 v28, v28, v29
    v_cvt_pk_bf16_f32 v29, v30, v31
    v_cvt_pk_bf16_f32 v30, v32, v33
    v_cvt_pk_bf16_f32 v31, v34, v35
    v_mov_b32_dpp v32, v28 row_ror:8 row_mask:0xf bank_mask:0xf
    v_mov_b32_dpp v33, v29 row_ror:8 row_mask:0xf bank_mask:0xf
    v_mov_b32_dpp v34, v30 row_ror:8 row_mask:0xf bank_mask:0xf
    v_mov_b32_dpp v35, v31 row_ror:8 row_mask:0xf bank_mask:0xf
    v_cvt_pk_bf16_f32 v52, v52, v53
    v_cvt_pk_bf16_f32 v53, v54, v55
    s_nop 0
    v_mov_b32_dpp v54, v52 row_ror:8 row_mask:0xf bank_mask:0xf
    v_mfma_f32_16x16x32_bf16 v[12:15], v[16:19], v[28:31], 0
    ds_read_b128 v[56:59], v0 offset:8192
    s_waitcnt lgkmcnt(0)
    v_mfma_f32_16x16x32_bf16 v[20:23], v[56:59], v[28:31], 0
    s_nop 3
    ds_read_b128 v[60:63], v0 offset:9216
    s_waitcnt lgkmcnt(0)
    v_mfma_f32_16x16x32_bf16 v[20:23], v[60:63], v[32:35], v[20:23]
    s_nop 3
    ds_read_b128 v[56:59], v0 offset:10240
    s_waitcnt lgkmcnt(0)
    v_mfma_f32_16x16x32_bf16 v[24:27], v[56:59], v[28:31], 0
    s_nop 3
    ds_read_b128 v[60:63], v0 offset:11264
    s_waitcnt lgkmcnt(0)
    v_mfma_f32_16x16x32_bf16 v[24:27], v[60:63], v[32:35], v[24:27]
    s_nop 3
    ds_read_b128 v[56:59], v0 offset:12288
    s_waitcnt lgkmcnt(0)
    v_mfma_f32_16x16x32_bf16 v[72:75], v[56:59], v[28:31], 0
    s_nop 3
    ds_read_b128 v[60:63], v0 offset:13312
    s_waitcnt lgkmcnt(0)
    v_mfma_f32_16x16x32_bf16 v[72:75], v[60:63], v[32:35], v[72:75]
    s_nop 3
    ds_read_b128 v[56:59], v0 offset:14336
    s_waitcnt lgkmcnt(0)
    v_mfma_f32_16x16x32_bf16 v[76:79], v[56:59], v[28:31], 0
    s_nop 3
    ds_read_b128 v[60:63], v0 offset:15360
    s_waitcnt lgkmcnt(0)
    v_mfma_f32_16x16x32_bf16 v[76:79], v[60:63], v[32:35], v[76:79]
    s_nop 3
    s_nop 7
    s_branch main_kernel_c1_2_fin
main_kernel_c1_2_last:
    s_cmp_lg_u32 s70, 0
    s_cbranch_scc1 main_kernel_c1_2_last2
    v_cmp_u_f32 vcc, v32, v32
    s_cbranch_vccnz main_kernel_c1_2_vfy0
main_kernel_c1_2_last2:
    s_waitcnt vmcnt(0) lgkmcnt(0)
    s_nop 7
    v_add_u32 v10, 16384, v0
    v_add_u32 v11, 28928, v3
    v_cndmask_b32_e64 v10, v10, v11, s[42:43]
    ds_read_b128 v[72:75], v10 offset:0
    v_add_u32 v10, 17408, v0
    v_add_u32 v11, 28992, v3
    v_cndmask_b32_e64 v10, v10, v11, s[42:43]
    ds_read_b128 v[76:79], v10 offset:0
    s_lshl_b32 s4, s44, 18
    s_add_u32 s4, s4, s53
    s_waitcnt lgkmcnt(1)
    buffer_store_dwordx4 v[72:75], v0, s[8:11], s4 offen offset:0 sc1
    s_waitcnt lgkmcnt(0)
    buffer_store_dwordx4 v[76:79], v0, s[8:11], s4 offen offset:1024 sc1
    s_mov_b32 s4, 0x10000000
    s_waitcnt vmcnt(0)
    s_barrier
    s_add_u32 s44, s44, 1
    s_cmp_eq_u32 s44, 128
    s_cbranch_scc1 main_kernel_end
    s_branch main_kernel_c1_2_layer
main_kernel_c1_2_lr:
    s_mov_b32 s30, 0
main_kernel_c1_2_lr_l:
    s_waitcnt lgkmcnt(0)
    s_and_b32 s27, s30, 1
    s_cbranch_scc0 main_kernel_c1_2_lr_n
    s_waitcnt vmcnt(3)
    s_mov_b32 m0, 21504
    s_nop 0
    buffer_load_dwordx4 v0, s[8:11], s48 offen offset:0 sc1 lds
    buffer_load_dwordx4 v0, s[8:11], s48 offen offset:1024 sc1 lds
    buffer_load_dwordx4 v0, s[8:11], s48 offen offset:2048 sc1 lds
main_kernel_c1_2_lr_n:
    ds_read_b128 v[36:39], v6 offset:21504
    ds_read_b128 v[40:43], v6 offset:22528
    ds_read_b128 v[44:47], v6 offset:23552
    ds_read_b128 v[48:51], v6 offset:24576
    ds_read_b128 v[52:55], v6 offset:25600
    s_waitcnt lgkmcnt(2)
    v_max3_u32 v10, v36, v40, v44
    s_waitcnt lgkmcnt(0)
    v_max3_u32 v10, v10, v48, v52
    v_cmp_eq_u32 vcc, -1, v10
    s_cbranch_vccz main_kernel_c1_2_lr_d
    s_add_u32 s30, s30, 1
    s_cmp_ge_u32 s30, 480000
    s_cbranch_scc1 main_kernel_fail
    s_branch main_kernel_c1_2_lr_l
main_kernel_c1_2_lr_d:
    ds_read_b128 v[56:59], v5 offset:0
    ds_read_b128 v[60:63], v5 offset:1024
    ds_read_b128 v[64:67], v5 offset:2048
    ds_read_b128 v[68:71], v5 offset:3072
    v_mov_b64 v[12:13], 0
    v_mov_b64 v[14:15], 0
    v_mov_b64 v[16:17], 0
    v_mov_b64 v[18:19], 0
    v_mov_b64 v[20:21], 0
    v_mov_b64 v[22:23], 0
    v_mov_b64 v[24:25], 0
    v_mov_b64 v[26:27], 0
    v_mov_b64 v[28:29], 0
    v_mov_b64 v[30:31], 0
    v_mov_b64 v[32:33], 0
    v_mov_b64 v[34:35], 0
    s_waitcnt lgkmcnt(0)
    s_branch main_kernel_c1_2_lr_r
main_kernel_c1_2_rr:
    s_mov_b32 s30, 0
main_kernel_c1_2_rr_l:
    s_waitcnt lgkmcnt(0)
    s_and_b32 s27, s30, 1
    s_cbranch_scc1 main_kernel_c1_2_rr_n
    s_waitcnt vmcnt(1)
    s_mov_b32 m0, 16384
    s_nop 0
    buffer_load_dwordx4 v0, s[8:11], s49 offen offset:3072 sc1 lds
main_kernel_c1_2_rr_n:
    ds_read_b128 v[36:39], v6 offset:16384
    ds_read_b128 v[40:43], v6 offset:17408
    ds_read_b128 v[44:47], v6 offset:18432
    ds_read_b128 v[48:51], v6 offset:19456
    ds_read_b32 v11, v6 offset:20480
    s_waitcnt lgkmcnt(2)
    v_max3_u32 v10, v36, v40, v44
    s_waitcnt lgkmcnt(0)
    v_max3_u32 v10, v10, v48, v11
    v_cmp_eq_u32 vcc, -1, v10
    s_cbranch_vccz main_kernel_c1_2_rr_d
    s_add_u32 s30, s30, 1
    s_cmp_ge_u32 s30, 480000
    s_cbranch_scc1 main_kernel_fail
    s_branch main_kernel_c1_2_rr_l
main_kernel_c1_2_rr_d:
    s_branch main_kernel_c1_2_rr_r
main_kernel_c1_3_layer:
    s_lshr_b32 s27, s44, 6
    s_mul_i32 s50, s27, 33554432
    s_lshl_b32 s27, s22, 13
    s_add_u32 s50, s50, s27
    s_add_u32 s50, s50, 37748736
    s_barrier
    s_and_b32 s26, s44, 63
    s_lshl_b32 s26, s26, 18
    s_add_u32 s26, s26, s50
    s_mul_i32 s27, s20, 5120
    s_add_u32 s48, s27, 167772160
    s_sub_u32 s49, 167777280, s27
    s_mov_b32 m0, 21504
    s_nop 0
    buffer_load_dwordx4 v0, s[8:11], s48 offen offset:3072 sc1 lds
    s_mov_b32 m0, 25600
    s_add_u32 s59, s48, 4096
    buffer_load_dwordx4 v0, s[8:11], s59 offen offset:0 sc1 lds
    ds_read_b128 v[56:59], v5 offset:0
    ds_read_b128 v[60:63], v5 offset:1024
    ds_read_b128 v[64:67], v5 offset:2048
    ds_read_b128 v[68:71], v5 offset:3072
    v_mov_b64 v[12:13], 0
    v_mov_b64 v[14:15], 0
    v_mov_b64 v[16:17], 0
    v_mov_b64 v[18:19], 0
    v_mov_b64 v[20:21], 0
    v_mov_b64 v[22:23], 0
    v_mov_b64 v[24:25], 0
    v_mov_b64 v[26:27], 0
    v_mov_b64 v[28:29], 0
    v_mov_b64 v[30:31], 0
    v_mov_b64 v[32:33], 0
    v_mov_b64 v[34:35], 0
    s_mov_b32 s70, 0
    s_waitcnt vmcnt(0) lgkmcnt(0)
main_kernel_c1_3_top:
    s_barrier
    ds_read_b128 v[36:39], v6 offset:21504
    ds_read_b128 v[40:43], v6 offset:22528
    ds_read_b128 v[44:47], v6 offset:23552
    ds_read_b128 v[48:51], v6 offset:24576
    ds_read_b128 v[52:55], v6 offset:25600
    s_mov_b32 m0, 20480
    s_add_u32 s59, s49, 4096
    buffer_load_dwordx4 v0, s[8:11], s59 offen offset:0 sc1 lds
main_kernel_c1_3_lr_r:
    s_waitcnt lgkmcnt(4)
    v_smfmac_f32_16x16x64_bf16 v[20:23], v[36:39], v[56:63], v1
    ds_read_b128 v[56:59], v5 offset:4096
    v_smfmac_f32_16x16x64_bf16 v[24:27], v[36:39], a[248:255], v1
    ds_read_b128 v[60:63], v5 offset:5120
    v_smfmac_f32_16x16x64_bf16 v[28:31], v[36:39], a[240:247], v1
    v_smfmac_f32_16x16x64_bf16 v[32:35], v[36:39], v[64:71], v1
    ds_read_b128 v[64:67], v5 offset:6144
    v_smfmac_f32_16x16x64_bf16 v[12:15], v[36:39], a[232:239], v1
    ds_read_b128 v[68:71], v5 offset:7168
    s_waitcnt lgkmcnt(6)
    v_max3_u32 v10, v36, v40, v44
    v_smfmac_f32_16x16x64_bf16 v[16:19], v[36:39], a[224:231], v1
    s_waitcnt lgkmcnt(4)
    s_waitcnt lgkmcnt(2)
    v_max3_u32 v10, v10, v48, v52
    v_smfmac_f32_16x16x64_bf16 v[20:23], v[40:43], v[56:63], v1
    ds_read_b128 v[56:59], v5 offset:8192
    v_cmp_eq_u32 vcc, -1, v10
    v_smfmac_f32_16x16x64_bf16 v[24:27], v[40:43], a[216:223], v1
    ds_read_b128 v[60:63], v5 offset:9216
    s_cbranch_vccnz main_kernel_c1_3_lr
    v_smfmac_f32_16x16x64_bf16 v[28:31], v[40:43], a[208:215], v1
    s_and_b32 s55, s44, 3
    s_mul_i32 s55, s55, 167936
    s_waitcnt lgkmcnt(2)
    v_smfmac_f32_16x16x64_bf16 v[32:35], v[40:43], v[64:71], v1
    ds_read_b128 v[64:67], v5 offset:10240
    s_add_u32 s55, s55, s34
    s_add_u32 s56, s55, s35
    v_smfmac_f32_16x16x64_bf16 v[20:23], v[44:47], a[200:207], v1
    ds_read_b128 v[68:71], v5 offset:11264
    s_and_b32 s57, s44, 63
    v_smfmac_f32_16x16x64_bf16 v[24:27], v[44:47], a[192:199], v1
    s_waitcnt lgkmcnt(2)
    v_smfmac_f32_16x16x64_bf16 v[28:31], v[44:47], v[56:63], v1
    ds_read_b128 v[56:59], v5 offset:12288
    v_smfmac_f32_16x16x64_bf16 v[32:35], v[44:47], a[184:191], v1
    ds_read_b128 v[60:63], v5 offset:13312
    v_smfmac_f32_16x16x64_bf16 v[20:23], v[48:51], a[176:183], v1
    s_waitcnt lgkmcnt(2)
    v_smfmac_f32_16x16x64_bf16 v[24:27], v[48:51], v[64:71], v1
    ds_read_b128 v[64:67], v5 offset:14336
    v_smfmac_f32_16x16x64_bf16 v[28:31], v[48:51], a[168:175], v1
    ds_read_b128 v[68:71], v5 offset:15360
    v_smfmac_f32_16x16x64_bf16 v[32:35], v[48:51], a[160:167], v1
    s_add_u32 s27, s26, 16777216
    s_mov_b32 m0, 8192
    s_nop 0
    buffer_load_dwordx4 v0, s[8:11], s27 offen offset:2048 sc1 lds
    buffer_load_dwordx4 v0, s[8:11], s27 offen offset:3072 sc1 lds
    s_mov_b32 m0, 12288
    s_add_u32 s59, s27, 4096
    buffer_load_dwordx4 v0, s[8:11], s59 offen offset:0 sc1 lds
    buffer_load_dwordx4 v0, s[8:11], s59 offen offset:1024 sc1 lds
    buffer_load_dwordx4 v0, s[8:11], s59 offen offset:2048 sc1 lds
    buffer_load_dwordx4 v0, s[8:11], s59 offen offset:3072 sc1 lds
    s_waitcnt vmcnt(6)
    s_barrier
    ds_read_b128 v[36:39], v6 offset:16384
    ds_read_b128 v[40:43], v6 offset:17408
    ds_read_b128 v[44:47], v6 offset:18432
    ds_read_b128 v[48:51], v6 offset:19456
    ds_read_b32 v11, v6 offset:20480
    s_waitcnt lgkmcnt(7)
    v_smfmac_f32_16x16x64_bf16 v[20:23], v[52:55], v[56:63], v1
    ds_read_b128 v[56:59], v5 offset:16384
    v_smfmac_f32_16x16x64_bf16 v[24:27], v[52:55], a[152:159], v1
    ds_read_b128 v[60:63], v5 offset:17408
    v_smfmac_f32_16x16x64_bf16 v[28:31], v[52:55], a[144:151], v1
    s_waitcnt lgkmcnt(4)
    v_max3_u32 v10, v36, v40, v44
    v_smfmac_f32_16x16x64_bf16 v[32:35], v[52:55], v[64:71], v1
    s_waitcnt lgkmcnt(2)
    v_max3_u32 v10, v10, v48, v11
    v_cmp_eq_u32 vcc, -1, v10
    s_cbranch_vccnz main_kernel_c1_3_rr
main_kernel_c1_3_rr_r:
    ds_read_b128 v[52:55], v6 offset:20480
    v_smfmac_f32_16x16x64_bf16 v[20:23], v[36:39], a[136:143], v1
    ds_read_b128 v[64:67], v5 offset:18432
    v_smfmac_f32_16x16x64_bf16 v[24:27], v[36:39], a[128:135], v1
    ds_read_b128 v[68:71], v5 offset:19456
    s_waitcnt lgkmcnt(3)
    v_smfmac_f32_16x16x64_bf16 v[20:23], v[40:43], v[56:63], v1
    ds_read_b128 v[56:59], v5 offset:20480
    v_smfmac_f32_16x16x64_bf16 v[24:27], v[40:43], a[120:127], v1
    ds_read_b128 v[60:63], v5 offset:21504
    buffer_store_dwordx4 v[72:75], v0, s[8:11], s4 offen offset:2048 sc1
    buffer_store_dwordx4 v[76:79], v0, s[8:11], s4 offen offset:3072 sc1
    s_mov_b32 s4, 0x10000000
    v_smfmac_f32_16x16x64_bf16 v[20:23], v[44:47], a[112:119], v1
    s_waitcnt lgkmcnt(2)
    v_smfmac_f32_16x16x64_bf16 v[24:27], v[44:47], v[64:71], v1
    ds_read_b128 v[64:67], v5 offset:22528
    v_smfmac_f32_16x16x64_bf16 v[20:23], v[48:51], a[104:111], v1
    ds_read_b128 v[68:71], v5 offset:23552
    v_smfmac_f32_16x16x64_bf16 v[24:27], v[48:51], a[96:103], v1
    s_waitcnt lgkmcnt(2)
    v_smfmac_f32_16x16x64_bf16 v[20:23], v[52:55], v[56:63], v1
    ds_read_b128 v[56:59], v5 offset:24576
    v_smfmac_f32_16x16x64_bf16 v[24:27], v[52:55], a[88:95], v1
    ds_read_b128 v[60:63], v5 offset:25600
    v_smfmac_f32_16x16x64_bf16 v[28:31], v[36:39], a[80:87], v1
    s_waitcnt lgkmcnt(2)
    v_smfmac_f32_16x16x64_bf16 v[32:35], v[36:39], v[64:71], v1
    ds_read_b128 v[64:67], v5 offset:26624
    s_nop 0
    v_permlane32_swap_b32 v20, v21
    v_smfmac_f32_16x16x64_bf16 v[28:31], v[40:43], a[72:79], v1
    ds_read_b128 v[68:71], v5 offset:27648
    v_permlane32_swap_b32 v22, v23
    v_smfmac_f32_16x16x64_bf16 v[32:35], v[40:43], a[64:71], v1
    s_waitcnt lgkmcnt(2)
    v_permlane32_swap_b32 v24, v25
    v_smfmac_f32_16x16x64_bf16 v[28:31], v[44:47], v[56:63], v1
    ds_read_b128 v[56:59], v5 offset:28672
    v_permlane32_swap_b32 v26, v27
    v_smfmac_f32_16x16x64_bf16 v[32:35], v[44:47], a[56:63], v1
    ds_read_b128 v[60:63], v5 offset:29696
    v_add_f32 v20, v20, v21
    v_add_f32 v22, v22, v23
    v_smfmac_f32_16x16x64_bf16 v[28:31], v[48:51], a[48:55], v1
    s_waitcnt lgkmcnt(2)
    v_add_f32 v24, v24, v25
    v_add_f32 v26, v26, v27
    v_smfmac_f32_16x16x64_bf16 v[32:35], v[48:51], v[64:71], v1
    ds_read_b128 v[64:67], v5 offset:30720
    v_mul_f32 v20, s40, v20
    v_mul_f32 v24, s40, v24
    v_smfmac_f32_16x16x64_bf16 v[28:31], v[52:55], a[40:47], v1
    ds_read_b128 v[68:71], v5 offset:31744
    v_mul_f32 v22, s40, v22
    v_mul_f32 v26, s40, v26
    v_smfmac_f32_16x16x64_bf16 v[32:35], v[52:55], a[32:39], v1
    s_waitcnt lgkmcnt(2)
    v_cvt_pk_bf16_f32 v20, v20, v24
    v_cvt_pk_bf16_f32 v21, v22, v26
    v_smfmac_f32_16x16x64_bf16 v[12:15], v[36:39], v[56:63], v1
    ds_write_b32 v2, v20 offset:26624
    ds_write_b32 v2, v21 offset:27200
    v_smfmac_f32_16x16x64_bf16 v[16:19], v[36:39], a[24:31], v1
    v_permlane32_swap_b32 v28, v29
    v_smfmac_f32_16x16x64_bf16 v[12:15], v[40:43], a[16:23], v1
    s_waitcnt lgkmcnt(2)
    v_permlane32_swap_b32 v30, v31
    v_smfmac_f32_16x16x64_bf16 v[16:19], v[40:43], v[64:71], v1
    ds_read_b128 v[40:43], v6 offset:22528
    v_permlane32_swap_b32 v32, v33
    v_smfmac_f32_16x16x64_bf16 v[12:15], v[44:47], a[8:15], v1
    v_permlane32_swap_b32 v34, v35
    v_smfmac_f32_16x16x64_bf16 v[16:19], v[44:47], a[0:7], v1
    ds_read_b128 v[44:47], v6 offset:23552
    v_add_f32 v28, v28, v29
    v_add_f32 v30, v30, v31
    v_smfmac_f32_16x16x64_bf16 v[12:15], v[48:51], v[248:255], v1
    v_add_f32 v32, v32, v33
    v_add_f32 v34, v34, v35
    v_smfmac_f32_16x16x64_bf16 v[16:19], v[48:51], v[240:247], v1
    ds_read_b128 v[48:51], v6 offset:24576
    v_cvt_pk_bf16_f32 v28, v28, v32
    v_cvt_pk_bf16_f32 v29, v30, v34
    v_smfmac_f32_16x16x64_bf16 v[12:15], v[52:55], v[232:239], v1
    ds_write_b32 v2, v28 offset:28928
    ds_write_b32 v2, v29 offset:29504
    v_smfmac_f32_16x16x64_bf16 v[16:19], v[52:55], v[224:231], v1
    ds_read_b128 v[52:55], v6 offset:25600
    s_waitcnt lgkmcnt(5)
    v_smfmac_f32_16x16x64_bf16 v[12:15], v[40:43], v[216:223], v1
    v_smfmac_f32_16x16x64_bf16 v[16:19], v[40:43], v[208:215], v1
    s_waitcnt vmcnt(2) lgkmcnt(1)
    s_barrier
    ds_read_b128 v[56:59], v0 offset:0
    ds_read_b128 v[20:23], v4 offset:26624
    v_smfmac_f32_16x16x64_bf16 v[12:15], v[44:47], v[200:207], v1
    ds_read_b128 v[60:63], v0 offset:1024
    ds_read_b128 v[24:27], v4 offset:26688
    v_smfmac_f32_16x16x64_bf16 v[16:19], v[44:47], v[192:199], v1
    ds_read_b128 v[64:67], v0 offset:2048
    ds_read_b128 v[72:75], v4 offset:26752
    v_smfmac_f32_16x16x64_bf16 v[12:15], v[48:51], v[184:191], v1
    ds_read_b128 v[68:71], v0 offset:3072
    ds_read_b128 v[76:79], v4 offset:26816
    v_smfmac_f32_16x16x64_bf16 v[16:19], v[48:51], v[176:183], v1
    ds_read_b128 v[36:39], v0 offset:4096
    ds_read_b128 v[40:43], v0 offset:5120
    s_waitcnt lgkmcnt(10)
    v_smfmac_f32_16x16x64_bf16 v[12:15], v[52:55], v[168:175], v1
    ds_read_b128 v[44:47], v0 offset:6144
    ds_read_b128 v[48:51], v0 offset:7168
    v_smfmac_f32_16x16x64_bf16 v[16:19], v[52:55], v[160:167], v1
    s_waitcnt lgkmcnt(10)
    v_mfma_f32_16x16x32_bf16 v[28:31], v[56:59], v[20:23], 0
    s_waitcnt lgkmcnt(8)
    v_mfma_f32_16x16x32_bf16 v[28:31], v[60:63], v[24:27], v[28:31]
    s_nop 0
    s_waitcnt lgkmcnt(6)
    v_cvt_pk_bf16_f32 v12, v12, v13
    v_cvt_pk_bf16_f32 v13, v14, v15
    v_mfma_f32_16x16x32_bf16 v[28:31], v[64:67], v[72:75], v[28:31]
    s_waitcnt lgkmcnt(4)
    v_cvt_pk_bf16_f32 v14, v16, v17
    v_cvt_pk_bf16_f32 v15, v18, v19
    v_mfma_f32_16x16x32_bf16 v[28:31], v[68:71], v[76:79], v[28:31]
    ds_write_b128 v0, v[12:15] offset:19456
    s_waitcnt lgkmcnt(4)
    v_mfma_f32_16x16x32_bf16 v[32:35], v[36:39], v[20:23], 0
    ds_read_b128 v[56:59], v3 offset:28928
    ds_read_b128 v[60:63], v3 offset:28992
    s_waitcnt lgkmcnt(5)
    v_mfma_f32_16x16x32_bf16 v[32:35], v[40:43], v[24:27], v[32:35]
    ds_read_b128 v[64:67], v3 offset:29056
    ds_read_b128 v[68:71], v3 offset:29120
    s_waitcnt lgkmcnt(6)
    v_mfma_f32_16x16x32_bf16 v[32:35], v[44:47], v[72:75], v[32:35]
    s_mov_b64 exec, s[36:37]
    v_exp_f32 v28, v28
    v_exp_f32 v29, v29
    s_mov_b64 exec, -1
    s_waitcnt lgkmcnt(5)
    v_mfma_f32_16x16x32_bf16 v[32:35], v[48:51], v[76:79], v[32:35]
    s_mov_b64 exec, s[36:37]
    v_exp_f32 v30, v30
    v_exp_f32 v31, v31
    s_mov_b64 exec, -1
    s_waitcnt lgkmcnt(4)
    s_barrier
    s_waitcnt lgkmcnt(3)
    v_mfma_f32_16x16x32_bf16 v[52:55], v[56:59], v[20:23], 0
    ds_read_b128 v[36:39], v0 offset:8192
    s_waitcnt lgkmcnt(3)
    v_cvt_pk_bf16_f32 v28, v28, v29
    v_cvt_pk_bf16_f32 v29, v30, v31
    v_mfma_f32_16x16x32_bf16 v[52:55], v[60:63], v[24:27], v[52:55]
    ds_read_b128 v[40:43], v0 offset:10240
    s_mov_b64 exec, s[36:37]
    v_exp_f32 v32, v32
    v_exp_f32 v33, v33
    s_mov_b64 exec, -1
    s_waitcnt lgkmcnt(3)
    v_mfma_f32_16x16x32_bf16 v[52:55], v[64:67], v[72:75], v[52:55]
    ds_read_b128 v[44:47], v0 offset:12288
    s_mov_b64 exec, s[36:37]
    v_exp_f32 v34, v34
    v_exp_f32 v35, v35
    s_mov_b64 exec, -1
    s_waitcnt lgkmcnt(3)
    v_mfma_f32_16x16x32_bf16 v[52:55], v[68:71], v[76:79], v[52:55]
    ds_read_b128 v[48:51], v0 offset:14336
    v_cvt_pk_bf16_f32 v30, v32, v33
    v_cvt_pk_bf16_f32 v31, v34, v35
    s_cmp_eq_u32 s57, 63
    s_cbranch_scc1 main_kernel_c1_3_last
    s_waitcnt lgkmcnt(3)
    v_mfma_f32_16x16x32_bf16 v[20:23], v[36:39], v[28:31], 0
    ds_read_b128 v[56:59], v0 offset:9216
    s_waitcnt lgkmcnt(3)
    v_mov_b32_dpp v32, v28 row_ror:8 row_mask:0xf bank_mask:0xf
    v_mov_b32_dpp v33, v29 row_ror:8 row_mask:0xf bank_mask:0xf
    v_mfma_f32_16x16x32_bf16 v[24:27], v[40:43], v[28:31], 0
    ds_read_b128 v[60:63], v0 offset:11264
    s_waitcnt lgkmcnt(3)
    v_mov_b32_dpp v34, v30 row_ror:8 row_mask:0xf bank_mask:0xf
    v_mov_b32_dpp v35, v31 row_ror:8 row_mask:0xf bank_mask:0xf
    v_mfma_f32_16x16x32_bf16 v[72:75], v[44:47], v[28:31], 0
    ds_read_b128 v[64:67], v0 offset:13312
    s_waitcnt lgkmcnt(3)
    v_mov_b64 v[16:17], s[24:25]
    v_mov_b64 v[18:19], s[24:25]
    v_mfma_f32_16x16x32_bf16 v[76:79], v[48:51], v[28:31], 0
    ds_read_b128 v[68:71], v0 offset:15360
    s_mov_b64 exec, s[36:37]
    v_exp_f32 v52, v52
    s_mov_b64 exec, -1
    v_mfma_f32_16x16x32_bf16 v[12:15], v[16:19], v[28:31], 0
    ds_read_b128 v[36:39], v0 offset:16384
    s_mov_b64 exec, s[36:37]
    v_exp_f32 v53, v53
    s_mov_b64 exec, -1
    s_waitcnt lgkmcnt(4)
    v_mfma_f32_16x16x32_bf16 v[20:23], v[56:59], v[32:35], v[20:23]
    ds_read_b128 v[40:43], v0 offset:17408
    s_mov_b64 exec, s[36:37]
    v_exp_f32 v54, v54
    s_mov_b64 exec, -1
    s_waitcnt lgkmcnt(4)
    v_mfma_f32_16x16x32_bf16 v[24:27], v[60:63], v[32:35], v[24:27]
    ds_read_b128 v[44:47], v0 offset:18432
    s_mov_b64 exec, s[36:37]
    v_exp_f32 v55, v55
    s_mov_b64 exec, -1
    s_waitcnt lgkmcnt(4)
    v_mfma_f32_16x16x32_bf16 v[72:75], v[64:67], v[32:35], v[72:75]
    ds_read_b128 v[48:51], v0 offset:19456
    s_waitcnt lgkmcnt(4)
    v_cvt_pk_bf16_f32 v52, v52, v53
    v_cvt_pk_bf16_f32 v53, v54, v55
    v_mfma_f32_16x16x32_bf16 v[76:79], v[68:71], v[32:35], v[76:79]
    v_mov_b64 v[10:11], s[16:17]
    v_mov_b32_dpp v54, v52 row_ror:8 row_mask:0xf bank_mask:0xf
main_kernel_c1_3_fin:
    s_waitcnt lgkmcnt(3)
    v_mfma_f32_16x16x16_bf16 v[20:23], v[36:37], v[52:53], v[20:23]
    v_mov_b32_dpp v55, v53 row_ror:8 row_mask:0xf bank_mask:0xf
    v_mov_b64 v[56:57], 0
    v_mfma_f32_16x16x16_bf16 v[12:15], v[10:11], v[52:53], v[12:15]
    s_waitcnt lgkmcnt(2)
    v_mov_b64 v[58:59], 0
    v_mov_b64 v[60:61], 0
    v_mfma_f32_16x16x16_bf16 v[24:27], v[40:41], v[52:53], v[24:27]
    v_mov_b64 v[62:63], 0
    v_mov_b64 v[64:65], 0
    v_mfma_f32_16x16x16_bf16 v[20:23], v[38:39], v[54:55], v[20:23]
    v_mov_b64 v[66:67], 0
    v_mov_b64 v[68:69], 0
    v_mfma_f32_16x16x16_bf16 v[24:27], v[42:43], v[54:55], v[24:27]
    s_waitcnt lgkmcnt(1)
    v_add_f32_dpp v12, v12, v12 row_ror:8 row_mask:0xf bank_mask:0xf
    v_mov_b64 v[70:71], 0
    v_mfma_f32_16x16x16_bf16 v[72:75], v[44:45], v[52:53], v[72:75]
    s_waitcnt lgkmcnt(0)
    v_rcp_f32 v14, v12
    v_mfma_f32_16x16x16_bf16 v[76:79], v[48:49], v[52:53], v[76:79]
    v_subrev_u32 v13, s68, v12
    v_cmp_lt_u32 vcc, s69, v13
    v_mfma_f32_16x16x16_bf16 v[72:75], v[46:47], v[54:55], v[72:75]
    s_cbranch_vccnz main_kernel_c1_3_zbad
main_kernel_c1_3_zok:
    v_mov_b64 v[28:29], 0
    v_mov_b64 v[30:31], 0
    v_mfma_f32_16x16x16_bf16 v[76:79], v[50:51], v[54:55], v[76:79]
    v_mul_f32 v20, v20, v14
    v_mul_f32 v21, v21, v14
    v_mul_f32 v22, v22, v14
    v_mul_f32 v23, v23, v14
    v_mul_f32 v24, v24, v14
    v_mul_f32 v25, v25, v14
    v_mul_f32 v26, v26, v14
    v_mul_f32 v27, v27, v14
    v_cvt_pk_bf16_f32 v20, v20, v21
    v_cvt_pk_bf16_f32 v21, v22, v23
    v_cvt_pk_bf16_f32 v22, v24, v25
    v_cvt_pk_bf16_f32 v23, v26, v27
    v_mul_f32 v72, v72, v14
    v_mul_f32 v73, v73, v14
    v_smfmac_f32_16x16x64_bf16 v[56:59], v[20:23], v[152:159], v1
    v_mul_f32 v74, v74, v14
    v_mul_f32 v75, v75, v14
    v_mul_f32 v76, v76, v14
    v_smfmac_f32_16x16x64_bf16 v[60:63], v[20:23], v[136:143], v1
    v_mul_f32 v77, v77, v14
    v_mul_f32 v78, v78, v14
    v_mul_f32 v79, v79, v14
    v_smfmac_f32_16x16x64_bf16 v[64:67], v[20:23], v[120:127], v1
    v_cvt_pk_bf16_f32 v72, v72, v73
    v_cvt_pk_bf16_f32 v73, v74, v75
    v_cvt_pk_bf16_f32 v74, v76, v77
    v_smfmac_f32_16x16x64_bf16 v[68:71], v[20:23], v[104:111], v1
    v_cvt_pk_bf16_f32 v75, v78, v79
    v_smfmac_f32_16x16x64_bf16 v[28:31], v[20:23], v[88:95], v1
    s_nop 0
    v_smfmac_f32_16x16x64_bf16 v[56:59], v[72:75], v[144:151], v1
    v_smfmac_f32_16x16x64_bf16 v[60:63], v[72:75], v[128:135], v1
    v_smfmac_f32_16x16x64_bf16 v[64:67], v[72:75], v[112:119], v1
    v_mov_b32 v5, v5
    v_mov_b32 v5, v5
    v_permlane32_swap_b32 v56, v57
    v_smfmac_f32_16x16x64_bf16 v[68:71], v[72:75], v[96:103], v1
    v_permlane32_swap_b32 v58, v59
    v_smfmac_f32_16x16x64_bf16 v[28:31], v[72:75], v[80:87], v1
    v_add_f32 v56, v56, v57
    v_add_f32 v58, v58, v59
    v_permlane32_swap_b32 v60, v61
    v_permlane32_swap_b32 v62, v63
    v_add_f32 v60, v60, v61
    v_add_f32 v62, v62, v63
    v_cvt_pk_bf16_f32 v36, v56, v60
    v_cvt_pk_bf16_f32 v38, v58, v62
    v_permlane32_swap_b32 v64, v65
    v_permlane32_swap_b32 v66, v67
    v_add_f32 v64, v64, v65
    v_add_f32 v66, v66, v67
    v_permlane32_swap_b32 v68, v69
    v_permlane32_swap_b32 v70, v71
    v_add_f32 v68, v68, v69
    v_add_f32 v70, v70, v71
    v_cvt_pk_bf16_f32 v37, v64, v68
    v_cvt_pk_bf16_f32 v39, v66, v70
    buffer_store_dwordx4 v[36:39], v0, s[8:11], s56 offen sc1
    v_permlane32_swap_b32 v28, v29
    v_permlane32_swap_b32 v30, v31
    v_add_f32 v28, v28, v29
    v_add_f32 v30, v30, v31
    v_cvt_pk_bf16_f32 v28, v28, v30
    buffer_store_dword v28, v7, s[8:11], s55 offen sc1
    s_add_u32 s27, s44, 1
    s_and_b32 s27, s27, 3
    s_mul_i32 s48, s27, 5120
    s_add_u32 s48, s48, s41
    s_lshl_b32 s27, s27, 15
    s_add_u32 s49, s27, s47
    v_add_u32 v10, 18432, v0
    v_add_u32 v11, 29056, v3
    v_cndmask_b32_e64 v10, v10, v11, s[42:43]
    ds_read_b128 v[72:75], v10 offset:0
    v_add_u32 v10, 19456, v0
    v_add_u32 v11, 29120, v3
    v_cndmask_b32_e64 v10, v10, v11, s[42:43]
    ds_read_b128 v[76:79], v10 offset:0
    s_lshl_b32 s4, s44, 18
    s_add_u32 s4, s4, s53
    ds_read_b128 v[56:59], v5 offset:0
    ds_read_b128 v[60:63], v5 offset:1024
    ds_read_b128 v[64:67], v5 offset:2048
    ds_read_b128 v[68:71], v5 offset:3072
    v_mov_b64 v[12:13], 0
    v_mov_b64 v[14:15], 0
    v_mov_b64 v[16:17], 0
    v_mov_b64 v[18:19], 0
    v_mov_b64 v[20:21], 0
    v_mov_b64 v[22:23], 0
    v_mov_b64 v[24:25], 0
    v_mov_b64 v[26:27], 0
    v_mov_b64 v[28:29], 0
    v_mov_b64 v[30:31], 0
    v_mov_b64 v[32:33], 0
    v_mov_b64 v[34:35], 0
    s_barrier
    s_and_b32 s26, s44, 63
    s_add_u32 s26, s26, 1
    s_min_u32 s26, s26, 63
    s_lshl_b32 s26, s26, 18
    s_add_u32 s26, s26, s50
    s_nop 15
    s_nop 15
    s_nop 14
    s_mov_b32 m0, 21504
    s_nop 0
    buffer_load_dwordx4 v0, s[8:11], s48 offen offset:3072 sc1 lds
    s_mov_b32 m0, 25600
    s_add_u32 s59, s48, 4096
    buffer_load_dwordx4 v0, s[8:11], s59 offen offset:0 sc1 lds
    s_add_u32 s44, s44, 1
    s_mov_b32 s70, 0
    s_waitcnt vmcnt(0) lgkmcnt(0)
    s_branch main_kernel_c1_3_top
main_kernel_c1_3_restart:
    s_waitcnt vmcnt(0) lgkmcnt(0)
    s_nop 7
    s_barrier
    s_mov_b32 m0, 21504
    s_nop 0
    buffer_load_dwordx4 v0, s[8:11], s48 offen offset:3072 sc1 lds
    s_mov_b32 m0, 25600
    s_add_u32 s59, s48, 4096
    buffer_load_dwordx4 v0, s[8:11], s59 offen offset:0 sc1 lds
    ds_read_b128 v[56:59], v5 offset:0
    ds_read_b128 v[60:63], v5 offset:1024
    ds_read_b128 v[64:67], v5 offset:2048
    ds_read_b128 v[68:71], v5 offset:3072
    v_mov_b64 v[12:13], 0
    v_mov_b64 v[14:15], 0
    v_mov_b64 v[16:17], 0
    v_mov_b64 v[18:19], 0
    v_mov_b64 v[20:21], 0
    v_mov_b64 v[22:23], 0
    v_mov_b64 v[24:25], 0
    v_mov_b64 v[26:27], 0
    v_mov_b64 v[28:29], 0
    v_mov_b64 v[30:31], 0
    v_mov_b64 v[32:33], 0
    v_mov_b64 v[34:35], 0
    s_waitcnt vmcnt(0) lgkmcnt(0)
    s_branch main_kernel_c1_3_top
main_kernel_c1_3_zbad:
    s_cmp_eq_u32 s70, 2
    s_cbranch_scc1 main_kernel_c1_3_zok
    v_cmp_u_f32 vcc, v12, v12
    s_cbranch_vccz main_kernel_c1_3_exact
    s_cmp_eq_u32 s70, 1
    s_cbranch_scc1 main_kernel_c1_3_exact
main_kernel_c1_3_vfy0:
    s_mov_b32 s70, 1
    s_mov_b32 s30, 0
    s_waitcnt vmcnt(0) lgkmcnt(0)
    s_nop 7
main_kernel_c1_3_vfy:
    v_mov_b32 v10, 0
    s_add_u32 s59, s48, 4096
    buffer_load_dwordx4 v[36:39], v0, s[8:11], s48 offen offset:0 sc1
    buffer_load_dwordx4 v[40:43], v0, s[8:11], s48 offen offset:1024 sc1
    buffer_load_dwordx4 v[44:47], v0, s[8:11], s48 offen offset:2048 sc1
    buffer_load_dwordx4 v[48:51], v0, s[8:11], s48 offen offset:3072 sc1
    buffer_load_dwordx4 v[52:55], v0, s[8:11], s59 offen offset:0 sc1
    s_waitcnt vmcnt(4)
    v_max3_u32 v10, v10, v36, v37
    v_max3_u32 v10, v10, v38, v39
    s_waitcnt vmcnt(3)
    v_max3_u32 v10, v10, v40, v41
    v_max3_u32 v10, v10, v42, v43
    s_waitcnt vmcnt(2)
    v_max3_u32 v10, v10, v44, v45
    v_max3_u32 v10, v10, v46, v47
    s_waitcnt vmcnt(1)
    v_max3_u32 v10, v10, v48, v49
    v_max3_u32 v10, v10, v50, v51
    s_waitcnt vmcnt(0)
    v_max3_u32 v10, v10, v52, v53
    v_max3_u32 v10, v10, v54, v55
    s_add_u32 s59, s49, 4096
    buffer_load_dwordx4 v[36:39], v0, s[8:11], s49 offen offset:0 sc1
    buffer_load_dwordx4 v[40:43], v0, s[8:11], s49 offen offset:1024 sc1
    buffer_load_dwordx4 v[44:47], v0, s[8:11], s49 offen offset:2048 sc1
    buffer_load_dwordx4 v[48:51], v0, s[8:11], s49 offen offset:3072 sc1
    buffer_load_dwordx4 v[52:55], v0, s[8:11], s59 offen offset:0 sc1
    s_waitcnt vmcnt(4)
    v_max3_u32 v10, v10, v36, v37
    v_max3_u32 v10, v10, v38, v39
    s_waitcnt vmcnt(3)
    v_max3_u32 v10, v10, v40, v41
    v_max3_u32 v10, v10, v42, v43
    s_waitcnt vmcnt(2)
    v_max3_u32 v10, v10, v44, v45
    v_max3_u32 v10, v10, v46, v47
    s_waitcnt vmcnt(1)
    v_max3_u32 v10, v10, v48, v49
    v_max3_u32 v10, v10, v50, v51
    s_waitcnt vmcnt(0)
    v_max3_u32 v10, v10, v52, v53
    v_max3_u32 v10, v10, v54, v55
    v_cmp_eq_u32 vcc, -1, v10
    s_cbranch_vccz main_kernel_c1_3_restart
    s_add_u32 s30, s30, 1
    s_cmp_ge_u32 s30, 60000
    s_cbranch_scc1 main_kernel_fail
    s_branch main_kernel_c1_3_vfy
main_kernel_c1_3_exact:
    s_nop 7
    s_mov_b32 s70, 2
    ds_read_b128 v[20:23], v3 offset:26624
    ds_read_b128 v[24:27], v3 offset:26688
    ds_read_b128 v[72:75], v3 offset:26752
    ds_read_b128 v[76:79], v3 offset:26816
    ds_read_b128 v[56:59], v0 offset:0
    s_waitcnt lgkmcnt(0)
    v_mfma_f32_16x16x32_bf16 v[28:31], v[56:59], v[20:23], 0
    s_nop 3
    ds_read_b128 v[60:63], v0 offset:1024
    s_waitcnt lgkmcnt(0)
    v_mfma_f32_16x16x32_bf16 v[28:31], v[60:63], v[24:27], v[28:31]
    s_nop 3
    ds_read_b128 v[56:59], v0 offset:2048
    s_waitcnt lgkmcnt(0)
    v_mfma_f32_16x16x32_bf16 v[28:31], v[56:59], v[72:75], v[28:31]
    s_nop 3
    ds_read_b128 v[60:63], v0 offset:3072
    s_waitcnt lgkmcnt(0)
    v_mfma_f32_16x16x32_bf16 v[28:31], v[60:63], v[76:79], v[28:31]
    s_nop 3
    ds_read_b128 v[56:59], v0 offset:4096
    s_waitcnt lgkmcnt(0)
    v_mfma_f32_16x16x32_bf16 v[32:35], v[56:59], v[20:23], 0
    s_nop 3
    ds_read_b128 v[60:63], v0 offset:5120
    s_waitcnt lgkmcnt(0)
    v_mfma_f32_16x16x32_bf16 v[32:35], v[60:63], v[24:27], v[32:35]
    s_nop 3
    ds_read_b128 v[56:59], v0 offset:6144
    s_waitcnt lgkmcnt(0)
    v_mfma_f32_16x16x32_bf16 v[32:35], v[56:59], v[72:75], v[32:35]
    s_nop 3
    ds_read_b128 v[60:63], v0 offset:7168
    s_waitcnt lgkmcnt(0)
    v_mfma_f32_16x16x32_bf16 v[32:35], v[60:63], v[76:79], v[32:35]
    s_nop 3
    ds_read_b128 v[56:59], v3 offset:28928
    s_waitcnt lgkmcnt(0)
    v_mfma_f32_16x16x32_bf16 v[52:55], v[56:59], v[20:23], 0
    s_nop 3
    ds_read_b128 v[60:63], v3 offset:28992
    s_waitcnt lgkmcnt(0)
    v_mfma_f32_16x16x32_bf16 v[52:55], v[60:63], v[24:27], v[52:55]
    s_nop 3
    ds_read_b128 v[56:59], v3 offset:29056
    s_waitcnt lgkmcnt(0)
    v_mfma_f32_16x16x32_bf16 v[52:55], v[56:59], v[72:75], v[52:55]
    s_nop 3
    ds_read_b128 v[60:63], v3 offset:29120
    s_waitcnt lgkmcnt(0)
    v_mfma_f32_16x16x32_bf16 v[52:55], v[60:63], v[76:79], v[52:55]
    s_nop 3
    v_max3_f32 v64, v28, v29, v30
    v_max3_f32 v64, v64, v31, v32
    v_max3_f32 v64, v64, v33, v34
    s_nop 0
    v_max3_f32 v64, v64, v35, v52
    v_max3_f32 v64, v64, v53, v54
    v_max_f32 v64, v64, v55
    v_mov_b32 v65, v64
    s_nop 1
    v_permlane16_swap_b32 v64, v65
    v_max_f32 v64, v64, v65
    v_mov_b32 v65, v64
    s_nop 1
    v_permlane32_swap_b32 v64, v65
    v_max_f32 v64, v64, v65
    v_sub_f32 v28, v28, v64
    v_exp_f32 v28, v28
    s_nop 0
    v_cndmask_b32_e64 v28, 0, v28, s[36:37]
    v_sub_f32 v29, v29, v64
    v_exp_f32 v29, v29
    s_nop 0
    v_cndmask_b32_e64 v29, 0, v29, s[36:37]
    v_sub_f32 v30, v30, v64
    v_exp_f32 v30, v30
    s_nop 0
    v_cndmask_b32_e64 v30, 0, v30, s[36:37]
    v_sub_f32 v31, v31, v64
    v_exp_f32 v31, v31
    s_nop 0
    v_cndmask_b32_e64 v31, 0, v31, s[36:37]
    v_sub_f32 v32, v32, v64
    v_exp_f32 v32, v32
    s_nop 0
    v_cndmask_b32_e64 v32, 0, v32, s[36:37]
    v_sub_f32 v33, v33, v64
    v_exp_f32 v33, v33
    s_nop 0
    v_cndmask_b32_e64 v33, 0, v33, s[36:37]
    v_sub_f32 v34, v34, v64
    v_exp_f32 v34, v34
    s_nop 0
    v_cndmask_b32_e64 v34, 0, v34, s[36:37]
    v_sub_f32 v35, v35, v64
    v_exp_f32 v35, v35
    s_nop 0
    v_cndmask_b32_e64 v35, 0, v35, s[36:37]
    v_sub_f32 v52, v52, v64
    v_exp_f32 v52, v52
    s_nop 0
    v_cndmask_b32_e64 v52, 0, v52, s[36:37]
    v_sub_f32 v53, v53, v64
    v_exp_f32 v53, v53
    s_nop 0
    v_cndmask_b32_e64 v53, 0, v53, s[36:37]
    v_sub_f32 v54, v54, v64
    v_exp_f32 v54, v54
    s_nop 0
    v_cndmask_b32_e64 v54, 0, v54, s[36:37]
    v_sub_f32 v55, v55, v64
    v_exp_f32 v55, v55
    s_nop 0
    v_cndmask_b32_e64 v55, 0, v55, s[36:37]
    v_cvt_pk_bf16_f32 v28, v28, v29
    v_cvt_pk_bf16_f32 v29, v30, v31
    v_cvt_pk_bf16_f32 v30, v32, v33
    v_cvt_pk_bf16_f32 v31, v34, v35
    v_mov_b32_dpp v32, v28 row_ror:8 row_mask:0xf bank_mask:0xf
    v_mov_b32_dpp v33, v29 row_ror:8 row_mask:0xf bank_mask:0xf
    v_mov_b32_dpp v34, v30 row_ror:8 row_mask:0xf bank_mask:0xf
    v_mov_b32_dpp v35, v31 row_ror:8 row_mask:0xf bank_mask:0xf
    v_cvt_pk_bf16_f32 v52, v52, v53
    v_cvt_pk_bf16_f32 v53, v54, v55
    s_nop 0
    v_mov_b32_dpp v54, v52 row_ror:8 row_mask:0xf bank_mask:0xf
    v_mfma_f32_16x16x32_bf16 v[12:15], v[16:19], v[28:31], 0
    ds_read_b128 v[56:59], v0 offset:8192
    s_waitcnt lgkmcnt(0)
    v_mfma_f32_16x16x32_bf16 v[20:23], v[56:59], v[28:31], 0
    s_nop 3
    ds_read_b128 v[60:63], v0 offset:9216
    s_waitcnt lgkmcnt(0)
    v_mfma_f32_16x16x32_bf16 v[20:23], v[60:63], v[32:35], v[20:23]
    s_nop 3
    ds_read_b128 v[56:59], v0 offset:10240
    s_waitcnt lgkmcnt(0)
    v_mfma_f32_16x16x32_bf16 v[24:27], v[56:59], v[28:31], 0
    s_nop 3
    ds_read_b128 v[60:63], v0 offset:11264
    s_waitcnt lgkmcnt(0)
    v_mfma_f32_16x16x32_bf16 v[24:27], v[60:63], v[32:35], v[24:27]
    s_nop 3
    ds_read_b128 v[56:59], v0 offset:12288
    s_waitcnt lgkmcnt(0)
    v_mfma_f32_16x16x32_bf16 v[72:75], v[56:59], v[28:31], 0
    s_nop 3
    ds_read_b128 v[60:63], v0 offset:13312
    s_waitcnt lgkmcnt(0)
    v_mfma_f32_16x16x32_bf16 v[72:75], v[60:63], v[32:35], v[72:75]
    s_nop 3
    ds_read_b128 v[56:59], v0 offset:14336
    s_waitcnt lgkmcnt(0)
    v_mfma_f32_16x16x32_bf16 v[76:79], v[56:59], v[28:31], 0
    s_nop 3
    ds_read_b128 v[60:63], v0 offset:15360
    s_waitcnt lgkmcnt(0)
    v_mfma_f32_16x16x32_bf16 v[76:79], v[60:63], v[32:35], v[76:79]
    s_nop 3
    s_nop 7
    s_branch main_kernel_c1_3_fin
main_kernel_c1_3_last:
    s_cmp_lg_u32 s70, 0
    s_cbranch_scc1 main_kernel_c1_3_last2
    v_cmp_u_f32 vcc, v32, v32
    s_cbranch_vccnz main_kernel_c1_3_vfy0
main_kernel_c1_3_last2:
    s_waitcnt vmcnt(0) lgkmcnt(0)
    s_nop 7
    v_add_u32 v10, 18432, v0
    v_add_u32 v11, 29056, v3
    v_cndmask_b32_e64 v10, v10, v11, s[42:43]
    ds_read_b128 v[72:75], v10 offset:0
    v_add_u32 v10, 19456, v0
    v_add_u32 v11, 29120, v3
    v_cndmask_b32_e64 v10, v10, v11, s[42:43]
    ds_read_b128 v[76:79], v10 offset:0
    s_lshl_b32 s4, s44, 18
    s_add_u32 s4, s4, s53
    s_waitcnt lgkmcnt(1)
    buffer_store_dwordx4 v[72:75], v0, s[8:11], s4 offen offset:2048 sc1
    s_waitcnt lgkmcnt(0)
    buffer_store_dwordx4 v[76:79], v0, s[8:11], s4 offen offset:3072 sc1
    s_mov_b32 s4, 0x10000000
    s_waitcnt vmcnt(0)
    s_barrier
    s_add_u32 s44, s44, 1
    s_cmp_eq_u32 s44, 128
    s_cbranch_scc1 main_kernel_end
    s_branch main_kernel_c1_3_layer
main_kernel_c1_3_lr:
    s_mov_b32 s30, 0
main_kernel_c1_3_lr_l:
    s_waitcnt lgkmcnt(0)
    s_and_b32 s27, s30, 1
    s_cbranch_scc0 main_kernel_c1_3_lr_n
    s_waitcnt vmcnt(2)
    s_mov_b32 m0, 21504
    s_nop 0
    buffer_load_dwordx4 v0, s[8:11], s48 offen offset:3072 sc1 lds
    s_mov_b32 m0, 25600
    s_add_u32 s59, s48, 4096
    buffer_load_dwordx4 v0, s[8:11], s59 offen offset:0 sc1 lds
main_kernel_c1_3_lr_n:
    ds_read_b128 v[36:39], v6 offset:21504
    ds_read_b128 v[40:43], v6 offset:22528
    ds_read_b128 v[44:47], v6 offset:23552
    ds_read_b128 v[48:51], v6 offset:24576
    ds_read_b128 v[52:55], v6 offset:25600
    s_waitcnt lgkmcnt(2)
    v_max3_u32 v10, v36, v40, v44
    s_waitcnt lgkmcnt(0)
    v_max3_u32 v10, v10, v48, v52
    v_cmp_eq_u32 vcc, -1, v10
    s_cbranch_vccz main_kernel_c1_3_lr_d
    s_add_u32 s30, s30, 1
    s_cmp_ge_u32 s30, 480000
    s_cbranch_scc1 main_kernel_fail
    s_branch main_kernel_c1_3_lr_l
main_kernel_c1_3_lr_d:
    ds_read_b128 v[56:59], v5 offset:0
    ds_read_b128 v[60:63], v5 offset:1024
    ds_read_b128 v[64:67], v5 offset:2048
    ds_read_b128 v[68:71], v5 offset:3072
    v_mov_b64 v[12:13], 0
    v_mov_b64 v[14:15], 0
    v_mov_b64 v[16:17], 0
    v_mov_b64 v[18:19], 0
    v_mov_b64 v[20:21], 0
    v_mov_b64 v[22:23], 0
    v_mov_b64 v[24:25], 0
    v_mov_b64 v[26:27], 0
    v_mov_b64 v[28:29], 0
    v_mov_b64 v[30:31], 0
    v_mov_b64 v[32:33], 0
    v_mov_b64 v[34:35], 0
    s_waitcnt lgkmcnt(0)
    s_branch main_kernel_c1_3_lr_r
main_kernel_c1_3_rr:
    s_mov_b32 s30, 0
main_kernel_c1_3_rr_l:
    s_waitcnt lgkmcnt(0)
    s_and_b32 s27, s30, 1
    s_cbranch_scc1 main_kernel_c1_3_rr_n
    s_waitcnt vmcnt(1)
    s_mov_b32 m0, 20480
    s_add_u32 s59, s49, 4096
    buffer_load_dwordx4 v0, s[8:11], s59 offen offset:0 sc1 lds
main_kernel_c1_3_rr_n:
    ds_read_b128 v[36:39], v6 offset:16384
    ds_read_b128 v[40:43], v6 offset:17408
    ds_read_b128 v[44:47], v6 offset:18432
    ds_read_b128 v[48:51], v6 offset:19456
    ds_read_b32 v11, v6 offset:20480
    s_waitcnt lgkmcnt(2)
    v_max3_u32 v10, v36, v40, v44
    s_waitcnt lgkmcnt(0)
    v_max3_u32 v10, v10, v48, v11
    v_cmp_eq_u32 vcc, -1, v10
    s_cbranch_vccz main_kernel_c1_3_rr_d
    s_add_u32 s30, s30, 1
    s_cmp_ge_u32 s30, 480000
    s_cbranch_scc1 main_kernel_fail
    s_branch main_kernel_c1_3_rr_l
main_kernel_c1_3_rr_d:
    s_branch main_kernel_c1_3_rr_r
main_kernel_bulk:
    s_waitcnt vmcnt(0)
    s_mul_i32 s42, s21, 10240
    s_mul_i32 s47, s101, 3145728
    s_add_u32 s47, s47, s42
    s_add_u32 s47, s47, 29360128
    s_mul_i32 s50, s101, 33554432
    s_lshl_b32 s27, s22, 13
    s_add_u32 s50, s50, s27
    s_add_u32 s50, s50, 37748736
    s_lshl_b32 s43, s101, 6
    s_cmp_ge_u32 s20, 4
    s_cbranch_scc1 main_kernel_qao
    s_sub_u32 s27, s20, 2
    s_mul_i32 s28, s27, 16777216
    s_add_u32 s50, s50, s28
    s_add_u32 s28, s27, 10
    s_lshl_b32 s28, s21, s28
    s_add_u32 s50, s50, s28
    s_lshl_b32 s51, s27, 7
    s_lshl_b32 s28, s22, 8
    s_add_u32 s51, s51, s28
    s_add_u32 s51, s51, 167886848
    s_mov_b32 s44, 0
    s_mov_b32 s45, 0
    s_min_u32 s27, s44, 63
    s_mul_i32 s27, s27, 40960
    s_add_u32 s27, s27, s47
    s_add_u32 s28, s45, s42
    s_mov_b32 m0, s28
    s_nop 0
    buffer_load_dwordx4 v0, s[8:11], s27 offen offset:0 sc1 lds
    buffer_load_dwordx4 v0, s[8:11], s27 offen offset:1024 sc1 lds
    buffer_load_dwordx4 v0, s[8:11], s27 offen offset:2048 sc1 lds
    buffer_load_dwordx4 v0, s[8:11], s27 offen offset:3072 sc1 lds
    s_add_u32 s27, s27, 4096
    s_add_u32 s28, s28, 4096
    s_mov_b32 m0, s28
    s_nop 0
    buffer_load_dwordx4 v0, s[8:11], s27 offen offset:0 sc1 lds
    buffer_load_dwordx4 v0, s[8:11], s27 offen offset:1024 sc1 lds
    buffer_load_dwordx4 v0, s[8:11], s27 offen offset:2048 sc1 lds
    buffer_load_dwordx4 v0, s[8:11], s27 offen offset:3072 sc1 lds
    s_add_u32 s27, s27, 4096
    s_add_u32 s28, s28, 4096
    s_mov_b32 m0, s28
    s_nop 0
    buffer_load_dwordx4 v0, s[8:11], s27 offen offset:0 sc1 lds
    buffer_load_dwordx4 v0, s[8:11], s27 offen offset:1024 sc1 lds
    s_waitcnt vmcnt(0)
    s_barrier
main_kernel_kv_top:
    v_add_u32 v1, s45, v0
    s_sub_u32 s45, 40960, s45
    s_add_u32 s44, s44, 1
    s_min_u32 s27, s44, 63
    s_mul_i32 s27, s27, 40960
    s_add_u32 s27, s27, s47
    s_add_u32 s28, s45, s42
    s_mov_b32 m0, s28
    s_nop 0
    buffer_load_dwordx4 v0, s[8:11], s27 offen offset:0 sc1 lds
    buffer_load_dwordx4 v0, s[8:11], s27 offen offset:1024 sc1 lds
    buffer_load_dwordx4 v0, s[8:11], s27 offen offset:2048 sc1 lds
    buffer_load_dwordx4 v0, s[8:11], s27 offen offset:3072 sc1 lds
    s_add_u32 s27, s27, 4096
    s_add_u32 s28, s28, 4096
    s_mov_b32 m0, s28
    s_nop 0
    buffer_load_dwordx4 v0, s[8:11], s27 offen offset:0 sc1 lds
    buffer_load_dwordx4 v0, s[8:11], s27 offen offset:1024 sc1 lds
    buffer_load_dwordx4 v0, s[8:11], s27 offen offset:2048 sc1 lds
    buffer_load_dwordx4 v0, s[8:11], s27 offen offset:3072 sc1 lds
    s_add_u32 s27, s27, 4096
    s_add_u32 s28, s28, 4096
    s_mov_b32 m0, s28
    s_nop 0
    buffer_load_dwordx4 v0, s[8:11], s27 offen offset:0 sc1 lds
    buffer_load_dwordx4 v0, s[8:11], s27 offen offset:1024 sc1 lds
    s_cmp_eq_u32 s20, 3
    s_cbranch_scc1 main_kernel_kv_v
    ds_read_b128 v[32:35], v1 offset:0
    ds_read_b128 v[36:39], v1 offset:1024
    ds_read_b128 v[40:43], v1 offset:2048
    ds_read_b128 v[44:47], v1 offset:3072
    ds_read_b128 v[48:51], v1 offset:4096
    ds_read_b128 v[52:55], v1 offset:5120
    s_waitcnt lgkmcnt(5)
    v_mfma_f32_16x16x32_bf16 v[8:11], a[0:3], v[32:35], 0
    v_mfma_f32_16x16x32_bf16 v[12:15], a[80:83], v[32:35], 0
    ds_read_b128 v[32:35], v1 offset:6144
    s_waitcnt lgkmcnt(5)
    v_mfma_f32_16x16x32_bf16 v[8:11], a[4:7], v[36:39], v[8:11]
    v_mfma_f32_16x16x32_bf16 v[12:15], a[84:87], v[36:39], v[12:15]
    ds_read_b128 v[36:39], v1 offset:7168
    s_waitcnt lgkmcnt(5)
    v_mfma_f32_16x16x32_bf16 v[8:11], a[8:11], v[40:43], v[8:11]
    v_mfma_f32_16x16x32_bf16 v[12:15], a[88:91], v[40:43], v[12:15]
    ds_read_b128 v[40:43], v1 offset:8192
    s_waitcnt lgkmcnt(5)
    v_mfma_f32_16x16x32_bf16 v[8:11], a[12:15], v[44:47], v[8:11]
    v_mfma_f32_16x16x32_bf16 v[12:15], a[92:95], v[44:47], v[12:15]
    ds_read_b128 v[44:47], v1 offset:9216
    s_waitcnt lgkmcnt(5)
    v_mfma_f32_16x16x32_bf16 v[8:11], a[16:19], v[48:51], v[8:11]
    v_mfma_f32_16x16x32_bf16 v[12:15], a[96:99], v[48:51], v[12:15]
    ds_read_b128 v[48:51], v1 offset:10240
    s_waitcnt lgkmcnt(5)
    v_mfma_f32_16x16x32_bf16 v[8:11], a[20:23], v[52:55], v[8:11]
    v_mfma_f32_16x16x32_bf16 v[12:15], a[100:103], v[52:55], v[12:15]
    ds_read_b128 v[52:55], v1 offset:11264
    s_waitcnt lgkmcnt(5)
    v_mfma_f32_16x16x32_bf16 v[8:11], a[24:27], v[32:35], v[8:11]
    v_mfma_f32_16x16x32_bf16 v[12:15], a[104:107], v[32:35], v[12:15]
    ds_read_b128 v[32:35], v1 offset:12288
    s_waitcnt lgkmcnt(5)
    v_mfma_f32_16x16x32_bf16 v[8:11], a[28:31], v[36:39], v[8:11]
    v_mfma_f32_16x16x32_bf16 v[12:15], a[108:111], v[36:39], v[12:15]
    ds_read_b128 v[36:39], v1 offset:13312
    s_waitcnt lgkmcnt(5)
    v_mfma_f32_16x16x32_bf16 v[8:11], a[32:35], v[40:43], v[8:11]
    v_mfma_f32_16x16x32_bf16 v[12:15], a[112:115], v[40:43], v[12:15]
    ds_read_b128 v[40:43], v1 offset:14336
    s_waitcnt lgkmcnt(5)
    v_mfma_f32_16x16x32_bf16 v[8:11], a[36:39], v[44:47], v[8:11]
    v_mfma_f32_16x16x32_bf16 v[12:15], a[116:119], v[44:47], v[12:15]
    ds_read_b128 v[44:47], v1 offset:15360
    s_waitcnt lgkmcnt(5)
    v_mfma_f32_16x16x32_bf16 v[8:11], a[40:43], v[48:51], v[8:11]
    v_mfma_f32_16x16x32_bf16 v[12:15], a[120:123], v[48:51], v[12:15]
    ds_read_b128 v[48:51], v1 offset:16384
    s_waitcnt lgkmcnt(5)
    v_mfma_f32_16x16x32_bf16 v[8:11], a[44:47], v[52:55], v[8:11]
    v_mfma_f32_16x16x32_bf16 v[12:15], a[124:127], v[52:55], v[12:15]
    ds_read_b128 v[52:55], v1 offset:17408
    s_waitcnt lgkmcnt(5)
    v_mfma_f32_16x16x32_bf16 v[8:11], a[48:51], v[32:35], v[8:11]
    v_mfma_f32_16x16x32_bf16 v[12:15], a[128:131], v[32:35], v[12:15]
    ds_read_b128 v[32:35], v1 offset:18432
    s_waitcnt lgkmcnt(5)
    v_mfma_f32_16x16x32_bf16 v[8:11], a[52:55], v[36:39], v[8:11]
    v_mfma_f32_16x16x32_bf16 v[12:15], a[132:135], v[36:39], v[12:15]
    ds_read_b128 v[36:39], v1 offset:19456
    s_waitcnt lgkmcnt(5)
    v_mfma_f32_16x16x32_bf16 v[8:11], a[56:59], v[40:43], v[8:11]
    v_mfma_f32_16x16x32_bf16 v[12:15], a[136:139], v[40:43], v[12:15]
    ds_read_b128 v[40:43], v1 offset:20480
    s_waitcnt lgkmcnt(5)
    v_mfma_f32_16x16x32_bf16 v[8:11], a[60:63], v[44:47], v[8:11]
    v_mfma_f32_16x16x32_bf16 v[12:15], a[140:143], v[44:47], v[12:15]
    ds_read_b128 v[44:47], v1 offset:21504
    s_waitcnt lgkmcnt(5)
    v_mfma_f32_16x16x32_bf16 v[8:11], a[64:67], v[48:51], v[8:11]
    v_mfma_f32_16x16x32_bf16 v[12:15], a[144:147], v[48:51], v[12:15]
    ds_read_b128 v[48:51], v1 offset:22528
    s_waitcnt lgkmcnt(5)
    v_mfma_f32_16x16x32_bf16 v[8:11], a[68:71], v[52:55], v[8:11]
    v_mfma_f32_16x16x32_bf16 v[12:15], a[148:151], v[52:55], v[12:15]
    ds_read_b128 v[52:55], v1 offset:23552
    s_waitcnt lgkmcnt(5)
    v_mfma_f32_16x16x32_bf16 v[8:11], a[72:75], v[32:35], v[8:11]
    v_mfma_f32_16x16x32_bf16 v[12:15], a[152:155], v[32:35], v[12:15]
    ds_read_b128 v[32:35], v1 offset:24576
    s_waitcnt lgkmcnt(5)
    v_mfma_f32_16x16x32_bf16 v[8:11], a[76:79], v[36:39], v[8:11]
    v_mfma_f32_16x16x32_bf16 v[12:15], a[156:159], v[36:39], v[12:15]
    ds_read_b128 v[36:39], v1 offset:25600
    s_waitcnt lgkmcnt(5)
    v_mfma_f32_16x16x32_bf16 v[16:19], a[0:3], v[40:43], 0
    v_mfma_f32_16x16x32_bf16 v[20:23], a[80:83], v[40:43], 0
    ds_read_b128 v[40:43], v1 offset:26624
    s_waitcnt lgkmcnt(5)
    v_mfma_f32_16x16x32_bf16 v[16:19], a[4:7], v[44:47], v[16:19]
    v_mfma_f32_16x16x32_bf16 v[20:23], a[84:87], v[44:47], v[20:23]
    ds_read_b128 v[44:47], v1 offset:27648
    s_waitcnt lgkmcnt(5)
    v_mfma_f32_16x16x32_bf16 v[16:19], a[8:11], v[48:51], v[16:19]
    v_mfma_f32_16x16x32_bf16 v[20:23], a[88:91], v[48:51], v[20:23]
    ds_read_b128 v[48:51], v1 offset:28672
    s_waitcnt lgkmcnt(5)
    v_mfma_f32_16x16x32_bf16 v[16:19], a[12:15], v[52:55], v[16:19]
    v_mfma_f32_16x16x32_bf16 v[20:23], a[92:95], v[52:55], v[20:23]
    ds_read_b128 v[52:55], v1 offset:29696
    s_waitcnt lgkmcnt(5)
    v_mfma_f32_16x16x32_bf16 v[16:19], a[16:19], v[32:35], v[16:19]
    v_mfma_f32_16x16x32_bf16 v[20:23], a[96:99], v[32:35], v[20:23]
    ds_read_b128 v[32:35], v1 offset:30720
    s_waitcnt lgkmcnt(5)
    v_mfma_f32_16x16x32_bf16 v[16:19], a[20:23], v[36:39], v[16:19]
    v_mfma_f32_16x16x32_bf16 v[20:23], a[100:103], v[36:39], v[20:23]
    ds_read_b128 v[36:39], v1 offset:31744
    s_waitcnt lgkmcnt(5)
    v_mfma_f32_16x16x32_bf16 v[16:19], a[24:27], v[40:43], v[16:19]
    v_mfma_f32_16x16x32_bf16 v[20:23], a[104:107], v[40:43], v[20:23]
    ds_read_b128 v[40:43], v1 offset:32768
    s_waitcnt lgkmcnt(5)
    v_mfma_f32_16x16x32_bf16 v[16:19], a[28:31], v[44:47], v[16:19]
    v_mfma_f32_16x16x32_bf16 v[20:23], a[108:111], v[44:47], v[20:23]
    ds_read_b128 v[44:47], v1 offset:33792
    s_waitcnt lgkmcnt(5)
    v_mfma_f32_16x16x32_bf16 v[16:19], a[32:35], v[48:51], v[16:19]
    v_mfma_f32_16x16x32_bf16 v[20:23], a[112:115], v[48:51], v[20:23]
    ds_read_b128 v[48:51], v1 offset:34816
    s_waitcnt lgkmcnt(5)
    v_mfma_f32_16x16x32_bf16 v[16:19], a[36:39], v[52:55], v[16:19]
    v_mfma_f32_16x16x32_bf16 v[20:23], a[116:119], v[52:55], v[20:23]
    ds_read_b128 v[52:55], v1 offset:35840
    s_waitcnt lgkmcnt(5)
    v_mfma_f32_16x16x32_bf16 v[16:19], a[40:43], v[32:35], v[16:19]
    v_mfma_f32_16x16x32_bf16 v[20:23], a[120:123], v[32:35], v[20:23]
    ds_read_b128 v[32:35], v1 offset:36864
    s_waitcnt lgkmcnt(5)
    v_mfma_f32_16x16x32_bf16 v[16:19], a[44:47], v[36:39], v[16:19]
    v_mfma_f32_16x16x32_bf16 v[20:23], a[124:127], v[36:39], v[20:23]
    ds_read_b128 v[36:39], v1 offset:37888
    s_waitcnt lgkmcnt(5)
    v_mfma_f32_16x16x32_bf16 v[16:19], a[48:51], v[40:43], v[16:19]
    v_mfma_f32_16x16x32_bf16 v[20:23], a[128:131], v[40:43], v[20:23]
    ds_read_b128 v[40:43], v1 offset:38912
    s_waitcnt lgkmcnt(5)
    v_mfma_f32_16x16x32_bf16 v[16:19], a[52:55], v[44:47], v[16:19]
    v_mfma_f32_16x16x32_bf16 v[20:23], a[132:135], v[44:47], v[20:23]
    ds_read_b128 v[44:47], v1 offset:39936
    s_waitcnt lgkmcnt(5)
    v_mfma_f32_16x16x32_bf16 v[16:19], a[56:59], v[48:51], v[16:19]
    v_mfma_f32_16x16x32_bf16 v[20:23], a[136:139], v[48:51], v[20:23]
    s_waitcnt lgkmcnt(4)
    v_mfma_f32_16x16x32_bf16 v[16:19], a[60:63], v[52:55], v[16:19]
    v_mfma_f32_16x16x32_bf16 v[20:23], a[140:143], v[52:55], v[20:23]
    s_waitcnt lgkmcnt(3)
    v_mfma_f32_16x16x32_bf16 v[16:19], a[64:67], v[32:35], v[16:19]
    v_mfma_f32_16x16x32_bf16 v[20:23], a[144:147], v[32:35], v[20:23]
    s_waitcnt lgkmcnt(2)
    v_mfma_f32_16x16x32_bf16 v[16:19], a[68:71], v[36:39], v[16:19]
    v_mfma_f32_16x16x32_bf16 v[20:23], a[148:151], v[36:39], v[20:23]
    s_waitcnt lgkmcnt(1)
    v_mfma_f32_16x16x32_bf16 v[16:19], a[72:75], v[40:43], v[16:19]
    v_mfma_f32_16x16x32_bf16 v[20:23], a[152:155], v[40:43], v[20:23]
    s_waitcnt lgkmcnt(0)
    v_mfma_f32_16x16x32_bf16 v[16:19], a[76:79], v[44:47], v[16:19]
    v_mfma_f32_16x16x32_bf16 v[20:23], a[156:159], v[44:47], v[20:23]
    s_add_u32 s27, s50, 4096
    v_cvt_pk_bf16_f32 v24, v8, v12
    v_cvt_pk_bf16_f32 v25, v9, v13
    v_cvt_pk_bf16_f32 v26, v10, v14
    v_cvt_pk_bf16_f32 v27, v11, v15
    buffer_store_dwordx4 v[24:27], v0, s[8:11], s50 offen sc1
    s_nop 1
    v_cvt_pk_bf16_f32 v28, v16, v20
    v_cvt_pk_bf16_f32 v29, v17, v21
    v_cvt_pk_bf16_f32 v30, v18, v22
    v_cvt_pk_bf16_f32 v31, v19, v23
    buffer_store_dwordx4 v[28:31], v0, s[8:11], s27 offen sc1
    s_branch main_kernel_kv_c
main_kernel_kv_v:
    ds_read_b128 v[32:35], v1 offset:0
    ds_read_b128 v[36:39], v1 offset:1024
    ds_read_b128 v[40:43], v1 offset:2048
    ds_read_b128 v[44:47], v1 offset:3072
    ds_read_b128 v[48:51], v1 offset:4096
    ds_read_b128 v[52:55], v1 offset:5120
    s_waitcnt lgkmcnt(5)
    v_mfma_f32_16x16x32_bf16 v[8:11], v[32:35], a[0:3], 0
    v_mfma_f32_16x16x32_bf16 v[12:15], v[32:35], a[80:83], 0
    ds_read_b128 v[32:35], v1 offset:6144
    s_waitcnt lgkmcnt(5)
    v_mfma_f32_16x16x32_bf16 v[8:11], v[36:39], a[4:7], v[8:11]
    v_mfma_f32_16x16x32_bf16 v[12:15], v[36:39], a[84:87], v[12:15]
    ds_read_b128 v[36:39], v1 offset:7168
    s_waitcnt lgkmcnt(5)
    v_mfma_f32_16x16x32_bf16 v[8:11], v[40:43], a[8:11], v[8:11]
    v_mfma_f32_16x16x32_bf16 v[12:15], v[40:43], a[88:91], v[12:15]
    ds_read_b128 v[40:43], v1 offset:8192
    s_waitcnt lgkmcnt(5)
    v_mfma_f32_16x16x32_bf16 v[8:11], v[44:47], a[12:15], v[8:11]
    v_mfma_f32_16x16x32_bf16 v[12:15], v[44:47], a[92:95], v[12:15]
    ds_read_b128 v[44:47], v1 offset:9216
    s_waitcnt lgkmcnt(5)
    v_mfma_f32_16x16x32_bf16 v[8:11], v[48:51], a[16:19], v[8:11]
    v_mfma_f32_16x16x32_bf16 v[12:15], v[48:51], a[96:99], v[12:15]
    ds_read_b128 v[48:51], v1 offset:10240
    s_waitcnt lgkmcnt(5)
    v_mfma_f32_16x16x32_bf16 v[8:11], v[52:55], a[20:23], v[8:11]
    v_mfma_f32_16x16x32_bf16 v[12:15], v[52:55], a[100:103], v[12:15]
    ds_read_b128 v[52:55], v1 offset:11264
    s_waitcnt lgkmcnt(5)
    v_mfma_f32_16x16x32_bf16 v[8:11], v[32:35], a[24:27], v[8:11]
    v_mfma_f32_16x16x32_bf16 v[12:15], v[32:35], a[104:107], v[12:15]
    ds_read_b128 v[32:35], v1 offset:12288
    s_waitcnt lgkmcnt(5)
    v_mfma_f32_16x16x32_bf16 v[8:11], v[36:39], a[28:31], v[8:11]
    v_mfma_f32_16x16x32_bf16 v[12:15], v[36:39], a[108:111], v[12:15]
    ds_read_b128 v[36:39], v1 offset:13312
    s_waitcnt lgkmcnt(5)
    v_mfma_f32_16x16x32_bf16 v[8:11], v[40:43], a[32:35], v[8:11]
    v_mfma_f32_16x16x32_bf16 v[12:15], v[40:43], a[112:115], v[12:15]
    ds_read_b128 v[40:43], v1 offset:14336
    s_waitcnt lgkmcnt(5)
    v_mfma_f32_16x16x32_bf16 v[8:11], v[44:47], a[36:39], v[8:11]
    v_mfma_f32_16x16x32_bf16 v[12:15], v[44:47], a[116:119], v[12:15]
    ds_read_b128 v[44:47], v1 offset:15360
    s_waitcnt lgkmcnt(5)
    v_mfma_f32_16x16x32_bf16 v[8:11], v[48:51], a[40:43], v[8:11]
    v_mfma_f32_16x16x32_bf16 v[12:15], v[48:51], a[120:123], v[12:15]
    ds_read_b128 v[48:51], v1 offset:16384
    s_waitcnt lgkmcnt(5)
    v_mfma_f32_16x16x32_bf16 v[8:11], v[52:55], a[44:47], v[8:11]
    v_mfma_f32_16x16x32_bf16 v[12:15], v[52:55], a[124:127], v[12:15]
    ds_read_b128 v[52:55], v1 offset:17408
    s_waitcnt lgkmcnt(5)
    v_mfma_f32_16x16x32_bf16 v[8:11], v[32:35], a[48:51], v[8:11]
    v_mfma_f32_16x16x32_bf16 v[12:15], v[32:35], a[128:131], v[12:15]
    ds_read_b128 v[32:35], v1 offset:18432
    s_waitcnt lgkmcnt(5)
    v_mfma_f32_16x16x32_bf16 v[8:11], v[36:39], a[52:55], v[8:11]
    v_mfma_f32_16x16x32_bf16 v[12:15], v[36:39], a[132:135], v[12:15]
    ds_read_b128 v[36:39], v1 offset:19456
    s_waitcnt lgkmcnt(5)
    v_mfma_f32_16x16x32_bf16 v[8:11], v[40:43], a[56:59], v[8:11]
    v_mfma_f32_16x16x32_bf16 v[12:15], v[40:43], a[136:139], v[12:15]
    ds_read_b128 v[40:43], v1 offset:20480
    s_waitcnt lgkmcnt(5)
    v_mfma_f32_16x16x32_bf16 v[8:11], v[44:47], a[60:63], v[8:11]
    v_mfma_f32_16x16x32_bf16 v[12:15], v[44:47], a[140:143], v[12:15]
    ds_read_b128 v[44:47], v1 offset:21504
    s_waitcnt lgkmcnt(5)
    v_mfma_f32_16x16x32_bf16 v[8:11], v[48:51], a[64:67], v[8:11]
    v_mfma_f32_16x16x32_bf16 v[12:15], v[48:51], a[144:147], v[12:15]
    ds_read_b128 v[48:51], v1 offset:22528
    s_waitcnt lgkmcnt(5)
    v_mfma_f32_16x16x32_bf16 v[8:11], v[52:55], a[68:71], v[8:11]
    v_mfma_f32_16x16x32_bf16 v[12:15], v[52:55], a[148:151], v[12:15]
    ds_read_b128 v[52:55], v1 offset:23552
    s_waitcnt lgkmcnt(5)
    v_mfma_f32_16x16x32_bf16 v[8:11], v[32:35], a[72:75], v[8:11]
    v_mfma_f32_16x16x32_bf16 v[12:15], v[32:35], a[152:155], v[12:15]
    ds_read_b128 v[32:35], v1 offset:24576
    s_waitcnt lgkmcnt(5)
    v_mfma_f32_16x16x32_bf16 v[8:11], v[36:39], a[76:79], v[8:11]
    v_mfma_f32_16x16x32_bf16 v[12:15], v[36:39], a[156:159], v[12:15]
    ds_read_b128 v[36:39], v1 offset:25600
    s_waitcnt lgkmcnt(5)
    v_mfma_f32_16x16x32_bf16 v[16:19], v[40:43], a[0:3], 0
    v_mfma_f32_16x16x32_bf16 v[20:23], v[40:43], a[80:83], 0
    ds_read_b128 v[40:43], v1 offset:26624
    s_waitcnt lgkmcnt(5)
    v_mfma_f32_16x16x32_bf16 v[16:19], v[44:47], a[4:7], v[16:19]
    v_mfma_f32_16x16x32_bf16 v[20:23], v[44:47], a[84:87], v[20:23]
    ds_read_b128 v[44:47], v1 offset:27648
    s_waitcnt lgkmcnt(5)
    v_mfma_f32_16x16x32_bf16 v[16:19], v[48:51], a[8:11], v[16:19]
    v_mfma_f32_16x16x32_bf16 v[20:23], v[48:51], a[88:91], v[20:23]
    ds_read_b128 v[48:51], v1 offset:28672
    s_waitcnt lgkmcnt(5)
    v_mfma_f32_16x16x32_bf16 v[16:19], v[52:55], a[12:15], v[16:19]
    v_mfma_f32_16x16x32_bf16 v[20:23], v[52:55], a[92:95], v[20:23]
    ds_read_b128 v[52:55], v1 offset:29696
    s_waitcnt lgkmcnt(5)
    v_mfma_f32_16x16x32_bf16 v[16:19], v[32:35], a[16:19], v[16:19]
    v_mfma_f32_16x16x32_bf16 v[20:23], v[32:35], a[96:99], v[20:23]
    ds_read_b128 v[32:35], v1 offset:30720
    s_waitcnt lgkmcnt(5)
    v_mfma_f32_16x16x32_bf16 v[16:19], v[36:39], a[20:23], v[16:19]
    v_mfma_f32_16x16x32_bf16 v[20:23], v[36:39], a[100:103], v[20:23]
    ds_read_b128 v[36:39], v1 offset:31744
    s_waitcnt lgkmcnt(5)
    v_mfma_f32_16x16x32_bf16 v[16:19], v[40:43], a[24:27], v[16:19]
    v_mfma_f32_16x16x32_bf16 v[20:23], v[40:43], a[104:107], v[20:23]
    ds_read_b128 v[40:43], v1 offset:32768
    s_waitcnt lgkmcnt(5)
    v_mfma_f32_16x16x32_bf16 v[16:19], v[44:47], a[28:31], v[16:19]
    v_mfma_f32_16x16x32_bf16 v[20:23], v[44:47], a[108:111], v[20:23]
    ds_read_b128 v[44:47], v1 offset:33792
    s_waitcnt lgkmcnt(5)
    v_mfma_f32_16x16x32_bf16 v[16:19], v[48:51], a[32:35], v[16:19]
    v_mfma_f32_16x16x32_bf16 v[20:23], v[48:51], a[112:115], v[20:23]
    ds_read_b128 v[48:51], v1 offset:34816
    s_waitcnt lgkmcnt(5)
    v_mfma_f32_16x16x32_bf16 v[16:19], v[52:55], a[36:39], v[16:19]
    v_mfma_f32_16x16x32_bf16 v[20:23], v[52:55], a[116:119], v[20:23]
    ds_read_b128 v[52:55], v1 offset:35840
    s_waitcnt lgkmcnt(5)
    v_mfma_f32_16x16x32_bf16 v[16:19], v[32:35], a[40:43], v[16:19]
    v_mfma_f32_16x16x32_bf16 v[20:23], v[32:35], a[120:123], v[20:23]
    ds_read_b128 v[32:35], v1 offset:36864
    s_waitcnt lgkmcnt(5)
    v_mfma_f32_16x16x32_bf16 v[16:19], v[36:39], a[44:47], v[16:19]
    v_mfma_f32_16x16x32_bf16 v[20:23], v[36:39], a[124:127], v[20:23]
    ds_read_b128 v[36:39], v1 offset:37888
    s_waitcnt lgkmcnt(5)
    v_mfma_f32_16x16x32_bf16 v[16:19], v[40:43], a[48:51], v[16:19]
    v_mfma_f32_16x16x32_bf16 v[20:23], v[40:43], a[128:131], v[20:23]
    ds_read_b128 v[40:43], v1 offset:38912
    s_waitcnt lgkmcnt(5)
    v_mfma_f32_16x16x32_bf16 v[16:19], v[44:47], a[52:55], v[16:19]
    v_mfma_f32_16x16x32_bf16 v[20:23], v[44:47], a[132:135], v[20:23]
    ds_read_b128 v[44:47], v1 offset:39936
    s_waitcnt lgkmcnt(5)
    v_mfma_f32_16x16x32_bf16 v[16:19], v[48:51], a[56:59], v[16:19]
    v_mfma_f32_16x16x32_bf16 v[20:23], v[48:51], a[136:139], v[20:23]
    s_waitcnt lgkmcnt(4)
    v_mfma_f32_16x16x32_bf16 v[16:19], v[52:55], a[60:63], v[16:19]
    v_mfma_f32_16x16x32_bf16 v[20:23], v[52:55], a[140:143], v[20:23]
    s_waitcnt lgkmcnt(3)
    v_mfma_f32_16x16x32_bf16 v[16:19], v[32:35], a[64:67], v[16:19]
    v_mfma_f32_16x16x32_bf16 v[20:23], v[32:35], a[144:147], v[20:23]
    s_waitcnt lgkmcnt(2)
    v_mfma_f32_16x16x32_bf16 v[16:19], v[36:39], a[68:71], v[16:19]
    v_mfma_f32_16x16x32_bf16 v[20:23], v[36:39], a[148:151], v[20:23]
    s_waitcnt lgkmcnt(1)
    v_mfma_f32_16x16x32_bf16 v[16:19], v[40:43], a[72:75], v[16:19]
    v_mfma_f32_16x16x32_bf16 v[20:23], v[40:43], a[152:155], v[20:23]
    s_waitcnt lgkmcnt(0)
    v_mfma_f32_16x16x32_bf16 v[16:19], v[44:47], a[76:79], v[16:19]
    v_mfma_f32_16x16x32_bf16 v[20:23], v[44:47], a[156:159], v[20:23]
    v_cvt_pk_bf16_f32 v24, v8, v9
    v_cvt_pk_bf16_f32 v25, v10, v11
    s_nop 4
    v_cvt_pk_bf16_f32 v26, v16, v17
    v_cvt_pk_bf16_f32 v27, v18, v19
    buffer_store_dwordx4 v[24:27], v0, s[8:11], s50 offen offset:0 sc1
    v_cvt_pk_bf16_f32 v28, v12, v13
    v_cvt_pk_bf16_f32 v29, v14, v15
    v_cvt_pk_bf16_f32 v30, v20, v21
    v_cvt_pk_bf16_f32 v31, v22, v23
    buffer_store_dwordx4 v[28:31], v0, s[8:11], s50 offen offset:1024 sc1
main_kernel_kv_c:
    s_add_u32 s50, s50, 262144
    s_add_u32 s27, s44, s43
    v_mov_b32 v2, s27
    s_waitcnt vmcnt(0)
    s_barrier
    s_cmp_lg_u32 s21, 0
    s_cbranch_scc1 main_kernel_kv_nf
    s_mov_b64 exec, 1
    buffer_store_dword v2, v0, s[8:11], s51 offen sc1
    s_mov_b64 exec, -1
main_kernel_kv_nf:
    s_cmp_lt_u32 s44, 64
    s_cbranch_scc1 main_kernel_kv_top
    s_branch main_kernel_bphase
main_kernel_qao:
    v_lshrrev_b32 v1, 8, v0
    v_bfe_u32 v2, v0, 4, 4
    v_add_u32 v3, 81920, v0
    v_mul_u32_u24 v10, 40960, v2
    v_lshl_add_u32 v10, v1, 4, v10
    s_mul_i32 s27, s22, 1280
    s_mul_i32 s28, s21, 320
    s_add_u32 s27, s27, s28
    v_add_u32 v6, s27, v10
    v_mul_u32_u24 v10, 1280, v1
    v_lshl_add_u32 v10, v2, 4, v10
    s_mul_i32 s27, s22, 40960
    s_lshl_b32 s28, s21, 8
    s_add_u32 s27, s27, s28
    v_add_u32 v7, s27, v10
    v_lshlrev_b32 v10, 4, v2
    v_lshl_add_u32 v10, v1, 3, v10
    s_mul_i32 s27, s22, 1280
    s_add_u32 s27, s27, s28
    v_add_u32 v8, s27, v10
    v_lshlrev_b32 v10, 2, v1
    v_sub_u32 v9, v2, v10
    v_and_b32 v10, 16, v0
    s_movk_i32 s27, 0x3f80
    v_lshlrev_b32_e64 v10, v10, s27
    v_bfe_u32 v11, v0, 5, 2
    v_cmp_eq_u32 vcc, 0, v11
    s_nop 1
    v_cndmask_b32 v20, 0, v10, vcc
    v_cmp_eq_u32 vcc, 1, v11
    s_nop 1
    v_cndmask_b32 v21, 0, v10, vcc
    v_cmp_eq_u32 vcc, 2, v11
    s_nop 1
    v_cndmask_b32 v22, 0, v10, vcc
    v_cmp_eq_u32 vcc, 3, v11
    s_nop 1
    v_cndmask_b32 v23, 0, v10, vcc
    s_mov_b32 s40, 0x3e0293ee
    s_mov_b32 s36, 0x00ff00ff
    s_mov_b32 s37, 0x00ff00ff
    s_sub_u32 s44, s20, 4
    s_mov_b32 s45, 0
    s_mul_i32 s48, s44, 2621440
    s_add_u32 s48, s48, 121634816
    s_mov_b32 s49, 1310720
    s_lshl_b32 s51, s44, 12
    s_lshl_b32 s27, s101, 11
    s_add_u32 s51, s51, s27
    s_add_u32 s51, s51, 167903232
    s_lshl_b32 s52, s22, 7
    s_lshl_b32 s27, s101, 12
    s_add_u32 s52, s52, s27
    s_add_u32 s52, s52, 167895040
    s_lshl_b32 s53, s22, 13
    s_add_u32 s53, s53, 218103808
    s_mul_i32 s54, s101, 8388608
    s_add_u32 s54, s54, 134217728
    s_min_u32 s27, s44, 63
    s_mul_i32 s27, s27, 40960
    s_add_u32 s27, s27, s47
    s_add_u32 s28, s45, s42
    s_mov_b32 m0, s28
    s_nop 0
    buffer_load_dwordx4 v0, s[8:11], s27 offen offset:0 sc1 lds
    buffer_load_dwordx4 v0, s[8:11], s27 offen offset:1024 sc1 lds
    buffer_load_dwordx4 v0, s[8:11], s27 offen offset:2048 sc1 lds
    buffer_load_dwordx4 v0, s[8:11], s27 offen offset:3072 sc1 lds
    s_add_u32 s27, s27, 4096
    s_add_u32 s28, s28, 4096
    s_mov_b32 m0, s28
    s_nop 0
    buffer_load_dwordx4 v0, s[8:11], s27 offen offset:0 sc1 lds
    buffer_load_dwordx4 v0, s[8:11], s27 offen offset:1024 sc1 lds
    buffer_load_dwordx4 v0, s[8:11], s27 offen offset:2048 sc1 lds
    buffer_load_dwordx4 v0, s[8:11], s27 offen offset:3072 sc1 lds
    s_add_u32 s27, s27, 4096
    s_add_u32 s28, s28, 4096
    s_mov_b32 m0, s28
    s_nop 0
    buffer_load_dwordx4 v0, s[8:11], s27 offen offset:0 sc1 lds
    buffer_load_dwordx4 v0, s[8:11], s27 offen offset:1024 sc1 lds
    s_waitcnt vmcnt(0)
    s_barrier
main_kernel_q_top:
    v_add_u32 v10, s45, v0
    s_sub_u32 s45, 40960, s45
    s_add_u32 s46, s44, 4
    s_min_u32 s27, s46, 63
    s_mul_i32 s27, s27, 40960
    s_add_u32 s27, s27, s47
    s_add_u32 s28, s45, s42
    s_mov_b32 m0, s28
    s_nop 0
    buffer_load_dwordx4 v0, s[8:11], s27 offen offset:0 sc1 lds
    buffer_load_dwordx4 v0, s[8:11], s27 offen offset:1024 sc1 lds
    buffer_load_dwordx4 v0, s[8:11], s27 offen offset:2048 sc1 lds
    buffer_load_dwordx4 v0, s[8:11], s27 offen offset:3072 sc1 lds
    s_add_u32 s27, s27, 4096
    s_add_u32 s28, s28, 4096
    s_mov_b32 m0, s28
    s_nop 0
    buffer_load_dwordx4 v0, s[8:11], s27 offen offset:0 sc1 lds
    buffer_load_dwordx4 v0, s[8:11], s27 offen offset:1024 sc1 lds
    buffer_load_dwordx4 v0, s[8:11], s27 offen offset:2048 sc1 lds
    buffer_load_dwordx4 v0, s[8:11], s27 offen offset:3072 sc1 lds
    s_add_u32 s27, s27, 4096
    s_add_u32 s28, s28, 4096
    s_mov_b32 m0, s28
    s_nop 0
    buffer_load_dwordx4 v0, s[8:11], s27 offen offset:0 sc1 lds
    buffer_load_dwordx4 v0, s[8:11], s27 offen offset:1024 sc1 lds
    ds_read_b128 v[48:51], v10 offset:0
    ds_read_b128 v[52:55], v10 offset:1024
    ds_read_b128 v[56:59], v10 offset:2048
    ds_read_b128 v[60:63], v10 offset:3072
    ds_read_b128 v[64:67], v10 offset:4096
    ds_read_b128 v[68:71], v10 offset:5120
    s_waitcnt lgkmcnt(5)
    v_mfma_f32_16x16x32_bf16 v[24:27], a[0:3], v[48:51], 0
    v_mfma_f32_16x16x32_bf16 v[28:31], a[80:83], v[48:51], 0
    ds_read_b128 v[48:51], v10 offset:6144
    s_waitcnt lgkmcnt(5)
    v_mfma_f32_16x16x32_bf16 v[24:27], a[4:7], v[52:55], v[24:27]
    v_mfma_f32_16x16x32_bf16 v[28:31], a[84:87], v[52:55], v[28:31]
    ds_read_b128 v[52:55], v10 offset:7168
    s_waitcnt lgkmcnt(5)
    v_mfma_f32_16x16x32_bf16 v[24:27], a[8:11], v[56:59], v[24:27]
    v_mfma_f32_16x16x32_bf16 v[28:31], a[88:91], v[56:59], v[28:31]
    ds_read_b128 v[56:59], v10 offset:8192
    s_waitcnt lgkmcnt(5)
    v_mfma_f32_16x16x32_bf16 v[24:27], a[12:15], v[60:63], v[24:27]
    v_mfma_f32_16x16x32_bf16 v[28:31], a[92:95], v[60:63], v[28:31]
    ds_read_b128 v[60:63], v10 offset:9216
    s_waitcnt lgkmcnt(5)
    v_mfma_f32_16x16x32_bf16 v[24:27], a[16:19], v[64:67], v[24:27]
    v_mfma_f32_16x16x32_bf16 v[28:31], a[96:99], v[64:67], v[28:31]
    ds_read_b128 v[64:67], v10 offset:10240
    s_waitcnt lgkmcnt(5)
    v_mfma_f32_16x16x32_bf16 v[24:27], a[20:23], v[68:71], v[24:27]
    v_mfma_f32_16x16x32_bf16 v[28:31], a[100:103], v[68:71], v[28:31]
    ds_read_b128 v[68:71], v10 offset:11264
    s_waitcnt lgkmcnt(5)
    v_mfma_f32_16x16x32_bf16 v[24:27], a[24:27], v[48:51], v[24:27]
    v_mfma_f32_16x16x32_bf16 v[28:31], a[104:107], v[48:51], v[28:31]
    ds_read_b128 v[48:51], v10 offset:12288
    s_waitcnt lgkmcnt(5)
    v_mfma_f32_16x16x32_bf16 v[24:27], a[28:31], v[52:55], v[24:27]
    v_mfma_f32_16x16x32_bf16 v[28:31], a[108:111], v[52:55], v[28:31]
    ds_read_b128 v[52:55], v10 offset:13312
    s_waitcnt lgkmcnt(5)
    v_mfma_f32_16x16x32_bf16 v[24:27], a[32:35], v[56:59], v[24:27]
    v_mfma_f32_16x16x32_bf16 v[28:31], a[112:115], v[56:59], v[28:31]
    ds_read_b128 v[56:59], v10 offset:14336
    s_waitcnt lgkmcnt(5)
    v_mfma_f32_16x16x32_bf16 v[24:27], a[36:39], v[60:63], v[24:27]
    v_mfma_f32_16x16x32_bf16 v[28:31], a[116:119], v[60:63], v[28:31]
    ds_read_b128 v[60:63], v10 offset:15360
    s_waitcnt lgkmcnt(5)
    v_mfma_f32_16x16x32_bf16 v[24:27], a[40:43], v[64:67], v[24:27]
    v_mfma_f32_16x16x32_bf16 v[28:31], a[120:123], v[64:67], v[28:31]
    ds_read_b128 v[64:67], v10 offset:16384
    s_waitcnt lgkmcnt(5)
    v_mfma_f32_16x16x32_bf16 v[24:27], a[44:47], v[68:71], v[24:27]
    v_mfma_f32_16x16x32_bf16 v[28:31], a[124:127], v[68:71], v[28:31]
    ds_read_b128 v[68:71], v10 offset:17408
    s_waitcnt lgkmcnt(5)
    v_mfma_f32_16x16x32_bf16 v[24:27], a[48:51], v[48:51], v[24:27]
    v_mfma_f32_16x16x32_bf16 v[28:31], a[128:131], v[48:51], v[28:31]
    ds_read_b128 v[48:51], v10 offset:18432
    s_waitcnt lgkmcnt(5)
    v_mfma_f32_16x16x32_bf16 v[24:27], a[52:55], v[52:55], v[24:27]
    v_mfma_f32_16x16x32_bf16 v[28:31], a[132:135], v[52:55], v[28:31]
    ds_read_b128 v[52:55], v10 offset:19456
    s_waitcnt lgkmcnt(5)
    v_mfma_f32_16x16x32_bf16 v[24:27], a[56:59], v[56:59], v[24:27]
    v_mfma_f32_16x16x32_bf16 v[28:31], a[136:139], v[56:59], v[28:31]
    ds_read_b128 v[56:59], v10 offset:20480
    s_waitcnt lgkmcnt(5)
    v_mfma_f32_16x16x32_bf16 v[24:27], a[60:63], v[60:63], v[24:27]
    v_mfma_f32_16x16x32_bf16 v[28:31], a[140:143], v[60:63], v[28:31]
    ds_read_b128 v[60:63], v10 offset:21504
    s_waitcnt lgkmcnt(5)
    v_mfma_f32_16x16x32_bf16 v[24:27], a[64:67], v[64:67], v[24:27]
    v_mfma_f32_16x16x32_bf16 v[28:31], a[144:147], v[64:67], v[28:31]
    ds_read_b128 v[64:67], v10 offset:22528
    s_waitcnt lgkmcnt(5)
    v_mfma_f32_16x16x32_bf16 v[24:27], a[68:71], v[68:71], v[24:27]
    v_mfma_f32_16x16x32_bf16 v[28:31], a[148:151], v[68:71], v[28:31]
    ds_read_b128 v[68:71], v10 offset:23552
    s_waitcnt lgkmcnt(5)
    v_mfma_f32_16x16x32_bf16 v[24:27], a[72:75], v[48:51], v[24:27]
    v_mfma_f32_16x16x32_bf16 v[28:31], a[152:155], v[48:51], v[28:31]
    ds_read_b128 v[48:51], v10 offset:24576
    s_waitcnt lgkmcnt(5)
    v_mfma_f32_16x16x32_bf16 v[24:27], a[76:79], v[52:55], v[24:27]
    v_mfma_f32_16x16x32_bf16 v[28:31], a[156:159], v[52:55], v[28:31]
    ds_read_b128 v[52:55], v10 offset:25600
    s_waitcnt lgkmcnt(5)
    v_mfma_f32_16x16x32_bf16 v[32:35], a[0:3], v[56:59], 0
    v_mfma_f32_16x16x32_bf16 v[36:39], a[80:83], v[56:59], 0
    ds_read_b128 v[56:59], v10 offset:26624
    s_waitcnt lgkmcnt(5)
    v_mfma_f32_16x16x32_bf16 v[32:35], a[4:7], v[60:63], v[32:35]
    v_mfma_f32_16x16x32_bf16 v[36:39], a[84:87], v[60:63], v[36:39]
    ds_read_b128 v[60:63], v10 offset:27648
    s_waitcnt lgkmcnt(5)
    v_mfma_f32_16x16x32_bf16 v[32:35], a[8:11], v[64:67], v[32:35]
    v_mfma_f32_16x16x32_bf16 v[36:39], a[88:91], v[64:67], v[36:39]
    ds_read_b128 v[64:67], v10 offset:28672
    s_waitcnt lgkmcnt(5)
    v_mfma_f32_16x16x32_bf16 v[32:35], a[12:15], v[68:71], v[32:35]
    v_mfma_f32_16x16x32_bf16 v[36:39], a[92:95], v[68:71], v[36:39]
    ds_read_b128 v[68:71], v10 offset:29696
    s_waitcnt lgkmcnt(5)
    v_mfma_f32_16x16x32_bf16 v[32:35], a[16:19], v[48:51], v[32:35]
    v_mfma_f32_16x16x32_bf16 v[36:39], a[96:99], v[48:51], v[36:39]
    ds_read_b128 v[48:51], v10 offset:30720
    s_waitcnt lgkmcnt(5)
    v_mfma_f32_16x16x32_bf16 v[32:35], a[20:23], v[52:55], v[32:35]
    v_mfma_f32_16x16x32_bf16 v[36:39], a[100:103], v[52:55], v[36:39]
    ds_read_b128 v[52:55], v10 offset:31744
    s_waitcnt lgkmcnt(5)
    v_mfma_f32_16x16x32_bf16 v[32:35], a[24:27], v[56:59], v[32:35]
    v_mfma_f32_16x16x32_bf16 v[36:39], a[104:107], v[56:59], v[36:39]
    ds_read_b128 v[56:59], v10 offset:32768
    s_waitcnt lgkmcnt(5)
    v_mfma_f32_16x16x32_bf16 v[32:35], a[28:31], v[60:63], v[32:35]
    v_mfma_f32_16x16x32_bf16 v[36:39], a[108:111], v[60:63], v[36:39]
    ds_read_b128 v[60:63], v10 offset:33792
    s_waitcnt lgkmcnt(5)
    v_mfma_f32_16x16x32_bf16 v[32:35], a[32:35], v[64:67], v[32:35]
    v_mfma_f32_16x16x32_bf16 v[36:39], a[112:115], v[64:67], v[36:39]
    ds_read_b128 v[64:67], v10 offset:34816
    s_waitcnt lgkmcnt(5)
    v_mfma_f32_16x16x32_bf16 v[32:35], a[36:39], v[68:71], v[32:35]
    v_mfma_f32_16x16x32_bf16 v[36:39], a[116:119], v[68:71], v[36:39]
    ds_read_b128 v[68:71], v10 offset:35840
    s_waitcnt lgkmcnt(5)
    v_mfma_f32_16x16x32_bf16 v[32:35], a[40:43], v[48:51], v[32:35]
    v_mfma_f32_16x16x32_bf16 v[36:39], a[120:123], v[48:51], v[36:39]
    ds_read_b128 v[48:51], v10 offset:36864
    s_waitcnt lgkmcnt(5)
    v_mfma_f32_16x16x32_bf16 v[32:35], a[44:47], v[52:55], v[32:35]
    v_mfma_f32_16x16x32_bf16 v[36:39], a[124:127], v[52:55], v[36:39]
    ds_read_b128 v[52:55], v10 offset:37888
    s_waitcnt lgkmcnt(5)
    v_mfma_f32_16x16x32_bf16 v[32:35], a[48:51], v[56:59], v[32:35]
    v_mfma_f32_16x16x32_bf16 v[36:39], a[128:131], v[56:59], v[36:39]
    ds_read_b128 v[56:59], v10 offset:38912
    s_waitcnt lgkmcnt(5)
    v_mfma_f32_16x16x32_bf16 v[32:35], a[52:55], v[60:63], v[32:35]
    v_mfma_f32_16x16x32_bf16 v[36:39], a[132:135], v[60:63], v[36:39]
    ds_read_b128 v[60:63], v10 offset:39936
    s_waitcnt lgkmcnt(5)
    v_mfma_f32_16x16x32_bf16 v[32:35], a[56:59], v[64:67], v[32:35]
    v_mfma_f32_16x16x32_bf16 v[36:39], a[136:139], v[64:67], v[36:39]
    s_waitcnt lgkmcnt(4)
    v_mfma_f32_16x16x32_bf16 v[32:35], a[60:63], v[68:71], v[32:35]
    v_mfma_f32_16x16x32_bf16 v[36:39], a[140:143], v[68:71], v[36:39]
    s_waitcnt lgkmcnt(3)
    v_mfma_f32_16x16x32_bf16 v[32:35], a[64:67], v[48:51], v[32:35]
    v_mfma_f32_16x16x32_bf16 v[36:39], a[144:147], v[48:51], v[36:39]
    s_waitcnt lgkmcnt(2)
    v_mfma_f32_16x16x32_bf16 v[32:35], a[68:71], v[52:55], v[32:35]
    v_mfma_f32_16x16x32_bf16 v[36:39], a[148:151], v[52:55], v[36:39]
    s_waitcnt lgkmcnt(1)
    v_mfma_f32_16x16x32_bf16 v[32:35], a[72:75], v[56:59], v[32:35]
    v_mfma_f32_16x16x32_bf16 v[36:39], a[152:155], v[56:59], v[36:39]
    s_waitcnt lgkmcnt(0)
    v_mfma_f32_16x16x32_bf16 v[32:35], a[76:79], v[60:63], v[32:35]
    v_mfma_f32_16x16x32_bf16 v[36:39], a[156:159], v[60:63], v[36:39]
    v_mul_f32 v24, s40, v24
    v_mul_f32 v25, s40, v25
    v_mul_f32 v26, s40, v26
    v_mul_f32 v27, s40, v27
    v_mul_f32 v28, s40, v28
    v_mul_f32 v29, s40, v29
    v_mul_f32 v30, s40, v30
    v_mul_f32 v31, s40, v31
    v_mul_f32 v32, s40, v32
    v_mul_f32 v33, s40, v33
    v_mul_f32 v34, s40, v34
    v_mul_f32 v35, s40, v35
    v_mul_f32 v36, s40, v36
    v_mul_f32 v37, s40, v37
    v_mul_f32 v38, s40, v38
    v_mul_f32 v39, s40, v39
    s_lshl_b32 s27, s21, 10
    v_add_u32 v10, s27, v3
    v_cvt_pk_bf16_f32 v40, v24, v28
    v_cvt_pk_bf16_f32 v41, v25, v29
    v_cvt_pk_bf16_f32 v42, v26, v30
    v_cvt_pk_bf16_f32 v43, v27, v31
    ds_write_b128 v10, v[40:43] offset:0
    v_cvt_pk_bf16_f32 v44, v32, v36
    v_cvt_pk_bf16_f32 v45, v33, v37
    v_cvt_pk_bf16_f32 v46, v34, v38
    v_cvt_pk_bf16_f32 v47, v35, v39
    ds_write_b128 v10, v[44:47] offset:4096
    s_mul_i32 s55, s44, 40960
    s_mov_b32 exec_hi, 0
    buffer_load_dwordx2 v[184:185], v8, s[16:19], s55 offen sc1
    buffer_load_dwordx2 v[186:187], v8, s[16:19], s55 offen offset:1024 sc1
    s_mov_b64 exec, -1
    s_add_u32 s56, s44, s43
    s_lshl_b32 s57, s44, 7
    s_waitcnt lgkmcnt(0)
    s_cmp_lg_u32 s21, 0
    s_cbranch_scc1 main_kernel_cf_1
    s_mov_b64 exec, 0x3
    s_mov_b32 s30, 0
    v_lshrrev_b32 v190, 2, v0
main_kernel_cf_2:
    buffer_load_dword v191, v190, s[8:11], s52 offen sc1
    s_add_u32 s30, s30, 1
    s_cmp_ge_u32 s30, 60000
    s_cbranch_scc1 main_kernel_fail
    s_waitcnt vmcnt(0)
    v_cmp_ge_u32 vcc, s57, v191
    s_cbranch_vccz main_kernel_cf_2d
    s_sleep 1
    s_branch main_kernel_cf_2
main_kernel_cf_2d:
    s_mov_b64 exec, -1
main_kernel_cf_1:
    s_barrier
    s_lshl_b32 s27, s56, 18
    s_add_u32 s27, s27, s53
    buffer_load_dwordx4 v[88:91], v0, s[8:11], s27 offen offset:0 sc1
    buffer_load_dwordx4 v[92:95], v0, s[8:11], s27 offen offset:1024 sc1
    buffer_load_dwordx4 v[96:99], v0, s[8:11], s27 offen offset:2048 sc1
    buffer_load_dwordx4 v[100:103], v0, s[8:11], s27 offen offset:3072 sc1
    s_lshl_b32 s28, s21, 10
    s_add_u32 s27, s27, s28
    s_add_u32 s27, s27, 4096
    buffer_load_dwordx4 v[112:115], v0, s[8:11], s27 offen sc1
    s_lshl_b32 s27, s44, 18
    s_add_u32 s27, s27, s50
    s_lshl_b32 s28, s21, 11
    s_add_u32 s29, s27, s28
    s_add_u32 m0, s28, 98304
    s_nop 0
    buffer_load_dwordx4 v0, s[8:11], s29 offen offset:0 sc1 lds
    buffer_load_dwordx4 v0, s[8:11], s29 offen offset:1024 sc1 lds
    s_add_u32 s27, s29, 16777216
    buffer_load_dwordx4 v[104:107], v0, s[8:11], s27 offen offset:0 sc1
    buffer_load_dwordx4 v[108:111], v0, s[8:11], s27 offen offset:1024 sc1
    ds_read_b128 v[24:27], v3 offset:0
    ds_read_b128 v[28:31], v3 offset:1024
    ds_read_b128 v[32:35], v3 offset:2048
    ds_read_b128 v[36:39], v3 offset:3072
    ds_read_b128 v[40:43], v3 offset:4096
    ds_read_b128 v[44:47], v3 offset:5120
    ds_read_b128 v[48:51], v3 offset:6144
    ds_read_b128 v[52:55], v3 offset:7168
    v_mov_b32 v10, 0xf149f2ca
    v_cmp_gt_i32 vcc, 0, v9
    s_nop 1
    v_cndmask_b32 v120, 0, v10, vcc
    v_mov_b32 v132, v120
    v_cmp_gt_i32 vcc, 1, v9
    s_nop 1
    v_cndmask_b32 v121, 0, v10, vcc
    v_mov_b32 v133, v121
    v_cmp_gt_i32 vcc, 2, v9
    s_nop 1
    v_cndmask_b32 v122, 0, v10, vcc
    v_mov_b32 v134, v122
    v_cmp_gt_i32 vcc, 3, v9
    s_nop 1
    v_cndmask_b32 v123, 0, v10, vcc
    v_mov_b32 v135, v123
    s_waitcnt vmcnt(2)
    s_barrier
    ds_read_b128 v[56:59], v3 offset:16384
    ds_read_b128 v[60:63], v3 offset:17408
    ds_read_b128 v[64:67], v3 offset:18432
    ds_read_b128 v[68:71], v3 offset:19456
    ds_read_b128 v[72:75], v3 offset:20480
    ds_read_b128 v[76:79], v3 offset:21504
    ds_read_b128 v[80:83], v3 offset:22528
    ds_read_b128 v[84:87], v3 offset:23552
    s_waitcnt lgkmcnt(15)
    v_mfma_f32_16x16x32_bf16 v[116:119], v[88:91], v[24:27], 0
    s_waitcnt lgkmcnt(11)
    v_mfma_f32_16x16x32_bf16 v[124:127], v[88:91], v[40:43], 0
    v_mfma_f32_16x16x32_bf16 v[116:119], v[92:95], v[28:31], v[116:119]
    s_waitcnt lgkmcnt(10)
    v_mfma_f32_16x16x32_bf16 v[124:127], v[92:95], v[44:47], v[124:127]
    v_mfma_f32_16x16x32_bf16 v[116:119], v[96:99], v[32:35], v[116:119]
    s_waitcnt lgkmcnt(9)
    v_mfma_f32_16x16x32_bf16 v[124:127], v[96:99], v[48:51], v[124:127]
    v_mfma_f32_16x16x32_bf16 v[116:119], v[100:103], v[36:39], v[116:119]
    s_waitcnt lgkmcnt(8)
    v_mfma_f32_16x16x32_bf16 v[124:127], v[100:103], v[52:55], v[124:127]
    s_waitcnt lgkmcnt(7)
    v_mfma_f32_16x16x32_bf16 v[120:123], v[56:59], v[24:27], v[120:123]
    v_mfma_f32_16x16x32_bf16 v[128:131], v[56:59], v[40:43], 0
    s_waitcnt lgkmcnt(3)
    v_mfma_f32_16x16x32_bf16 v[132:135], v[72:75], v[40:43], v[132:135]
    v_mfma_f32_16x16x32_bf16 v[120:123], v[60:63], v[28:31], v[120:123]
    v_mfma_f32_16x16x32_bf16 v[128:131], v[60:63], v[44:47], v[128:131]
    s_waitcnt lgkmcnt(2)
    v_mfma_f32_16x16x32_bf16 v[132:135], v[76:79], v[44:47], v[132:135]
    v_mfma_f32_16x16x32_bf16 v[120:123], v[64:67], v[32:35], v[120:123]
    v_mfma_f32_16x16x32_bf16 v[128:131], v[64:67], v[48:51], v[128:131]
    s_waitcnt lgkmcnt(1)
    v_mfma_f32_16x16x32_bf16 v[132:135], v[80:83], v[48:51], v[132:135]
    v_mfma_f32_16x16x32_bf16 v[120:123], v[68:71], v[36:39], v[120:123]
    v_mfma_f32_16x16x32_bf16 v[128:131], v[68:71], v[52:55], v[128:131]
    s_waitcnt lgkmcnt(0)
    v_mfma_f32_16x16x32_bf16 v[132:135], v[84:87], v[52:55], v[132:135]
    v_max3_f32 v160, v116, v117, v118
    s_nop 3
    v_max3_f32 v160, v160, v119, v120
    v_max3_f32 v160, v160, v121, v122
    v_max_f32 v160, v160, v123
    v_mov_b32 v161, v160
    s_nop 1
    v_permlane16_swap_b32 v160, v161
    v_max_f32 v160, v160, v161
    v_mov_b32 v161, v160
    s_nop 1
    v_permlane32_swap_b32 v160, v161
    v_max_f32 v160, v160, v161
    v_sub_f32 v116, v116, v160
    v_sub_f32 v117, v117, v160
    v_sub_f32 v118, v118, v160
    v_sub_f32 v119, v119, v160
    v_sub_f32 v120, v120, v160
    v_sub_f32 v121, v121, v160
    v_sub_f32 v122, v122, v160
    v_sub_f32 v123, v123, v160
    v_exp_f32 v116, v116
    v_exp_f32 v117, v117
    v_exp_f32 v118, v118
    v_exp_f32 v119, v119
    v_exp_f32 v120, v120
    v_exp_f32 v121, v121
    v_exp_f32 v122, v122
    v_exp_f32 v123, v123
    v_add_f32 v162, v116, v117
    v_add_f32 v161, v118, v119
    v_add_f32 v162, v162, v161
    v_fma_f32 v162, v162, 0.5, v120
    v_add_f32 v162, v162, v121
    v_add_f32 v162, v162, v122
    v_add_f32 v162, v162, v123
    v_mov_b32 v161, v162
    s_nop 1
    v_permlane16_swap_b32 v162, v161
    v_add_f32 v162, v162, v161
    v_mov_b32 v161, v162
    s_nop 1
    v_permlane32_swap_b32 v162, v161
    v_add_f32 v162, v162, v161
    v_rcp_f32 v162, v162
    s_nop 0
    v_mul_f32 v116, v116, v162
    v_mul_f32 v117, v117, v162
    v_mul_f32 v118, v118, v162
    v_mul_f32 v119, v119, v162
    v_mul_f32 v120, v120, v162
    v_mul_f32 v121, v121, v162
    v_mul_f32 v122, v122, v162
    v_mul_f32 v123, v123, v162
    v_cvt_pk_bf16_f32 v28, v116, v117
    v_cvt_pk_bf16_f32 v29, v118, v119
    v_cvt_pk_bf16_f32 v24, v120, v121
    v_cvt_pk_bf16_f32 v25, v122, v123
    v_mov_b32 v26, 0
    v_mov_b32 v27, 0
    v_max3_f32 v164, v124, v125, v126
    v_max3_f32 v164, v164, v127, v128
    v_max3_f32 v164, v164, v129, v130
    v_max3_f32 v164, v164, v131, v132
    v_max3_f32 v164, v164, v133, v134
    v_max_f32 v164, v164, v135
    v_mov_b32 v165, v164
    s_nop 1
    v_permlane16_swap_b32 v164, v165
    v_max_f32 v164, v164, v165
    v_mov_b32 v165, v164
    s_nop 1
    v_permlane32_swap_b32 v164, v165
    v_max_f32 v164, v164, v165
    v_sub_f32 v124, v124, v164
    v_sub_f32 v125, v125, v164
    v_sub_f32 v126, v126, v164
    v_sub_f32 v127, v127, v164
    v_sub_f32 v128, v128, v164
    v_sub_f32 v129, v129, v164
    v_sub_f32 v130, v130, v164
    v_sub_f32 v131, v131, v164
    v_sub_f32 v132, v132, v164
    v_sub_f32 v133, v133, v164
    v_sub_f32 v134, v134, v164
    v_sub_f32 v135, v135, v164
    v_exp_f32 v124, v124
    v_exp_f32 v125, v125
    v_exp_f32 v126, v126
    v_exp_f32 v127, v127
    v_exp_f32 v128, v128
    v_exp_f32 v129, v129
    v_exp_f32 v130, v130
    v_exp_f32 v131, v131
    v_exp_f32 v132, v132
    v_exp_f32 v133, v133
    v_exp_f32 v134, v134
    v_exp_f32 v135, v135
    v_add_f32 v166, v124, v125
    v_add_f32 v165, v126, v127
    v_add_f32 v166, v166, v165
    v_fma_f32 v166, v166, 0.5, v128
    v_add_f32 v166, v166, v129
    v_add_f32 v166, v166, v130
    v_add_f32 v166, v166, v131
    v_add_f32 v166, v166, v132
    v_add_f32 v166, v166, v133
    v_add_f32 v166, v166, v134
    v_add_f32 v166, v166, v135
    v_mov_b32 v165, v166
    s_nop 1
    v_permlane16_swap_b32 v166, v165
    v_add_f32 v166, v166, v165
    v_mov_b32 v165, v166
    s_nop 1
    v_permlane32_swap_b32 v166, v165
    v_add_f32 v166, v166, v165
    v_rcp_f32 v166, v166
    s_nop 0
    v_mul_f32 v124, v124, v166
    v_mul_f32 v125, v125, v166
    v_mul_f32 v126, v126, v166
    v_mul_f32 v127, v127, v166
    v_mul_f32 v128, v128, v166
    v_mul_f32 v129, v129, v166
    v_mul_f32 v130, v130, v166
    v_mul_f32 v131, v131, v166
    v_mul_f32 v132, v132, v166
    v_mul_f32 v133, v133, v166
    v_mul_f32 v134, v134, v166
    v_mul_f32 v135, v135, v166
    v_cvt_pk_bf16_f32 v36, v124, v125
    v_cvt_pk_bf16_f32 v37, v126, v127
    v_cvt_pk_bf16_f32 v32, v128, v129
    v_cvt_pk_bf16_f32 v33, v130, v131
    v_cvt_pk_bf16_f32 v34, v132, v133
    v_cvt_pk_bf16_f32 v35, v134, v135
    s_waitcnt vmcnt(1)
    v_mfma_f32_16x16x32_bf16 v[40:43], v[104:107], v[24:27], 0
    s_waitcnt vmcnt(0)
    v_mfma_f32_16x16x32_bf16 v[44:47], v[108:111], v[24:27], 0
    v_mfma_f32_16x16x32_bf16 v[48:51], v[104:107], v[32:35], 0
    v_mfma_f32_16x16x32_bf16 v[52:55], v[108:111], v[32:35], 0
    s_nop 1
    v_mfma_f32_16x16x16_bf16 v[40:43], v[112:113], v[28:29], v[40:43]
    s_nop 0
    v_mfma_f32_16x16x16_bf16 v[44:47], v[114:115], v[28:29], v[44:47]
    v_mfma_f32_16x16x16_bf16 v[48:51], v[112:113], v[36:37], v[48:51]
    v_mfma_f32_16x16x16_bf16 v[52:55], v[114:115], v[36:37], v[52:55]
    s_lshl_b32 s27, s21, 10
    v_add_u32 v10, s27, v3
    s_nop 3
    v_cvt_pk_bf16_f32 v56, v40, v44
    v_cvt_pk_bf16_f32 v57, v41, v45
    v_cvt_pk_bf16_f32 v58, v42, v46
    v_cvt_pk_bf16_f32 v59, v43, v47
    ds_write_b128 v10, v[56:59] offset:8192
    v_cvt_pk_bf16_f32 v60, v48, v52
    v_cvt_pk_bf16_f32 v61, v49, v53
    v_cvt_pk_bf16_f32 v62, v50, v54
    v_cvt_pk_bf16_f32 v63, v51, v55
    ds_write_b128 v10, v[60:63] offset:12288
    s_waitcnt lgkmcnt(0)
    s_barrier
    ds_read_b128 v[24:27], v3 offset:8192
    ds_read_b128 v[28:31], v3 offset:9216
    ds_read_b128 v[32:35], v3 offset:10240
    ds_read_b128 v[36:39], v3 offset:11264
    ds_read_b128 v[40:43], v3 offset:12288
    ds_read_b128 v[44:47], v3 offset:13312
    ds_read_b128 v[48:51], v3 offset:14336
    ds_read_b128 v[52:55], v3 offset:15360
    s_add_u32 s27, s48, 655360
    s_waitcnt lgkmcnt(7)
    v_mfma_f32_16x16x32_bf16 v[64:67], a[160:163], v[24:27], 0
    v_mfma_f32_16x16x32_bf16 v[68:71], a[176:179], v[24:27], 0
    s_waitcnt lgkmcnt(3)
    v_mfma_f32_16x16x32_bf16 v[72:75], a[160:163], v[40:43], 0
    v_mfma_f32_16x16x32_bf16 v[76:79], a[176:179], v[40:43], 0
    v_mfma_f32_16x16x32_bf16 v[64:67], a[164:167], v[28:31], v[64:67]
    v_mfma_f32_16x16x32_bf16 v[68:71], a[180:183], v[28:31], v[68:71]
    s_waitcnt lgkmcnt(2)
    v_mfma_f32_16x16x32_bf16 v[72:75], a[164:167], v[44:47], v[72:75]
    v_mfma_f32_16x16x32_bf16 v[76:79], a[180:183], v[44:47], v[76:79]
    v_mfma_f32_16x16x32_bf16 v[64:67], a[168:171], v[32:35], v[64:67]
    v_mfma_f32_16x16x32_bf16 v[68:71], a[184:187], v[32:35], v[68:71]
    s_waitcnt lgkmcnt(1)
    v_mfma_f32_16x16x32_bf16 v[72:75], a[168:171], v[48:51], v[72:75]
    v_mfma_f32_16x16x32_bf16 v[76:79], a[184:187], v[48:51], v[76:79]
    v_mfma_f32_16x16x32_bf16 v[64:67], a[172:175], v[36:39], v[64:67]
    v_mfma_f32_16x16x32_bf16 v[68:71], a[188:191], v[36:39], v[68:71]
    s_waitcnt lgkmcnt(0)
    v_mfma_f32_16x16x32_bf16 v[72:75], a[172:175], v[52:55], v[72:75]
    v_mfma_f32_16x16x32_bf16 v[76:79], a[188:191], v[52:55], v[76:79]
    v_mfma_f32_16x16x32_bf16 v[80:83], a[192:195], v[24:27], 0
    v_mfma_f32_16x16x32_bf16 v[84:87], a[208:211], v[24:27], 0
    v_mfma_f32_16x16x32_bf16 v[88:91], a[192:195], v[40:43], 0
    v_mfma_f32_16x16x32_bf16 v[92:95], a[208:211], v[40:43], 0
    v_mfma_f32_16x16x32_bf16 v[80:83], a[196:199], v[28:31], v[80:83]
    v_mfma_f32_16x16x32_bf16 v[84:87], a[212:215], v[28:31], v[84:87]
    v_mfma_f32_16x16x32_bf16 v[88:91], a[196:199], v[44:47], v[88:91]
    v_mfma_f32_16x16x32_bf16 v[92:95], a[212:215], v[44:47], v[92:95]
    v_mfma_f32_16x16x32_bf16 v[80:83], a[200:203], v[32:35], v[80:83]
    v_mfma_f32_16x16x32_bf16 v[84:87], a[216:219], v[32:35], v[84:87]
    v_mfma_f32_16x16x32_bf16 v[88:91], a[200:203], v[48:51], v[88:91]
    v_mfma_f32_16x16x32_bf16 v[92:95], a[216:219], v[48:51], v[92:95]
    v_mfma_f32_16x16x32_bf16 v[80:83], a[204:207], v[36:39], v[80:83]
    v_mfma_f32_16x16x32_bf16 v[84:87], a[220:223], v[36:39], v[84:87]
    v_mfma_f32_16x16x32_bf16 v[88:91], a[204:207], v[52:55], v[88:91]
    v_mfma_f32_16x16x32_bf16 v[92:95], a[220:223], v[52:55], v[92:95]
    v_mfma_f32_16x16x32_bf16 v[96:99], a[224:227], v[24:27], 0
    v_mfma_f32_16x16x32_bf16 v[100:103], a[240:243], v[24:27], 0
    v_mfma_f32_16x16x32_bf16 v[104:107], a[224:227], v[40:43], 0
    v_mfma_f32_16x16x32_bf16 v[108:111], a[240:243], v[40:43], 0
    v_mfma_f32_16x16x32_bf16 v[96:99], a[228:231], v[28:31], v[96:99]
    v_mfma_f32_16x16x32_bf16 v[100:103], a[244:247], v[28:31], v[100:103]
    v_mfma_f32_16x16x32_bf16 v[104:107], a[228:231], v[44:47], v[104:107]
    v_mfma_f32_16x16x32_bf16 v[108:111], a[244:247], v[44:47], v[108:111]
    v_mfma_f32_16x16x32_bf16 v[96:99], a[232:235], v[32:35], v[96:99]
    v_mfma_f32_16x16x32_bf16 v[100:103], a[248:251], v[32:35], v[100:103]
    v_mfma_f32_16x16x32_bf16 v[104:107], a[232:235], v[48:51], v[104:107]
    v_mfma_f32_16x16x32_bf16 v[108:111], a[248:251], v[48:51], v[108:111]
    v_mfma_f32_16x16x32_bf16 v[96:99], a[236:239], v[36:39], v[96:99]
    v_mfma_f32_16x16x32_bf16 v[100:103], a[252:255], v[36:39], v[100:103]
    v_mfma_f32_16x16x32_bf16 v[104:107], a[236:239], v[52:55], v[104:107]
    v_mfma_f32_16x16x32_bf16 v[108:111], a[252:255], v[52:55], v[108:111]
    v_mfma_f32_16x16x32_bf16 v[112:115], v[192:195], v[24:27], 0
    v_mfma_f32_16x16x32_bf16 v[116:119], v[208:211], v[24:27], 0
    v_mfma_f32_16x16x32_bf16 v[120:123], v[192:195], v[40:43], 0
    v_mfma_f32_16x16x32_bf16 v[124:127], v[208:211], v[40:43], 0
    v_mfma_f32_16x16x32_bf16 v[112:115], v[196:199], v[28:31], v[112:115]
    v_mfma_f32_16x16x32_bf16 v[116:119], v[212:215], v[28:31], v[116:119]
    v_mfma_f32_16x16x32_bf16 v[120:123], v[196:199], v[44:47], v[120:123]
    v_mfma_f32_16x16x32_bf16 v[124:127], v[212:215], v[44:47], v[124:127]
    v_mfma_f32_16x16x32_bf16 v[112:115], v[200:203], v[32:35], v[112:115]
    v_mfma_f32_16x16x32_bf16 v[116:119], v[216:219], v[32:35], v[116:119]
    v_mfma_f32_16x16x32_bf16 v[120:123], v[200:203], v[48:51], v[120:123]
    v_mfma_f32_16x16x32_bf16 v[124:127], v[216:219], v[48:51], v[124:127]
    v_mfma_f32_16x16x32_bf16 v[112:115], v[204:207], v[36:39], v[112:115]
    v_mfma_f32_16x16x32_bf16 v[116:119], v[220:223], v[36:39], v[116:119]
    v_mfma_f32_16x16x32_bf16 v[120:123], v[204:207], v[52:55], v[120:123]
    v_mfma_f32_16x16x32_bf16 v[124:127], v[220:223], v[52:55], v[124:127]
    v_mfma_f32_16x16x32_bf16 v[128:131], v[224:227], v[24:27], 0
    v_mfma_f32_16x16x32_bf16 v[132:135], v[240:243], v[24:27], 0
    v_mfma_f32_16x16x32_bf16 v[136:139], v[224:227], v[40:43], 0
    v_mfma_f32_16x16x32_bf16 v[140:143], v[240:243], v[40:43], 0
    v_mfma_f32_16x16x32_bf16 v[128:131], v[228:231], v[28:31], v[128:131]
    v_mfma_f32_16x16x32_bf16 v[132:135], v[244:247], v[28:31], v[132:135]
    v_mfma_f32_16x16x32_bf16 v[136:139], v[228:231], v[44:47], v[136:139]
    v_mfma_f32_16x16x32_bf16 v[140:143], v[244:247], v[44:47], v[140:143]
    v_mfma_f32_16x16x32_bf16 v[128:131], v[232:235], v[32:35], v[128:131]
    v_mfma_f32_16x16x32_bf16 v[132:135], v[248:251], v[32:35], v[132:135]
    v_mfma_f32_16x16x32_bf16 v[136:139], v[232:235], v[48:51], v[136:139]
    v_mfma_f32_16x16x32_bf16 v[140:143], v[248:251], v[48:51], v[140:143]
    v_mfma_f32_16x16x32_bf16 v[128:131], v[236:239], v[36:39], v[128:131]
    v_mfma_f32_16x16x32_bf16 v[132:135], v[252:255], v[36:39], v[132:135]
    v_mfma_f32_16x16x32_bf16 v[136:139], v[236:239], v[52:55], v[136:139]
    v_mfma_f32_16x16x32_bf16 v[140:143], v[252:255], v[52:55], v[140:143]
    v_cvt_pk_bf16_f32 v64, v64, v65
    v_cvt_pk_bf16_f32 v65, v66, v67
    v_cvt_pk_bf16_f32 v66, v68, v69
    v_cvt_pk_bf16_f32 v67, v70, v71
    v_cvt_pk_bf16_f32 v72, v72, v73
    v_cvt_pk_bf16_f32 v73, v74, v75
    v_cvt_pk_bf16_f32 v74, v76, v77
    v_cvt_pk_bf16_f32 v75, v78, v79
    v_cvt_pk_bf16_f32 v80, v80, v81
    v_cvt_pk_bf16_f32 v81, v82, v83
    v_cvt_pk_bf16_f32 v82, v84, v85
    v_cvt_pk_bf16_f32 v83, v86, v87
    v_cvt_pk_bf16_f32 v88, v88, v89
    v_cvt_pk_bf16_f32 v89, v90, v91
    v_cvt_pk_bf16_f32 v90, v92, v93
    v_cvt_pk_bf16_f32 v91, v94, v95
    v_cvt_pk_bf16_f32 v96, v96, v97
    v_cvt_pk_bf16_f32 v97, v98, v99
    v_cvt_pk_bf16_f32 v98, v100, v101
    v_cvt_pk_bf16_f32 v99, v102, v103
    v_cvt_pk_bf16_f32 v104, v104, v105
    v_cvt_pk_bf16_f32 v105, v106, v107
    v_cvt_pk_bf16_f32 v106, v108, v109
    v_cvt_pk_bf16_f32 v107, v110, v111
    v_cvt_pk_bf16_f32 v112, v112, v113
    v_cvt_pk_bf16_f32 v113, v114, v115
    v_cvt_pk_bf16_f32 v114, v116, v117
    v_cvt_pk_bf16_f32 v115, v118, v119
    v_cvt_pk_bf16_f32 v120, v120, v121
    v_cvt_pk_bf16_f32 v121, v122, v123
    v_cvt_pk_bf16_f32 v122, v124, v125
    v_cvt_pk_bf16_f32 v123, v126, v127
    v_cvt_pk_bf16_f32 v128, v128, v129
    v_cvt_pk_bf16_f32 v129, v130, v131
    v_cvt_pk_bf16_f32 v130, v132, v133
    v_cvt_pk_bf16_f32 v131, v134, v135
    v_cvt_pk_bf16_f32 v136, v136, v137
    v_cvt_pk_bf16_f32 v137, v138, v139
    v_cvt_pk_bf16_f32 v138, v140, v141
    v_cvt_pk_bf16_f32 v139, v142, v143
    s_cmp_lg_u32 s23, 0
    s_cbranch_scc1 main_kernel_ls_3
    buffer_store_dwordx4 v[64:67], v6, s[8:11], s48 offen offset:0
    buffer_store_dwordx4 v[72:75], v6, s[8:11], s27 offen offset:0
    buffer_store_dwordx4 v[80:83], v6, s[8:11], s48 offen offset:64
    buffer_store_dwordx4 v[88:91], v6, s[8:11], s27 offen offset:64
    buffer_store_dwordx4 v[96:99], v6, s[8:11], s48 offen offset:128
    buffer_store_dwordx4 v[104:107], v6, s[8:11], s27 offen offset:128
    buffer_store_dwordx4 v[112:115], v6, s[8:11], s48 offen offset:192
    buffer_store_dwordx4 v[120:123], v6, s[8:11], s27 offen offset:192
    buffer_store_dwordx4 v[128:131], v6, s[8:11], s48 offen offset:256
    buffer_store_dwordx4 v[136:139], v6, s[8:11], s27 offen offset:256
main_kernel_ls_3_r:
    s_waitcnt vmcnt(0)
    s_barrier
    s_cmp_lg_u32 s21, 0
    s_cbranch_scc1 main_kernel_q_na
    s_mov_b64 exec, 1
    v_mov_b32 v10, s22
    v_mov_b32 v11, 1
    s_cmp_lg_u32 s23, 0
    s_cbranch_scc1 main_kernel_ls_4
    buffer_store_byte v11, v10, s[8:11], s51 offen
main_kernel_ls_4_r:
    s_mov_b64 exec, -1
main_kernel_q_na:
    s_cmp_lg_u32 s21, 0
    s_cbranch_scc1 main_kernel_ar_5
    s_mov_b64 exec, 0xff
    s_mov_b32 s30, 0
    v_lshrrev_b32 v190, 2, v0
main_kernel_ar_6:
    buffer_load_dword v191, v190, s[8:11], s51 offen sc1
    s_add_u32 s30, s30, 1
    s_cmp_ge_u32 s30, 60000
    s_cbranch_scc1 main_kernel_fail
    s_waitcnt vmcnt(0)
    v_cmp_ne_u32 vcc, 0x01010101, v191
    s_cbranch_vccz main_kernel_ar_6d
    s_branch main_kernel_ar_6
main_kernel_ar_6d:
    s_mov_b64 exec, -1
main_kernel_ar_5:
    s_barrier
    s_add_u32 s55, s55, s54
    buffer_load_dwordx4 v[24:27], v7, s[8:11], s48 offen offset:0 sc1
    s_add_u32 s27, s48, 5120
    buffer_load_dwordx4 v[28:31], v7, s[8:11], s27 offen offset:0 sc1
    s_add_u32 s27, s48, 10240
    buffer_load_dwordx4 v[32:35], v7, s[8:11], s27 offen offset:0 sc1
    s_add_u32 s27, s48, 15360
    buffer_load_dwordx4 v[36:39], v7, s[8:11], s27 offen offset:0 sc1
    s_add_u32 s27, s48, 20480
    buffer_load_dwordx4 v[40:43], v7, s[8:11], s27 offen offset:0 sc1
    s_add_u32 s27, s48, 25600
    buffer_load_dwordx4 v[44:47], v7, s[8:11], s27 offen offset:0 sc1
    s_add_u32 s27, s48, 30720
    buffer_load_dwordx4 v[48:51], v7, s[8:11], s27 offen offset:0 sc1
    s_add_u32 s27, s48, 35840
    buffer_load_dwordx4 v[52:55], v7, s[8:11], s27 offen offset:0 sc1
    s_cmp_lg_u32 s21, 0
    s_cbranch_scc1 main_kernel_q_r1
    buffer_load_dwordx4 v[56:59], v7, s[8:11], s48 offen offset:1024 sc1
    s_add_u32 s27, s48, 5120
    buffer_load_dwordx4 v[60:63], v7, s[8:11], s27 offen offset:1024 sc1
    s_add_u32 s27, s48, 10240
    buffer_load_dwordx4 v[64:67], v7, s[8:11], s27 offen offset:1024 sc1
    s_add_u32 s27, s48, 15360
    buffer_load_dwordx4 v[68:71], v7, s[8:11], s27 offen offset:1024 sc1
    s_add_u32 s27, s48, 20480
    buffer_load_dwordx4 v[72:75], v7, s[8:11], s27 offen offset:1024 sc1
    s_add_u32 s27, s48, 25600
    buffer_load_dwordx4 v[76:79], v7, s[8:11], s27 offen offset:1024 sc1
    s_add_u32 s27, s48, 30720
    buffer_load_dwordx4 v[80:83], v7, s[8:11], s27 offen offset:1024 sc1
    s_add_u32 s27, s48, 35840
    buffer_load_dwordx4 v[84:87], v7, s[8:11], s27 offen offset:1024 sc1
    s_waitcnt vmcnt(7)
    v_mfma_f32_16x16x32_bf16 v[92:95], v[20:23], v[56:59], 0
    s_waitcnt vmcnt(6)
    v_mfma_f32_16x16x32_bf16 v[92:95], v[20:23], v[60:63], v[92:95]
    s_waitcnt vmcnt(5)
    v_mfma_f32_16x16x32_bf16 v[92:95], v[20:23], v[64:67], v[92:95]
    s_waitcnt vmcnt(4)
    v_mfma_f32_16x16x32_bf16 v[92:95], v[20:23], v[68:71], v[92:95]
    s_waitcnt vmcnt(3)
    v_mfma_f32_16x16x32_bf16 v[92:95], v[20:23], v[72:75], v[92:95]
    s_waitcnt vmcnt(2)
    v_mfma_f32_16x16x32_bf16 v[92:95], v[20:23], v[76:79], v[92:95]
    s_waitcnt vmcnt(1)
    v_mfma_f32_16x16x32_bf16 v[92:95], v[20:23], v[80:83], v[92:95]
    s_waitcnt vmcnt(0)
    v_mfma_f32_16x16x32_bf16 v[92:95], v[20:23], v[84:87], v[92:95]
    v_lshlrev_b32 v10, 16, v186
    v_and_b32 v11, 0xffff0000, v186
    s_nop 5
    v_add_f32 v10, v10, v92
    v_add_f32 v11, v11, v93
    v_cvt_pk_bf16_f32 v186, v10, v11
    v_lshlrev_b32 v10, 16, v187
    v_and_b32 v11, 0xffff0000, v187
    v_add_f32 v10, v10, v94
    v_add_f32 v11, v11, v95
    v_cvt_pk_bf16_f32 v187, v10, v11
    s_mov_b32 exec_hi, 0
    buffer_store_dwordx2 v[186:187], v8, s[8:11], s55 offen offset:1024 sc1
    s_mov_b64 exec, -1
main_kernel_q_r1:
    s_waitcnt vmcnt(0)
    v_mfma_f32_16x16x32_bf16 v[88:91], v[20:23], v[24:27], 0
    v_mfma_f32_16x16x32_bf16 v[88:91], v[20:23], v[28:31], v[88:91]
    v_mfma_f32_16x16x32_bf16 v[88:91], v[20:23], v[32:35], v[88:91]
    v_mfma_f32_16x16x32_bf16 v[88:91], v[20:23], v[36:39], v[88:91]
    v_mfma_f32_16x16x32_bf16 v[88:91], v[20:23], v[40:43], v[88:91]
    v_mfma_f32_16x16x32_bf16 v[88:91], v[20:23], v[44:47], v[88:91]
    v_mfma_f32_16x16x32_bf16 v[88:91], v[20:23], v[48:51], v[88:91]
    v_mfma_f32_16x16x32_bf16 v[88:91], v[20:23], v[52:55], v[88:91]
    v_lshlrev_b32 v10, 16, v184
    v_and_b32 v11, 0xffff0000, v184
    s_nop 5
    v_add_f32 v10, v10, v88
    v_add_f32 v11, v11, v89
    v_cvt_pk_bf16_f32 v184, v10, v11
    v_lshlrev_b32 v10, 16, v185
    v_and_b32 v11, 0xffff0000, v185
    v_add_f32 v10, v10, v90
    v_add_f32 v11, v11, v91
    v_cvt_pk_bf16_f32 v185, v10, v11
    s_mov_b32 exec_hi, 0
    buffer_store_dwordx2 v[184:185], v8, s[8:11], s55 offen offset:0 sc1
    s_mov_b64 exec, -1
    s_add_u32 s48, s48, s49
    s_sub_u32 s49, 0, s49
    s_add_u32 s51, s51, 128
    s_add_u32 s44, s44, 4
    s_cmp_lt_u32 s44, 64
    s_cbranch_scc1 main_kernel_q_top
main_kernel_bphase:
    s_sub_u32 s82, s20, 2
    s_mov_b32 s83, s21
    s_mov_b32 s84, s22
    s_mov_b32 s85, s23
    s_lshl_b32 s87, s82, 5
    s_add_u32 s87, s87, s22
    s_mul_i32 s86, s101, 24576
    s_mul_i32 s80, s101, 8388608
    s_add_u32 s80, s80, 134217728
    s_load_dwordx2 s[16:17], s[0:1], 80
    s_waitcnt lgkmcnt(0)
    s_and_b32 s17, s17, 0xffff
    s_cmp_eq_u32 s101, 1
    s_cbranch_scc1 main_kernel_osrd
    s_add_u32 s16, s8, 138412032
    s_addc_u32 s17, s9, 0
main_kernel_osrd:
    s_barrier
    s_mov_b32 s21, s83
    s_and_b32 s22, s87, 7
    v_mbcnt_lo_u32_b32 v1, -1, 0
    v_mbcnt_hi_u32_b32 v1, -1, v1
    v_lshlrev_b32 v1, 4, v1
    s_mul_i32 s27, s21, 25600
    s_mul_i32 s28, s22, 102400
    s_add_u32 s28, s28, s27
    s_add_u32 s28, s28, 146800640
    s_mov_b32 m0, s27
    s_nop 0
    buffer_load_dwordx4 v1, s[8:11], s28 offen offset:0 lds
    buffer_load_dwordx4 v1, s[8:11], s28 offen offset:1024 lds
    buffer_load_dwordx4 v1, s[8:11], s28 offen offset:2048 lds
    buffer_load_dwordx4 v1, s[8:11], s28 offen offset:3072 lds
    s_add_u32 s27, s27, 4096
    s_add_u32 s28, s28, 4096
    s_mov_b32 m0, s27
    s_nop 0
    buffer_load_dwordx4 v1, s[8:11], s28 offen offset:0 lds
    buffer_load_dwordx4 v1, s[8:11], s28 offen offset:1024 lds
    buffer_load_dwordx4 v1, s[8:11], s28 offen offset:2048 lds
    buffer_load_dwordx4 v1, s[8:11], s28 offen offset:3072 lds
    s_add_u32 s27, s27, 4096
    s_add_u32 s28, s28, 4096
    s_mov_b32 m0, s27
    s_nop 0
    buffer_load_dwordx4 v1, s[8:11], s28 offen offset:0 lds
    buffer_load_dwordx4 v1, s[8:11], s28 offen offset:1024 lds
    buffer_load_dwordx4 v1, s[8:11], s28 offen offset:2048 lds
    buffer_load_dwordx4 v1, s[8:11], s28 offen offset:3072 lds
    s_add_u32 s27, s27, 4096
    s_add_u32 s28, s28, 4096
    s_mov_b32 m0, s27
    s_nop 0
    buffer_load_dwordx4 v1, s[8:11], s28 offen offset:0 lds
    buffer_load_dwordx4 v1, s[8:11], s28 offen offset:1024 lds
    buffer_load_dwordx4 v1, s[8:11], s28 offen offset:2048 lds
    buffer_load_dwordx4 v1, s[8:11], s28 offen offset:3072 lds
    s_add_u32 s27, s27, 4096
    s_add_u32 s28, s28, 4096
    s_mov_b32 m0, s27
    s_nop 0
    buffer_load_dwordx4 v1, s[8:11], s28 offen offset:0 lds
    buffer_load_dwordx4 v1, s[8:11], s28 offen offset:1024 lds
    buffer_load_dwordx4 v1, s[8:11], s28 offen offset:2048 lds
    buffer_load_dwordx4 v1, s[8:11], s28 offen offset:3072 lds
    s_add_u32 s27, s27, 4096
    s_add_u32 s28, s28, 4096
    s_mov_b32 m0, s27
    s_nop 0
    buffer_load_dwordx4 v1, s[8:11], s28 offen offset:0 lds
    buffer_load_dwordx4 v1, s[8:11], s28 offen offset:1024 lds
    buffer_load_dwordx4 v1, s[8:11], s28 offen offset:2048 lds
    buffer_load_dwordx4 v1, s[8:11], s28 offen offset:3072 lds
    s_add_u32 s27, s27, 4096
    s_add_u32 s28, s28, 4096
    s_mov_b32 m0, s27
    s_nop 0
    buffer_load_dwordx4 v1, s[8:11], s28 offen offset:0 lds
    s_waitcnt vmcnt(0) lgkmcnt(0)
    s_barrier
    s_cmp_lg_u32 s83, 0
    s_cbranch_scc1 main_kernel_gb_8
    s_mov_b32 s23, s85
    s_add_u32 s28, s86, 167837696
    s_lshl_b32 s27, s82, 7
    v_mbcnt_lo_u32_b32 v189, -1, 0
    s_mov_b64 exec, 1
    s_add_u32 s31, s27, s84
    v_mov_b32 v190, s31
    v_mov_b32 v191, 1
    s_cmp_lg_u32 s23, 0
    s_cbranch_scc1 main_kernel_ls_9
    buffer_store_byte v191, v190, s[8:11], s28 offen
main_kernel_ls_9_r:
    s_cmp_lg_u32 s84, 0
    s_cbranch_scc1 main_kernel_gb_7
    s_mov_b64 exec, 0xff
    v_lshl_add_u32 v190, v189, 2, s27
    s_mov_b32 s30, 0
main_kernel_gs_10:
    buffer_load_dword v191, v190, s[8:11], s28 offen sc1
    s_add_u32 s30, s30, 1
    s_cmp_ge_u32 s30, 240000
    s_cbranch_scc1 main_kernel_fail
    s_waitcnt vmcnt(0)
    v_cmp_ne_u32 vcc, 0x1010101, v191
    s_cbranch_vccnz main_kernel_gs_10
    s_mov_b64 exec, 1
    v_mov_b32 v190, s27
    v_mov_b32 v191, 1
    buffer_store_dword v191, v190, s[8:11], s28 offen offset:1024 sc1
    s_mov_b64 exec, 0x3f
    v_lshlrev_b32 v190, 7, v189
    v_add_u32 v190, 1024, v190
    s_mov_b32 s30, 0
main_kernel_gs_11:
    buffer_load_dword v191, v190, s[8:11], s28 offen sc1
    s_add_u32 s30, s30, 1
    s_cmp_ge_u32 s30, 240000
    s_cbranch_scc1 main_kernel_fail
    s_waitcnt vmcnt(0)
    v_cmp_ne_u32 vcc, 0x1, v191
    s_cbranch_vccnz main_kernel_gs_11
    s_mov_b64 exec, 1
    v_mov_b32 v190, s27
    v_mov_b32 v191, 1
    s_cmp_lg_u32 s23, 0
    s_cbranch_scc1 main_kernel_ls_12
    buffer_store_dword v191, v190, s[8:11], s28 offen offset:2048
main_kernel_ls_12_r:
main_kernel_gb_7:
    s_mov_b64 exec, 0x1
    s_add_u32 s31, s27, 2048
    v_mov_b32 v190, s31
    s_mov_b32 s30, 0
main_kernel_gs_13:
    buffer_load_dword v191, v190, s[8:11], s28 offen sc1
    s_add_u32 s30, s30, 1
    s_cmp_ge_u32 s30, 240000
    s_cbranch_scc1 main_kernel_fail
    s_waitcnt vmcnt(0)
    v_cmp_ne_u32 vcc, 0x1, v191
    s_cbranch_vccnz main_kernel_gs_13
    s_mov_b64 exec, -1
main_kernel_gb_8:
    s_barrier
    s_add_u32 s20, s82, 2
    s_mov_b32 s21, s83
    s_mov_b32 s22, s84
    s_mov_b32 s23, s85
    s_lshr_b32 s34, s87, 3
    s_bitcmp1_b32 s87, 2
    s_cselect_b32 s27, 24, 0
    s_add_u32 s34, s34, s27
    s_cmp_ge_u32 s34, 32
    s_cbranch_scc1 main_kernel_nolnf
    s_lshl_b32 s34, s34, 2
    s_and_b32 s27, s87, 3
    s_add_u32 s34, s34, s27
    s_mov_b32 s23, s85
    v_mbcnt_lo_u32_b32 v1, -1, 0
    v_mbcnt_hi_u32_b32 v1, -1, v1
    v_lshrrev_b32 v3, 4, v1
    v_and_b32 v4, 15, v1
    v_lshlrev_b32 v5, 4, v1
    s_mov_b32 s33, s83
    v_mul_u32_u24 v6, 1280, v4
    v_lshl_add_u32 v6, v3, 4, v6
    s_mul_i32 s36, s34, 20480
    s_mul_i32 s35, s33, 320
    s_add_u32 s36, s36, s35
    s_add_u32 s36, s36, s80
    buffer_load_dwordx4 v[8:11], v6, s[8:11], s36 offen offset:0 sc1
    buffer_load_dwordx4 v[12:15], v6, s[8:11], s36 offen offset:64 sc1
    buffer_load_dwordx4 v[16:19], v6, s[8:11], s36 offen offset:128 sc1
    buffer_load_dwordx4 v[20:23], v6, s[8:11], s36 offen offset:192 sc1
    buffer_load_dwordx4 v[24:27], v6, s[8:11], s36 offen offset:256 sc1
    s_waitcnt vmcnt(4)
    v_lshlrev_b32 v32, 16, v8
    v_and_b32 v33, 0xffff0000, v8
    v_lshlrev_b32 v34, 16, v9
    v_and_b32 v35, 0xffff0000, v9
    v_lshlrev_b32 v36, 16, v10
    v_and_b32 v37, 0xffff0000, v10
    v_lshlrev_b32 v38, 16, v11
    v_and_b32 v39, 0xffff0000, v11
    s_waitcnt vmcnt(3)
    v_lshlrev_b32 v40, 16, v12
    v_and_b32 v41, 0xffff0000, v12
    v_lshlrev_b32 v42, 16, v13
    v_and_b32 v43, 0xffff0000, v13
    v_lshlrev_b32 v44, 16, v14
    v_and_b32 v45, 0xffff0000, v14
    v_lshlrev_b32 v46, 16, v15
    v_and_b32 v47, 0xffff0000, v15
    s_waitcnt vmcnt(2)
    v_lshlrev_b32 v48, 16, v16
    v_and_b32 v49, 0xffff0000, v16
    v_lshlrev_b32 v50, 16, v17
    v_and_b32 v51, 0xffff0000, v17
    v_lshlrev_b32 v52, 16, v18
    v_and_b32 v53, 0xffff0000, v18
    v_lshlrev_b32 v54, 16, v19
    v_and_b32 v55, 0xffff0000, v19
    s_waitcnt vmcnt(1)
    v_lshlrev_b32 v56, 16, v20
    v_and_b32 v57, 0xffff0000, v20
    v_lshlrev_b32 v58, 16, v21
    v_and_b32 v59, 0xffff0000, v21
    v_lshlrev_b32 v60, 16, v22
    v_and_b32 v61, 0xffff0000, v22
    v_lshlrev_b32 v62, 16, v23
    v_and_b32 v63, 0xffff0000, v23
    s_waitcnt vmcnt(0)
    v_lshlrev_b32 v64, 16, v24
    v_and_b32 v65, 0xffff0000, v24
    v_lshlrev_b32 v66, 16, v25
    v_and_b32 v67, 0xffff0000, v25
    v_lshlrev_b32 v68, 16, v26
    v_and_b32 v69, 0xffff0000, v26
    v_lshlrev_b32 v70, 16, v27
    v_and_b32 v71, 0xffff0000, v27
    v_add_f32 v72, v32, v33
    v_add_f32 v72, v72, v34
    v_add_f32 v72, v72, v35
    v_add_f32 v72, v72, v36
    v_add_f32 v72, v72, v37
    v_add_f32 v72, v72, v38
    v_add_f32 v72, v72, v39
    v_add_f32 v72, v72, v40
    v_add_f32 v72, v72, v41
    v_add_f32 v72, v72, v42
    v_add_f32 v72, v72, v43
    v_add_f32 v72, v72, v44
    v_add_f32 v72, v72, v45
    v_add_f32 v72, v72, v46
    v_add_f32 v72, v72, v47
    v_add_f32 v72, v72, v48
    v_add_f32 v72, v72, v49
    v_add_f32 v72, v72, v50
    v_add_f32 v72, v72, v51
    v_add_f32 v72, v72, v52
    v_add_f32 v72, v72, v53
    v_add_f32 v72, v72, v54
    v_add_f32 v72, v72, v55
    v_add_f32 v72, v72, v56
    v_add_f32 v72, v72, v57
    v_add_f32 v72, v72, v58
    v_add_f32 v72, v72, v59
    v_add_f32 v72, v72, v60
    v_add_f32 v72, v72, v61
    v_add_f32 v72, v72, v62
    v_add_f32 v72, v72, v63
    v_add_f32 v72, v72, v64
    v_add_f32 v72, v72, v65
    v_add_f32 v72, v72, v66
    v_add_f32 v72, v72, v67
    v_add_f32 v72, v72, v68
    v_add_f32 v72, v72, v69
    v_add_f32 v72, v72, v70
    v_add_f32 v72, v72, v71
    v_lshlrev_b32 v77, 4, v4
    v_add_u32 v77, 102400, v77
    s_lshl_b32 s35, s33, 2
    v_add_u32 v76, s35, v77
    v_mov_b32 v73, v72
    s_nop 1
    v_permlane16_swap_b32 v72, v73
    v_add_f32 v72, v72, v73
    v_mov_b32 v73, v72
    s_nop 1
    v_permlane32_swap_b32 v72, v73
    v_add_f32 v72, v72, v73
    ds_write_b32 v76, v72 offset:0
    s_waitcnt lgkmcnt(0)
    s_barrier
    ds_read_b128 v[80:83], v77 offset:0
    s_waitcnt lgkmcnt(0)
    v_add_f32 v80, v80, v81
    v_add_f32 v82, v82, v83
    v_add_f32 v72, v80, v82
    v_mul_f32 v72, 0x3acccccd, v72
    v_sub_f32 v32, v32, v72
    v_sub_f32 v33, v33, v72
    v_sub_f32 v34, v34, v72
    v_sub_f32 v35, v35, v72
    v_sub_f32 v36, v36, v72
    v_sub_f32 v37, v37, v72
    v_sub_f32 v38, v38, v72
    v_sub_f32 v39, v39, v72
    v_sub_f32 v40, v40, v72
    v_sub_f32 v41, v41, v72
    v_sub_f32 v42, v42, v72
    v_sub_f32 v43, v43, v72
    v_sub_f32 v44, v44, v72
    v_sub_f32 v45, v45, v72
    v_sub_f32 v46, v46, v72
    v_sub_f32 v47, v47, v72
    v_sub_f32 v48, v48, v72
    v_sub_f32 v49, v49, v72
    v_sub_f32 v50, v50, v72
    v_sub_f32 v51, v51, v72
    v_sub_f32 v52, v52, v72
    v_sub_f32 v53, v53, v72
    v_sub_f32 v54, v54, v72
    v_sub_f32 v55, v55, v72
    v_sub_f32 v56, v56, v72
    v_sub_f32 v57, v57, v72
    v_sub_f32 v58, v58, v72
    v_sub_f32 v59, v59, v72
    v_sub_f32 v60, v60, v72
    v_sub_f32 v61, v61, v72
    v_sub_f32 v62, v62, v72
    v_sub_f32 v63, v63, v72
    v_sub_f32 v64, v64, v72
    v_sub_f32 v65, v65, v72
    v_sub_f32 v66, v66, v72
    v_sub_f32 v67, v67, v72
    v_sub_f32 v68, v68, v72
    v_sub_f32 v69, v69, v72
    v_sub_f32 v70, v70, v72
    v_sub_f32 v71, v71, v72
    v_mul_f32 v74, v32, v32
    v_fmac_f32 v74, v33, v33
    v_fmac_f32 v74, v34, v34
    v_fmac_f32 v74, v35, v35
    v_fmac_f32 v74, v36, v36
    v_fmac_f32 v74, v37, v37
    v_fmac_f32 v74, v38, v38
    v_fmac_f32 v74, v39, v39
    v_fmac_f32 v74, v40, v40
    v_fmac_f32 v74, v41, v41
    v_fmac_f32 v74, v42, v42
    v_fmac_f32 v74, v43, v43
    v_fmac_f32 v74, v44, v44
    v_fmac_f32 v74, v45, v45
    v_fmac_f32 v74, v46, v46
    v_fmac_f32 v74, v47, v47
    v_fmac_f32 v74, v48, v48
    v_fmac_f32 v74, v49, v49
    v_fmac_f32 v74, v50, v50
    v_fmac_f32 v74, v51, v51
    v_fmac_f32 v74, v52, v52
    v_fmac_f32 v74, v53, v53
    v_fmac_f32 v74, v54, v54
    v_fmac_f32 v74, v55, v55
    v_fmac_f32 v74, v56, v56
    v_fmac_f32 v74, v57, v57
    v_fmac_f32 v74, v58, v58
    v_fmac_f32 v74, v59, v59
    v_fmac_f32 v74, v60, v60
    v_fmac_f32 v74, v61, v61
    v_fmac_f32 v74, v62, v62
    v_fmac_f32 v74, v63, v63
    v_fmac_f32 v74, v64, v64
    v_fmac_f32 v74, v65, v65
    v_fmac_f32 v74, v66, v66
    v_fmac_f32 v74, v67, v67
    v_fmac_f32 v74, v68, v68
    v_fmac_f32 v74, v69, v69
    v_fmac_f32 v74, v70, v70
    v_fmac_f32 v74, v71, v71
    v_mov_b32 v73, v74
    s_nop 1
    v_permlane16_swap_b32 v74, v73
    v_add_f32 v74, v74, v73
    v_mov_b32 v73, v74
    s_nop 1
    v_permlane32_swap_b32 v74, v73
    v_add_f32 v74, v74, v73
    ds_write_b32 v76, v74 offset:512
    s_waitcnt lgkmcnt(0)
    s_barrier
    ds_read_b128 v[80:83], v77 offset:512
    s_waitcnt lgkmcnt(0)
    v_add_f32 v80, v80, v81
    v_add_f32 v82, v82, v83
    v_add_f32 v74, v80, v82
    v_mov_b32 v75, 0x3727c5ac
    v_fmac_f32 v75, 0x3acccccd, v74
    v_rsq_f32 v75, v75
    s_nop 0
    v_mul_f32 v32, v32, v75
    v_mul_f32 v33, v33, v75
    v_mul_f32 v34, v34, v75
    v_mul_f32 v35, v35, v75
    v_mul_f32 v36, v36, v75
    v_mul_f32 v37, v37, v75
    v_mul_f32 v38, v38, v75
    v_mul_f32 v39, v39, v75
    v_mul_f32 v40, v40, v75
    v_mul_f32 v41, v41, v75
    v_mul_f32 v42, v42, v75
    v_mul_f32 v43, v43, v75
    v_mul_f32 v44, v44, v75
    v_mul_f32 v45, v45, v75
    v_mul_f32 v46, v46, v75
    v_mul_f32 v47, v47, v75
    v_mul_f32 v48, v48, v75
    v_mul_f32 v49, v49, v75
    v_mul_f32 v50, v50, v75
    v_mul_f32 v51, v51, v75
    v_mul_f32 v52, v52, v75
    v_mul_f32 v53, v53, v75
    v_mul_f32 v54, v54, v75
    v_mul_f32 v55, v55, v75
    v_mul_f32 v56, v56, v75
    v_mul_f32 v57, v57, v75
    v_mul_f32 v58, v58, v75
    v_mul_f32 v59, v59, v75
    v_mul_f32 v60, v60, v75
    v_mul_f32 v61, v61, v75
    v_mul_f32 v62, v62, v75
    v_mul_f32 v63, v63, v75
    v_mul_f32 v64, v64, v75
    v_mul_f32 v65, v65, v75
    v_mul_f32 v66, v66, v75
    v_mul_f32 v67, v67, v75
    v_mul_f32 v68, v68, v75
    v_mul_f32 v69, v69, v75
    v_mul_f32 v70, v70, v75
    v_mul_f32 v71, v71, v75
    v_cvt_pk_f16_f32 v8, v32, v33
    v_cvt_pk_f16_f32 v9, v34, v35
    v_cvt_pk_f16_f32 v10, v36, v37
    v_cvt_pk_f16_f32 v11, v38, v39
    v_cvt_pk_f16_f32 v12, v40, v41
    v_cvt_pk_f16_f32 v13, v42, v43
    v_cvt_pk_f16_f32 v14, v44, v45
    v_cvt_pk_f16_f32 v15, v46, v47
    v_cvt_pk_f16_f32 v16, v48, v49
    v_cvt_pk_f16_f32 v17, v50, v51
    v_cvt_pk_f16_f32 v18, v52, v53
    v_cvt_pk_f16_f32 v19, v54, v55
    v_cvt_pk_f16_f32 v20, v56, v57
    v_cvt_pk_f16_f32 v21, v58, v59
    v_cvt_pk_f16_f32 v22, v60, v61
    v_cvt_pk_f16_f32 v23, v62, v63
    v_cvt_pk_f16_f32 v24, v64, v65
    v_cvt_pk_f16_f32 v25, v66, v67
    v_cvt_pk_f16_f32 v26, v68, v69
    v_cvt_pk_f16_f32 v27, v70, v71
    s_mul_i32 s36, s34, 20480
    s_mul_i32 s35, s33, 5120
    s_add_u32 s36, s36, s35
    s_add_u32 s36, s36, 153092096
    s_add_u32 s35, s36, 4096
    s_cmp_lg_u32 s23, 0
    s_cbranch_scc1 main_kernel_ls_14
    buffer_store_dwordx4 v[8:11], v5, s[8:11], s36 offen offset:0
    buffer_store_dwordx4 v[12:15], v5, s[8:11], s36 offen offset:1024
    buffer_store_dwordx4 v[16:19], v5, s[8:11], s36 offen offset:2048
    buffer_store_dwordx4 v[20:23], v5, s[8:11], s36 offen offset:3072
    buffer_store_dwordx4 v[24:27], v5, s[8:11], s35 offen offset:0
main_kernel_ls_14_r:
main_kernel_nolnf:
    s_waitcnt vmcnt(0) lgkmcnt(0)
    s_barrier
    s_cmp_lg_u32 s83, 0
    s_cbranch_scc1 main_kernel_rs_15
    s_mov_b32 s23, s85
    s_add_u32 s28, s86, 167840768
    s_lshl_b32 s27, s82, 7
    s_add_u32 s31, s27, s84
    s_mov_b64 exec, 1
    v_mov_b32 v190, s31
    v_mov_b32 v191, 1
    s_cmp_lg_u32 s23, 0
    s_cbranch_scc1 main_kernel_ls_17
    buffer_store_byte v191, v190, s[8:11], s28 offen
main_kernel_ls_17_r:
    s_and_b32 s31, s31, 0xfffffff8
    v_mov_b32 v190, s31
    s_mov_b32 s30, 0
main_kernel_rs_16:
    buffer_load_dwordx2 v[188:189], v190, s[8:11], s28 offen sc1
    s_add_u32 s30, s30, 1
    s_cmp_ge_u32 s30, 60000
    s_cbranch_scc1 main_kernel_fail
    s_waitcnt vmcnt(0)
    v_and_b32 v188, v188, v189
    v_cmp_ne_u32 vcc, 0x01010101, v188
    s_cbranch_vccnz main_kernel_rs_16
    s_mov_b64 exec, -1
main_kernel_rs_15:
    s_barrier
    s_mov_b32 s81, s87
main_kernel_trf:
    v_mbcnt_lo_u32_b32 v0, -1, 0
    v_mbcnt_hi_u32_b32 v0, -1, v0
    s_lshl_b32 s27, s83, 6
    v_add_u32 v0, s27, v0
    s_mov_b32 s2, s81
    v_lshrrev_b32 v2, 6, v0
    v_and_b32 v0, 63, v0
    v_readfirstlane_b32 s21, v2
    v_lshlrev_b32 v1, 4, v0
    v_lshrrev_b32 v3, 4, v0
    v_and_b32 v4, 15, v0
    s_and_b32 s22, s2, 7
    s_lshr_b32 s23, s2, 3
    s_lshl_b32 s24, s23, 2
    s_add_u32 s24, s24, s21
    s_mul_i32 s29, s24, 20480
    s_add_u32 s29, s29, 153092096
    buffer_load_dwordx4 v[16:19], v1, s[8:11], s29 offen offset:0 sc1
    buffer_load_dwordx4 v[20:23], v1, s[8:11], s29 offen offset:1024 sc1
    buffer_load_dwordx4 v[24:27], v1, s[8:11], s29 offen offset:2048 sc1
    buffer_load_dwordx4 v[28:31], v1, s[8:11], s29 offen offset:3072 sc1
    s_add_u32 s29, s29, 4096
    buffer_load_dwordx4 v[32:35], v1, s[8:11], s29 offen offset:0 sc1
    buffer_load_dwordx4 v[36:39], v1, s[8:11], s29 offen offset:1024 sc1
    buffer_load_dwordx4 v[40:43], v1, s[8:11], s29 offen offset:2048 sc1
    buffer_load_dwordx4 v[44:47], v1, s[8:11], s29 offen offset:3072 sc1
    s_add_u32 s29, s29, 4096
    buffer_load_dwordx4 v[48:51], v1, s[8:11], s29 offen offset:0 sc1
    buffer_load_dwordx4 v[52:55], v1, s[8:11], s29 offen offset:1024 sc1
    buffer_load_dwordx4 v[56:59], v1, s[8:11], s29 offen offset:2048 sc1
    buffer_load_dwordx4 v[60:63], v1, s[8:11], s29 offen offset:3072 sc1
    s_add_u32 s29, s29, 4096
    buffer_load_dwordx4 v[64:67], v1, s[8:11], s29 offen offset:0 sc1
    buffer_load_dwordx4 v[68:71], v1, s[8:11], s29 offen offset:1024 sc1
    buffer_load_dwordx4 v[72:75], v1, s[8:11], s29 offen offset:2048 sc1
    buffer_load_dwordx4 v[76:79], v1, s[8:11], s29 offen offset:3072 sc1
    s_add_u32 s29, s29, 4096
    buffer_load_dwordx4 v[80:83], v1, s[8:11], s29 offen offset:0 sc1
    buffer_load_dwordx4 v[84:87], v1, s[8:11], s29 offen offset:1024 sc1
    buffer_load_dwordx4 v[88:91], v1, s[8:11], s29 offen offset:2048 sc1
    buffer_load_dwordx4 v[92:95], v1, s[8:11], s29 offen offset:3072 sc1
    s_add_u32 s29, s29, 4096
    v_lshlrev_b32 v5, 13, v4
    v_lshl_add_u32 v5, v3, 4, v5
    s_mul_i32 s30, s22, 655360
    s_lshl_b32 s31, s24, 6
    s_add_u32 s30, s30, s31
    s_add_u32 s30, s30, 157286400
    s_barrier
    v_add_u32 v6, 61440, v1
    ds_read_b128 v[128:131], v1 offset:0
    ds_read_b128 v[132:135], v1 offset:20480
    ds_read_b128 v[136:139], v1 offset:40960
    ds_read_b128 v[140:143], v6 offset:0
    ds_read_b128 v[144:147], v6 offset:20480
    ds_read_b128 v[148:151], v1 offset:1024
    ds_read_b128 v[152:155], v1 offset:21504
    ds_read_b128 v[156:159], v1 offset:41984
    s_waitcnt vmcnt(19) lgkmcnt(7)
    v_mfma_f32_16x16x32_f16 v[96:99], v[16:19], v[128:131], 0
    ds_read_b128 v[128:131], v6 offset:1024
    s_waitcnt lgkmcnt(7)
    v_mfma_f32_16x16x32_f16 v[100:103], v[16:19], v[132:135], 0
    ds_read_b128 v[132:135], v6 offset:21504
    s_waitcnt lgkmcnt(7)
    v_mfma_f32_16x16x32_f16 v[104:107], v[16:19], v[136:139], 0
    ds_read_b128 v[136:139], v1 offset:2048
    s_waitcnt lgkmcnt(7)
    v_mfma_f32_16x16x32_f16 v[108:111], v[16:19], v[140:143], 0
    ds_read_b128 v[140:143], v1 offset:22528
    s_waitcnt lgkmcnt(7)
    v_mfma_f32_16x16x32_f16 v[112:115], v[16:19], v[144:147], 0
    ds_read_b128 v[144:147], v1 offset:43008
    s_waitcnt vmcnt(18) lgkmcnt(7)
    v_mfma_f32_16x16x32_f16 v[96:99], v[20:23], v[148:151], v[96:99]
    ds_read_b128 v[148:151], v6 offset:2048
    s_waitcnt lgkmcnt(7)
    v_mfma_f32_16x16x32_f16 v[100:103], v[20:23], v[152:155], v[100:103]
    ds_read_b128 v[152:155], v6 offset:22528
    s_waitcnt lgkmcnt(7)
    v_mfma_f32_16x16x32_f16 v[104:107], v[20:23], v[156:159], v[104:107]
    ds_read_b128 v[156:159], v1 offset:3072
    s_waitcnt lgkmcnt(7)
    v_mfma_f32_16x16x32_f16 v[108:111], v[20:23], v[128:131], v[108:111]
    ds_read_b128 v[128:131], v1 offset:23552
    s_waitcnt lgkmcnt(7)
    v_mfma_f32_16x16x32_f16 v[112:115], v[20:23], v[132:135], v[112:115]
    ds_read_b128 v[132:135], v1 offset:44032
    s_waitcnt vmcnt(17) lgkmcnt(7)
    v_mfma_f32_16x16x32_f16 v[96:99], v[24:27], v[136:139], v[96:99]
    ds_read_b128 v[136:139], v6 offset:3072
    s_waitcnt lgkmcnt(7)
    v_mfma_f32_16x16x32_f16 v[100:103], v[24:27], v[140:143], v[100:103]
    ds_read_b128 v[140:143], v6 offset:23552
    s_waitcnt lgkmcnt(7)
    v_mfma_f32_16x16x32_f16 v[104:107], v[24:27], v[144:147], v[104:107]
    ds_read_b128 v[144:147], v1 offset:4096
    s_waitcnt lgkmcnt(7)
    v_mfma_f32_16x16x32_f16 v[108:111], v[24:27], v[148:151], v[108:111]
    ds_read_b128 v[148:151], v1 offset:24576
    s_waitcnt lgkmcnt(7)
    v_mfma_f32_16x16x32_f16 v[112:115], v[24:27], v[152:155], v[112:115]
    ds_read_b128 v[152:155], v1 offset:45056
    s_waitcnt vmcnt(16) lgkmcnt(7)
    v_mfma_f32_16x16x32_f16 v[96:99], v[28:31], v[156:159], v[96:99]
    ds_read_b128 v[156:159], v6 offset:4096
    s_waitcnt lgkmcnt(7)
    v_mfma_f32_16x16x32_f16 v[100:103], v[28:31], v[128:131], v[100:103]
    ds_read_b128 v[128:131], v6 offset:24576
    s_waitcnt lgkmcnt(7)
    v_mfma_f32_16x16x32_f16 v[104:107], v[28:31], v[132:135], v[104:107]
    ds_read_b128 v[132:135], v1 offset:5120
    s_waitcnt lgkmcnt(7)
    v_mfma_f32_16x16x32_f16 v[108:111], v[28:31], v[136:139], v[108:111]
    ds_read_b128 v[136:139], v1 offset:25600
    s_waitcnt lgkmcnt(7)
    v_mfma_f32_16x16x32_f16 v[112:115], v[28:31], v[140:143], v[112:115]
    ds_read_b128 v[140:143], v1 offset:46080
    s_waitcnt vmcnt(15) lgkmcnt(7)
    v_mfma_f32_16x16x32_f16 v[96:99], v[32:35], v[144:147], v[96:99]
    ds_read_b128 v[144:147], v6 offset:5120
    s_waitcnt lgkmcnt(7)
    v_mfma_f32_16x16x32_f16 v[100:103], v[32:35], v[148:151], v[100:103]
    ds_read_b128 v[148:151], v6 offset:25600
    s_waitcnt lgkmcnt(7)
    v_mfma_f32_16x16x32_f16 v[104:107], v[32:35], v[152:155], v[104:107]
    ds_read_b128 v[152:155], v1 offset:6144
    s_waitcnt lgkmcnt(7)
    v_mfma_f32_16x16x32_f16 v[108:111], v[32:35], v[156:159], v[108:111]
    ds_read_b128 v[156:159], v1 offset:26624
    s_waitcnt lgkmcnt(7)
    v_mfma_f32_16x16x32_f16 v[112:115], v[32:35], v[128:131], v[112:115]
    ds_read_b128 v[128:131], v1 offset:47104
    s_waitcnt vmcnt(14) lgkmcnt(7)
    v_mfma_f32_16x16x32_f16 v[96:99], v[36:39], v[132:135], v[96:99]
    ds_read_b128 v[132:135], v6 offset:6144
    s_waitcnt lgkmcnt(7)
    v_mfma_f32_16x16x32_f16 v[100:103], v[36:39], v[136:139], v[100:103]
    ds_read_b128 v[136:139], v6 offset:26624
    s_waitcnt lgkmcnt(7)
    v_mfma_f32_16x16x32_f16 v[104:107], v[36:39], v[140:143], v[104:107]
    ds_read_b128 v[140:143], v1 offset:7168
    s_waitcnt lgkmcnt(7)
    v_mfma_f32_16x16x32_f16 v[108:111], v[36:39], v[144:147], v[108:111]
    ds_read_b128 v[144:147], v1 offset:27648
    s_waitcnt lgkmcnt(7)
    v_mfma_f32_16x16x32_f16 v[112:115], v[36:39], v[148:151], v[112:115]
    ds_read_b128 v[148:151], v1 offset:48128
    s_waitcnt vmcnt(13) lgkmcnt(7)
    v_mfma_f32_16x16x32_f16 v[96:99], v[40:43], v[152:155], v[96:99]
    ds_read_b128 v[152:155], v6 offset:7168
    s_waitcnt lgkmcnt(7)
    v_mfma_f32_16x16x32_f16 v[100:103], v[40:43], v[156:159], v[100:103]
    ds_read_b128 v[156:159], v6 offset:27648
    s_waitcnt lgkmcnt(7)
    v_mfma_f32_16x16x32_f16 v[104:107], v[40:43], v[128:131], v[104:107]
    ds_read_b128 v[128:131], v1 offset:8192
    s_waitcnt lgkmcnt(7)
    v_mfma_f32_16x16x32_f16 v[108:111], v[40:43], v[132:135], v[108:111]
    ds_read_b128 v[132:135], v1 offset:28672
    s_waitcnt lgkmcnt(7)
    v_mfma_f32_16x16x32_f16 v[112:115], v[40:43], v[136:139], v[112:115]
    ds_read_b128 v[136:139], v1 offset:49152
    s_waitcnt vmcnt(12) lgkmcnt(7)
    v_mfma_f32_16x16x32_f16 v[96:99], v[44:47], v[140:143], v[96:99]
    ds_read_b128 v[140:143], v6 offset:8192
    s_waitcnt lgkmcnt(7)
    v_mfma_f32_16x16x32_f16 v[100:103], v[44:47], v[144:147], v[100:103]
    ds_read_b128 v[144:147], v6 offset:28672
    s_waitcnt lgkmcnt(7)
    v_mfma_f32_16x16x32_f16 v[104:107], v[44:47], v[148:151], v[104:107]
    ds_read_b128 v[148:151], v1 offset:9216
    s_waitcnt lgkmcnt(7)
    v_mfma_f32_16x16x32_f16 v[108:111], v[44:47], v[152:155], v[108:111]
    ds_read_b128 v[152:155], v1 offset:29696
    s_waitcnt lgkmcnt(7)
    v_mfma_f32_16x16x32_f16 v[112:115], v[44:47], v[156:159], v[112:115]
    ds_read_b128 v[156:159], v1 offset:50176
    s_waitcnt vmcnt(11) lgkmcnt(7)
    v_mfma_f32_16x16x32_f16 v[96:99], v[48:51], v[128:131], v[96:99]
    ds_read_b128 v[128:131], v6 offset:9216
    s_waitcnt lgkmcnt(7)
    v_mfma_f32_16x16x32_f16 v[100:103], v[48:51], v[132:135], v[100:103]
    ds_read_b128 v[132:135], v6 offset:29696
    s_waitcnt lgkmcnt(7)
    v_mfma_f32_16x16x32_f16 v[104:107], v[48:51], v[136:139], v[104:107]
    ds_read_b128 v[136:139], v1 offset:10240
    s_waitcnt lgkmcnt(7)
    v_mfma_f32_16x16x32_f16 v[108:111], v[48:51], v[140:143], v[108:111]
    ds_read_b128 v[140:143], v1 offset:30720
    s_waitcnt lgkmcnt(7)
    v_mfma_f32_16x16x32_f16 v[112:115], v[48:51], v[144:147], v[112:115]
    ds_read_b128 v[144:147], v1 offset:51200
    s_waitcnt vmcnt(10) lgkmcnt(7)
    v_mfma_f32_16x16x32_f16 v[96:99], v[52:55], v[148:151], v[96:99]
    ds_read_b128 v[148:151], v6 offset:10240
    s_waitcnt lgkmcnt(7)
    v_mfma_f32_16x16x32_f16 v[100:103], v[52:55], v[152:155], v[100:103]
    ds_read_b128 v[152:155], v6 offset:30720
    s_waitcnt lgkmcnt(7)
    v_mfma_f32_16x16x32_f16 v[104:107], v[52:55], v[156:159], v[104:107]
    ds_read_b128 v[156:159], v1 offset:11264
    s_waitcnt lgkmcnt(7)
    v_mfma_f32_16x16x32_f16 v[108:111], v[52:55], v[128:131], v[108:111]
    ds_read_b128 v[128:131], v1 offset:31744
    s_waitcnt lgkmcnt(7)
    v_mfma_f32_16x16x32_f16 v[112:115], v[52:55], v[132:135], v[112:115]
    ds_read_b128 v[132:135], v1 offset:52224
    s_waitcnt vmcnt(9) lgkmcnt(7)
    v_mfma_f32_16x16x32_f16 v[96:99], v[56:59], v[136:139], v[96:99]
    ds_read_b128 v[136:139], v6 offset:11264
    s_waitcnt lgkmcnt(7)
    v_mfma_f32_16x16x32_f16 v[100:103], v[56:59], v[140:143], v[100:103]
    ds_read_b128 v[140:143], v6 offset:31744
    s_waitcnt lgkmcnt(7)
    v_mfma_f32_16x16x32_f16 v[104:107], v[56:59], v[144:147], v[104:107]
    ds_read_b128 v[144:147], v1 offset:12288
    s_waitcnt lgkmcnt(7)
    v_mfma_f32_16x16x32_f16 v[108:111], v[56:59], v[148:151], v[108:111]
    ds_read_b128 v[148:151], v1 offset:32768
    s_waitcnt lgkmcnt(7)
    v_mfma_f32_16x16x32_f16 v[112:115], v[56:59], v[152:155], v[112:115]
    ds_read_b128 v[152:155], v1 offset:53248
    s_waitcnt vmcnt(8) lgkmcnt(7)
    v_mfma_f32_16x16x32_f16 v[96:99], v[60:63], v[156:159], v[96:99]
    ds_read_b128 v[156:159], v6 offset:12288
    s_waitcnt lgkmcnt(7)
    v_mfma_f32_16x16x32_f16 v[100:103], v[60:63], v[128:131], v[100:103]
    ds_read_b128 v[128:131], v6 offset:32768
    s_waitcnt lgkmcnt(7)
    v_mfma_f32_16x16x32_f16 v[104:107], v[60:63], v[132:135], v[104:107]
    ds_read_b128 v[132:135], v1 offset:13312
    s_waitcnt lgkmcnt(7)
    v_mfma_f32_16x16x32_f16 v[108:111], v[60:63], v[136:139], v[108:111]
    ds_read_b128 v[136:139], v1 offset:33792
    s_waitcnt lgkmcnt(7)
    v_mfma_f32_16x16x32_f16 v[112:115], v[60:63], v[140:143], v[112:115]
    ds_read_b128 v[140:143], v1 offset:54272
    s_waitcnt vmcnt(7) lgkmcnt(7)
    v_mfma_f32_16x16x32_f16 v[96:99], v[64:67], v[144:147], v[96:99]
    ds_read_b128 v[144:147], v6 offset:13312
    s_waitcnt lgkmcnt(7)
    v_mfma_f32_16x16x32_f16 v[100:103], v[64:67], v[148:151], v[100:103]
    ds_read_b128 v[148:151], v6 offset:33792
    s_waitcnt lgkmcnt(7)
    v_mfma_f32_16x16x32_f16 v[104:107], v[64:67], v[152:155], v[104:107]
    ds_read_b128 v[152:155], v1 offset:14336
    s_waitcnt lgkmcnt(7)
    v_mfma_f32_16x16x32_f16 v[108:111], v[64:67], v[156:159], v[108:111]
    ds_read_b128 v[156:159], v1 offset:34816
    s_waitcnt lgkmcnt(7)
    v_mfma_f32_16x16x32_f16 v[112:115], v[64:67], v[128:131], v[112:115]
    ds_read_b128 v[128:131], v1 offset:55296
    s_waitcnt vmcnt(6) lgkmcnt(7)
    v_mfma_f32_16x16x32_f16 v[96:99], v[68:71], v[132:135], v[96:99]
    ds_read_b128 v[132:135], v6 offset:14336
    s_waitcnt lgkmcnt(7)
    v_mfma_f32_16x16x32_f16 v[100:103], v[68:71], v[136:139], v[100:103]
    ds_read_b128 v[136:139], v6 offset:34816
    s_waitcnt lgkmcnt(7)
    v_mfma_f32_16x16x32_f16 v[104:107], v[68:71], v[140:143], v[104:107]
    ds_read_b128 v[140:143], v1 offset:15360
    s_waitcnt lgkmcnt(7)
    v_mfma_f32_16x16x32_f16 v[108:111], v[68:71], v[144:147], v[108:111]
    ds_read_b128 v[144:147], v1 offset:35840
    s_waitcnt lgkmcnt(7)
    v_mfma_f32_16x16x32_f16 v[112:115], v[68:71], v[148:151], v[112:115]
    ds_read_b128 v[148:151], v1 offset:56320
    s_waitcnt vmcnt(5) lgkmcnt(7)
    v_mfma_f32_16x16x32_f16 v[96:99], v[72:75], v[152:155], v[96:99]
    ds_read_b128 v[152:155], v6 offset:15360
    s_waitcnt lgkmcnt(7)
    v_mfma_f32_16x16x32_f16 v[100:103], v[72:75], v[156:159], v[100:103]
    ds_read_b128 v[156:159], v6 offset:35840
    s_waitcnt lgkmcnt(7)
    v_mfma_f32_16x16x32_f16 v[104:107], v[72:75], v[128:131], v[104:107]
    ds_read_b128 v[128:131], v1 offset:16384
    s_waitcnt lgkmcnt(7)
    v_mfma_f32_16x16x32_f16 v[108:111], v[72:75], v[132:135], v[108:111]
    ds_read_b128 v[132:135], v1 offset:36864
    s_waitcnt lgkmcnt(7)
    v_mfma_f32_16x16x32_f16 v[112:115], v[72:75], v[136:139], v[112:115]
    ds_read_b128 v[136:139], v1 offset:57344
    s_waitcnt vmcnt(4) lgkmcnt(7)
    v_mfma_f32_16x16x32_f16 v[96:99], v[76:79], v[140:143], v[96:99]
    ds_read_b128 v[140:143], v6 offset:16384
    s_waitcnt lgkmcnt(7)
    v_mfma_f32_16x16x32_f16 v[100:103], v[76:79], v[144:147], v[100:103]
    ds_read_b128 v[144:147], v6 offset:36864
    s_waitcnt lgkmcnt(7)
    v_mfma_f32_16x16x32_f16 v[104:107], v[76:79], v[148:151], v[104:107]
    ds_read_b128 v[148:151], v1 offset:17408
    s_waitcnt lgkmcnt(7)
    v_mfma_f32_16x16x32_f16 v[108:111], v[76:79], v[152:155], v[108:111]
    ds_read_b128 v[152:155], v1 offset:37888
    s_waitcnt lgkmcnt(7)
    v_mfma_f32_16x16x32_f16 v[112:115], v[76:79], v[156:159], v[112:115]
    ds_read_b128 v[156:159], v1 offset:58368
    s_waitcnt vmcnt(3) lgkmcnt(7)
    v_mfma_f32_16x16x32_f16 v[96:99], v[80:83], v[128:131], v[96:99]
    ds_read_b128 v[128:131], v6 offset:17408
    s_waitcnt lgkmcnt(7)
    v_mfma_f32_16x16x32_f16 v[100:103], v[80:83], v[132:135], v[100:103]
    ds_read_b128 v[132:135], v6 offset:37888
    s_waitcnt lgkmcnt(7)
    v_mfma_f32_16x16x32_f16 v[104:107], v[80:83], v[136:139], v[104:107]
    ds_read_b128 v[136:139], v1 offset:18432
    s_waitcnt lgkmcnt(7)
    v_mfma_f32_16x16x32_f16 v[108:111], v[80:83], v[140:143], v[108:111]
    ds_read_b128 v[140:143], v1 offset:38912
    s_waitcnt lgkmcnt(7)
    v_mfma_f32_16x16x32_f16 v[112:115], v[80:83], v[144:147], v[112:115]
    ds_read_b128 v[144:147], v1 offset:59392
    s_waitcnt vmcnt(2) lgkmcnt(7)
    v_mfma_f32_16x16x32_f16 v[96:99], v[84:87], v[148:151], v[96:99]
    ds_read_b128 v[148:151], v6 offset:18432
    s_waitcnt lgkmcnt(7)
    v_mfma_f32_16x16x32_f16 v[100:103], v[84:87], v[152:155], v[100:103]
    ds_read_b128 v[152:155], v6 offset:38912
    s_waitcnt lgkmcnt(7)
    v_mfma_f32_16x16x32_f16 v[104:107], v[84:87], v[156:159], v[104:107]
    ds_read_b128 v[156:159], v1 offset:19456
    s_waitcnt lgkmcnt(7)
    v_mfma_f32_16x16x32_f16 v[108:111], v[84:87], v[128:131], v[108:111]
    ds_read_b128 v[128:131], v1 offset:39936
    s_waitcnt lgkmcnt(7)
    v_mfma_f32_16x16x32_f16 v[112:115], v[84:87], v[132:135], v[112:115]
    ds_read_b128 v[132:135], v1 offset:60416
    s_waitcnt vmcnt(1) lgkmcnt(7)
    v_mfma_f32_16x16x32_f16 v[96:99], v[88:91], v[136:139], v[96:99]
    ds_read_b128 v[136:139], v6 offset:19456
    s_waitcnt lgkmcnt(7)
    v_mfma_f32_16x16x32_f16 v[100:103], v[88:91], v[140:143], v[100:103]
    ds_read_b128 v[140:143], v6 offset:39936
    s_waitcnt lgkmcnt(7)
    v_mfma_f32_16x16x32_f16 v[104:107], v[88:91], v[144:147], v[104:107]
    s_waitcnt lgkmcnt(6)
    v_mfma_f32_16x16x32_f16 v[108:111], v[88:91], v[148:151], v[108:111]
    s_waitcnt lgkmcnt(5)
    v_mfma_f32_16x16x32_f16 v[112:115], v[88:91], v[152:155], v[112:115]
    s_waitcnt vmcnt(0) lgkmcnt(4)
    v_mfma_f32_16x16x32_f16 v[96:99], v[92:95], v[156:159], v[96:99]
    s_waitcnt lgkmcnt(3)
    v_mfma_f32_16x16x32_f16 v[100:103], v[92:95], v[128:131], v[100:103]
    s_waitcnt lgkmcnt(2)
    v_mfma_f32_16x16x32_f16 v[104:107], v[92:95], v[132:135], v[104:107]
    s_waitcnt lgkmcnt(1)
    v_mfma_f32_16x16x32_f16 v[108:111], v[92:95], v[136:139], v[108:111]
    s_waitcnt lgkmcnt(0)
    v_mfma_f32_16x16x32_f16 v[112:115], v[92:95], v[140:143], v[112:115]
    s_waitcnt vmcnt(0)
    s_nop 7
    buffer_store_dwordx4 v[96:99], v5, s[8:11], s30 offen sc1
    s_add_u32 s30, s30, 131072
    buffer_store_dwordx4 v[100:103], v5, s[8:11], s30 offen sc1
    s_add_u32 s30, s30, 131072
    buffer_store_dwordx4 v[104:107], v5, s[8:11], s30 offen sc1
    s_add_u32 s30, s30, 131072
    buffer_store_dwordx4 v[108:111], v5, s[8:11], s30 offen sc1
    s_add_u32 s30, s30, 131072
    buffer_store_dwordx4 v[112:115], v5, s[8:11], s30 offen sc1
    s_add_u32 s30, s30, 131072
    s_add_u32 s81, s81, 192
    s_cmp_lt_u32 s81, 256
    s_cbranch_scc1 main_kernel_trf
    s_barrier
    s_mov_b32 s21, s83
    s_and_b32 s22, s87, 7
    v_mbcnt_lo_u32_b32 v1, -1, 0
    v_mbcnt_hi_u32_b32 v1, -1, v1
    v_lshlrev_b32 v1, 4, v1
    s_mul_i32 s27, s21, 25600
    s_mul_i32 s28, s22, 102400
    s_add_u32 s28, s28, s27
    s_add_u32 s28, s28, 147849216
    s_mov_b32 m0, s27
    s_nop 0
    buffer_load_dwordx4 v1, s[8:11], s28 offen offset:0 lds
    buffer_load_dwordx4 v1, s[8:11], s28 offen offset:1024 lds
    buffer_load_dwordx4 v1, s[8:11], s28 offen offset:2048 lds
    buffer_load_dwordx4 v1, s[8:11], s28 offen offset:3072 lds
    s_add_u32 s27, s27, 4096
    s_add_u32 s28, s28, 4096
    s_mov_b32 m0, s27
    s_nop 0
    buffer_load_dwordx4 v1, s[8:11], s28 offen offset:0 lds
    buffer_load_dwordx4 v1, s[8:11], s28 offen offset:1024 lds
    buffer_load_dwordx4 v1, s[8:11], s28 offen offset:2048 lds
    buffer_load_dwordx4 v1, s[8:11], s28 offen offset:3072 lds
    s_add_u32 s27, s27, 4096
    s_add_u32 s28, s28, 4096
    s_mov_b32 m0, s27
    s_nop 0
    buffer_load_dwordx4 v1, s[8:11], s28 offen offset:0 lds
    buffer_load_dwordx4 v1, s[8:11], s28 offen offset:1024 lds
    buffer_load_dwordx4 v1, s[8:11], s28 offen offset:2048 lds
    buffer_load_dwordx4 v1, s[8:11], s28 offen offset:3072 lds
    s_add_u32 s27, s27, 4096
    s_add_u32 s28, s28, 4096
    s_mov_b32 m0, s27
    s_nop 0
    buffer_load_dwordx4 v1, s[8:11], s28 offen offset:0 lds
    buffer_load_dwordx4 v1, s[8:11], s28 offen offset:1024 lds
    buffer_load_dwordx4 v1, s[8:11], s28 offen offset:2048 lds
    buffer_load_dwordx4 v1, s[8:11], s28 offen offset:3072 lds
    s_add_u32 s27, s27, 4096
    s_add_u32 s28, s28, 4096
    s_mov_b32 m0, s27
    s_nop 0
    buffer_load_dwordx4 v1, s[8:11], s28 offen offset:0 lds
    buffer_load_dwordx4 v1, s[8:11], s28 offen offset:1024 lds
    buffer_load_dwordx4 v1, s[8:11], s28 offen offset:2048 lds
    buffer_load_dwordx4 v1, s[8:11], s28 offen offset:3072 lds
    s_add_u32 s27, s27, 4096
    s_add_u32 s28, s28, 4096
    s_mov_b32 m0, s27
    s_nop 0
    buffer_load_dwordx4 v1, s[8:11], s28 offen offset:0 lds
    buffer_load_dwordx4 v1, s[8:11], s28 offen offset:1024 lds
    buffer_load_dwordx4 v1, s[8:11], s28 offen offset:2048 lds
    buffer_load_dwordx4 v1, s[8:11], s28 offen offset:3072 lds
    s_add_u32 s27, s27, 4096
    s_add_u32 s28, s28, 4096
    s_mov_b32 m0, s27
    s_nop 0
    buffer_load_dwordx4 v1, s[8:11], s28 offen offset:0 lds
    s_mov_b32 s81, s87
    v_mbcnt_lo_u32_b32 v0, -1, 0
    v_mbcnt_hi_u32_b32 v0, -1, v0
    s_lshl_b32 s27, s83, 6
    v_add_u32 v0, s27, v0
    s_mov_b32 s2, s81
    s_add_u32 s29, s2, 192
    s_min_u32 s29, s29, 320
    v_lshlrev_b32 v2, 5, v0
    s_lshl_b32 s24, s2, 13
    s_add_u32 s24, s24, 148897792
    buffer_load_dwordx4 v[92:95], v2, s[8:11], s24 offen
    buffer_load_dwordx4 v[96:99], v2, s[8:11], s24 offen offset:16
    v_lshlrev_b32 v2, 5, v0
    s_lshl_b32 s24, s29, 13
    s_add_u32 s24, s24, 148897792
    buffer_load_dwordx4 v[104:107], v2, s[8:11], s24 offen
    buffer_load_dwordx4 v[108:111], v2, s[8:11], s24 offen offset:16
    s_mov_b32 s26, 0x3f3504f3
    s_mov_b32 s27, s26
    v_and_b32 v3, 255, v0
    v_cvt_f32_u32 v3, v3
    v_mul_f32 v4, 0xba000000, v3
    v_cos_f32 v48, v4
    v_sin_f32 v49, v4
    v_mul_f32 v4, 0xba800000, v3
    v_cos_f32 v50, v4
    v_sin_f32 v51, v4
    v_mul_f32 v4, 0xbac00000, v3
    v_cos_f32 v52, v4
    v_sin_f32 v53, v4
    v_mul_f32 v4, 0xbb000000, v3
    v_cos_f32 v54, v4
    v_sin_f32 v55, v4
    v_mul_f32 v4, 0xbb200000, v3
    v_cos_f32 v56, v4
    v_sin_f32 v57, v4
    v_mul_f32 v4, 0xbb400000, v3
    v_cos_f32 v58, v4
    v_sin_f32 v59, v4
    v_mul_f32 v4, 0xbb600000, v3
    v_cos_f32 v60, v4
    v_sin_f32 v61, v4
    v_and_b32 v3, 31, v0
    v_cvt_f32_u32 v3, v3
    v_mul_f32 v4, 0xbb800000, v3
    v_cos_f32 v62, v4
    v_sin_f32 v63, v4
    v_mul_f32 v4, 0xbc000000, v3
    v_cos_f32 v64, v4
    v_sin_f32 v65, v4
    v_mul_f32 v4, 0xbc400000, v3
    v_cos_f32 v66, v4
    v_sin_f32 v67, v4
    v_mul_f32 v4, 0xbc800000, v3
    v_cos_f32 v68, v4
    v_sin_f32 v69, v4
    v_mul_f32 v4, 0xbca00000, v3
    v_cos_f32 v70, v4
    v_sin_f32 v71, v4
    v_mul_f32 v4, 0xbcc00000, v3
    v_cos_f32 v72, v4
    v_sin_f32 v73, v4
    v_mul_f32 v4, 0xbce00000, v3
    v_cos_f32 v74, v4
    v_sin_f32 v75, v4
    v_and_b32 v3, 3, v0
    v_cvt_f32_u32 v3, v3
    v_mul_f32 v4, 0xbd000000, v3
    v_cos_f32 v76, v4
    v_sin_f32 v77, v4
    v_mul_f32 v4, 0xbd800000, v3
    v_cos_f32 v78, v4
    v_sin_f32 v79, v4
    v_mul_f32 v4, 0xbdc00000, v3
    v_cos_f32 v80, v4
    v_sin_f32 v81, v4
    v_mul_f32 v4, 0xbe000000, v3
    v_cos_f32 v82, v4
    v_sin_f32 v83, v4
    v_mul_f32 v4, 0xbe200000, v3
    v_cos_f32 v84, v4
    v_sin_f32 v85, v4
    v_mul_f32 v4, 0xbe400000, v3
    v_cos_f32 v86, v4
    v_sin_f32 v87, v4
    v_mul_f32 v4, 0xbe600000, v3
    v_cos_f32 v88, v4
    v_sin_f32 v89, v4
    v_lshlrev_b32 v3, 3, v0
    v_lshrrev_b32 v4, 5, v0
    v_mul_u32_u24 v4, 2304, v4
    v_add_u32 v3, 102400, v3
    v_add_u32 v4, 102400, v4
    v_and_b32 v5, 31, v0
    v_lshl_add_u32 v5, v5, 3, v4
    v_bfe_u32 v6, v0, 2, 3
    v_mul_u32_u24 v6, 288, v6
    v_add_u32 v6, v6, v4
    v_and_b32 v7, 3, v0
    v_lshl_add_u32 v100, v7, 6, v6
    v_lshl_add_u32 v6, v7, 3, v6
    v_lshrrev_b32 v101, 4, v0
    v_mul_u32_u24 v101, 20480, v101
    v_and_b32 v2, 15, v0
    v_lshl_add_u32 v101, v2, 4, v101
    s_waitcnt vmcnt(0) lgkmcnt(0)
    s_barrier
    s_cmp_lg_u32 s83, 0
    s_cbranch_scc1 main_kernel_gb_19
    s_mov_b32 s23, s85
    s_add_u32 s28, s86, 167841792
    s_lshl_b32 s27, s82, 7
    v_mbcnt_lo_u32_b32 v189, -1, 0
    s_mov_b64 exec, 1
    s_add_u32 s31, s27, s84
    v_mov_b32 v190, s31
    v_mov_b32 v191, 1
    s_cmp_lg_u32 s23, 0
    s_cbranch_scc1 main_kernel_ls_20
    buffer_store_byte v191, v190, s[8:11], s28 offen
main_kernel_ls_20_r:
    s_cmp_lg_u32 s84, 0
    s_cbranch_scc1 main_kernel_gb_18
    s_mov_b64 exec, 0xff
    v_lshl_add_u32 v190, v189, 2, s27
    s_mov_b32 s30, 0
main_kernel_gs_21:
    buffer_load_dword v191, v190, s[8:11], s28 offen sc1
    s_add_u32 s30, s30, 1
    s_cmp_ge_u32 s30, 240000
    s_cbranch_scc1 main_kernel_fail
    s_waitcnt vmcnt(0)
    v_cmp_ne_u32 vcc, 0x1010101, v191
    s_cbranch_vccnz main_kernel_gs_21
    s_mov_b64 exec, 1
    v_mov_b32 v190, s27
    v_mov_b32 v191, 1
    buffer_store_dword v191, v190, s[8:11], s28 offen offset:1024 sc1
    s_mov_b64 exec, 0x3f
    v_lshlrev_b32 v190, 7, v189
    v_add_u32 v190, 1024, v190
    s_mov_b32 s30, 0
main_kernel_gs_22:
    buffer_load_dword v191, v190, s[8:11], s28 offen sc1
    s_add_u32 s30, s30, 1
    s_cmp_ge_u32 s30, 240000
    s_cbranch_scc1 main_kernel_fail
    s_waitcnt vmcnt(0)
    v_cmp_ne_u32 vcc, 0x1, v191
    s_cbranch_vccnz main_kernel_gs_22
    s_mov_b64 exec, 1
    v_mov_b32 v190, s27
    v_mov_b32 v191, 1
    s_cmp_lg_u32 s23, 0
    s_cbranch_scc1 main_kernel_ls_23
    buffer_store_dword v191, v190, s[8:11], s28 offen offset:2048
main_kernel_ls_23_r:
main_kernel_gb_18:
    s_mov_b64 exec, 0x1
    s_add_u32 s31, s27, 2048
    v_mov_b32 v190, s31
    s_mov_b32 s30, 0
main_kernel_gs_24:
    buffer_load_dword v191, v190, s[8:11], s28 offen sc1
    s_add_u32 s30, s30, 1
    s_cmp_ge_u32 s30, 240000
    s_cbranch_scc1 main_kernel_fail
    s_waitcnt vmcnt(0)
    v_cmp_ne_u32 vcc, 0x1, v191
    s_cbranch_vccnz main_kernel_gs_24
    s_mov_b64 exec, -1
main_kernel_gb_19:
    s_barrier
    s_mov_b32 s26, 0x3f3504f3
    s_mov_b32 s27, s26
    s_add_u32 s29, s2, 192
    v_lshlrev_b32 v1, 2, v0
    s_lshl_b32 s20, s2, 13
    s_add_u32 s20, s20, 157286400
    s_add_u32 s21, s20, 2621440
    s_cmp_eq_u32 s2, 0
    s_cselect_b32 s21, 0x10000000, s21
    s_cmp_ge_u32 s2, 320
    s_cselect_b32 s21, 0x10000000, s21
    s_cmp_ge_u32 s2, 321
    s_cselect_b32 s20, 0x10000000, s20
    s_add_u32 s22, s20, 4096
    s_add_u32 s23, s21, 4096
    buffer_load_dword v8, v1, s[8:11], s20 offen offset:0 sc1
    buffer_load_dword v9, v1, s[8:11], s21 offen offset:0 sc1
    buffer_load_dword v10, v1, s[8:11], s20 offen offset:1024 sc1
    buffer_load_dword v11, v1, s[8:11], s21 offen offset:1024 sc1
    buffer_load_dword v12, v1, s[8:11], s20 offen offset:2048 sc1
    buffer_load_dword v13, v1, s[8:11], s21 offen offset:2048 sc1
    buffer_load_dword v14, v1, s[8:11], s20 offen offset:3072 sc1
    buffer_load_dword v15, v1, s[8:11], s21 offen offset:3072 sc1
    buffer_load_dword v16, v1, s[8:11], s22 offen offset:0 sc1
    buffer_load_dword v17, v1, s[8:11], s23 offen offset:0 sc1
    buffer_load_dword v18, v1, s[8:11], s22 offen offset:1024 sc1
    buffer_load_dword v19, v1, s[8:11], s23 offen offset:1024 sc1
    buffer_load_dword v20, v1, s[8:11], s22 offen offset:2048 sc1
    buffer_load_dword v21, v1, s[8:11], s23 offen offset:2048 sc1
    buffer_load_dword v22, v1, s[8:11], s22 offen offset:3072 sc1
    buffer_load_dword v23, v1, s[8:11], s23 offen offset:3072 sc1
    v_lshlrev_b32 v1, 2, v0
    s_lshl_b32 s20, s29, 13
    s_add_u32 s20, s20, 157286400
    s_add_u32 s21, s20, 2621440
    s_cmp_eq_u32 s29, 0
    s_cselect_b32 s21, 0x10000000, s21
    s_cmp_ge_u32 s29, 320
    s_cselect_b32 s21, 0x10000000, s21
    s_cmp_ge_u32 s29, 321
    s_cselect_b32 s20, 0x10000000, s20
    s_add_u32 s22, s20, 4096
    s_add_u32 s23, s21, 4096
    buffer_load_dword v112, v1, s[8:11], s20 offen offset:0 sc1
    buffer_load_dword v113, v1, s[8:11], s21 offen offset:0 sc1
    buffer_load_dword v114, v1, s[8:11], s20 offen offset:1024 sc1
    buffer_load_dword v115, v1, s[8:11], s21 offen offset:1024 sc1
    buffer_load_dword v116, v1, s[8:11], s20 offen offset:2048 sc1
    buffer_load_dword v117, v1, s[8:11], s21 offen offset:2048 sc1
    buffer_load_dword v118, v1, s[8:11], s20 offen offset:3072 sc1
    buffer_load_dword v119, v1, s[8:11], s21 offen offset:3072 sc1
    buffer_load_dword v120, v1, s[8:11], s22 offen offset:0 sc1
    buffer_load_dword v121, v1, s[8:11], s23 offen offset:0 sc1
    buffer_load_dword v122, v1, s[8:11], s22 offen offset:1024 sc1
    buffer_load_dword v123, v1, s[8:11], s23 offen offset:1024 sc1
    buffer_load_dword v124, v1, s[8:11], s22 offen offset:2048 sc1
    buffer_load_dword v125, v1, s[8:11], s23 offen offset:2048 sc1
    buffer_load_dword v126, v1, s[8:11], s22 offen offset:3072 sc1
    buffer_load_dword v127, v1, s[8:11], s23 offen offset:3072 sc1
    s_waitcnt vmcnt(16)
    v_pk_add_f32 v[24:25], v[8:9], v[16:17]
    v_pk_add_f32 v[26:27], v[8:9], v[16:17] neg_lo:[0,1] neg_hi:[0,1]
    v_pk_add_f32 v[28:29], v[10:11], v[18:19]
    v_pk_add_f32 v[30:31], v[10:11], v[18:19] neg_lo:[0,1] neg_hi:[0,1]
    v_pk_add_f32 v[32:33], v[12:13], v[20:21]
    v_pk_add_f32 v[34:35], v[12:13], v[20:21] neg_lo:[0,1] neg_hi:[0,1]
    v_pk_add_f32 v[36:37], v[14:15], v[22:23]
    v_pk_add_f32 v[38:39], v[14:15], v[22:23] neg_lo:[0,1] neg_hi:[0,1]
    v_pk_add_f32 v[40:41], v[24:25], v[32:33]
    v_pk_add_f32 v[42:43], v[24:25], v[32:33] neg_lo:[0,1] neg_hi:[0,1]
    v_pk_add_f32 v[44:45], v[28:29], v[36:37]
    v_pk_add_f32 v[46:47], v[28:29], v[36:37] neg_lo:[0,1] neg_hi:[0,1]
    v_pk_add_f32 v[8:9], v[40:41], v[44:45]
    v_pk_add_f32 v[16:17], v[40:41], v[44:45] neg_lo:[0,1] neg_hi:[0,1]
    v_pk_add_f32 v[10:11], v[42:43], v[46:47] op_sel:[0,1] op_sel_hi:[1,0] neg_lo:[0,0] neg_hi:[0,1]
    v_pk_add_f32 v[18:19], v[42:43], v[46:47] op_sel:[0,1] op_sel_hi:[1,0] neg_lo:[0,1] neg_hi:[0,0]
    v_pk_add_f32 v[12:13], v[30:31], v[30:31] op_sel:[0,1] op_sel_hi:[1,0] neg_lo:[0,0] neg_hi:[0,1]
    v_pk_add_f32 v[20:21], v[38:39], v[38:39] op_sel:[0,1] op_sel_hi:[1,0] neg_lo:[1,0] neg_hi:[1,1]
    v_pk_add_f32 v[14:15], v[26:27], v[34:35] op_sel:[0,1] op_sel_hi:[1,0] neg_lo:[0,0] neg_hi:[0,1]
    v_pk_add_f32 v[22:23], v[26:27], v[34:35] op_sel:[0,1] op_sel_hi:[1,0] neg_lo:[0,1] neg_hi:[0,0]
    v_pk_add_f32 v[24:25], v[12:13], v[20:21]
    v_pk_add_f32 v[28:29], v[12:13], v[20:21] neg_lo:[0,1] neg_hi:[0,1]
    v_pk_fma_f32 v[32:33], v[24:25], s[26:27], v[14:15] neg_lo:[0,0,0] neg_hi:[0,0,0]
    v_pk_fma_f32 v[36:37], v[24:25], s[26:27], v[14:15] neg_lo:[1,0,0] neg_hi:[1,0,0]
    v_pk_fma_f32 v[40:41], v[28:29], s[26:27], v[22:23] op_sel:[1,0,0] op_sel_hi:[0,1,1] neg_lo:[0,0,0] neg_hi:[1,0,0]
    v_pk_fma_f32 v[42:43], v[28:29], s[26:27], v[22:23] op_sel:[1,0,0] op_sel_hi:[0,1,1] neg_lo:[1,0,0] neg_hi:[0,0,0]
    v_pk_mul_f32 v[44:45], v[32:33], v[48:49] op_sel:[0,0] op_sel_hi:[1,0]
    v_pk_fma_f32 v[44:45], v[32:33], v[48:49], v[44:45] op_sel:[1,1,0] op_sel_hi:[0,1,1] neg_lo:[1,0,0] neg_hi:[0,0,0]
    v_pk_mul_f32 v[46:47], v[10:11], v[50:51] op_sel:[0,0] op_sel_hi:[1,0]
    v_pk_fma_f32 v[46:47], v[10:11], v[50:51], v[46:47] op_sel:[1,1,0] op_sel_hi:[0,1,1] neg_lo:[1,0,0] neg_hi:[0,0,0]
    v_pk_mul_f32 v[26:27], v[40:41], v[52:53] op_sel:[0,0] op_sel_hi:[1,0]
    v_pk_fma_f32 v[26:27], v[40:41], v[52:53], v[26:27] op_sel:[1,1,0] op_sel_hi:[0,1,1] neg_lo:[1,0,0] neg_hi:[0,0,0]
    v_pk_mul_f32 v[30:31], v[16:17], v[54:55] op_sel:[0,0] op_sel_hi:[1,0]
    v_pk_fma_f32 v[30:31], v[16:17], v[54:55], v[30:31] op_sel:[1,1,0] op_sel_hi:[0,1,1] neg_lo:[1,0,0] neg_hi:[0,0,0]
    v_pk_mul_f32 v[34:35], v[36:37], v[56:57] op_sel:[0,0] op_sel_hi:[1,0]
    v_pk_fma_f32 v[34:35], v[36:37], v[56:57], v[34:35] op_sel:[1,1,0] op_sel_hi:[0,1,1] neg_lo:[1,0,0] neg_hi:[0,0,0]
    v_pk_mul_f32 v[38:39], v[18:19], v[58:59] op_sel:[0,0] op_sel_hi:[1,0]
    v_pk_fma_f32 v[38:39], v[18:19], v[58:59], v[38:39] op_sel:[1,1,0] op_sel_hi:[0,1,1] neg_lo:[1,0,0] neg_hi:[0,0,0]
    v_pk_mul_f32 v[12:13], v[42:43], v[60:61] op_sel:[0,0] op_sel_hi:[1,0]
    v_pk_fma_f32 v[12:13], v[42:43], v[60:61], v[12:13] op_sel:[1,1,0] op_sel_hi:[0,1,1] neg_lo:[1,0,0] neg_hi:[0,0,0]
    ds_write_b64 v3, v[8:9] offset:0
    ds_write_b64 v3, v[44:45] offset:2304
    ds_write_b64 v3, v[46:47] offset:4608
    ds_write_b64 v3, v[26:27] offset:6912
    ds_write_b64 v3, v[30:31] offset:9216
    ds_write_b64 v3, v[34:35] offset:11520
    ds_write_b64 v3, v[38:39] offset:13824
    ds_write_b64 v3, v[12:13] offset:16128
    s_waitcnt lgkmcnt(0)
    s_barrier
    ds_read_b64 v[20:21], v5 offset:0
    ds_read_b64 v[14:15], v5 offset:256
    ds_read_b64 v[22:23], v5 offset:512
    ds_read_b64 v[24:25], v5 offset:768
    ds_read_b64 v[28:29], v5 offset:1024
    ds_read_b64 v[32:33], v5 offset:1280
    ds_read_b64 v[10:11], v5 offset:1536
    ds_read_b64 v[40:41], v5 offset:1792
    s_waitcnt lgkmcnt(0)
    v_pk_add_f32 v[16:17], v[20:21], v[28:29]
    v_pk_add_f32 v[36:37], v[20:21], v[28:29] neg_lo:[0,1] neg_hi:[0,1]
    v_pk_add_f32 v[18:19], v[14:15], v[32:33]
    v_pk_add_f32 v[42:43], v[14:15], v[32:33] neg_lo:[0,1] neg_hi:[0,1]
    v_pk_add_f32 v[8:9], v[22:23], v[10:11]
    v_pk_add_f32 v[44:45], v[22:23], v[10:11] neg_lo:[0,1] neg_hi:[0,1]
    v_pk_add_f32 v[46:47], v[24:25], v[40:41]
    v_pk_add_f32 v[26:27], v[24:25], v[40:41] neg_lo:[0,1] neg_hi:[0,1]
    v_pk_add_f32 v[30:31], v[16:17], v[8:9]
    v_pk_add_f32 v[34:35], v[16:17], v[8:9] neg_lo:[0,1] neg_hi:[0,1]
    v_pk_add_f32 v[38:39], v[18:19], v[46:47]
    v_pk_add_f32 v[12:13], v[18:19], v[46:47] neg_lo:[0,1] neg_hi:[0,1]
    v_pk_add_f32 v[20:21], v[30:31], v[38:39]
    v_pk_add_f32 v[28:29], v[30:31], v[38:39] neg_lo:[0,1] neg_hi:[0,1]
    v_pk_add_f32 v[14:15], v[34:35], v[12:13] op_sel:[0,1] op_sel_hi:[1,0] neg_lo:[0,0] neg_hi:[0,1]
    v_pk_add_f32 v[32:33], v[34:35], v[12:13] op_sel:[0,1] op_sel_hi:[1,0] neg_lo:[0,1] neg_hi:[0,0]
    v_pk_add_f32 v[22:23], v[42:43], v[42:43] op_sel:[0,1] op_sel_hi:[1,0] neg_lo:[0,0] neg_hi:[0,1]
    v_pk_add_f32 v[10:11], v[26:27], v[26:27] op_sel:[0,1] op_sel_hi:[1,0] neg_lo:[1,0] neg_hi:[1,1]
    v_pk_add_f32 v[24:25], v[36:37], v[44:45] op_sel:[0,1] op_sel_hi:[1,0] neg_lo:[0,0] neg_hi:[0,1]
    v_pk_add_f32 v[40:41], v[36:37], v[44:45] op_sel:[0,1] op_sel_hi:[1,0] neg_lo:[0,1] neg_hi:[0,0]
    v_pk_add_f32 v[16:17], v[22:23], v[10:11]
    v_pk_add_f32 v[18:19], v[22:23], v[10:11] neg_lo:[0,1] neg_hi:[0,1]
    v_pk_fma_f32 v[8:9], v[16:17], s[26:27], v[24:25] neg_lo:[0,0,0] neg_hi:[0,0,0]
    v_pk_fma_f32 v[46:47], v[16:17], s[26:27], v[24:25] neg_lo:[1,0,0] neg_hi:[1,0,0]
    v_pk_fma_f32 v[30:31], v[18:19], s[26:27], v[40:41] op_sel:[1,0,0] op_sel_hi:[0,1,1] neg_lo:[0,0,0] neg_hi:[1,0,0]
    v_pk_fma_f32 v[34:35], v[18:19], s[26:27], v[40:41] op_sel:[1,0,0] op_sel_hi:[0,1,1] neg_lo:[1,0,0] neg_hi:[0,0,0]
    v_pk_mul_f32 v[38:39], v[8:9], v[62:63] op_sel:[0,0] op_sel_hi:[1,0]
    v_pk_fma_f32 v[38:39], v[8:9], v[62:63], v[38:39] op_sel:[1,1,0] op_sel_hi:[0,1,1] neg_lo:[1,0,0] neg_hi:[0,0,0]
    v_pk_mul_f32 v[12:13], v[14:15], v[64:65] op_sel:[0,0] op_sel_hi:[1,0]
    v_pk_fma_f32 v[12:13], v[14:15], v[64:65], v[12:13] op_sel:[1,1,0] op_sel_hi:[0,1,1] neg_lo:[1,0,0] neg_hi:[0,0,0]
    v_pk_mul_f32 v[36:37], v[30:31], v[66:67] op_sel:[0,0] op_sel_hi:[1,0]
    v_pk_fma_f32 v[36:37], v[30:31], v[66:67], v[36:37] op_sel:[1,1,0] op_sel_hi:[0,1,1] neg_lo:[1,0,0] neg_hi:[0,0,0]
    v_pk_mul_f32 v[42:43], v[28:29], v[68:69] op_sel:[0,0] op_sel_hi:[1,0]
    v_pk_fma_f32 v[42:43], v[28:29], v[68:69], v[42:43] op_sel:[1,1,0] op_sel_hi:[0,1,1] neg_lo:[1,0,0] neg_hi:[0,0,0]
    v_pk_mul_f32 v[44:45], v[46:47], v[70:71] op_sel:[0,0] op_sel_hi:[1,0]
    v_pk_fma_f32 v[44:45], v[46:47], v[70:71], v[44:45] op_sel:[1,1,0] op_sel_hi:[0,1,1] neg_lo:[1,0,0] neg_hi:[0,0,0]
    v_pk_mul_f32 v[26:27], v[32:33], v[72:73] op_sel:[0,0] op_sel_hi:[1,0]
    v_pk_fma_f32 v[26:27], v[32:33], v[72:73], v[26:27] op_sel:[1,1,0] op_sel_hi:[0,1,1] neg_lo:[1,0,0] neg_hi:[0,0,0]
    v_pk_mul_f32 v[22:23], v[34:35], v[74:75] op_sel:[0,0] op_sel_hi:[1,0]
    v_pk_fma_f32 v[22:23], v[34:35], v[74:75], v[22:23] op_sel:[1,1,0] op_sel_hi:[0,1,1] neg_lo:[1,0,0] neg_hi:[0,0,0]
    ds_write_b64 v5, v[20:21] offset:0
    ds_write_b64 v5, v[38:39] offset:288
    ds_write_b64 v5, v[12:13] offset:576
    ds_write_b64 v5, v[36:37] offset:864
    ds_write_b64 v5, v[42:43] offset:1152
    ds_write_b64 v5, v[44:45] offset:1440
    ds_write_b64 v5, v[26:27] offset:1728
    ds_write_b64 v5, v[22:23] offset:2016
    ds_read_b64 v[10:11], v6 offset:0
    ds_read_b64 v[24:25], v6 offset:32
    ds_read_b64 v[40:41], v6 offset:64
    ds_read_b64 v[16:17], v6 offset:96
    ds_read_b64 v[18:19], v6 offset:128
    ds_read_b64 v[8:9], v6 offset:160
    ds_read_b64 v[14:15], v6 offset:192
    ds_read_b64 v[30:31], v6 offset:224
    s_waitcnt lgkmcnt(0)
    v_pk_add_f32 v[28:29], v[10:11], v[18:19]
    v_pk_add_f32 v[46:47], v[10:11], v[18:19] neg_lo:[0,1] neg_hi:[0,1]
    v_pk_add_f32 v[32:33], v[24:25], v[8:9]
    v_pk_add_f32 v[34:35], v[24:25], v[8:9] neg_lo:[0,1] neg_hi:[0,1]
    v_pk_add_f32 v[20:21], v[40:41], v[14:15]
    v_pk_add_f32 v[38:39], v[40:41], v[14:15] neg_lo:[0,1] neg_hi:[0,1]
    v_pk_add_f32 v[12:13], v[16:17], v[30:31]
    v_pk_add_f32 v[36:37], v[16:17], v[30:31] neg_lo:[0,1] neg_hi:[0,1]
    v_pk_add_f32 v[42:43], v[28:29], v[20:21]
    v_pk_add_f32 v[44:45], v[28:29], v[20:21] neg_lo:[0,1] neg_hi:[0,1]
    v_pk_add_f32 v[26:27], v[32:33], v[12:13]
    v_pk_add_f32 v[22:23], v[32:33], v[12:13] neg_lo:[0,1] neg_hi:[0,1]
    v_pk_add_f32 v[10:11], v[42:43], v[26:27]
    v_pk_add_f32 v[18:19], v[42:43], v[26:27] neg_lo:[0,1] neg_hi:[0,1]
    v_pk_add_f32 v[24:25], v[44:45], v[22:23] op_sel:[0,1] op_sel_hi:[1,0] neg_lo:[0,0] neg_hi:[0,1]
    v_pk_add_f32 v[8:9], v[44:45], v[22:23] op_sel:[0,1] op_sel_hi:[1,0] neg_lo:[0,1] neg_hi:[0,0]
    v_pk_add_f32 v[40:41], v[34:35], v[34:35] op_sel:[0,1] op_sel_hi:[1,0] neg_lo:[0,0] neg_hi:[0,1]
    v_pk_add_f32 v[14:15], v[36:37], v[36:37] op_sel:[0,1] op_sel_hi:[1,0] neg_lo:[1,0] neg_hi:[1,1]
    v_pk_add_f32 v[16:17], v[46:47], v[38:39] op_sel:[0,1] op_sel_hi:[1,0] neg_lo:[0,0] neg_hi:[0,1]
    v_pk_add_f32 v[30:31], v[46:47], v[38:39] op_sel:[0,1] op_sel_hi:[1,0] neg_lo:[0,1] neg_hi:[0,0]
    v_pk_add_f32 v[28:29], v[40:41], v[14:15]
    v_pk_add_f32 v[32:33], v[40:41], v[14:15] neg_lo:[0,1] neg_hi:[0,1]
    v_pk_fma_f32 v[20:21], v[28:29], s[26:27], v[16:17] neg_lo:[0,0,0] neg_hi:[0,0,0]
    v_pk_fma_f32 v[12:13], v[28:29], s[26:27], v[16:17] neg_lo:[1,0,0] neg_hi:[1,0,0]
    v_pk_fma_f32 v[42:43], v[32:33], s[26:27], v[30:31] op_sel:[1,0,0] op_sel_hi:[0,1,1] neg_lo:[0,0,0] neg_hi:[1,0,0]
    v_pk_fma_f32 v[44:45], v[32:33], s[26:27], v[30:31] op_sel:[1,0,0] op_sel_hi:[0,1,1] neg_lo:[1,0,0] neg_hi:[0,0,0]
    v_pk_mul_f32 v[26:27], v[20:21], v[76:77] op_sel:[0,0] op_sel_hi:[1,0]
    v_pk_fma_f32 v[26:27], v[20:21], v[76:77], v[26:27] op_sel:[1,1,0] op_sel_hi:[0,1,1] neg_lo:[1,0,0] neg_hi:[0,0,0]
    v_pk_mul_f32 v[22:23], v[24:25], v[78:79] op_sel:[0,0] op_sel_hi:[1,0]
    v_pk_fma_f32 v[22:23], v[24:25], v[78:79], v[22:23] op_sel:[1,1,0] op_sel_hi:[0,1,1] neg_lo:[1,0,0] neg_hi:[0,0,0]
    v_pk_mul_f32 v[46:47], v[42:43], v[80:81] op_sel:[0,0] op_sel_hi:[1,0]
    v_pk_fma_f32 v[46:47], v[42:43], v[80:81], v[46:47] op_sel:[1,1,0] op_sel_hi:[0,1,1] neg_lo:[1,0,0] neg_hi:[0,0,0]
    v_pk_mul_f32 v[34:35], v[18:19], v[82:83] op_sel:[0,0] op_sel_hi:[1,0]
    v_pk_fma_f32 v[34:35], v[18:19], v[82:83], v[34:35] op_sel:[1,1,0] op_sel_hi:[0,1,1] neg_lo:[1,0,0] neg_hi:[0,0,0]
    v_pk_mul_f32 v[38:39], v[12:13], v[84:85] op_sel:[0,0] op_sel_hi:[1,0]
    v_pk_fma_f32 v[38:39], v[12:13], v[84:85], v[38:39] op_sel:[1,1,0] op_sel_hi:[0,1,1] neg_lo:[1,0,0] neg_hi:[0,0,0]
    v_pk_mul_f32 v[36:37], v[8:9], v[86:87] op_sel:[0,0] op_sel_hi:[1,0]
    v_pk_fma_f32 v[36:37], v[8:9], v[86:87], v[36:37] op_sel:[1,1,0] op_sel_hi:[0,1,1] neg_lo:[1,0,0] neg_hi:[0,0,0]
    v_pk_mul_f32 v[40:41], v[44:45], v[88:89] op_sel:[0,0] op_sel_hi:[1,0]
    v_pk_fma_f32 v[40:41], v[44:45], v[88:89], v[40:41] op_sel:[1,1,0] op_sel_hi:[0,1,1] neg_lo:[1,0,0] neg_hi:[0,0,0]
    ds_write_b64 v6, v[10:11] offset:0
    ds_write_b64 v6, v[26:27] offset:32
    ds_write_b64 v6, v[22:23] offset:64
    ds_write_b64 v6, v[46:47] offset:96
    ds_write_b64 v6, v[34:35] offset:128
    ds_write_b64 v6, v[38:39] offset:160
    ds_write_b64 v6, v[36:37] offset:192
    ds_write_b64 v6, v[40:41] offset:224
    ds_read_b64 v[14:15], v100 offset:0
    ds_read_b64 v[16:17], v100 offset:8
    ds_read_b64 v[30:31], v100 offset:16
    ds_read_b64 v[28:29], v100 offset:24
    ds_read_b64 v[32:33], v100 offset:32
    ds_read_b64 v[20:21], v100 offset:40
    ds_read_b64 v[24:25], v100 offset:48
    ds_read_b64 v[42:43], v100 offset:56
    s_waitcnt lgkmcnt(0)
    v_pk_add_f32 v[18:19], v[14:15], v[30:31]
    v_pk_add_f32 v[12:13], v[14:15], v[30:31] neg_lo:[0,1] neg_hi:[0,1]
    v_pk_add_f32 v[8:9], v[16:17], v[28:29]
    v_pk_add_f32 v[44:45], v[16:17], v[28:29] neg_lo:[0,1] neg_hi:[0,1]
    v_pk_add_f32 v[10:11], v[18:19], v[8:9]
    v_pk_add_f32 v[26:27], v[18:19], v[8:9] neg_lo:[0,1] neg_hi:[0,1]
    v_pk_add_f32 v[22:23], v[12:13], v[44:45] op_sel:[0,1] op_sel_hi:[1,0] neg_lo:[0,0] neg_hi:[0,1]
    v_pk_add_f32 v[46:47], v[12:13], v[44:45] op_sel:[0,1] op_sel_hi:[1,0] neg_lo:[0,1] neg_hi:[0,0]
    v_pk_add_f32 v[34:35], v[32:33], v[24:25]
    v_pk_add_f32 v[38:39], v[32:33], v[24:25] neg_lo:[0,1] neg_hi:[0,1]
    v_pk_add_f32 v[36:37], v[20:21], v[42:43]
    v_pk_add_f32 v[40:41], v[20:21], v[42:43] neg_lo:[0,1] neg_hi:[0,1]
    v_pk_add_f32 v[14:15], v[34:35], v[36:37]
    v_pk_add_f32 v[16:17], v[34:35], v[36:37] neg_lo:[0,1] neg_hi:[0,1]
    v_pk_add_f32 v[30:31], v[38:39], v[40:41] op_sel:[0,1] op_sel_hi:[1,0] neg_lo:[0,0] neg_hi:[0,1]
    v_pk_add_f32 v[28:29], v[38:39], v[40:41] op_sel:[0,1] op_sel_hi:[1,0] neg_lo:[0,1] neg_hi:[0,0]
    v_lshlrev_b32 v18, 16, v92
    v_and_b32 v19, 0xffff0000, v92
    v_pk_mul_f32 v[12:13], v[10:11], v[18:19] op_sel:[0,0] op_sel_hi:[1,0]
    v_pk_fma_f32 v[12:13], v[10:11], v[18:19], v[12:13] op_sel:[1,1,0] op_sel_hi:[0,1,1] neg_lo:[1,0,0] neg_hi:[0,0,0]
    v_lshlrev_b32 v8, 16, v93
    v_and_b32 v9, 0xffff0000, v93
    v_pk_mul_f32 v[44:45], v[22:23], v[8:9] op_sel:[0,0] op_sel_hi:[1,0]
    v_pk_fma_f32 v[44:45], v[22:23], v[8:9], v[44:45] op_sel:[1,1,0] op_sel_hi:[0,1,1] neg_lo:[1,0,0] neg_hi:[0,0,0]
    v_lshlrev_b32 v32, 16, v94
    v_and_b32 v33, 0xffff0000, v94
    v_pk_mul_f32 v[20:21], v[26:27], v[32:33] op_sel:[0,0] op_sel_hi:[1,0]
    v_pk_fma_f32 v[20:21], v[26:27], v[32:33], v[20:21] op_sel:[1,1,0] op_sel_hi:[0,1,1] neg_lo:[1,0,0] neg_hi:[0,0,0]
    v_lshlrev_b32 v24, 16, v95
    v_and_b32 v25, 0xffff0000, v95
    v_pk_mul_f32 v[42:43], v[46:47], v[24:25] op_sel:[0,0] op_sel_hi:[1,0]
    v_pk_fma_f32 v[42:43], v[46:47], v[24:25], v[42:43] op_sel:[1,1,0] op_sel_hi:[0,1,1] neg_lo:[1,0,0] neg_hi:[0,0,0]
    v_lshlrev_b32 v34, 16, v96
    v_and_b32 v35, 0xffff0000, v96
    v_pk_mul_f32 v[38:39], v[14:15], v[34:35] op_sel:[0,0] op_sel_hi:[1,0]
    v_pk_fma_f32 v[38:39], v[14:15], v[34:35], v[38:39] op_sel:[1,1,0] op_sel_hi:[0,1,1] neg_lo:[1,0,0] neg_hi:[0,0,0]
    v_lshlrev_b32 v36, 16, v97
    v_and_b32 v37, 0xffff0000, v97
    v_pk_mul_f32 v[40:41], v[30:31], v[36:37] op_sel:[0,0] op_sel_hi:[1,0]
    v_pk_fma_f32 v[40:41], v[30:31], v[36:37], v[40:41] op_sel:[1,1,0] op_sel_hi:[0,1,1] neg_lo:[1,0,0] neg_hi:[0,0,0]
    v_lshlrev_b32 v10, 16, v98
    v_and_b32 v11, 0xffff0000, v98
    v_pk_mul_f32 v[18:19], v[16:17], v[10:11] op_sel:[0,0] op_sel_hi:[1,0]
    v_pk_fma_f32 v[18:19], v[16:17], v[10:11], v[18:19] op_sel:[1,1,0] op_sel_hi:[0,1,1] neg_lo:[1,0,0] neg_hi:[0,0,0]
    v_lshlrev_b32 v22, 16, v99
    v_and_b32 v23, 0xffff0000, v99
    v_pk_mul_f32 v[8:9], v[28:29], v[22:23] op_sel:[0,0] op_sel_hi:[1,0]
    v_pk_fma_f32 v[8:9], v[28:29], v[22:23], v[8:9] op_sel:[1,1,0] op_sel_hi:[0,1,1] neg_lo:[1,0,0] neg_hi:[0,0,0]
    v_pk_add_f32 v[26:27], v[12:13], v[20:21]
    v_pk_add_f32 v[32:33], v[12:13], v[20:21] neg_lo:[0,1] neg_hi:[0,1]
    v_pk_add_f32 v[46:47], v[44:45], v[42:43]
    v_pk_add_f32 v[24:25], v[44:45], v[42:43] neg_lo:[0,1] neg_hi:[0,1]
    v_pk_add_f32 v[14:15], v[26:27], v[46:47]
    v_pk_add_f32 v[34:35], v[26:27], v[46:47] neg_lo:[0,1] neg_hi:[0,1]
    v_pk_add_f32 v[30:31], v[32:33], v[24:25] op_sel:[0,1] op_sel_hi:[1,0] neg_lo:[0,1] neg_hi:[0,0]
    v_pk_add_f32 v[36:37], v[32:33], v[24:25] op_sel:[0,1] op_sel_hi:[1,0] neg_lo:[0,0] neg_hi:[0,1]
    v_pk_add_f32 v[16:17], v[38:39], v[18:19]
    v_pk_add_f32 v[10:11], v[38:39], v[18:19] neg_lo:[0,1] neg_hi:[0,1]
    v_pk_add_f32 v[28:29], v[40:41], v[8:9]
    v_pk_add_f32 v[22:23], v[40:41], v[8:9] neg_lo:[0,1] neg_hi:[0,1]
    v_pk_add_f32 v[12:13], v[16:17], v[28:29]
    v_pk_add_f32 v[44:45], v[16:17], v[28:29] neg_lo:[0,1] neg_hi:[0,1]
    v_pk_add_f32 v[20:21], v[10:11], v[22:23] op_sel:[0,1] op_sel_hi:[1,0] neg_lo:[0,1] neg_hi:[0,0]
    v_pk_add_f32 v[42:43], v[10:11], v[22:23] op_sel:[0,1] op_sel_hi:[1,0] neg_lo:[0,0] neg_hi:[0,1]
    ds_write_b64 v100, v[14:15] offset:0
    ds_write_b64 v100, v[30:31] offset:8
    ds_write_b64 v100, v[34:35] offset:16
    ds_write_b64 v100, v[36:37] offset:24
    ds_write_b64 v100, v[12:13] offset:32
    ds_write_b64 v100, v[20:21] offset:40
    ds_write_b64 v100, v[44:45] offset:48
    ds_write_b64 v100, v[42:43] offset:56
    ds_read_b64 v[26:27], v6 offset:0
    ds_read_b64 v[32:33], v6 offset:32
    ds_read_b64 v[46:47], v6 offset:64
    ds_read_b64 v[24:25], v6 offset:96
    ds_read_b64 v[38:39], v6 offset:128
    ds_read_b64 v[40:41], v6 offset:160
    ds_read_b64 v[18:19], v6 offset:192
    ds_read_b64 v[8:9], v6 offset:224
    s_waitcnt lgkmcnt(0)
    v_pk_mul_f32 v[16:17], v[32:33], v[76:77] op_sel:[0,0] op_sel_hi:[1,0]
    v_pk_fma_f32 v[16:17], v[32:33], v[76:77], v[16:17] op_sel:[1,1,0] op_sel_hi:[0,1,1] neg_lo:[0,0,0] neg_hi:[1,0,0]
    v_pk_mul_f32 v[10:11], v[46:47], v[78:79] op_sel:[0,0] op_sel_hi:[1,0]
    v_pk_fma_f32 v[10:11], v[46:47], v[78:79], v[10:11] op_sel:[1,1,0] op_sel_hi:[0,1,1] neg_lo:[0,0,0] neg_hi:[1,0,0]
    v_pk_mul_f32 v[28:29], v[24:25], v[80:81] op_sel:[0,0] op_sel_hi:[1,0]
    v_pk_fma_f32 v[28:29], v[24:25], v[80:81], v[28:29] op_sel:[1,1,0] op_sel_hi:[0,1,1] neg_lo:[0,0,0] neg_hi:[1,0,0]
    v_pk_mul_f32 v[22:23], v[38:39], v[82:83] op_sel:[0,0] op_sel_hi:[1,0]
    v_pk_fma_f32 v[22:23], v[38:39], v[82:83], v[22:23] op_sel:[1,1,0] op_sel_hi:[0,1,1] neg_lo:[0,0,0] neg_hi:[1,0,0]
    v_pk_mul_f32 v[14:15], v[40:41], v[84:85] op_sel:[0,0] op_sel_hi:[1,0]
    v_pk_fma_f32 v[14:15], v[40:41], v[84:85], v[14:15] op_sel:[1,1,0] op_sel_hi:[0,1,1] neg_lo:[0,0,0] neg_hi:[1,0,0]
    v_pk_mul_f32 v[30:31], v[18:19], v[86:87] op_sel:[0,0] op_sel_hi:[1,0]
    v_pk_fma_f32 v[30:31], v[18:19], v[86:87], v[30:31] op_sel:[1,1,0] op_sel_hi:[0,1,1] neg_lo:[0,0,0] neg_hi:[1,0,0]
    v_pk_mul_f32 v[34:35], v[8:9], v[88:89] op_sel:[0,0] op_sel_hi:[1,0]
    v_pk_fma_f32 v[34:35], v[8:9], v[88:89], v[34:35] op_sel:[1,1,0] op_sel_hi:[0,1,1] neg_lo:[0,0,0] neg_hi:[1,0,0]
    v_pk_add_f32 v[36:37], v[26:27], v[22:23]
    v_pk_add_f32 v[12:13], v[26:27], v[22:23] neg_lo:[0,1] neg_hi:[0,1]
    v_pk_add_f32 v[20:21], v[16:17], v[14:15]
    v_pk_add_f32 v[44:45], v[16:17], v[14:15] neg_lo:[0,1] neg_hi:[0,1]
    v_pk_add_f32 v[42:43], v[10:11], v[30:31]
    v_pk_add_f32 v[32:33], v[10:11], v[30:31] neg_lo:[0,1] neg_hi:[0,1]
    v_pk_add_f32 v[46:47], v[28:29], v[34:35]
    v_pk_add_f32 v[24:25], v[28:29], v[34:35] neg_lo:[0,1] neg_hi:[0,1]
    v_pk_add_f32 v[38:39], v[36:37], v[42:43]
    v_pk_add_f32 v[40:41], v[36:37], v[42:43] neg_lo:[0,1] neg_hi:[0,1]
    v_pk_add_f32 v[18:19], v[20:21], v[46:47]
    v_pk_add_f32 v[8:9], v[20:21], v[46:47] neg_lo:[0,1] neg_hi:[0,1]
    v_pk_add_f32 v[26:27], v[38:39], v[18:19]
    v_pk_add_f32 v[22:23], v[38:39], v[18:19] neg_lo:[0,1] neg_hi:[0,1]
    v_pk_add_f32 v[16:17], v[40:41], v[8:9] op_sel:[0,1] op_sel_hi:[1,0] neg_lo:[0,1] neg_hi:[0,0]
    v_pk_add_f32 v[14:15], v[40:41], v[8:9] op_sel:[0,1] op_sel_hi:[1,0] neg_lo:[0,0] neg_hi:[0,1]
    v_pk_add_f32 v[10:11], v[44:45], v[44:45] op_sel:[0,1] op_sel_hi:[1,0] neg_lo:[0,1] neg_hi:[0,0]
    v_pk_add_f32 v[30:31], v[24:25], v[24:25] op_sel:[0,1] op_sel_hi:[1,0] neg_lo:[1,1] neg_hi:[1,0]
    v_pk_add_f32 v[28:29], v[12:13], v[32:33] op_sel:[0,1] op_sel_hi:[1,0] neg_lo:[0,1] neg_hi:[0,0]
    v_pk_add_f32 v[34:35], v[12:13], v[32:33] op_sel:[0,1] op_sel_hi:[1,0] neg_lo:[0,0] neg_hi:[0,1]
    v_pk_add_f32 v[36:37], v[10:11], v[30:31]
    v_pk_add_f32 v[20:21], v[10:11], v[30:31] neg_lo:[0,1] neg_hi:[0,1]
    v_pk_fma_f32 v[42:43], v[36:37], s[26:27], v[28:29] neg_lo:[0,0,0] neg_hi:[0,0,0]
    v_pk_fma_f32 v[46:47], v[36:37], s[26:27], v[28:29] neg_lo:[1,0,0] neg_hi:[1,0,0]
    v_pk_fma_f32 v[38:39], v[20:21], s[26:27], v[34:35] op_sel:[1,0,0] op_sel_hi:[0,1,1] neg_lo:[1,0,0] neg_hi:[0,0,0]
    v_pk_fma_f32 v[40:41], v[20:21], s[26:27], v[34:35] op_sel:[1,0,0] op_sel_hi:[0,1,1] neg_lo:[0,0,0] neg_hi:[1,0,0]
    ds_write_b64 v6, v[26:27] offset:0
    ds_write_b64 v6, v[42:43] offset:32
    ds_write_b64 v6, v[16:17] offset:64
    ds_write_b64 v6, v[38:39] offset:96
    ds_write_b64 v6, v[22:23] offset:128
    ds_write_b64 v6, v[46:47] offset:160
    ds_write_b64 v6, v[14:15] offset:192
    ds_write_b64 v6, v[40:41] offset:224
    ds_read_b64 v[18:19], v5 offset:0
    ds_read_b64 v[8:9], v5 offset:288
    ds_read_b64 v[12:13], v5 offset:576
    ds_read_b64 v[44:45], v5 offset:864
    ds_read_b64 v[32:33], v5 offset:1152
    ds_read_b64 v[24:25], v5 offset:1440
    ds_read_b64 v[10:11], v5 offset:1728
    ds_read_b64 v[30:31], v5 offset:2016
    s_waitcnt lgkmcnt(0)
    v_pk_mul_f32 v[28:29], v[8:9], v[62:63] op_sel:[0,0] op_sel_hi:[1,0]
    v_pk_fma_f32 v[28:29], v[8:9], v[62:63], v[28:29] op_sel:[1,1,0] op_sel_hi:[0,1,1] neg_lo:[0,0,0] neg_hi:[1,0,0]
    v_pk_mul_f32 v[34:35], v[12:13], v[64:65] op_sel:[0,0] op_sel_hi:[1,0]
    v_pk_fma_f32 v[34:35], v[12:13], v[64:65], v[34:35] op_sel:[1,1,0] op_sel_hi:[0,1,1] neg_lo:[0,0,0] neg_hi:[1,0,0]
    v_pk_mul_f32 v[36:37], v[44:45], v[66:67] op_sel:[0,0] op_sel_hi:[1,0]
    v_pk_fma_f32 v[36:37], v[44:45], v[66:67], v[36:37] op_sel:[1,1,0] op_sel_hi:[0,1,1] neg_lo:[0,0,0] neg_hi:[1,0,0]
    v_pk_mul_f32 v[20:21], v[32:33], v[68:69] op_sel:[0,0] op_sel_hi:[1,0]
    v_pk_fma_f32 v[20:21], v[32:33], v[68:69], v[20:21] op_sel:[1,1,0] op_sel_hi:[0,1,1] neg_lo:[0,0,0] neg_hi:[1,0,0]
    v_pk_mul_f32 v[26:27], v[24:25], v[70:71] op_sel:[0,0] op_sel_hi:[1,0]
    v_pk_fma_f32 v[26:27], v[24:25], v[70:71], v[26:27] op_sel:[1,1,0] op_sel_hi:[0,1,1] neg_lo:[0,0,0] neg_hi:[1,0,0]
    v_pk_mul_f32 v[42:43], v[10:11], v[72:73] op_sel:[0,0] op_sel_hi:[1,0]
    v_pk_fma_f32 v[42:43], v[10:11], v[72:73], v[42:43] op_sel:[1,1,0] op_sel_hi:[0,1,1] neg_lo:[0,0,0] neg_hi:[1,0,0]
    v_pk_mul_f32 v[16:17], v[30:31], v[74:75] op_sel:[0,0] op_sel_hi:[1,0]
    v_pk_fma_f32 v[16:17], v[30:31], v[74:75], v[16:17] op_sel:[1,1,0] op_sel_hi:[0,1,1] neg_lo:[0,0,0] neg_hi:[1,0,0]
    v_pk_add_f32 v[38:39], v[18:19], v[20:21]
    v_pk_add_f32 v[22:23], v[18:19], v[20:21] neg_lo:[0,1] neg_hi:[0,1]
    v_pk_add_f32 v[46:47], v[28:29], v[26:27]
    v_pk_add_f32 v[14:15], v[28:29], v[26:27] neg_lo:[0,1] neg_hi:[0,1]
    v_pk_add_f32 v[40:41], v[34:35], v[42:43]
    v_pk_add_f32 v[8:9], v[34:35], v[42:43] neg_lo:[0,1] neg_hi:[0,1]
    v_pk_add_f32 v[12:13], v[36:37], v[16:17]
    v_pk_add_f32 v[44:45], v[36:37], v[16:17] neg_lo:[0,1] neg_hi:[0,1]
    v_pk_add_f32 v[32:33], v[38:39], v[40:41]
    v_pk_add_f32 v[24:25], v[38:39], v[40:41] neg_lo:[0,1] neg_hi:[0,1]
    v_pk_add_f32 v[10:11], v[46:47], v[12:13]
    v_pk_add_f32 v[30:31], v[46:47], v[12:13] neg_lo:[0,1] neg_hi:[0,1]
    v_pk_add_f32 v[18:19], v[32:33], v[10:11]
    v_pk_add_f32 v[20:21], v[32:33], v[10:11] neg_lo:[0,1] neg_hi:[0,1]
    v_pk_add_f32 v[28:29], v[24:25], v[30:31] op_sel:[0,1] op_sel_hi:[1,0] neg_lo:[0,1] neg_hi:[0,0]
    v_pk_add_f32 v[26:27], v[24:25], v[30:31] op_sel:[0,1] op_sel_hi:[1,0] neg_lo:[0,0] neg_hi:[0,1]
    v_pk_add_f32 v[34:35], v[14:15], v[14:15] op_sel:[0,1] op_sel_hi:[1,0] neg_lo:[0,1] neg_hi:[0,0]
    v_pk_add_f32 v[42:43], v[44:45], v[44:45] op_sel:[0,1] op_sel_hi:[1,0] neg_lo:[1,1] neg_hi:[1,0]
    v_pk_add_f32 v[36:37], v[22:23], v[8:9] op_sel:[0,1] op_sel_hi:[1,0] neg_lo:[0,1] neg_hi:[0,0]
    v_pk_add_f32 v[16:17], v[22:23], v[8:9] op_sel:[0,1] op_sel_hi:[1,0] neg_lo:[0,0] neg_hi:[0,1]
    v_pk_add_f32 v[38:39], v[34:35], v[42:43]
    v_pk_add_f32 v[46:47], v[34:35], v[42:43] neg_lo:[0,1] neg_hi:[0,1]
    v_pk_fma_f32 v[40:41], v[38:39], s[26:27], v[36:37] neg_lo:[0,0,0] neg_hi:[0,0,0]
    v_pk_fma_f32 v[12:13], v[38:39], s[26:27], v[36:37] neg_lo:[1,0,0] neg_hi:[1,0,0]
    v_pk_fma_f32 v[32:33], v[46:47], s[26:27], v[16:17] op_sel:[1,0,0] op_sel_hi:[0,1,1] neg_lo:[1,0,0] neg_hi:[0,0,0]
    v_pk_fma_f32 v[24:25], v[46:47], s[26:27], v[16:17] op_sel:[1,0,0] op_sel_hi:[0,1,1] neg_lo:[0,0,0] neg_hi:[1,0,0]
    ds_write_b64 v5, v[18:19] offset:0
    ds_write_b64 v5, v[40:41] offset:256
    ds_write_b64 v5, v[28:29] offset:512
    ds_write_b64 v5, v[32:33] offset:768
    ds_write_b64 v5, v[20:21] offset:1024
    ds_write_b64 v5, v[12:13] offset:1280
    ds_write_b64 v5, v[26:27] offset:1536
    ds_write_b64 v5, v[24:25] offset:1792
    s_waitcnt lgkmcnt(0)
    s_barrier
    ds_read_b64 v[10:11], v3 offset:0
    ds_read_b64 v[30:31], v3 offset:2304
    ds_read_b64 v[22:23], v3 offset:4608
    ds_read_b64 v[14:15], v3 offset:6912
    ds_read_b64 v[8:9], v3 offset:9216
    ds_read_b64 v[44:45], v3 offset:11520
    ds_read_b64 v[34:35], v3 offset:13824
    ds_read_b64 v[42:43], v3 offset:16128
    s_waitcnt lgkmcnt(0)
    v_pk_mul_f32 v[36:37], v[30:31], v[48:49] op_sel:[0,0] op_sel_hi:[1,0]
    v_pk_fma_f32 v[36:37], v[30:31], v[48:49], v[36:37] op_sel:[1,1,0] op_sel_hi:[0,1,1] neg_lo:[0,0,0] neg_hi:[1,0,0]
    v_pk_mul_f32 v[16:17], v[22:23], v[50:51] op_sel:[0,0] op_sel_hi:[1,0]
    v_pk_fma_f32 v[16:17], v[22:23], v[50:51], v[16:17] op_sel:[1,1,0] op_sel_hi:[0,1,1] neg_lo:[0,0,0] neg_hi:[1,0,0]
    v_pk_mul_f32 v[38:39], v[14:15], v[52:53] op_sel:[0,0] op_sel_hi:[1,0]
    v_pk_fma_f32 v[38:39], v[14:15], v[52:53], v[38:39] op_sel:[1,1,0] op_sel_hi:[0,1,1] neg_lo:[0,0,0] neg_hi:[1,0,0]
    v_pk_mul_f32 v[46:47], v[8:9], v[54:55] op_sel:[0,0] op_sel_hi:[1,0]
    v_pk_fma_f32 v[46:47], v[8:9], v[54:55], v[46:47] op_sel:[1,1,0] op_sel_hi:[0,1,1] neg_lo:[0,0,0] neg_hi:[1,0,0]
    v_pk_mul_f32 v[18:19], v[44:45], v[56:57] op_sel:[0,0] op_sel_hi:[1,0]
    v_pk_fma_f32 v[18:19], v[44:45], v[56:57], v[18:19] op_sel:[1,1,0] op_sel_hi:[0,1,1] neg_lo:[0,0,0] neg_hi:[1,0,0]
    v_pk_mul_f32 v[40:41], v[34:35], v[58:59] op_sel:[0,0] op_sel_hi:[1,0]
    v_pk_fma_f32 v[40:41], v[34:35], v[58:59], v[40:41] op_sel:[1,1,0] op_sel_hi:[0,1,1] neg_lo:[0,0,0] neg_hi:[1,0,0]
    v_pk_mul_f32 v[28:29], v[42:43], v[60:61] op_sel:[0,0] op_sel_hi:[1,0]
    v_pk_fma_f32 v[28:29], v[42:43], v[60:61], v[28:29] op_sel:[1,1,0] op_sel_hi:[0,1,1] neg_lo:[0,0,0] neg_hi:[1,0,0]
    v_pk_add_f32 v[32:33], v[10:11], v[46:47]
    v_pk_add_f32 v[20:21], v[10:11], v[46:47] neg_lo:[0,1] neg_hi:[0,1]
    v_pk_add_f32 v[12:13], v[36:37], v[18:19]
    v_pk_add_f32 v[26:27], v[36:37], v[18:19] neg_lo:[0,1] neg_hi:[0,1]
    v_pk_add_f32 v[24:25], v[16:17], v[40:41]
    v_pk_add_f32 v[30:31], v[16:17], v[40:41] neg_lo:[0,1] neg_hi:[0,1]
    v_pk_add_f32 v[22:23], v[38:39], v[28:29]
    v_pk_add_f32 v[14:15], v[38:39], v[28:29] neg_lo:[0,1] neg_hi:[0,1]
    v_pk_add_f32 v[8:9], v[32:33], v[24:25]
    v_pk_add_f32 v[44:45], v[32:33], v[24:25] neg_lo:[0,1] neg_hi:[0,1]
    v_pk_add_f32 v[34:35], v[12:13], v[22:23]
    v_pk_add_f32 v[42:43], v[12:13], v[22:23] neg_lo:[0,1] neg_hi:[0,1]
    v_pk_add_f32 v[10:11], v[8:9], v[34:35]
    v_pk_add_f32 v[46:47], v[8:9], v[34:35] neg_lo:[0,1] neg_hi:[0,1]
    v_pk_add_f32 v[36:37], v[44:45], v[42:43] op_sel:[0,1] op_sel_hi:[1,0] neg_lo:[0,1] neg_hi:[0,0]
    v_pk_add_f32 v[18:19], v[44:45], v[42:43] op_sel:[0,1] op_sel_hi:[1,0] neg_lo:[0,0] neg_hi:[0,1]
    v_pk_add_f32 v[16:17], v[26:27], v[26:27] op_sel:[0,1] op_sel_hi:[1,0] neg_lo:[0,1] neg_hi:[0,0]
    v_pk_add_f32 v[40:41], v[14:15], v[14:15] op_sel:[0,1] op_sel_hi:[1,0] neg_lo:[1,1] neg_hi:[1,0]
    v_pk_add_f32 v[38:39], v[20:21], v[30:31] op_sel:[0,1] op_sel_hi:[1,0] neg_lo:[0,1] neg_hi:[0,0]
    v_pk_add_f32 v[28:29], v[20:21], v[30:31] op_sel:[0,1] op_sel_hi:[1,0] neg_lo:[0,0] neg_hi:[0,1]
    v_pk_add_f32 v[32:33], v[16:17], v[40:41]
    v_pk_add_f32 v[12:13], v[16:17], v[40:41] neg_lo:[0,1] neg_hi:[0,1]
    v_pk_fma_f32 v[24:25], v[32:33], s[26:27], v[38:39] neg_lo:[0,0,0] neg_hi:[0,0,0]
    v_pk_fma_f32 v[22:23], v[32:33], s[26:27], v[38:39] neg_lo:[1,0,0] neg_hi:[1,0,0]
    v_pk_fma_f32 v[8:9], v[12:13], s[26:27], v[28:29] op_sel:[1,0,0] op_sel_hi:[0,1,1] neg_lo:[1,0,0] neg_hi:[0,0,0]
    v_pk_fma_f32 v[44:45], v[12:13], s[26:27], v[28:29] op_sel:[1,0,0] op_sel_hi:[0,1,1] neg_lo:[0,0,0] neg_hi:[1,0,0]
    s_cmp_eq_u32 s2, 320
    s_cselect_b32 s20, 0, s2
    s_cselect_b32 s25, 2, 0
    s_lshr_b32 s21, s20, 4
    s_lshl_b32 s21, s21, 10
    s_bfe_u32 s22, s20, 0x20002
    s_lshl_b32 s22, s22, 8
    s_add_u32 s21, s21, s22
    s_and_b32 s22, s20, 3
    s_lshl_b32 s22, s22, 2
    s_add_u32 s21, s21, s22
    s_add_u32 s21, s21, s25
    s_add_u32 s21, s21, 163577856
    v_cvt_pk_bf16_f32 v10, v10, v11
    v_cvt_pk_bf16_f32 v24, v24, v25
    v_cvt_pk_bf16_f32 v36, v36, v37
    v_cvt_pk_bf16_f32 v8, v8, v9
    v_cvt_pk_bf16_f32 v46, v46, v47
    v_cvt_pk_bf16_f32 v22, v22, v23
    v_cvt_pk_bf16_f32 v18, v18, v19
    v_cvt_pk_bf16_f32 v44, v44, v45
    s_cmp_eq_u32 s20, 0
    s_cbranch_scc1 main_kernel_fft_shorta
    buffer_store_dword v10, v101, s[8:11], s21 offen sc1
    s_add_u32 s21, s21, 327680
    buffer_store_dword v24, v101, s[8:11], s21 offen sc1
    s_add_u32 s21, s21, 327680
    buffer_store_dword v36, v101, s[8:11], s21 offen sc1
    s_add_u32 s21, s21, 327680
    buffer_store_dword v8, v101, s[8:11], s21 offen sc1
    s_add_u32 s21, s21, 327680
    buffer_store_dword v46, v101, s[8:11], s21 offen sc1
    s_add_u32 s21, s21, 327680
    buffer_store_dword v22, v101, s[8:11], s21 offen sc1
    s_add_u32 s21, s21, 327680
    buffer_store_dword v18, v101, s[8:11], s21 offen sc1
    s_add_u32 s21, s21, 327680
    buffer_store_dword v44, v101, s[8:11], s21 offen sc1
    s_add_u32 s21, s21, 327680
    s_branch main_kernel_fft_donea
main_kernel_fft_shorta:
    buffer_store_short v10, v101, s[8:11], s21 offen sc1
    s_add_u32 s21, s21, 327680
    buffer_store_short v24, v101, s[8:11], s21 offen sc1
    s_add_u32 s21, s21, 327680
    buffer_store_short v36, v101, s[8:11], s21 offen sc1
    s_add_u32 s21, s21, 327680
    buffer_store_short v8, v101, s[8:11], s21 offen sc1
    s_add_u32 s21, s21, 327680
    buffer_store_short v46, v101, s[8:11], s21 offen sc1
    s_add_u32 s21, s21, 327680
    buffer_store_short v22, v101, s[8:11], s21 offen sc1
    s_add_u32 s21, s21, 327680
    buffer_store_short v18, v101, s[8:11], s21 offen sc1
    s_add_u32 s21, s21, 327680
    buffer_store_short v44, v101, s[8:11], s21 offen sc1
    s_add_u32 s21, s21, 327680
main_kernel_fft_donea:
    s_cmp_ge_u32 s29, 321
    s_cbranch_scc1 main_kernel_fft_end
    s_waitcnt vmcnt(8)
    s_barrier
    v_pk_add_f32 v[34:35], v[112:113], v[120:121]
    v_pk_add_f32 v[42:43], v[112:113], v[120:121] neg_lo:[0,1] neg_hi:[0,1]
    v_pk_add_f32 v[20:21], v[114:115], v[122:123]
    v_pk_add_f32 v[26:27], v[114:115], v[122:123] neg_lo:[0,1] neg_hi:[0,1]
    v_pk_add_f32 v[30:31], v[116:117], v[124:125]
    v_pk_add_f32 v[14:15], v[116:117], v[124:125] neg_lo:[0,1] neg_hi:[0,1]
    v_pk_add_f32 v[16:17], v[118:119], v[126:127]
    v_pk_add_f32 v[40:41], v[118:119], v[126:127] neg_lo:[0,1] neg_hi:[0,1]
    v_pk_add_f32 v[38:39], v[34:35], v[30:31]
    v_pk_add_f32 v[28:29], v[34:35], v[30:31] neg_lo:[0,1] neg_hi:[0,1]
    v_pk_add_f32 v[32:33], v[20:21], v[16:17]
    v_pk_add_f32 v[12:13], v[20:21], v[16:17] neg_lo:[0,1] neg_hi:[0,1]
    v_pk_add_f32 v[10:11], v[38:39], v[32:33]
    v_pk_add_f32 v[24:25], v[38:39], v[32:33] neg_lo:[0,1] neg_hi:[0,1]
    v_pk_add_f32 v[36:37], v[28:29], v[12:13] op_sel:[0,1] op_sel_hi:[1,0] neg_lo:[0,0] neg_hi:[0,1]
    v_pk_add_f32 v[8:9], v[28:29], v[12:13] op_sel:[0,1] op_sel_hi:[1,0] neg_lo:[0,1] neg_hi:[0,0]
    v_pk_add_f32 v[46:47], v[26:27], v[26:27] op_sel:[0,1] op_sel_hi:[1,0] neg_lo:[0,0] neg_hi:[0,1]
    v_pk_add_f32 v[22:23], v[40:41], v[40:41] op_sel:[0,1] op_sel_hi:[1,0] neg_lo:[1,0] neg_hi:[1,1]
    v_pk_add_f32 v[18:19], v[42:43], v[14:15] op_sel:[0,1] op_sel_hi:[1,0] neg_lo:[0,0] neg_hi:[0,1]
    v_pk_add_f32 v[44:45], v[42:43], v[14:15] op_sel:[0,1] op_sel_hi:[1,0] neg_lo:[0,1] neg_hi:[0,0]
    v_pk_add_f32 v[112:113], v[46:47], v[22:23]
    v_pk_add_f32 v[120:121], v[46:47], v[22:23] neg_lo:[0,1] neg_hi:[0,1]
    v_pk_fma_f32 v[114:115], v[112:113], s[26:27], v[18:19] neg_lo:[0,0,0] neg_hi:[0,0,0]
    v_pk_fma_f32 v[122:123], v[112:113], s[26:27], v[18:19] neg_lo:[1,0,0] neg_hi:[1,0,0]
    v_pk_fma_f32 v[116:117], v[120:121], s[26:27], v[44:45] op_sel:[1,0,0] op_sel_hi:[0,1,1] neg_lo:[0,0,0] neg_hi:[1,0,0]
    v_pk_fma_f32 v[124:125], v[120:121], s[26:27], v[44:45] op_sel:[1,0,0] op_sel_hi:[0,1,1] neg_lo:[1,0,0] neg_hi:[0,0,0]
    v_pk_mul_f32 v[118:119], v[114:115], v[48:49] op_sel:[0,0] op_sel_hi:[1,0]
    v_pk_fma_f32 v[118:119], v[114:115], v[48:49], v[118:119] op_sel:[1,1,0] op_sel_hi:[0,1,1] neg_lo:[1,0,0] neg_hi:[0,0,0]
    v_pk_mul_f32 v[126:127], v[36:37], v[50:51] op_sel:[0,0] op_sel_hi:[1,0]
    v_pk_fma_f32 v[126:127], v[36:37], v[50:51], v[126:127] op_sel:[1,1,0] op_sel_hi:[0,1,1] neg_lo:[1,0,0] neg_hi:[0,0,0]
    v_pk_mul_f32 v[34:35], v[116:117], v[52:53] op_sel:[0,0] op_sel_hi:[1,0]
    v_pk_fma_f32 v[34:35], v[116:117], v[52:53], v[34:35] op_sel:[1,1,0] op_sel_hi:[0,1,1] neg_lo:[1,0,0] neg_hi:[0,0,0]
    v_pk_mul_f32 v[20:21], v[24:25], v[54:55] op_sel:[0,0] op_sel_hi:[1,0]
    v_pk_fma_f32 v[20:21], v[24:25], v[54:55], v[20:21] op_sel:[1,1,0] op_sel_hi:[0,1,1] neg_lo:[1,0,0] neg_hi:[0,0,0]
    v_pk_mul_f32 v[30:31], v[122:123], v[56:57] op_sel:[0,0] op_sel_hi:[1,0]
    v_pk_fma_f32 v[30:31], v[122:123], v[56:57], v[30:31] op_sel:[1,1,0] op_sel_hi:[0,1,1] neg_lo:[1,0,0] neg_hi:[0,0,0]
    v_pk_mul_f32 v[16:17], v[8:9], v[58:59] op_sel:[0,0] op_sel_hi:[1,0]
    v_pk_fma_f32 v[16:17], v[8:9], v[58:59], v[16:17] op_sel:[1,1,0] op_sel_hi:[0,1,1] neg_lo:[1,0,0] neg_hi:[0,0,0]
    v_pk_mul_f32 v[38:39], v[124:125], v[60:61] op_sel:[0,0] op_sel_hi:[1,0]
    v_pk_fma_f32 v[38:39], v[124:125], v[60:61], v[38:39] op_sel:[1,1,0] op_sel_hi:[0,1,1] neg_lo:[1,0,0] neg_hi:[0,0,0]
    ds_write_b64 v3, v[10:11] offset:0
    ds_write_b64 v3, v[118:119] offset:2304
    ds_write_b64 v3, v[126:127] offset:4608
    ds_write_b64 v3, v[34:35] offset:6912
    ds_write_b64 v3, v[20:21] offset:9216
    ds_write_b64 v3, v[30:31] offset:11520
    ds_write_b64 v3, v[16:17] offset:13824
    ds_write_b64 v3, v[38:39] offset:16128
    s_waitcnt lgkmcnt(0)
    s_barrier
    ds_read_b64 v[28:29], v5 offset:0
    ds_read_b64 v[32:33], v5 offset:256
    ds_read_b64 v[12:13], v5 offset:512
    ds_read_b64 v[42:43], v5 offset:768
    ds_read_b64 v[26:27], v5 offset:1024
    ds_read_b64 v[14:15], v5 offset:1280
    ds_read_b64 v[40:41], v5 offset:1536
    ds_read_b64 v[46:47], v5 offset:1792
    s_waitcnt lgkmcnt(0)
    v_pk_add_f32 v[22:23], v[28:29], v[26:27]
    v_pk_add_f32 v[18:19], v[28:29], v[26:27] neg_lo:[0,1] neg_hi:[0,1]
    v_pk_add_f32 v[44:45], v[32:33], v[14:15]
    v_pk_add_f32 v[112:113], v[32:33], v[14:15] neg_lo:[0,1] neg_hi:[0,1]
    v_pk_add_f32 v[120:121], v[12:13], v[40:41]
    v_pk_add_f32 v[114:115], v[12:13], v[40:41] neg_lo:[0,1] neg_hi:[0,1]
    v_pk_add_f32 v[36:37], v[42:43], v[46:47]
    v_pk_add_f32 v[116:117], v[42:43], v[46:47] neg_lo:[0,1] neg_hi:[0,1]
    v_pk_add_f32 v[24:25], v[22:23], v[120:121]
    v_pk_add_f32 v[122:123], v[22:23], v[120:121] neg_lo:[0,1] neg_hi:[0,1]
    v_pk_add_f32 v[8:9], v[44:45], v[36:37]
    v_pk_add_f32 v[124:125], v[44:45], v[36:37] neg_lo:[0,1] neg_hi:[0,1]
    v_pk_add_f32 v[10:11], v[24:25], v[8:9]
    v_pk_add_f32 v[118:119], v[24:25], v[8:9] neg_lo:[0,1] neg_hi:[0,1]
    v_pk_add_f32 v[126:127], v[122:123], v[124:125] op_sel:[0,1] op_sel_hi:[1,0] neg_lo:[0,0] neg_hi:[0,1]
    v_pk_add_f32 v[34:35], v[122:123], v[124:125] op_sel:[0,1] op_sel_hi:[1,0] neg_lo:[0,1] neg_hi:[0,0]
    v_pk_add_f32 v[20:21], v[112:113], v[112:113] op_sel:[0,1] op_sel_hi:[1,0] neg_lo:[0,0] neg_hi:[0,1]
    v_pk_add_f32 v[30:31], v[116:117], v[116:117] op_sel:[0,1] op_sel_hi:[1,0] neg_lo:[1,0] neg_hi:[1,1]
    v_pk_add_f32 v[16:17], v[18:19], v[114:115] op_sel:[0,1] op_sel_hi:[1,0] neg_lo:[0,0] neg_hi:[0,1]
    v_pk_add_f32 v[38:39], v[18:19], v[114:115] op_sel:[0,1] op_sel_hi:[1,0] neg_lo:[0,1] neg_hi:[0,0]
    v_pk_add_f32 v[28:29], v[20:21], v[30:31]
    v_pk_add_f32 v[26:27], v[20:21], v[30:31] neg_lo:[0,1] neg_hi:[0,1]
    v_pk_fma_f32 v[32:33], v[28:29], s[26:27], v[16:17] neg_lo:[0,0,0] neg_hi:[0,0,0]
    v_pk_fma_f32 v[14:15], v[28:29], s[26:27], v[16:17] neg_lo:[1,0,0] neg_hi:[1,0,0]
    v_pk_fma_f32 v[12:13], v[26:27], s[26:27], v[38:39] op_sel:[1,0,0] op_sel_hi:[0,1,1] neg_lo:[0,0,0] neg_hi:[1,0,0]
    v_pk_fma_f32 v[40:41], v[26:27], s[26:27], v[38:39] op_sel:[1,0,0] op_sel_hi:[0,1,1] neg_lo:[1,0,0] neg_hi:[0,0,0]
    v_pk_mul_f32 v[42:43], v[32:33], v[62:63] op_sel:[0,0] op_sel_hi:[1,0]
    v_pk_fma_f32 v[42:43], v[32:33], v[62:63], v[42:43] op_sel:[1,1,0] op_sel_hi:[0,1,1] neg_lo:[1,0,0] neg_hi:[0,0,0]
    v_pk_mul_f32 v[46:47], v[126:127], v[64:65] op_sel:[0,0] op_sel_hi:[1,0]
    v_pk_fma_f32 v[46:47], v[126:127], v[64:65], v[46:47] op_sel:[1,1,0] op_sel_hi:[0,1,1] neg_lo:[1,0,0] neg_hi:[0,0,0]
    v_pk_mul_f32 v[22:23], v[12:13], v[66:67] op_sel:[0,0] op_sel_hi:[1,0]
    v_pk_fma_f32 v[22:23], v[12:13], v[66:67], v[22:23] op_sel:[1,1,0] op_sel_hi:[0,1,1] neg_lo:[1,0,0] neg_hi:[0,0,0]
    v_pk_mul_f32 v[44:45], v[118:119], v[68:69] op_sel:[0,0] op_sel_hi:[1,0]
    v_pk_fma_f32 v[44:45], v[118:119], v[68:69], v[44:45] op_sel:[1,1,0] op_sel_hi:[0,1,1] neg_lo:[1,0,0] neg_hi:[0,0,0]
    v_pk_mul_f32 v[120:121], v[14:15], v[70:71] op_sel:[0,0] op_sel_hi:[1,0]
    v_pk_fma_f32 v[120:121], v[14:15], v[70:71], v[120:121] op_sel:[1,1,0] op_sel_hi:[0,1,1] neg_lo:[1,0,0] neg_hi:[0,0,0]
    v_pk_mul_f32 v[36:37], v[34:35], v[72:73] op_sel:[0,0] op_sel_hi:[1,0]
    v_pk_fma_f32 v[36:37], v[34:35], v[72:73], v[36:37] op_sel:[1,1,0] op_sel_hi:[0,1,1] neg_lo:[1,0,0] neg_hi:[0,0,0]
    v_pk_mul_f32 v[24:25], v[40:41], v[74:75] op_sel:[0,0] op_sel_hi:[1,0]
    v_pk_fma_f32 v[24:25], v[40:41], v[74:75], v[24:25] op_sel:[1,1,0] op_sel_hi:[0,1,1] neg_lo:[1,0,0] neg_hi:[0,0,0]
    ds_write_b64 v5, v[10:11] offset:0
    ds_write_b64 v5, v[42:43] offset:288
    ds_write_b64 v5, v[46:47] offset:576
    ds_write_b64 v5, v[22:23] offset:864
    ds_write_b64 v5, v[44:45] offset:1152
    ds_write_b64 v5, v[120:121] offset:1440
    ds_write_b64 v5, v[36:37] offset:1728
    ds_write_b64 v5, v[24:25] offset:2016
    ds_read_b64 v[122:123], v6 offset:0
    ds_read_b64 v[8:9], v6 offset:32
    ds_read_b64 v[124:125], v6 offset:64
    ds_read_b64 v[18:19], v6 offset:96
    ds_read_b64 v[112:113], v6 offset:128
    ds_read_b64 v[114:115], v6 offset:160
    ds_read_b64 v[116:117], v6 offset:192
    ds_read_b64 v[20:21], v6 offset:224
    s_waitcnt lgkmcnt(0)
    v_pk_add_f32 v[30:31], v[122:123], v[112:113]
    v_pk_add_f32 v[16:17], v[122:123], v[112:113] neg_lo:[0,1] neg_hi:[0,1]
    v_pk_add_f32 v[38:39], v[8:9], v[114:115]
    v_pk_add_f32 v[28:29], v[8:9], v[114:115] neg_lo:[0,1] neg_hi:[0,1]
    v_pk_add_f32 v[26:27], v[124:125], v[116:117]
    v_pk_add_f32 v[32:33], v[124:125], v[116:117] neg_lo:[0,1] neg_hi:[0,1]
    v_pk_add_f32 v[126:127], v[18:19], v[20:21]
    v_pk_add_f32 v[12:13], v[18:19], v[20:21] neg_lo:[0,1] neg_hi:[0,1]
    v_pk_add_f32 v[118:119], v[30:31], v[26:27]
    v_pk_add_f32 v[14:15], v[30:31], v[26:27] neg_lo:[0,1] neg_hi:[0,1]
    v_pk_add_f32 v[34:35], v[38:39], v[126:127]
    v_pk_add_f32 v[40:41], v[38:39], v[126:127] neg_lo:[0,1] neg_hi:[0,1]
    v_pk_add_f32 v[10:11], v[118:119], v[34:35]
    v_pk_add_f32 v[42:43], v[118:119], v[34:35] neg_lo:[0,1] neg_hi:[0,1]
    v_pk_add_f32 v[46:47], v[14:15], v[40:41] op_sel:[0,1] op_sel_hi:[1,0] neg_lo:[0,0] neg_hi:[0,1]
    v_pk_add_f32 v[22:23], v[14:15], v[40:41] op_sel:[0,1] op_sel_hi:[1,0] neg_lo:[0,1] neg_hi:[0,0]
    v_pk_add_f32 v[44:45], v[28:29], v[28:29] op_sel:[0,1] op_sel_hi:[1,0] neg_lo:[0,0] neg_hi:[0,1]
    v_pk_add_f32 v[120:121], v[12:13], v[12:13] op_sel:[0,1] op_sel_hi:[1,0] neg_lo:[1,0] neg_hi:[1,1]
    v_pk_add_f32 v[36:37], v[16:17], v[32:33] op_sel:[0,1] op_sel_hi:[1,0] neg_lo:[0,0] neg_hi:[0,1]
    v_pk_add_f32 v[24:25], v[16:17], v[32:33] op_sel:[0,1] op_sel_hi:[1,0] neg_lo:[0,1] neg_hi:[0,0]
    v_pk_add_f32 v[122:123], v[44:45], v[120:121]
    v_pk_add_f32 v[112:113], v[44:45], v[120:121] neg_lo:[0,1] neg_hi:[0,1]
    v_pk_fma_f32 v[8:9], v[122:123], s[26:27], v[36:37] neg_lo:[0,0,0] neg_hi:[0,0,0]
    v_pk_fma_f32 v[114:115], v[122:123], s[26:27], v[36:37] neg_lo:[1,0,0] neg_hi:[1,0,0]
    v_pk_fma_f32 v[124:125], v[112:113], s[26:27], v[24:25] op_sel:[1,0,0] op_sel_hi:[0,1,1] neg_lo:[0,0,0] neg_hi:[1,0,0]
    v_pk_fma_f32 v[116:117], v[112:113], s[26:27], v[24:25] op_sel:[1,0,0] op_sel_hi:[0,1,1] neg_lo:[1,0,0] neg_hi:[0,0,0]
    v_pk_mul_f32 v[18:19], v[8:9], v[76:77] op_sel:[0,0] op_sel_hi:[1,0]
    v_pk_fma_f32 v[18:19], v[8:9], v[76:77], v[18:19] op_sel:[1,1,0] op_sel_hi:[0,1,1] neg_lo:[1,0,0] neg_hi:[0,0,0]
    v_pk_mul_f32 v[20:21], v[46:47], v[78:79] op_sel:[0,0] op_sel_hi:[1,0]
    v_pk_fma_f32 v[20:21], v[46:47], v[78:79], v[20:21] op_sel:[1,1,0] op_sel_hi:[0,1,1] neg_lo:[1,0,0] neg_hi:[0,0,0]
    v_pk_mul_f32 v[30:31], v[124:125], v[80:81] op_sel:[0,0] op_sel_hi:[1,0]
    v_pk_fma_f32 v[30:31], v[124:125], v[80:81], v[30:31] op_sel:[1,1,0] op_sel_hi:[0,1,1] neg_lo:[1,0,0] neg_hi:[0,0,0]
    v_pk_mul_f32 v[38:39], v[42:43], v[82:83] op_sel:[0,0] op_sel_hi:[1,0]
    v_pk_fma_f32 v[38:39], v[42:43], v[82:83], v[38:39] op_sel:[1,1,0] op_sel_hi:[0,1,1] neg_lo:[1,0,0] neg_hi:[0,0,0]
    v_pk_mul_f32 v[26:27], v[114:115], v[84:85] op_sel:[0,0] op_sel_hi:[1,0]
    v_pk_fma_f32 v[26:27], v[114:115], v[84:85], v[26:27] op_sel:[1,1,0] op_sel_hi:[0,1,1] neg_lo:[1,0,0] neg_hi:[0,0,0]
    v_pk_mul_f32 v[126:127], v[22:23], v[86:87] op_sel:[0,0] op_sel_hi:[1,0]
    v_pk_fma_f32 v[126:127], v[22:23], v[86:87], v[126:127] op_sel:[1,1,0] op_sel_hi:[0,1,1] neg_lo:[1,0,0] neg_hi:[0,0,0]
    v_pk_mul_f32 v[118:119], v[116:117], v[88:89] op_sel:[0,0] op_sel_hi:[1,0]
    v_pk_fma_f32 v[118:119], v[116:117], v[88:89], v[118:119] op_sel:[1,1,0] op_sel_hi:[0,1,1] neg_lo:[1,0,0] neg_hi:[0,0,0]
    ds_write_b64 v6, v[10:11] offset:0
    ds_write_b64 v6, v[18:19] offset:32
    ds_write_b64 v6, v[20:21] offset:64
    ds_write_b64 v6, v[30:31] offset:96
    ds_write_b64 v6, v[38:39] offset:128
    ds_write_b64 v6, v[26:27] offset:160
    ds_write_b64 v6, v[126:127] offset:192
    ds_write_b64 v6, v[118:119] offset:224
    ds_read_b64 v[14:15], v100 offset:0
    ds_read_b64 v[34:35], v100 offset:8
    ds_read_b64 v[40:41], v100 offset:16
    ds_read_b64 v[16:17], v100 offset:24
    ds_read_b64 v[28:29], v100 offset:32
    ds_read_b64 v[32:33], v100 offset:40
    ds_read_b64 v[12:13], v100 offset:48
    ds_read_b64 v[44:45], v100 offset:56
    s_waitcnt lgkmcnt(0)
    v_pk_add_f32 v[120:121], v[14:15], v[40:41]
    v_pk_add_f32 v[36:37], v[14:15], v[40:41] neg_lo:[0,1] neg_hi:[0,1]
    v_pk_add_f32 v[24:25], v[34:35], v[16:17]
    v_pk_add_f32 v[122:123], v[34:35], v[16:17] neg_lo:[0,1] neg_hi:[0,1]
    v_pk_add_f32 v[112:113], v[120:121], v[24:25]
    v_pk_add_f32 v[8:9], v[120:121], v[24:25] neg_lo:[0,1] neg_hi:[0,1]
    v_pk_add_f32 v[46:47], v[36:37], v[122:123] op_sel:[0,1] op_sel_hi:[1,0] neg_lo:[0,0] neg_hi:[0,1]
    v_pk_add_f32 v[124:125], v[36:37], v[122:123] op_sel:[0,1] op_sel_hi:[1,0] neg_lo:[0,1] neg_hi:[0,0]
    v_pk_add_f32 v[42:43], v[28:29], v[12:13]
    v_pk_add_f32 v[114:115], v[28:29], v[12:13] neg_lo:[0,1] neg_hi:[0,1]
    v_pk_add_f32 v[22:23], v[32:33], v[44:45]
    v_pk_add_f32 v[116:117], v[32:33], v[44:45] neg_lo:[0,1] neg_hi:[0,1]
    v_pk_add_f32 v[10:11], v[42:43], v[22:23]
    v_pk_add_f32 v[18:19], v[42:43], v[22:23] neg_lo:[0,1] neg_hi:[0,1]
    v_pk_add_f32 v[20:21], v[114:115], v[116:117] op_sel:[0,1] op_sel_hi:[1,0] neg_lo:[0,0] neg_hi:[0,1]
    v_pk_add_f32 v[30:31], v[114:115], v[116:117] op_sel:[0,1] op_sel_hi:[1,0] neg_lo:[0,1] neg_hi:[0,0]
    v_lshlrev_b32 v38, 16, v104
    v_and_b32 v39, 0xffff0000, v104
    v_pk_mul_f32 v[26:27], v[112:113], v[38:39] op_sel:[0,0] op_sel_hi:[1,0]
    v_pk_fma_f32 v[26:27], v[112:113], v[38:39], v[26:27] op_sel:[1,1,0] op_sel_hi:[0,1,1] neg_lo:[1,0,0] neg_hi:[0,0,0]
    v_lshlrev_b32 v126, 16, v105
    v_and_b32 v127, 0xffff0000, v105
    v_pk_mul_f32 v[118:119], v[46:47], v[126:127] op_sel:[0,0] op_sel_hi:[1,0]
    v_pk_fma_f32 v[118:119], v[46:47], v[126:127], v[118:119] op_sel:[1,1,0] op_sel_hi:[0,1,1] neg_lo:[1,0,0] neg_hi:[0,0,0]
    v_lshlrev_b32 v14, 16, v106
    v_and_b32 v15, 0xffff0000, v106
    v_pk_mul_f32 v[34:35], v[8:9], v[14:15] op_sel:[0,0] op_sel_hi:[1,0]
    v_pk_fma_f32 v[34:35], v[8:9], v[14:15], v[34:35] op_sel:[1,1,0] op_sel_hi:[0,1,1] neg_lo:[1,0,0] neg_hi:[0,0,0]
    v_lshlrev_b32 v40, 16, v107
    v_and_b32 v41, 0xffff0000, v107
    v_pk_mul_f32 v[16:17], v[124:125], v[40:41] op_sel:[0,0] op_sel_hi:[1,0]
    v_pk_fma_f32 v[16:17], v[124:125], v[40:41], v[16:17] op_sel:[1,1,0] op_sel_hi:[0,1,1] neg_lo:[1,0,0] neg_hi:[0,0,0]
    v_lshlrev_b32 v120, 16, v108
    v_and_b32 v121, 0xffff0000, v108
    v_pk_mul_f32 v[36:37], v[10:11], v[120:121] op_sel:[0,0] op_sel_hi:[1,0]
    v_pk_fma_f32 v[36:37], v[10:11], v[120:121], v[36:37] op_sel:[1,1,0] op_sel_hi:[0,1,1] neg_lo:[1,0,0] neg_hi:[0,0,0]
    v_lshlrev_b32 v24, 16, v109
    v_and_b32 v25, 0xffff0000, v109
    v_pk_mul_f32 v[122:123], v[20:21], v[24:25] op_sel:[0,0] op_sel_hi:[1,0]
    v_pk_fma_f32 v[122:123], v[20:21], v[24:25], v[122:123] op_sel:[1,1,0] op_sel_hi:[0,1,1] neg_lo:[1,0,0] neg_hi:[0,0,0]
    v_lshlrev_b32 v28, 16, v110
    v_and_b32 v29, 0xffff0000, v110
    v_pk_mul_f32 v[32:33], v[18:19], v[28:29] op_sel:[0,0] op_sel_hi:[1,0]
    v_pk_fma_f32 v[32:33], v[18:19], v[28:29], v[32:33] op_sel:[1,1,0] op_sel_hi:[0,1,1] neg_lo:[1,0,0] neg_hi:[0,0,0]
    v_lshlrev_b32 v12, 16, v111
    v_and_b32 v13, 0xffff0000, v111
    v_pk_mul_f32 v[44:45], v[30:31], v[12:13] op_sel:[0,0] op_sel_hi:[1,0]
    v_pk_fma_f32 v[44:45], v[30:31], v[12:13], v[44:45] op_sel:[1,1,0] op_sel_hi:[0,1,1] neg_lo:[1,0,0] neg_hi:[0,0,0]
    v_pk_add_f32 v[42:43], v[26:27], v[34:35]
    v_pk_add_f32 v[114:115], v[26:27], v[34:35] neg_lo:[0,1] neg_hi:[0,1]
    v_pk_add_f32 v[22:23], v[118:119], v[16:17]
    v_pk_add_f32 v[116:117], v[118:119], v[16:17] neg_lo:[0,1] neg_hi:[0,1]
    v_pk_add_f32 v[112:113], v[42:43], v[22:23]
    v_pk_add_f32 v[38:39], v[42:43], v[22:23] neg_lo:[0,1] neg_hi:[0,1]
    v_pk_add_f32 v[46:47], v[114:115], v[116:117] op_sel:[0,1] op_sel_hi:[1,0] neg_lo:[0,1] neg_hi:[0,0]
    v_pk_add_f32 v[126:127], v[114:115], v[116:117] op_sel:[0,1] op_sel_hi:[1,0] neg_lo:[0,0] neg_hi:[0,1]
    v_pk_add_f32 v[8:9], v[36:37], v[32:33]
    v_pk_add_f32 v[14:15], v[36:37], v[32:33] neg_lo:[0,1] neg_hi:[0,1]
    v_pk_add_f32 v[124:125], v[122:123], v[44:45]
    v_pk_add_f32 v[40:41], v[122:123], v[44:45] neg_lo:[0,1] neg_hi:[0,1]
    v_pk_add_f32 v[10:11], v[8:9], v[124:125]
    v_pk_add_f32 v[120:121], v[8:9], v[124:125] neg_lo:[0,1] neg_hi:[0,1]
    v_pk_add_f32 v[20:21], v[14:15], v[40:41] op_sel:[0,1] op_sel_hi:[1,0] neg_lo:[0,1] neg_hi:[0,0]
    v_pk_add_f32 v[24:25], v[14:15], v[40:41] op_sel:[0,1] op_sel_hi:[1,0] neg_lo:[0,0] neg_hi:[0,1]
    ds_write_b64 v100, v[112:113] offset:0
    ds_write_b64 v100, v[46:47] offset:8
    ds_write_b64 v100, v[38:39] offset:16
    ds_write_b64 v100, v[126:127] offset:24
    ds_write_b64 v100, v[10:11] offset:32
    ds_write_b64 v100, v[20:21] offset:40
    ds_write_b64 v100, v[120:121] offset:48
    ds_write_b64 v100, v[24:25] offset:56
    ds_read_b64 v[18:19], v6 offset:0
    ds_read_b64 v[28:29], v6 offset:32
    ds_read_b64 v[30:31], v6 offset:64
    ds_read_b64 v[12:13], v6 offset:96
    ds_read_b64 v[26:27], v6 offset:128
    ds_read_b64 v[118:119], v6 offset:160
    ds_read_b64 v[34:35], v6 offset:192
    ds_read_b64 v[16:17], v6 offset:224
    s_waitcnt lgkmcnt(0)
    v_pk_mul_f32 v[42:43], v[28:29], v[76:77] op_sel:[0,0] op_sel_hi:[1,0]
    v_pk_fma_f32 v[42:43], v[28:29], v[76:77], v[42:43] op_sel:[1,1,0] op_sel_hi:[0,1,1] neg_lo:[0,0,0] neg_hi:[1,0,0]
    v_pk_mul_f32 v[114:115], v[30:31], v[78:79] op_sel:[0,0] op_sel_hi:[1,0]
    v_pk_fma_f32 v[114:115], v[30:31], v[78:79], v[114:115] op_sel:[1,1,0] op_sel_hi:[0,1,1] neg_lo:[0,0,0] neg_hi:[1,0,0]
    v_pk_mul_f32 v[22:23], v[12:13], v[80:81] op_sel:[0,0] op_sel_hi:[1,0]
    v_pk_fma_f32 v[22:23], v[12:13], v[80:81], v[22:23] op_sel:[1,1,0] op_sel_hi:[0,1,1] neg_lo:[0,0,0] neg_hi:[1,0,0]
    v_pk_mul_f32 v[116:117], v[26:27], v[82:83] op_sel:[0,0] op_sel_hi:[1,0]
    v_pk_fma_f32 v[116:117], v[26:27], v[82:83], v[116:117] op_sel:[1,1,0] op_sel_hi:[0,1,1] neg_lo:[0,0,0] neg_hi:[1,0,0]
    v_pk_mul_f32 v[36:37], v[118:119], v[84:85] op_sel:[0,0] op_sel_hi:[1,0]
    v_pk_fma_f32 v[36:37], v[118:119], v[84:85], v[36:37] op_sel:[1,1,0] op_sel_hi:[0,1,1] neg_lo:[0,0,0] neg_hi:[1,0,0]
    v_pk_mul_f32 v[122:123], v[34:35], v[86:87] op_sel:[0,0] op_sel_hi:[1,0]
    v_pk_fma_f32 v[122:123], v[34:35], v[86:87], v[122:123] op_sel:[1,1,0] op_sel_hi:[0,1,1] neg_lo:[0,0,0] neg_hi:[1,0,0]
    v_pk_mul_f32 v[32:33], v[16:17], v[88:89] op_sel:[0,0] op_sel_hi:[1,0]
    v_pk_fma_f32 v[32:33], v[16:17], v[88:89], v[32:33] op_sel:[1,1,0] op_sel_hi:[0,1,1] neg_lo:[0,0,0] neg_hi:[1,0,0]
    v_pk_add_f32 v[44:45], v[18:19], v[116:117]
    v_pk_add_f32 v[8:9], v[18:19], v[116:117] neg_lo:[0,1] neg_hi:[0,1]
    v_pk_add_f32 v[14:15], v[42:43], v[36:37]
    v_pk_add_f32 v[124:125], v[42:43], v[36:37] neg_lo:[0,1] neg_hi:[0,1]
    v_pk_add_f32 v[40:41], v[114:115], v[122:123]
    v_pk_add_f32 v[112:113], v[114:115], v[122:123] neg_lo:[0,1] neg_hi:[0,1]
    v_pk_add_f32 v[46:47], v[22:23], v[32:33]
    v_pk_add_f32 v[38:39], v[22:23], v[32:33] neg_lo:[0,1] neg_hi:[0,1]
    v_pk_add_f32 v[126:127], v[44:45], v[40:41]
    v_pk_add_f32 v[10:11], v[44:45], v[40:41] neg_lo:[0,1] neg_hi:[0,1]
    v_pk_add_f32 v[20:21], v[14:15], v[46:47]
    v_pk_add_f32 v[120:121], v[14:15], v[46:47] neg_lo:[0,1] neg_hi:[0,1]
    v_pk_add_f32 v[24:25], v[126:127], v[20:21]
    v_pk_add_f32 v[28:29], v[126:127], v[20:21] neg_lo:[0,1] neg_hi:[0,1]
    v_pk_add_f32 v[30:31], v[10:11], v[120:121] op_sel:[0,1] op_sel_hi:[1,0] neg_lo:[0,1] neg_hi:[0,0]
    v_pk_add_f32 v[12:13], v[10:11], v[120:121] op_sel:[0,1] op_sel_hi:[1,0] neg_lo:[0,0] neg_hi:[0,1]
    v_pk_add_f32 v[26:27], v[124:125], v[124:125] op_sel:[0,1] op_sel_hi:[1,0] neg_lo:[0,1] neg_hi:[0,0]
    v_pk_add_f32 v[118:119], v[38:39], v[38:39] op_sel:[0,1] op_sel_hi:[1,0] neg_lo:[1,1] neg_hi:[1,0]
    v_pk_add_f32 v[34:35], v[8:9], v[112:113] op_sel:[0,1] op_sel_hi:[1,0] neg_lo:[0,1] neg_hi:[0,0]
    v_pk_add_f32 v[16:17], v[8:9], v[112:113] op_sel:[0,1] op_sel_hi:[1,0] neg_lo:[0,0] neg_hi:[0,1]
    v_pk_add_f32 v[18:19], v[26:27], v[118:119]
    v_pk_add_f32 v[116:117], v[26:27], v[118:119] neg_lo:[0,1] neg_hi:[0,1]
    v_pk_fma_f32 v[42:43], v[18:19], s[26:27], v[34:35] neg_lo:[0,0,0] neg_hi:[0,0,0]
    v_pk_fma_f32 v[36:37], v[18:19], s[26:27], v[34:35] neg_lo:[1,0,0] neg_hi:[1,0,0]
    v_pk_fma_f32 v[114:115], v[116:117], s[26:27], v[16:17] op_sel:[1,0,0] op_sel_hi:[0,1,1] neg_lo:[1,0,0] neg_hi:[0,0,0]
    v_pk_fma_f32 v[122:123], v[116:117], s[26:27], v[16:17] op_sel:[1,0,0] op_sel_hi:[0,1,1] neg_lo:[0,0,0] neg_hi:[1,0,0]
    ds_write_b64 v6, v[24:25] offset:0
    ds_write_b64 v6, v[42:43] offset:32
    ds_write_b64 v6, v[30:31] offset:64
    ds_write_b64 v6, v[114:115] offset:96
    ds_write_b64 v6, v[28:29] offset:128
    ds_write_b64 v6, v[36:37] offset:160
    ds_write_b64 v6, v[12:13] offset:192
    ds_write_b64 v6, v[122:123] offset:224
    ds_read_b64 v[22:23], v5 offset:0
    ds_read_b64 v[32:33], v5 offset:288
    ds_read_b64 v[44:45], v5 offset:576
    ds_read_b64 v[14:15], v5 offset:864
    ds_read_b64 v[40:41], v5 offset:1152
    ds_read_b64 v[46:47], v5 offset:1440
    ds_read_b64 v[126:127], v5 offset:1728
    ds_read_b64 v[10:11], v5 offset:2016
    s_waitcnt lgkmcnt(0)
    v_pk_mul_f32 v[20:21], v[32:33], v[62:63] op_sel:[0,0] op_sel_hi:[1,0]
    v_pk_fma_f32 v[20:21], v[32:33], v[62:63], v[20:21] op_sel:[1,1,0] op_sel_hi:[0,1,1] neg_lo:[0,0,0] neg_hi:[1,0,0]
    v_pk_mul_f32 v[120:121], v[44:45], v[64:65] op_sel:[0,0] op_sel_hi:[1,0]
    v_pk_fma_f32 v[120:121], v[44:45], v[64:65], v[120:121] op_sel:[1,1,0] op_sel_hi:[0,1,1] neg_lo:[0,0,0] neg_hi:[1,0,0]
    v_pk_mul_f32 v[8:9], v[14:15], v[66:67] op_sel:[0,0] op_sel_hi:[1,0]
    v_pk_fma_f32 v[8:9], v[14:15], v[66:67], v[8:9] op_sel:[1,1,0] op_sel_hi:[0,1,1] neg_lo:[0,0,0] neg_hi:[1,0,0]
    v_pk_mul_f32 v[124:125], v[40:41], v[68:69] op_sel:[0,0] op_sel_hi:[1,0]
    v_pk_fma_f32 v[124:125], v[40:41], v[68:69], v[124:125] op_sel:[1,1,0] op_sel_hi:[0,1,1] neg_lo:[0,0,0] neg_hi:[1,0,0]
    v_pk_mul_f32 v[112:113], v[46:47], v[70:71] op_sel:[0,0] op_sel_hi:[1,0]
    v_pk_fma_f32 v[112:113], v[46:47], v[70:71], v[112:113] op_sel:[1,1,0] op_sel_hi:[0,1,1] neg_lo:[0,0,0] neg_hi:[1,0,0]
    v_pk_mul_f32 v[38:39], v[126:127], v[72:73] op_sel:[0,0] op_sel_hi:[1,0]
    v_pk_fma_f32 v[38:39], v[126:127], v[72:73], v[38:39] op_sel:[1,1,0] op_sel_hi:[0,1,1] neg_lo:[0,0,0] neg_hi:[1,0,0]
    v_pk_mul_f32 v[26:27], v[10:11], v[74:75] op_sel:[0,0] op_sel_hi:[1,0]
    v_pk_fma_f32 v[26:27], v[10:11], v[74:75], v[26:27] op_sel:[1,1,0] op_sel_hi:[0,1,1] neg_lo:[0,0,0] neg_hi:[1,0,0]
    v_pk_add_f32 v[118:119], v[22:23], v[124:125]
    v_pk_add_f32 v[34:35], v[22:23], v[124:125] neg_lo:[0,1] neg_hi:[0,1]
    v_pk_add_f32 v[16:17], v[20:21], v[112:113]
    v_pk_add_f32 v[18:19], v[20:21], v[112:113] neg_lo:[0,1] neg_hi:[0,1]
    v_pk_add_f32 v[116:117], v[120:121], v[38:39]
    v_pk_add_f32 v[24:25], v[120:121], v[38:39] neg_lo:[0,1] neg_hi:[0,1]
    v_pk_add_f32 v[42:43], v[8:9], v[26:27]
    v_pk_add_f32 v[30:31], v[8:9], v[26:27] neg_lo:[0,1] neg_hi:[0,1]
    v_pk_add_f32 v[114:115], v[118:119], v[116:117]
    v_pk_add_f32 v[28:29], v[118:119], v[116:117] neg_lo:[0,1] neg_hi:[0,1]
    v_pk_add_f32 v[36:37], v[16:17], v[42:43]
    v_pk_add_f32 v[12:13], v[16:17], v[42:43] neg_lo:[0,1] neg_hi:[0,1]
    v_pk_add_f32 v[122:123], v[114:115], v[36:37]
    v_pk_add_f32 v[32:33], v[114:115], v[36:37] neg_lo:[0,1] neg_hi:[0,1]
    v_pk_add_f32 v[44:45], v[28:29], v[12:13] op_sel:[0,1] op_sel_hi:[1,0] neg_lo:[0,1] neg_hi:[0,0]
    v_pk_add_f32 v[14:15], v[28:29], v[12:13] op_sel:[0,1] op_sel_hi:[1,0] neg_lo:[0,0] neg_hi:[0,1]
    v_pk_add_f32 v[40:41], v[18:19], v[18:19] op_sel:[0,1] op_sel_hi:[1,0] neg_lo:[0,1] neg_hi:[0,0]
    v_pk_add_f32 v[46:47], v[30:31], v[30:31] op_sel:[0,1] op_sel_hi:[1,0] neg_lo:[1,1] neg_hi:[1,0]
    v_pk_add_f32 v[126:127], v[34:35], v[24:25] op_sel:[0,1] op_sel_hi:[1,0] neg_lo:[0,1] neg_hi:[0,0]
    v_pk_add_f32 v[10:11], v[34:35], v[24:25] op_sel:[0,1] op_sel_hi:[1,0] neg_lo:[0,0] neg_hi:[0,1]
    v_pk_add_f32 v[22:23], v[40:41], v[46:47]
    v_pk_add_f32 v[124:125], v[40:41], v[46:47] neg_lo:[0,1] neg_hi:[0,1]
    v_pk_fma_f32 v[20:21], v[22:23], s[26:27], v[126:127] neg_lo:[0,0,0] neg_hi:[0,0,0]
    v_pk_fma_f32 v[112:113], v[22:23], s[26:27], v[126:127] neg_lo:[1,0,0] neg_hi:[1,0,0]
    v_pk_fma_f32 v[120:121], v[124:125], s[26:27], v[10:11] op_sel:[1,0,0] op_sel_hi:[0,1,1] neg_lo:[1,0,0] neg_hi:[0,0,0]
    v_pk_fma_f32 v[38:39], v[124:125], s[26:27], v[10:11] op_sel:[1,0,0] op_sel_hi:[0,1,1] neg_lo:[0,0,0] neg_hi:[1,0,0]
    ds_write_b64 v5, v[122:123] offset:0
    ds_write_b64 v5, v[20:21] offset:256
    ds_write_b64 v5, v[44:45] offset:512
    ds_write_b64 v5, v[120:121] offset:768
    ds_write_b64 v5, v[32:33] offset:1024
    ds_write_b64 v5, v[112:113] offset:1280
    ds_write_b64 v5, v[14:15] offset:1536
    ds_write_b64 v5, v[38:39] offset:1792
    s_waitcnt lgkmcnt(0)
    s_barrier
    ds_read_b64 v[8:9], v3 offset:0
    ds_read_b64 v[26:27], v3 offset:2304
    ds_read_b64 v[118:119], v3 offset:4608
    ds_read_b64 v[16:17], v3 offset:6912
    ds_read_b64 v[116:117], v3 offset:9216
    ds_read_b64 v[42:43], v3 offset:11520
    ds_read_b64 v[114:115], v3 offset:13824
    ds_read_b64 v[28:29], v3 offset:16128
    s_waitcnt lgkmcnt(0)
    v_pk_mul_f32 v[36:37], v[26:27], v[48:49] op_sel:[0,0] op_sel_hi:[1,0]
    v_pk_fma_f32 v[36:37], v[26:27], v[48:49], v[36:37] op_sel:[1,1,0] op_sel_hi:[0,1,1] neg_lo:[0,0,0] neg_hi:[1,0,0]
    v_pk_mul_f32 v[12:13], v[118:119], v[50:51] op_sel:[0,0] op_sel_hi:[1,0]
    v_pk_fma_f32 v[12:13], v[118:119], v[50:51], v[12:13] op_sel:[1,1,0] op_sel_hi:[0,1,1] neg_lo:[0,0,0] neg_hi:[1,0,0]
    v_pk_mul_f32 v[34:35], v[16:17], v[52:53] op_sel:[0,0] op_sel_hi:[1,0]
    v_pk_fma_f32 v[34:35], v[16:17], v[52:53], v[34:35] op_sel:[1,1,0] op_sel_hi:[0,1,1] neg_lo:[0,0,0] neg_hi:[1,0,0]
    v_pk_mul_f32 v[18:19], v[116:117], v[54:55] op_sel:[0,0] op_sel_hi:[1,0]
    v_pk_fma_f32 v[18:19], v[116:117], v[54:55], v[18:19] op_sel:[1,1,0] op_sel_hi:[0,1,1] neg_lo:[0,0,0] neg_hi:[1,0,0]
    v_pk_mul_f32 v[24:25], v[42:43], v[56:57] op_sel:[0,0] op_sel_hi:[1,0]
    v_pk_fma_f32 v[24:25], v[42:43], v[56:57], v[24:25] op_sel:[1,1,0] op_sel_hi:[0,1,1] neg_lo:[0,0,0] neg_hi:[1,0,0]
    v_pk_mul_f32 v[30:31], v[114:115], v[58:59] op_sel:[0,0] op_sel_hi:[1,0]
    v_pk_fma_f32 v[30:31], v[114:115], v[58:59], v[30:31] op_sel:[1,1,0] op_sel_hi:[0,1,1] neg_lo:[0,0,0] neg_hi:[1,0,0]
    v_pk_mul_f32 v[40:41], v[28:29], v[60:61] op_sel:[0,0] op_sel_hi:[1,0]
    v_pk_fma_f32 v[40:41], v[28:29], v[60:61], v[40:41] op_sel:[1,1,0] op_sel_hi:[0,1,1] neg_lo:[0,0,0] neg_hi:[1,0,0]
    v_pk_add_f32 v[46:47], v[8:9], v[18:19]
    v_pk_add_f32 v[126:127], v[8:9], v[18:19] neg_lo:[0,1] neg_hi:[0,1]
    v_pk_add_f32 v[10:11], v[36:37], v[24:25]
    v_pk_add_f32 v[22:23], v[36:37], v[24:25] neg_lo:[0,1] neg_hi:[0,1]
    v_pk_add_f32 v[124:125], v[12:13], v[30:31]
    v_pk_add_f32 v[122:123], v[12:13], v[30:31] neg_lo:[0,1] neg_hi:[0,1]
    v_pk_add_f32 v[20:21], v[34:35], v[40:41]
    v_pk_add_f32 v[44:45], v[34:35], v[40:41] neg_lo:[0,1] neg_hi:[0,1]
    v_pk_add_f32 v[120:121], v[46:47], v[124:125]
    v_pk_add_f32 v[32:33], v[46:47], v[124:125] neg_lo:[0,1] neg_hi:[0,1]
    v_pk_add_f32 v[112:113], v[10:11], v[20:21]
    v_pk_add_f32 v[14:15], v[10:11], v[20:21] neg_lo:[0,1] neg_hi:[0,1]
    v_pk_add_f32 v[38:39], v[120:121], v[112:113]
    v_pk_add_f32 v[26:27], v[120:121], v[112:113] neg_lo:[0,1] neg_hi:[0,1]
    v_pk_add_f32 v[118:119], v[32:33], v[14:15] op_sel:[0,1] op_sel_hi:[1,0] neg_lo:[0,1] neg_hi:[0,0]
    v_pk_add_f32 v[16:17], v[32:33], v[14:15] op_sel:[0,1] op_sel_hi:[1,0] neg_lo:[0,0] neg_hi:[0,1]
    v_pk_add_f32 v[116:117], v[22:23], v[22:23] op_sel:[0,1] op_sel_hi:[1,0] neg_lo:[0,1] neg_hi:[0,0]
    v_pk_add_f32 v[42:43], v[44:45], v[44:45] op_sel:[0,1] op_sel_hi:[1,0] neg_lo:[1,1] neg_hi:[1,0]
    v_pk_add_f32 v[114:115], v[126:127], v[122:123] op_sel:[0,1] op_sel_hi:[1,0] neg_lo:[0,1] neg_hi:[0,0]
    v_pk_add_f32 v[28:29], v[126:127], v[122:123] op_sel:[0,1] op_sel_hi:[1,0] neg_lo:[0,0] neg_hi:[0,1]
    v_pk_add_f32 v[8:9], v[116:117], v[42:43]
    v_pk_add_f32 v[18:19], v[116:117], v[42:43] neg_lo:[0,1] neg_hi:[0,1]
    v_pk_fma_f32 v[36:37], v[8:9], s[26:27], v[114:115] neg_lo:[0,0,0] neg_hi:[0,0,0]
    v_pk_fma_f32 v[24:25], v[8:9], s[26:27], v[114:115] neg_lo:[1,0,0] neg_hi:[1,0,0]
    v_pk_fma_f32 v[12:13], v[18:19], s[26:27], v[28:29] op_sel:[1,0,0] op_sel_hi:[0,1,1] neg_lo:[1,0,0] neg_hi:[0,0,0]
    v_pk_fma_f32 v[30:31], v[18:19], s[26:27], v[28:29] op_sel:[1,0,0] op_sel_hi:[0,1,1] neg_lo:[0,0,0] neg_hi:[1,0,0]
    s_cmp_eq_u32 s29, 320
    s_cselect_b32 s20, 0, s29
    s_cselect_b32 s25, 2, 0
    s_lshr_b32 s21, s20, 4
    s_lshl_b32 s21, s21, 10
    s_bfe_u32 s22, s20, 0x20002
    s_lshl_b32 s22, s22, 8
    s_add_u32 s21, s21, s22
    s_and_b32 s22, s20, 3
    s_lshl_b32 s22, s22, 2
    s_add_u32 s21, s21, s22
    s_add_u32 s21, s21, s25
    s_add_u32 s21, s21, 163577856
    v_cvt_pk_bf16_f32 v38, v38, v39
    v_cvt_pk_bf16_f32 v36, v36, v37
    v_cvt_pk_bf16_f32 v118, v118, v119
    v_cvt_pk_bf16_f32 v12, v12, v13
    v_cvt_pk_bf16_f32 v26, v26, v27
    v_cvt_pk_bf16_f32 v24, v24, v25
    v_cvt_pk_bf16_f32 v16, v16, v17
    v_cvt_pk_bf16_f32 v30, v30, v31
    s_cmp_eq_u32 s20, 0
    s_cbranch_scc1 main_kernel_fft_shortb
    buffer_store_dword v38, v101, s[8:11], s21 offen sc1
    s_add_u32 s21, s21, 327680
    buffer_store_dword v36, v101, s[8:11], s21 offen sc1
    s_add_u32 s21, s21, 327680
    buffer_store_dword v118, v101, s[8:11], s21 offen sc1
    s_add_u32 s21, s21, 327680
    buffer_store_dword v12, v101, s[8:11], s21 offen sc1
    s_add_u32 s21, s21, 327680
    buffer_store_dword v26, v101, s[8:11], s21 offen sc1
    s_add_u32 s21, s21, 327680
    buffer_store_dword v24, v101, s[8:11], s21 offen sc1
    s_add_u32 s21, s21, 327680
    buffer_store_dword v16, v101, s[8:11], s21 offen sc1
    s_add_u32 s21, s21, 327680
    buffer_store_dword v30, v101, s[8:11], s21 offen sc1
    s_add_u32 s21, s21, 327680
    s_branch main_kernel_fft_doneb
main_kernel_fft_shortb:
    buffer_store_short v38, v101, s[8:11], s21 offen sc1
    s_add_u32 s21, s21, 327680
    buffer_store_short v36, v101, s[8:11], s21 offen sc1
    s_add_u32 s21, s21, 327680
    buffer_store_short v118, v101, s[8:11], s21 offen sc1
    s_add_u32 s21, s21, 327680
    buffer_store_short v12, v101, s[8:11], s21 offen sc1
    s_add_u32 s21, s21, 327680
    buffer_store_short v26, v101, s[8:11], s21 offen sc1
    s_add_u32 s21, s21, 327680
    buffer_store_short v24, v101, s[8:11], s21 offen sc1
    s_add_u32 s21, s21, 327680
    buffer_store_short v16, v101, s[8:11], s21 offen sc1
    s_add_u32 s21, s21, 327680
    buffer_store_short v30, v101, s[8:11], s21 offen sc1
    s_add_u32 s21, s21, 327680
main_kernel_fft_doneb:
main_kernel_fft_end:
    s_waitcnt vmcnt(0) lgkmcnt(0)
    s_barrier
    s_cmp_lg_u32 s83, 0
    s_cbranch_scc1 main_kernel_gb_26
    s_mov_b32 s23, s85
    s_add_u32 s28, s86, 167845888
    s_lshl_b32 s27, s82, 7
    v_mbcnt_lo_u32_b32 v189, -1, 0
    s_mov_b64 exec, 1
    s_add_u32 s31, s27, s84
    v_mov_b32 v190, s31
    v_mov_b32 v191, 1
    s_cmp_lg_u32 s23, 0
    s_cbranch_scc1 main_kernel_ls_27
    buffer_store_byte v191, v190, s[8:11], s28 offen
main_kernel_ls_27_r:
    s_cmp_lg_u32 s84, 0
    s_cbranch_scc1 main_kernel_gb_25
    s_mov_b64 exec, 0xff
    v_lshl_add_u32 v190, v189, 2, s27
    s_mov_b32 s30, 0
main_kernel_gs_28:
    buffer_load_dword v191, v190, s[8:11], s28 offen sc1
    s_add_u32 s30, s30, 1
    s_cmp_ge_u32 s30, 240000
    s_cbranch_scc1 main_kernel_fail
    s_waitcnt vmcnt(0)
    v_cmp_ne_u32 vcc, 0x1010101, v191
    s_cbranch_vccnz main_kernel_gs_28
    s_mov_b64 exec, 1
    v_mov_b32 v190, s27
    v_mov_b32 v191, 1
    buffer_store_dword v191, v190, s[8:11], s28 offen offset:1024 sc1
    s_mov_b64 exec, 0x3f
    v_lshlrev_b32 v190, 7, v189
    v_add_u32 v190, 1024, v190
    s_mov_b32 s30, 0
main_kernel_gs_29:
    buffer_load_dword v191, v190, s[8:11], s28 offen sc1
    s_add_u32 s30, s30, 1
    s_cmp_ge_u32 s30, 240000
    s_cbranch_scc1 main_kernel_fail
    s_waitcnt vmcnt(0)
    v_cmp_ne_u32 vcc, 0x1, v191
    s_cbranch_vccnz main_kernel_gs_29
    s_mov_b64 exec, 1
    v_mov_b32 v190, s27
    v_mov_b32 v191, 1
    s_cmp_lg_u32 s23, 0
    s_cbranch_scc1 main_kernel_ls_30
    buffer_store_dword v191, v190, s[8:11], s28 offen offset:2048
main_kernel_ls_30_r:
main_kernel_gb_25:
    s_mov_b64 exec, 0x1
    s_add_u32 s31, s27, 2048
    v_mov_b32 v190, s31
    s_mov_b32 s30, 0
main_kernel_gs_31:
    buffer_load_dword v191, v190, s[8:11], s28 offen sc1
    s_add_u32 s30, s30, 1
    s_cmp_ge_u32 s30, 240000
    s_cbranch_scc1 main_kernel_fail
    s_waitcnt vmcnt(0)
    v_cmp_ne_u32 vcc, 0x1, v191
    s_cbranch_vccnz main_kernel_gs_31
    s_mov_b64 exec, -1
main_kernel_gb_26:
    s_barrier
    s_mov_b32 s81, s87
main_kernel_tri:
    v_mbcnt_lo_u32_b32 v0, -1, 0
    v_mbcnt_hi_u32_b32 v0, -1, v0
    s_lshl_b32 s27, s83, 6
    v_add_u32 v0, s27, v0
    s_mov_b32 s2, s81
    v_lshrrev_b32 v2, 6, v0
    v_and_b32 v0, 63, v0
    v_readfirstlane_b32 s21, v2
    v_lshlrev_b32 v1, 4, v0
    v_lshrrev_b32 v3, 4, v0
    v_and_b32 v4, 15, v0
    s_and_b32 s22, s2, 7
    s_lshr_b32 s23, s2, 3
    s_lshl_b32 s24, s23, 2
    s_add_u32 s24, s24, s21
    s_mul_i32 s29, s24, 20480
    s_add_u32 s29, s29, 163577856
    buffer_load_dwordx4 v[16:19], v1, s[8:11], s29 offen offset:0 sc1
    buffer_load_dwordx4 v[20:23], v1, s[8:11], s29 offen offset:1024 sc1
    buffer_load_dwordx4 v[24:27], v1, s[8:11], s29 offen offset:2048 sc1
    buffer_load_dwordx4 v[28:31], v1, s[8:11], s29 offen offset:3072 sc1
    s_add_u32 s29, s29, 4096
    buffer_load_dwordx4 v[32:35], v1, s[8:11], s29 offen offset:0 sc1
    buffer_load_dwordx4 v[36:39], v1, s[8:11], s29 offen offset:1024 sc1
    buffer_load_dwordx4 v[40:43], v1, s[8:11], s29 offen offset:2048 sc1
    buffer_load_dwordx4 v[44:47], v1, s[8:11], s29 offen offset:3072 sc1
    s_add_u32 s29, s29, 4096
    buffer_load_dwordx4 v[48:51], v1, s[8:11], s29 offen offset:0 sc1
    buffer_load_dwordx4 v[52:55], v1, s[8:11], s29 offen offset:1024 sc1
    buffer_load_dwordx4 v[56:59], v1, s[8:11], s29 offen offset:2048 sc1
    buffer_load_dwordx4 v[60:63], v1, s[8:11], s29 offen offset:3072 sc1
    s_add_u32 s29, s29, 4096
    buffer_load_dwordx4 v[64:67], v1, s[8:11], s29 offen offset:0 sc1
    buffer_load_dwordx4 v[68:71], v1, s[8:11], s29 offen offset:1024 sc1
    buffer_load_dwordx4 v[72:75], v1, s[8:11], s29 offen offset:2048 sc1
    buffer_load_dwordx4 v[76:79], v1, s[8:11], s29 offen offset:3072 sc1
    s_add_u32 s29, s29, 4096
    buffer_load_dwordx4 v[80:83], v1, s[8:11], s29 offen offset:0 sc1
    buffer_load_dwordx4 v[84:87], v1, s[8:11], s29 offen offset:1024 sc1
    buffer_load_dwordx4 v[88:91], v1, s[8:11], s29 offen offset:2048 sc1
    buffer_load_dwordx4 v[92:95], v1, s[8:11], s29 offen offset:3072 sc1
    s_add_u32 s29, s29, 4096
    v_mul_u32_u24 v5, 1280, v4
    v_lshl_add_u32 v5, v3, 3, v5
    s_mul_i32 s30, s24, 20480
    s_mul_i32 s31, s22, 160
    s_add_u32 s30, s30, s31
    s_add_u32 s31, s30, s80
    buffer_load_dwordx2 v[116:117], v5, s[8:11], s31 offen offset:0 sc1
    buffer_load_dwordx2 v[118:119], v5, s[8:11], s31 offen offset:32 sc1
    buffer_load_dwordx2 v[120:121], v5, s[8:11], s31 offen offset:64 sc1
    buffer_load_dwordx2 v[122:123], v5, s[8:11], s31 offen offset:96 sc1
    buffer_load_dwordx2 v[124:125], v5, s[8:11], s31 offen offset:128 sc1
    s_waitcnt vmcnt(25)
    s_barrier
    v_add_u32 v6, 61440, v1
    ds_read_b128 v[128:131], v1 offset:0
    ds_read_b128 v[132:135], v1 offset:20480
    ds_read_b128 v[136:139], v1 offset:40960
    ds_read_b128 v[140:143], v6 offset:0
    ds_read_b128 v[144:147], v6 offset:20480
    ds_read_b128 v[148:151], v1 offset:1024
    ds_read_b128 v[152:155], v1 offset:21504
    ds_read_b128 v[156:159], v1 offset:41984
    s_waitcnt vmcnt(24) lgkmcnt(7)
    v_mfma_f32_16x16x32_bf16 v[96:99], v[128:131], v[16:19], 0
    ds_read_b128 v[128:131], v6 offset:1024
    s_waitcnt lgkmcnt(7)
    v_mfma_f32_16x16x32_bf16 v[100:103], v[132:135], v[16:19], 0
    ds_read_b128 v[132:135], v6 offset:21504
    s_waitcnt lgkmcnt(7)
    v_mfma_f32_16x16x32_bf16 v[104:107], v[136:139], v[16:19], 0
    ds_read_b128 v[136:139], v1 offset:2048
    s_waitcnt lgkmcnt(7)
    v_mfma_f32_16x16x32_bf16 v[108:111], v[140:143], v[16:19], 0
    ds_read_b128 v[140:143], v1 offset:22528
    s_waitcnt lgkmcnt(7)
    v_mfma_f32_16x16x32_bf16 v[112:115], v[144:147], v[16:19], 0
    ds_read_b128 v[144:147], v1 offset:43008
    s_waitcnt vmcnt(23) lgkmcnt(7)
    v_mfma_f32_16x16x32_bf16 v[96:99], v[148:151], v[20:23], v[96:99]
    ds_read_b128 v[148:151], v6 offset:2048
    s_waitcnt lgkmcnt(7)
    v_mfma_f32_16x16x32_bf16 v[100:103], v[152:155], v[20:23], v[100:103]
    ds_read_b128 v[152:155], v6 offset:22528
    s_waitcnt lgkmcnt(7)
    v_mfma_f32_16x16x32_bf16 v[104:107], v[156:159], v[20:23], v[104:107]
    ds_read_b128 v[156:159], v1 offset:3072
    s_waitcnt lgkmcnt(7)
    v_mfma_f32_16x16x32_bf16 v[108:111], v[128:131], v[20:23], v[108:111]
    ds_read_b128 v[128:131], v1 offset:23552
    s_waitcnt lgkmcnt(7)
    v_mfma_f32_16x16x32_bf16 v[112:115], v[132:135], v[20:23], v[112:115]
    ds_read_b128 v[132:135], v1 offset:44032
    s_waitcnt vmcnt(22) lgkmcnt(7)
    v_mfma_f32_16x16x32_bf16 v[96:99], v[136:139], v[24:27], v[96:99]
    ds_read_b128 v[136:139], v6 offset:3072
    s_waitcnt lgkmcnt(7)
    v_mfma_f32_16x16x32_bf16 v[100:103], v[140:143], v[24:27], v[100:103]
    ds_read_b128 v[140:143], v6 offset:23552
    s_waitcnt lgkmcnt(7)
    v_mfma_f32_16x16x32_bf16 v[104:107], v[144:147], v[24:27], v[104:107]
    ds_read_b128 v[144:147], v1 offset:4096
    s_waitcnt lgkmcnt(7)
    v_mfma_f32_16x16x32_bf16 v[108:111], v[148:151], v[24:27], v[108:111]
    ds_read_b128 v[148:151], v1 offset:24576
    s_waitcnt lgkmcnt(7)
    v_mfma_f32_16x16x32_bf16 v[112:115], v[152:155], v[24:27], v[112:115]
    ds_read_b128 v[152:155], v1 offset:45056
    s_waitcnt vmcnt(21) lgkmcnt(7)
    v_mfma_f32_16x16x32_bf16 v[96:99], v[156:159], v[28:31], v[96:99]
    ds_read_b128 v[156:159], v6 offset:4096
    s_waitcnt lgkmcnt(7)
    v_mfma_f32_16x16x32_bf16 v[100:103], v[128:131], v[28:31], v[100:103]
    ds_read_b128 v[128:131], v6 offset:24576
    s_waitcnt lgkmcnt(7)
    v_mfma_f32_16x16x32_bf16 v[104:107], v[132:135], v[28:31], v[104:107]
    ds_read_b128 v[132:135], v1 offset:5120
    s_waitcnt lgkmcnt(7)
    v_mfma_f32_16x16x32_bf16 v[108:111], v[136:139], v[28:31], v[108:111]
    ds_read_b128 v[136:139], v1 offset:25600
    s_waitcnt lgkmcnt(7)
    v_mfma_f32_16x16x32_bf16 v[112:115], v[140:143], v[28:31], v[112:115]
    ds_read_b128 v[140:143], v1 offset:46080
    s_waitcnt vmcnt(20) lgkmcnt(7)
    v_mfma_f32_16x16x32_bf16 v[96:99], v[144:147], v[32:35], v[96:99]
    ds_read_b128 v[144:147], v6 offset:5120
    s_waitcnt lgkmcnt(7)
    v_mfma_f32_16x16x32_bf16 v[100:103], v[148:151], v[32:35], v[100:103]
    ds_read_b128 v[148:151], v6 offset:25600
    s_waitcnt lgkmcnt(7)
    v_mfma_f32_16x16x32_bf16 v[104:107], v[152:155], v[32:35], v[104:107]
    ds_read_b128 v[152:155], v1 offset:6144
    s_waitcnt lgkmcnt(7)
    v_mfma_f32_16x16x32_bf16 v[108:111], v[156:159], v[32:35], v[108:111]
    ds_read_b128 v[156:159], v1 offset:26624
    s_waitcnt lgkmcnt(7)
    v_mfma_f32_16x16x32_bf16 v[112:115], v[128:131], v[32:35], v[112:115]
    ds_read_b128 v[128:131], v1 offset:47104
    s_waitcnt vmcnt(19) lgkmcnt(7)
    v_mfma_f32_16x16x32_bf16 v[96:99], v[132:135], v[36:39], v[96:99]
    ds_read_b128 v[132:135], v6 offset:6144
    s_waitcnt lgkmcnt(7)
    v_mfma_f32_16x16x32_bf16 v[100:103], v[136:139], v[36:39], v[100:103]
    ds_read_b128 v[136:139], v6 offset:26624
    s_waitcnt lgkmcnt(7)
    v_mfma_f32_16x16x32_bf16 v[104:107], v[140:143], v[36:39], v[104:107]
    ds_read_b128 v[140:143], v1 offset:7168
    s_waitcnt lgkmcnt(7)
    v_mfma_f32_16x16x32_bf16 v[108:111], v[144:147], v[36:39], v[108:111]
    ds_read_b128 v[144:147], v1 offset:27648
    s_waitcnt lgkmcnt(7)
    v_mfma_f32_16x16x32_bf16 v[112:115], v[148:151], v[36:39], v[112:115]
    ds_read_b128 v[148:151], v1 offset:48128
    s_waitcnt vmcnt(18) lgkmcnt(7)
    v_mfma_f32_16x16x32_bf16 v[96:99], v[152:155], v[40:43], v[96:99]
    ds_read_b128 v[152:155], v6 offset:7168
    s_waitcnt lgkmcnt(7)
    v_mfma_f32_16x16x32_bf16 v[100:103], v[156:159], v[40:43], v[100:103]
    ds_read_b128 v[156:159], v6 offset:27648
    s_waitcnt lgkmcnt(7)
    v_mfma_f32_16x16x32_bf16 v[104:107], v[128:131], v[40:43], v[104:107]
    ds_read_b128 v[128:131], v1 offset:8192
    s_waitcnt lgkmcnt(7)
    v_mfma_f32_16x16x32_bf16 v[108:111], v[132:135], v[40:43], v[108:111]
    ds_read_b128 v[132:135], v1 offset:28672
    s_waitcnt lgkmcnt(7)
    v_mfma_f32_16x16x32_bf16 v[112:115], v[136:139], v[40:43], v[112:115]
    ds_read_b128 v[136:139], v1 offset:49152
    s_waitcnt vmcnt(17) lgkmcnt(7)
    v_mfma_f32_16x16x32_bf16 v[96:99], v[140:143], v[44:47], v[96:99]
    ds_read_b128 v[140:143], v6 offset:8192
    s_waitcnt lgkmcnt(7)
    v_mfma_f32_16x16x32_bf16 v[100:103], v[144:147], v[44:47], v[100:103]
    ds_read_b128 v[144:147], v6 offset:28672
    s_waitcnt lgkmcnt(7)
    v_mfma_f32_16x16x32_bf16 v[104:107], v[148:151], v[44:47], v[104:107]
    ds_read_b128 v[148:151], v1 offset:9216
    s_waitcnt lgkmcnt(7)
    v_mfma_f32_16x16x32_bf16 v[108:111], v[152:155], v[44:47], v[108:111]
    ds_read_b128 v[152:155], v1 offset:29696
    s_waitcnt lgkmcnt(7)
    v_mfma_f32_16x16x32_bf16 v[112:115], v[156:159], v[44:47], v[112:115]
    ds_read_b128 v[156:159], v1 offset:50176
    s_waitcnt vmcnt(16) lgkmcnt(7)
    v_mfma_f32_16x16x32_bf16 v[96:99], v[128:131], v[48:51], v[96:99]
    ds_read_b128 v[128:131], v6 offset:9216
    s_waitcnt lgkmcnt(7)
    v_mfma_f32_16x16x32_bf16 v[100:103], v[132:135], v[48:51], v[100:103]
    ds_read_b128 v[132:135], v6 offset:29696
    s_waitcnt lgkmcnt(7)
    v_mfma_f32_16x16x32_bf16 v[104:107], v[136:139], v[48:51], v[104:107]
    ds_read_b128 v[136:139], v1 offset:10240
    s_waitcnt lgkmcnt(7)
    v_mfma_f32_16x16x32_bf16 v[108:111], v[140:143], v[48:51], v[108:111]
    ds_read_b128 v[140:143], v1 offset:30720
    s_waitcnt lgkmcnt(7)
    v_mfma_f32_16x16x32_bf16 v[112:115], v[144:147], v[48:51], v[112:115]
    ds_read_b128 v[144:147], v1 offset:51200
    s_waitcnt vmcnt(15) lgkmcnt(7)
    v_mfma_f32_16x16x32_bf16 v[96:99], v[148:151], v[52:55], v[96:99]
    ds_read_b128 v[148:151], v6 offset:10240
    s_waitcnt lgkmcnt(7)
    v_mfma_f32_16x16x32_bf16 v[100:103], v[152:155], v[52:55], v[100:103]
    ds_read_b128 v[152:155], v6 offset:30720
    s_waitcnt lgkmcnt(7)
    v_mfma_f32_16x16x32_bf16 v[104:107], v[156:159], v[52:55], v[104:107]
    ds_read_b128 v[156:159], v1 offset:11264
    s_waitcnt lgkmcnt(7)
    v_mfma_f32_16x16x32_bf16 v[108:111], v[128:131], v[52:55], v[108:111]
    ds_read_b128 v[128:131], v1 offset:31744
    s_waitcnt lgkmcnt(7)
    v_mfma_f32_16x16x32_bf16 v[112:115], v[132:135], v[52:55], v[112:115]
    ds_read_b128 v[132:135], v1 offset:52224
    s_waitcnt vmcnt(14) lgkmcnt(7)
    v_mfma_f32_16x16x32_bf16 v[96:99], v[136:139], v[56:59], v[96:99]
    ds_read_b128 v[136:139], v6 offset:11264
    s_waitcnt lgkmcnt(7)
    v_mfma_f32_16x16x32_bf16 v[100:103], v[140:143], v[56:59], v[100:103]
    ds_read_b128 v[140:143], v6 offset:31744
    s_waitcnt lgkmcnt(7)
    v_mfma_f32_16x16x32_bf16 v[104:107], v[144:147], v[56:59], v[104:107]
    ds_read_b128 v[144:147], v1 offset:12288
    s_waitcnt lgkmcnt(7)
    v_mfma_f32_16x16x32_bf16 v[108:111], v[148:151], v[56:59], v[108:111]
    ds_read_b128 v[148:151], v1 offset:32768
    s_waitcnt lgkmcnt(7)
    v_mfma_f32_16x16x32_bf16 v[112:115], v[152:155], v[56:59], v[112:115]
    ds_read_b128 v[152:155], v1 offset:53248
    s_waitcnt vmcnt(13) lgkmcnt(7)
    v_mfma_f32_16x16x32_bf16 v[96:99], v[156:159], v[60:63], v[96:99]
    ds_read_b128 v[156:159], v6 offset:12288
    s_waitcnt lgkmcnt(7)
    v_mfma_f32_16x16x32_bf16 v[100:103], v[128:131], v[60:63], v[100:103]
    ds_read_b128 v[128:131], v6 offset:32768
    s_waitcnt lgkmcnt(7)
    v_mfma_f32_16x16x32_bf16 v[104:107], v[132:135], v[60:63], v[104:107]
    ds_read_b128 v[132:135], v1 offset:13312
    s_waitcnt lgkmcnt(7)
    v_mfma_f32_16x16x32_bf16 v[108:111], v[136:139], v[60:63], v[108:111]
    ds_read_b128 v[136:139], v1 offset:33792
    s_waitcnt lgkmcnt(7)
    v_mfma_f32_16x16x32_bf16 v[112:115], v[140:143], v[60:63], v[112:115]
    ds_read_b128 v[140:143], v1 offset:54272
    s_waitcnt vmcnt(12) lgkmcnt(7)
    v_mfma_f32_16x16x32_bf16 v[96:99], v[144:147], v[64:67], v[96:99]
    ds_read_b128 v[144:147], v6 offset:13312
    s_waitcnt lgkmcnt(7)
    v_mfma_f32_16x16x32_bf16 v[100:103], v[148:151], v[64:67], v[100:103]
    ds_read_b128 v[148:151], v6 offset:33792
    s_waitcnt lgkmcnt(7)
    v_mfma_f32_16x16x32_bf16 v[104:107], v[152:155], v[64:67], v[104:107]
    ds_read_b128 v[152:155], v1 offset:14336
    s_waitcnt lgkmcnt(7)
    v_mfma_f32_16x16x32_bf16 v[108:111], v[156:159], v[64:67], v[108:111]
    ds_read_b128 v[156:159], v1 offset:34816
    s_waitcnt lgkmcnt(7)
    v_mfma_f32_16x16x32_bf16 v[112:115], v[128:131], v[64:67], v[112:115]
    ds_read_b128 v[128:131], v1 offset:55296
    s_waitcnt vmcnt(11) lgkmcnt(7)
    v_mfma_f32_16x16x32_bf16 v[96:99], v[132:135], v[68:71], v[96:99]
    ds_read_b128 v[132:135], v6 offset:14336
    s_waitcnt lgkmcnt(7)
    v_mfma_f32_16x16x32_bf16 v[100:103], v[136:139], v[68:71], v[100:103]
    ds_read_b128 v[136:139], v6 offset:34816
    s_waitcnt lgkmcnt(7)
    v_mfma_f32_16x16x32_bf16 v[104:107], v[140:143], v[68:71], v[104:107]
    ds_read_b128 v[140:143], v1 offset:15360
    s_waitcnt lgkmcnt(7)
    v_mfma_f32_16x16x32_bf16 v[108:111], v[144:147], v[68:71], v[108:111]
    ds_read_b128 v[144:147], v1 offset:35840
    s_waitcnt lgkmcnt(7)
    v_mfma_f32_16x16x32_bf16 v[112:115], v[148:151], v[68:71], v[112:115]
    ds_read_b128 v[148:151], v1 offset:56320
    s_waitcnt vmcnt(10) lgkmcnt(7)
    v_mfma_f32_16x16x32_bf16 v[96:99], v[152:155], v[72:75], v[96:99]
    ds_read_b128 v[152:155], v6 offset:15360
    s_waitcnt lgkmcnt(7)
    v_mfma_f32_16x16x32_bf16 v[100:103], v[156:159], v[72:75], v[100:103]
    ds_read_b128 v[156:159], v6 offset:35840
    s_waitcnt lgkmcnt(7)
    v_mfma_f32_16x16x32_bf16 v[104:107], v[128:131], v[72:75], v[104:107]
    ds_read_b128 v[128:131], v1 offset:16384
    s_waitcnt lgkmcnt(7)
    v_mfma_f32_16x16x32_bf16 v[108:111], v[132:135], v[72:75], v[108:111]
    ds_read_b128 v[132:135], v1 offset:36864
    s_waitcnt lgkmcnt(7)
    v_mfma_f32_16x16x32_bf16 v[112:115], v[136:139], v[72:75], v[112:115]
    ds_read_b128 v[136:139], v1 offset:57344
    s_waitcnt vmcnt(9) lgkmcnt(7)
    v_mfma_f32_16x16x32_bf16 v[96:99], v[140:143], v[76:79], v[96:99]
    ds_read_b128 v[140:143], v6 offset:16384
    s_waitcnt lgkmcnt(7)
    v_mfma_f32_16x16x32_bf16 v[100:103], v[144:147], v[76:79], v[100:103]
    ds_read_b128 v[144:147], v6 offset:36864
    s_waitcnt lgkmcnt(7)
    v_mfma_f32_16x16x32_bf16 v[104:107], v[148:151], v[76:79], v[104:107]
    ds_read_b128 v[148:151], v1 offset:17408
    s_waitcnt lgkmcnt(7)
    v_mfma_f32_16x16x32_bf16 v[108:111], v[152:155], v[76:79], v[108:111]
    ds_read_b128 v[152:155], v1 offset:37888
    s_waitcnt lgkmcnt(7)
    v_mfma_f32_16x16x32_bf16 v[112:115], v[156:159], v[76:79], v[112:115]
    ds_read_b128 v[156:159], v1 offset:58368
    s_waitcnt vmcnt(8) lgkmcnt(7)
    v_mfma_f32_16x16x32_bf16 v[96:99], v[128:131], v[80:83], v[96:99]
    ds_read_b128 v[128:131], v6 offset:17408
    s_waitcnt lgkmcnt(7)
    v_mfma_f32_16x16x32_bf16 v[100:103], v[132:135], v[80:83], v[100:103]
    ds_read_b128 v[132:135], v6 offset:37888
    s_waitcnt lgkmcnt(7)
    v_mfma_f32_16x16x32_bf16 v[104:107], v[136:139], v[80:83], v[104:107]
    ds_read_b128 v[136:139], v1 offset:18432
    s_waitcnt lgkmcnt(7)
    v_mfma_f32_16x16x32_bf16 v[108:111], v[140:143], v[80:83], v[108:111]
    ds_read_b128 v[140:143], v1 offset:38912
    s_waitcnt lgkmcnt(7)
    v_mfma_f32_16x16x32_bf16 v[112:115], v[144:147], v[80:83], v[112:115]
    ds_read_b128 v[144:147], v1 offset:59392
    s_waitcnt vmcnt(7) lgkmcnt(7)
    v_mfma_f32_16x16x32_bf16 v[96:99], v[148:151], v[84:87], v[96:99]
    ds_read_b128 v[148:151], v6 offset:18432
    s_waitcnt lgkmcnt(7)
    v_mfma_f32_16x16x32_bf16 v[100:103], v[152:155], v[84:87], v[100:103]
    ds_read_b128 v[152:155], v6 offset:38912
    s_waitcnt lgkmcnt(7)
    v_mfma_f32_16x16x32_bf16 v[104:107], v[156:159], v[84:87], v[104:107]
    ds_read_b128 v[156:159], v1 offset:19456
    s_waitcnt lgkmcnt(7)
    v_mfma_f32_16x16x32_bf16 v[108:111], v[128:131], v[84:87], v[108:111]
    ds_read_b128 v[128:131], v1 offset:39936
    s_waitcnt lgkmcnt(7)
    v_mfma_f32_16x16x32_bf16 v[112:115], v[132:135], v[84:87], v[112:115]
    ds_read_b128 v[132:135], v1 offset:60416
    s_waitcnt vmcnt(6) lgkmcnt(7)
    v_mfma_f32_16x16x32_bf16 v[96:99], v[136:139], v[88:91], v[96:99]
    ds_read_b128 v[136:139], v6 offset:19456
    s_waitcnt lgkmcnt(7)
    v_mfma_f32_16x16x32_bf16 v[100:103], v[140:143], v[88:91], v[100:103]
    ds_read_b128 v[140:143], v6 offset:39936
    s_waitcnt lgkmcnt(7)
    v_mfma_f32_16x16x32_bf16 v[104:107], v[144:147], v[88:91], v[104:107]
    s_waitcnt lgkmcnt(6)
    v_mfma_f32_16x16x32_bf16 v[108:111], v[148:151], v[88:91], v[108:111]
    s_waitcnt lgkmcnt(5)
    v_mfma_f32_16x16x32_bf16 v[112:115], v[152:155], v[88:91], v[112:115]
    s_waitcnt vmcnt(5) lgkmcnt(4)
    v_mfma_f32_16x16x32_bf16 v[96:99], v[156:159], v[92:95], v[96:99]
    s_waitcnt lgkmcnt(3)
    v_mfma_f32_16x16x32_bf16 v[100:103], v[128:131], v[92:95], v[100:103]
    s_waitcnt lgkmcnt(2)
    v_mfma_f32_16x16x32_bf16 v[104:107], v[132:135], v[92:95], v[104:107]
    s_waitcnt lgkmcnt(1)
    v_mfma_f32_16x16x32_bf16 v[108:111], v[136:139], v[92:95], v[108:111]
    s_waitcnt lgkmcnt(0)
    v_mfma_f32_16x16x32_bf16 v[112:115], v[140:143], v[92:95], v[112:115]
    s_waitcnt vmcnt(0)
    s_nop 7
    v_lshlrev_b32 v8, 16, v116
    v_and_b32 v9, 0xffff0000, v116
    v_add_f32 v8, v8, v96
    v_add_f32 v9, v9, v97
    v_cvt_pk_bf16_f32 v116, v8, v9
    v_lshlrev_b32 v8, 16, v117
    v_and_b32 v9, 0xffff0000, v117
    v_add_f32 v8, v8, v98
    v_add_f32 v9, v9, v99
    v_cvt_pk_bf16_f32 v117, v8, v9
    v_lshlrev_b32 v8, 16, v118
    v_and_b32 v9, 0xffff0000, v118
    v_add_f32 v8, v8, v100
    v_add_f32 v9, v9, v101
    v_cvt_pk_bf16_f32 v118, v8, v9
    v_lshlrev_b32 v8, 16, v119
    v_and_b32 v9, 0xffff0000, v119
    v_add_f32 v8, v8, v102
    v_add_f32 v9, v9, v103
    v_cvt_pk_bf16_f32 v119, v8, v9
    v_lshlrev_b32 v8, 16, v120
    v_and_b32 v9, 0xffff0000, v120
    v_add_f32 v8, v8, v104
    v_add_f32 v9, v9, v105
    v_cvt_pk_bf16_f32 v120, v8, v9
    v_lshlrev_b32 v8, 16, v121
    v_and_b32 v9, 0xffff0000, v121
    v_add_f32 v8, v8, v106
    v_add_f32 v9, v9, v107
    v_cvt_pk_bf16_f32 v121, v8, v9
    v_lshlrev_b32 v8, 16, v122
    v_and_b32 v9, 0xffff0000, v122
    v_add_f32 v8, v8, v108
    v_add_f32 v9, v9, v109
    v_cvt_pk_bf16_f32 v122, v8, v9
    v_lshlrev_b32 v8, 16, v123
    v_and_b32 v9, 0xffff0000, v123
    v_add_f32 v8, v8, v110
    v_add_f32 v9, v9, v111
    v_cvt_pk_bf16_f32 v123, v8, v9
    v_lshlrev_b32 v8, 16, v124
    v_and_b32 v9, 0xffff0000, v124
    v_add_f32 v8, v8, v112
    v_add_f32 v9, v9, v113
    v_cvt_pk_bf16_f32 v124, v8, v9
    v_lshlrev_b32 v8, 16, v125
    v_and_b32 v9, 0xffff0000, v125
    v_add_f32 v8, v8, v114
    v_add_f32 v9, v9, v115
    v_cvt_pk_bf16_f32 v125, v8, v9
    buffer_store_dwordx2 v[116:117], v5, s[16:19], s30 offen offset:0 sc1
    buffer_store_dwordx2 v[118:119], v5, s[16:19], s30 offen offset:32 sc1
    buffer_store_dwordx2 v[120:121], v5, s[16:19], s30 offen offset:64 sc1
    buffer_store_dwordx2 v[122:123], v5, s[16:19], s30 offen offset:96 sc1
    buffer_store_dwordx2 v[124:125], v5, s[16:19], s30 offen offset:128 sc1
    s_add_u32 s81, s81, 192
    s_cmp_lt_u32 s81, 256
    s_cbranch_scc1 main_kernel_tri
    s_add_u32 s20, s82, 2
    s_mov_b32 s21, s83
    s_mov_b32 s22, s84
    s_mov_b32 s23, s85
    s_cmp_eq_u32 s101, 1
    s_cbranch_scc1 main_kernel_end
    s_waitcnt vmcnt(0) lgkmcnt(0)
    s_barrier
    s_cmp_lg_u32 s83, 0
    s_cbranch_scc1 main_kernel_rs_32
    s_mov_b32 s23, s85
    s_add_u32 s28, s86, 167853056
    s_lshl_b32 s27, s82, 7
    s_add_u32 s31, s27, s84
    s_mov_b64 exec, 1
    v_mov_b32 v190, s31
    v_mov_b32 v191, 1
    s_cmp_lg_u32 s23, 0
    s_cbranch_scc1 main_kernel_ls_34
    buffer_store_byte v191, v190, s[8:11], s28 offen
main_kernel_ls_34_r:
    s_and_b32 s31, s31, 0xfffffff8
    v_mov_b32 v190, s31
    s_mov_b32 s30, 0
main_kernel_rs_33:
    buffer_load_dwordx2 v[188:189], v190, s[8:11], s28 offen sc1
    s_add_u32 s30, s30, 1
    s_cmp_ge_u32 s30, 60000
    s_cbranch_scc1 main_kernel_fail
    s_waitcnt vmcnt(0)
    v_and_b32 v188, v188, v189
    v_cmp_ne_u32 vcc, 0x01010101, v188
    s_cbranch_vccnz main_kernel_rs_33
    s_mov_b64 exec, -1
main_kernel_rs_32:
    s_barrier
    s_lshr_b32 s34, s87, 3
    s_bitcmp1_b32 s87, 2
    s_cselect_b32 s27, 24, 0
    s_add_u32 s34, s34, s27
    s_cmp_ge_u32 s34, 32
    s_cbranch_scc1 main_kernel_nolna
    s_lshl_b32 s34, s34, 2
    s_and_b32 s27, s87, 3
    s_add_u32 s34, s34, s27
    s_mov_b32 s23, s85
    v_mbcnt_lo_u32_b32 v1, -1, 0
    v_mbcnt_hi_u32_b32 v1, -1, v1
    v_lshrrev_b32 v3, 4, v1
    v_and_b32 v4, 15, v1
    v_lshlrev_b32 v5, 4, v1
    s_mov_b32 s33, s83
    v_mul_u32_u24 v6, 1280, v4
    v_lshl_add_u32 v6, v3, 4, v6
    s_mul_i32 s36, s34, 20480
    s_mul_i32 s35, s33, 320
    s_add_u32 s36, s36, s35
    s_add_u32 s36, s36, 138412032
    buffer_load_dwordx4 v[8:11], v6, s[8:11], s36 offen offset:0 sc1
    buffer_load_dwordx4 v[12:15], v6, s[8:11], s36 offen offset:64 sc1
    buffer_load_dwordx4 v[16:19], v6, s[8:11], s36 offen offset:128 sc1
    buffer_load_dwordx4 v[20:23], v6, s[8:11], s36 offen offset:192 sc1
    buffer_load_dwordx4 v[24:27], v6, s[8:11], s36 offen offset:256 sc1
    s_waitcnt vmcnt(4)
    v_lshlrev_b32 v32, 16, v8
    v_and_b32 v33, 0xffff0000, v8
    v_lshlrev_b32 v34, 16, v9
    v_and_b32 v35, 0xffff0000, v9
    v_lshlrev_b32 v36, 16, v10
    v_and_b32 v37, 0xffff0000, v10
    v_lshlrev_b32 v38, 16, v11
    v_and_b32 v39, 0xffff0000, v11
    s_waitcnt vmcnt(3)
    v_lshlrev_b32 v40, 16, v12
    v_and_b32 v41, 0xffff0000, v12
    v_lshlrev_b32 v42, 16, v13
    v_and_b32 v43, 0xffff0000, v13
    v_lshlrev_b32 v44, 16, v14
    v_and_b32 v45, 0xffff0000, v14
    v_lshlrev_b32 v46, 16, v15
    v_and_b32 v47, 0xffff0000, v15
    s_waitcnt vmcnt(2)
    v_lshlrev_b32 v48, 16, v16
    v_and_b32 v49, 0xffff0000, v16
    v_lshlrev_b32 v50, 16, v17
    v_and_b32 v51, 0xffff0000, v17
    v_lshlrev_b32 v52, 16, v18
    v_and_b32 v53, 0xffff0000, v18
    v_lshlrev_b32 v54, 16, v19
    v_and_b32 v55, 0xffff0000, v19
    s_waitcnt vmcnt(1)
    v_lshlrev_b32 v56, 16, v20
    v_and_b32 v57, 0xffff0000, v20
    v_lshlrev_b32 v58, 16, v21
    v_and_b32 v59, 0xffff0000, v21
    v_lshlrev_b32 v60, 16, v22
    v_and_b32 v61, 0xffff0000, v22
    v_lshlrev_b32 v62, 16, v23
    v_and_b32 v63, 0xffff0000, v23
    s_waitcnt vmcnt(0)
    v_lshlrev_b32 v64, 16, v24
    v_and_b32 v65, 0xffff0000, v24
    v_lshlrev_b32 v66, 16, v25
    v_and_b32 v67, 0xffff0000, v25
    v_lshlrev_b32 v68, 16, v26
    v_and_b32 v69, 0xffff0000, v26
    v_lshlrev_b32 v70, 16, v27
    v_and_b32 v71, 0xffff0000, v27
    v_add_f32 v72, v32, v33
    v_add_f32 v72, v72, v34
    v_add_f32 v72, v72, v35
    v_add_f32 v72, v72, v36
    v_add_f32 v72, v72, v37
    v_add_f32 v72, v72, v38
    v_add_f32 v72, v72, v39
    v_add_f32 v72, v72, v40
    v_add_f32 v72, v72, v41
    v_add_f32 v72, v72, v42
    v_add_f32 v72, v72, v43
    v_add_f32 v72, v72, v44
    v_add_f32 v72, v72, v45
    v_add_f32 v72, v72, v46
    v_add_f32 v72, v72, v47
    v_add_f32 v72, v72, v48
    v_add_f32 v72, v72, v49
    v_add_f32 v72, v72, v50
    v_add_f32 v72, v72, v51
    v_add_f32 v72, v72, v52
    v_add_f32 v72, v72, v53
    v_add_f32 v72, v72, v54
    v_add_f32 v72, v72, v55
    v_add_f32 v72, v72, v56
    v_add_f32 v72, v72, v57
    v_add_f32 v72, v72, v58
    v_add_f32 v72, v72, v59
    v_add_f32 v72, v72, v60
    v_add_f32 v72, v72, v61
    v_add_f32 v72, v72, v62
    v_add_f32 v72, v72, v63
    v_add_f32 v72, v72, v64
    v_add_f32 v72, v72, v65
    v_add_f32 v72, v72, v66
    v_add_f32 v72, v72, v67
    v_add_f32 v72, v72, v68
    v_add_f32 v72, v72, v69
    v_add_f32 v72, v72, v70
    v_add_f32 v72, v72, v71
    v_lshlrev_b32 v77, 4, v4
    v_add_u32 v77, 102400, v77
    s_lshl_b32 s35, s33, 2
    v_add_u32 v76, s35, v77
    v_mov_b32 v73, v72
    s_nop 1
    v_permlane16_swap_b32 v72, v73
    v_add_f32 v72, v72, v73
    v_mov_b32 v73, v72
    s_nop 1
    v_permlane32_swap_b32 v72, v73
    v_add_f32 v72, v72, v73
    ds_write_b32 v76, v72 offset:0
    s_waitcnt lgkmcnt(0)
    s_barrier
    ds_read_b128 v[80:83], v77 offset:0
    s_waitcnt lgkmcnt(0)
    v_add_f32 v80, v80, v81
    v_add_f32 v82, v82, v83
    v_add_f32 v72, v80, v82
    v_mul_f32 v72, 0x3acccccd, v72
    v_sub_f32 v32, v32, v72
    v_sub_f32 v33, v33, v72
    v_sub_f32 v34, v34, v72
    v_sub_f32 v35, v35, v72
    v_sub_f32 v36, v36, v72
    v_sub_f32 v37, v37, v72
    v_sub_f32 v38, v38, v72
    v_sub_f32 v39, v39, v72
    v_sub_f32 v40, v40, v72
    v_sub_f32 v41, v41, v72
    v_sub_f32 v42, v42, v72
    v_sub_f32 v43, v43, v72
    v_sub_f32 v44, v44, v72
    v_sub_f32 v45, v45, v72
    v_sub_f32 v46, v46, v72
    v_sub_f32 v47, v47, v72
    v_sub_f32 v48, v48, v72
    v_sub_f32 v49, v49, v72
    v_sub_f32 v50, v50, v72
    v_sub_f32 v51, v51, v72
    v_sub_f32 v52, v52, v72
    v_sub_f32 v53, v53, v72
    v_sub_f32 v54, v54, v72
    v_sub_f32 v55, v55, v72
    v_sub_f32 v56, v56, v72
    v_sub_f32 v57, v57, v72
    v_sub_f32 v58, v58, v72
    v_sub_f32 v59, v59, v72
    v_sub_f32 v60, v60, v72
    v_sub_f32 v61, v61, v72
    v_sub_f32 v62, v62, v72
    v_sub_f32 v63, v63, v72
    v_sub_f32 v64, v64, v72
    v_sub_f32 v65, v65, v72
    v_sub_f32 v66, v66, v72
    v_sub_f32 v67, v67, v72
    v_sub_f32 v68, v68, v72
    v_sub_f32 v69, v69, v72
    v_sub_f32 v70, v70, v72
    v_sub_f32 v71, v71, v72
    v_mul_f32 v74, v32, v32
    v_fmac_f32 v74, v33, v33
    v_fmac_f32 v74, v34, v34
    v_fmac_f32 v74, v35, v35
    v_fmac_f32 v74, v36, v36
    v_fmac_f32 v74, v37, v37
    v_fmac_f32 v74, v38, v38
    v_fmac_f32 v74, v39, v39
    v_fmac_f32 v74, v40, v40
    v_fmac_f32 v74, v41, v41
    v_fmac_f32 v74, v42, v42
    v_fmac_f32 v74, v43, v43
    v_fmac_f32 v74, v44, v44
    v_fmac_f32 v74, v45, v45
    v_fmac_f32 v74, v46, v46
    v_fmac_f32 v74, v47, v47
    v_fmac_f32 v74, v48, v48
    v_fmac_f32 v74, v49, v49
    v_fmac_f32 v74, v50, v50
    v_fmac_f32 v74, v51, v51
    v_fmac_f32 v74, v52, v52
    v_fmac_f32 v74, v53, v53
    v_fmac_f32 v74, v54, v54
    v_fmac_f32 v74, v55, v55
    v_fmac_f32 v74, v56, v56
    v_fmac_f32 v74, v57, v57
    v_fmac_f32 v74, v58, v58
    v_fmac_f32 v74, v59, v59
    v_fmac_f32 v74, v60, v60
    v_fmac_f32 v74, v61, v61
    v_fmac_f32 v74, v62, v62
    v_fmac_f32 v74, v63, v63
    v_fmac_f32 v74, v64, v64
    v_fmac_f32 v74, v65, v65
    v_fmac_f32 v74, v66, v66
    v_fmac_f32 v74, v67, v67
    v_fmac_f32 v74, v68, v68
    v_fmac_f32 v74, v69, v69
    v_fmac_f32 v74, v70, v70
    v_fmac_f32 v74, v71, v71
    v_mov_b32 v73, v74
    s_nop 1
    v_permlane16_swap_b32 v74, v73
    v_add_f32 v74, v74, v73
    v_mov_b32 v73, v74
    s_nop 1
    v_permlane32_swap_b32 v74, v73
    v_add_f32 v74, v74, v73
    ds_write_b32 v76, v74 offset:512
    s_waitcnt lgkmcnt(0)
    s_barrier
    ds_read_b128 v[80:83], v77 offset:512
    s_waitcnt lgkmcnt(0)
    v_add_f32 v80, v80, v81
    v_add_f32 v82, v82, v83
    v_add_f32 v74, v80, v82
    v_mov_b32 v75, 0x3727c5ac
    v_fmac_f32 v75, 0x3acccccd, v74
    v_rsq_f32 v75, v75
    s_nop 0
    v_mul_f32 v32, v32, v75
    v_mul_f32 v33, v33, v75
    v_mul_f32 v34, v34, v75
    v_mul_f32 v35, v35, v75
    v_mul_f32 v36, v36, v75
    v_mul_f32 v37, v37, v75
    v_mul_f32 v38, v38, v75
    v_mul_f32 v39, v39, v75
    v_mul_f32 v40, v40, v75
    v_mul_f32 v41, v41, v75
    v_mul_f32 v42, v42, v75
    v_mul_f32 v43, v43, v75
    v_mul_f32 v44, v44, v75
    v_mul_f32 v45, v45, v75
    v_mul_f32 v46, v46, v75
    v_mul_f32 v47, v47, v75
    v_mul_f32 v48, v48, v75
    v_mul_f32 v49, v49, v75
    v_mul_f32 v50, v50, v75
    v_mul_f32 v51, v51, v75
    v_mul_f32 v52, v52, v75
    v_mul_f32 v53, v53, v75
    v_mul_f32 v54, v54, v75
    v_mul_f32 v55, v55, v75
    v_mul_f32 v56, v56, v75
    v_mul_f32 v57, v57, v75
    v_mul_f32 v58, v58, v75
    v_mul_f32 v59, v59, v75
    v_mul_f32 v60, v60, v75
    v_mul_f32 v61, v61, v75
    v_mul_f32 v62, v62, v75
    v_mul_f32 v63, v63, v75
    v_mul_f32 v64, v64, v75
    v_mul_f32 v65, v65, v75
    v_mul_f32 v66, v66, v75
    v_mul_f32 v67, v67, v75
    v_mul_f32 v68, v68, v75
    v_mul_f32 v69, v69, v75
    v_mul_f32 v70, v70, v75
    v_mul_f32 v71, v71, v75
    v_cvt_pk_bf16_f32 v8, v32, v33
    v_cvt_pk_bf16_f32 v9, v34, v35
    v_cvt_pk_bf16_f32 v10, v36, v37
    v_cvt_pk_bf16_f32 v11, v38, v39
    v_cvt_pk_bf16_f32 v12, v40, v41
    v_cvt_pk_bf16_f32 v13, v42, v43
    v_cvt_pk_bf16_f32 v14, v44, v45
    v_cvt_pk_bf16_f32 v15, v46, v47
    v_cvt_pk_bf16_f32 v16, v48, v49
    v_cvt_pk_bf16_f32 v17, v50, v51
    v_cvt_pk_bf16_f32 v18, v52, v53
    v_cvt_pk_bf16_f32 v19, v54, v55
    v_cvt_pk_bf16_f32 v20, v56, v57
    v_cvt_pk_bf16_f32 v21, v58, v59
    v_cvt_pk_bf16_f32 v22, v60, v61
    v_cvt_pk_bf16_f32 v23, v62, v63
    v_cvt_pk_bf16_f32 v24, v64, v65
    v_cvt_pk_bf16_f32 v25, v66, v67
    v_cvt_pk_bf16_f32 v26, v68, v69
    v_cvt_pk_bf16_f32 v27, v70, v71
    s_mul_i32 s36, s34, 20480
    s_mul_i32 s35, s33, 5120
    s_add_u32 s36, s36, s35
    s_add_u32 s36, s36, 32505856
    s_add_u32 s35, s36, 4096
    buffer_store_dwordx4 v[8:11], v5, s[8:11], s36 offen offset:0 sc1
    buffer_store_dwordx4 v[12:15], v5, s[8:11], s36 offen offset:1024 sc1
    buffer_store_dwordx4 v[16:19], v5, s[8:11], s36 offen offset:2048 sc1
    buffer_store_dwordx4 v[20:23], v5, s[8:11], s36 offen offset:3072 sc1
    buffer_store_dwordx4 v[24:27], v5, s[8:11], s35 offen offset:0 sc1
main_kernel_nolna:
    s_waitcnt vmcnt(0) lgkmcnt(0)
    s_barrier
    s_cmp_lg_u32 s83, 0
    s_cbranch_scc1 main_kernel_gb_36
    s_mov_b32 s23, s85
    s_add_u32 s28, s86, 167854080
    s_lshl_b32 s27, s82, 7
    v_mbcnt_lo_u32_b32 v189, -1, 0
    s_mov_b64 exec, 1
    s_add_u32 s31, s27, s84
    v_mov_b32 v190, s31
    v_mov_b32 v191, 1
    s_cmp_lg_u32 s23, 0
    s_cbranch_scc1 main_kernel_ls_37
    buffer_store_byte v191, v190, s[8:11], s28 offen
main_kernel_ls_37_r:
    s_cmp_lg_u32 s84, 0
    s_cbranch_scc1 main_kernel_gb_35
    s_mov_b64 exec, 0xff
    v_lshl_add_u32 v190, v189, 2, s27
    s_mov_b32 s30, 0
main_kernel_gs_38:
    buffer_load_dword v191, v190, s[8:11], s28 offen sc1
    s_add_u32 s30, s30, 1
    s_cmp_ge_u32 s30, 240000
    s_cbranch_scc1 main_kernel_fail
    s_waitcnt vmcnt(0)
    v_cmp_ne_u32 vcc, 0x1010101, v191
    s_cbranch_vccnz main_kernel_gs_38
    s_mov_b64 exec, 1
    v_mov_b32 v190, s27
    v_mov_b32 v191, 1
    buffer_store_dword v191, v190, s[8:11], s28 offen offset:1024 sc1
    s_mov_b64 exec, 0x3f
    v_lshlrev_b32 v190, 7, v189
    v_add_u32 v190, 1024, v190
    s_mov_b32 s30, 0
main_kernel_gs_39:
    buffer_load_dword v191, v190, s[8:11], s28 offen sc1
    s_add_u32 s30, s30, 1
    s_cmp_ge_u32 s30, 240000
    s_cbranch_scc1 main_kernel_fail
    s_waitcnt vmcnt(0)
    v_cmp_ne_u32 vcc, 0x1, v191
    s_cbranch_vccnz main_kernel_gs_39
    s_mov_b64 exec, 1
    v_mov_b32 v190, s27
    v_mov_b32 v191, 1
    s_cmp_lg_u32 s23, 0
    s_cbranch_scc1 main_kernel_ls_40
    buffer_store_dword v191, v190, s[8:11], s28 offen offset:2048
main_kernel_ls_40_r:
main_kernel_gb_35:
    s_mov_b64 exec, 0x1
    s_add_u32 s31, s27, 2048
    v_mov_b32 v190, s31
    s_mov_b32 s30, 0
main_kernel_gs_41:
    buffer_load_dword v191, v190, s[8:11], s28 offen sc1
    s_add_u32 s30, s30, 1
    s_cmp_ge_u32 s30, 240000
    s_cbranch_scc1 main_kernel_fail
    s_waitcnt vmcnt(0)
    v_cmp_ne_u32 vcc, 0x1, v191
    s_cbranch_vccnz main_kernel_gs_41
    s_mov_b64 exec, -1
main_kernel_gb_36:
    s_barrier
    s_add_u32 s20, s82, 2
    s_mov_b32 s21, s83
    s_mov_b32 s22, s84
    s_mov_b32 s23, s85
    s_mov_b32 s101, 1
    v_mbcnt_lo_u32_b32 v0, -1, 0
    v_mbcnt_hi_u32_b32 v0, -1, v0
    v_lshlrev_b32 v0, 4, v0
    s_branch main_kernel_bulk
main_kernel_ls_3:
    s_nop 7
    buffer_store_dwordx4 v[64:67], v6, s[8:11], s48 offen offset:0 sc1
    buffer_store_dwordx4 v[72:75], v6, s[8:11], s27 offen offset:0 sc1
    buffer_store_dwordx4 v[80:83], v6, s[8:11], s48 offen offset:64 sc1
    buffer_store_dwordx4 v[88:91], v6, s[8:11], s27 offen offset:64 sc1
    buffer_store_dwordx4 v[96:99], v6, s[8:11], s48 offen offset:128 sc1
    buffer_store_dwordx4 v[104:107], v6, s[8:11], s27 offen offset:128 sc1
    buffer_store_dwordx4 v[112:115], v6, s[8:11], s48 offen offset:192 sc1
    buffer_store_dwordx4 v[120:123], v6, s[8:11], s27 offen offset:192 sc1
    buffer_store_dwordx4 v[128:131], v6, s[8:11], s48 offen offset:256 sc1
    buffer_store_dwordx4 v[136:139], v6, s[8:11], s27 offen offset:256 sc1
    s_branch main_kernel_ls_3_r
main_kernel_ls_4:
    s_nop 7
    buffer_store_byte v11, v10, s[8:11], s51 offen sc1
    s_branch main_kernel_ls_4_r
main_kernel_ls_9:
    s_nop 7
    buffer_store_byte v191, v190, s[8:11], s28 offen sc1
    s_branch main_kernel_ls_9_r
main_kernel_ls_12:
    s_nop 7
    buffer_store_dword v191, v190, s[8:11], s28 offen offset:2048 sc1
    s_branch main_kernel_ls_12_r
main_kernel_ls_14:
    s_nop 7
    buffer_store_dwordx4 v[8:11], v5, s[8:11], s36 offen offset:0 sc1
    buffer_store_dwordx4 v[12:15], v5, s[8:11], s36 offen offset:1024 sc1
    buffer_store_dwordx4 v[16:19], v5, s[8:11], s36 offen offset:2048 sc1
    buffer_store_dwordx4 v[20:23], v5, s[8:11], s36 offen offset:3072 sc1
    buffer_store_dwordx4 v[24:27], v5, s[8:11], s35 offen offset:0 sc1
    s_branch main_kernel_ls_14_r
main_kernel_ls_17:
    s_nop 7
    buffer_store_byte v191, v190, s[8:11], s28 offen sc1
    s_branch main_kernel_ls_17_r
main_kernel_ls_20:
    s_nop 7
    buffer_store_byte v191, v190, s[8:11], s28 offen sc1
    s_branch main_kernel_ls_20_r
main_kernel_ls_23:
    s_nop 7
    buffer_store_dword v191, v190, s[8:11], s28 offen offset:2048 sc1
    s_branch main_kernel_ls_23_r
main_kernel_ls_27:
    s_nop 7
    buffer_store_byte v191, v190, s[8:11], s28 offen sc1
    s_branch main_kernel_ls_27_r
main_kernel_ls_30:
    s_nop 7
    buffer_store_dword v191, v190, s[8:11], s28 offen offset:2048 sc1
    s_branch main_kernel_ls_30_r
main_kernel_ls_34:
    s_nop 7
    buffer_store_byte v191, v190, s[8:11], s28 offen sc1
    s_branch main_kernel_ls_34_r
main_kernel_ls_37:
    s_nop 7
    buffer_store_byte v191, v190, s[8:11], s28 offen sc1
    s_branch main_kernel_ls_37_r
main_kernel_ls_40:
    s_nop 7
    buffer_store_dword v191, v190, s[8:11], s28 offen offset:2048 sc1
    s_branch main_kernel_ls_40_r
main_kernel_fail:
    s_mov_b64 exec, 1
    v_mov_b32 v12, 1
    v_mov_b32 v13, 48
    buffer_atomic_add v12, v13, s[12:15], 0 offen
main_kernel_end:
    s_endpgm

.section .rodata,"a"
.p2align 6
.amdhsa_kernel prep_kernel
  .amdhsa_next_free_vgpr 96
  .amdhsa_next_free_sgpr 96
  .amdhsa_accum_offset 96
  .amdhsa_group_segment_fixed_size 0
  .amdhsa_kernarg_size 104
  .amdhsa_user_sgpr_count 2
  .amdhsa_user_sgpr_kernarg_segment_ptr 1
  .amdhsa_system_sgpr_workgroup_id_x 1
  .amdhsa_float_denorm_mode_32 3
  .amdhsa_float_denorm_mode_16_64 3
.end_amdhsa_kernel

.p2align 6
.amdhsa_kernel main_kernel
  .amdhsa_next_free_vgpr 512
  .amdhsa_next_free_sgpr 102
  .amdhsa_accum_offset 256
  .amdhsa_group_segment_fixed_size 0
  .amdhsa_kernarg_size 104
  .amdhsa_user_sgpr_count 2
  .amdhsa_user_sgpr_kernarg_segment_ptr 1
  .amdhsa_system_sgpr_workgroup_id_x 1
  .amdhsa_float_denorm_mode_32 3
  .amdhsa_float_denorm_mode_16_64 3
.end_amdhsa_kernel
```

```asm
; @launch kernel=interleave_layers__memory_aug_recurrent_mem_tr__spectral_gfnet__prompt_kernel grid=(256,1,1) block=(256,1,1) lds=163840
.amdgcn_target "amdgcn-amd-amdhsa--gfx950"
.text
.globl interleave_layers__memory_aug_recurrent_mem_tr__spectral_gfnet__prompt_kernel
.p2align 8
.type interleave_layers__memory_aug_recurrent_mem_tr__spectral_gfnet__prompt_kernel,@function
interleave_layers__memory_aug_recurrent_mem_tr__spectral_gfnet__prompt_kernel:
    s_cmp_ge_u32 s2, 256
    s_cbranch_scc1 M_end
    s_load_dwordx2 s[16:17], s[0:1], 0
    s_load_dwordx2 s[8:9], s[0:1], 96
    s_load_dwordx2 s[12:13], s[0:1], 88
    s_load_dwordx2 s[72:73], s[0:1], 16
    s_load_dwordx2 s[76:77], s[0:1], 24
    s_load_dwordx2 s[80:81], s[0:1], 32
    s_load_dwordx2 s[84:85], s[0:1], 40
    s_load_dwordx2 s[68:69], s[0:1], 8
    s_getreg_b32 s24, hwreg(HW_REG_XCC_ID)
    s_and_b32 s24, s24, 7
    s_getpc_b64 s[26:27]
M_cpf:
    s_lshr_b32 s28, s2, 3
    s_lshl_b32 s28, s28, 8
    v_add_u32 v13, s28, v0
    v_lshlrev_b32 v13, 6, v13
    v_cmp_gt_u32 vcc, M_end - M_cpf, v13
    s_and_saveexec_b64 s[28:29], vcc
    s_cbranch_execz M_cpfd
    global_load_dword v14, v13, s[26:27]
M_cpfd:
    s_mov_b64 exec, s[28:29]
    v_lshrrev_b32 v12, 6, v0
    v_and_b32 v0, 63, v0
    v_readfirstlane_b32 s21, v12
    v_lshlrev_b32 v0, 4, v0
    s_waitcnt lgkmcnt(0)
    s_and_b32 s9, s9, 0xffff
    s_mov_b32 s10, 268435456
    s_mov_b32 s11, 0x00020000
    s_and_b32 s13, s13, 0xffff
    s_mov_b32 s14, 256
    s_mov_b32 s15, 0x00020000
    s_and_b32 s17, s17, 0xffff
    s_mov_b32 s18, 2621440
    s_mov_b32 s19, 0x00020000
    s_and_b32 s73, s73, 0xffff
    s_mov_b32 s74, 5242880
    s_mov_b32 s75, 0x00020000
    s_and_b32 s77, s77, 0xffff
    s_mov_b32 s78, 5242880
    s_mov_b32 s79, 0x00020000
    s_and_b32 s81, s81, 0xffff
    s_mov_b32 s82, 5242880
    s_mov_b32 s83, 0x00020000
    s_and_b32 s85, s85, 0xffff
    s_mov_b32 s86, 5242880
    s_mov_b32 s87, 0x00020000
    s_and_b32 s69, s69, 0xffff
    s_mov_b32 s70, 10240
    s_mov_b32 s71, 0x00020000
    s_mov_b32 s5, 0
    s_mov_b32 s101, 0
    s_cmp_eq_u32 s21, 0
    s_cbranch_scc1 M_tick
    s_cmp_eq_u32 s21, 3
    s_cbranch_scc1 M_zero
    v_mov_b32 v28, -1
    v_mov_b32 v29, -1
    v_mov_b32 v30, -1
    v_mov_b32 v31, -1
    s_lshl_b32 s26, s2, 1
    s_add_u32 s26, s26, s21
    s_lshl_b32 s26, s26, 12
    s_add_u32 s26, s26, 171962368
    buffer_store_dwordx4 v[28:31], v0, s[8:11], s26 offen offset:0 sc1
    buffer_store_dwordx4 v[28:31], v0, s[8:11], s26 offen offset:1024 sc1
    buffer_store_dwordx4 v[28:31], v0, s[8:11], s26 offen offset:2048 sc1
    buffer_store_dwordx4 v[28:31], v0, s[8:11], s26 offen offset:3072 sc1
    s_branch M_notick
M_zero:
    v_mov_b32 v28, 0
    v_mov_b32 v29, 0
    v_mov_b32 v30, 0
    v_mov_b32 v31, 0
    s_lshl_b32 s26, s2, 9
    s_add_u32 s26, s26, 167837696
    s_mov_b32 exec_hi, 0
    buffer_store_dwordx4 v[28:31], v0, s[8:11], s26 offen sc1
    s_mov_b64 exec, -1
    s_cmp_ge_u32 s2, 10
    s_cbranch_scc1 M_notick
    v_bfe_u32 v6, v0, 4, 3
    v_mul_u32_u24 v6, 1280, v6
    v_lshrrev_b32 v7, 8, v0
    v_lshl_add_u32 v6, v7, 5, v6
    v_bfe_u32 v7, v0, 7, 1
    v_lshl_add_u32 v6, v7, 2, v6
    s_lshl_b32 s26, s2, 7
    buffer_load_dword v32, v6, s[68:71], s26 offen offset:0
    buffer_load_dword v33, v6, s[68:71], s26 offen offset:8
    buffer_load_dword v34, v6, s[68:71], s26 offen offset:16
    buffer_load_dword v35, v6, s[68:71], s26 offen offset:24
    v_and_b32 v7, 0x200, v0
    v_bfe_u32 v12, v0, 6, 1
    v_lshl_or_b32 v7, v12, 8, v7
    v_bfe_u32 v12, v0, 4, 1
    v_lshl_or_b32 v7, v12, 7, v7
    v_bfe_u32 v12, v0, 5, 1
    v_lshl_or_b32 v7, v12, 6, v7
    v_bfe_u32 v12, v0, 8, 1
    v_lshl_or_b32 v7, v12, 5, v7
    v_bfe_u32 v12, v0, 7, 1
    v_lshl_or_b32 v7, v12, 4, v7
    s_lshl_b32 s26, s2, 10
    s_add_u32 s26, s26, 167772160
    s_waitcnt vmcnt(0)
    v_min_u32 v32, -2, v32
    v_min_u32 v33, -2, v33
    v_min_u32 v34, -2, v34
    v_min_u32 v35, -2, v35
    buffer_store_dwordx4 v[32:35], v7, s[8:11], s26 offen sc1
    s_branch M_notick
M_tick:
    s_and_b32 s25, s24, 5
    s_cmp_lg_u32 s25, 1
    s_cbranch_scc1 M_nocal
    s_bfe_u32 s25, s2, 0x20003
    s_lshl_b32 s26, s25, 13
    s_lshr_b32 s27, s2, 5
    s_lshl_b32 s27, s27, 15
    s_add_u32 s26, s26, s27
    s_lshl_b32 s27, s24, 8
    s_add_u32 s26, s26, s27
    s_add_u32 s26, s26, 171966464
    v_mov_b32 v28, -1
    v_mov_b32 v29, -1
    v_mov_b32 v30, -1
    v_mov_b32 v31, -1
    s_mov_b64 exec, 0xff
    s_mov_b32 s27, -1
    s_waitcnt vmcnt(0)
    s_memtime s[28:29]
    buffer_store_dwordx4 v[28:31], v0, s[8:11], s26 offen sc1
    s_waitcnt vmcnt(0)
    s_memtime s[30:31]
    s_waitcnt lgkmcnt(0)
    s_sub_u32 s28, s30, s28
    s_min_u32 s27, s27, s28
    s_memtime s[28:29]
    buffer_store_dwordx4 v[28:31], v0, s[8:11], s26 offen sc1
    s_waitcnt vmcnt(0)
    s_memtime s[30:31]
    s_waitcnt lgkmcnt(0)
    s_sub_u32 s28, s30, s28
    s_min_u32 s27, s27, s28
    s_memtime s[28:29]
    buffer_store_dwordx4 v[28:31], v0, s[8:11], s26 offen sc1
    s_waitcnt vmcnt(0)
    s_memtime s[30:31]
    s_waitcnt lgkmcnt(0)
    s_sub_u32 s28, s30, s28
    s_min_u32 s27, s27, s28
    s_memtime s[28:29]
    buffer_store_dwordx4 v[28:31], v0, s[8:11], s26 offen sc1
    s_waitcnt vmcnt(0)
    s_memtime s[30:31]
    s_waitcnt lgkmcnt(0)
    s_sub_u32 s28, s30, s28
    s_min_u32 s27, s27, s28
    s_mov_b64 exec, 1
    s_not_b32 s27, s27
    v_mov_b32 v28, s27
    s_lshl_b32 s25, s25, 2
    s_add_u32 s25, s25, 128
    v_mov_b32 v29, s25
    buffer_atomic_umax v28, v29, s[12:15], 0 offen
M_nocal:
    s_mov_b64 exec, 1
    v_mov_b32 v28, 1
    s_lshl_b32 s25, s24, 2
    v_mov_b32 v29, s25
    buffer_atomic_add v28, v29, s[12:15], 0 offen sc0
    s_waitcnt vmcnt(0)
    v_mov_b32 v29, 23296
    ds_write_b32 v29, v28
    s_waitcnt lgkmcnt(0)
    s_mov_b64 exec, -1
M_notick:
    s_waitcnt vmcnt(0)
    s_barrier
    s_cmp_lg_u32 s21, 0
    s_cbranch_scc1 M_noarr
    s_mov_b64 exec, 1
    v_mov_b32 v30, 1
    v_mov_b32 v29, 32
    buffer_atomic_add v30, v29, s[12:15], 0 offen
    s_mov_b64 exec, -1
M_noarr:
    v_mov_b32 v29, 23296
    ds_read_b32 v28, v29
    s_waitcnt lgkmcnt(0)
    v_readfirstlane_b32 s25, v28
    s_lshl_b32 s20, s24, 2
    s_lshr_b32 s20, 0x76325140, s20
    s_and_b32 s20, s20, 7
    s_and_b32 s22, s25, 31
    s_mov_b32 s23, 0
    s_mov_b32 s32, 0
    s_cmp_ge_u32 s20, 4
    s_cbranch_scc1 M_lw_done
M_loadw:
    s_barrier
    s_cmp_lt_u32 s20, 2
    s_cbranch_scc1 M_lw_chain
    s_cmp_lt_u32 s20, 4
    s_cbranch_scc1 M_lw_bulk
    s_lshl_b32 s34, s22, 2
    s_add_u32 s34, s34, s20
    s_sub_u32 s34, s34, 4
    s_mov_b32 s92, s33
    s_mov_b32 s33, s21
    v_lshrrev_b32 v1, 4, v0
    v_lshrrev_b32 v3, 8, v0
    v_and_b32 v4, 15, v1
    v_mov_b32 v5, v0
    v_mul_u32_u24 v6, 1280, v4
    v_lshl_add_u32 v6, v3, 4, v6
    s_mul_i32 s36, s34, 20480
    s_mul_i32 s35, s33, 320
    s_add_u32 s36, s36, s35
    buffer_load_dwordx4 v[8:11], v6, s[16:19], s36 offen offset:0
    buffer_load_dwordx4 v[12:15], v6, s[16:19], s36 offen offset:64
    buffer_load_dwordx4 v[16:19], v6, s[16:19], s36 offen offset:128
    buffer_load_dwordx4 v[20:23], v6, s[16:19], s36 offen offset:192
    buffer_load_dwordx4 v[24:27], v6, s[16:19], s36 offen offset:256
    s_waitcnt vmcnt(4)
    v_lshlrev_b32 v32, 16, v8
    v_and_b32 v33, 0xffff0000, v8
    v_lshlrev_b32 v34, 16, v9
    v_and_b32 v35, 0xffff0000, v9
    v_lshlrev_b32 v36, 16, v10
    v_and_b32 v37, 0xffff0000, v10
    v_lshlrev_b32 v38, 16, v11
    v_and_b32 v39, 0xffff0000, v11
    s_waitcnt vmcnt(3)
    v_lshlrev_b32 v40, 16, v12
    v_and_b32 v41, 0xffff0000, v12
    v_lshlrev_b32 v42, 16, v13
    v_and_b32 v43, 0xffff0000, v13
    v_lshlrev_b32 v44, 16, v14
    v_and_b32 v45, 0xffff0000, v14
    v_lshlrev_b32 v46, 16, v15
    v_and_b32 v47, 0xffff0000, v15
    s_waitcnt vmcnt(2)
    v_lshlrev_b32 v48, 16, v16
    v_and_b32 v49, 0xffff0000, v16
    v_lshlrev_b32 v50, 16, v17
    v_and_b32 v51, 0xffff0000, v17
    v_lshlrev_b32 v52, 16, v18
    v_and_b32 v53, 0xffff0000, v18
    v_lshlrev_b32 v54, 16, v19
    v_and_b32 v55, 0xffff0000, v19
    s_waitcnt vmcnt(1)
    v_lshlrev_b32 v56, 16, v20
    v_and_b32 v57, 0xffff0000, v20
    v_lshlrev_b32 v58, 16, v21
    v_and_b32 v59, 0xffff0000, v21
    v_lshlrev_b32 v60, 16, v22
    v_and_b32 v61, 0xffff0000, v22
    v_lshlrev_b32 v62, 16, v23
    v_and_b32 v63, 0xffff0000, v23
    s_waitcnt vmcnt(0)
    v_lshlrev_b32 v64, 16, v24
    v_and_b32 v65, 0xffff0000, v24
    v_lshlrev_b32 v66, 16, v25
    v_and_b32 v67, 0xffff0000, v25
    v_lshlrev_b32 v68, 16, v26
    v_and_b32 v69, 0xffff0000, v26
    v_lshlrev_b32 v70, 16, v27
    v_and_b32 v71, 0xffff0000, v27
    v_add_f32 v72, v32, v33
    v_add_f32 v72, v72, v34
    v_add_f32 v72, v72, v35
    v_add_f32 v72, v72, v36
    v_add_f32 v72, v72, v37
    v_add_f32 v72, v72, v38
    v_add_f32 v72, v72, v39
    v_add_f32 v72, v72, v40
    v_add_f32 v72, v72, v41
    v_add_f32 v72, v72, v42
    v_add_f32 v72, v72, v43
    v_add_f32 v72, v72, v44
    v_add_f32 v72, v72, v45
    v_add_f32 v72, v72, v46
    v_add_f32 v72, v72, v47
    v_add_f32 v72, v72, v48
    v_add_f32 v72, v72, v49
    v_add_f32 v72, v72, v50
    v_add_f32 v72, v72, v51
    v_add_f32 v72, v72, v52
    v_add_f32 v72, v72, v53
    v_add_f32 v72, v72, v54
    v_add_f32 v72, v72, v55
    v_add_f32 v72, v72, v56
    v_add_f32 v72, v72, v57
    v_add_f32 v72, v72, v58
    v_add_f32 v72, v72, v59
    v_add_f32 v72, v72, v60
    v_add_f32 v72, v72, v61
    v_add_f32 v72, v72, v62
    v_add_f32 v72, v72, v63
    v_add_f32 v72, v72, v64
    v_add_f32 v72, v72, v65
    v_add_f32 v72, v72, v66
    v_add_f32 v72, v72, v67
    v_add_f32 v72, v72, v68
    v_add_f32 v72, v72, v69
    v_add_f32 v72, v72, v70
    v_add_f32 v72, v72, v71
    v_lshlrev_b32 v77, 4, v4
    s_lshl_b32 s35, s33, 2
    v_add_u32 v76, s35, v77
    v_mov_b32 v73, v72
    s_nop 1
    v_permlane16_swap_b32 v72, v73
    v_add_f32 v72, v72, v73
    v_mov_b32 v73, v72
    s_nop 1
    v_permlane32_swap_b32 v72, v73
    v_add_f32 v72, v72, v73
    ds_write_b32 v76, v72 offset:0
    s_waitcnt lgkmcnt(0)
    s_barrier
    ds_read_b128 v[80:83], v77 offset:0
    s_waitcnt lgkmcnt(0)
    v_add_f32 v80, v80, v81
    v_add_f32 v82, v82, v83
    v_add_f32 v72, v80, v82
    v_mul_f32 v72, 0x3acccccd, v72
    v_sub_f32 v32, v32, v72
    v_sub_f32 v33, v33, v72
    v_sub_f32 v34, v34, v72
    v_sub_f32 v35, v35, v72
    v_sub_f32 v36, v36, v72
    v_sub_f32 v37, v37, v72
    v_sub_f32 v38, v38, v72
    v_sub_f32 v39, v39, v72
    v_sub_f32 v40, v40, v72
    v_sub_f32 v41, v41, v72
    v_sub_f32 v42, v42, v72
    v_sub_f32 v43, v43, v72
    v_sub_f32 v44, v44, v72
    v_sub_f32 v45, v45, v72
    v_sub_f32 v46, v46, v72
    v_sub_f32 v47, v47, v72
    v_sub_f32 v48, v48, v72
    v_sub_f32 v49, v49, v72
    v_sub_f32 v50, v50, v72
    v_sub_f32 v51, v51, v72
    v_sub_f32 v52, v52, v72
    v_sub_f32 v53, v53, v72
    v_sub_f32 v54, v54, v72
    v_sub_f32 v55, v55, v72
    v_sub_f32 v56, v56, v72
    v_sub_f32 v57, v57, v72
    v_sub_f32 v58, v58, v72
    v_sub_f32 v59, v59, v72
    v_sub_f32 v60, v60, v72
    v_sub_f32 v61, v61, v72
    v_sub_f32 v62, v62, v72
    v_sub_f32 v63, v63, v72
    v_sub_f32 v64, v64, v72
    v_sub_f32 v65, v65, v72
    v_sub_f32 v66, v66, v72
    v_sub_f32 v67, v67, v72
    v_sub_f32 v68, v68, v72
    v_sub_f32 v69, v69, v72
    v_sub_f32 v70, v70, v72
    v_sub_f32 v71, v71, v72
    v_mul_f32 v74, v32, v32
    v_fmac_f32 v74, v33, v33
    v_fmac_f32 v74, v34, v34
    v_fmac_f32 v74, v35, v35
    v_fmac_f32 v74, v36, v36
    v_fmac_f32 v74, v37, v37
    v_fmac_f32 v74, v38, v38
    v_fmac_f32 v74, v39, v39
    v_fmac_f32 v74, v40, v40
    v_fmac_f32 v74, v41, v41
    v_fmac_f32 v74, v42, v42
    v_fmac_f32 v74, v43, v43
    v_fmac_f32 v74, v44, v44
    v_fmac_f32 v74, v45, v45
    v_fmac_f32 v74, v46, v46
    v_fmac_f32 v74, v47, v47
    v_fmac_f32 v74, v48, v48
    v_fmac_f32 v74, v49, v49
    v_fmac_f32 v74, v50, v50
    v_fmac_f32 v74, v51, v51
    v_fmac_f32 v74, v52, v52
    v_fmac_f32 v74, v53, v53
    v_fmac_f32 v74, v54, v54
    v_fmac_f32 v74, v55, v55
    v_fmac_f32 v74, v56, v56
    v_fmac_f32 v74, v57, v57
    v_fmac_f32 v74, v58, v58
    v_fmac_f32 v74, v59, v59
    v_fmac_f32 v74, v60, v60
    v_fmac_f32 v74, v61, v61
    v_fmac_f32 v74, v62, v62
    v_fmac_f32 v74, v63, v63
    v_fmac_f32 v74, v64, v64
    v_fmac_f32 v74, v65, v65
    v_fmac_f32 v74, v66, v66
    v_fmac_f32 v74, v67, v67
    v_fmac_f32 v74, v68, v68
    v_fmac_f32 v74, v69, v69
    v_fmac_f32 v74, v70, v70
    v_fmac_f32 v74, v71, v71
    v_mov_b32 v73, v74
    s_nop 1
    v_permlane16_swap_b32 v74, v73
    v_add_f32 v74, v74, v73
    v_mov_b32 v73, v74
    s_nop 1
    v_permlane32_swap_b32 v74, v73
    v_add_f32 v74, v74, v73
    ds_write_b32 v76, v74 offset:512
    s_waitcnt lgkmcnt(0)
    s_barrier
    ds_read_b128 v[80:83], v77 offset:512
    s_waitcnt lgkmcnt(0)
    v_add_f32 v80, v80, v81
    v_add_f32 v82, v82, v83
    v_add_f32 v74, v80, v82
    v_mov_b32 v75, 0x3727c5ac
    v_fmac_f32 v75, 0x3acccccd, v74
    v_rsq_f32 v75, v75
    s_nop 0
    v_mul_f32 v32, v32, v75
    v_mul_f32 v33, v33, v75
    v_mul_f32 v34, v34, v75
    v_mul_f32 v35, v35, v75
    v_mul_f32 v36, v36, v75
    v_mul_f32 v37, v37, v75
    v_mul_f32 v38, v38, v75
    v_mul_f32 v39, v39, v75
    v_mul_f32 v40, v40, v75
    v_mul_f32 v41, v41, v75
    v_mul_f32 v42, v42, v75
    v_mul_f32 v43, v43, v75
    v_mul_f32 v44, v44, v75
    v_mul_f32 v45, v45, v75
    v_mul_f32 v46, v46, v75
    v_mul_f32 v47, v47, v75
    v_mul_f32 v48, v48, v75
    v_mul_f32 v49, v49, v75
    v_mul_f32 v50, v50, v75
    v_mul_f32 v51, v51, v75
    v_mul_f32 v52, v52, v75
    v_mul_f32 v53, v53, v75
    v_mul_f32 v54, v54, v75
    v_mul_f32 v55, v55, v75
    v_mul_f32 v56, v56, v75
    v_mul_f32 v57, v57, v75
    v_mul_f32 v58, v58, v75
    v_mul_f32 v59, v59, v75
    v_mul_f32 v60, v60, v75
    v_mul_f32 v61, v61, v75
    v_mul_f32 v62, v62, v75
    v_mul_f32 v63, v63, v75
    v_mul_f32 v64, v64, v75
    v_mul_f32 v65, v65, v75
    v_mul_f32 v66, v66, v75
    v_mul_f32 v67, v67, v75
    v_mul_f32 v68, v68, v75
    v_mul_f32 v69, v69, v75
    v_mul_f32 v70, v70, v75
    v_mul_f32 v71, v71, v75
    v_cvt_pk_bf16_f32 v8, v32, v33
    v_cvt_pk_bf16_f32 v9, v34, v35
    v_cvt_pk_bf16_f32 v10, v36, v37
    v_cvt_pk_bf16_f32 v11, v38, v39
    v_cvt_pk_bf16_f32 v12, v40, v41
    v_cvt_pk_bf16_f32 v13, v42, v43
    v_cvt_pk_bf16_f32 v14, v44, v45
    v_cvt_pk_bf16_f32 v15, v46, v47
    v_cvt_pk_bf16_f32 v16, v48, v49
    v_cvt_pk_bf16_f32 v17, v50, v51
    v_cvt_pk_bf16_f32 v18, v52, v53
    v_cvt_pk_bf16_f32 v19, v54, v55
    v_cvt_pk_bf16_f32 v20, v56, v57
    v_cvt_pk_bf16_f32 v21, v58, v59
    v_cvt_pk_bf16_f32 v22, v60, v61
    v_cvt_pk_bf16_f32 v23, v62, v63
    v_cvt_pk_bf16_f32 v24, v64, v65
    v_cvt_pk_bf16_f32 v25, v66, v67
    v_cvt_pk_bf16_f32 v26, v68, v69
    v_cvt_pk_bf16_f32 v27, v70, v71
    s_mul_i32 s36, s34, 20480
    s_mul_i32 s35, s33, 5120
    s_add_u32 s36, s36, s35
    s_add_u32 s36, s36, 29360128
    s_add_u32 s35, s36, 4096
    buffer_store_dwordx4 v[8:11], v5, s[8:11], s36 offen offset:0 sc1
    buffer_store_dwordx4 v[12:15], v5, s[8:11], s36 offen offset:1024 sc1
    buffer_store_dwordx4 v[16:19], v5, s[8:11], s36 offen offset:2048 sc1
    buffer_store_dwordx4 v[20:23], v5, s[8:11], s36 offen offset:3072 sc1
    buffer_store_dwordx4 v[24:27], v5, s[8:11], s35 offen offset:0 sc1
    s_mov_b32 s33, s92
    s_waitcnt vmcnt(0)
    s_barrier
    s_cmp_lg_u32 s21, 0
    s_cbranch_scc1 M_lw_bulk
    s_lshr_b32 s27, s34, 1
    s_lshl_b32 s27, s27, 7
    s_and_b32 s28, s34, 1
    s_mul_i32 s28, s28, 20
    s_add_u32 s27, s27, s28
    s_add_u32 s27, s27, 167936000
    v_lshrrev_b32 v12, 2, v0
    v_mov_b32 v13, 1
    s_mov_b64 exec, 31
    buffer_store_dword v13, v12, s[8:11], s27 offen sc1
    s_mov_b64 exec, -1
M_lw_bulk:
    v_lshrrev_b32 v12, 8, v0
    v_lshlrev_b32 v12, 16, v12
    v_and_b32 v14, 0xf0, v0
    v_add_u32 v12, v12, v14
    s_lshl_b32 s46, s22, 8
    s_lshl_b32 s27, s21, 13
    v_add_u32 v4, s27, v0
    v_add_u32 v5, 32768, v4
    s_mov_b32 s90, 5242880
    s_mov_b32 s91, 0x00020000
    s_cmp_eq_u32 s20, 2
    s_cselect_b64 s[88:89], s[76:77], s[72:73]
    s_cmp_eq_u32 s20, 3
    s_cselect_b64 s[88:89], s[80:81], s[88:89]
    s_cmp_lt_u32 s20, 4
    s_cbranch_scc1 M_bl_m
    s_mul_i32 s27, s21, 40960
    v_add_u32 v7, s27, v0
    v_lshrrev_b32 v8, 8, v0
    v_mul_u32_u24 v8, 40960, v8
    s_lshl_b32 s47, s22, 6
    s_add_u32 s47, s47, s21
    s_mul_i32 s47, s47, 2560
    v_and_b32 v14, 0xf0, v0
    v_add_u32 v8, v8, v14
    s_mov_b32 s44, 0x05040100
    s_mov_b32 s45, 0x07060302
    s_add_u32 s27, s47, 0
    buffer_load_dwordx4 v[16:19], v8, s[84:87], s27 offen
    s_add_u32 s27, s47, 1280
    buffer_load_dwordx4 v[20:23], v8, s[84:87], s27 offen
    s_add_u32 s27, s47, 10240
    buffer_load_dwordx4 v[24:27], v8, s[84:87], s27 offen
    s_add_u32 s27, s47, 11520
    buffer_load_dwordx4 v[28:31], v8, s[84:87], s27 offen
    s_add_u32 s27, s47, 20480
    buffer_load_dwordx4 v[32:35], v8, s[84:87], s27 offen
    s_add_u32 s27, s47, 21760
    buffer_load_dwordx4 v[36:39], v8, s[84:87], s27 offen
    s_add_u32 s27, s47, 30720
    buffer_load_dwordx4 v[40:43], v8, s[84:87], s27 offen
    s_add_u32 s27, s47, 32000
    buffer_load_dwordx4 v[44:47], v8, s[84:87], s27 offen
    s_add_u32 s27, s47, 256
    buffer_load_dwordx4 v[48:51], v8, s[84:87], s27 offen
    s_add_u32 s27, s47, 1536
    buffer_load_dwordx4 v[52:55], v8, s[84:87], s27 offen
    s_add_u32 s27, s47, 10496
    buffer_load_dwordx4 v[56:59], v8, s[84:87], s27 offen
    s_add_u32 s27, s47, 11776
    buffer_load_dwordx4 v[60:63], v8, s[84:87], s27 offen
    s_add_u32 s27, s47, 20736
    buffer_load_dwordx4 v[64:67], v8, s[84:87], s27 offen
    s_add_u32 s27, s47, 22016
    buffer_load_dwordx4 v[68:71], v8, s[84:87], s27 offen
    s_add_u32 s27, s47, 30976
    buffer_load_dwordx4 v[72:75], v8, s[84:87], s27 offen
    s_add_u32 s27, s47, 32256
    buffer_load_dwordx4 v[76:79], v8, s[84:87], s27 offen
    v_and_b32 v13, 0x300, v0
    s_lshl_b32 s27, s21, 10
    s_add_u32 s27, s27, 0
    v_add_u32 v13, s27, v13
    v_bfe_u32 v14, v0, 6, 2
    v_lshl_add_u32 v13, v14, 13, v13
    v_bfe_u32 v14, v0, 4, 2
    v_lshl_add_u32 v13, v14, 6, v13
    s_waitcnt vmcnt(14)
    v_perm_b32 v80, v20, v16, s44
    s_waitcnt vmcnt(12)
    v_perm_b32 v81, v28, v24, s44
    s_waitcnt vmcnt(10)
    v_perm_b32 v82, v36, v32, s44
    s_waitcnt vmcnt(8)
    v_perm_b32 v83, v44, v40, s44
    ds_write_b128 v13, v[80:83] offset:0
    v_perm_b32 v84, v20, v16, s45
    v_perm_b32 v85, v28, v24, s45
    v_perm_b32 v86, v36, v32, s45
    v_perm_b32 v87, v44, v40, s45
    ds_write_b128 v13, v[84:87] offset:16
    v_perm_b32 v80, v21, v17, s44
    v_perm_b32 v81, v29, v25, s44
    v_perm_b32 v82, v37, v33, s44
    v_perm_b32 v83, v45, v41, s44
    ds_write_b128 v13, v[80:83] offset:32
    v_perm_b32 v84, v21, v17, s45
    v_perm_b32 v85, v29, v25, s45
    v_perm_b32 v86, v37, v33, s45
    v_perm_b32 v87, v45, v41, s45
    ds_write_b128 v13, v[84:87] offset:48
    v_perm_b32 v80, v22, v18, s44
    v_perm_b32 v81, v30, v26, s44
    v_perm_b32 v82, v38, v34, s44
    v_perm_b32 v83, v46, v42, s44
    ds_write_b128 v13, v[80:83] offset:4096
    v_perm_b32 v84, v22, v18, s45
    v_perm_b32 v85, v30, v26, s45
    v_perm_b32 v86, v38, v34, s45
    v_perm_b32 v87, v46, v42, s45
    ds_write_b128 v13, v[84:87] offset:4112
    v_perm_b32 v80, v23, v19, s44
    v_perm_b32 v81, v31, v27, s44
    v_perm_b32 v82, v39, v35, s44
    v_perm_b32 v83, v47, v43, s44
    ds_write_b128 v13, v[80:83] offset:4128
    v_perm_b32 v84, v23, v19, s45
    v_perm_b32 v85, v31, v27, s45
    v_perm_b32 v86, v39, v35, s45
    v_perm_b32 v87, v47, v43, s45
    ds_write_b128 v13, v[84:87] offset:4144
    s_add_u32 s27, s47, 512
    buffer_load_dwordx4 v[16:19], v8, s[84:87], s27 offen
    s_add_u32 s27, s47, 1792
    buffer_load_dwordx4 v[20:23], v8, s[84:87], s27 offen
    s_add_u32 s27, s47, 10752
    buffer_load_dwordx4 v[24:27], v8, s[84:87], s27 offen
    s_add_u32 s27, s47, 12032
    buffer_load_dwordx4 v[28:31], v8, s[84:87], s27 offen
    s_add_u32 s27, s47, 20992
    buffer_load_dwordx4 v[32:35], v8, s[84:87], s27 offen
    s_add_u32 s27, s47, 22272
    buffer_load_dwordx4 v[36:39], v8, s[84:87], s27 offen
    s_add_u32 s27, s47, 31232
    buffer_load_dwordx4 v[40:43], v8, s[84:87], s27 offen
    s_add_u32 s27, s47, 32512
    buffer_load_dwordx4 v[44:47], v8, s[84:87], s27 offen
    v_and_b32 v13, 0x300, v0
    s_lshl_b32 s27, s21, 10
    s_add_u32 s27, s27, 32768
    v_add_u32 v13, s27, v13
    v_bfe_u32 v14, v0, 6, 2
    v_lshl_add_u32 v13, v14, 13, v13
    v_bfe_u32 v14, v0, 4, 2
    v_lshl_add_u32 v13, v14, 6, v13
    s_waitcnt vmcnt(14)
    v_perm_b32 v80, v52, v48, s44
    s_waitcnt vmcnt(12)
    v_perm_b32 v81, v60, v56, s44
    s_waitcnt vmcnt(10)
    v_perm_b32 v82, v68, v64, s44
    s_waitcnt vmcnt(8)
    v_perm_b32 v83, v76, v72, s44
    ds_write_b128 v13, v[80:83] offset:0
    v_perm_b32 v84, v52, v48, s45
    v_perm_b32 v85, v60, v56, s45
    v_perm_b32 v86, v68, v64, s45
    v_perm_b32 v87, v76, v72, s45
    ds_write_b128 v13, v[84:87] offset:16
    v_perm_b32 v80, v53, v49, s44
    v_perm_b32 v81, v61, v57, s44
    v_perm_b32 v82, v69, v65, s44
    v_perm_b32 v83, v77, v73, s44
    ds_write_b128 v13, v[80:83] offset:32
    v_perm_b32 v84, v53, v49, s45
    v_perm_b32 v85, v61, v57, s45
    v_perm_b32 v86, v69, v65, s45
    v_perm_b32 v87, v77, v73, s45
    ds_write_b128 v13, v[84:87] offset:48
    v_perm_b32 v80, v54, v50, s44
    v_perm_b32 v81, v62, v58, s44
    v_perm_b32 v82, v70, v66, s44
    v_perm_b32 v83, v78, v74, s44
    ds_write_b128 v13, v[80:83] offset:4096
    v_perm_b32 v84, v54, v50, s45
    v_perm_b32 v85, v62, v58, s45
    v_perm_b32 v86, v70, v66, s45
    v_perm_b32 v87, v78, v74, s45
    ds_write_b128 v13, v[84:87] offset:4112
    v_perm_b32 v80, v55, v51, s44
    v_perm_b32 v81, v63, v59, s44
    v_perm_b32 v82, v71, v67, s44
    v_perm_b32 v83, v79, v75, s44
    ds_write_b128 v13, v[80:83] offset:4128
    v_perm_b32 v84, v55, v51, s45
    v_perm_b32 v85, v63, v59, s45
    v_perm_b32 v86, v71, v67, s45
    v_perm_b32 v87, v79, v75, s45
    ds_write_b128 v13, v[84:87] offset:4144
    s_add_u32 s27, s47, 768
    buffer_load_dwordx4 v[48:51], v8, s[84:87], s27 offen
    s_add_u32 s27, s47, 2048
    buffer_load_dwordx4 v[52:55], v8, s[84:87], s27 offen
    s_add_u32 s27, s47, 11008
    buffer_load_dwordx4 v[56:59], v8, s[84:87], s27 offen
    s_add_u32 s27, s47, 12288
    buffer_load_dwordx4 v[60:63], v8, s[84:87], s27 offen
    s_add_u32 s27, s47, 21248
    buffer_load_dwordx4 v[64:67], v8, s[84:87], s27 offen
    s_add_u32 s27, s47, 22528
    buffer_load_dwordx4 v[68:71], v8, s[84:87], s27 offen
    s_add_u32 s27, s47, 31488
    buffer_load_dwordx4 v[72:75], v8, s[84:87], s27 offen
    s_add_u32 s27, s47, 32768
    buffer_load_dwordx4 v[76:79], v8, s[84:87], s27 offen
    v_and_b32 v13, 0x300, v0
    s_lshl_b32 s27, s21, 10
    s_add_u32 s27, s27, 65536
    v_add_u32 v13, s27, v13
    v_bfe_u32 v14, v0, 6, 2
    v_lshl_add_u32 v13, v14, 13, v13
    v_bfe_u32 v14, v0, 4, 2
    v_lshl_add_u32 v13, v14, 6, v13
    s_waitcnt vmcnt(14)
    v_perm_b32 v80, v20, v16, s44
    s_waitcnt vmcnt(12)
    v_perm_b32 v81, v28, v24, s44
    s_waitcnt vmcnt(10)
    v_perm_b32 v82, v36, v32, s44
    s_waitcnt vmcnt(8)
    v_perm_b32 v83, v44, v40, s44
    ds_write_b128 v13, v[80:83] offset:0
    v_perm_b32 v84, v20, v16, s45
    v_perm_b32 v85, v28, v24, s45
    v_perm_b32 v86, v36, v32, s45
    v_perm_b32 v87, v44, v40, s45
    ds_write_b128 v13, v[84:87] offset:16
    v_perm_b32 v80, v21, v17, s44
    v_perm_b32 v81, v29, v25, s44
    v_perm_b32 v82, v37, v33, s44
    v_perm_b32 v83, v45, v41, s44
    ds_write_b128 v13, v[80:83] offset:32
    v_perm_b32 v84, v21, v17, s45
    v_perm_b32 v85, v29, v25, s45
    v_perm_b32 v86, v37, v33, s45
    v_perm_b32 v87, v45, v41, s45
    ds_write_b128 v13, v[84:87] offset:48
    v_perm_b32 v80, v22, v18, s44
    v_perm_b32 v81, v30, v26, s44
    v_perm_b32 v82, v38, v34, s44
    v_perm_b32 v83, v46, v42, s44
    ds_write_b128 v13, v[80:83] offset:4096
    v_perm_b32 v84, v22, v18, s45
    v_perm_b32 v85, v30, v26, s45
    v_perm_b32 v86, v38, v34, s45
    v_perm_b32 v87, v46, v42, s45
    ds_write_b128 v13, v[84:87] offset:4112
    v_perm_b32 v80, v23, v19, s44
    v_perm_b32 v81, v31, v27, s44
    v_perm_b32 v82, v39, v35, s44
    v_perm_b32 v83, v47, v43, s44
    ds_write_b128 v13, v[80:83] offset:4128
    v_perm_b32 v84, v23, v19, s45
    v_perm_b32 v85, v31, v27, s45
    v_perm_b32 v86, v39, v35, s45
    v_perm_b32 v87, v47, v43, s45
    ds_write_b128 v13, v[84:87] offset:4144
    s_add_u32 s27, s47, 1024
    buffer_load_dwordx4 v[16:19], v8, s[84:87], s27 offen
    s_add_u32 s27, s47, 2304
    buffer_load_dwordx4 v[20:23], v8, s[84:87], s27 offen
    s_add_u32 s27, s47, 11264
    buffer_load_dwordx4 v[24:27], v8, s[84:87], s27 offen
    s_add_u32 s27, s47, 12544
    buffer_load_dwordx4 v[28:31], v8, s[84:87], s27 offen
    s_add_u32 s27, s47, 21504
    buffer_load_dwordx4 v[32:35], v8, s[84:87], s27 offen
    s_add_u32 s27, s47, 22784
    buffer_load_dwordx4 v[36:39], v8, s[84:87], s27 offen
    s_add_u32 s27, s47, 31744
    buffer_load_dwordx4 v[40:43], v8, s[84:87], s27 offen
    s_add_u32 s27, s47, 33024
    buffer_load_dwordx4 v[44:47], v8, s[84:87], s27 offen
    v_and_b32 v13, 0x300, v0
    s_lshl_b32 s27, s21, 10
    s_add_u32 s27, s27, 98304
    v_add_u32 v13, s27, v13
    v_bfe_u32 v14, v0, 6, 2
    v_lshl_add_u32 v13, v14, 13, v13
    v_bfe_u32 v14, v0, 4, 2
    v_lshl_add_u32 v13, v14, 6, v13
    s_waitcnt vmcnt(14)
    v_perm_b32 v80, v52, v48, s44
    s_waitcnt vmcnt(12)
    v_perm_b32 v81, v60, v56, s44
    s_waitcnt vmcnt(10)
    v_perm_b32 v82, v68, v64, s44
    s_waitcnt vmcnt(8)
    v_perm_b32 v83, v76, v72, s44
    ds_write_b128 v13, v[80:83] offset:0
    v_perm_b32 v84, v52, v48, s45
    v_perm_b32 v85, v60, v56, s45
    v_perm_b32 v86, v68, v64, s45
    v_perm_b32 v87, v76, v72, s45
    ds_write_b128 v13, v[84:87] offset:16
    v_perm_b32 v80, v53, v49, s44
    v_perm_b32 v81, v61, v57, s44
    v_perm_b32 v82, v69, v65, s44
    v_perm_b32 v83, v77, v73, s44
    ds_write_b128 v13, v[80:83] offset:32
    v_perm_b32 v84, v53, v49, s45
    v_perm_b32 v85, v61, v57, s45
    v_perm_b32 v86, v69, v65, s45
    v_perm_b32 v87, v77, v73, s45
    ds_write_b128 v13, v[84:87] offset:48
    v_perm_b32 v80, v54, v50, s44
    v_perm_b32 v81, v62, v58, s44
    v_perm_b32 v82, v70, v66, s44
    v_perm_b32 v83, v78, v74, s44
    ds_write_b128 v13, v[80:83] offset:4096
    v_perm_b32 v84, v54, v50, s45
    v_perm_b32 v85, v62, v58, s45
    v_perm_b32 v86, v70, v66, s45
    v_perm_b32 v87, v78, v74, s45
    ds_write_b128 v13, v[84:87] offset:4112
    v_perm_b32 v80, v55, v51, s44
    v_perm_b32 v81, v63, v59, s44
    v_perm_b32 v82, v71, v67, s44
    v_perm_b32 v83, v79, v75, s44
    ds_write_b128 v13, v[80:83] offset:4128
    v_perm_b32 v84, v55, v51, s45
    v_perm_b32 v85, v63, v59, s45
    v_perm_b32 v86, v71, v67, s45
    v_perm_b32 v87, v79, v75, s45
    ds_write_b128 v13, v[84:87] offset:4144
    v_and_b32 v13, 0x300, v0
    s_lshl_b32 s27, s21, 10
    s_add_u32 s27, s27, 131072
    v_add_u32 v13, s27, v13
    v_bfe_u32 v14, v0, 6, 2
    v_lshl_add_u32 v13, v14, 13, v13
    v_bfe_u32 v14, v0, 4, 2
    v_lshl_add_u32 v13, v14, 6, v13
    s_waitcnt vmcnt(6)
    v_perm_b32 v80, v20, v16, s44
    s_waitcnt vmcnt(4)
    v_perm_b32 v81, v28, v24, s44
    s_waitcnt vmcnt(2)
    v_perm_b32 v82, v36, v32, s44
    s_waitcnt vmcnt(0)
    v_perm_b32 v83, v44, v40, s44
    ds_write_b128 v13, v[80:83] offset:0
    v_perm_b32 v84, v20, v16, s45
    v_perm_b32 v85, v28, v24, s45
    v_perm_b32 v86, v36, v32, s45
    v_perm_b32 v87, v44, v40, s45
    ds_write_b128 v13, v[84:87] offset:16
    v_perm_b32 v80, v21, v17, s44
    v_perm_b32 v81, v29, v25, s44
    v_perm_b32 v82, v37, v33, s44
    v_perm_b32 v83, v45, v41, s44
    ds_write_b128 v13, v[80:83] offset:32
    v_perm_b32 v84, v21, v17, s45
    v_perm_b32 v85, v29, v25, s45
    v_perm_b32 v86, v37, v33, s45
    v_perm_b32 v87, v45, v41, s45
    ds_write_b128 v13, v[84:87] offset:48
    v_perm_b32 v80, v22, v18, s44
    v_perm_b32 v81, v30, v26, s44
    v_perm_b32 v82, v38, v34, s44
    v_perm_b32 v83, v46, v42, s44
    ds_write_b128 v13, v[80:83] offset:4096
    v_perm_b32 v84, v22, v18, s45
    v_perm_b32 v85, v30, v26, s45
    v_perm_b32 v86, v38, v34, s45
    v_perm_b32 v87, v46, v42, s45
    ds_write_b128 v13, v[84:87] offset:4112
    v_perm_b32 v80, v23, v19, s44
    v_perm_b32 v81, v31, v27, s44
    v_perm_b32 v82, v39, v35, s44
    v_perm_b32 v83, v47, v43, s44
    ds_write_b128 v13, v[80:83] offset:4128
    v_perm_b32 v84, v23, v19, s45
    v_perm_b32 v85, v31, v27, s45
    v_perm_b32 v86, v39, v35, s45
    v_perm_b32 v87, v47, v43, s45
    ds_write_b128 v13, v[84:87] offset:4144
    s_waitcnt lgkmcnt(0)
    s_barrier
    ds_read_b128 a[160:163], v7 offset:0
    ds_read_b128 a[164:167], v7 offset:1024
    ds_read_b128 a[168:171], v7 offset:2048
    ds_read_b128 a[172:175], v7 offset:3072
    ds_read_b128 a[176:179], v7 offset:4096
    ds_read_b128 a[180:183], v7 offset:5120
    ds_read_b128 a[184:187], v7 offset:6144
    ds_read_b128 a[188:191], v7 offset:7168
    ds_read_b128 a[192:195], v7 offset:8192
    ds_read_b128 a[196:199], v7 offset:9216
    ds_read_b128 a[200:203], v7 offset:10240
    ds_read_b128 a[204:207], v7 offset:11264
    ds_read_b128 a[208:211], v7 offset:12288
    ds_read_b128 a[212:215], v7 offset:13312
    ds_read_b128 a[216:219], v7 offset:14336
    ds_read_b128 a[220:223], v7 offset:15360
    ds_read_b128 a[224:227], v7 offset:16384
    ds_read_b128 a[228:231], v7 offset:17408
    ds_read_b128 a[232:235], v7 offset:18432
    ds_read_b128 a[236:239], v7 offset:19456
    ds_read_b128 a[240:243], v7 offset:20480
    ds_read_b128 a[244:247], v7 offset:21504
    ds_read_b128 a[248:251], v7 offset:22528
    ds_read_b128 a[252:255], v7 offset:23552
    ds_read_b128 v[192:195], v7 offset:24576
    ds_read_b128 v[196:199], v7 offset:25600
    ds_read_b128 v[200:203], v7 offset:26624
    ds_read_b128 v[204:207], v7 offset:27648
    ds_read_b128 v[208:211], v7 offset:28672
    ds_read_b128 v[212:215], v7 offset:29696
    ds_read_b128 v[216:219], v7 offset:30720
    ds_read_b128 v[220:223], v7 offset:31744
    ds_read_b128 v[224:227], v7 offset:32768
    ds_read_b128 v[228:231], v7 offset:33792
    ds_read_b128 v[232:235], v7 offset:34816
    ds_read_b128 v[236:239], v7 offset:35840
    ds_read_b128 v[240:243], v7 offset:36864
    ds_read_b128 v[244:247], v7 offset:37888
    ds_read_b128 v[248:251], v7 offset:38912
    ds_read_b128 v[252:255], v7 offset:39936
    s_waitcnt lgkmcnt(0)
    s_barrier
M_bl_m:
    s_mov_b32 s44, 0x05040100
    s_mov_b32 s45, 0x07060302
    s_add_u32 s26, s21, 0
    s_lshl_b32 s27, s26, 18
    s_add_u32 s27, s27, s46
    buffer_load_dwordx4 v[16:19], v12, s[88:91], s27 offen
    s_add_u32 s27, s27, 8192
    buffer_load_dwordx4 v[20:23], v12, s[88:91], s27 offen
    s_add_u32 s27, s27, 8192
    buffer_load_dwordx4 v[24:27], v12, s[88:91], s27 offen
    s_add_u32 s27, s27, 8192
    buffer_load_dwordx4 v[28:31], v12, s[88:91], s27 offen
    s_add_u32 s27, s27, 8192
    buffer_load_dwordx4 v[32:35], v12, s[88:91], s27 offen
    s_add_u32 s27, s27, 8192
    buffer_load_dwordx4 v[36:39], v12, s[88:91], s27 offen
    s_add_u32 s27, s27, 8192
    buffer_load_dwordx4 v[40:43], v12, s[88:91], s27 offen
    s_add_u32 s27, s27, 8192
    buffer_load_dwordx4 v[44:47], v12, s[88:91], s27 offen
    s_add_u32 s26, s21, 4
    s_lshl_b32 s27, s26, 18
    s_add_u32 s27, s27, s46
    buffer_load_dwordx4 v[48:51], v12, s[88:91], s27 offen
    s_add_u32 s27, s27, 8192
    buffer_load_dwordx4 v[52:55], v12, s[88:91], s27 offen
    s_add_u32 s27, s27, 8192
    buffer_load_dwordx4 v[56:59], v12, s[88:91], s27 offen
    s_add_u32 s27, s27, 8192
    buffer_load_dwordx4 v[60:63], v12, s[88:91], s27 offen
    s_add_u32 s27, s27, 8192
    buffer_load_dwordx4 v[64:67], v12, s[88:91], s27 offen
    s_add_u32 s27, s27, 8192
    buffer_load_dwordx4 v[68:71], v12, s[88:91], s27 offen
    s_add_u32 s27, s27, 8192
    buffer_load_dwordx4 v[72:75], v12, s[88:91], s27 offen
    s_add_u32 s27, s27, 8192
    buffer_load_dwordx4 v[76:79], v12, s[88:91], s27 offen
    s_lshl_b32 s27, s21, 11
    s_add_u32 s27, s27, 0
    v_add_u32 v13, s27, v0
    s_waitcnt vmcnt(14)
    v_perm_b32 v80, v20, v16, s44
    s_waitcnt vmcnt(12)
    v_perm_b32 v81, v28, v24, s44
    s_waitcnt vmcnt(10)
    v_perm_b32 v82, v36, v32, s44
    s_waitcnt vmcnt(8)
    v_perm_b32 v83, v44, v40, s44
    ds_write_b128 v13, v[80:83] offset:0
    v_perm_b32 v84, v20, v16, s45
    v_perm_b32 v85, v28, v24, s45
    v_perm_b32 v86, v36, v32, s45
    v_perm_b32 v87, v44, v40, s45
    ds_write_b128 v13, v[84:87] offset:1024
    v_perm_b32 v80, v21, v17, s44
    v_perm_b32 v81, v29, v25, s44
    v_perm_b32 v82, v37, v33, s44
    v_perm_b32 v83, v45, v41, s44
    ds_write_b128 v13, v[80:83] offset:8192
    v_perm_b32 v84, v21, v17, s45
    v_perm_b32 v85, v29, v25, s45
    v_perm_b32 v86, v37, v33, s45
    v_perm_b32 v87, v45, v41, s45
    ds_write_b128 v13, v[84:87] offset:9216
    v_perm_b32 v80, v22, v18, s44
    v_perm_b32 v81, v30, v26, s44
    v_perm_b32 v82, v38, v34, s44
    v_perm_b32 v83, v46, v42, s44
    ds_write_b128 v13, v[80:83] offset:16384
    v_perm_b32 v84, v22, v18, s45
    v_perm_b32 v85, v30, v26, s45
    v_perm_b32 v86, v38, v34, s45
    v_perm_b32 v87, v46, v42, s45
    ds_write_b128 v13, v[84:87] offset:17408
    v_perm_b32 v80, v23, v19, s44
    v_perm_b32 v81, v31, v27, s44
    v_perm_b32 v82, v39, v35, s44
    v_perm_b32 v83, v47, v43, s44
    ds_write_b128 v13, v[80:83] offset:24576
    v_perm_b32 v84, v23, v19, s45
    v_perm_b32 v85, v31, v27, s45
    v_perm_b32 v86, v39, v35, s45
    v_perm_b32 v87, v47, v43, s45
    ds_write_b128 v13, v[84:87] offset:25600
    s_add_u32 s26, s21, 8
    s_lshl_b32 s27, s26, 18
    s_add_u32 s27, s27, s46
    buffer_load_dwordx4 v[16:19], v12, s[88:91], s27 offen
    s_add_u32 s27, s27, 8192
    buffer_load_dwordx4 v[20:23], v12, s[88:91], s27 offen
    s_add_u32 s27, s27, 8192
    buffer_load_dwordx4 v[24:27], v12, s[88:91], s27 offen
    s_add_u32 s27, s27, 8192
    buffer_load_dwordx4 v[28:31], v12, s[88:91], s27 offen
    s_add_u32 s27, s27, 8192
    buffer_load_dwordx4 v[32:35], v12, s[88:91], s27 offen
    s_add_u32 s27, s27, 8192
    buffer_load_dwordx4 v[36:39], v12, s[88:91], s27 offen
    s_add_u32 s27, s27, 8192
    buffer_load_dwordx4 v[40:43], v12, s[88:91], s27 offen
    s_add_u32 s27, s27, 8192
    buffer_load_dwordx4 v[44:47], v12, s[88:91], s27 offen
    s_waitcnt lgkmcnt(0)
    s_barrier
    ds_read_b128 a[0:3], v4 offset:0
    ds_read_b128 a[80:83], v4 offset:1024
    ds_read_b128 a[4:7], v4 offset:2048
    ds_read_b128 a[84:87], v4 offset:3072
    ds_read_b128 a[8:11], v4 offset:4096
    ds_read_b128 a[88:91], v4 offset:5120
    ds_read_b128 a[12:15], v4 offset:6144
    ds_read_b128 a[92:95], v4 offset:7168
    s_lshl_b32 s27, s21, 11
    s_add_u32 s27, s27, 32768
    v_add_u32 v13, s27, v0
    s_waitcnt vmcnt(14)
    v_perm_b32 v80, v52, v48, s44
    s_waitcnt vmcnt(12)
    v_perm_b32 v81, v60, v56, s44
    s_waitcnt vmcnt(10)
    v_perm_b32 v82, v68, v64, s44
    s_waitcnt vmcnt(8)
    v_perm_b32 v83, v76, v72, s44
    ds_write_b128 v13, v[80:83] offset:0
    v_perm_b32 v84, v52, v48, s45
    v_perm_b32 v85, v60, v56, s45
    v_perm_b32 v86, v68, v64, s45
    v_perm_b32 v87, v76, v72, s45
    ds_write_b128 v13, v[84:87] offset:1024
    v_perm_b32 v80, v53, v49, s44
    v_perm_b32 v81, v61, v57, s44
    v_perm_b32 v82, v69, v65, s44
    v_perm_b32 v83, v77, v73, s44
    ds_write_b128 v13, v[80:83] offset:8192
    v_perm_b32 v84, v53, v49, s45
    v_perm_b32 v85, v61, v57, s45
    v_perm_b32 v86, v69, v65, s45
    v_perm_b32 v87, v77, v73, s45
    ds_write_b128 v13, v[84:87] offset:9216
    v_perm_b32 v80, v54, v50, s44
    v_perm_b32 v81, v62, v58, s44
    v_perm_b32 v82, v70, v66, s44
    v_perm_b32 v83, v78, v74, s44
    ds_write_b128 v13, v[80:83] offset:16384
    v_perm_b32 v84, v54, v50, s45
    v_perm_b32 v85, v62, v58, s45
    v_perm_b32 v86, v70, v66, s45
    v_perm_b32 v87, v78, v74, s45
    ds_write_b128 v13, v[84:87] offset:17408
    v_perm_b32 v80, v55, v51, s44
    v_perm_b32 v81, v63, v59, s44
    v_perm_b32 v82, v71, v67, s44
    v_perm_b32 v83, v79, v75, s44
    ds_write_b128 v13, v[80:83] offset:24576
    v_perm_b32 v84, v55, v51, s45
    v_perm_b32 v85, v63, v59, s45
    v_perm_b32 v86, v71, v67, s45
    v_perm_b32 v87, v79, v75, s45
    ds_write_b128 v13, v[84:87] offset:25600
    s_add_u32 s26, s21, 12
    s_lshl_b32 s27, s26, 18
    s_add_u32 s27, s27, s46
    buffer_load_dwordx4 v[48:51], v12, s[88:91], s27 offen
    s_add_u32 s27, s27, 8192
    buffer_load_dwordx4 v[52:55], v12, s[88:91], s27 offen
    s_add_u32 s27, s27, 8192
    buffer_load_dwordx4 v[56:59], v12, s[88:91], s27 offen
    s_add_u32 s27, s27, 8192
    buffer_load_dwordx4 v[60:63], v12, s[88:91], s27 offen
    s_add_u32 s27, s27, 8192
    buffer_load_dwordx4 v[64:67], v12, s[88:91], s27 offen
    s_add_u32 s27, s27, 8192
    buffer_load_dwordx4 v[68:71], v12, s[88:91], s27 offen
    s_add_u32 s27, s27, 8192
    buffer_load_dwordx4 v[72:75], v12, s[88:91], s27 offen
    s_add_u32 s27, s27, 8192
    buffer_load_dwordx4 v[76:79], v12, s[88:91], s27 offen
    s_waitcnt lgkmcnt(0)
    s_barrier
    ds_read_b128 a[16:19], v5 offset:0
    ds_read_b128 a[96:99], v5 offset:1024
    ds_read_b128 a[20:23], v5 offset:2048
    ds_read_b128 a[100:103], v5 offset:3072
    ds_read_b128 a[24:27], v5 offset:4096
    ds_read_b128 a[104:107], v5 offset:5120
    ds_read_b128 a[28:31], v5 offset:6144
    ds_read_b128 a[108:111], v5 offset:7168
    s_lshl_b32 s27, s21, 11
    s_add_u32 s27, s27, 0
    v_add_u32 v13, s27, v0
    s_waitcnt vmcnt(14)
    v_perm_b32 v80, v20, v16, s44
    s_waitcnt vmcnt(12)
    v_perm_b32 v81, v28, v24, s44
    s_waitcnt vmcnt(10)
    v_perm_b32 v82, v36, v32, s44
    s_waitcnt vmcnt(8)
    v_perm_b32 v83, v44, v40, s44
    ds_write_b128 v13, v[80:83] offset:0
    v_perm_b32 v84, v20, v16, s45
    v_perm_b32 v85, v28, v24, s45
    v_perm_b32 v86, v36, v32, s45
    v_perm_b32 v87, v44, v40, s45
    ds_write_b128 v13, v[84:87] offset:1024
    v_perm_b32 v80, v21, v17, s44
    v_perm_b32 v81, v29, v25, s44
    v_perm_b32 v82, v37, v33, s44
    v_perm_b32 v83, v45, v41, s44
    ds_write_b128 v13, v[80:83] offset:8192
    v_perm_b32 v84, v21, v17, s45
    v_perm_b32 v85, v29, v25, s45
    v_perm_b32 v86, v37, v33, s45
    v_perm_b32 v87, v45, v41, s45
    ds_write_b128 v13, v[84:87] offset:9216
    v_perm_b32 v80, v22, v18, s44
    v_perm_b32 v81, v30, v26, s44
    v_perm_b32 v82, v38, v34, s44
    v_perm_b32 v83, v46, v42, s44
    ds_write_b128 v13, v[80:83] offset:16384
    v_perm_b32 v84, v22, v18, s45
    v_perm_b32 v85, v30, v26, s45
    v_perm_b32 v86, v38, v34, s45
    v_perm_b32 v87, v46, v42, s45
    ds_write_b128 v13, v[84:87] offset:17408
    v_perm_b32 v80, v23, v19, s44
    v_perm_b32 v81, v31, v27, s44
    v_perm_b32 v82, v39, v35, s44
    v_perm_b32 v83, v47, v43, s44
    ds_write_b128 v13, v[80:83] offset:24576
    v_perm_b32 v84, v23, v19, s45
    v_perm_b32 v85, v31, v27, s45
    v_perm_b32 v86, v39, v35, s45
    v_perm_b32 v87, v47, v43, s45
    ds_write_b128 v13, v[84:87] offset:25600
    s_add_u32 s26, s21, 16
    s_lshl_b32 s27, s26, 18
    s_add_u32 s27, s27, s46
    buffer_load_dwordx4 v[16:19], v12, s[88:91], s27 offen
    s_add_u32 s27, s27, 8192
    buffer_load_dwordx4 v[20:23], v12, s[88:91], s27 offen
    s_add_u32 s27, s27, 8192
    buffer_load_dwordx4 v[24:27], v12, s[88:91], s27 offen
    s_add_u32 s27, s27, 8192
    buffer_load_dwordx4 v[28:31], v12, s[88:91], s27 offen
    s_add_u32 s27, s27, 8192
    buffer_load_dwordx4 v[32:35], v12, s[88:91], s27 offen
    s_add_u32 s27, s27, 8192
    buffer_load_dwordx4 v[36:39], v12, s[88:91], s27 offen
    s_add_u32 s27, s27, 8192
    buffer_load_dwordx4 v[40:43], v12, s[88:91], s27 offen
    s_add_u32 s27, s27, 8192
    buffer_load_dwordx4 v[44:47], v12, s[88:91], s27 offen
    s_waitcnt lgkmcnt(0)
    s_barrier
    ds_read_b128 a[32:35], v4 offset:0
    ds_read_b128 a[112:115], v4 offset:1024
    ds_read_b128 a[36:39], v4 offset:2048
    ds_read_b128 a[116:119], v4 offset:3072
    ds_read_b128 a[40:43], v4 offset:4096
    ds_read_b128 a[120:123], v4 offset:5120
    ds_read_b128 a[44:47], v4 offset:6144
    ds_read_b128 a[124:127], v4 offset:7168
    s_lshl_b32 s27, s21, 11
    s_add_u32 s27, s27, 32768
    v_add_u32 v13, s27, v0
    s_waitcnt vmcnt(14)
    v_perm_b32 v80, v52, v48, s44
    s_waitcnt vmcnt(12)
    v_perm_b32 v81, v60, v56, s44
    s_waitcnt vmcnt(10)
    v_perm_b32 v82, v68, v64, s44
    s_waitcnt vmcnt(8)
    v_perm_b32 v83, v76, v72, s44
    ds_write_b128 v13, v[80:83] offset:0
    v_perm_b32 v84, v52, v48, s45
    v_perm_b32 v85, v60, v56, s45
    v_perm_b32 v86, v68, v64, s45
    v_perm_b32 v87, v76, v72, s45
    ds_write_b128 v13, v[84:87] offset:1024
    v_perm_b32 v80, v53, v49, s44
    v_perm_b32 v81, v61, v57, s44
    v_perm_b32 v82, v69, v65, s44
    v_perm_b32 v83, v77, v73, s44
    ds_write_b128 v13, v[80:83] offset:8192
    v_perm_b32 v84, v53, v49, s45
    v_perm_b32 v85, v61, v57, s45
    v_perm_b32 v86, v69, v65, s45
    v_perm_b32 v87, v77, v73, s45
    ds_write_b128 v13, v[84:87] offset:9216
    v_perm_b32 v80, v54, v50, s44
    v_perm_b32 v81, v62, v58, s44
    v_perm_b32 v82, v70, v66, s44
    v_perm_b32 v83, v78, v74, s44
    ds_write_b128 v13, v[80:83] offset:16384
    v_perm_b32 v84, v54, v50, s45
    v_perm_b32 v85, v62, v58, s45
    v_perm_b32 v86, v70, v66, s45
    v_perm_b32 v87, v78, v74, s45
    ds_write_b128 v13, v[84:87] offset:17408
    v_perm_b32 v80, v55, v51, s44
    v_perm_b32 v81, v63, v59, s44
    v_perm_b32 v82, v71, v67, s44
    v_perm_b32 v83, v79, v75, s44
    ds_write_b128 v13, v[80:83] offset:24576
    v_perm_b32 v84, v55, v51, s45
    v_perm_b32 v85, v63, v59, s45
    v_perm_b32 v86, v71, v67, s45
    v_perm_b32 v87, v79, v75, s45
    ds_write_b128 v13, v[84:87] offset:25600
    s_waitcnt lgkmcnt(0)
    s_barrier
    ds_read_b128 a[48:51], v5 offset:0
    ds_read_b128 a[128:131], v5 offset:1024
    ds_read_b128 a[52:55], v5 offset:2048
    ds_read_b128 a[132:135], v5 offset:3072
    ds_read_b128 a[56:59], v5 offset:4096
    ds_read_b128 a[136:139], v5 offset:5120
    ds_read_b128 a[60:63], v5 offset:6144
    ds_read_b128 a[140:143], v5 offset:7168
    s_lshl_b32 s27, s21, 11
    s_add_u32 s27, s27, 0
    v_add_u32 v13, s27, v0
    s_waitcnt vmcnt(6)
    v_perm_b32 v80, v20, v16, s44
    s_waitcnt vmcnt(4)
    v_perm_b32 v81, v28, v24, s44
    s_waitcnt vmcnt(2)
    v_perm_b32 v82, v36, v32, s44
    s_waitcnt vmcnt(0)
    v_perm_b32 v83, v44, v40, s44
    ds_write_b128 v13, v[80:83] offset:0
    v_perm_b32 v84, v20, v16, s45
    v_perm_b32 v85, v28, v24, s45
    v_perm_b32 v86, v36, v32, s45
    v_perm_b32 v87, v44, v40, s45
    ds_write_b128 v13, v[84:87] offset:1024
    v_perm_b32 v80, v21, v17, s44
    v_perm_b32 v81, v29, v25, s44
    v_perm_b32 v82, v37, v33, s44
    v_perm_b32 v83, v45, v41, s44
    ds_write_b128 v13, v[80:83] offset:8192
    v_perm_b32 v84, v21, v17, s45
    v_perm_b32 v85, v29, v25, s45
    v_perm_b32 v86, v37, v33, s45
    v_perm_b32 v87, v45, v41, s45
    ds_write_b128 v13, v[84:87] offset:9216
    v_perm_b32 v80, v22, v18, s44
    v_perm_b32 v81, v30, v26, s44
    v_perm_b32 v82, v38, v34, s44
    v_perm_b32 v83, v46, v42, s44
    ds_write_b128 v13, v[80:83] offset:16384
    v_perm_b32 v84, v22, v18, s45
    v_perm_b32 v85, v30, v26, s45
    v_perm_b32 v86, v38, v34, s45
    v_perm_b32 v87, v46, v42, s45
    ds_write_b128 v13, v[84:87] offset:17408
    v_perm_b32 v80, v23, v19, s44
    v_perm_b32 v81, v31, v27, s44
    v_perm_b32 v82, v39, v35, s44
    v_perm_b32 v83, v47, v43, s44
    ds_write_b128 v13, v[80:83] offset:24576
    v_perm_b32 v84, v23, v19, s45
    v_perm_b32 v85, v31, v27, s45
    v_perm_b32 v86, v39, v35, s45
    v_perm_b32 v87, v47, v43, s45
    ds_write_b128 v13, v[84:87] offset:25600
    s_waitcnt lgkmcnt(0)
    s_barrier
    ds_read_b128 a[64:67], v4 offset:0
    ds_read_b128 a[144:147], v4 offset:1024
    ds_read_b128 a[68:71], v4 offset:2048
    ds_read_b128 a[148:151], v4 offset:3072
    ds_read_b128 a[72:75], v4 offset:4096
    ds_read_b128 a[152:155], v4 offset:5120
    ds_read_b128 a[76:79], v4 offset:6144
    ds_read_b128 a[156:159], v4 offset:7168
    s_waitcnt lgkmcnt(0)
    s_branch M_lw_done
M_lw_chain:
    v_lshrrev_b32 v12, 8, v0
    v_lshlrev_b32 v12, 16, v12
    v_and_b32 v14, 0xf0, v0
    v_add_u32 v12, v12, v14
    s_lshl_b32 s46, s22, 8
    s_lshl_b32 s27, s21, 13
    s_add_u32 s28, s27, 106496
    v_add_u32 v4, s28, v0
    s_add_u32 s28, s27, 24576
    v_add_u32 v5, s28, v0
    s_lshl_b32 s27, s21, 12
    v_add_u32 v6, s27, v0
    s_mul_i32 s27, s21, 20480
    s_add_u32 s27, s27, 24576
    v_add_u32 v7, s27, v0
    s_mul_i32 s48, s20, 10
    s_and_b32 s27, s21, 1
    s_add_u32 s49, s27, 10
    s_sub_u32 s49, s49, s48
    s_add_u32 s48, s48, s27
    v_lshrrev_b32 v8, 9, v0
    v_lshlrev_b32 v8, 4, v8
    v_bfe_u32 v14, v0, 8, 1
    v_add_u32 v8, v8, v14
    v_mul_u32_u24 v8, 2560, v8
    s_and_b32 s47, s21, 1
    s_lshl_b32 s47, s47, 6
    s_lshr_b32 s27, s21, 1
    s_lshl_b32 s27, s27, 2
    s_add_u32 s47, s47, s27
    s_lshl_b32 s27, s22, 7
    s_add_u32 s47, s47, s27
    s_mul_i32 s47, s47, 1280
    s_mul_i32 s27, s20, 640
    s_add_u32 s47, s47, s27
    v_and_b32 v14, 0xf0, v0
    v_add_u32 v8, v8, v14
    s_mov_b32 s90, 5242880
    s_mov_b32 s91, 0x00020000
    s_mov_b32 s44, 0x05040100
    s_mov_b32 s45, 0x07060302
    s_add_u32 s27, s47, 0
    buffer_load_dwordx4 v[16:19], v8, s[84:87], s27 offen
    s_add_u32 s27, s47, 10240
    buffer_load_dwordx4 v[20:23], v8, s[84:87], s27 offen
    s_add_u32 s27, s47, 1280
    buffer_load_dwordx4 v[24:27], v8, s[84:87], s27 offen
    s_add_u32 s27, s47, 11520
    buffer_load_dwordx4 v[28:31], v8, s[84:87], s27 offen
    s_add_u32 s27, s47, 20480
    buffer_load_dwordx4 v[32:35], v8, s[84:87], s27 offen
    s_add_u32 s27, s47, 30720
    buffer_load_dwordx4 v[36:39], v8, s[84:87], s27 offen
    s_add_u32 s27, s47, 21760
    buffer_load_dwordx4 v[40:43], v8, s[84:87], s27 offen
    s_add_u32 s27, s47, 32000
    buffer_load_dwordx4 v[44:47], v8, s[84:87], s27 offen
    s_add_u32 s27, s47, 256
    buffer_load_dwordx4 v[48:51], v8, s[84:87], s27 offen
    s_add_u32 s27, s47, 10496
    buffer_load_dwordx4 v[52:55], v8, s[84:87], s27 offen
    s_add_u32 s27, s47, 1536
    buffer_load_dwordx4 v[56:59], v8, s[84:87], s27 offen
    s_add_u32 s27, s47, 11776
    buffer_load_dwordx4 v[60:63], v8, s[84:87], s27 offen
    s_add_u32 s27, s47, 20736
    buffer_load_dwordx4 v[64:67], v8, s[84:87], s27 offen
    s_add_u32 s27, s47, 30976
    buffer_load_dwordx4 v[68:71], v8, s[84:87], s27 offen
    s_add_u32 s27, s47, 22016
    buffer_load_dwordx4 v[72:75], v8, s[84:87], s27 offen
    s_add_u32 s27, s47, 32256
    buffer_load_dwordx4 v[76:79], v8, s[84:87], s27 offen
    v_and_b32 v13, 0x300, v0
    s_lshl_b32 s27, s21, 10
    s_add_u32 s27, s27, 24576
    v_add_u32 v13, s27, v13
    v_bfe_u32 v14, v0, 7, 1
    v_mul_u32_u24 v14, 20480, v14
    v_add_u32 v13, v13, v14
    v_bfe_u32 v14, v0, 5, 2
    v_lshl_add_u32 v13, v14, 6, v13
    v_and_b32 v14, 16, v0
    v_add_u32 v13, v13, v14
    s_waitcnt vmcnt(14)
    v_perm_b32 v80, v20, v16, s44
    s_waitcnt vmcnt(12)
    v_perm_b32 v81, v28, v24, s44
    s_waitcnt vmcnt(10)
    v_perm_b32 v82, v36, v32, s44
    s_waitcnt vmcnt(8)
    v_perm_b32 v83, v44, v40, s44
    ds_write_b128 v13, v[80:83] offset:0
    v_perm_b32 v84, v20, v16, s45
    v_perm_b32 v85, v28, v24, s45
    v_perm_b32 v86, v36, v32, s45
    v_perm_b32 v87, v44, v40, s45
    ds_write_b128 v13, v[84:87] offset:4096
    v_perm_b32 v80, v21, v17, s44
    v_perm_b32 v81, v29, v25, s44
    v_perm_b32 v82, v37, v33, s44
    v_perm_b32 v83, v45, v41, s44
    ds_write_b128 v13, v[80:83] offset:32
    v_perm_b32 v84, v21, v17, s45
    v_perm_b32 v85, v29, v25, s45
    v_perm_b32 v86, v37, v33, s45
    v_perm_b32 v87, v45, v41, s45
    ds_write_b128 v13, v[84:87] offset:4128
    v_perm_b32 v80, v22, v18, s44
    v_perm_b32 v81, v30, v26, s44
    v_perm_b32 v82, v38, v34, s44
    v_perm_b32 v83, v46, v42, s44
    ds_write_b128 v13, v[80:83] offset:8192
    v_perm_b32 v84, v22, v18, s45
    v_perm_b32 v85, v30, v26, s45
    v_perm_b32 v86, v38, v34, s45
    v_perm_b32 v87, v46, v42, s45
    ds_write_b128 v13, v[84:87] offset:12288
    v_perm_b32 v80, v23, v19, s44
    v_perm_b32 v81, v31, v27, s44
    v_perm_b32 v82, v39, v35, s44
    v_perm_b32 v83, v47, v43, s44
    ds_write_b128 v13, v[80:83] offset:8224
    v_perm_b32 v84, v23, v19, s45
    v_perm_b32 v85, v31, v27, s45
    v_perm_b32 v86, v39, v35, s45
    v_perm_b32 v87, v47, v43, s45
    ds_write_b128 v13, v[84:87] offset:12320
    s_mov_b32 exec_lo, 0x00ff00ff
    s_mov_b32 exec_hi, 0x00ff00ff
    s_add_u32 s27, s47, 512
    buffer_load_dwordx4 v[16:19], v8, s[84:87], s27 offen
    s_add_u32 s27, s47, 10752
    buffer_load_dwordx4 v[20:23], v8, s[84:87], s27 offen
    s_add_u32 s27, s47, 1792
    buffer_load_dwordx4 v[24:27], v8, s[84:87], s27 offen
    s_add_u32 s27, s47, 12032
    buffer_load_dwordx4 v[28:31], v8, s[84:87], s27 offen
    s_add_u32 s27, s47, 20992
    buffer_load_dwordx4 v[32:35], v8, s[84:87], s27 offen
    s_add_u32 s27, s47, 31232
    buffer_load_dwordx4 v[36:39], v8, s[84:87], s27 offen
    s_add_u32 s27, s47, 22272
    buffer_load_dwordx4 v[40:43], v8, s[84:87], s27 offen
    s_add_u32 s27, s47, 32512
    buffer_load_dwordx4 v[44:47], v8, s[84:87], s27 offen
    s_mov_b64 exec, -1
    v_and_b32 v13, 0x300, v0
    s_lshl_b32 s27, s21, 10
    s_add_u32 s27, s27, 65536
    v_add_u32 v13, s27, v13
    v_bfe_u32 v14, v0, 7, 1
    v_mul_u32_u24 v14, 20480, v14
    v_add_u32 v13, v13, v14
    v_bfe_u32 v14, v0, 5, 2
    v_lshl_add_u32 v13, v14, 6, v13
    v_and_b32 v14, 16, v0
    v_add_u32 v13, v13, v14
    s_waitcnt vmcnt(14)
    v_perm_b32 v80, v52, v48, s44
    s_waitcnt vmcnt(12)
    v_perm_b32 v81, v60, v56, s44
    s_waitcnt vmcnt(10)
    v_perm_b32 v82, v68, v64, s44
    s_waitcnt vmcnt(8)
    v_perm_b32 v83, v76, v72, s44
    ds_write_b128 v13, v[80:83] offset:0
    v_perm_b32 v84, v52, v48, s45
    v_perm_b32 v85, v60, v56, s45
    v_perm_b32 v86, v68, v64, s45
    v_perm_b32 v87, v76, v72, s45
    ds_write_b128 v13, v[84:87] offset:4096
    v_perm_b32 v80, v53, v49, s44
    v_perm_b32 v81, v61, v57, s44
    v_perm_b32 v82, v69, v65, s44
    v_perm_b32 v83, v77, v73, s44
    ds_write_b128 v13, v[80:83] offset:32
    v_perm_b32 v84, v53, v49, s45
    v_perm_b32 v85, v61, v57, s45
    v_perm_b32 v86, v69, v65, s45
    v_perm_b32 v87, v77, v73, s45
    ds_write_b128 v13, v[84:87] offset:4128
    v_perm_b32 v80, v54, v50, s44
    v_perm_b32 v81, v62, v58, s44
    v_perm_b32 v82, v70, v66, s44
    v_perm_b32 v83, v78, v74, s44
    ds_write_b128 v13, v[80:83] offset:8192
    v_perm_b32 v84, v54, v50, s45
    v_perm_b32 v85, v62, v58, s45
    v_perm_b32 v86, v70, v66, s45
    v_perm_b32 v87, v78, v74, s45
    ds_write_b128 v13, v[84:87] offset:12288
    v_perm_b32 v80, v55, v51, s44
    v_perm_b32 v81, v63, v59, s44
    v_perm_b32 v82, v71, v67, s44
    v_perm_b32 v83, v79, v75, s44
    ds_write_b128 v13, v[80:83] offset:8224
    v_perm_b32 v84, v55, v51, s45
    v_perm_b32 v85, v63, v59, s45
    v_perm_b32 v86, v71, v67, s45
    v_perm_b32 v87, v79, v75, s45
    ds_write_b128 v13, v[84:87] offset:12320
    s_cmp_lt_u32 s21, 2
    s_cselect_b32 s26, s48, s48
    s_cselect_b32 s27, 0, 2
    s_cselect_b64 s[88:89], s[76:77], s[76:77]
    s_add_u32 s26, s26, s27
    s_lshl_b32 s27, s26, 18
    s_add_u32 s27, s27, s46
    buffer_load_dwordx4 v[48:51], v12, s[88:91], s27 offen
    s_add_u32 s27, s27, 8192
    buffer_load_dwordx4 v[52:55], v12, s[88:91], s27 offen
    s_add_u32 s27, s27, 8192
    buffer_load_dwordx4 v[56:59], v12, s[88:91], s27 offen
    s_add_u32 s27, s27, 8192
    buffer_load_dwordx4 v[60:63], v12, s[88:91], s27 offen
    s_add_u32 s27, s27, 8192
    buffer_load_dwordx4 v[64:67], v12, s[88:91], s27 offen
    s_add_u32 s27, s27, 8192
    buffer_load_dwordx4 v[68:71], v12, s[88:91], s27 offen
    s_add_u32 s27, s27, 8192
    buffer_load_dwordx4 v[72:75], v12, s[88:91], s27 offen
    s_add_u32 s27, s27, 8192
    buffer_load_dwordx4 v[76:79], v12, s[88:91], s27 offen
    v_and_b32 v13, 0x300, v0
    s_lshl_b32 s27, s21, 10
    s_add_u32 s27, s27, 40960
    v_add_u32 v13, s27, v13
    v_bfe_u32 v14, v0, 5, 2
    v_mul_u32_u24 v14, 20480, v14
    v_add_u32 v13, v13, v14
    v_bfe_u32 v14, v0, 4, 1
    v_lshl_add_u32 v13, v14, 6, v13
    s_mov_b32 exec_lo, 0x00ff00ff
    s_mov_b32 exec_hi, 0x00ff00ff
    s_waitcnt vmcnt(14)
    v_perm_b32 v80, v20, v16, s44
    s_waitcnt vmcnt(12)
    v_perm_b32 v81, v28, v24, s44
    s_waitcnt vmcnt(10)
    v_perm_b32 v82, v36, v32, s44
    s_waitcnt vmcnt(8)
    v_perm_b32 v83, v44, v40, s44
    ds_write_b128 v13, v[80:83] offset:0
    v_perm_b32 v84, v20, v16, s45
    v_perm_b32 v85, v28, v24, s45
    v_perm_b32 v86, v36, v32, s45
    v_perm_b32 v87, v44, v40, s45
    ds_write_b128 v13, v[84:87] offset:16
    v_perm_b32 v80, v21, v17, s44
    v_perm_b32 v81, v29, v25, s44
    v_perm_b32 v82, v37, v33, s44
    v_perm_b32 v83, v45, v41, s44
    ds_write_b128 v13, v[80:83] offset:128
    v_perm_b32 v84, v21, v17, s45
    v_perm_b32 v85, v29, v25, s45
    v_perm_b32 v86, v37, v33, s45
    v_perm_b32 v87, v45, v41, s45
    ds_write_b128 v13, v[84:87] offset:144
    v_perm_b32 v80, v22, v18, s44
    v_perm_b32 v81, v30, v26, s44
    v_perm_b32 v82, v38, v34, s44
    v_perm_b32 v83, v46, v42, s44
    ds_write_b128 v13, v[80:83] offset:32
    v_perm_b32 v84, v22, v18, s45
    v_perm_b32 v85, v30, v26, s45
    v_perm_b32 v86, v38, v34, s45
    v_perm_b32 v87, v46, v42, s45
    ds_write_b128 v13, v[84:87] offset:48
    v_perm_b32 v80, v23, v19, s44
    v_perm_b32 v81, v31, v27, s44
    v_perm_b32 v82, v39, v35, s44
    v_perm_b32 v83, v47, v43, s44
    ds_write_b128 v13, v[80:83] offset:160
    v_perm_b32 v84, v23, v19, s45
    v_perm_b32 v85, v31, v27, s45
    v_perm_b32 v86, v39, v35, s45
    v_perm_b32 v87, v47, v43, s45
    ds_write_b128 v13, v[84:87] offset:176
    s_mov_b64 exec, -1
    s_cmp_lt_u32 s21, 2
    s_cselect_b32 s26, s48, s48
    s_cselect_b32 s27, 6, 8
    s_cselect_b64 s[88:89], s[72:73], s[76:77]
    s_add_u32 s26, s26, s27
    s_lshl_b32 s27, s26, 18
    s_add_u32 s27, s27, s46
    buffer_load_dwordx4 v[16:19], v12, s[88:91], s27 offen
    s_add_u32 s27, s27, 8192
    buffer_load_dwordx4 v[20:23], v12, s[88:91], s27 offen
    s_add_u32 s27, s27, 8192
    buffer_load_dwordx4 v[24:27], v12, s[88:91], s27 offen
    s_add_u32 s27, s27, 8192
    buffer_load_dwordx4 v[28:31], v12, s[88:91], s27 offen
    s_add_u32 s27, s27, 8192
    buffer_load_dwordx4 v[32:35], v12, s[88:91], s27 offen
    s_add_u32 s27, s27, 8192
    buffer_load_dwordx4 v[36:39], v12, s[88:91], s27 offen
    s_add_u32 s27, s27, 8192
    buffer_load_dwordx4 v[40:43], v12, s[88:91], s27 offen
    s_add_u32 s27, s27, 8192
    buffer_load_dwordx4 v[44:47], v12, s[88:91], s27 offen
    s_waitcnt lgkmcnt(0)
    s_barrier
    ds_read_b128 v[160:163], v7 offset:0
    ds_read_b128 v[164:167], v7 offset:1024
    ds_read_b128 v[152:155], v7 offset:2048
    ds_read_b128 v[156:159], v7 offset:3072
    ds_read_b128 v[144:147], v7 offset:4096
    ds_read_b128 v[148:151], v7 offset:5120
    ds_read_b128 v[136:139], v7 offset:6144
    ds_read_b128 v[140:143], v7 offset:7168
    ds_read_b128 v[128:131], v7 offset:8192
    ds_read_b128 v[132:135], v7 offset:9216
    ds_read_b128 v[120:123], v7 offset:10240
    ds_read_b128 v[124:127], v7 offset:11264
    ds_read_b128 v[112:115], v7 offset:12288
    ds_read_b128 v[116:119], v7 offset:13312
    ds_read_b128 v[104:107], v7 offset:14336
    ds_read_b128 v[108:111], v7 offset:15360
    ds_read_b128 v[96:99], v7 offset:16384
    ds_read_b128 v[100:103], v7 offset:17408
    ds_read_b128 v[88:91], v7 offset:18432
    ds_read_b128 v[92:95], v7 offset:19456
    s_lshl_b32 s27, s21, 11
    s_add_u32 s27, s27, 106496
    v_add_u32 v13, s27, v0
    s_waitcnt vmcnt(14)
    v_perm_b32 v80, v52, v48, s44
    s_waitcnt vmcnt(12)
    v_perm_b32 v81, v60, v56, s44
    s_waitcnt vmcnt(10)
    v_perm_b32 v82, v68, v64, s44
    s_waitcnt vmcnt(8)
    v_perm_b32 v83, v76, v72, s44
    ds_write_b128 v13, v[80:83] offset:0
    v_perm_b32 v84, v52, v48, s45
    v_perm_b32 v85, v60, v56, s45
    v_perm_b32 v86, v68, v64, s45
    v_perm_b32 v87, v76, v72, s45
    ds_write_b128 v13, v[84:87] offset:1024
    v_perm_b32 v80, v53, v49, s44
    v_perm_b32 v81, v61, v57, s44
    v_perm_b32 v82, v69, v65, s44
    v_perm_b32 v83, v77, v73, s44
    ds_write_b128 v13, v[80:83] offset:8192
    v_perm_b32 v84, v53, v49, s45
    v_perm_b32 v85, v61, v57, s45
    v_perm_b32 v86, v69, v65, s45
    v_perm_b32 v87, v77, v73, s45
    ds_write_b128 v13, v[84:87] offset:9216
    v_perm_b32 v80, v54, v50, s44
    v_perm_b32 v81, v62, v58, s44
    v_perm_b32 v82, v70, v66, s44
    v_perm_b32 v83, v78, v74, s44
    ds_write_b128 v13, v[80:83] offset:16384
    v_perm_b32 v84, v54, v50, s45
    v_perm_b32 v85, v62, v58, s45
    v_perm_b32 v86, v70, v66, s45
    v_perm_b32 v87, v78, v74, s45
    ds_write_b128 v13, v[84:87] offset:17408
    v_perm_b32 v80, v55, v51, s44
    v_perm_b32 v81, v63, v59, s44
    v_perm_b32 v82, v71, v67, s44
    v_perm_b32 v83, v79, v75, s44
    ds_write_b128 v13, v[80:83] offset:24576
    v_perm_b32 v84, v55, v51, s45
    v_perm_b32 v85, v63, v59, s45
    v_perm_b32 v86, v71, v67, s45
    v_perm_b32 v87, v79, v75, s45
    ds_write_b128 v13, v[84:87] offset:25600
    s_cmp_lt_u32 s21, 2
    s_cselect_b32 s26, s49, s49
    s_cselect_b32 s27, 4, 0
    s_cselect_b64 s[88:89], s[72:73], s[76:77]
    s_add_u32 s26, s26, s27
    s_lshl_b32 s27, s26, 18
    s_add_u32 s27, s27, s46
    buffer_load_dwordx4 v[48:51], v12, s[88:91], s27 offen
    s_add_u32 s27, s27, 8192
    buffer_load_dwordx4 v[52:55], v12, s[88:91], s27 offen
    s_add_u32 s27, s27, 8192
    buffer_load_dwordx4 v[56:59], v12, s[88:91], s27 offen
    s_add_u32 s27, s27, 8192
    buffer_load_dwordx4 v[60:63], v12, s[88:91], s27 offen
    s_add_u32 s27, s27, 8192
    buffer_load_dwordx4 v[64:67], v12, s[88:91], s27 offen
    s_add_u32 s27, s27, 8192
    buffer_load_dwordx4 v[68:71], v12, s[88:91], s27 offen
    s_add_u32 s27, s27, 8192
    buffer_load_dwordx4 v[72:75], v12, s[88:91], s27 offen
    s_add_u32 s27, s27, 8192
    buffer_load_dwordx4 v[76:79], v12, s[88:91], s27 offen
    s_waitcnt lgkmcnt(0)
    s_barrier
    ds_read_b128 a[248:251], v4 offset:0
    ds_read_b128 a[240:243], v4 offset:1024
    ds_read_b128 a[252:255], v4 offset:2048
    ds_read_b128 a[244:247], v4 offset:3072
    ds_read_b128 a[224:227], v4 offset:4096
    ds_read_b128 a[216:219], v4 offset:5120
    ds_read_b128 a[228:231], v4 offset:6144
    ds_read_b128 a[220:223], v4 offset:7168
    s_lshl_b32 s27, s21, 11
    s_add_u32 s27, s27, 24576
    v_add_u32 v13, s27, v0
    s_waitcnt vmcnt(14)
    v_perm_b32 v80, v20, v16, s44
    s_waitcnt vmcnt(12)
    v_perm_b32 v81, v28, v24, s44
    s_waitcnt vmcnt(10)
    v_perm_b32 v82, v36, v32, s44
    s_waitcnt vmcnt(8)
    v_perm_b32 v83, v44, v40, s44
    ds_write_b128 v13, v[80:83] offset:0
    v_perm_b32 v84, v20, v16, s45
    v_perm_b32 v85, v28, v24, s45
    v_perm_b32 v86, v36, v32, s45
    v_perm_b32 v87, v44, v40, s45
    ds_write_b128 v13, v[84:87] offset:1024
    v_perm_b32 v80, v21, v17, s44
    v_perm_b32 v81, v29, v25, s44
    v_perm_b32 v82, v37, v33, s44
    v_perm_b32 v83, v45, v41, s44
    ds_write_b128 v13, v[80:83] offset:8192
    v_perm_b32 v84, v21, v17, s45
    v_perm_b32 v85, v29, v25, s45
    v_perm_b32 v86, v37, v33, s45
    v_perm_b32 v87, v45, v41, s45
    ds_write_b128 v13, v[84:87] offset:9216
    v_perm_b32 v80, v22, v18, s44
    v_perm_b32 v81, v30, v26, s44
    v_perm_b32 v82, v38, v34, s44
    v_perm_b32 v83, v46, v42, s44
    ds_write_b128 v13, v[80:83] offset:16384
    v_perm_b32 v84, v22, v18, s45
    v_perm_b32 v85, v30, v26, s45
    v_perm_b32 v86, v38, v34, s45
    v_perm_b32 v87, v46, v42, s45
    ds_write_b128 v13, v[84:87] offset:17408
    v_perm_b32 v80, v23, v19, s44
    v_perm_b32 v81, v31, v27, s44
    v_perm_b32 v82, v39, v35, s44
    v_perm_b32 v83, v47, v43, s44
    ds_write_b128 v13, v[80:83] offset:24576
    v_perm_b32 v84, v23, v19, s45
    v_perm_b32 v85, v31, v27, s45
    v_perm_b32 v86, v39, v35, s45
    v_perm_b32 v87, v47, v43, s45
    ds_write_b128 v13, v[84:87] offset:25600
    s_cmp_lt_u32 s21, 2
    s_cselect_b32 s26, s49, s49
    s_cselect_b32 s27, 6, 2
    s_cselect_b64 s[88:89], s[76:77], s[80:81]
    s_add_u32 s26, s26, s27
    s_lshl_b32 s27, s26, 18
    s_add_u32 s27, s27, s46
    buffer_load_dwordx4 v[16:19], v12, s[88:91], s27 offen
    s_add_u32 s27, s27, 8192
    buffer_load_dwordx4 v[20:23], v12, s[88:91], s27 offen
    s_add_u32 s27, s27, 8192
    buffer_load_dwordx4 v[24:27], v12, s[88:91], s27 offen
    s_add_u32 s27, s27, 8192
    buffer_load_dwordx4 v[28:31], v12, s[88:91], s27 offen
    s_add_u32 s27, s27, 8192
    buffer_load_dwordx4 v[32:35], v12, s[88:91], s27 offen
    s_add_u32 s27, s27, 8192
    buffer_load_dwordx4 v[36:39], v12, s[88:91], s27 offen
    s_add_u32 s27, s27, 8192
    buffer_load_dwordx4 v[40:43], v12, s[88:91], s27 offen
    s_add_u32 s27, s27, 8192
    buffer_load_dwordx4 v[44:47], v12, s[88:91], s27 offen
    s_waitcnt lgkmcnt(0)
    s_barrier
    ds_read_b128 a[192:195], v5 offset:0
    ds_read_b128 a[184:187], v5 offset:1024
    ds_read_b128 a[196:199], v5 offset:2048
    ds_read_b128 a[188:191], v5 offset:3072
    ds_read_b128 a[160:163], v5 offset:4096
    ds_read_b128 a[152:155], v5 offset:5120
    ds_read_b128 a[164:167], v5 offset:6144
    ds_read_b128 a[156:159], v5 offset:7168
    s_lshl_b32 s27, s21, 11
    s_add_u32 s27, s27, 106496
    v_add_u32 v13, s27, v0
    s_waitcnt vmcnt(14)
    v_perm_b32 v80, v52, v48, s44
    s_waitcnt vmcnt(12)
    v_perm_b32 v81, v60, v56, s44
    s_waitcnt vmcnt(10)
    v_perm_b32 v82, v68, v64, s44
    s_waitcnt vmcnt(8)
    v_perm_b32 v83, v76, v72, s44
    ds_write_b128 v13, v[80:83] offset:0
    v_perm_b32 v84, v52, v48, s45
    v_perm_b32 v85, v60, v56, s45
    v_perm_b32 v86, v68, v64, s45
    v_perm_b32 v87, v76, v72, s45
    ds_write_b128 v13, v[84:87] offset:1024
    v_perm_b32 v80, v53, v49, s44
    v_perm_b32 v81, v61, v57, s44
    v_perm_b32 v82, v69, v65, s44
    v_perm_b32 v83, v77, v73, s44
    ds_write_b128 v13, v[80:83] offset:8192
    v_perm_b32 v84, v53, v49, s45
    v_perm_b32 v85, v61, v57, s45
    v_perm_b32 v86, v69, v65, s45
    v_perm_b32 v87, v77, v73, s45
    ds_write_b128 v13, v[84:87] offset:9216
    v_perm_b32 v80, v54, v50, s44
    v_perm_b32 v81, v62, v58, s44
    v_perm_b32 v82, v70, v66, s44
    v_perm_b32 v83, v78, v74, s44
    ds_write_b128 v13, v[80:83] offset:16384
    v_perm_b32 v84, v54, v50, s45
    v_perm_b32 v85, v62, v58, s45
    v_perm_b32 v86, v70, v66, s45
    v_perm_b32 v87, v78, v74, s45
    ds_write_b128 v13, v[84:87] offset:17408
    v_perm_b32 v80, v55, v51, s44
    v_perm_b32 v81, v63, v59, s44
    v_perm_b32 v82, v71, v67, s44
    v_perm_b32 v83, v79, v75, s44
    ds_write_b128 v13, v[80:83] offset:24576
    v_perm_b32 v84, v55, v51, s45
    v_perm_b32 v85, v63, v59, s45
    v_perm_b32 v86, v71, v67, s45
    v_perm_b32 v87, v79, v75, s45
    ds_write_b128 v13, v[84:87] offset:25600
    s_cmp_lt_u32 s21, 2
    s_cselect_b32 s26, s49, s48
    s_cselect_b32 s27, 8, 0
    s_cselect_b64 s[88:89], s[80:81], s[80:81]
    s_add_u32 s26, s26, s27
    s_lshl_b32 s27, s26, 18
    s_add_u32 s27, s27, s46
    buffer_load_dwordx4 v[48:51], v12, s[88:91], s27 offen
    s_add_u32 s27, s27, 8192
    buffer_load_dwordx4 v[52:55], v12, s[88:91], s27 offen
    s_add_u32 s27, s27, 8192
    buffer_load_dwordx4 v[56:59], v12, s[88:91], s27 offen
    s_add_u32 s27, s27, 8192
    buffer_load_dwordx4 v[60:63], v12, s[88:91], s27 offen
    s_add_u32 s27, s27, 8192
    buffer_load_dwordx4 v[64:67], v12, s[88:91], s27 offen
    s_add_u32 s27, s27, 8192
    buffer_load_dwordx4 v[68:71], v12, s[88:91], s27 offen
    s_add_u32 s27, s27, 8192
    buffer_load_dwordx4 v[72:75], v12, s[88:91], s27 offen
    s_add_u32 s27, s27, 8192
    buffer_load_dwordx4 v[76:79], v12, s[88:91], s27 offen
    s_waitcnt lgkmcnt(0)
    s_barrier
    ds_read_b128 a[128:131], v4 offset:0
    ds_read_b128 a[120:123], v4 offset:1024
    ds_read_b128 a[132:135], v4 offset:2048
    ds_read_b128 a[124:127], v4 offset:3072
    ds_read_b128 a[96:99], v4 offset:4096
    ds_read_b128 a[88:91], v4 offset:5120
    ds_read_b128 a[100:103], v4 offset:6144
    ds_read_b128 a[92:95], v4 offset:7168
    s_lshl_b32 s27, s21, 11
    s_add_u32 s27, s27, 24576
    v_add_u32 v13, s27, v0
    s_waitcnt vmcnt(14)
    v_perm_b32 v80, v20, v16, s44
    s_waitcnt vmcnt(12)
    v_perm_b32 v81, v28, v24, s44
    s_waitcnt vmcnt(10)
    v_perm_b32 v82, v36, v32, s44
    s_waitcnt vmcnt(8)
    v_perm_b32 v83, v44, v40, s44
    ds_write_b128 v13, v[80:83] offset:0
    v_perm_b32 v84, v20, v16, s45
    v_perm_b32 v85, v28, v24, s45
    v_perm_b32 v86, v36, v32, s45
    v_perm_b32 v87, v44, v40, s45
    ds_write_b128 v13, v[84:87] offset:1024
    v_perm_b32 v80, v21, v17, s44
    v_perm_b32 v81, v29, v25, s44
    v_perm_b32 v82, v37, v33, s44
    v_perm_b32 v83, v45, v41, s44
    ds_write_b128 v13, v[80:83] offset:8192
    v_perm_b32 v84, v21, v17, s45
    v_perm_b32 v85, v29, v25, s45
    v_perm_b32 v86, v37, v33, s45
    v_perm_b32 v87, v45, v41, s45
    ds_write_b128 v13, v[84:87] offset:9216
    v_perm_b32 v80, v22, v18, s44
    v_perm_b32 v81, v30, v26, s44
    v_perm_b32 v82, v38, v34, s44
    v_perm_b32 v83, v46, v42, s44
    ds_write_b128 v13, v[80:83] offset:16384
    v_perm_b32 v84, v22, v18, s45
    v_perm_b32 v85, v30, v26, s45
    v_perm_b32 v86, v38, v34, s45
    v_perm_b32 v87, v46, v42, s45
    ds_write_b128 v13, v[84:87] offset:17408
    v_perm_b32 v80, v23, v19, s44
    v_perm_b32 v81, v31, v27, s44
    v_perm_b32 v82, v39, v35, s44
    v_perm_b32 v83, v47, v43, s44
    ds_write_b128 v13, v[80:83] offset:24576
    v_perm_b32 v84, v23, v19, s45
    v_perm_b32 v85, v31, v27, s45
    v_perm_b32 v86, v39, v35, s45
    v_perm_b32 v87, v47, v43, s45
    ds_write_b128 v13, v[84:87] offset:25600
    s_cmp_lt_u32 s21, 2
    s_cselect_b32 s26, s48, s48
    s_cselect_b32 s27, 2, 4
    s_cselect_b64 s[88:89], s[80:81], s[80:81]
    s_add_u32 s26, s26, s27
    s_lshl_b32 s27, s26, 18
    s_add_u32 s27, s27, s46
    buffer_load_dwordx4 v[16:19], v12, s[88:91], s27 offen
    s_add_u32 s27, s27, 8192
    buffer_load_dwordx4 v[20:23], v12, s[88:91], s27 offen
    s_add_u32 s27, s27, 8192
    buffer_load_dwordx4 v[24:27], v12, s[88:91], s27 offen
    s_add_u32 s27, s27, 8192
    buffer_load_dwordx4 v[28:31], v12, s[88:91], s27 offen
    s_add_u32 s27, s27, 8192
    buffer_load_dwordx4 v[32:35], v12, s[88:91], s27 offen
    s_add_u32 s27, s27, 8192
    buffer_load_dwordx4 v[36:39], v12, s[88:91], s27 offen
    s_add_u32 s27, s27, 8192
    buffer_load_dwordx4 v[40:43], v12, s[88:91], s27 offen
    s_add_u32 s27, s27, 8192
    buffer_load_dwordx4 v[44:47], v12, s[88:91], s27 offen
    s_waitcnt lgkmcnt(0)
    s_barrier
    ds_read_b128 a[64:67], v5 offset:0
    ds_read_b128 a[56:59], v5 offset:1024
    ds_read_b128 a[68:71], v5 offset:2048
    ds_read_b128 a[60:63], v5 offset:3072
    ds_read_b128 a[32:35], v5 offset:4096
    ds_read_b128 a[24:27], v5 offset:5120
    ds_read_b128 a[36:39], v5 offset:6144
    ds_read_b128 a[28:31], v5 offset:7168
    s_lshl_b32 s27, s21, 11
    s_add_u32 s27, s27, 106496
    v_add_u32 v13, s27, v0
    s_waitcnt vmcnt(14)
    v_perm_b32 v80, v52, v48, s44
    s_waitcnt vmcnt(12)
    v_perm_b32 v81, v60, v56, s44
    s_waitcnt vmcnt(10)
    v_perm_b32 v82, v68, v64, s44
    s_waitcnt vmcnt(8)
    v_perm_b32 v83, v76, v72, s44
    ds_write_b128 v13, v[80:83] offset:0
    v_perm_b32 v84, v52, v48, s45
    v_perm_b32 v85, v60, v56, s45
    v_perm_b32 v86, v68, v64, s45
    v_perm_b32 v87, v76, v72, s45
    ds_write_b128 v13, v[84:87] offset:1024
    v_perm_b32 v80, v53, v49, s44
    v_perm_b32 v81, v61, v57, s44
    v_perm_b32 v82, v69, v65, s44
    v_perm_b32 v83, v77, v73, s44
    ds_write_b128 v13, v[80:83] offset:8192
    v_perm_b32 v84, v53, v49, s45
    v_perm_b32 v85, v61, v57, s45
    v_perm_b32 v86, v69, v65, s45
    v_perm_b32 v87, v77, v73, s45
    ds_write_b128 v13, v[84:87] offset:9216
    v_perm_b32 v80, v54, v50, s44
    v_perm_b32 v81, v62, v58, s44
    v_perm_b32 v82, v70, v66, s44
    v_perm_b32 v83, v78, v74, s44
    ds_write_b128 v13, v[80:83] offset:16384
    v_perm_b32 v84, v54, v50, s45
    v_perm_b32 v85, v62, v58, s45
    v_perm_b32 v86, v70, v66, s45
    v_perm_b32 v87, v78, v74, s45
    ds_write_b128 v13, v[84:87] offset:17408
    v_perm_b32 v80, v55, v51, s44
    v_perm_b32 v81, v63, v59, s44
    v_perm_b32 v82, v71, v67, s44
    v_perm_b32 v83, v79, v75, s44
    ds_write_b128 v13, v[80:83] offset:24576
    v_perm_b32 v84, v55, v51, s45
    v_perm_b32 v85, v63, v59, s45
    v_perm_b32 v86, v71, v67, s45
    v_perm_b32 v87, v79, v75, s45
    ds_write_b128 v13, v[84:87] offset:25600
    s_cmp_lt_u32 s21, 2
    s_cselect_b32 s26, s48, s48
    s_cselect_b32 s27, 6, 8
    s_cselect_b64 s[88:89], s[80:81], s[80:81]
    s_add_u32 s26, s26, s27
    s_lshl_b32 s27, s26, 18
    s_add_u32 s27, s27, s46
    buffer_load_dwordx4 v[48:51], v12, s[88:91], s27 offen
    s_add_u32 s27, s27, 8192
    buffer_load_dwordx4 v[52:55], v12, s[88:91], s27 offen
    s_add_u32 s27, s27, 8192
    buffer_load_dwordx4 v[56:59], v12, s[88:91], s27 offen
    s_add_u32 s27, s27, 8192
    buffer_load_dwordx4 v[60:63], v12, s[88:91], s27 offen
    s_add_u32 s27, s27, 8192
    buffer_load_dwordx4 v[64:67], v12, s[88:91], s27 offen
    s_add_u32 s27, s27, 8192
    buffer_load_dwordx4 v[68:71], v12, s[88:91], s27 offen
    s_add_u32 s27, s27, 8192
    buffer_load_dwordx4 v[72:75], v12, s[88:91], s27 offen
    s_add_u32 s27, s27, 8192
    buffer_load_dwordx4 v[76:79], v12, s[88:91], s27 offen
    s_waitcnt lgkmcnt(0)
    s_barrier
    ds_read_b128 a[0:3], v4 offset:0
    ds_read_b128 v[248:251], v4 offset:1024
    ds_read_b128 a[4:7], v4 offset:2048
    ds_read_b128 v[252:255], v4 offset:3072
    ds_read_b128 v[240:243], v4 offset:4096
    ds_read_b128 v[232:235], v4 offset:5120
    ds_read_b128 v[244:247], v4 offset:6144
    ds_read_b128 v[236:239], v4 offset:7168
    s_lshl_b32 s27, s21, 11
    s_add_u32 s27, s27, 24576
    v_add_u32 v13, s27, v0
    s_waitcnt vmcnt(14)
    v_perm_b32 v80, v20, v16, s44
    s_waitcnt vmcnt(12)
    v_perm_b32 v81, v28, v24, s44
    s_waitcnt vmcnt(10)
    v_perm_b32 v82, v36, v32, s44
    s_waitcnt vmcnt(8)
    v_perm_b32 v83, v44, v40, s44
    ds_write_b128 v13, v[80:83] offset:0
    v_perm_b32 v84, v20, v16, s45
    v_perm_b32 v85, v28, v24, s45
    v_perm_b32 v86, v36, v32, s45
    v_perm_b32 v87, v44, v40, s45
    ds_write_b128 v13, v[84:87] offset:1024
    v_perm_b32 v80, v21, v17, s44
    v_perm_b32 v81, v29, v25, s44
    v_perm_b32 v82, v37, v33, s44
    v_perm_b32 v83, v45, v41, s44
    ds_write_b128 v13, v[80:83] offset:8192
    v_perm_b32 v84, v21, v17, s45
    v_perm_b32 v85, v29, v25, s45
    v_perm_b32 v86, v37, v33, s45
    v_perm_b32 v87, v45, v41, s45
    ds_write_b128 v13, v[84:87] offset:9216
    v_perm_b32 v80, v22, v18, s44
    v_perm_b32 v81, v30, v26, s44
    v_perm_b32 v82, v38, v34, s44
    v_perm_b32 v83, v46, v42, s44
    ds_write_b128 v13, v[80:83] offset:16384
    v_perm_b32 v84, v22, v18, s45
    v_perm_b32 v85, v30, v26, s45
    v_perm_b32 v86, v38, v34, s45
    v_perm_b32 v87, v46, v42, s45
    ds_write_b128 v13, v[84:87] offset:17408
    v_perm_b32 v80, v23, v19, s44
    v_perm_b32 v81, v31, v27, s44
    v_perm_b32 v82, v39, v35, s44
    v_perm_b32 v83, v47, v43, s44
    ds_write_b128 v13, v[80:83] offset:24576
    v_perm_b32 v84, v23, v19, s45
    v_perm_b32 v85, v31, v27, s45
    v_perm_b32 v86, v39, v35, s45
    v_perm_b32 v87, v47, v43, s45
    ds_write_b128 v13, v[84:87] offset:25600
    s_cmp_lt_u32 s21, 2
    s_cselect_b32 s26, s48, s48
    s_cselect_b32 s27, 0, 2
    s_cselect_b64 s[88:89], s[72:73], s[72:73]
    s_add_u32 s26, s26, s27
    s_lshl_b32 s27, s26, 18
    s_add_u32 s27, s27, s46
    buffer_load_dwordx4 v[16:19], v12, s[88:91], s27 offen
    s_add_u32 s27, s27, 8192
    buffer_load_dwordx4 v[20:23], v12, s[88:91], s27 offen
    s_add_u32 s27, s27, 8192
    buffer_load_dwordx4 v[24:27], v12, s[88:91], s27 offen
    s_add_u32 s27, s27, 8192
    buffer_load_dwordx4 v[28:31], v12, s[88:91], s27 offen
    s_add_u32 s27, s27, 8192
    buffer_load_dwordx4 v[32:35], v12, s[88:91], s27 offen
    s_add_u32 s27, s27, 8192
    buffer_load_dwordx4 v[36:39], v12, s[88:91], s27 offen
    s_add_u32 s27, s27, 8192
    buffer_load_dwordx4 v[40:43], v12, s[88:91], s27 offen
    s_add_u32 s27, s27, 8192
    buffer_load_dwordx4 v[44:47], v12, s[88:91], s27 offen
    s_waitcnt lgkmcnt(0)
    s_barrier
    ds_read_b128 v[224:227], v5 offset:0
    ds_read_b128 v[216:219], v5 offset:1024
    ds_read_b128 v[228:231], v5 offset:2048
    ds_read_b128 v[220:223], v5 offset:3072
    ds_read_b128 v[208:211], v5 offset:4096
    ds_read_b128 v[200:203], v5 offset:5120
    ds_read_b128 v[212:215], v5 offset:6144
    ds_read_b128 v[204:207], v5 offset:7168
    s_lshl_b32 s27, s21, 11
    s_add_u32 s27, s27, 106496
    v_add_u32 v13, s27, v0
    s_waitcnt vmcnt(14)
    v_perm_b32 v80, v52, v48, s44
    s_waitcnt vmcnt(12)
    v_perm_b32 v81, v60, v56, s44
    s_waitcnt vmcnt(10)
    v_perm_b32 v82, v68, v64, s44
    s_waitcnt vmcnt(8)
    v_perm_b32 v83, v76, v72, s44
    ds_write_b128 v13, v[80:83] offset:0
    v_perm_b32 v84, v52, v48, s45
    v_perm_b32 v85, v60, v56, s45
    v_perm_b32 v86, v68, v64, s45
    v_perm_b32 v87, v76, v72, s45
    ds_write_b128 v13, v[84:87] offset:1024
    v_perm_b32 v80, v53, v49, s44
    v_perm_b32 v81, v61, v57, s44
    v_perm_b32 v82, v69, v65, s44
    v_perm_b32 v83, v77, v73, s44
    ds_write_b128 v13, v[80:83] offset:8192
    v_perm_b32 v84, v53, v49, s45
    v_perm_b32 v85, v61, v57, s45
    v_perm_b32 v86, v69, v65, s45
    v_perm_b32 v87, v77, v73, s45
    ds_write_b128 v13, v[84:87] offset:9216
    v_perm_b32 v80, v54, v50, s44
    v_perm_b32 v81, v62, v58, s44
    v_perm_b32 v82, v70, v66, s44
    v_perm_b32 v83, v78, v74, s44
    ds_write_b128 v13, v[80:83] offset:16384
    v_perm_b32 v84, v54, v50, s45
    v_perm_b32 v85, v62, v58, s45
    v_perm_b32 v86, v70, v66, s45
    v_perm_b32 v87, v78, v74, s45
    ds_write_b128 v13, v[84:87] offset:17408
    v_perm_b32 v80, v55, v51, s44
    v_perm_b32 v81, v63, v59, s44
    v_perm_b32 v82, v71, v67, s44
    v_perm_b32 v83, v79, v75, s44
    ds_write_b128 v13, v[80:83] offset:24576
    v_perm_b32 v84, v55, v51, s45
    v_perm_b32 v85, v63, v59, s45
    v_perm_b32 v86, v71, v67, s45
    v_perm_b32 v87, v79, v75, s45
    ds_write_b128 v13, v[84:87] offset:25600
    s_cmp_lt_u32 s21, 2
    s_cselect_b32 s26, s48, s48
    s_cselect_b32 s27, 4, 4
    s_cselect_b64 s[88:89], s[72:73], s[76:77]
    s_add_u32 s26, s26, s27
    s_lshl_b32 s27, s26, 18
    s_add_u32 s27, s27, s46
    buffer_load_dwordx4 v[48:51], v12, s[88:91], s27 offen
    s_add_u32 s27, s27, 8192
    buffer_load_dwordx4 v[52:55], v12, s[88:91], s27 offen
    s_add_u32 s27, s27, 8192
    buffer_load_dwordx4 v[56:59], v12, s[88:91], s27 offen
    s_add_u32 s27, s27, 8192
    buffer_load_dwordx4 v[60:63], v12, s[88:91], s27 offen
    s_add_u32 s27, s27, 8192
    buffer_load_dwordx4 v[64:67], v12, s[88:91], s27 offen
    s_add_u32 s27, s27, 8192
    buffer_load_dwordx4 v[68:71], v12, s[88:91], s27 offen
    s_add_u32 s27, s27, 8192
    buffer_load_dwordx4 v[72:75], v12, s[88:91], s27 offen
    s_add_u32 s27, s27, 8192
    buffer_load_dwordx4 v[76:79], v12, s[88:91], s27 offen
    s_waitcnt lgkmcnt(0)
    s_barrier
    ds_read_b128 v[192:195], v4 offset:0
    ds_read_b128 v[184:187], v4 offset:1024
    ds_read_b128 v[196:199], v4 offset:2048
    ds_read_b128 v[188:191], v4 offset:3072
    ds_read_b128 v[176:179], v4 offset:4096
    ds_read_b128 v[168:171], v4 offset:5120
    ds_read_b128 v[180:183], v4 offset:6144
    ds_read_b128 v[172:175], v4 offset:7168
    s_waitcnt lgkmcnt(0)
    s_barrier
    s_and_b32 s28, s21, 1
    s_lshl_b32 s28, s28, 10
    s_mov_b32 s29, 2048
    s_mov_b32 s30, 4096
    s_cmp_lt_u32 s21, 2
    s_cselect_b32 s29, 24576, s29
    s_cselect_b32 s30, 34816, s30
    s_add_u32 s29, s29, s28
    v_add_u32 v13, s29, v0
    s_add_u32 s29, s29, s30
    s_waitcnt vmcnt(14)
    v_perm_b32 v80, v20, v16, s44
    s_waitcnt vmcnt(12)
    v_perm_b32 v81, v28, v24, s44
    s_waitcnt vmcnt(10)
    v_perm_b32 v82, v36, v32, s44
    s_waitcnt vmcnt(8)
    v_perm_b32 v83, v44, v40, s44
    ds_write_b128 v13, v[80:83]
    v_add_u32 v14, s29, v0
    s_add_u32 s29, s29, s30
    v_perm_b32 v84, v21, v17, s44
    v_perm_b32 v85, v29, v25, s44
    v_perm_b32 v86, v37, v33, s44
    v_perm_b32 v87, v45, v41, s44
    ds_write_b128 v14, v[84:87]
    v_add_u32 v13, s29, v0
    s_add_u32 s29, s29, s30
    v_perm_b32 v80, v22, v18, s44
    v_perm_b32 v81, v30, v26, s44
    v_perm_b32 v82, v38, v34, s44
    v_perm_b32 v83, v46, v42, s44
    ds_write_b128 v13, v[80:83]
    v_add_u32 v14, s29, v0
    s_add_u32 s29, s29, s30
    v_perm_b32 v84, v23, v19, s44
    v_perm_b32 v85, v31, v27, s44
    v_perm_b32 v86, v39, v35, s44
    v_perm_b32 v87, v47, v43, s44
    ds_write_b128 v14, v[84:87]
    s_mov_b32 s29, 28672
    s_mov_b32 s30, 34816
    s_cmp_lt_u32 s21, 2
    s_cselect_b32 s29, 26624, s29
    s_cselect_b32 s30, 34816, s30
    s_add_u32 s29, s29, s28
    v_add_u32 v13, s29, v0
    s_add_u32 s29, s29, s30
    v_perm_b32 v80, v20, v16, s45
    v_perm_b32 v81, v28, v24, s45
    v_perm_b32 v82, v36, v32, s45
    v_perm_b32 v83, v44, v40, s45
    ds_write_b128 v13, v[80:83]
    v_add_u32 v14, s29, v0
    s_add_u32 s29, s29, s30
    v_perm_b32 v84, v21, v17, s45
    v_perm_b32 v85, v29, v25, s45
    v_perm_b32 v86, v37, v33, s45
    v_perm_b32 v87, v45, v41, s45
    ds_write_b128 v14, v[84:87]
    v_add_u32 v13, s29, v0
    s_add_u32 s29, s29, s30
    v_perm_b32 v80, v22, v18, s45
    v_perm_b32 v81, v30, v26, s45
    v_perm_b32 v82, v38, v34, s45
    v_perm_b32 v83, v46, v42, s45
    ds_write_b128 v13, v[80:83]
    v_add_u32 v14, s29, v0
    s_add_u32 s29, s29, s30
    v_perm_b32 v84, v23, v19, s45
    v_perm_b32 v85, v31, v27, s45
    v_perm_b32 v86, v39, v35, s45
    v_perm_b32 v87, v47, v43, s45
    ds_write_b128 v14, v[84:87]
    s_cmp_lt_u32 s21, 2
    s_cselect_b32 s26, s48, s48
    s_cselect_b32 s27, 6, 8
    s_cselect_b64 s[88:89], s[76:77], s[72:73]
    s_add_u32 s26, s26, s27
    s_lshl_b32 s27, s26, 18
    s_add_u32 s27, s27, s46
    buffer_load_dwordx4 v[16:19], v12, s[88:91], s27 offen
    s_add_u32 s27, s27, 8192
    buffer_load_dwordx4 v[20:23], v12, s[88:91], s27 offen
    s_add_u32 s27, s27, 8192
    buffer_load_dwordx4 v[24:27], v12, s[88:91], s27 offen
    s_add_u32 s27, s27, 8192
    buffer_load_dwordx4 v[28:31], v12, s[88:91], s27 offen
    s_add_u32 s27, s27, 8192
    buffer_load_dwordx4 v[32:35], v12, s[88:91], s27 offen
    s_add_u32 s27, s27, 8192
    buffer_load_dwordx4 v[36:39], v12, s[88:91], s27 offen
    s_add_u32 s27, s27, 8192
    buffer_load_dwordx4 v[40:43], v12, s[88:91], s27 offen
    s_add_u32 s27, s27, 8192
    buffer_load_dwordx4 v[44:47], v12, s[88:91], s27 offen
    s_waitcnt lgkmcnt(0)
    s_barrier
    ds_read_b128 a[232:235], v6 offset:2048
    ds_read_b128 a[236:239], v6 offset:3072
    s_waitcnt lgkmcnt(0)
    s_barrier
    s_and_b32 s28, s21, 1
    s_lshl_b32 s28, s28, 10
    s_mov_b32 s29, 2048
    s_mov_b32 s30, 4096
    s_cmp_lt_u32 s21, 2
    s_cselect_b32 s29, 30720, s29
    s_cselect_b32 s30, 34816, s30
    s_add_u32 s29, s29, s28
    v_add_u32 v13, s29, v0
    s_add_u32 s29, s29, s30
    s_waitcnt vmcnt(14)
    v_perm_b32 v80, v52, v48, s44
    s_waitcnt vmcnt(12)
    v_perm_b32 v81, v60, v56, s44
    s_waitcnt vmcnt(10)
    v_perm_b32 v82, v68, v64, s44
    s_waitcnt vmcnt(8)
    v_perm_b32 v83, v76, v72, s44
    ds_write_b128 v13, v[80:83]
    v_add_u32 v14, s29, v0
    s_add_u32 s29, s29, s30
    v_perm_b32 v84, v53, v49, s44
    v_perm_b32 v85, v61, v57, s44
    v_perm_b32 v86, v69, v65, s44
    v_perm_b32 v87, v77, v73, s44
    ds_write_b128 v14, v[84:87]
    v_add_u32 v13, s29, v0
    s_add_u32 s29, s29, s30
    v_perm_b32 v80, v54, v50, s44
    v_perm_b32 v81, v62, v58, s44
    v_perm_b32 v82, v70, v66, s44
    v_perm_b32 v83, v78, v74, s44
    ds_write_b128 v13, v[80:83]
    v_add_u32 v14, s29, v0
    s_add_u32 s29, s29, s30
    v_perm_b32 v84, v55, v51, s44
    v_perm_b32 v85, v63, v59, s44
    v_perm_b32 v86, v71, v67, s44
    v_perm_b32 v87, v79, v75, s44
    ds_write_b128 v14, v[84:87]
    s_mov_b32 s29, 32768
    s_mov_b32 s30, 34816
    s_cmp_lt_u32 s21, 2
    s_cselect_b32 s29, 0, s29
    s_cselect_b32 s30, 4096, s30
    s_add_u32 s29, s29, s28
    v_add_u32 v13, s29, v0
    s_add_u32 s29, s29, s30
    v_perm_b32 v80, v52, v48, s45
    v_perm_b32 v81, v60, v56, s45
    v_perm_b32 v82, v68, v64, s45
    v_perm_b32 v83, v76, v72, s45
    ds_write_b128 v13, v[80:83]
    v_add_u32 v14, s29, v0
    s_add_u32 s29, s29, s30
    v_perm_b32 v84, v53, v49, s45
    v_perm_b32 v85, v61, v57, s45
    v_perm_b32 v86, v69, v65, s45
    v_perm_b32 v87, v77, v73, s45
    ds_write_b128 v14, v[84:87]
    v_add_u32 v13, s29, v0
    s_add_u32 s29, s29, s30
    v_perm_b32 v80, v54, v50, s45
    v_perm_b32 v81, v62, v58, s45
    v_perm_b32 v82, v70, v66, s45
    v_perm_b32 v83, v78, v74, s45
    ds_write_b128 v13, v[80:83]
    v_add_u32 v14, s29, v0
    s_add_u32 s29, s29, s30
    v_perm_b32 v84, v55, v51, s45
    v_perm_b32 v85, v63, v59, s45
    v_perm_b32 v86, v71, v67, s45
    v_perm_b32 v87, v79, v75, s45
    ds_write_b128 v14, v[84:87]
    s_cmp_lt_u32 s21, 2
    s_cselect_b32 s26, s49, s49
    s_cselect_b32 s27, 0, 2
    s_cselect_b64 s[88:89], s[72:73], s[72:73]
    s_add_u32 s26, s26, s27
    s_lshl_b32 s27, s26, 18
    s_add_u32 s27, s27, s46
    buffer_load_dwordx4 v[48:51], v12, s[88:91], s27 offen
    s_add_u32 s27, s27, 8192
    buffer_load_dwordx4 v[52:55], v12, s[88:91], s27 offen
    s_add_u32 s27, s27, 8192
    buffer_load_dwordx4 v[56:59], v12, s[88:91], s27 offen
    s_add_u32 s27, s27, 8192
    buffer_load_dwordx4 v[60:63], v12, s[88:91], s27 offen
    s_add_u32 s27, s27, 8192
    buffer_load_dwordx4 v[64:67], v12, s[88:91], s27 offen
    s_add_u32 s27, s27, 8192
    buffer_load_dwordx4 v[68:71], v12, s[88:91], s27 offen
    s_add_u32 s27, s27, 8192
    buffer_load_dwordx4 v[72:75], v12, s[88:91], s27 offen
    s_add_u32 s27, s27, 8192
    buffer_load_dwordx4 v[76:79], v12, s[88:91], s27 offen
    s_waitcnt lgkmcnt(0)
    s_barrier
    ds_read_b128 a[208:211], v6 offset:0
    ds_read_b128 a[212:215], v6 offset:1024
    ds_read_b128 a[200:203], v6 offset:2048
    ds_read_b128 a[204:207], v6 offset:3072
    s_waitcnt lgkmcnt(0)
    s_barrier
    s_and_b32 s28, s21, 1
    s_lshl_b32 s28, s28, 10
    s_mov_b32 s29, 2048
    s_mov_b32 s30, 4096
    s_cmp_lt_u32 s21, 2
    s_cselect_b32 s29, 34816, s29
    s_cselect_b32 s30, 34816, s30
    s_add_u32 s29, s29, s28
    v_add_u32 v13, s29, v0
    s_add_u32 s29, s29, s30
    s_waitcnt vmcnt(14)
    v_perm_b32 v80, v20, v16, s44
    s_waitcnt vmcnt(12)
    v_perm_b32 v81, v28, v24, s44
    s_waitcnt vmcnt(10)
    v_perm_b32 v82, v36, v32, s44
    s_waitcnt vmcnt(8)
    v_perm_b32 v83, v44, v40, s44
    ds_write_b128 v13, v[80:83]
    v_add_u32 v14, s29, v0
    s_add_u32 s29, s29, s30
    v_perm_b32 v84, v21, v17, s44
    v_perm_b32 v85, v29, v25, s44
    v_perm_b32 v86, v37, v33, s44
    v_perm_b32 v87, v45, v41, s44
    ds_write_b128 v14, v[84:87]
    v_add_u32 v13, s29, v0
    s_add_u32 s29, s29, s30
    v_perm_b32 v80, v22, v18, s44
    v_perm_b32 v81, v30, v26, s44
    v_perm_b32 v82, v38, v34, s44
    v_perm_b32 v83, v46, v42, s44
    ds_write_b128 v13, v[80:83]
    v_add_u32 v14, s29, v0
    s_add_u32 s29, s29, s30
    v_perm_b32 v84, v23, v19, s44
    v_perm_b32 v85, v31, v27, s44
    v_perm_b32 v86, v39, v35, s44
    v_perm_b32 v87, v47, v43, s44
    ds_write_b128 v14, v[84:87]
    s_mov_b32 s29, 36864
    s_mov_b32 s30, 34816
    s_cmp_lt_u32 s21, 2
    s_cselect_b32 s29, 0, s29
    s_cselect_b32 s30, 4096, s30
    s_add_u32 s29, s29, s28
    v_add_u32 v13, s29, v0
    s_add_u32 s29, s29, s30
    v_perm_b32 v80, v20, v16, s45
    v_perm_b32 v81, v28, v24, s45
    v_perm_b32 v82, v36, v32, s45
    v_perm_b32 v83, v44, v40, s45
    ds_write_b128 v13, v[80:83]
    v_add_u32 v14, s29, v0
    s_add_u32 s29, s29, s30
    v_perm_b32 v84, v21, v17, s45
    v_perm_b32 v85, v29, v25, s45
    v_perm_b32 v86, v37, v33, s45
    v_perm_b32 v87, v45, v41, s45
    ds_write_b128 v14, v[84:87]
    v_add_u32 v13, s29, v0
    s_add_u32 s29, s29, s30
    v_perm_b32 v80, v22, v18, s45
    v_perm_b32 v81, v30, v26, s45
    v_perm_b32 v82, v38, v34, s45
    v_perm_b32 v83, v46, v42, s45
    ds_write_b128 v13, v[80:83]
    v_add_u32 v14, s29, v0
    s_add_u32 s29, s29, s30
    v_perm_b32 v84, v23, v19, s45
    v_perm_b32 v85, v31, v27, s45
    v_perm_b32 v86, v39, v35, s45
    v_perm_b32 v87, v47, v43, s45
    ds_write_b128 v14, v[84:87]
    s_cmp_lt_u32 s21, 2
    s_cselect_b32 s26, s49, s49
    s_cselect_b32 s27, 6, 8
    s_cselect_b64 s[88:89], s[72:73], s[72:73]
    s_add_u32 s26, s26, s27
    s_lshl_b32 s27, s26, 18
    s_add_u32 s27, s27, s46
    buffer_load_dwordx4 v[16:19], v12, s[88:91], s27 offen
    s_add_u32 s27, s27, 8192
    buffer_load_dwordx4 v[20:23], v12, s[88:91], s27 offen
    s_add_u32 s27, s27, 8192
    buffer_load_dwordx4 v[24:27], v12, s[88:91], s27 offen
    s_add_u32 s27, s27, 8192
    buffer_load_dwordx4 v[28:31], v12, s[88:91], s27 offen
    s_add_u32 s27, s27, 8192
    buffer_load_dwordx4 v[32:35], v12, s[88:91], s27 offen
    s_add_u32 s27, s27, 8192
    buffer_load_dwordx4 v[36:39], v12, s[88:91], s27 offen
    s_add_u32 s27, s27, 8192
    buffer_load_dwordx4 v[40:43], v12, s[88:91], s27 offen
    s_add_u32 s27, s27, 8192
    buffer_load_dwordx4 v[44:47], v12, s[88:91], s27 offen
    s_waitcnt lgkmcnt(0)
    s_barrier
    ds_read_b128 a[176:179], v6 offset:0
    ds_read_b128 a[180:183], v6 offset:1024
    ds_read_b128 a[168:171], v6 offset:2048
    ds_read_b128 a[172:175], v6 offset:3072
    s_waitcnt lgkmcnt(0)
    s_barrier
    s_and_b32 s28, s21, 1
    s_lshl_b32 s28, s28, 10
    s_mov_b32 s29, 2048
    s_mov_b32 s30, 4096
    s_cmp_lt_u32 s21, 2
    s_cselect_b32 s29, 38912, s29
    s_cselect_b32 s30, 34816, s30
    s_add_u32 s29, s29, s28
    v_add_u32 v13, s29, v0
    s_add_u32 s29, s29, s30
    s_waitcnt vmcnt(14)
    v_perm_b32 v80, v52, v48, s44
    s_waitcnt vmcnt(12)
    v_perm_b32 v81, v60, v56, s44
    s_waitcnt vmcnt(10)
    v_perm_b32 v82, v68, v64, s44
    s_waitcnt vmcnt(8)
    v_perm_b32 v83, v76, v72, s44
    ds_write_b128 v13, v[80:83]
    v_add_u32 v14, s29, v0
    s_add_u32 s29, s29, s30
    v_perm_b32 v84, v53, v49, s44
    v_perm_b32 v85, v61, v57, s44
    v_perm_b32 v86, v69, v65, s44
    v_perm_b32 v87, v77, v73, s44
    ds_write_b128 v14, v[84:87]
    v_add_u32 v13, s29, v0
    s_add_u32 s29, s29, s30
    v_perm_b32 v80, v54, v50, s44
    v_perm_b32 v81, v62, v58, s44
    v_perm_b32 v82, v70, v66, s44
    v_perm_b32 v83, v78, v74, s44
    ds_write_b128 v13, v[80:83]
    v_add_u32 v14, s29, v0
    s_add_u32 s29, s29, s30
    v_perm_b32 v84, v55, v51, s44
    v_perm_b32 v85, v63, v59, s44
    v_perm_b32 v86, v71, v67, s44
    v_perm_b32 v87, v79, v75, s44
    ds_write_b128 v14, v[84:87]
    s_mov_b32 s29, 40960
    s_mov_b32 s30, 34816
    s_cmp_lt_u32 s21, 2
    s_cselect_b32 s29, 0, s29
    s_cselect_b32 s30, 4096, s30
    s_add_u32 s29, s29, s28
    v_add_u32 v13, s29, v0
    s_add_u32 s29, s29, s30
    v_perm_b32 v80, v52, v48, s45
    v_perm_b32 v81, v60, v56, s45
    v_perm_b32 v82, v68, v64, s45
    v_perm_b32 v83, v76, v72, s45
    ds_write_b128 v13, v[80:83]
    v_add_u32 v14, s29, v0
    s_add_u32 s29, s29, s30
    v_perm_b32 v84, v53, v49, s45
    v_perm_b32 v85, v61, v57, s45
    v_perm_b32 v86, v69, v65, s45
    v_perm_b32 v87, v77, v73, s45
    ds_write_b128 v14, v[84:87]
    v_add_u32 v13, s29, v0
    s_add_u32 s29, s29, s30
    v_perm_b32 v80, v54, v50, s45
    v_perm_b32 v81, v62, v58, s45
    v_perm_b32 v82, v70, v66, s45
    v_perm_b32 v83, v78, v74, s45
    ds_write_b128 v13, v[80:83]
    v_add_u32 v14, s29, v0
    s_add_u32 s29, s29, s30
    v_perm_b32 v84, v55, v51, s45
    v_perm_b32 v85, v63, v59, s45
    v_perm_b32 v86, v71, v67, s45
    v_perm_b32 v87, v79, v75, s45
    ds_write_b128 v14, v[84:87]
    s_cmp_lt_u32 s21, 2
    s_cselect_b32 s26, s49, s49
    s_cselect_b32 s27, 2, 4
    s_cselect_b64 s[88:89], s[76:77], s[76:77]
    s_add_u32 s26, s26, s27
    s_lshl_b32 s27, s26, 18
    s_add_u32 s27, s27, s46
    buffer_load_dwordx4 v[48:51], v12, s[88:91], s27 offen
    s_add_u32 s27, s27, 8192
    buffer_load_dwordx4 v[52:55], v12, s[88:91], s27 offen
    s_add_u32 s27, s27, 8192
    buffer_load_dwordx4 v[56:59], v12, s[88:91], s27 offen
    s_add_u32 s27, s27, 8192
    buffer_load_dwordx4 v[60:63], v12, s[88:91], s27 offen
    s_add_u32 s27, s27, 8192
    buffer_load_dwordx4 v[64:67], v12, s[88:91], s27 offen
    s_add_u32 s27, s27, 8192
    buffer_load_dwordx4 v[68:71], v12, s[88:91], s27 offen
    s_add_u32 s27, s27, 8192
    buffer_load_dwordx4 v[72:75], v12, s[88:91], s27 offen
    s_add_u32 s27, s27, 8192
    buffer_load_dwordx4 v[76:79], v12, s[88:91], s27 offen
    s_waitcnt lgkmcnt(0)
    s_barrier
    ds_read_b128 a[144:147], v6 offset:0
    ds_read_b128 a[148:151], v6 offset:1024
    ds_read_b128 a[136:139], v6 offset:2048
    ds_read_b128 a[140:143], v6 offset:3072
    s_waitcnt lgkmcnt(0)
    s_barrier
    s_and_b32 s28, s21, 1
    s_lshl_b32 s28, s28, 10
    s_mov_b32 s29, 2048
    s_mov_b32 s30, 4096
    s_cmp_lt_u32 s21, 2
    s_cselect_b32 s29, 43008, s29
    s_cselect_b32 s30, 34816, s30
    s_add_u32 s29, s29, s28
    v_add_u32 v13, s29, v0
    s_add_u32 s29, s29, s30
    s_waitcnt vmcnt(14)
    v_perm_b32 v80, v20, v16, s44
    s_waitcnt vmcnt(12)
    v_perm_b32 v81, v28, v24, s44
    s_waitcnt vmcnt(10)
    v_perm_b32 v82, v36, v32, s44
    s_waitcnt vmcnt(8)
    v_perm_b32 v83, v44, v40, s44
    ds_write_b128 v13, v[80:83]
    v_add_u32 v14, s29, v0
    s_add_u32 s29, s29, s30
    v_perm_b32 v84, v21, v17, s44
    v_perm_b32 v85, v29, v25, s44
    v_perm_b32 v86, v37, v33, s44
    v_perm_b32 v87, v45, v41, s44
    ds_write_b128 v14, v[84:87]
    v_add_u32 v13, s29, v0
    s_add_u32 s29, s29, s30
    v_perm_b32 v80, v22, v18, s44
    v_perm_b32 v81, v30, v26, s44
    v_perm_b32 v82, v38, v34, s44
    v_perm_b32 v83, v46, v42, s44
    ds_write_b128 v13, v[80:83]
    v_add_u32 v14, s29, v0
    s_add_u32 s29, s29, s30
    v_perm_b32 v84, v23, v19, s44
    v_perm_b32 v85, v31, v27, s44
    v_perm_b32 v86, v39, v35, s44
    v_perm_b32 v87, v47, v43, s44
    ds_write_b128 v14, v[84:87]
    s_mov_b32 s29, 45056
    s_mov_b32 s30, 34816
    s_cmp_lt_u32 s21, 2
    s_cselect_b32 s29, 0, s29
    s_cselect_b32 s30, 4096, s30
    s_add_u32 s29, s29, s28
    v_add_u32 v13, s29, v0
    s_add_u32 s29, s29, s30
    v_perm_b32 v80, v20, v16, s45
    v_perm_b32 v81, v28, v24, s45
    v_perm_b32 v82, v36, v32, s45
    v_perm_b32 v83, v44, v40, s45
    ds_write_b128 v13, v[80:83]
    v_add_u32 v14, s29, v0
    s_add_u32 s29, s29, s30
    v_perm_b32 v84, v21, v17, s45
    v_perm_b32 v85, v29, v25, s45
    v_perm_b32 v86, v37, v33, s45
    v_perm_b32 v87, v45, v41, s45
    ds_write_b128 v14, v[84:87]
    v_add_u32 v13, s29, v0
    s_add_u32 s29, s29, s30
    v_perm_b32 v80, v22, v18, s45
    v_perm_b32 v81, v30, v26, s45
    v_perm_b32 v82, v38, v34, s45
    v_perm_b32 v83, v46, v42, s45
    ds_write_b128 v13, v[80:83]
    v_add_u32 v14, s29, v0
    s_add_u32 s29, s29, s30
    v_perm_b32 v84, v23, v19, s45
    v_perm_b32 v85, v31, v27, s45
    v_perm_b32 v86, v39, v35, s45
    v_perm_b32 v87, v47, v43, s45
    ds_write_b128 v14, v[84:87]
    s_cmp_lt_u32 s21, 2
    s_cselect_b32 s26, s49, s49
    s_cselect_b32 s27, 8, 0
    s_cselect_b64 s[88:89], s[76:77], s[80:81]
    s_add_u32 s26, s26, s27
    s_lshl_b32 s27, s26, 18
    s_add_u32 s27, s27, s46
    buffer_load_dwordx4 v[16:19], v12, s[88:91], s27 offen
    s_add_u32 s27, s27, 8192
    buffer_load_dwordx4 v[20:23], v12, s[88:91], s27 offen
    s_add_u32 s27, s27, 8192
    buffer_load_dwordx4 v[24:27], v12, s[88:91], s27 offen
    s_add_u32 s27, s27, 8192
    buffer_load_dwordx4 v[28:31], v12, s[88:91], s27 offen
    s_add_u32 s27, s27, 8192
    buffer_load_dwordx4 v[32:35], v12, s[88:91], s27 offen
    s_add_u32 s27, s27, 8192
    buffer_load_dwordx4 v[36:39], v12, s[88:91], s27 offen
    s_add_u32 s27, s27, 8192
    buffer_load_dwordx4 v[40:43], v12, s[88:91], s27 offen
    s_add_u32 s27, s27, 8192
    buffer_load_dwordx4 v[44:47], v12, s[88:91], s27 offen
    s_waitcnt lgkmcnt(0)
    s_barrier
    ds_read_b128 a[112:115], v6 offset:0
    ds_read_b128 a[116:119], v6 offset:1024
    ds_read_b128 a[104:107], v6 offset:2048
    ds_read_b128 a[108:111], v6 offset:3072
    s_waitcnt lgkmcnt(0)
    s_barrier
    s_and_b32 s28, s21, 1
    s_lshl_b32 s28, s28, 10
    s_mov_b32 s29, 2048
    s_mov_b32 s30, 4096
    s_cmp_lt_u32 s21, 2
    s_cselect_b32 s29, 47104, s29
    s_cselect_b32 s30, 34816, s30
    s_add_u32 s29, s29, s28
    v_add_u32 v13, s29, v0
    s_add_u32 s29, s29, s30
    s_waitcnt vmcnt(14)
    v_perm_b32 v80, v52, v48, s44
    s_waitcnt vmcnt(12)
    v_perm_b32 v81, v60, v56, s44
    s_waitcnt vmcnt(10)
    v_perm_b32 v82, v68, v64, s44
    s_waitcnt vmcnt(8)
    v_perm_b32 v83, v76, v72, s44
    ds_write_b128 v13, v[80:83]
    v_add_u32 v14, s29, v0
    s_add_u32 s29, s29, s30
    v_perm_b32 v84, v53, v49, s44
    v_perm_b32 v85, v61, v57, s44
    v_perm_b32 v86, v69, v65, s44
    v_perm_b32 v87, v77, v73, s44
    ds_write_b128 v14, v[84:87]
    v_add_u32 v13, s29, v0
    s_add_u32 s29, s29, s30
    v_perm_b32 v80, v54, v50, s44
    v_perm_b32 v81, v62, v58, s44
    v_perm_b32 v82, v70, v66, s44
    v_perm_b32 v83, v78, v74, s44
    ds_write_b128 v13, v[80:83]
    v_add_u32 v14, s29, v0
    s_add_u32 s29, s29, s30
    v_perm_b32 v84, v55, v51, s44
    v_perm_b32 v85, v63, v59, s44
    v_perm_b32 v86, v71, v67, s44
    v_perm_b32 v87, v79, v75, s44
    ds_write_b128 v14, v[84:87]
    s_mov_b32 s29, 49152
    s_mov_b32 s30, 34816
    s_cmp_lt_u32 s21, 2
    s_cselect_b32 s29, 0, s29
    s_cselect_b32 s30, 4096, s30
    s_add_u32 s29, s29, s28
    v_add_u32 v13, s29, v0
    s_add_u32 s29, s29, s30
    v_perm_b32 v80, v52, v48, s45
    v_perm_b32 v81, v60, v56, s45
    v_perm_b32 v82, v68, v64, s45
    v_perm_b32 v83, v76, v72, s45
    ds_write_b128 v13, v[80:83]
    v_add_u32 v14, s29, v0
    s_add_u32 s29, s29, s30
    v_perm_b32 v84, v53, v49, s45
    v_perm_b32 v85, v61, v57, s45
    v_perm_b32 v86, v69, v65, s45
    v_perm_b32 v87, v77, v73, s45
    ds_write_b128 v14, v[84:87]
    v_add_u32 v13, s29, v0
    s_add_u32 s29, s29, s30
    v_perm_b32 v80, v54, v50, s45
    v_perm_b32 v81, v62, v58, s45
    v_perm_b32 v82, v70, v66, s45
    v_perm_b32 v83, v78, v74, s45
    ds_write_b128 v13, v[80:83]
    v_add_u32 v14, s29, v0
    s_add_u32 s29, s29, s30
    v_perm_b32 v84, v55, v51, s45
    v_perm_b32 v85, v63, v59, s45
    v_perm_b32 v86, v71, v67, s45
    v_perm_b32 v87, v79, v75, s45
    ds_write_b128 v14, v[84:87]
    s_cmp_lt_u32 s21, 2
    s_cselect_b32 s26, s49, s49
    s_cselect_b32 s27, 4, 6
    s_cselect_b64 s[88:89], s[80:81], s[80:81]
    s_add_u32 s26, s26, s27
    s_lshl_b32 s27, s26, 18
    s_add_u32 s27, s27, s46
    buffer_load_dwordx4 v[48:51], v12, s[88:91], s27 offen
    s_add_u32 s27, s27, 8192
    buffer_load_dwordx4 v[52:55], v12, s[88:91], s27 offen
    s_add_u32 s27, s27, 8192
    buffer_load_dwordx4 v[56:59], v12, s[88:91], s27 offen
    s_add_u32 s27, s27, 8192
    buffer_load_dwordx4 v[60:63], v12, s[88:91], s27 offen
    s_add_u32 s27, s27, 8192
    buffer_load_dwordx4 v[64:67], v12, s[88:91], s27 offen
    s_add_u32 s27, s27, 8192
    buffer_load_dwordx4 v[68:71], v12, s[88:91], s27 offen
    s_add_u32 s27, s27, 8192
    buffer_load_dwordx4 v[72:75], v12, s[88:91], s27 offen
    s_add_u32 s27, s27, 8192
    buffer_load_dwordx4 v[76:79], v12, s[88:91], s27 offen
    s_waitcnt lgkmcnt(0)
    s_barrier
    ds_read_b128 a[80:83], v6 offset:0
    ds_read_b128 a[84:87], v6 offset:1024
    ds_read_b128 a[72:75], v6 offset:2048
    ds_read_b128 a[76:79], v6 offset:3072
    s_waitcnt lgkmcnt(0)
    s_barrier
    s_and_b32 s28, s21, 1
    s_lshl_b32 s28, s28, 10
    s_mov_b32 s29, 2048
    s_mov_b32 s30, 4096
    s_cmp_lt_u32 s21, 2
    s_cselect_b32 s29, 51200, s29
    s_cselect_b32 s30, 34816, s30
    s_add_u32 s29, s29, s28
    v_add_u32 v13, s29, v0
    s_add_u32 s29, s29, s30
    s_waitcnt vmcnt(14)
    v_perm_b32 v80, v20, v16, s44
    s_waitcnt vmcnt(12)
    v_perm_b32 v81, v28, v24, s44
    s_waitcnt vmcnt(10)
    v_perm_b32 v82, v36, v32, s44
    s_waitcnt vmcnt(8)
    v_perm_b32 v83, v44, v40, s44
    ds_write_b128 v13, v[80:83]
    v_add_u32 v14, s29, v0
    s_add_u32 s29, s29, s30
    v_perm_b32 v84, v21, v17, s44
    v_perm_b32 v85, v29, v25, s44
    v_perm_b32 v86, v37, v33, s44
    v_perm_b32 v87, v45, v41, s44
    ds_write_b128 v14, v[84:87]
    v_add_u32 v13, s29, v0
    s_add_u32 s29, s29, s30
    v_perm_b32 v80, v22, v18, s44
    v_perm_b32 v81, v30, v26, s44
    v_perm_b32 v82, v38, v34, s44
    v_perm_b32 v83, v46, v42, s44
    ds_write_b128 v13, v[80:83]
    v_add_u32 v14, s29, v0
    s_add_u32 s29, s29, s30
    v_perm_b32 v84, v23, v19, s44
    v_perm_b32 v85, v31, v27, s44
    v_perm_b32 v86, v39, v35, s44
    v_perm_b32 v87, v47, v43, s44
    ds_write_b128 v14, v[84:87]
    s_mov_b32 s29, 53248
    s_mov_b32 s30, 34816
    s_cmp_lt_u32 s21, 2
    s_cselect_b32 s29, 0, s29
    s_cselect_b32 s30, 4096, s30
    s_add_u32 s29, s29, s28
    v_add_u32 v13, s29, v0
    s_add_u32 s29, s29, s30
    v_perm_b32 v80, v20, v16, s45
    v_perm_b32 v81, v28, v24, s45
    v_perm_b32 v82, v36, v32, s45
    v_perm_b32 v83, v44, v40, s45
    ds_write_b128 v13, v[80:83]
    v_add_u32 v14, s29, v0
    s_add_u32 s29, s29, s30
    v_perm_b32 v84, v21, v17, s45
    v_perm_b32 v85, v29, v25, s45
    v_perm_b32 v86, v37, v33, s45
    v_perm_b32 v87, v45, v41, s45
    ds_write_b128 v14, v[84:87]
    v_add_u32 v13, s29, v0
    s_add_u32 s29, s29, s30
    v_perm_b32 v80, v22, v18, s45
    v_perm_b32 v81, v30, v26, s45
    v_perm_b32 v82, v38, v34, s45
    v_perm_b32 v83, v46, v42, s45
    ds_write_b128 v13, v[80:83]
    v_add_u32 v14, s29, v0
    s_add_u32 s29, s29, s30
    v_perm_b32 v84, v23, v19, s45
    v_perm_b32 v85, v31, v27, s45
    v_perm_b32 v86, v39, v35, s45
    v_perm_b32 v87, v47, v43, s45
    ds_write_b128 v14, v[84:87]
    s_waitcnt lgkmcnt(0)
    s_barrier
    ds_read_b128 a[48:51], v6 offset:0
    ds_read_b128 a[52:55], v6 offset:1024
    ds_read_b128 a[40:43], v6 offset:2048
    ds_read_b128 a[44:47], v6 offset:3072
    s_waitcnt lgkmcnt(0)
    s_barrier
    s_and_b32 s28, s21, 1
    s_lshl_b32 s28, s28, 10
    s_mov_b32 s29, 2048
    s_mov_b32 s30, 4096
    s_cmp_lt_u32 s21, 2
    s_cselect_b32 s29, 55296, s29
    s_cselect_b32 s30, 34816, s30
    s_add_u32 s29, s29, s28
    v_add_u32 v13, s29, v0
    s_add_u32 s29, s29, s30
    s_waitcnt vmcnt(6)
    v_perm_b32 v80, v52, v48, s44
    s_waitcnt vmcnt(4)
    v_perm_b32 v81, v60, v56, s44
    s_waitcnt vmcnt(2)
    v_perm_b32 v82, v68, v64, s44
    s_waitcnt vmcnt(0)
    v_perm_b32 v83, v76, v72, s44
    ds_write_b128 v13, v[80:83]
    v_add_u32 v14, s29, v0
    s_add_u32 s29, s29, s30
    v_perm_b32 v84, v53, v49, s44
    v_perm_b32 v85, v61, v57, s44
    v_perm_b32 v86, v69, v65, s44
    v_perm_b32 v87, v77, v73, s44
    ds_write_b128 v14, v[84:87]
    v_add_u32 v13, s29, v0
    s_add_u32 s29, s29, s30
    v_perm_b32 v80, v54, v50, s44
    v_perm_b32 v81, v62, v58, s44
    v_perm_b32 v82, v70, v66, s44
    v_perm_b32 v83, v78, v74, s44
    ds_write_b128 v13, v[80:83]
    v_add_u32 v14, s29, v0
    s_add_u32 s29, s29, s30
    v_perm_b32 v84, v55, v51, s44
    v_perm_b32 v85, v63, v59, s44
    v_perm_b32 v86, v71, v67, s44
    v_perm_b32 v87, v79, v75, s44
    ds_write_b128 v14, v[84:87]
    s_mov_b32 s29, 57344
    s_mov_b32 s30, 34816
    s_cmp_lt_u32 s21, 2
    s_cselect_b32 s29, 0, s29
    s_cselect_b32 s30, 4096, s30
    s_add_u32 s29, s29, s28
    v_add_u32 v13, s29, v0
    s_add_u32 s29, s29, s30
    v_perm_b32 v80, v52, v48, s45
    v_perm_b32 v81, v60, v56, s45
    v_perm_b32 v82, v68, v64, s45
    v_perm_b32 v83, v76, v72, s45
    ds_write_b128 v13, v[80:83]
    v_add_u32 v14, s29, v0
    s_add_u32 s29, s29, s30
    v_perm_b32 v84, v53, v49, s45
    v_perm_b32 v85, v61, v57, s45
    v_perm_b32 v86, v69, v65, s45
    v_perm_b32 v87, v77, v73, s45
    ds_write_b128 v14, v[84:87]
    v_add_u32 v13, s29, v0
    s_add_u32 s29, s29, s30
    v_perm_b32 v80, v54, v50, s45
    v_perm_b32 v81, v62, v58, s45
    v_perm_b32 v82, v70, v66, s45
    v_perm_b32 v83, v78, v74, s45
    ds_write_b128 v13, v[80:83]
    v_add_u32 v14, s29, v0
    s_add_u32 s29, s29, s30
    v_perm_b32 v84, v55, v51, s45
    v_perm_b32 v85, v63, v59, s45
    v_perm_b32 v86, v71, v67, s45
    v_perm_b32 v87, v79, v75, s45
    ds_write_b128 v14, v[84:87]
    s_waitcnt lgkmcnt(0)
    s_barrier
    ds_read_b128 a[16:19], v6 offset:0
    ds_read_b128 a[20:23], v6 offset:1024
    ds_read_b128 a[8:11], v6 offset:2048
    ds_read_b128 a[12:15], v6 offset:3072
    s_waitcnt lgkmcnt(0)
M_lw_done:
    s_cmp_lg_u32 s32, 0
    s_cbranch_scc1 M_role_ok
    s_mov_b32 s32, 1
    s_mov_b32 s30, 0
    v_bfe_u32 v12, v0, 4, 4
    v_lshlrev_b32 v12, 2, v12
M_modepoll:
    buffer_load_dword v13, v12, s[12:15], 0 offen sc1
    s_waitcnt vmcnt(0)
    v_readlane_b32 s31, v13, 8
    s_cmp_eq_u32 s31, 256
    s_cbranch_scc1 M_modegot
    s_sleep 2
    s_add_u32 s30, s30, 1
    s_cmp_lt_u32 s30, 60000
    s_cbranch_scc1 M_modepoll
    s_branch M_fail
M_modegot:
    buffer_load_dword v13, v12, s[12:15], 0 offen sc1
    buffer_load_dword v14, v12, s[12:15], 0 offen offset:128 sc1
    s_waitcnt vmcnt(0)
    v_readlane_b32 s26, v14, 0
    s_mov_b32 s33, 0
    v_readlane_b32 s27, v14, 1
    s_nop 0
    s_cmp_gt_u32 s27, s26
    s_cselect_b32 s33, 8192, s33
    s_max_u32 s26, s26, s27
    v_readlane_b32 s27, v14, 2
    s_nop 0
    s_cmp_gt_u32 s27, s26
    s_cselect_b32 s33, 16384, s33
    s_max_u32 s26, s26, s27
    v_readlane_b32 s27, v14, 3
    s_nop 0
    s_cmp_gt_u32 s27, s26
    s_cselect_b32 s33, 24576, s33
    s_max_u32 s26, s26, s27
    s_xor_b32 s33, s33, 16384
    v_cmp_ne_u32 vcc, 32, v13
    s_and_b32 s31, vcc_lo, 0xff
    s_cmp_lg_u32 s31, 0
    s_cbranch_scc1 M_slowm
    s_cmp_ge_u32 s20, 4
    s_cbranch_scc1 M_loadw
    s_branch M_role_ok
M_slowm:
    s_mov_b32 s23, 1
    s_mov_b32 s31, s25
    v_readlane_b32 s30, v13, 0
    s_cmp_gt_u32 s24, 0
    s_cselect_b32 s30, s30, 0
    s_add_u32 s31, s31, s30
    v_readlane_b32 s30, v13, 1
    s_cmp_gt_u32 s24, 1
    s_cselect_b32 s30, s30, 0
    s_add_u32 s31, s31, s30
    v_readlane_b32 s30, v13, 2
    s_cmp_gt_u32 s24, 2
    s_cselect_b32 s30, s30, 0
    s_add_u32 s31, s31, s30
    v_readlane_b32 s30, v13, 3
    s_cmp_gt_u32 s24, 3
    s_cselect_b32 s30, s30, 0
    s_add_u32 s31, s31, s30
    v_readlane_b32 s30, v13, 4
    s_cmp_gt_u32 s24, 4
    s_cselect_b32 s30, s30, 0
    s_add_u32 s31, s31, s30
    v_readlane_b32 s30, v13, 5
    s_cmp_gt_u32 s24, 5
    s_cselect_b32 s30, s30, 0
    s_add_u32 s31, s31, s30
    v_readlane_b32 s30, v13, 6
    s_cmp_gt_u32 s24, 6
    s_cselect_b32 s30, s30, 0
    s_add_u32 s31, s31, s30
    s_lshr_b32 s20, s31, 5
    s_and_b32 s22, s31, 31
    s_and_b32 s20, s20, 7
    s_and_b32 s22, s22, 31
    s_branch M_loadw
M_role_ok:
    s_mov_b32 s25, s33
    s_cmp_ge_u32 s20, 2
    s_cbranch_scc1 M_bulk
    v_lshrrev_b32 v36, 8, v0
    v_bfe_u32 v37, v0, 4, 4
    v_bfe_u32 v38, v0, 4, 3
    v_bfe_u32 v39, v0, 7, 1
    s_mov_b32 s36, 0x00ff00ff
    s_mov_b32 s37, 0x00ff00ff
    s_not_b64 s[18:19], s[36:37]
    v_mov_b32 v1, 0x4444
    v_mov_b32 v40, 0xeeee
    v_cndmask_b32_e64 v1, v1, v40, s[18:19]
    v_and_b32 v40, 1, v36
    v_lshlrev_b32 v40, 2, v40
    v_lshrrev_b32 v41, 1, v36
    v_add_u32 v40, v40, v41
    v_mul_u32_u24 v40, 288, v40
    v_lshl_add_u32 v40, v37, 2, v40
    s_lshl_b32 s27, s21, 6
    v_add_u32 v2, s27, v40
    v_mul_u32_u24 v40, 288, v38
    v_lshl_add_u32 v3, v36, 4, v40
    s_lshr_b32 s27, s21, 1
    s_lshl_b32 s27, s27, 10
    s_and_b32 s28, s21, 1
    s_lshl_b32 s28, s28, 3
    s_add_u32 s27, s27, s28
    s_add_u32 s27, s27, 13312
    v_and_b32 v40, 0x37f, v0
    v_add_u32 v4, s27, v40
    s_mul_i32 s27, s21, 34816
    s_add_u32 s27, s27, 24576
    v_add_u32 v5, s27, v0
    v_and_b32 v6, 0x200, v0
    v_bfe_u32 v40, v0, 6, 1
    v_lshl_or_b32 v6, v40, 8, v6
    v_bfe_u32 v40, v0, 4, 1
    v_lshl_or_b32 v6, v40, 7, v6
    v_bfe_u32 v40, v0, 5, 1
    v_lshl_or_b32 v6, v40, 6, v6
    v_bfe_u32 v40, v0, 8, 1
    v_lshl_or_b32 v6, v40, 5, v6
    v_bfe_u32 v40, v0, 7, 1
    v_lshl_or_b32 v6, v40, 4, v6
    s_lshl_b32 s27, s21, 13
    s_lshl_b32 s28, s22, 5
    s_add_u32 s27, s27, s28
    s_add_u32 s27, s27, 135168
    v_lshrrev_b32 v40, 7, v0
    v_lshlrev_b32 v40, 10, v40
    v_lshl_add_u32 v40, v38, 2, v40
    v_add_u32 v7, s27, v40
    v_lshrrev_b32 v40, 7, v0
    v_mul_u32_u24 v40, 4224, v40
    v_lshl_add_u32 v8, v38, 4, v40
    v_lshlrev_b32 v9, 3, v0
    s_mul_i32 s34, s20, 671744
    s_add_u32 s34, s34, 172228608
    s_lshl_b32 s35, s21, 10
    s_mul_i32 s27, s22, 4224
    s_add_u32 s35, s35, s27
    s_and_b32 s27, s22, 1
    s_bfe_u32 s28, s22, 0x10001
    s_bfe_u32 s29, s22, 0x10002
    s_lshl_b32 s30, s27, 2
    s_lshl_b32 s31, s28, 1
    s_or_b32 s30, s30, s31
    s_or_b32 s30, s30, s29
    s_and_b32 s31, s22, 0x18
    s_or_b32 s30, s30, s31
    s_lshl_b32 s33, s30, 7
    s_lshl_b32 s32, s22, 7
    s_cmp_eq_u32 s21, 0
    s_cbranch_scc1 M_c_r0
    s_lshl_b32 s32, s22, 10
    s_add_u32 s32, s32, 135168
    s_lshl_b32 s33, s27, 4
    s_lshl_b32 s28, s28, 8
    s_or_b32 s33, s33, s28
    s_lshl_b32 s29, s29, 7
    s_or_b32 s33, s33, s29
    s_bfe_u32 s28, s22, 0x10003
    s_lshl_b32 s28, s28, 5
    s_or_b32 s33, s33, s28
    s_bfe_u32 s28, s22, 0x10004
    s_lshl_b32 s28, s28, 9
    s_or_b32 s33, s33, s28
    s_add_u32 s33, s33, 4096
M_c_r0:
    s_mul_i32 s41, s20, 20480
    s_add_u32 s41, s41, 173572736
    s_lshl_b32 s46, s20, 17
    s_add_u32 s46, s46, 171966464
    s_add_u32 s46, s46, s25
    s_xor_b32 s47, s46, 0x20000
    s_mov_b32 s38, 0x00ff00ff
    s_mov_b32 s39, 0
    s_mov_b32 s62, 0x00030003
    s_mov_b32 s63, 0x00030003
    s_mov_b32 s40, 0x3e0293ee
    s_movk_i32 s45, 0x3f80
    s_mov_b32 s68, 0x33800000
    s_mov_b32 s69, 0x18000000
    s_lshl_b32 s51, s22, 7
    s_add_u32 s52, s51, 167895040
    s_lshl_b32 s51, s22, 8
    s_add_u32 s51, s51, 167886848
    s_mov_b32 s24, 0x3f803f80
    s_mov_b32 s25, 0x3f803f80
    s_mov_b32 s16, 0x3f003f00
    s_mov_b32 s17, 0x3f003f00
    s_lshl_b32 s53, s22, 13
    s_add_u32 s53, s53, 218103808
    s_lshl_b32 s27, s20, 12
    s_add_u32 s53, s53, s27
    s_lshl_b32 s27, s20, 2
    s_add_u32 s52, s52, s27
    s_cmp_eq_u32 s20, 0
    s_cselect_b64 s[42:43], -1, 0
    s_cselect_b64 s[66:67], -1, 0
    s_mov_b32 s44, 0
    s_mov_b32 s54, 0
    s_mov_b32 s71, 0
    s_mov_b32 s4, 0x10000000
    s_mov_b32 s60, 0x10000000
    s_mov_b32 s64, 0x10000000
    s_mov_b32 s65, 0x10000000
    s_waitcnt vmcnt(0) lgkmcnt(0)
    s_barrier
    s_cmp_lg_u32 s23, 0
    s_cbranch_scc1 M_c_slow
    s_cmp_eq_u32 s21, 1
    s_cbranch_scc1 M_c0_1_layer
    s_cmp_eq_u32 s21, 2
    s_cbranch_scc1 M_c0_2_layer
    s_cmp_eq_u32 s21, 3
    s_cbranch_scc1 M_c0_3_layer
M_c0_0_layer:
    s_lshr_b32 s27, s44, 6
    s_mul_i32 s50, s27, 33554432
    s_lshl_b32 s27, s22, 13
    s_add_u32 s50, s50, s27
    s_add_u32 s50, s50, 37748736
    s_barrier
    s_and_b32 s26, s44, 63
    s_lshl_b32 s26, s26, 18
    s_add_u32 s26, s26, s50
    s_add_u32 s3, s26, 16777216
    s_mov_b32 m0, 0
    s_nop 0
    buffer_load_dwordx4 v0, s[8:11], s26 offen offset:0 sc1 lds
    buffer_load_dwordx4 v0, s[8:11], s26 offen offset:1024 sc1 lds
    buffer_load_dwordx4 v[80:83], v0, s[8:11], s3 offen offset:0 sc1
    buffer_load_dwordx4 v[84:87], v0, s[8:11], s3 offen offset:1024 sc1
    s_and_b32 s26, s44, 63
    s_add_u32 s26, s26, 1
    s_min_u32 s26, s26, 63
    s_lshl_b32 s26, s26, 18
    s_add_u32 s26, s26, s50
    s_add_u32 s3, s26, 16777216
    s_mul_i32 s27, s20, 5120
    s_add_u32 s48, s27, 167772160
    s_sub_u32 s49, 167777280, s27
    ds_read_b128 v[56:59], v5 offset:0
    ds_read_b128 v[60:63], v5 offset:1024
    ds_read_b128 v[64:67], v5 offset:2048
    ds_read_b128 v[68:71], v5 offset:3072
    v_mov_b64 v[12:13], 0
    v_mov_b64 v[14:15], 0
    v_mov_b64 v[16:17], 0
    v_mov_b64 v[18:19], 0
    v_mov_b64 v[20:21], 0
    v_mov_b64 v[22:23], 0
    v_mov_b64 v[24:25], 0
    v_mov_b64 v[26:27], 0
    v_mov_b64 v[28:29], 0
    v_mov_b64 v[30:31], 0
    v_mov_b64 v[32:33], 0
    v_mov_b64 v[34:35], 0
    s_mov_b32 s70, 0
    s_waitcnt vmcnt(0) lgkmcnt(0)
M_c0_0_top:
    s_nop 0
    s_barrier
    ds_read_b128 v[36:39], v6 offset:13312
    ds_read_b128 v[40:43], v6 offset:14336
    ds_read_b128 v[44:47], v6 offset:15360
    ds_read_b128 v[48:51], v6 offset:16384
    ds_read_b128 v[52:55], v6 offset:17408
    s_mov_b32 m0, 8192
    s_nop 0
    buffer_load_dwordx4 v0, s[8:11], s49 offen offset:0 sc1 lds
    buffer_load_dwordx4 v0, s[8:11], s49 offen offset:1024 sc1 lds
M_c0_0_lr_r:
    s_waitcnt lgkmcnt(4)
    v_smfmac_f32_16x16x64_bf16 v[20:23], v[36:39], v[56:63], v1
    ds_read_b128 v[56:59], v5 offset:4096
    s_and_b32 s55, s44, 3
    s_mul_i32 s55, s55, 167936
    v_smfmac_f32_16x16x64_bf16 v[24:27], v[36:39], v[64:71], v1
    ds_read_b128 v[64:67], v5 offset:6144
    s_add_u32 s55, s55, s34
    s_add_u32 s56, s55, s35
    v_smfmac_f32_16x16x64_bf16 v[28:31], v[36:39], a[248:255], v1
    ds_read_b128 v[68:71], v5 offset:7168
    s_and_b32 s57, s44, 63
    v_smfmac_f32_16x16x64_bf16 v[32:35], v[36:39], a[240:247], v1
    ds_read_b128 v[60:63], v5 offset:5120
    s_add_u32 s43, s55, s32
    s_waitcnt lgkmcnt(7)
    v_smfmac_f32_16x16x64_bf16 v[20:23], v[40:43], a[232:239], v1
    s_add_u32 s61, s43, 33792
    s_add_u32 s100, s43, 67584
    s_waitcnt lgkmcnt(0)
    v_smfmac_f32_16x16x64_bf16 v[24:27], v[40:43], v[56:63], v1
    ds_read_b128 v[56:59], v5 offset:8192
    s_add_u32 s101, s43, 101376
    v_smfmac_f32_16x16x64_bf16 v[28:31], v[40:43], a[224:231], v1
    ds_read_b128 v[60:63], v5 offset:9216
    v_smfmac_f32_16x16x64_bf16 v[32:35], v[40:43], a[216:223], v1
    v_smfmac_f32_16x16x64_bf16 v[20:23], v[44:47], v[64:71], v1
    ds_read_b128 v[64:67], v5 offset:10240
    v_max3_u32 v10, v36, v40, v44
    v_smfmac_f32_16x16x64_bf16 v[24:27], v[44:47], a[208:215], v1
    ds_read_b128 v[68:71], v5 offset:11264
    v_max3_u32 v10, v10, v48, v52
    v_smfmac_f32_16x16x64_bf16 v[28:31], v[44:47], a[200:207], v1
    s_waitcnt lgkmcnt(2)
    v_cmp_eq_u32 vcc, -1, v10
    v_smfmac_f32_16x16x64_bf16 v[32:35], v[44:47], v[56:63], v1
    ds_read_b128 v[56:59], v5 offset:12288
    s_cbranch_vccnz M_c0_0_lr
    v_smfmac_f32_16x16x64_bf16 v[20:23], v[48:51], a[192:199], v1
    ds_read_b128 v[60:63], v5 offset:13312
    v_smfmac_f32_16x16x64_bf16 v[24:27], v[48:51], a[184:191], v1
    s_waitcnt lgkmcnt(2)
    v_smfmac_f32_16x16x64_bf16 v[28:31], v[48:51], v[64:71], v1
    ds_read_b128 v[64:67], v5 offset:14336
    v_smfmac_f32_16x16x64_bf16 v[32:35], v[48:51], a[176:183], v1
    ds_read_b128 v[68:71], v5 offset:15360
    s_waitcnt vmcnt(0)
    s_barrier
    ds_read_b128 v[36:39], v6 offset:8192
    ds_read_b128 v[40:43], v6 offset:9216
    ds_read_b128 v[44:47], v6 offset:10240
    ds_read_b128 v[48:51], v6 offset:11264
    ds_read_b32 v11, v6 offset:12288
    v_smfmac_f32_16x16x64_bf16 v[20:23], v[52:55], a[168:175], v1
    s_waitcnt lgkmcnt(7)
    v_smfmac_f32_16x16x64_bf16 v[24:27], v[52:55], v[56:63], v1
    ds_read_b128 v[56:59], v5 offset:16384
    v_smfmac_f32_16x16x64_bf16 v[28:31], v[52:55], a[160:167], v1
    ds_read_b128 v[60:63], v5 offset:17408
    s_waitcnt lgkmcnt(4)
    v_max3_u32 v10, v36, v40, v44
    v_smfmac_f32_16x16x64_bf16 v[32:35], v[52:55], a[152:159], v1
    s_waitcnt lgkmcnt(2)
    v_max3_u32 v10, v10, v48, v11
    v_cmp_eq_u32 vcc, -1, v10
    s_cbranch_vccnz M_c0_0_rr
M_c0_0_rr_r:
    ds_read_b128 v[52:55], v6 offset:12288
    s_mov_b64 exec, 0x3ff
    buffer_store_dwordx4 v[72:75], v0, s[8:11], s60 offen sc1
    s_mov_b64 exec, -1
    s_mov_b32 s60, 0x10000000
    s_mov_b32 m0, 23040
    s_nop 0
    buffer_load_dword v9, s[8:11], s3 offen sc1 lds
    buffer_load_dword v9, s[8:11], s26 offen sc1 lds
    v_smfmac_f32_16x16x64_bf16 v[20:23], v[36:39], v[64:71], v1
    ds_read_b128 v[64:67], v5 offset:18432
    v_smfmac_f32_16x16x64_bf16 v[24:27], v[36:39], a[144:151], v1
    ds_read_b128 v[68:71], v5 offset:19456
    v_smfmac_f32_16x16x64_bf16 v[20:23], v[40:43], a[136:143], v1
    s_waitcnt lgkmcnt(3)
    v_smfmac_f32_16x16x64_bf16 v[24:27], v[40:43], v[56:63], v1
    ds_read_b128 v[56:59], v5 offset:20480
    v_smfmac_f32_16x16x64_bf16 v[20:23], v[44:47], a[128:135], v1
    ds_read_b128 v[60:63], v5 offset:21504
    v_smfmac_f32_16x16x64_bf16 v[24:27], v[44:47], a[120:127], v1
    s_waitcnt lgkmcnt(2)
    v_smfmac_f32_16x16x64_bf16 v[20:23], v[48:51], v[64:71], v1
    ds_read_b128 v[64:67], v5 offset:22528
    v_smfmac_f32_16x16x64_bf16 v[24:27], v[48:51], a[112:119], v1
    ds_read_b128 v[68:71], v5 offset:23552
    v_smfmac_f32_16x16x64_bf16 v[20:23], v[52:55], a[104:111], v1
    s_waitcnt lgkmcnt(2)
    v_smfmac_f32_16x16x64_bf16 v[24:27], v[52:55], v[56:63], v1
    ds_read_b128 v[56:59], v5 offset:24576
    v_smfmac_f32_16x16x64_bf16 v[28:31], v[36:39], a[96:103], v1
    ds_read_b128 v[60:63], v5 offset:25600
    v_smfmac_f32_16x16x64_bf16 v[32:35], v[36:39], a[88:95], v1
    s_waitcnt lgkmcnt(2)
    v_mov_b32 v5, v5
    v_mov_b32 v5, v5
    v_permlane32_swap_b32 v20, v21
    v_smfmac_f32_16x16x64_bf16 v[28:31], v[40:43], v[64:71], v1
    ds_read_b128 v[64:67], v5 offset:26624
    v_permlane32_swap_b32 v22, v23
    v_smfmac_f32_16x16x64_bf16 v[32:35], v[40:43], a[80:87], v1
    ds_read_b128 v[68:71], v5 offset:27648
    v_permlane32_swap_b32 v24, v25
    v_smfmac_f32_16x16x64_bf16 v[28:31], v[44:47], a[72:79], v1
    s_waitcnt lgkmcnt(2)
    v_permlane32_swap_b32 v26, v27
    v_smfmac_f32_16x16x64_bf16 v[32:35], v[44:47], v[56:63], v1
    ds_read_b128 v[56:59], v5 offset:28672
    v_add_f32 v20, v20, v21
    v_add_f32 v22, v22, v23
    v_smfmac_f32_16x16x64_bf16 v[28:31], v[48:51], a[64:71], v1
    ds_read_b128 v[60:63], v5 offset:29696
    v_add_f32 v24, v24, v25
    v_add_f32 v26, v26, v27
    v_smfmac_f32_16x16x64_bf16 v[32:35], v[48:51], a[56:63], v1
    s_waitcnt lgkmcnt(2)
    v_mul_f32 v20, s40, v20
    v_mul_f32 v24, s40, v24
    v_smfmac_f32_16x16x64_bf16 v[28:31], v[52:55], v[64:71], v1
    ds_read_b128 v[64:67], v5 offset:30720
    v_mul_f32 v22, s40, v22
    v_mul_f32 v26, s40, v26
    v_smfmac_f32_16x16x64_bf16 v[32:35], v[52:55], a[48:55], v1
    ds_read_b128 v[68:71], v5 offset:31744
    v_cvt_pk_bf16_f32 v20, v20, v24
    v_cvt_pk_bf16_f32 v21, v22, v26
    v_smfmac_f32_16x16x64_bf16 v[12:15], v[36:39], a[40:47], v1
    ds_write_b32 v2, v20 offset:18432
    ds_write_b32 v2, v21 offset:19008
    s_waitcnt lgkmcnt(4)
    v_smfmac_f32_16x16x64_bf16 v[16:19], v[36:39], v[56:63], v1
    ds_read_b128 v[56:59], v5 offset:32768
    v_permlane32_swap_b32 v28, v29
    v_smfmac_f32_16x16x64_bf16 v[12:15], v[40:43], a[32:39], v1
    ds_read_b128 v[60:63], v5 offset:33792
    v_permlane32_swap_b32 v30, v31
    v_smfmac_f32_16x16x64_bf16 v[16:19], v[40:43], a[24:31], v1
    ds_read_b128 v[36:39], v6 offset:13312
    s_waitcnt lgkmcnt(5)
    v_permlane32_swap_b32 v32, v33
    v_smfmac_f32_16x16x64_bf16 v[12:15], v[44:47], v[64:71], v1
    ds_read_b128 v[40:43], v6 offset:14336
    v_permlane32_swap_b32 v34, v35
    v_smfmac_f32_16x16x64_bf16 v[16:19], v[44:47], a[16:23], v1
    ds_read_b128 v[44:47], v6 offset:15360
    v_add_f32 v28, v28, v29
    v_add_f32 v30, v30, v31
    v_smfmac_f32_16x16x64_bf16 v[12:15], v[48:51], a[8:15], v1
    ds_read_b128 v[64:67], v0 offset:2048
    s_waitcnt lgkmcnt(4)
    v_add_f32 v32, v32, v33
    v_add_f32 v34, v34, v35
    v_smfmac_f32_16x16x64_bf16 v[16:19], v[48:51], v[56:63], v1
    ds_read_b128 v[68:71], v0 offset:3072
    v_cvt_pk_bf16_f32 v28, v28, v32
    v_cvt_pk_bf16_f32 v29, v30, v34
    v_smfmac_f32_16x16x64_bf16 v[12:15], v[52:55], a[0:7], v1
    ds_write_b32 v2, v28 offset:20736
    ds_write_b32 v2, v29 offset:21312
    v_smfmac_f32_16x16x64_bf16 v[16:19], v[52:55], v[248:255], v1
    ds_read_b128 v[48:51], v6 offset:16384
    s_waitcnt lgkmcnt(7)
    v_smfmac_f32_16x16x64_bf16 v[12:15], v[36:39], v[240:247], v1
    ds_read_b128 v[56:59], v0 offset:0
    v_smfmac_f32_16x16x64_bf16 v[16:19], v[36:39], v[232:239], v1
    s_waitcnt vmcnt(3) lgkmcnt(2)
    s_barrier
    ds_read_b128 v[20:23], v3 offset:18432
    ds_read_b128 v[24:27], v3 offset:18496
    v_smfmac_f32_16x16x64_bf16 v[12:15], v[40:43], v[224:231], v1
    ds_read_b128 v[28:31], v3 offset:18560
    v_smfmac_f32_16x16x64_bf16 v[16:19], v[40:43], v[216:223], v1
    ds_read_b128 v[32:35], v3 offset:18624
    v_smfmac_f32_16x16x64_bf16 v[12:15], v[44:47], v[208:215], v1
    ds_read_b128 v[60:63], v0 offset:1024
    v_smfmac_f32_16x16x64_bf16 v[16:19], v[44:47], v[200:207], v1
    ds_read_b128 v[52:55], v6 offset:17408
    s_waitcnt lgkmcnt(5)
    v_mfma_f32_16x16x32_bf16 v[36:39], v[56:59], v[20:23], 0
    ds_read_b128 v[56:59], v0 offset:4096
    s_waitcnt lgkmcnt(2)
    v_mfma_f32_16x16x32_bf16 v[36:39], v[60:63], v[24:27], v[36:39]
    ds_read_b128 v[60:63], v0 offset:5120
    v_mfma_f32_16x16x32_bf16 v[36:39], v[64:67], v[28:31], v[36:39]
    ds_read_b128 v[64:67], v0 offset:6144
    v_mfma_f32_16x16x32_bf16 v[36:39], v[68:71], v[32:35], v[36:39]
    ds_read_b128 v[68:71], v0 offset:7168
    v_mov_b64 v[72:73], s[24:25]
    v_smfmac_f32_16x16x64_bf16 v[12:15], v[48:51], v[192:199], v1
    v_mov_b64 v[74:75], s[24:25]
    v_smfmac_f32_16x16x64_bf16 v[16:19], v[48:51], v[184:191], v1
    s_waitcnt lgkmcnt(3)
    v_mov_b64 v[10:11], s[16:17]
    v_mfma_f32_16x16x32_bf16 v[40:43], v[56:59], v[20:23], 0
    ds_read_b128 v[56:59], v3 offset:20736
    s_waitcnt lgkmcnt(3)
    v_exp_f32 v36, v36
    v_mfma_f32_16x16x32_bf16 v[40:43], v[60:63], v[24:27], v[40:43]
    ds_read_b128 v[60:63], v3 offset:20800
    s_waitcnt lgkmcnt(3)
    v_exp_f32 v37, v37
    v_mfma_f32_16x16x32_bf16 v[40:43], v[64:67], v[28:31], v[40:43]
    ds_read_b128 v[64:67], v3 offset:20864
    s_waitcnt lgkmcnt(3)
    v_exp_f32 v38, v38
    v_mfma_f32_16x16x32_bf16 v[40:43], v[68:71], v[32:35], v[40:43]
    ds_read_b128 v[68:71], v3 offset:20928
    v_exp_f32 v39, v39
    v_smfmac_f32_16x16x64_bf16 v[12:15], v[52:55], v[176:183], v1
    v_cvt_pk_bf16_f32 v36, v36, v37
    v_smfmac_f32_16x16x64_bf16 v[16:19], v[52:55], v[168:175], v1
    s_waitcnt lgkmcnt(3)
    v_cvt_pk_bf16_f32 v37, v38, v39
    v_mfma_f32_16x16x32_bf16 v[48:51], v[56:59], v[20:23], 0
    s_waitcnt lgkmcnt(2)
    v_exp_f32 v40, v40
    v_mfma_f32_16x16x32_bf16 v[48:51], v[60:63], v[24:27], v[48:51]
    s_waitcnt lgkmcnt(1)
    v_exp_f32 v41, v41
    v_mfma_f32_16x16x32_bf16 v[48:51], v[64:67], v[28:31], v[48:51]
    s_waitcnt lgkmcnt(0)
    v_exp_f32 v42, v42
    v_mfma_f32_16x16x32_bf16 v[48:51], v[68:71], v[32:35], v[48:51]
    v_exp_f32 v43, v43
    v_cvt_pk_bf16_f32 v38, v40, v41
    v_cvt_pk_bf16_f32 v39, v42, v43
    v_cvt_pk_bf16_f32 v12, v12, v13
    v_cvt_pk_bf16_f32 v13, v14, v15
    v_mfma_f32_16x16x32_bf16 v[28:31], v[72:75], v[36:39], 0
    v_cvt_pk_bf16_f32 v14, v16, v17
    s_nop 0
    v_exp_f32 v48, v48
    v_mfma_f32_16x16x32_bf16 v[20:23], v[80:83], v[36:39], 0
    v_exp_f32 v49, v49
    v_exp_f32 v50, v50
    v_mfma_f32_16x16x32_bf16 v[24:27], v[84:87], v[36:39], 0
    v_exp_f32 v51, v51
    v_cvt_pk_bf16_f32 v48, v48, v49
    v_cvt_pk_bf16_f32 v49, v50, v51
    v_cvt_pk_bf16_f32 v15, v18, v19
M_c0_0_fin:
    s_nop 0
    v_mfma_f32_16x16x16_bf16 v[28:31], v[10:11], v[48:49], v[28:31]
    s_cmp_eq_u32 s57, 63
    v_mfma_f32_16x16x16_bf16 v[20:23], v[12:13], v[48:49], v[20:23]
    ds_write_b128 v0, v[12:15] offset:8192
    v_mfma_f32_16x16x16_bf16 v[24:27], v[14:15], v[48:49], v[24:27]
    s_cbranch_scc1 M_c0_0_last
    v_mov_b64 v[56:57], 0
    v_mov_b64 v[58:59], 0
    s_nop 0
    v_rcp_f32 v30, v28
    v_subrev_u32 v29, s68, v28
    v_pk_mul_f32 v[20:21], v[20:21], v[30:31] op_sel_hi:[1,0]
    v_pk_mul_f32 v[22:23], v[22:23], v[30:31] op_sel_hi:[1,0]
    v_cvt_pk_bf16_f32 v20, v20, v21
    v_cvt_pk_bf16_f32 v21, v22, v23
    v_pk_mul_f32 v[24:25], v[24:25], v[30:31] op_sel_hi:[1,0]
    v_pk_mul_f32 v[26:27], v[26:27], v[30:31] op_sel_hi:[1,0]
    v_cvt_pk_bf16_f32 v22, v24, v25
    v_cvt_pk_bf16_f32 v23, v26, v27
    ds_write2_b64 v4, v[20:21], v[22:23] offset0:0 offset1:16
    v_cmp_lt_u32 vcc, s69, v29
    s_cbranch_vccnz M_c0_0_zbad
M_c0_0_zok:
    buffer_load_dwordx4 v[80:83], v0, s[8:11], s3 offen offset:0 sc1
    buffer_load_dwordx4 v[84:87], v0, s[8:11], s3 offen offset:1024 sc1
    s_waitcnt vmcnt(4) lgkmcnt(0)
    s_barrier
    ds_read_b128 v[40:43], v0 offset:13312
    ds_read_b128 v[48:51], v0 offset:14336
    s_mov_b32 m0, 0
    s_nop 0
    buffer_load_dwordx4 v0, s[8:11], s26 offen offset:0 sc1 lds
    buffer_load_dwordx4 v0, s[8:11], s26 offen offset:1024 sc1 lds
    v_mov_b64 v[60:61], 0
    v_mov_b64 v[62:63], 0
    v_mov_b64 v[64:65], 0
    v_mov_b64 v[66:67], 0
    v_mov_b64 v[68:69], 0
    v_mov_b64 v[70:71], 0
    v_mov_b64 v[52:53], 0
    v_mov_b64 v[54:55], 0
    s_waitcnt lgkmcnt(1)
    v_smfmac_f32_16x16x64_bf16 v[56:59], v[40:43], v[160:167], v1
    v_smfmac_f32_16x16x64_bf16 v[60:63], v[40:43], v[144:151], v1
    s_waitcnt lgkmcnt(0)
    v_smfmac_f32_16x16x64_bf16 v[56:59], v[48:51], v[152:159], v1
    v_smfmac_f32_16x16x64_bf16 v[60:63], v[48:51], v[136:143], v1
    v_smfmac_f32_16x16x64_bf16 v[64:67], v[40:43], v[128:135], v1
    v_smfmac_f32_16x16x64_bf16 v[68:71], v[40:43], v[112:119], v1
    v_permlane32_swap_b32 v56, v57
    v_smfmac_f32_16x16x64_bf16 v[64:67], v[48:51], v[120:127], v1
    v_permlane32_swap_b32 v58, v59
    v_smfmac_f32_16x16x64_bf16 v[68:71], v[48:51], v[104:111], v1
    v_add_f32 v56, v56, v57
    v_add_f32 v58, v58, v59
    v_smfmac_f32_16x16x64_bf16 v[52:55], v[40:43], v[96:103], v1
    v_permlane32_swap_b32 v60, v61
    v_smfmac_f32_16x16x64_bf16 v[52:55], v[48:51], v[88:95], v1
    v_permlane32_swap_b32 v62, v63
    v_add_f32 v60, v60, v61
    v_add_f32 v62, v62, v63
    v_cvt_pk_bf16_f32 v36, v56, v60
    v_cvt_pk_bf16_f32 v38, v58, v62
    v_permlane32_swap_b32 v64, v65
    v_permlane32_swap_b32 v66, v67
    v_add_f32 v64, v64, v65
    v_add_f32 v66, v66, v67
    v_permlane32_swap_b32 v68, v69
    v_permlane32_swap_b32 v70, v71
    v_add_f32 v68, v68, v69
    v_add_f32 v70, v70, v71
    v_cvt_pk_bf16_f32 v37, v64, v68
    v_cvt_pk_bf16_f32 v39, v66, v70
    buffer_store_dwordx4 v[36:39], v0, s[8:11], s56 offen
    v_permlane32_swap_b32 v52, v53
    v_permlane32_swap_b32 v54, v55
    v_add_f32 v52, v52, v53
    v_add_f32 v54, v54, v55
    v_cvt_pk_bf16_f32 v52, v52, v54
    buffer_store_dword v52, v7, s[8:11], s55 offen
    v_and_b32 v32, 16, v0
    v_bfe_u32 v33, v0, 5, 2
    v_lshlrev_b32_e64 v32, v32, s45
    v_cmp_eq_u32_e64 s[64:65], 0, v33
    v_cmp_eq_u32_e64 vcc, 1, v33
    s_add_u32 s27, s44, 1
    s_and_b32 s27, s27, 3
    v_cndmask_b32_e64 v72, 0, v32, s[64:65]
    v_cndmask_b32_e64 v73, 0, v32, vcc
    v_cmp_eq_u32_e64 s[64:65], 2, v33
    v_cmp_eq_u32_e64 vcc, 3, v33
    s_mul_i32 s48, s27, 5120
    s_add_u32 s48, s48, s41
    v_cndmask_b32_e64 v74, 0, v32, s[64:65]
    v_cndmask_b32_e64 v75, 0, v32, vcc
    s_lshl_b32 s27, s27, 15
    s_add_u32 s49, s27, s47
    v_bfe_u32 v11, v0, 4, 3
    v_lshlrev_b32 v11, 3, v11
    v_lshrrev_b32 v32, 8, v0
    v_lshl_add_u32 v11, v32, 6, v11
    s_add_u32 s56, s27, s46
    s_add_u32 s56, s56, s33
    s_add_u32 s58, s48, s33
    v_mov_b32 v5, v5
    s_nop 1
    v_mov_b32 v5, v5
    s_nop 1
    v_mov_b32 v5, v5
    s_nop 1
    v_mov_b32 v5, v5
    s_nop 1
    v_mov_b32 v5, v5
    s_nop 1
    v_mov_b32 v5, v5
    s_nop 1
    v_mov_b32 v5, v5
    v_mov_b32 v5, v5
    buffer_load_dwordx4 v[40:43], v8, s[8:11], s43 offen sc1
    buffer_load_dwordx4 v[44:47], v8, s[8:11], s61 offen sc1
    buffer_load_dwordx4 v[48:51], v8, s[8:11], s100 offen sc1
    buffer_load_dwordx4 v[52:55], v8, s[8:11], s101 offen sc1
    v_mov_b32 v5, v5
    s_nop 1
    v_mov_b32 v5, v5
    s_nop 1
    v_mov_b32 v5, v5
    s_nop 1
    v_mov_b32 v5, v5
    s_nop 1
    v_mov_b32 v5, v5
    s_nop 1
    v_mov_b32 v5, v5
    s_nop 1
    v_mov_b32 v5, v5
    s_nop 1
    v_mov_b32 v5, v5
    s_nop 1
    buffer_load_dwordx4 v[12:15], v8, s[8:11], s43 offen sc1
    buffer_load_dwordx4 v[16:19], v8, s[8:11], s61 offen sc1
    buffer_load_dwordx4 v[20:23], v8, s[8:11], s100 offen sc1
    buffer_load_dwordx4 v[24:27], v8, s[8:11], s101 offen sc1
    v_mov_b32 v5, v5
    s_nop 1
    v_mov_b32 v5, v5
    s_nop 1
    v_mov_b32 v5, v5
    v_mov_b32 v5, v5
    s_waitcnt vmcnt(7)
    v_mfma_f32_16x16x32_bf16 v[76:79], v[72:75], v[40:43], 0
    s_waitcnt vmcnt(6)
    v_mfma_f32_16x16x32_bf16 v[76:79], v[72:75], v[44:47], v[76:79]
    s_waitcnt vmcnt(5)
    v_mfma_f32_16x16x32_bf16 v[76:79], v[72:75], v[48:51], v[76:79]
    s_waitcnt vmcnt(4)
    v_mfma_f32_16x16x32_bf16 v[76:79], v[72:75], v[52:55], v[76:79]
    v_max3_u32 v32, v40, v44, v48
    v_max_u32 v32, v32, v52
    v_cmp_eq_u32 vcc, -1, v32
    s_cbranch_vccnz M_c0_0_wrb_i0
    v_mov_b32 v5, v5
    v_mov_b32 v5, v5
    v_mov_b32 v5, v5
    v_mov_b32 v5, v5
    v_add_f32_dpp v76, v76, v76 row_ror:8 row_mask:0xf bank_mask:0xf
    v_add_f32_dpp v77, v77, v77 row_ror:8 row_mask:0xf bank_mask:0xf
    v_add_f32_dpp v78, v78, v78 row_ror:8 row_mask:0xf bank_mask:0xf
    v_add_f32_dpp v79, v79, v79 row_ror:8 row_mask:0xf bank_mask:0xf
    v_cmp_u_f32 vcc, v76, v76
    v_cvt_pk_bf16_f32 v76, v76, v77
    v_cvt_pk_bf16_f32 v77, v78, v79
    s_cbranch_vccnz M_c0_0_wrb_e0
    s_mov_b64 exec, s[38:39]
    buffer_store_dwordx2 v[76:77], v11, s[8:11], s58 offen
M_c0_0_wrb_d:
    s_barrier
    buffer_store_dwordx2 v[76:77], v11, s[8:11], s56 offen sc1
    s_mov_b64 exec, -1
    s_waitcnt vmcnt(2)
    ds_read_b128 v[56:59], v5 offset:0
    ds_read_b128 v[60:63], v5 offset:1024
    ds_read_b128 v[64:67], v5 offset:2048
    ds_read_b128 v[68:71], v5 offset:3072
    v_mov_b64 v[12:13], 0
    v_mov_b64 v[14:15], 0
    v_mov_b64 v[16:17], 0
    v_mov_b64 v[18:19], 0
    v_mov_b64 v[20:21], 0
    v_mov_b64 v[22:23], 0
    v_mov_b64 v[24:25], 0
    v_mov_b64 v[26:27], 0
    v_mov_b64 v[28:29], 0
    v_mov_b64 v[30:31], 0
    v_mov_b64 v[32:33], 0
    v_mov_b64 v[34:35], 0
    s_and_b32 s26, s44, 63
    s_add_u32 s26, s26, 2
    s_min_u32 s26, s26, 63
    s_lshl_b32 s26, s26, 18
    s_add_u32 s26, s26, s50
    s_add_u32 s3, s26, 16777216
    v_mov_b64 v[72:73], -1
    v_mov_b64 v[74:75], -1
    s_add_u32 s28, s44, 3
    s_and_b32 s29, s28, 3
    s_mul_i32 s31, s22, 160
    s_mul_i32 s28, s29, 167936
    s_add_u32 s28, s28, s34
    s_add_u32 s64, s28, s35
    s_mul_i32 s65, s29, 5120
    s_add_u32 s65, s65, s41
    s_add_u32 s65, s65, s31
    s_lshl_b32 s60, s29, 15
    s_add_u32 s60, s60, s47
    s_add_u32 s60, s60, s31
    s_nop 15
    s_nop 15
    s_nop 15
    s_nop 8
    buffer_store_dwordx4 v[72:75], v0, s[8:11], s64 offen offset:0
    buffer_store_dwordx4 v[72:75], v0, s[8:11], s64 offen offset:1024
    s_mov_b64 exec, 0x3ff
    buffer_store_dwordx4 v[72:75], v0, s[8:11], s65 offen
    s_mov_b64 exec, -1
    s_mov_b32 s65, 0x10000000
    s_mov_b32 s64, 0x10000000
    s_add_u32 s44, s44, 1
    s_mov_b32 s70, 0
    s_waitcnt lgkmcnt(0)
    s_branch M_c0_0_top
M_c0_0_restart:
    s_waitcnt vmcnt(0) lgkmcnt(0)
    s_nop 7
    s_barrier
    ds_read_b128 v[56:59], v5 offset:0
    ds_read_b128 v[60:63], v5 offset:1024
    ds_read_b128 v[64:67], v5 offset:2048
    ds_read_b128 v[68:71], v5 offset:3072
    v_mov_b64 v[12:13], 0
    v_mov_b64 v[14:15], 0
    v_mov_b64 v[16:17], 0
    v_mov_b64 v[18:19], 0
    v_mov_b64 v[20:21], 0
    v_mov_b64 v[22:23], 0
    v_mov_b64 v[24:25], 0
    v_mov_b64 v[26:27], 0
    v_mov_b64 v[28:29], 0
    v_mov_b64 v[30:31], 0
    v_mov_b64 v[32:33], 0
    v_mov_b64 v[34:35], 0
    s_waitcnt vmcnt(0) lgkmcnt(0)
    s_branch M_c0_0_top
M_c0_0_zbad:
    s_cmp_eq_u32 s70, 2
    s_cbranch_scc1 M_c0_0_zok
    v_cmp_u_f32 vcc, v28, v28
    s_cbranch_vccz M_c0_0_exact
    s_cmp_eq_u32 s70, 1
    s_cbranch_scc1 M_c0_0_exact
M_c0_0_vfy0:
    s_mov_b32 s70, 1
    s_mov_b32 s30, 0
    s_waitcnt vmcnt(0) lgkmcnt(0)
    s_nop 7
M_c0_0_vfy:
    v_mov_b32 v10, 0
    s_add_u32 s59, s48, 4096
    buffer_load_dwordx4 v[36:39], v0, s[8:11], s48 offen offset:0 sc1
    buffer_load_dwordx4 v[40:43], v0, s[8:11], s48 offen offset:1024 sc1
    buffer_load_dwordx4 v[44:47], v0, s[8:11], s48 offen offset:2048 sc1
    buffer_load_dwordx4 v[48:51], v0, s[8:11], s48 offen offset:3072 sc1
    buffer_load_dwordx4 v[52:55], v0, s[8:11], s59 offen offset:0 sc1
    s_waitcnt vmcnt(4)
    v_max3_u32 v10, v10, v36, v37
    v_max3_u32 v10, v10, v38, v39
    s_waitcnt vmcnt(3)
    v_max3_u32 v10, v10, v40, v41
    v_max3_u32 v10, v10, v42, v43
    s_waitcnt vmcnt(2)
    v_max3_u32 v10, v10, v44, v45
    v_max3_u32 v10, v10, v46, v47
    s_waitcnt vmcnt(1)
    v_max3_u32 v10, v10, v48, v49
    v_max3_u32 v10, v10, v50, v51
    s_waitcnt vmcnt(0)
    v_max3_u32 v10, v10, v52, v53
    v_max3_u32 v10, v10, v54, v55
    s_add_u32 s59, s49, 4096
    buffer_load_dwordx4 v[36:39], v0, s[8:11], s49 offen offset:0 sc1
    buffer_load_dwordx4 v[40:43], v0, s[8:11], s49 offen offset:1024 sc1
    buffer_load_dwordx4 v[44:47], v0, s[8:11], s49 offen offset:2048 sc1
    buffer_load_dwordx4 v[48:51], v0, s[8:11], s49 offen offset:3072 sc1
    buffer_load_dwordx4 v[52:55], v0, s[8:11], s59 offen offset:0 sc1
    s_waitcnt vmcnt(4)
    v_max3_u32 v10, v10, v36, v37
    v_max3_u32 v10, v10, v38, v39
    s_waitcnt vmcnt(3)
    v_max3_u32 v10, v10, v40, v41
    v_max3_u32 v10, v10, v42, v43
    s_waitcnt vmcnt(2)
    v_max3_u32 v10, v10, v44, v45
    v_max3_u32 v10, v10, v46, v47
    s_waitcnt vmcnt(1)
    v_max3_u32 v10, v10, v48, v49
    v_max3_u32 v10, v10, v50, v51
    s_waitcnt vmcnt(0)
    v_max3_u32 v10, v10, v52, v53
    v_max3_u32 v10, v10, v54, v55
    v_cmp_eq_u32 vcc, -1, v10
    s_cbranch_vccz M_c0_0_restart
    s_add_u32 s30, s30, 1
    s_cmp_ge_u32 s30, 60000
    s_cbranch_scc1 M_fail
    s_branch M_c0_0_vfy
M_c0_0_exact:
    s_nop 7
    s_mov_b32 s70, 2
    s_waitcnt lgkmcnt(0)
    ds_read_b128 v[20:23], v3 offset:18432
    ds_read_b128 v[24:27], v3 offset:18496
    ds_read_b128 v[28:31], v3 offset:18560
    ds_read_b128 v[32:35], v3 offset:18624
    ds_read_b128 v[56:59], v0 offset:0
    s_waitcnt lgkmcnt(0)
    v_mfma_f32_16x16x32_bf16 v[36:39], v[56:59], v[20:23], 0
    s_nop 3
    ds_read_b128 v[60:63], v0 offset:1024
    s_waitcnt lgkmcnt(0)
    v_mfma_f32_16x16x32_bf16 v[36:39], v[60:63], v[24:27], v[36:39]
    s_nop 3
    ds_read_b128 v[56:59], v0 offset:2048
    s_waitcnt lgkmcnt(0)
    v_mfma_f32_16x16x32_bf16 v[36:39], v[56:59], v[28:31], v[36:39]
    s_nop 3
    ds_read_b128 v[60:63], v0 offset:3072
    s_waitcnt lgkmcnt(0)
    v_mfma_f32_16x16x32_bf16 v[36:39], v[60:63], v[32:35], v[36:39]
    s_nop 3
    ds_read_b128 v[56:59], v0 offset:4096
    s_waitcnt lgkmcnt(0)
    v_mfma_f32_16x16x32_bf16 v[40:43], v[56:59], v[20:23], 0
    s_nop 3
    ds_read_b128 v[60:63], v0 offset:5120
    s_waitcnt lgkmcnt(0)
    v_mfma_f32_16x16x32_bf16 v[40:43], v[60:63], v[24:27], v[40:43]
    s_nop 3
    ds_read_b128 v[56:59], v0 offset:6144
    s_waitcnt lgkmcnt(0)
    v_mfma_f32_16x16x32_bf16 v[40:43], v[56:59], v[28:31], v[40:43]
    s_nop 3
    ds_read_b128 v[60:63], v0 offset:7168
    s_waitcnt lgkmcnt(0)
    v_mfma_f32_16x16x32_bf16 v[40:43], v[60:63], v[32:35], v[40:43]
    s_nop 3
    ds_read_b128 v[56:59], v3 offset:20736
    s_waitcnt lgkmcnt(0)
    v_mfma_f32_16x16x32_bf16 v[48:51], v[56:59], v[20:23], 0
    s_nop 3
    ds_read_b128 v[60:63], v3 offset:20800
    s_waitcnt lgkmcnt(0)
    v_mfma_f32_16x16x32_bf16 v[48:51], v[60:63], v[24:27], v[48:51]
    s_nop 3
    ds_read_b128 v[56:59], v3 offset:20864
    s_waitcnt lgkmcnt(0)
    v_mfma_f32_16x16x32_bf16 v[48:51], v[56:59], v[28:31], v[48:51]
    s_nop 3
    ds_read_b128 v[60:63], v3 offset:20928
    s_waitcnt lgkmcnt(0)
    v_mfma_f32_16x16x32_bf16 v[48:51], v[60:63], v[32:35], v[48:51]
    s_nop 3
    v_max3_f32 v64, v36, v37, v38
    v_max3_f32 v64, v64, v39, v40
    v_max3_f32 v64, v64, v41, v42
    s_nop 0
    v_max3_f32 v64, v64, v43, v48
    v_max3_f32 v64, v64, v49, v50
    v_max_f32 v64, v64, v51
    v_mov_b32 v65, v64
    s_nop 1
    v_permlane16_swap_b32 v64, v65
    v_max_f32 v64, v64, v65
    v_mov_b32 v65, v64
    s_nop 1
    v_permlane32_swap_b32 v64, v65
    v_max_f32 v64, v64, v65
    v_sub_f32 v36, v36, v64
    v_exp_f32 v36, v36
    v_sub_f32 v37, v37, v64
    v_exp_f32 v37, v37
    v_sub_f32 v38, v38, v64
    v_exp_f32 v38, v38
    v_sub_f32 v39, v39, v64
    v_exp_f32 v39, v39
    v_sub_f32 v40, v40, v64
    v_exp_f32 v40, v40
    v_sub_f32 v41, v41, v64
    v_exp_f32 v41, v41
    v_sub_f32 v42, v42, v64
    v_exp_f32 v42, v42
    v_sub_f32 v43, v43, v64
    v_exp_f32 v43, v43
    v_sub_f32 v48, v48, v64
    v_exp_f32 v48, v48
    v_sub_f32 v49, v49, v64
    v_exp_f32 v49, v49
    v_sub_f32 v50, v50, v64
    v_exp_f32 v50, v50
    v_sub_f32 v51, v51, v64
    v_exp_f32 v51, v51
    v_cvt_pk_bf16_f32 v36, v36, v37
    v_cvt_pk_bf16_f32 v37, v38, v39
    v_cvt_pk_bf16_f32 v38, v40, v41
    v_cvt_pk_bf16_f32 v39, v42, v43
    v_cvt_pk_bf16_f32 v48, v48, v49
    v_cvt_pk_bf16_f32 v49, v50, v51
    v_mfma_f32_16x16x32_bf16 v[20:23], v[80:83], v[36:39], 0
    v_mfma_f32_16x16x32_bf16 v[24:27], v[84:87], v[36:39], 0
    v_mfma_f32_16x16x32_bf16 v[28:31], v[72:75], v[36:39], 0
    ds_read_b128 v[56:59], v3 offset:20736
    s_waitcnt lgkmcnt(0)
    s_nop 7
    s_branch M_c0_0_fin
M_c0_0_last:
    s_cmp_lg_u32 s70, 0
    s_cbranch_scc1 M_c0_0_last2
    v_cmp_u_f32 vcc, v40, v40
    s_cbranch_vccnz M_c0_0_vfy0
M_c0_0_last2:
    s_waitcnt vmcnt(0) lgkmcnt(0)
    s_barrier
    s_barrier
    s_nop 7
    v_mov_b64 v[72:73], -1
    v_mov_b64 v[74:75], -1
    s_add_u32 s28, s44, 3
    s_and_b32 s29, s28, 3
    s_mul_i32 s31, s22, 160
    s_mul_i32 s28, s29, 167936
    s_add_u32 s28, s28, s34
    s_add_u32 s64, s28, s35
    s_mul_i32 s65, s29, 5120
    s_add_u32 s65, s65, s41
    s_add_u32 s65, s65, s31
    s_lshl_b32 s60, s29, 15
    s_add_u32 s60, s60, s47
    s_add_u32 s60, s60, s31
    buffer_store_dwordx4 v[72:75], v0, s[8:11], s64 offen offset:0
    buffer_store_dwordx4 v[72:75], v0, s[8:11], s64 offen offset:1024
    s_mov_b64 exec, 0x3ff
    buffer_store_dwordx4 v[72:75], v0, s[8:11], s65 offen
    s_mov_b64 exec, -1
    s_mov_b32 s65, 0x10000000
    s_mov_b32 s64, 0x10000000
    s_mov_b64 exec, 0x3ff
    buffer_store_dwordx4 v[72:75], v0, s[8:11], s60 offen sc1
    s_mov_b64 exec, -1
    s_mov_b32 s60, 0x10000000
    s_waitcnt vmcnt(0)
    s_add_u32 s44, s44, 1
    s_cmp_eq_u32 s44, 128
    s_cbranch_scc1 M_end
    s_branch M_c0_0_layer
M_c0_0_lr:
    s_mov_b32 s30, 0
M_c0_0_lr_l:
    s_waitcnt lgkmcnt(0)
    ds_read_b128 v[36:39], v6 offset:13312
    ds_read_b128 v[40:43], v6 offset:14336
    ds_read_b128 v[44:47], v6 offset:15360
    ds_read_b128 v[48:51], v6 offset:16384
    ds_read_b128 v[52:55], v6 offset:17408
    s_waitcnt lgkmcnt(2)
    v_max3_u32 v10, v36, v40, v44
    s_waitcnt lgkmcnt(0)
    v_max3_u32 v10, v10, v48, v52
    v_cmp_eq_u32 vcc, -1, v10
    s_cbranch_vccz M_c0_0_lr_d
    s_add_u32 s30, s30, 1
    s_cmp_ge_u32 s30, 480000
    s_cbranch_scc1 M_fail
    s_branch M_c0_0_lr_l
M_c0_0_lr_d:
    ds_read_b128 v[56:59], v5 offset:0
    ds_read_b128 v[60:63], v5 offset:1024
    ds_read_b128 v[64:67], v5 offset:2048
    ds_read_b128 v[68:71], v5 offset:3072
    v_mov_b64 v[12:13], 0
    v_mov_b64 v[14:15], 0
    v_mov_b64 v[16:17], 0
    v_mov_b64 v[18:19], 0
    v_mov_b64 v[20:21], 0
    v_mov_b64 v[22:23], 0
    v_mov_b64 v[24:25], 0
    v_mov_b64 v[26:27], 0
    v_mov_b64 v[28:29], 0
    v_mov_b64 v[30:31], 0
    v_mov_b64 v[32:33], 0
    v_mov_b64 v[34:35], 0
    s_waitcnt lgkmcnt(0)
    s_branch M_c0_0_lr_r
M_c0_0_rr:
    s_mov_b32 s30, 0
M_c0_0_rr_l:
    s_waitcnt lgkmcnt(0)
    s_and_b32 s27, s30, 1
    s_cbranch_scc1 M_c0_0_rr_n
    s_waitcnt vmcnt(2)
    s_mov_b32 m0, 8192
    s_nop 0
    buffer_load_dwordx4 v0, s[8:11], s49 offen offset:0 sc1 lds
    buffer_load_dwordx4 v0, s[8:11], s49 offen offset:1024 sc1 lds
M_c0_0_rr_n:
    ds_read_b128 v[36:39], v6 offset:8192
    ds_read_b128 v[40:43], v6 offset:9216
    ds_read_b128 v[44:47], v6 offset:10240
    ds_read_b128 v[48:51], v6 offset:11264
    ds_read_b32 v11, v6 offset:12288
    s_waitcnt lgkmcnt(2)
    v_max3_u32 v10, v36, v40, v44
    s_waitcnt lgkmcnt(0)
    v_max3_u32 v10, v10, v48, v11
    v_cmp_eq_u32 vcc, -1, v10
    s_cbranch_vccz M_c0_0_rr_d
    s_add_u32 s30, s30, 1
    s_cmp_ge_u32 s30, 480000
    s_cbranch_scc1 M_fail
    s_branch M_c0_0_rr_l
M_c0_0_rr_d:
    s_branch M_c0_0_rr_r
M_c0_0_wrb_l:
    s_waitcnt vmcnt(4)
    v_mfma_f32_16x16x32_bf16 v[76:79], v[72:75], v[40:43], 0
    v_mfma_f32_16x16x32_bf16 v[76:79], v[72:75], v[44:47], v[76:79]
    v_mfma_f32_16x16x32_bf16 v[76:79], v[72:75], v[48:51], v[76:79]
    v_mfma_f32_16x16x32_bf16 v[76:79], v[72:75], v[52:55], v[76:79]
    v_max3_u32 v32, v40, v44, v48
    v_max_u32 v32, v32, v52
    v_cmp_eq_u32 vcc, -1, v32
    s_cbranch_vccz M_c0_0_wrb_x0
M_c0_0_wrb_i0:
    buffer_load_dwordx4 v[40:43], v8, s[8:11], s43 offen sc1
    buffer_load_dwordx4 v[44:47], v8, s[8:11], s61 offen sc1
    buffer_load_dwordx4 v[48:51], v8, s[8:11], s100 offen sc1
    buffer_load_dwordx4 v[52:55], v8, s[8:11], s101 offen sc1
    s_waitcnt vmcnt(4)
    v_mfma_f32_16x16x32_bf16 v[76:79], v[72:75], v[12:15], 0
    v_mfma_f32_16x16x32_bf16 v[76:79], v[72:75], v[16:19], v[76:79]
    v_mfma_f32_16x16x32_bf16 v[76:79], v[72:75], v[20:23], v[76:79]
    v_mfma_f32_16x16x32_bf16 v[76:79], v[72:75], v[24:27], v[76:79]
    v_max3_u32 v32, v12, v16, v20
    v_max_u32 v32, v32, v24
    v_cmp_eq_u32 vcc, -1, v32
    s_cbranch_vccz M_c0_0_wrb_x1
M_c0_0_wrb_i1:
    buffer_load_dwordx4 v[12:15], v8, s[8:11], s43 offen sc1
    buffer_load_dwordx4 v[16:19], v8, s[8:11], s61 offen sc1
    buffer_load_dwordx4 v[20:23], v8, s[8:11], s100 offen sc1
    buffer_load_dwordx4 v[24:27], v8, s[8:11], s101 offen sc1
    s_add_u32 s71, s71, 1
    s_cmp_lt_u32 s71, 240000
    s_cbranch_scc1 M_c0_0_wrb_l
    s_branch M_fail
M_c0_0_wrb_x0:
    s_nop 3
    v_add_f32_dpp v76, v76, v76 row_ror:8 row_mask:0xf bank_mask:0xf
    v_add_f32_dpp v77, v77, v77 row_ror:8 row_mask:0xf bank_mask:0xf
    v_add_f32_dpp v78, v78, v78 row_ror:8 row_mask:0xf bank_mask:0xf
    v_add_f32_dpp v79, v79, v79 row_ror:8 row_mask:0xf bank_mask:0xf
    v_cmp_u_f32 vcc, v76, v76
    v_cvt_pk_bf16_f32 v76, v76, v77
    v_cvt_pk_bf16_f32 v77, v78, v79
    s_cbranch_vccz M_c0_0_wrb_n
M_c0_0_wrb_e0:
    v_max3_u32 v32, v40, v41, v42
    v_max3_u32 v32, v32, v43, v44
    v_max3_u32 v32, v32, v45, v46
    v_max3_u32 v32, v32, v47, v48
    v_max3_u32 v32, v32, v49, v50
    v_max3_u32 v32, v32, v51, v52
    v_max3_u32 v32, v32, v53, v54
    v_max_u32 v32, v32, v55
    v_cmp_eq_u32 vcc, -1, v32
    s_cbranch_vccnz M_c0_0_wrb_i0
    v_min_u32 v76, -2, v76
    v_min_u32 v77, -2, v77
    s_branch M_c0_0_wrb_n
M_c0_0_wrb_x1:
    s_nop 3
    v_add_f32_dpp v76, v76, v76 row_ror:8 row_mask:0xf bank_mask:0xf
    v_add_f32_dpp v77, v77, v77 row_ror:8 row_mask:0xf bank_mask:0xf
    v_add_f32_dpp v78, v78, v78 row_ror:8 row_mask:0xf bank_mask:0xf
    v_add_f32_dpp v79, v79, v79 row_ror:8 row_mask:0xf bank_mask:0xf
    v_cmp_u_f32 vcc, v76, v76
    v_cvt_pk_bf16_f32 v76, v76, v77
    v_cvt_pk_bf16_f32 v77, v78, v79
    s_cbranch_vccz M_c0_0_wrb_n
M_c0_0_wrb_e1:
    v_max3_u32 v32, v12, v13, v14
    v_max3_u32 v32, v32, v15, v16
    v_max3_u32 v32, v32, v17, v18
    v_max3_u32 v32, v32, v19, v20
    v_max3_u32 v32, v32, v21, v22
    v_max3_u32 v32, v32, v23, v24
    v_max3_u32 v32, v32, v25, v26
    v_max_u32 v32, v32, v27
    v_cmp_eq_u32 vcc, -1, v32
    s_cbranch_vccnz M_c0_0_wrb_i1
    v_min_u32 v76, -2, v76
    v_min_u32 v77, -2, v77
M_c0_0_wrb_n:
    s_mov_b64 exec, s[38:39]
    buffer_store_dwordx2 v[76:77], v11, s[8:11], s58 offen
    s_branch M_c0_0_wrb_d
M_c0_1_layer:
    s_lshr_b32 s27, s44, 6
    s_mul_i32 s50, s27, 33554432
    s_lshl_b32 s27, s22, 13
    s_add_u32 s50, s50, s27
    s_add_u32 s50, s50, 37748736
    s_add_u32 s27, s44, 1
    s_or_b32 s28, s44, 63
    s_add_u32 s28, s28, 1
    s_min_u32 s27, s27, s28
    s_cmp_lt_u32 s54, s27
    s_cbranch_scc1 M_c0_1_p1
M_c0_1_p1_r:
    s_barrier
    s_and_b32 s26, s44, 63
    s_lshl_b32 s26, s26, 18
    s_add_u32 s26, s26, s50
    s_add_u32 s26, s26, 2048
    s_add_u32 s3, s26, 16777216
    s_mov_b32 m0, 2048
    s_nop 0
    buffer_load_dwordx4 v0, s[8:11], s26 offen offset:0 sc1 lds
    buffer_load_dwordx4 v0, s[8:11], s26 offen offset:1024 sc1 lds
    buffer_load_dwordx4 v[80:83], v0, s[8:11], s3 offen offset:0 sc1
    buffer_load_dwordx4 v[84:87], v0, s[8:11], s3 offen offset:1024 sc1
    s_and_b32 s26, s44, 63
    s_add_u32 s26, s26, 1
    s_min_u32 s26, s26, 63
    s_lshl_b32 s26, s26, 18
    s_add_u32 s26, s26, s50
    s_add_u32 s26, s26, 2048
    s_add_u32 s3, s26, 16777216
    s_mul_i32 s27, s20, 5120
    s_add_u32 s48, s27, 167772160
    s_sub_u32 s49, 167777280, s27
    s_add_u32 s27, s44, 2
    s_or_b32 s28, s44, 63
    s_add_u32 s28, s28, 1
    s_min_u32 s27, s27, s28
    s_cmp_lt_u32 s54, s27
    s_cbranch_scc1 M_c0_1_p2
M_c0_1_p2_r:
    ds_read_b128 v[56:59], v5 offset:0
    ds_read_b128 v[60:63], v5 offset:1024
    ds_read_b128 v[64:67], v5 offset:2048
    ds_read_b128 v[68:71], v5 offset:3072
    v_mov_b64 v[12:13], 0
    v_mov_b64 v[14:15], 0
    v_mov_b64 v[16:17], 0
    v_mov_b64 v[18:19], 0
    v_mov_b64 v[20:21], 0
    v_mov_b64 v[22:23], 0
    v_mov_b64 v[24:25], 0
    v_mov_b64 v[26:27], 0
    v_mov_b64 v[28:29], 0
    v_mov_b64 v[30:31], 0
    v_mov_b64 v[32:33], 0
    v_mov_b64 v[34:35], 0
    s_mov_b32 s70, 0
    s_waitcnt vmcnt(0) lgkmcnt(0)
M_c0_1_top:
    s_nop 0
    s_barrier
    ds_read_b128 v[36:39], v6 offset:13312
    ds_read_b128 v[40:43], v6 offset:14336
    ds_read_b128 v[44:47], v6 offset:15360
    ds_read_b128 v[48:51], v6 offset:16384
    ds_read_b128 v[52:55], v6 offset:17408
    s_mov_b32 m0, 8192
    s_nop 0
    buffer_load_dwordx4 v0, s[8:11], s49 offen offset:2048 sc1 lds
M_c0_1_lr_r:
    s_waitcnt lgkmcnt(4)
    v_smfmac_f32_16x16x64_bf16 v[20:23], v[36:39], v[56:63], v1
    ds_read_b128 v[56:59], v5 offset:4096
    s_and_b32 s55, s44, 3
    s_mul_i32 s55, s55, 167936
    v_smfmac_f32_16x16x64_bf16 v[24:27], v[36:39], v[64:71], v1
    ds_read_b128 v[64:67], v5 offset:6144
    s_add_u32 s55, s55, s34
    s_add_u32 s56, s55, s35
    v_smfmac_f32_16x16x64_bf16 v[28:31], v[36:39], a[248:255], v1
    ds_read_b128 v[68:71], v5 offset:7168
    s_and_b32 s57, s44, 63
    v_smfmac_f32_16x16x64_bf16 v[32:35], v[36:39], a[240:247], v1
    ds_read_b128 v[60:63], v5 offset:5120
    s_add_u32 s43, s55, s32
    s_waitcnt lgkmcnt(7)
    v_smfmac_f32_16x16x64_bf16 v[20:23], v[40:43], a[232:239], v1
    s_sub_u32 s27, s57, 1
    s_max_i32 s27, s27, 0
    s_waitcnt lgkmcnt(0)
    v_smfmac_f32_16x16x64_bf16 v[24:27], v[40:43], v[56:63], v1
    ds_read_b128 v[56:59], v5 offset:8192
    s_lshl_b64 s[28:29], 1, s27
    s_lshl_b32 s27, s27, 7
    v_smfmac_f32_16x16x64_bf16 v[28:31], v[40:43], a[224:231], v1
    ds_read_b128 v[60:63], v5 offset:9216
    s_sub_u32 s31, s52, s27
    v_smfmac_f32_16x16x64_bf16 v[32:35], v[40:43], a[216:223], v1
    v_smfmac_f32_16x16x64_bf16 v[20:23], v[44:47], v[64:71], v1
    ds_read_b128 v[64:67], v5 offset:10240
    v_max3_u32 v10, v36, v40, v44
    v_smfmac_f32_16x16x64_bf16 v[24:27], v[44:47], a[208:215], v1
    ds_read_b128 v[68:71], v5 offset:11264
    v_max3_u32 v10, v10, v48, v52
    v_smfmac_f32_16x16x64_bf16 v[28:31], v[44:47], a[200:207], v1
    s_waitcnt lgkmcnt(2)
    v_cmp_eq_u32 vcc, -1, v10
    v_smfmac_f32_16x16x64_bf16 v[32:35], v[44:47], v[56:63], v1
    ds_read_b128 v[56:59], v5 offset:12288
    s_cbranch_vccnz M_c0_1_lr
    v_smfmac_f32_16x16x64_bf16 v[20:23], v[48:51], a[192:199], v1
    ds_read_b128 v[60:63], v5 offset:13312
    v_smfmac_f32_16x16x64_bf16 v[24:27], v[48:51], a[184:191], v1
    s_waitcnt lgkmcnt(2)
    v_smfmac_f32_16x16x64_bf16 v[28:31], v[48:51], v[64:71], v1
    ds_read_b128 v[64:67], v5 offset:14336
    v_smfmac_f32_16x16x64_bf16 v[32:35], v[48:51], a[176:183], v1
    ds_read_b128 v[68:71], v5 offset:15360
    s_waitcnt vmcnt(0)
    s_barrier
    ds_read_b128 v[36:39], v6 offset:8192
    ds_read_b128 v[40:43], v6 offset:9216
    ds_read_b128 v[44:47], v6 offset:10240
    ds_read_b128 v[48:51], v6 offset:11264
    ds_read_b32 v11, v6 offset:12288
    v_smfmac_f32_16x16x64_bf16 v[20:23], v[52:55], a[168:175], v1
    s_waitcnt lgkmcnt(7)
    v_smfmac_f32_16x16x64_bf16 v[24:27], v[52:55], v[56:63], v1
    ds_read_b128 v[56:59], v5 offset:16384
    v_smfmac_f32_16x16x64_bf16 v[28:31], v[52:55], a[160:167], v1
    ds_read_b128 v[60:63], v5 offset:17408
    s_waitcnt lgkmcnt(4)
    v_max3_u32 v10, v36, v40, v44
    v_smfmac_f32_16x16x64_bf16 v[32:35], v[52:55], a[152:159], v1
    s_waitcnt lgkmcnt(2)
    v_max3_u32 v10, v10, v48, v11
    v_cmp_eq_u32 vcc, -1, v10
    s_cbranch_vccnz M_c0_1_rr
M_c0_1_rr_r:
    ds_read_b128 v[52:55], v6 offset:12288
    s_mov_b32 m0, 23296
    s_mov_b64 exec, 3
    buffer_load_dword v9, s[8:11], s51 offen sc1 lds
    s_mov_b64 exec, s[28:29]
    buffer_store_dword v9, v9, s[8:11], s31 offen sc1
    s_mov_b64 exec, -1
    v_smfmac_f32_16x16x64_bf16 v[20:23], v[36:39], v[64:71], v1
    ds_read_b128 v[64:67], v5 offset:18432
    v_smfmac_f32_16x16x64_bf16 v[24:27], v[36:39], a[144:151], v1
    ds_read_b128 v[68:71], v5 offset:19456
    v_smfmac_f32_16x16x64_bf16 v[20:23], v[40:43], a[136:143], v1
    s_waitcnt lgkmcnt(3)
    v_smfmac_f32_16x16x64_bf16 v[24:27], v[40:43], v[56:63], v1
    ds_read_b128 v[56:59], v5 offset:20480
    v_smfmac_f32_16x16x64_bf16 v[20:23], v[44:47], a[128:135], v1
    ds_read_b128 v[60:63], v5 offset:21504
    v_smfmac_f32_16x16x64_bf16 v[24:27], v[44:47], a[120:127], v1
    s_waitcnt lgkmcnt(2)
    v_smfmac_f32_16x16x64_bf16 v[20:23], v[48:51], v[64:71], v1
    ds_read_b128 v[64:67], v5 offset:22528
    v_smfmac_f32_16x16x64_bf16 v[24:27], v[48:51], a[112:119], v1
    ds_read_b128 v[68:71], v5 offset:23552
    v_smfmac_f32_16x16x64_bf16 v[20:23], v[52:55], a[104:111], v1
    s_waitcnt lgkmcnt(2)
    v_smfmac_f32_16x16x64_bf16 v[24:27], v[52:55], v[56:63], v1
    ds_read_b128 v[56:59], v5 offset:24576
    v_smfmac_f32_16x16x64_bf16 v[28:31], v[36:39], a[96:103], v1
    ds_read_b128 v[60:63], v5 offset:25600
    v_smfmac_f32_16x16x64_bf16 v[32:35], v[36:39], a[88:95], v1
    s_waitcnt lgkmcnt(2)
    v_mov_b32 v5, v5
    v_mov_b32 v5, v5
    v_permlane32_swap_b32 v20, v21
    v_smfmac_f32_16x16x64_bf16 v[28:31], v[40:43], v[64:71], v1
    ds_read_b128 v[64:67], v5 offset:26624
    v_permlane32_swap_b32 v22, v23
    v_smfmac_f32_16x16x64_bf16 v[32:35], v[40:43], a[80:87], v1
    ds_read_b128 v[68:71], v5 offset:27648
    v_permlane32_swap_b32 v24, v25
    v_smfmac_f32_16x16x64_bf16 v[28:31], v[44:47], a[72:79], v1
    s_waitcnt lgkmcnt(2)
    v_permlane32_swap_b32 v26, v27
    v_smfmac_f32_16x16x64_bf16 v[32:35], v[44:47], v[56:63], v1
    ds_read_b128 v[56:59], v5 offset:28672
    v_add_f32 v20, v20, v21
    v_add_f32 v22, v22, v23
    v_smfmac_f32_16x16x64_bf16 v[28:31], v[48:51], a[64:71], v1
    ds_read_b128 v[60:63], v5 offset:29696
    v_add_f32 v24, v24, v25
    v_add_f32 v26, v26, v27
    v_smfmac_f32_16x16x64_bf16 v[32:35], v[48:51], a[56:63], v1
    s_waitcnt lgkmcnt(2)
    v_mul_f32 v20, s40, v20
    v_mul_f32 v24, s40, v24
    v_smfmac_f32_16x16x64_bf16 v[28:31], v[52:55], v[64:71], v1
    ds_read_b128 v[64:67], v5 offset:30720
    v_mul_f32 v22, s40, v22
    v_mul_f32 v26, s40, v26
    v_smfmac_f32_16x16x64_bf16 v[32:35], v[52:55], a[48:55], v1
    ds_read_b128 v[68:71], v5 offset:31744
    v_cvt_pk_bf16_f32 v20, v20, v24
    v_cvt_pk_bf16_f32 v21, v22, v26
    v_smfmac_f32_16x16x64_bf16 v[12:15], v[36:39], a[40:47], v1
    ds_write_b32 v2, v20 offset:18432
    ds_write_b32 v2, v21 offset:19008
    s_waitcnt lgkmcnt(4)
    v_smfmac_f32_16x16x64_bf16 v[16:19], v[36:39], v[56:63], v1
    ds_read_b128 v[56:59], v5 offset:32768
    v_permlane32_swap_b32 v28, v29
    v_smfmac_f32_16x16x64_bf16 v[12:15], v[40:43], a[32:39], v1
    ds_read_b128 v[60:63], v5 offset:33792
    v_permlane32_swap_b32 v30, v31
    v_smfmac_f32_16x16x64_bf16 v[16:19], v[40:43], a[24:31], v1
    ds_read_b128 v[36:39], v6 offset:13312
    s_waitcnt lgkmcnt(5)
    v_permlane32_swap_b32 v32, v33
    v_smfmac_f32_16x16x64_bf16 v[12:15], v[44:47], v[64:71], v1
    ds_read_b128 v[40:43], v6 offset:14336
    v_permlane32_swap_b32 v34, v35
    v_smfmac_f32_16x16x64_bf16 v[16:19], v[44:47], a[16:23], v1
    ds_read_b128 v[44:47], v6 offset:15360
    v_add_f32 v28, v28, v29
    v_add_f32 v30, v30, v31
    v_smfmac_f32_16x16x64_bf16 v[12:15], v[48:51], a[8:15], v1
    ds_read_b128 v[64:67], v0 offset:2048
    s_waitcnt lgkmcnt(4)
    v_add_f32 v32, v32, v33
    v_add_f32 v34, v34, v35
    v_smfmac_f32_16x16x64_bf16 v[16:19], v[48:51], v[56:63], v1
    ds_read_b128 v[68:71], v0 offset:3072
    v_cvt_pk_bf16_f32 v28, v28, v32
    v_cvt_pk_bf16_f32 v29, v30, v34
    v_smfmac_f32_16x16x64_bf16 v[12:15], v[52:55], a[0:7], v1
    ds_write_b32 v2, v28 offset:20736
    ds_write_b32 v2, v29 offset:21312
    v_smfmac_f32_16x16x64_bf16 v[16:19], v[52:55], v[248:255], v1
    ds_read_b128 v[48:51], v6 offset:16384
    s_waitcnt lgkmcnt(7)
    v_smfmac_f32_16x16x64_bf16 v[12:15], v[36:39], v[240:247], v1
    ds_read_b128 v[56:59], v0 offset:0
    v_smfmac_f32_16x16x64_bf16 v[16:19], v[36:39], v[232:239], v1
    s_waitcnt vmcnt(2) lgkmcnt(2)
    s_barrier
    ds_read_b128 v[20:23], v3 offset:18432
    ds_read_b128 v[24:27], v3 offset:18496
    v_smfmac_f32_16x16x64_bf16 v[12:15], v[40:43], v[224:231], v1
    ds_read_b128 v[28:31], v3 offset:18560
    v_smfmac_f32_16x16x64_bf16 v[16:19], v[40:43], v[216:223], v1
    ds_read_b128 v[32:35], v3 offset:18624
    v_smfmac_f32_16x16x64_bf16 v[12:15], v[44:47], v[208:215], v1
    ds_read_b128 v[60:63], v0 offset:1024
    v_smfmac_f32_16x16x64_bf16 v[16:19], v[44:47], v[200:207], v1
    ds_read_b128 v[52:55], v6 offset:17408
    s_waitcnt lgkmcnt(5)
    v_mfma_f32_16x16x32_bf16 v[36:39], v[56:59], v[20:23], 0
    ds_read_b128 v[56:59], v0 offset:4096
    s_waitcnt lgkmcnt(2)
    v_mfma_f32_16x16x32_bf16 v[36:39], v[60:63], v[24:27], v[36:39]
    ds_read_b128 v[60:63], v0 offset:5120
    v_mfma_f32_16x16x32_bf16 v[36:39], v[64:67], v[28:31], v[36:39]
    ds_read_b128 v[64:67], v0 offset:6144
    v_mfma_f32_16x16x32_bf16 v[36:39], v[68:71], v[32:35], v[36:39]
    ds_read_b128 v[68:71], v0 offset:7168
    v_mov_b64 v[72:73], s[24:25]
    v_smfmac_f32_16x16x64_bf16 v[12:15], v[48:51], v[192:199], v1
    v_mov_b64 v[74:75], s[24:25]
    v_smfmac_f32_16x16x64_bf16 v[16:19], v[48:51], v[184:191], v1
    s_waitcnt lgkmcnt(3)
    v_mov_b64 v[10:11], s[16:17]
    v_mfma_f32_16x16x32_bf16 v[40:43], v[56:59], v[20:23], 0
    ds_read_b128 v[56:59], v3 offset:20736
    s_waitcnt lgkmcnt(3)
    v_exp_f32 v36, v36
    v_mfma_f32_16x16x32_bf16 v[40:43], v[60:63], v[24:27], v[40:43]
    ds_read_b128 v[60:63], v3 offset:20800
    s_waitcnt lgkmcnt(3)
    v_exp_f32 v37, v37
    v_mfma_f32_16x16x32_bf16 v[40:43], v[64:67], v[28:31], v[40:43]
    ds_read_b128 v[64:67], v3 offset:20864
    s_waitcnt lgkmcnt(3)
    v_exp_f32 v38, v38
    v_mfma_f32_16x16x32_bf16 v[40:43], v[68:71], v[32:35], v[40:43]
    ds_read_b128 v[68:71], v3 offset:20928
    v_exp_f32 v39, v39
    v_smfmac_f32_16x16x64_bf16 v[12:15], v[52:55], v[176:183], v1
    v_cvt_pk_bf16_f32 v36, v36, v37
    v_smfmac_f32_16x16x64_bf16 v[16:19], v[52:55], v[168:175], v1
    s_waitcnt lgkmcnt(3)
    v_cvt_pk_bf16_f32 v37, v38, v39
    v_mfma_f32_16x16x32_bf16 v[48:51], v[56:59], v[20:23], 0
    s_waitcnt lgkmcnt(2)
    v_exp_f32 v40, v40
    v_mfma_f32_16x16x32_bf16 v[48:51], v[60:63], v[24:27], v[48:51]
    s_waitcnt lgkmcnt(1)
    v_exp_f32 v41, v41
    v_mfma_f32_16x16x32_bf16 v[48:51], v[64:67], v[28:31], v[48:51]
    s_waitcnt lgkmcnt(0)
    v_exp_f32 v42, v42
    v_mfma_f32_16x16x32_bf16 v[48:51], v[68:71], v[32:35], v[48:51]
    v_exp_f32 v43, v43
    v_cvt_pk_bf16_f32 v38, v40, v41
    v_cvt_pk_bf16_f32 v39, v42, v43
    v_cvt_pk_bf16_f32 v12, v12, v13
    v_cvt_pk_bf16_f32 v13, v14, v15
    v_mfma_f32_16x16x32_bf16 v[28:31], v[72:75], v[36:39], 0
    v_cvt_pk_bf16_f32 v14, v16, v17
    s_nop 0
    v_exp_f32 v48, v48
    v_mfma_f32_16x16x32_bf16 v[20:23], v[80:83], v[36:39], 0
    v_exp_f32 v49, v49
    v_exp_f32 v50, v50
    v_mfma_f32_16x16x32_bf16 v[24:27], v[84:87], v[36:39], 0
    v_exp_f32 v51, v51
    v_cvt_pk_bf16_f32 v48, v48, v49
    v_cvt_pk_bf16_f32 v49, v50, v51
    v_cvt_pk_bf16_f32 v15, v18, v19
M_c0_1_fin:
    s_nop 0
    v_mfma_f32_16x16x16_bf16 v[28:31], v[10:11], v[48:49], v[28:31]
    s_cmp_eq_u32 s57, 63
    v_mfma_f32_16x16x16_bf16 v[20:23], v[12:13], v[48:49], v[20:23]
    ds_write_b128 v0, v[12:15] offset:9216
    v_mfma_f32_16x16x16_bf16 v[24:27], v[14:15], v[48:49], v[24:27]
    s_cbranch_scc1 M_c0_1_last
    v_mov_b64 v[56:57], 0
    v_mov_b64 v[58:59], 0
    s_nop 0
    v_rcp_f32 v30, v28
    v_subrev_u32 v29, s68, v28
    v_pk_mul_f32 v[20:21], v[20:21], v[30:31] op_sel_hi:[1,0]
    v_pk_mul_f32 v[22:23], v[22:23], v[30:31] op_sel_hi:[1,0]
    v_cvt_pk_bf16_f32 v20, v20, v21
    v_cvt_pk_bf16_f32 v21, v22, v23
    v_pk_mul_f32 v[24:25], v[24:25], v[30:31] op_sel_hi:[1,0]
    v_pk_mul_f32 v[26:27], v[26:27], v[30:31] op_sel_hi:[1,0]
    v_cvt_pk_bf16_f32 v22, v24, v25
    v_cvt_pk_bf16_f32 v23, v26, v27
    ds_write2_b64 v4, v[20:21], v[22:23] offset0:0 offset1:16
    v_cmp_lt_u32 vcc, s69, v29
    s_cbranch_vccnz M_c0_1_zbad
M_c0_1_zok:
    buffer_load_dwordx4 v[80:83], v0, s[8:11], s3 offen offset:0 sc1
    buffer_load_dwordx4 v[84:87], v0, s[8:11], s3 offen offset:1024 sc1
    s_waitcnt lgkmcnt(0)
    s_barrier
    ds_read_b128 v[40:43], v0 offset:13312
    ds_read_b128 v[48:51], v0 offset:14336
    s_mov_b32 m0, 2048
    s_nop 0
    buffer_load_dwordx4 v0, s[8:11], s26 offen offset:0 sc1 lds
    buffer_load_dwordx4 v0, s[8:11], s26 offen offset:1024 sc1 lds
    v_mov_b64 v[60:61], 0
    v_mov_b64 v[62:63], 0
    v_mov_b64 v[64:65], 0
    v_mov_b64 v[66:67], 0
    v_mov_b64 v[68:69], 0
    v_mov_b64 v[70:71], 0
    v_mov_b64 v[52:53], 0
    v_mov_b64 v[54:55], 0
    s_waitcnt lgkmcnt(1)
    v_smfmac_f32_16x16x64_bf16 v[56:59], v[40:43], v[160:167], v1
    v_smfmac_f32_16x16x64_bf16 v[60:63], v[40:43], v[144:151], v1
    s_waitcnt lgkmcnt(0)
    v_smfmac_f32_16x16x64_bf16 v[56:59], v[48:51], v[152:159], v1
    v_smfmac_f32_16x16x64_bf16 v[60:63], v[48:51], v[136:143], v1
    v_smfmac_f32_16x16x64_bf16 v[64:67], v[40:43], v[128:135], v1
    v_smfmac_f32_16x16x64_bf16 v[68:71], v[40:43], v[112:119], v1
    v_permlane32_swap_b32 v56, v57
    v_smfmac_f32_16x16x64_bf16 v[64:67], v[48:51], v[120:127], v1
    v_permlane32_swap_b32 v58, v59
    v_smfmac_f32_16x16x64_bf16 v[68:71], v[48:51], v[104:111], v1
    v_add_f32 v56, v56, v57
    v_add_f32 v58, v58, v59
    v_smfmac_f32_16x16x64_bf16 v[52:55], v[40:43], v[96:103], v1
    v_permlane32_swap_b32 v60, v61
    v_smfmac_f32_16x16x64_bf16 v[52:55], v[48:51], v[88:95], v1
    v_permlane32_swap_b32 v62, v63
    v_add_f32 v60, v60, v61
    v_add_f32 v62, v62, v63
    v_cvt_pk_bf16_f32 v36, v56, v60
    v_cvt_pk_bf16_f32 v38, v58, v62
    v_permlane32_swap_b32 v64, v65
    v_permlane32_swap_b32 v66, v67
    v_add_f32 v64, v64, v65
    v_add_f32 v66, v66, v67
    v_permlane32_swap_b32 v68, v69
    v_permlane32_swap_b32 v70, v71
    v_add_f32 v68, v68, v69
    v_add_f32 v70, v70, v71
    v_cvt_pk_bf16_f32 v37, v64, v68
    v_cvt_pk_bf16_f32 v39, v66, v70
    buffer_store_dwordx4 v[36:39], v0, s[8:11], s56 offen
    v_permlane32_swap_b32 v52, v53
    v_permlane32_swap_b32 v54, v55
    v_add_f32 v52, v52, v53
    v_add_f32 v54, v54, v55
    v_cvt_pk_bf16_f32 v52, v52, v54
    buffer_store_dword v52, v7, s[8:11], s55 offen
    v_bfe_u32 v34, v0, 4, 1
    v_bfe_u32 v33, v0, 7, 1
    v_lshl_add_u32 v33, v33, 1, v34
    v_bfe_u32 v32, v0, 6, 1
    v_lshlrev_b32 v32, 4, v32
    v_lshlrev_b32_e64 v32, v32, s45
    v_cmp_eq_u32_e64 s[64:65], 0, v33
    v_cmp_eq_u32_e64 vcc, 1, v33
    s_add_u32 s27, s44, 1
    s_and_b32 s27, s27, 3
    v_cndmask_b32_e64 v72, 0, v32, s[64:65]
    v_cndmask_b32_e64 v73, 0, v32, vcc
    v_cmp_eq_u32_e64 s[64:65], 2, v33
    v_cmp_eq_u32_e64 vcc, 3, v33
    s_mul_i32 s48, s27, 5120
    s_add_u32 s48, s48, s41
    v_cndmask_b32_e64 v74, 0, v32, s[64:65]
    v_cndmask_b32_e64 v75, 0, v32, vcc
    s_lshl_b32 s27, s27, 15
    s_add_u32 s49, s27, s47
    v_bfe_u32 v32, v0, 8, 1
    v_lshlrev_b32 v11, 6, v32
    v_lshl_add_u32 v11, v34, 3, v11
    v_lshrrev_b32 v33, 9, v0
    v_lshl_add_u32 v11, v33, 2, v11
    s_add_u32 s56, s27, s46
    s_add_u32 s56, s56, s33
    s_add_u32 s58, s48, s33
    v_mov_b32 v5, v5
    s_nop 1
    v_mov_b32 v5, v5
    s_nop 1
    v_mov_b32 v5, v5
    s_nop 1
    v_mov_b32 v5, v5
    s_nop 1
    v_mov_b32 v5, v5
    s_nop 1
    v_mov_b32 v5, v5
    s_nop 1
    v_mov_b32 v5, v5
    v_mov_b32 v5, v5
    buffer_load_dwordx4 v[40:43], v0, s[8:11], s43 offen sc1
    v_mov_b32 v5, v5
    s_nop 1
    v_mov_b32 v5, v5
    s_nop 1
    v_mov_b32 v5, v5
    s_nop 1
    v_mov_b32 v5, v5
    s_nop 1
    v_mov_b32 v5, v5
    s_nop 1
    v_mov_b32 v5, v5
    s_nop 1
    v_mov_b32 v5, v5
    s_nop 1
    v_mov_b32 v5, v5
    s_nop 1
    v_mov_b32 v5, v5
    s_nop 1
    v_mov_b32 v5, v5
    s_nop 1
    v_mov_b32 v5, v5
    s_nop 1
    v_mov_b32 v5, v5
    s_nop 1
    v_mov_b32 v5, v5
    v_mov_b32 v5, v5
    buffer_load_dwordx4 v[44:47], v0, s[8:11], s43 offen sc1
    v_mov_b32 v5, v5
    s_nop 1
    v_mov_b32 v5, v5
    s_nop 1
    v_mov_b32 v5, v5
    v_mov_b32 v5, v5
    s_waitcnt vmcnt(1)
    v_mfma_f32_16x16x32_bf16 v[76:79], v[72:75], v[40:43], 0
    v_cmp_eq_u32 vcc, -1, v40
    s_cbranch_vccnz M_c0_1_wrb_i0
    v_mov_b32 v5, v5
    v_mov_b32 v5, v5
    v_mov_b32 v5, v5
    v_mov_b32 v5, v5
    v_mov_b32 v5, v5
    v_mov_b32 v5, v5
    v_add_f32_dpp v76, v76, v76 row_ror:8 row_mask:0xf bank_mask:0xf
    v_add_f32_dpp v77, v77, v77 row_ror:8 row_mask:0xf bank_mask:0xf
    s_nop 0
    v_add_f32_dpp v76, v76, v76 row_ror:4 row_mask:0xf bank_mask:0xf
    v_add_f32_dpp v77, v77, v77 row_ror:4 row_mask:0xf bank_mask:0xf
    s_nop 0
    v_add_f32_dpp v76, v76, v76 row_ror:2 row_mask:0xf bank_mask:0xf
    v_add_f32_dpp v77, v77, v77 row_ror:2 row_mask:0xf bank_mask:0xf
    v_cmp_u_f32 vcc, v76, v76
    v_cvt_pk_bf16_f32 v76, v76, v77
    s_cbranch_vccnz M_c0_1_wrb_e0
    s_mov_b64 exec, s[62:63]
    buffer_store_dword v76, v11, s[8:11], s58 offen
M_c0_1_wrb_d:
    s_barrier
    buffer_store_dword v76, v11, s[8:11], s56 offen sc1
    s_mov_b64 exec, -1
    s_waitcnt vmcnt(2)
    ds_read_b128 v[56:59], v5 offset:0
    ds_read_b128 v[60:63], v5 offset:1024
    ds_read_b128 v[64:67], v5 offset:2048
    ds_read_b128 v[68:71], v5 offset:3072
    v_mov_b64 v[12:13], 0
    v_mov_b64 v[14:15], 0
    v_mov_b64 v[16:17], 0
    v_mov_b64 v[18:19], 0
    v_mov_b64 v[20:21], 0
    v_mov_b64 v[22:23], 0
    v_mov_b64 v[24:25], 0
    v_mov_b64 v[26:27], 0
    v_mov_b64 v[28:29], 0
    v_mov_b64 v[30:31], 0
    v_mov_b64 v[32:33], 0
    v_mov_b64 v[34:35], 0
    s_and_b32 s26, s44, 63
    s_add_u32 s26, s26, 2
    s_min_u32 s26, s26, 63
    s_lshl_b32 s26, s26, 18
    s_add_u32 s26, s26, s50
    s_add_u32 s26, s26, 2048
    s_add_u32 s3, s26, 16777216
    v_mov_b64 v[72:73], -1
    v_mov_b64 v[74:75], -1
    s_add_u32 s28, s44, 3
    s_and_b32 s29, s28, 3
    s_mul_i32 s31, s22, 160
    s_mul_i32 s28, s29, 167936
    s_add_u32 s28, s28, s34
    s_add_u32 s64, s28, s35
    s_lshl_b32 s65, s22, 10
    s_add_u32 s65, s65, s28
    s_add_u32 s65, s65, 135168
    ds_read_b64 v[78:79], v0 offset:23296
    s_waitcnt lgkmcnt(0)
    v_min_u32 v78, v78, v79
    s_nop 0
    v_readfirstlane_b32 s28, v78
    s_nop 0
    s_max_u32 s54, s54, s28
    s_add_u32 s27, s44, 3
    s_or_b32 s28, s44, 63
    s_add_u32 s28, s28, 1
    s_min_u32 s27, s27, s28
    s_cmp_lt_u32 s54, s27
    s_cbranch_scc1 M_c0_1_wkw
M_c0_1_wkw_r:
    s_nop 15
    s_nop 15
    s_nop 13
    buffer_store_dwordx4 v[72:75], v0, s[8:11], s64 offen offset:1024
    buffer_store_dwordx4 v[72:75], v0, s[8:11], s64 offen offset:2048
    buffer_store_dwordx4 v[72:75], v0, s[8:11], s65 offen
    s_mov_b32 s65, 0x10000000
    s_mov_b32 s64, 0x10000000
    s_add_u32 s44, s44, 1
    s_mov_b32 s70, 0
    s_branch M_c0_1_top
M_c0_1_restart:
    s_waitcnt vmcnt(0) lgkmcnt(0)
    s_nop 7
    s_barrier
    ds_read_b128 v[56:59], v5 offset:0
    ds_read_b128 v[60:63], v5 offset:1024
    ds_read_b128 v[64:67], v5 offset:2048
    ds_read_b128 v[68:71], v5 offset:3072
    v_mov_b64 v[12:13], 0
    v_mov_b64 v[14:15], 0
    v_mov_b64 v[16:17], 0
    v_mov_b64 v[18:19], 0
    v_mov_b64 v[20:21], 0
    v_mov_b64 v[22:23], 0
    v_mov_b64 v[24:25], 0
    v_mov_b64 v[26:27], 0
    v_mov_b64 v[28:29], 0
    v_mov_b64 v[30:31], 0
    v_mov_b64 v[32:33], 0
    v_mov_b64 v[34:35], 0
    s_waitcnt vmcnt(0) lgkmcnt(0)
    s_branch M_c0_1_top
M_c0_1_zbad:
    s_cmp_eq_u32 s70, 2
    s_cbranch_scc1 M_c0_1_zok
    v_cmp_u_f32 vcc, v28, v28
    s_cbranch_vccz M_c0_1_exact
    s_cmp_eq_u32 s70, 1
    s_cbranch_scc1 M_c0_1_exact
M_c0_1_vfy0:
    s_mov_b32 s70, 1
    s_mov_b32 s30, 0
    s_waitcnt vmcnt(0) lgkmcnt(0)
    s_nop 7
M_c0_1_vfy:
    v_mov_b32 v10, 0
    s_add_u32 s59, s48, 4096
    buffer_load_dwordx4 v[36:39], v0, s[8:11], s48 offen offset:0 sc1
    buffer_load_dwordx4 v[40:43], v0, s[8:11], s48 offen offset:1024 sc1
    buffer_load_dwordx4 v[44:47], v0, s[8:11], s48 offen offset:2048 sc1
    buffer_load_dwordx4 v[48:51], v0, s[8:11], s48 offen offset:3072 sc1
    buffer_load_dwordx4 v[52:55], v0, s[8:11], s59 offen offset:0 sc1
    s_waitcnt vmcnt(4)
    v_max3_u32 v10, v10, v36, v37
    v_max3_u32 v10, v10, v38, v39
    s_waitcnt vmcnt(3)
    v_max3_u32 v10, v10, v40, v41
    v_max3_u32 v10, v10, v42, v43
    s_waitcnt vmcnt(2)
    v_max3_u32 v10, v10, v44, v45
    v_max3_u32 v10, v10, v46, v47
    s_waitcnt vmcnt(1)
    v_max3_u32 v10, v10, v48, v49
    v_max3_u32 v10, v10, v50, v51
    s_waitcnt vmcnt(0)
    v_max3_u32 v10, v10, v52, v53
    v_max3_u32 v10, v10, v54, v55
    s_add_u32 s59, s49, 4096
    buffer_load_dwordx4 v[36:39], v0, s[8:11], s49 offen offset:0 sc1
    buffer_load_dwordx4 v[40:43], v0, s[8:11], s49 offen offset:1024 sc1
    buffer_load_dwordx4 v[44:47], v0, s[8:11], s49 offen offset:2048 sc1
    buffer_load_dwordx4 v[48:51], v0, s[8:11], s49 offen offset:3072 sc1
    buffer_load_dwordx4 v[52:55], v0, s[8:11], s59 offen offset:0 sc1
    s_waitcnt vmcnt(4)
    v_max3_u32 v10, v10, v36, v37
    v_max3_u32 v10, v10, v38, v39
    s_waitcnt vmcnt(3)
    v_max3_u32 v10, v10, v40, v41
    v_max3_u32 v10, v10, v42, v43
    s_waitcnt vmcnt(2)
    v_max3_u32 v10, v10, v44, v45
    v_max3_u32 v10, v10, v46, v47
    s_waitcnt vmcnt(1)
    v_max3_u32 v10, v10, v48, v49
    v_max3_u32 v10, v10, v50, v51
    s_waitcnt vmcnt(0)
    v_max3_u32 v10, v10, v52, v53
    v_max3_u32 v10, v10, v54, v55
    v_cmp_eq_u32 vcc, -1, v10
    s_cbranch_vccz M_c0_1_restart
    s_add_u32 s30, s30, 1
    s_cmp_ge_u32 s30, 60000
    s_cbranch_scc1 M_fail
    s_branch M_c0_1_vfy
M_c0_1_exact:
    s_nop 7
    s_mov_b32 s70, 2
    s_waitcnt lgkmcnt(0)
    ds_read_b128 v[20:23], v3 offset:18432
    ds_read_b128 v[24:27], v3 offset:18496
    ds_read_b128 v[28:31], v3 offset:18560
    ds_read_b128 v[32:35], v3 offset:18624
    ds_read_b128 v[56:59], v0 offset:0
    s_waitcnt lgkmcnt(0)
    v_mfma_f32_16x16x32_bf16 v[36:39], v[56:59], v[20:23], 0
    s_nop 3
    ds_read_b128 v[60:63], v0 offset:1024
    s_waitcnt lgkmcnt(0)
    v_mfma_f32_16x16x32_bf16 v[36:39], v[60:63], v[24:27], v[36:39]
    s_nop 3
    ds_read_b128 v[56:59], v0 offset:2048
    s_waitcnt lgkmcnt(0)
    v_mfma_f32_16x16x32_bf16 v[36:39], v[56:59], v[28:31], v[36:39]
    s_nop 3
    ds_read_b128 v[60:63], v0 offset:3072
    s_waitcnt lgkmcnt(0)
    v_mfma_f32_16x16x32_bf16 v[36:39], v[60:63], v[32:35], v[36:39]
    s_nop 3
    ds_read_b128 v[56:59], v0 offset:4096
    s_waitcnt lgkmcnt(0)
    v_mfma_f32_16x16x32_bf16 v[40:43], v[56:59], v[20:23], 0
    s_nop 3
    ds_read_b128 v[60:63], v0 offset:5120
    s_waitcnt lgkmcnt(0)
    v_mfma_f32_16x16x32_bf16 v[40:43], v[60:63], v[24:27], v[40:43]
    s_nop 3
    ds_read_b128 v[56:59], v0 offset:6144
    s_waitcnt lgkmcnt(0)
    v_mfma_f32_16x16x32_bf16 v[40:43], v[56:59], v[28:31], v[40:43]
    s_nop 3
    ds_read_b128 v[60:63], v0 offset:7168
    s_waitcnt lgkmcnt(0)
    v_mfma_f32_16x16x32_bf16 v[40:43], v[60:63], v[32:35], v[40:43]
    s_nop 3
    ds_read_b128 v[56:59], v3 offset:20736
    s_waitcnt lgkmcnt(0)
    v_mfma_f32_16x16x32_bf16 v[48:51], v[56:59], v[20:23], 0
    s_nop 3
    ds_read_b128 v[60:63], v3 offset:20800
    s_waitcnt lgkmcnt(0)
    v_mfma_f32_16x16x32_bf16 v[48:51], v[60:63], v[24:27], v[48:51]
    s_nop 3
    ds_read_b128 v[56:59], v3 offset:20864
    s_waitcnt lgkmcnt(0)
    v_mfma_f32_16x16x32_bf16 v[48:51], v[56:59], v[28:31], v[48:51]
    s_nop 3
    ds_read_b128 v[60:63], v3 offset:20928
    s_waitcnt lgkmcnt(0)
    v_mfma_f32_16x16x32_bf16 v[48:51], v[60:63], v[32:35], v[48:51]
    s_nop 3
    v_max3_f32 v64, v36, v37, v38
    v_max3_f32 v64, v64, v39, v40
    v_max3_f32 v64, v64, v41, v42
    s_nop 0
    v_max3_f32 v64, v64, v43, v48
    v_max3_f32 v64, v64, v49, v50
    v_max_f32 v64, v64, v51
    v_mov_b32 v65, v64
    s_nop 1
    v_permlane16_swap_b32 v64, v65
    v_max_f32 v64, v64, v65
    v_mov_b32 v65, v64
    s_nop 1
    v_permlane32_swap_b32 v64, v65
    v_max_f32 v64, v64, v65
    v_sub_f32 v36, v36, v64
    v_exp_f32 v36, v36
    v_sub_f32 v37, v37, v64
    v_exp_f32 v37, v37
    v_sub_f32 v38, v38, v64
    v_exp_f32 v38, v38
    v_sub_f32 v39, v39, v64
    v_exp_f32 v39, v39
    v_sub_f32 v40, v40, v64
    v_exp_f32 v40, v40
    v_sub_f32 v41, v41, v64
    v_exp_f32 v41, v41
    v_sub_f32 v42, v42, v64
    v_exp_f32 v42, v42
    v_sub_f32 v43, v43, v64
    v_exp_f32 v43, v43
    v_sub_f32 v48, v48, v64
    v_exp_f32 v48, v48
    v_sub_f32 v49, v49, v64
    v_exp_f32 v49, v49
    v_sub_f32 v50, v50, v64
    v_exp_f32 v50, v50
    v_sub_f32 v51, v51, v64
    v_exp_f32 v51, v51
    v_cvt_pk_bf16_f32 v36, v36, v37
    v_cvt_pk_bf16_f32 v37, v38, v39
    v_cvt_pk_bf16_f32 v38, v40, v41
    v_cvt_pk_bf16_f32 v39, v42, v43
    v_cvt_pk_bf16_f32 v48, v48, v49
    v_cvt_pk_bf16_f32 v49, v50, v51
    v_mfma_f32_16x16x32_bf16 v[20:23], v[80:83], v[36:39], 0
    v_mfma_f32_16x16x32_bf16 v[24:27], v[84:87], v[36:39], 0
    v_mfma_f32_16x16x32_bf16 v[28:31], v[72:75], v[36:39], 0
    ds_read_b128 v[60:63], v3 offset:20800
    s_waitcnt lgkmcnt(0)
    s_nop 7
    s_branch M_c0_1_fin
M_c0_1_last:
    s_cmp_lg_u32 s70, 0
    s_cbranch_scc1 M_c0_1_last2
    v_cmp_u_f32 vcc, v40, v40
    s_cbranch_vccnz M_c0_1_vfy0
M_c0_1_last2:
    s_waitcnt vmcnt(0) lgkmcnt(0)
    s_barrier
    s_barrier
    v_mov_b32 v11, 8192
    s_mov_b64 exec, 1
    buffer_store_dword v11, v0, s[8:11], s52 offen sc1
    s_mov_b64 exec, -1
    s_add_u32 s52, s52, 4096
    s_nop 7
    v_mov_b64 v[72:73], -1
    v_mov_b64 v[74:75], -1
    s_add_u32 s28, s44, 3
    s_and_b32 s29, s28, 3
    s_mul_i32 s31, s22, 160
    s_mul_i32 s28, s29, 167936
    s_add_u32 s28, s28, s34
    s_add_u32 s64, s28, s35
    s_lshl_b32 s65, s22, 10
    s_add_u32 s65, s65, s28
    s_add_u32 s65, s65, 135168
    buffer_store_dwordx4 v[72:75], v0, s[8:11], s64 offen offset:1024
    buffer_store_dwordx4 v[72:75], v0, s[8:11], s64 offen offset:2048
    buffer_store_dwordx4 v[72:75], v0, s[8:11], s65 offen
    s_mov_b32 s65, 0x10000000
    s_mov_b32 s64, 0x10000000
    s_waitcnt vmcnt(0)
    s_add_u32 s44, s44, 1
    s_cmp_eq_u32 s44, 128
    s_cbranch_scc1 M_end
    s_branch M_c0_1_layer
M_c0_1_p1:
    s_mov_b32 s30, 0
M_c0_1_p1_l:
    s_waitcnt lgkmcnt(0)
    s_mov_b64 exec, 3
    buffer_load_dword v11, v9, s[8:11], s51 offen sc1
    s_waitcnt vmcnt(0)
    s_mov_b64 exec, -1
    v_readlane_b32 s54, v11, 0
    v_readlane_b32 s28, v11, 1
    s_nop 3
    s_min_u32 s54, s54, s28
    s_cmp_ge_u32 s54, s27
    s_cbranch_scc1 M_c0_1_p1_r
    s_sleep 1
    s_add_u32 s30, s30, 1
    s_cmp_ge_u32 s30, 60000
    s_cbranch_scc1 M_fail
    s_branch M_c0_1_p1_l
M_c0_1_p2:
    s_mov_b32 s30, 0
M_c0_1_p2_l:
    s_waitcnt lgkmcnt(0)
    s_mov_b64 exec, 3
    buffer_load_dword v11, v9, s[8:11], s51 offen sc1
    s_waitcnt vmcnt(0)
    s_mov_b64 exec, -1
    v_readlane_b32 s54, v11, 0
    v_readlane_b32 s28, v11, 1
    s_nop 3
    s_min_u32 s54, s54, s28
    s_cmp_ge_u32 s54, s27
    s_cbranch_scc1 M_c0_1_p2_r
    s_sleep 1
    s_add_u32 s30, s30, 1
    s_cmp_ge_u32 s30, 60000
    s_cbranch_scc1 M_fail
    s_branch M_c0_1_p2_l
M_c0_1_lr:
    s_mov_b32 s30, 0
M_c0_1_lr_l:
    s_waitcnt lgkmcnt(0)
    ds_read_b128 v[36:39], v6 offset:13312
    ds_read_b128 v[40:43], v6 offset:14336
    ds_read_b128 v[44:47], v6 offset:15360
    ds_read_b128 v[48:51], v6 offset:16384
    ds_read_b128 v[52:55], v6 offset:17408
    s_waitcnt lgkmcnt(2)
    v_max3_u32 v10, v36, v40, v44
    s_waitcnt lgkmcnt(0)
    v_max3_u32 v10, v10, v48, v52
    v_cmp_eq_u32 vcc, -1, v10
    s_cbranch_vccz M_c0_1_lr_d
    s_add_u32 s30, s30, 1
    s_cmp_ge_u32 s30, 480000
    s_cbranch_scc1 M_fail
    s_branch M_c0_1_lr_l
M_c0_1_lr_d:
    ds_read_b128 v[56:59], v5 offset:0
    ds_read_b128 v[60:63], v5 offset:1024
    ds_read_b128 v[64:67], v5 offset:2048
    ds_read_b128 v[68:71], v5 offset:3072
    v_mov_b64 v[12:13], 0
    v_mov_b64 v[14:15], 0
    v_mov_b64 v[16:17], 0
    v_mov_b64 v[18:19], 0
    v_mov_b64 v[20:21], 0
    v_mov_b64 v[22:23], 0
    v_mov_b64 v[24:25], 0
    v_mov_b64 v[26:27], 0
    v_mov_b64 v[28:29], 0
    v_mov_b64 v[30:31], 0
    v_mov_b64 v[32:33], 0
    v_mov_b64 v[34:35], 0
    s_waitcnt lgkmcnt(0)
    s_branch M_c0_1_lr_r
M_c0_1_rr:
    s_mov_b32 s30, 0
M_c0_1_rr_l:
    s_waitcnt lgkmcnt(0)
    s_and_b32 s27, s30, 1
    s_cbranch_scc1 M_c0_1_rr_n
    s_waitcnt vmcnt(1)
    s_mov_b32 m0, 8192
    s_nop 0
    buffer_load_dwordx4 v0, s[8:11], s49 offen offset:2048 sc1 lds
M_c0_1_rr_n:
    ds_read_b128 v[36:39], v6 offset:8192
    ds_read_b128 v[40:43], v6 offset:9216
    ds_read_b128 v[44:47], v6 offset:10240
    ds_read_b128 v[48:51], v6 offset:11264
    ds_read_b32 v11, v6 offset:12288
    s_waitcnt lgkmcnt(2)
    v_max3_u32 v10, v36, v40, v44
    s_waitcnt lgkmcnt(0)
    v_max3_u32 v10, v10, v48, v11
    v_cmp_eq_u32 vcc, -1, v10
    s_cbranch_vccz M_c0_1_rr_d
    s_add_u32 s30, s30, 1
    s_cmp_ge_u32 s30, 480000
    s_cbranch_scc1 M_fail
    s_branch M_c0_1_rr_l
M_c0_1_rr_d:
    s_branch M_c0_1_rr_r
M_c0_1_wrb_l:
    s_waitcnt vmcnt(1)
    v_mfma_f32_16x16x32_bf16 v[76:79], v[72:75], v[40:43], 0
    v_cmp_eq_u32 vcc, -1, v40
    s_cbranch_vccz M_c0_1_wrb_x0
M_c0_1_wrb_i0:
    buffer_load_dwordx4 v[40:43], v0, s[8:11], s43 offen sc1
    s_waitcnt vmcnt(1)
    v_mfma_f32_16x16x32_bf16 v[76:79], v[72:75], v[44:47], 0
    v_cmp_eq_u32 vcc, -1, v44
    s_cbranch_vccz M_c0_1_wrb_x1
M_c0_1_wrb_i1:
    buffer_load_dwordx4 v[44:47], v0, s[8:11], s43 offen sc1
    s_add_u32 s71, s71, 1
    s_cmp_lt_u32 s71, 240000
    s_cbranch_scc1 M_c0_1_wrb_l
    s_branch M_fail
M_c0_1_wrb_x0:
    s_nop 5
    v_add_f32_dpp v76, v76, v76 row_ror:8 row_mask:0xf bank_mask:0xf
    v_add_f32_dpp v77, v77, v77 row_ror:8 row_mask:0xf bank_mask:0xf
    s_nop 0
    v_add_f32_dpp v76, v76, v76 row_ror:4 row_mask:0xf bank_mask:0xf
    v_add_f32_dpp v77, v77, v77 row_ror:4 row_mask:0xf bank_mask:0xf
    s_nop 0
    v_add_f32_dpp v76, v76, v76 row_ror:2 row_mask:0xf bank_mask:0xf
    v_add_f32_dpp v77, v77, v77 row_ror:2 row_mask:0xf bank_mask:0xf
    v_cmp_u_f32 vcc, v76, v76
    v_cvt_pk_bf16_f32 v76, v76, v77
    s_cbranch_vccz M_c0_1_wrb_n
M_c0_1_wrb_e0:
    v_max3_u32 v32, v40, v41, v42
    v_max_u32 v32, v32, v43
    v_cmp_eq_u32 vcc, -1, v32
    s_cbranch_vccnz M_c0_1_wrb_i0
    v_min_u32 v76, -2, v76
    v_min_u32 v77, -2, v77
    s_branch M_c0_1_wrb_n
M_c0_1_wrb_x1:
    s_nop 5
    v_add_f32_dpp v76, v76, v76 row_ror:8 row_mask:0xf bank_mask:0xf
    v_add_f32_dpp v77, v77, v77 row_ror:8 row_mask:0xf bank_mask:0xf
    s_nop 0
    v_add_f32_dpp v76, v76, v76 row_ror:4 row_mask:0xf bank_mask:0xf
    v_add_f32_dpp v77, v77, v77 row_ror:4 row_mask:0xf bank_mask:0xf
    s_nop 0
    v_add_f32_dpp v76, v76, v76 row_ror:2 row_mask:0xf bank_mask:0xf
    v_add_f32_dpp v77, v77, v77 row_ror:2 row_mask:0xf bank_mask:0xf
    v_cmp_u_f32 vcc, v76, v76
    v_cvt_pk_bf16_f32 v76, v76, v77
    s_cbranch_vccz M_c0_1_wrb_n
M_c0_1_wrb_e1:
    v_max3_u32 v32, v44, v45, v46
    v_max_u32 v32, v32, v47
    v_cmp_eq_u32 vcc, -1, v32
    s_cbranch_vccnz M_c0_1_wrb_i1
    v_min_u32 v76, -2, v76
    v_min_u32 v77, -2, v77
M_c0_1_wrb_n:
    s_mov_b64 exec, s[62:63]
    buffer_store_dword v76, v11, s[8:11], s58 offen
    s_branch M_c0_1_wrb_d
M_c0_1_wkw:
    s_mov_b32 s30, 0
M_c0_1_wkw_l:
    s_waitcnt lgkmcnt(0)
    s_mov_b64 exec, 3
    buffer_load_dword v11, v9, s[8:11], s51 offen sc1
    s_waitcnt vmcnt(0)
    s_mov_b64 exec, -1
    v_readlane_b32 s54, v11, 0
    v_readlane_b32 s28, v11, 1
    s_nop 3
    s_min_u32 s54, s54, s28
    s_cmp_ge_u32 s54, s27
    s_cbranch_scc1 M_c0_1_wkw_r
    s_sleep 1
    s_add_u32 s30, s30, 1
    s_cmp_ge_u32 s30, 60000
    s_cbranch_scc1 M_fail
    s_branch M_c0_1_wkw_l
M_c0_2_layer:
    s_lshr_b32 s27, s44, 6
    s_mul_i32 s50, s27, 33554432
    s_lshl_b32 s27, s22, 13
    s_add_u32 s50, s50, s27
    s_add_u32 s50, s50, 37748736
    s_barrier
    s_and_b32 s26, s44, 63
    s_lshl_b32 s26, s26, 18
    s_add_u32 s26, s26, s50
    s_add_u32 s26, s26, 4096
    s_add_u32 s3, s26, 16777216
    s_mov_b32 m0, 4096
    s_nop 0
    buffer_load_dwordx4 v0, s[8:11], s26 offen offset:0 sc1 lds
    buffer_load_dwordx4 v0, s[8:11], s26 offen offset:1024 sc1 lds
    buffer_load_dwordx4 v[80:83], v0, s[8:11], s3 offen offset:0 sc1
    buffer_load_dwordx4 v[84:87], v0, s[8:11], s3 offen offset:1024 sc1
    s_and_b32 s26, s44, 63
    s_add_u32 s26, s26, 1
    s_min_u32 s26, s26, 63
    s_lshl_b32 s26, s26, 18
    s_add_u32 s26, s26, s50
    s_add_u32 s26, s26, 4096
    s_add_u32 s3, s26, 16777216
    s_mul_i32 s27, s20, 5120
    s_add_u32 s48, s27, 167772160
    s_sub_u32 s49, 167777280, s27
    s_mov_b32 m0, 13312
    s_nop 0
    buffer_load_dwordx4 v0, s[8:11], s48 offen offset:0 sc1 lds
    buffer_load_dwordx4 v0, s[8:11], s48 offen offset:1024 sc1 lds
    buffer_load_dwordx4 v0, s[8:11], s48 offen offset:2048 sc1 lds
    ds_read_b128 v[56:59], v5 offset:0
    ds_read_b128 v[60:63], v5 offset:1024
    ds_read_b128 v[64:67], v5 offset:2048
    ds_read_b128 v[68:71], v5 offset:3072
    v_mov_b64 v[12:13], 0
    v_mov_b64 v[14:15], 0
    v_mov_b64 v[16:17], 0
    v_mov_b64 v[18:19], 0
    v_mov_b64 v[20:21], 0
    v_mov_b64 v[22:23], 0
    v_mov_b64 v[24:25], 0
    v_mov_b64 v[26:27], 0
    v_mov_b64 v[28:29], 0
    v_mov_b64 v[30:31], 0
    v_mov_b64 v[32:33], 0
    v_mov_b64 v[34:35], 0
    s_mov_b32 s70, 0
    s_waitcnt vmcnt(0) lgkmcnt(0)
M_c0_2_top:
    s_waitcnt vmcnt(6)
    s_barrier
    ds_read_b128 v[36:39], v6 offset:13312
    ds_read_b128 v[40:43], v6 offset:14336
    ds_read_b128 v[44:47], v6 offset:15360
    ds_read_b128 v[48:51], v6 offset:16384
    ds_read_b128 v[52:55], v6 offset:17408
    s_mov_b32 m0, 8192
    s_nop 0
    buffer_load_dwordx4 v0, s[8:11], s49 offen offset:3072 sc1 lds
M_c0_2_lr_r:
    s_waitcnt lgkmcnt(4)
    v_smfmac_f32_16x16x64_bf16 v[20:23], v[36:39], v[56:63], v1
    ds_read_b128 v[56:59], v5 offset:4096
    s_and_b32 s55, s44, 3
    s_mul_i32 s55, s55, 167936
    v_smfmac_f32_16x16x64_bf16 v[24:27], v[36:39], v[64:71], v1
    ds_read_b128 v[64:67], v5 offset:6144
    s_add_u32 s55, s55, s34
    s_add_u32 s56, s55, s35
    v_smfmac_f32_16x16x64_bf16 v[28:31], v[36:39], a[248:255], v1
    ds_read_b128 v[68:71], v5 offset:7168
    s_and_b32 s57, s44, 63
    v_smfmac_f32_16x16x64_bf16 v[32:35], v[36:39], a[240:247], v1
    ds_read_b128 v[60:63], v5 offset:5120
    s_waitcnt lgkmcnt(7)
    v_smfmac_f32_16x16x64_bf16 v[20:23], v[40:43], a[232:239], v1
    s_waitcnt lgkmcnt(0)
    v_smfmac_f32_16x16x64_bf16 v[24:27], v[40:43], v[56:63], v1
    ds_read_b128 v[56:59], v5 offset:8192
    v_smfmac_f32_16x16x64_bf16 v[28:31], v[40:43], a[224:231], v1
    ds_read_b128 v[60:63], v5 offset:9216
    v_smfmac_f32_16x16x64_bf16 v[32:35], v[40:43], a[216:223], v1
    v_smfmac_f32_16x16x64_bf16 v[20:23], v[44:47], v[64:71], v1
    ds_read_b128 v[64:67], v5 offset:10240
    v_max3_u32 v10, v36, v40, v44
    v_smfmac_f32_16x16x64_bf16 v[24:27], v[44:47], a[208:215], v1
    ds_read_b128 v[68:71], v5 offset:11264
    v_max3_u32 v10, v10, v48, v52
    v_smfmac_f32_16x16x64_bf16 v[28:31], v[44:47], a[200:207], v1
    s_waitcnt lgkmcnt(2)
    v_cmp_eq_u32 vcc, -1, v10
    v_smfmac_f32_16x16x64_bf16 v[32:35], v[44:47], v[56:63], v1
    ds_read_b128 v[56:59], v5 offset:12288
    s_cbranch_vccnz M_c0_2_lr
    v_smfmac_f32_16x16x64_bf16 v[20:23], v[48:51], a[192:199], v1
    ds_read_b128 v[60:63], v5 offset:13312
    v_smfmac_f32_16x16x64_bf16 v[24:27], v[48:51], a[184:191], v1
    s_waitcnt lgkmcnt(2)
    v_smfmac_f32_16x16x64_bf16 v[28:31], v[48:51], v[64:71], v1
    ds_read_b128 v[64:67], v5 offset:14336
    v_smfmac_f32_16x16x64_bf16 v[32:35], v[48:51], a[176:183], v1
    ds_read_b128 v[68:71], v5 offset:15360
    s_waitcnt vmcnt(0)
    s_barrier
    ds_read_b128 v[36:39], v6 offset:8192
    ds_read_b128 v[40:43], v6 offset:9216
    ds_read_b128 v[44:47], v6 offset:10240
    ds_read_b128 v[48:51], v6 offset:11264
    ds_read_b32 v11, v6 offset:12288
    v_smfmac_f32_16x16x64_bf16 v[20:23], v[52:55], a[168:175], v1
    s_waitcnt lgkmcnt(7)
    v_smfmac_f32_16x16x64_bf16 v[24:27], v[52:55], v[56:63], v1
    ds_read_b128 v[56:59], v5 offset:16384
    v_smfmac_f32_16x16x64_bf16 v[28:31], v[52:55], a[160:167], v1
    ds_read_b128 v[60:63], v5 offset:17408
    s_waitcnt lgkmcnt(4)
    v_max3_u32 v10, v36, v40, v44
    v_smfmac_f32_16x16x64_bf16 v[32:35], v[52:55], a[152:159], v1
    s_waitcnt lgkmcnt(2)
    v_max3_u32 v10, v10, v48, v11
    v_cmp_eq_u32 vcc, -1, v10
    s_cbranch_vccnz M_c0_2_rr
M_c0_2_rr_r:
    ds_read_b128 v[52:55], v6 offset:12288
    buffer_store_dwordx4 v[72:75], v0, s[8:11], s4 offen offset:0 sc1
    buffer_store_dwordx4 v[76:79], v0, s[8:11], s4 offen offset:1024 sc1
    s_mov_b32 s4, 0x10000000
    v_smfmac_f32_16x16x64_bf16 v[20:23], v[36:39], v[64:71], v1
    ds_read_b128 v[64:67], v5 offset:18432
    v_smfmac_f32_16x16x64_bf16 v[24:27], v[36:39], a[144:151], v1
    ds_read_b128 v[68:71], v5 offset:19456
    v_smfmac_f32_16x16x64_bf16 v[20:23], v[40:43], a[136:143], v1
    s_waitcnt lgkmcnt(3)
    v_smfmac_f32_16x16x64_bf16 v[24:27], v[40:43], v[56:63], v1
    ds_read_b128 v[56:59], v5 offset:20480
    v_smfmac_f32_16x16x64_bf16 v[20:23], v[44:47], a[128:135], v1
    ds_read_b128 v[60:63], v5 offset:21504
    v_smfmac_f32_16x16x64_bf16 v[24:27], v[44:47], a[120:127], v1
    s_waitcnt lgkmcnt(2)
    v_smfmac_f32_16x16x64_bf16 v[20:23], v[48:51], v[64:71], v1
    ds_read_b128 v[64:67], v5 offset:22528
    v_smfmac_f32_16x16x64_bf16 v[24:27], v[48:51], a[112:119], v1
    ds_read_b128 v[68:71], v5 offset:23552
    v_smfmac_f32_16x16x64_bf16 v[20:23], v[52:55], a[104:111], v1
    s_waitcnt lgkmcnt(2)
    v_smfmac_f32_16x16x64_bf16 v[24:27], v[52:55], v[56:63], v1
    ds_read_b128 v[56:59], v5 offset:24576
    v_smfmac_f32_16x16x64_bf16 v[28:31], v[36:39], a[96:103], v1
    ds_read_b128 v[60:63], v5 offset:25600
    v_smfmac_f32_16x16x64_bf16 v[32:35], v[36:39], a[88:95], v1
    s_waitcnt lgkmcnt(2)
    v_mov_b32 v5, v5
    v_mov_b32 v5, v5
    v_permlane32_swap_b32 v20, v21
    v_smfmac_f32_16x16x64_bf16 v[28:31], v[40:43], v[64:71], v1
    ds_read_b128 v[64:67], v5 offset:26624
    v_permlane32_swap_b32 v22, v23
    v_smfmac_f32_16x16x64_bf16 v[32:35], v[40:43], a[80:87], v1
    ds_read_b128 v[68:71], v5 offset:27648
    v_permlane32_swap_b32 v24, v25
    v_smfmac_f32_16x16x64_bf16 v[28:31], v[44:47], a[72:79], v1
    s_waitcnt lgkmcnt(2)
    v_permlane32_swap_b32 v26, v27
    v_smfmac_f32_16x16x64_bf16 v[32:35], v[44:47], v[56:63], v1
    ds_read_b128 v[56:59], v5 offset:28672
    v_add_f32 v20, v20, v21
    v_add_f32 v22, v22, v23
    v_smfmac_f32_16x16x64_bf16 v[28:31], v[48:51], a[64:71], v1
    ds_read_b128 v[60:63], v5 offset:29696
    v_add_f32 v24, v24, v25
    v_add_f32 v26, v26, v27
    v_smfmac_f32_16x16x64_bf16 v[32:35], v[48:51], a[56:63], v1
    s_waitcnt lgkmcnt(2)
    v_mul_f32 v20, s40, v20
    v_mul_f32 v24, s40, v24
    v_smfmac_f32_16x16x64_bf16 v[28:31], v[52:55], v[64:71], v1
    ds_read_b128 v[64:67], v5 offset:30720
    v_mul_f32 v22, s40, v22
    v_mul_f32 v26, s40, v26
    v_smfmac_f32_16x16x64_bf16 v[32:35], v[52:55], a[48:55], v1
    ds_read_b128 v[68:71], v5 offset:31744
    v_cvt_pk_bf16_f32 v20, v20, v24
    v_cvt_pk_bf16_f32 v21, v22, v26
    v_smfmac_f32_16x16x64_bf16 v[12:15], v[36:39], a[40:47], v1
    ds_write_b32 v2, v20 offset:18432
    ds_write_b32 v2, v21 offset:19008
    s_waitcnt lgkmcnt(4)
    v_smfmac_f32_16x16x64_bf16 v[16:19], v[36:39], v[56:63], v1
    ds_read_b128 v[56:59], v5 offset:32768
    v_permlane32_swap_b32 v28, v29
    v_smfmac_f32_16x16x64_bf16 v[12:15], v[40:43], a[32:39], v1
    ds_read_b128 v[60:63], v5 offset:33792
    v_permlane32_swap_b32 v30, v31
    v_smfmac_f32_16x16x64_bf16 v[16:19], v[40:43], a[24:31], v1
    ds_read_b128 v[36:39], v6 offset:13312
    s_waitcnt lgkmcnt(5)
    v_permlane32_swap_b32 v32, v33
    v_smfmac_f32_16x16x64_bf16 v[12:15], v[44:47], v[64:71], v1
    ds_read_b128 v[40:43], v6 offset:14336
    v_permlane32_swap_b32 v34, v35
    v_smfmac_f32_16x16x64_bf16 v[16:19], v[44:47], a[16:23], v1
    ds_read_b128 v[44:47], v6 offset:15360
    v_add_f32 v28, v28, v29
    v_add_f32 v30, v30, v31
    v_smfmac_f32_16x16x64_bf16 v[12:15], v[48:51], a[8:15], v1
    ds_read_b128 v[64:67], v0 offset:2048
    s_waitcnt lgkmcnt(4)
    v_add_f32 v32, v32, v33
    v_add_f32 v34, v34, v35
    v_smfmac_f32_16x16x64_bf16 v[16:19], v[48:51], v[56:63], v1
    ds_read_b128 v[68:71], v0 offset:3072
    v_cvt_pk_bf16_f32 v28, v28, v32
    v_cvt_pk_bf16_f32 v29, v30, v34
    v_smfmac_f32_16x16x64_bf16 v[12:15], v[52:55], a[0:7], v1
    ds_write_b32 v2, v28 offset:20736
    ds_write_b32 v2, v29 offset:21312
    v_smfmac_f32_16x16x64_bf16 v[16:19], v[52:55], v[248:255], v1
    ds_read_b128 v[48:51], v6 offset:16384
    s_waitcnt lgkmcnt(7)
    v_smfmac_f32_16x16x64_bf16 v[12:15], v[36:39], v[240:247], v1
    ds_read_b128 v[56:59], v0 offset:0
    v_smfmac_f32_16x16x64_bf16 v[16:19], v[36:39], v[232:239], v1
    s_waitcnt vmcnt(2) lgkmcnt(2)
    s_barrier
    ds_read_b128 v[20:23], v3 offset:18432
    ds_read_b128 v[24:27], v3 offset:18496
    v_smfmac_f32_16x16x64_bf16 v[12:15], v[40:43], v[224:231], v1
    ds_read_b128 v[28:31], v3 offset:18560
    v_smfmac_f32_16x16x64_bf16 v[16:19], v[40:43], v[216:223], v1
    ds_read_b128 v[32:35], v3 offset:18624
    v_smfmac_f32_16x16x64_bf16 v[12:15], v[44:47], v[208:215], v1
    ds_read_b128 v[60:63], v0 offset:1024
    v_smfmac_f32_16x16x64_bf16 v[16:19], v[44:47], v[200:207], v1
    ds_read_b128 v[52:55], v6 offset:17408
    s_waitcnt lgkmcnt(5)
    v_mfma_f32_16x16x32_bf16 v[36:39], v[56:59], v[20:23], 0
    ds_read_b128 v[56:59], v0 offset:4096
    s_waitcnt lgkmcnt(2)
    v_mfma_f32_16x16x32_bf16 v[36:39], v[60:63], v[24:27], v[36:39]
    ds_read_b128 v[60:63], v0 offset:5120
    v_mfma_f32_16x16x32_bf16 v[36:39], v[64:67], v[28:31], v[36:39]
    ds_read_b128 v[64:67], v0 offset:6144
    v_mfma_f32_16x16x32_bf16 v[36:39], v[68:71], v[32:35], v[36:39]
    ds_read_b128 v[68:71], v0 offset:7168
    v_mov_b64 v[72:73], s[24:25]
    v_smfmac_f32_16x16x64_bf16 v[12:15], v[48:51], v[192:199], v1
    v_mov_b64 v[74:75], s[24:25]
    v_smfmac_f32_16x16x64_bf16 v[16:19], v[48:51], v[184:191], v1
    s_waitcnt lgkmcnt(3)
    v_mov_b64 v[10:11], s[16:17]
    v_mfma_f32_16x16x32_bf16 v[40:43], v[56:59], v[20:23], 0
    ds_read_b128 v[56:59], v3 offset:20736
    s_waitcnt lgkmcnt(3)
    v_exp_f32 v36, v36
    v_mfma_f32_16x16x32_bf16 v[40:43], v[60:63], v[24:27], v[40:43]
    ds_read_b128 v[60:63], v3 offset:20800
    s_waitcnt lgkmcnt(3)
    v_exp_f32 v37, v37
    v_mfma_f32_16x16x32_bf16 v[40:43], v[64:67], v[28:31], v[40:43]
    ds_read_b128 v[64:67], v3 offset:20864
    s_waitcnt lgkmcnt(3)
    v_exp_f32 v38, v38
    v_mfma_f32_16x16x32_bf16 v[40:43], v[68:71], v[32:35], v[40:43]
    ds_read_b128 v[68:71], v3 offset:20928
    v_exp_f32 v39, v39
    v_smfmac_f32_16x16x64_bf16 v[12:15], v[52:55], v[176:183], v1
    v_cvt_pk_bf16_f32 v36, v36, v37
    v_smfmac_f32_16x16x64_bf16 v[16:19], v[52:55], v[168:175], v1
    s_waitcnt lgkmcnt(3)
    v_cvt_pk_bf16_f32 v37, v38, v39
    v_mfma_f32_16x16x32_bf16 v[48:51], v[56:59], v[20:23], 0
    s_waitcnt lgkmcnt(2)
    v_exp_f32 v40, v40
    v_mfma_f32_16x16x32_bf16 v[48:51], v[60:63], v[24:27], v[48:51]
    s_waitcnt lgkmcnt(1)
    v_exp_f32 v41, v41
    v_mfma_f32_16x16x32_bf16 v[48:51], v[64:67], v[28:31], v[48:51]
    s_waitcnt lgkmcnt(0)
    v_exp_f32 v42, v42
    v_mfma_f32_16x16x32_bf16 v[48:51], v[68:71], v[32:35], v[48:51]
    v_exp_f32 v43, v43
    v_cvt_pk_bf16_f32 v38, v40, v41
    v_cvt_pk_bf16_f32 v39, v42, v43
    v_cvt_pk_bf16_f32 v12, v12, v13
    v_cvt_pk_bf16_f32 v13, v14, v15
    v_mfma_f32_16x16x32_bf16 v[28:31], v[72:75], v[36:39], 0
    v_cvt_pk_bf16_f32 v14, v16, v17
    s_nop 0
    v_exp_f32 v48, v48
    v_mfma_f32_16x16x32_bf16 v[20:23], v[80:83], v[36:39], 0
    v_exp_f32 v49, v49
    v_exp_f32 v50, v50
    v_mfma_f32_16x16x32_bf16 v[24:27], v[84:87], v[36:39], 0
    v_exp_f32 v51, v51
    v_cvt_pk_bf16_f32 v48, v48, v49
    v_cvt_pk_bf16_f32 v49, v50, v51
    v_cvt_pk_bf16_f32 v15, v18, v19
M_c0_2_fin:
    s_nop 0
    v_mfma_f32_16x16x16_bf16 v[28:31], v[10:11], v[48:49], v[28:31]
    s_cmp_eq_u32 s57, 63
    v_mfma_f32_16x16x16_bf16 v[20:23], v[12:13], v[48:49], v[20:23]
    ds_write_b128 v0, v[12:15] offset:10240
    v_mfma_f32_16x16x16_bf16 v[24:27], v[14:15], v[48:49], v[24:27]
    s_cbranch_scc1 M_c0_2_last
    v_mov_b64 v[56:57], 0
    v_mov_b64 v[58:59], 0
    s_nop 0
    v_rcp_f32 v30, v28
    v_subrev_u32 v29, s68, v28
    v_pk_mul_f32 v[20:21], v[20:21], v[30:31] op_sel_hi:[1,0]
    v_pk_mul_f32 v[22:23], v[22:23], v[30:31] op_sel_hi:[1,0]
    v_cvt_pk_bf16_f32 v20, v20, v21
    v_cvt_pk_bf16_f32 v21, v22, v23
    v_pk_mul_f32 v[24:25], v[24:25], v[30:31] op_sel_hi:[1,0]
    v_pk_mul_f32 v[26:27], v[26:27], v[30:31] op_sel_hi:[1,0]
    v_cvt_pk_bf16_f32 v22, v24, v25
    v_cvt_pk_bf16_f32 v23, v26, v27
    ds_write2_b64 v4, v[20:21], v[22:23] offset0:0 offset1:16
    v_cmp_lt_u32 vcc, s69, v29
    s_cbranch_vccnz M_c0_2_zbad
M_c0_2_zok:
    buffer_load_dwordx4 v[80:83], v0, s[8:11], s3 offen offset:0 sc1
    buffer_load_dwordx4 v[84:87], v0, s[8:11], s3 offen offset:1024 sc1
    s_waitcnt lgkmcnt(0)
    s_barrier
    ds_read_b128 v[40:43], v0 offset:13312
    ds_read_b128 v[48:51], v0 offset:14336
    s_mov_b32 m0, 4096
    s_nop 0
    buffer_load_dwordx4 v0, s[8:11], s26 offen offset:0 sc1 lds
    buffer_load_dwordx4 v0, s[8:11], s26 offen offset:1024 sc1 lds
    v_mov_b64 v[60:61], 0
    v_mov_b64 v[62:63], 0
    v_mov_b64 v[64:65], 0
    v_mov_b64 v[66:67], 0
    v_mov_b64 v[68:69], 0
    v_mov_b64 v[70:71], 0
    v_mov_b64 v[52:53], 0
    v_mov_b64 v[54:55], 0
    s_waitcnt lgkmcnt(1)
    v_smfmac_f32_16x16x64_bf16 v[56:59], v[40:43], v[160:167], v1
    v_smfmac_f32_16x16x64_bf16 v[60:63], v[40:43], v[144:151], v1
    s_waitcnt lgkmcnt(0)
    v_smfmac_f32_16x16x64_bf16 v[56:59], v[48:51], v[152:159], v1
    v_smfmac_f32_16x16x64_bf16 v[60:63], v[48:51], v[136:143], v1
    v_smfmac_f32_16x16x64_bf16 v[64:67], v[40:43], v[128:135], v1
    v_smfmac_f32_16x16x64_bf16 v[68:71], v[40:43], v[112:119], v1
    v_permlane32_swap_b32 v56, v57
    v_smfmac_f32_16x16x64_bf16 v[64:67], v[48:51], v[120:127], v1
    v_permlane32_swap_b32 v58, v59
    v_smfmac_f32_16x16x64_bf16 v[68:71], v[48:51], v[104:111], v1
    v_add_f32 v56, v56, v57
    v_add_f32 v58, v58, v59
    v_smfmac_f32_16x16x64_bf16 v[52:55], v[40:43], v[96:103], v1
    v_permlane32_swap_b32 v60, v61
    v_smfmac_f32_16x16x64_bf16 v[52:55], v[48:51], v[88:95], v1
    v_permlane32_swap_b32 v62, v63
    v_add_f32 v60, v60, v61
    v_add_f32 v62, v62, v63
    v_cvt_pk_bf16_f32 v36, v56, v60
    v_cvt_pk_bf16_f32 v38, v58, v62
    v_permlane32_swap_b32 v64, v65
    v_permlane32_swap_b32 v66, v67
    v_add_f32 v64, v64, v65
    v_add_f32 v66, v66, v67
    v_permlane32_swap_b32 v68, v69
    v_permlane32_swap_b32 v70, v71
    v_add_f32 v68, v68, v69
    v_add_f32 v70, v70, v71
    v_cvt_pk_bf16_f32 v37, v64, v68
    v_cvt_pk_bf16_f32 v39, v66, v70
    buffer_store_dwordx4 v[36:39], v0, s[8:11], s56 offen
    v_permlane32_swap_b32 v52, v53
    v_permlane32_swap_b32 v54, v55
    v_add_f32 v52, v52, v53
    v_add_f32 v54, v54, v55
    v_cvt_pk_bf16_f32 v52, v52, v54
    buffer_store_dword v52, v7, s[8:11], s55 offen
    s_add_u32 s27, s44, 1
    s_and_b32 s27, s27, 3
    s_mul_i32 s48, s27, 5120
    s_add_u32 s48, s48, s41
    s_lshl_b32 s27, s27, 15
    s_add_u32 s49, s27, s47
    v_add_u32 v10, 8192, v0
    v_add_u32 v11, 20736, v3
    v_cndmask_b32_e64 v10, v10, v11, s[42:43]
    ds_read_b128 v[72:75], v10 offset:0
    v_add_u32 v10, 9216, v0
    v_add_u32 v11, 20800, v3
    v_cndmask_b32_e64 v10, v10, v11, s[42:43]
    ds_read_b128 v[76:79], v10 offset:0
    s_lshl_b32 s4, s44, 18
    s_add_u32 s4, s4, s53
    ds_read_b128 v[56:59], v5 offset:0
    ds_read_b128 v[60:63], v5 offset:1024
    ds_read_b128 v[64:67], v5 offset:2048
    ds_read_b128 v[68:71], v5 offset:3072
    v_mov_b64 v[12:13], 0
    v_mov_b64 v[14:15], 0
    v_mov_b64 v[16:17], 0
    v_mov_b64 v[18:19], 0
    v_mov_b64 v[20:21], 0
    v_mov_b64 v[22:23], 0
    v_mov_b64 v[24:25], 0
    v_mov_b64 v[26:27], 0
    v_mov_b64 v[28:29], 0
    v_mov_b64 v[30:31], 0
    v_mov_b64 v[32:33], 0
    v_mov_b64 v[34:35], 0
    s_barrier
    s_and_b32 s26, s44, 63
    s_add_u32 s26, s26, 2
    s_min_u32 s26, s26, 63
    s_lshl_b32 s26, s26, 18
    s_add_u32 s26, s26, s50
    s_add_u32 s26, s26, 4096
    s_add_u32 s3, s26, 16777216
    s_nop 15
    s_nop 15
    s_nop 15
    s_nop 0
    s_mov_b32 m0, 13312
    s_nop 0
    buffer_load_dwordx4 v0, s[8:11], s48 offen offset:0 sc1 lds
    buffer_load_dwordx4 v0, s[8:11], s48 offen offset:1024 sc1 lds
    buffer_load_dwordx4 v0, s[8:11], s48 offen offset:2048 sc1 lds
    s_nop 11
    s_mov_b32 m0, 13312
    s_nop 0
    buffer_load_dwordx4 v0, s[8:11], s48 offen offset:0 sc1 lds
    buffer_load_dwordx4 v0, s[8:11], s48 offen offset:1024 sc1 lds
    buffer_load_dwordx4 v0, s[8:11], s48 offen offset:2048 sc1 lds
    s_nop 11
    s_mov_b32 m0, 13312
    s_nop 0
    buffer_load_dwordx4 v0, s[8:11], s48 offen offset:0 sc1 lds
    buffer_load_dwordx4 v0, s[8:11], s48 offen offset:1024 sc1 lds
    buffer_load_dwordx4 v0, s[8:11], s48 offen offset:2048 sc1 lds
    s_add_u32 s44, s44, 1
    s_mov_b32 s70, 0
    s_waitcnt lgkmcnt(0)
    s_branch M_c0_2_top
M_c0_2_restart:
    s_waitcnt vmcnt(0) lgkmcnt(0)
    s_nop 7
    s_barrier
    s_mov_b32 m0, 13312
    s_nop 0
    buffer_load_dwordx4 v0, s[8:11], s48 offen offset:0 sc1 lds
    buffer_load_dwordx4 v0, s[8:11], s48 offen offset:1024 sc1 lds
    buffer_load_dwordx4 v0, s[8:11], s48 offen offset:2048 sc1 lds
    ds_read_b128 v[56:59], v5 offset:0
    ds_read_b128 v[60:63], v5 offset:1024
    ds_read_b128 v[64:67], v5 offset:2048
    ds_read_b128 v[68:71], v5 offset:3072
    v_mov_b64 v[12:13], 0
    v_mov_b64 v[14:15], 0
    v_mov_b64 v[16:17], 0
    v_mov_b64 v[18:19], 0
    v_mov_b64 v[20:21], 0
    v_mov_b64 v[22:23], 0
    v_mov_b64 v[24:25], 0
    v_mov_b64 v[26:27], 0
    v_mov_b64 v[28:29], 0
    v_mov_b64 v[30:31], 0
    v_mov_b64 v[32:33], 0
    v_mov_b64 v[34:35], 0
    s_waitcnt vmcnt(0) lgkmcnt(0)
    s_branch M_c0_2_top
M_c0_2_zbad:
    s_cmp_eq_u32 s70, 2
    s_cbranch_scc1 M_c0_2_zok
    v_cmp_u_f32 vcc, v28, v28
    s_cbranch_vccz M_c0_2_exact
    s_cmp_eq_u32 s70, 1
    s_cbranch_scc1 M_c0_2_exact
M_c0_2_vfy0:
    s_mov_b32 s70, 1
    s_mov_b32 s30, 0
    s_waitcnt vmcnt(0) lgkmcnt(0)
    s_nop 7
M_c0_2_vfy:
    v_mov_b32 v10, 0
    s_add_u32 s59, s48, 4096
    buffer_load_dwordx4 v[36:39], v0, s[8:11], s48 offen offset:0 sc1
    buffer_load_dwordx4 v[40:43], v0, s[8:11], s48 offen offset:1024 sc1
    buffer_load_dwordx4 v[44:47], v0, s[8:11], s48 offen offset:2048 sc1
    buffer_load_dwordx4 v[48:51], v0, s[8:11], s48 offen offset:3072 sc1
    buffer_load_dwordx4 v[52:55], v0, s[8:11], s59 offen offset:0 sc1
    s_waitcnt vmcnt(4)
    v_max3_u32 v10, v10, v36, v37
    v_max3_u32 v10, v10, v38, v39
    s_waitcnt vmcnt(3)
    v_max3_u32 v10, v10, v40, v41
    v_max3_u32 v10, v10, v42, v43
    s_waitcnt vmcnt(2)
    v_max3_u32 v10, v10, v44, v45
    v_max3_u32 v10, v10, v46, v47
    s_waitcnt vmcnt(1)
    v_max3_u32 v10, v10, v48, v49
    v_max3_u32 v10, v10, v50, v51
    s_waitcnt vmcnt(0)
    v_max3_u32 v10, v10, v52, v53
    v_max3_u32 v10, v10, v54, v55
    s_add_u32 s59, s49, 4096
    buffer_load_dwordx4 v[36:39], v0, s[8:11], s49 offen offset:0 sc1
    buffer_load_dwordx4 v[40:43], v0, s[8:11], s49 offen offset:1024 sc1
    buffer_load_dwordx4 v[44:47], v0, s[8:11], s49 offen offset:2048 sc1
    buffer_load_dwordx4 v[48:51], v0, s[8:11], s49 offen offset:3072 sc1
    buffer_load_dwordx4 v[52:55], v0, s[8:11], s59 offen offset:0 sc1
    s_waitcnt vmcnt(4)
    v_max3_u32 v10, v10, v36, v37
    v_max3_u32 v10, v10, v38, v39
    s_waitcnt vmcnt(3)
    v_max3_u32 v10, v10, v40, v41
    v_max3_u32 v10, v10, v42, v43
    s_waitcnt vmcnt(2)
    v_max3_u32 v10, v10, v44, v45
    v_max3_u32 v10, v10, v46, v47
    s_waitcnt vmcnt(1)
    v_max3_u32 v10, v10, v48, v49
    v_max3_u32 v10, v10, v50, v51
    s_waitcnt vmcnt(0)
    v_max3_u32 v10, v10, v52, v53
    v_max3_u32 v10, v10, v54, v55
    v_cmp_eq_u32 vcc, -1, v10
    s_cbranch_vccz M_c0_2_restart
    s_add_u32 s30, s30, 1
    s_cmp_ge_u32 s30, 60000
    s_cbranch_scc1 M_fail
    s_branch M_c0_2_vfy
M_c0_2_exact:
    s_nop 7
    s_mov_b32 s70, 2
    s_waitcnt lgkmcnt(0)
    ds_read_b128 v[20:23], v3 offset:18432
    ds_read_b128 v[24:27], v3 offset:18496
    ds_read_b128 v[28:31], v3 offset:18560
    ds_read_b128 v[32:35], v3 offset:18624
    ds_read_b128 v[56:59], v0 offset:0
    s_waitcnt lgkmcnt(0)
    v_mfma_f32_16x16x32_bf16 v[36:39], v[56:59], v[20:23], 0
    s_nop 3
    ds_read_b128 v[60:63], v0 offset:1024
    s_waitcnt lgkmcnt(0)
    v_mfma_f32_16x16x32_bf16 v[36:39], v[60:63], v[24:27], v[36:39]
    s_nop 3
    ds_read_b128 v[56:59], v0 offset:2048
    s_waitcnt lgkmcnt(0)
    v_mfma_f32_16x16x32_bf16 v[36:39], v[56:59], v[28:31], v[36:39]
    s_nop 3
    ds_read_b128 v[60:63], v0 offset:3072
    s_waitcnt lgkmcnt(0)
    v_mfma_f32_16x16x32_bf16 v[36:39], v[60:63], v[32:35], v[36:39]
    s_nop 3
    ds_read_b128 v[56:59], v0 offset:4096
    s_waitcnt lgkmcnt(0)
    v_mfma_f32_16x16x32_bf16 v[40:43], v[56:59], v[20:23], 0
    s_nop 3
    ds_read_b128 v[60:63], v0 offset:5120
    s_waitcnt lgkmcnt(0)
    v_mfma_f32_16x16x32_bf16 v[40:43], v[60:63], v[24:27], v[40:43]
    s_nop 3
    ds_read_b128 v[56:59], v0 offset:6144
    s_waitcnt lgkmcnt(0)
    v_mfma_f32_16x16x32_bf16 v[40:43], v[56:59], v[28:31], v[40:43]
    s_nop 3
    ds_read_b128 v[60:63], v0 offset:7168
    s_waitcnt lgkmcnt(0)
    v_mfma_f32_16x16x32_bf16 v[40:43], v[60:63], v[32:35], v[40:43]
    s_nop 3
    ds_read_b128 v[56:59], v3 offset:20736
    s_waitcnt lgkmcnt(0)
    v_mfma_f32_16x16x32_bf16 v[48:51], v[56:59], v[20:23], 0
    s_nop 3
    ds_read_b128 v[60:63], v3 offset:20800
    s_waitcnt lgkmcnt(0)
    v_mfma_f32_16x16x32_bf16 v[48:51], v[60:63], v[24:27], v[48:51]
    s_nop 3
    ds_read_b128 v[56:59], v3 offset:20864
    s_waitcnt lgkmcnt(0)
    v_mfma_f32_16x16x32_bf16 v[48:51], v[56:59], v[28:31], v[48:51]
    s_nop 3
    ds_read_b128 v[60:63], v3 offset:20928
    s_waitcnt lgkmcnt(0)
    v_mfma_f32_16x16x32_bf16 v[48:51], v[60:63], v[32:35], v[48:51]
    s_nop 3
    v_max3_f32 v64, v36, v37, v38
    v_max3_f32 v64, v64, v39, v40
    v_max3_f32 v64, v64, v41, v42
    s_nop 0
    v_max3_f32 v64, v64, v43, v48
    v_max3_f32 v64, v64, v49, v50
    v_max_f32 v64, v64, v51
    v_mov_b32 v65, v64
    s_nop 1
    v_permlane16_swap_b32 v64, v65
    v_max_f32 v64, v64, v65
    v_mov_b32 v65, v64
    s_nop 1
    v_permlane32_swap_b32 v64, v65
    v_max_f32 v64, v64, v65
    v_sub_f32 v36, v36, v64
    v_exp_f32 v36, v36
    v_sub_f32 v37, v37, v64
    v_exp_f32 v37, v37
    v_sub_f32 v38, v38, v64
    v_exp_f32 v38, v38
    v_sub_f32 v39, v39, v64
    v_exp_f32 v39, v39
    v_sub_f32 v40, v40, v64
    v_exp_f32 v40, v40
    v_sub_f32 v41, v41, v64
    v_exp_f32 v41, v41
    v_sub_f32 v42, v42, v64
    v_exp_f32 v42, v42
    v_sub_f32 v43, v43, v64
    v_exp_f32 v43, v43
    v_sub_f32 v48, v48, v64
    v_exp_f32 v48, v48
    v_sub_f32 v49, v49, v64
    v_exp_f32 v49, v49
    v_sub_f32 v50, v50, v64
    v_exp_f32 v50, v50
    v_sub_f32 v51, v51, v64
    v_exp_f32 v51, v51
    v_cvt_pk_bf16_f32 v36, v36, v37
    v_cvt_pk_bf16_f32 v37, v38, v39
    v_cvt_pk_bf16_f32 v38, v40, v41
    v_cvt_pk_bf16_f32 v39, v42, v43
    v_cvt_pk_bf16_f32 v48, v48, v49
    v_cvt_pk_bf16_f32 v49, v50, v51
    v_mfma_f32_16x16x32_bf16 v[20:23], v[80:83], v[36:39], 0
    v_mfma_f32_16x16x32_bf16 v[24:27], v[84:87], v[36:39], 0
    v_mfma_f32_16x16x32_bf16 v[28:31], v[72:75], v[36:39], 0
    ds_read_b128 v[64:67], v3 offset:20864
    s_waitcnt lgkmcnt(0)
    s_nop 7
    s_branch M_c0_2_fin
M_c0_2_last:
    s_cmp_lg_u32 s70, 0
    s_cbranch_scc1 M_c0_2_last2
    v_cmp_u_f32 vcc, v40, v40
    s_cbranch_vccnz M_c0_2_vfy0
M_c0_2_last2:
    s_waitcnt vmcnt(0) lgkmcnt(0)
    s_barrier
    s_nop 7
    v_add_u32 v10, 8192, v0
    v_add_u32 v11, 20736, v3
    v_cndmask_b32_e64 v10, v10, v11, s[42:43]
    ds_read_b128 v[72:75], v10 offset:0
    v_add_u32 v10, 9216, v0
    v_add_u32 v11, 20800, v3
    v_cndmask_b32_e64 v10, v10, v11, s[42:43]
    ds_read_b128 v[76:79], v10 offset:0
    s_lshl_b32 s4, s44, 18
    s_add_u32 s4, s4, s53
    s_waitcnt lgkmcnt(1)
    buffer_store_dwordx4 v[72:75], v0, s[8:11], s4 offen offset:0 sc1
    s_waitcnt lgkmcnt(0)
    buffer_store_dwordx4 v[76:79], v0, s[8:11], s4 offen offset:1024 sc1
    s_mov_b32 s4, 0x10000000
    s_waitcnt vmcnt(0)
    s_barrier
    s_nop 7
    v_mov_b64 v[72:73], -1
    v_mov_b64 v[74:75], -1
    s_add_u32 s28, s44, 3
    s_and_b32 s29, s28, 3
    s_mul_i32 s31, s22, 160
    s_waitcnt vmcnt(0)
    s_add_u32 s44, s44, 1
    s_cmp_eq_u32 s44, 128
    s_cbranch_scc1 M_end
    s_branch M_c0_2_layer
M_c0_2_lr:
    s_mov_b32 s30, 0
M_c0_2_lr_l:
    s_waitcnt lgkmcnt(0)
    s_and_b32 s27, s30, 1
    s_cbranch_scc0 M_c0_2_lr_n
    s_waitcnt vmcnt(3)
    s_mov_b32 m0, 13312
    s_nop 0
    buffer_load_dwordx4 v0, s[8:11], s48 offen offset:0 sc1 lds
    buffer_load_dwordx4 v0, s[8:11], s48 offen offset:1024 sc1 lds
    buffer_load_dwordx4 v0, s[8:11], s48 offen offset:2048 sc1 lds
M_c0_2_lr_n:
    ds_read_b128 v[36:39], v6 offset:13312
    ds_read_b128 v[40:43], v6 offset:14336
    ds_read_b128 v[44:47], v6 offset:15360
    ds_read_b128 v[48:51], v6 offset:16384
    ds_read_b128 v[52:55], v6 offset:17408
    s_waitcnt lgkmcnt(2)
    v_max3_u32 v10, v36, v40, v44
    s_waitcnt lgkmcnt(0)
    v_max3_u32 v10, v10, v48, v52
    v_cmp_eq_u32 vcc, -1, v10
    s_cbranch_vccz M_c0_2_lr_d
    s_add_u32 s30, s30, 1
    s_cmp_ge_u32 s30, 480000
    s_cbranch_scc1 M_fail
    s_branch M_c0_2_lr_l
M_c0_2_lr_d:
    ds_read_b128 v[56:59], v5 offset:0
    ds_read_b128 v[60:63], v5 offset:1024
    ds_read_b128 v[64:67], v5 offset:2048
    ds_read_b128 v[68:71], v5 offset:3072
    v_mov_b64 v[12:13], 0
    v_mov_b64 v[14:15], 0
    v_mov_b64 v[16:17], 0
    v_mov_b64 v[18:19], 0
    v_mov_b64 v[20:21], 0
    v_mov_b64 v[22:23], 0
    v_mov_b64 v[24:25], 0
    v_mov_b64 v[26:27], 0
    v_mov_b64 v[28:29], 0
    v_mov_b64 v[30:31], 0
    v_mov_b64 v[32:33], 0
    v_mov_b64 v[34:35], 0
    s_waitcnt lgkmcnt(0)
    s_branch M_c0_2_lr_r
M_c0_2_rr:
    s_mov_b32 s30, 0
M_c0_2_rr_l:
    s_waitcnt lgkmcnt(0)
    s_and_b32 s27, s30, 1
    s_cbranch_scc1 M_c0_2_rr_n
    s_waitcnt vmcnt(1)
    s_mov_b32 m0, 8192
    s_nop 0
    buffer_load_dwordx4 v0, s[8:11], s49 offen offset:3072 sc1 lds
M_c0_2_rr_n:
    ds_read_b128 v[36:39], v6 offset:8192
    ds_read_b128 v[40:43], v6 offset:9216
    ds_read_b128 v[44:47], v6 offset:10240
    ds_read_b128 v[48:51], v6 offset:11264
    ds_read_b32 v11, v6 offset:12288
    s_waitcnt lgkmcnt(2)
    v_max3_u32 v10, v36, v40, v44
    s_waitcnt lgkmcnt(0)
    v_max3_u32 v10, v10, v48, v11
    v_cmp_eq_u32 vcc, -1, v10
    s_cbranch_vccz M_c0_2_rr_d
    s_add_u32 s30, s30, 1
    s_cmp_ge_u32 s30, 480000
    s_cbranch_scc1 M_fail
    s_branch M_c0_2_rr_l
M_c0_2_rr_d:
    s_branch M_c0_2_rr_r
M_c0_3_layer:
    s_lshr_b32 s27, s44, 6
    s_mul_i32 s50, s27, 33554432
    s_lshl_b32 s27, s22, 13
    s_add_u32 s50, s50, s27
    s_add_u32 s50, s50, 37748736
    s_barrier
    s_and_b32 s26, s44, 63
    s_lshl_b32 s26, s26, 18
    s_add_u32 s26, s26, s50
    s_add_u32 s26, s26, 6144
    s_add_u32 s3, s26, 16777216
    s_mov_b32 m0, 6144
    s_nop 0
    buffer_load_dwordx4 v0, s[8:11], s26 offen offset:0 sc1 lds
    buffer_load_dwordx4 v0, s[8:11], s26 offen offset:1024 sc1 lds
    buffer_load_dwordx4 v[80:83], v0, s[8:11], s3 offen offset:0 sc1
    buffer_load_dwordx4 v[84:87], v0, s[8:11], s3 offen offset:1024 sc1
    s_and_b32 s26, s44, 63
    s_add_u32 s26, s26, 1
    s_min_u32 s26, s26, 63
    s_lshl_b32 s26, s26, 18
    s_add_u32 s26, s26, s50
    s_add_u32 s26, s26, 6144
    s_add_u32 s3, s26, 16777216
    s_mul_i32 s27, s20, 5120
    s_add_u32 s48, s27, 167772160
    s_sub_u32 s49, 167777280, s27
    s_mov_b32 m0, 13312
    s_nop 0
    buffer_load_dwordx4 v0, s[8:11], s48 offen offset:3072 sc1 lds
    s_mov_b32 m0, 17408
    s_add_u32 s59, s48, 4096
    buffer_load_dwordx4 v0, s[8:11], s59 offen offset:0 sc1 lds
    ds_read_b128 v[56:59], v5 offset:0
    ds_read_b128 v[60:63], v5 offset:1024
    ds_read_b128 v[64:67], v5 offset:2048
    ds_read_b128 v[68:71], v5 offset:3072
    v_mov_b64 v[12:13], 0
    v_mov_b64 v[14:15], 0
    v_mov_b64 v[16:17], 0
    v_mov_b64 v[18:19], 0
    v_mov_b64 v[20:21], 0
    v_mov_b64 v[22:23], 0
    v_mov_b64 v[24:25], 0
    v_mov_b64 v[26:27], 0
    v_mov_b64 v[28:29], 0
    v_mov_b64 v[30:31], 0
    v_mov_b64 v[32:33], 0
    v_mov_b64 v[34:35], 0
    s_mov_b32 s70, 0
    s_waitcnt vmcnt(0) lgkmcnt(0)
M_c0_3_top:
    s_waitcnt vmcnt(4)
    s_barrier
    ds_read_b128 v[36:39], v6 offset:13312
    ds_read_b128 v[40:43], v6 offset:14336
    ds_read_b128 v[44:47], v6 offset:15360
    ds_read_b128 v[48:51], v6 offset:16384
    ds_read_b128 v[52:55], v6 offset:17408
    s_mov_b32 m0, 12288
    s_add_u32 s59, s49, 4096
    buffer_load_dwordx4 v0, s[8:11], s59 offen offset:0 sc1 lds
M_c0_3_lr_r:
    s_waitcnt lgkmcnt(4)
    v_smfmac_f32_16x16x64_bf16 v[20:23], v[36:39], v[56:63], v1
    ds_read_b128 v[56:59], v5 offset:4096
    s_and_b32 s55, s44, 3
    s_mul_i32 s55, s55, 167936
    v_smfmac_f32_16x16x64_bf16 v[24:27], v[36:39], v[64:71], v1
    ds_read_b128 v[64:67], v5 offset:6144
    s_add_u32 s55, s55, s34
    s_add_u32 s56, s55, s35
    v_smfmac_f32_16x16x64_bf16 v[28:31], v[36:39], a[248:255], v1
    ds_read_b128 v[68:71], v5 offset:7168
    s_and_b32 s57, s44, 63
    v_smfmac_f32_16x16x64_bf16 v[32:35], v[36:39], a[240:247], v1
    ds_read_b128 v[60:63], v5 offset:5120
    s_waitcnt lgkmcnt(7)
    v_smfmac_f32_16x16x64_bf16 v[20:23], v[40:43], a[232:239], v1
    s_waitcnt lgkmcnt(0)
    v_smfmac_f32_16x16x64_bf16 v[24:27], v[40:43], v[56:63], v1
    ds_read_b128 v[56:59], v5 offset:8192
    v_smfmac_f32_16x16x64_bf16 v[28:31], v[40:43], a[224:231], v1
    ds_read_b128 v[60:63], v5 offset:9216
    v_smfmac_f32_16x16x64_bf16 v[32:35], v[40:43], a[216:223], v1
    v_smfmac_f32_16x16x64_bf16 v[20:23], v[44:47], v[64:71], v1
    ds_read_b128 v[64:67], v5 offset:10240
    v_max3_u32 v10, v36, v40, v44
    v_smfmac_f32_16x16x64_bf16 v[24:27], v[44:47], a[208:215], v1
    ds_read_b128 v[68:71], v5 offset:11264
    v_max3_u32 v10, v10, v48, v52
    v_smfmac_f32_16x16x64_bf16 v[28:31], v[44:47], a[200:207], v1
    s_waitcnt lgkmcnt(2)
    v_cmp_eq_u32 vcc, -1, v10
    v_smfmac_f32_16x16x64_bf16 v[32:35], v[44:47], v[56:63], v1
    ds_read_b128 v[56:59], v5 offset:12288
    s_cbranch_vccnz M_c0_3_lr
    v_smfmac_f32_16x16x64_bf16 v[20:23], v[48:51], a[192:199], v1
    ds_read_b128 v[60:63], v5 offset:13312
    v_smfmac_f32_16x16x64_bf16 v[24:27], v[48:51], a[184:191], v1
    s_waitcnt lgkmcnt(2)
    v_smfmac_f32_16x16x64_bf16 v[28:31], v[48:51], v[64:71], v1
    ds_read_b128 v[64:67], v5 offset:14336
    v_smfmac_f32_16x16x64_bf16 v[32:35], v[48:51], a[176:183], v1
    ds_read_b128 v[68:71], v5 offset:15360
    s_waitcnt vmcnt(0)
    s_barrier
    ds_read_b128 v[36:39], v6 offset:8192
    ds_read_b128 v[40:43], v6 offset:9216
    ds_read_b128 v[44:47], v6 offset:10240
    ds_read_b128 v[48:51], v6 offset:11264
    ds_read_b32 v11, v6 offset:12288
    v_smfmac_f32_16x16x64_bf16 v[20:23], v[52:55], a[168:175], v1
    s_waitcnt lgkmcnt(7)
    v_smfmac_f32_16x16x64_bf16 v[24:27], v[52:55], v[56:63], v1
    ds_read_b128 v[56:59], v5 offset:16384
    v_smfmac_f32_16x16x64_bf16 v[28:31], v[52:55], a[160:167], v1
    ds_read_b128 v[60:63], v5 offset:17408
    s_waitcnt lgkmcnt(4)
    v_max3_u32 v10, v36, v40, v44
    v_smfmac_f32_16x16x64_bf16 v[32:35], v[52:55], a[152:159], v1
    s_waitcnt lgkmcnt(2)
    v_max3_u32 v10, v10, v48, v11
    v_cmp_eq_u32 vcc, -1, v10
    s_cbranch_vccnz M_c0_3_rr
M_c0_3_rr_r:
    ds_read_b128 v[52:55], v6 offset:12288
    buffer_store_dwordx4 v[72:75], v0, s[8:11], s4 offen offset:2048 sc1
    buffer_store_dwordx4 v[76:79], v0, s[8:11], s4 offen offset:3072 sc1
    s_mov_b32 s4, 0x10000000
    v_smfmac_f32_16x16x64_bf16 v[20:23], v[36:39], v[64:71], v1
    ds_read_b128 v[64:67], v5 offset:18432
    v_smfmac_f32_16x16x64_bf16 v[24:27], v[36:39], a[144:151], v1
    ds_read_b128 v[68:71], v5 offset:19456
    v_smfmac_f32_16x16x64_bf16 v[20:23], v[40:43], a[136:143], v1
    s_waitcnt lgkmcnt(3)
    v_smfmac_f32_16x16x64_bf16 v[24:27], v[40:43], v[56:63], v1
    ds_read_b128 v[56:59], v5 offset:20480
    v_smfmac_f32_16x16x64_bf16 v[20:23], v[44:47], a[128:135], v1
    ds_read_b128 v[60:63], v5 offset:21504
    v_smfmac_f32_16x16x64_bf16 v[24:27], v[44:47], a[120:127], v1
    s_waitcnt lgkmcnt(2)
    v_smfmac_f32_16x16x64_bf16 v[20:23], v[48:51], v[64:71], v1
    ds_read_b128 v[64:67], v5 offset:22528
    v_smfmac_f32_16x16x64_bf16 v[24:27], v[48:51], a[112:119], v1
    ds_read_b128 v[68:71], v5 offset:23552
    v_smfmac_f32_16x16x64_bf16 v[20:23], v[52:55], a[104:111], v1
    s_waitcnt lgkmcnt(2)
    v_smfmac_f32_16x16x64_bf16 v[24:27], v[52:55], v[56:63], v1
    ds_read_b128 v[56:59], v5 offset:24576
    v_smfmac_f32_16x16x64_bf16 v[28:31], v[36:39], a[96:103], v1
    ds_read_b128 v[60:63], v5 offset:25600
    v_smfmac_f32_16x16x64_bf16 v[32:35], v[36:39], a[88:95], v1
    s_waitcnt lgkmcnt(2)
    v_mov_b32 v5, v5
    v_mov_b32 v5, v5
    v_permlane32_swap_b32 v20, v21
    v_smfmac_f32_16x16x64_bf16 v[28:31], v[40:43], v[64:71], v1
    ds_read_b128 v[64:67], v5 offset:26624
    v_permlane32_swap_b32 v22, v23
    v_smfmac_f32_16x16x64_bf16 v[32:35], v[40:43], a[80:87], v1
    ds_read_b128 v[68:71], v5 offset:27648
    v_permlane32_swap_b32 v24, v25
    v_smfmac_f32_16x16x64_bf16 v[28:31], v[44:47], a[72:79], v1
    s_waitcnt lgkmcnt(2)
    v_permlane32_swap_b32 v26, v27
    v_smfmac_f32_16x16x64_bf16 v[32:35], v[44:47], v[56:63], v1
    ds_read_b128 v[56:59], v5 offset:28672
    v_add_f32 v20, v20, v21
    v_add_f32 v22, v22, v23
    v_smfmac_f32_16x16x64_bf16 v[28:31], v[48:51], a[64:71], v1
    ds_read_b128 v[60:63], v5 offset:29696
    v_add_f32 v24, v24, v25
    v_add_f32 v26, v26, v27
    v_smfmac_f32_16x16x64_bf16 v[32:35], v[48:51], a[56:63], v1
    s_waitcnt lgkmcnt(2)
    v_mul_f32 v20, s40, v20
    v_mul_f32 v24, s40, v24
    v_smfmac_f32_16x16x64_bf16 v[28:31], v[52:55], v[64:71], v1
    ds_read_b128 v[64:67], v5 offset:30720
    v_mul_f32 v22, s40, v22
    v_mul_f32 v26, s40, v26
    v_smfmac_f32_16x16x64_bf16 v[32:35], v[52:55], a[48:55], v1
    ds_read_b128 v[68:71], v5 offset:31744
    v_cvt_pk_bf16_f32 v20, v20, v24
    v_cvt_pk_bf16_f32 v21, v22, v26
    v_smfmac_f32_16x16x64_bf16 v[12:15], v[36:39], a[40:47], v1
    ds_write_b32 v2, v20 offset:18432
    ds_write_b32 v2, v21 offset:19008
    s_waitcnt lgkmcnt(4)
    v_smfmac_f32_16x16x64_bf16 v[16:19], v[36:39], v[56:63], v1
    ds_read_b128 v[56:59], v5 offset:32768
    v_permlane32_swap_b32 v28, v29
    v_smfmac_f32_16x16x64_bf16 v[12:15], v[40:43], a[32:39], v1
    ds_read_b128 v[60:63], v5 offset:33792
    v_permlane32_swap_b32 v30, v31
    v_smfmac_f32_16x16x64_bf16 v[16:19], v[40:43], a[24:31], v1
    ds_read_b128 v[36:39], v6 offset:13312
    s_waitcnt lgkmcnt(5)
    v_permlane32_swap_b32 v32, v33
    v_smfmac_f32_16x16x64_bf16 v[12:15], v[44:47], v[64:71], v1
    ds_read_b128 v[40:43], v6 offset:14336
    v_permlane32_swap_b32 v34, v35
    v_smfmac_f32_16x16x64_bf16 v[16:19], v[44:47], a[16:23], v1
    ds_read_b128 v[44:47], v6 offset:15360
    v_add_f32 v28, v28, v29
    v_add_f32 v30, v30, v31
    v_smfmac_f32_16x16x64_bf16 v[12:15], v[48:51], a[8:15], v1
    ds_read_b128 v[64:67], v0 offset:2048
    s_waitcnt lgkmcnt(4)
    v_add_f32 v32, v32, v33
    v_add_f32 v34, v34, v35
    v_smfmac_f32_16x16x64_bf16 v[16:19], v[48:51], v[56:63], v1
    ds_read_b128 v[68:71], v0 offset:3072
    v_cvt_pk_bf16_f32 v28, v28, v32
    v_cvt_pk_bf16_f32 v29, v30, v34
    v_smfmac_f32_16x16x64_bf16 v[12:15], v[52:55], a[0:7], v1
    ds_write_b32 v2, v28 offset:20736
    ds_write_b32 v2, v29 offset:21312
    v_smfmac_f32_16x16x64_bf16 v[16:19], v[52:55], v[248:255], v1
    ds_read_b128 v[48:51], v6 offset:16384
    s_waitcnt lgkmcnt(7)
    v_smfmac_f32_16x16x64_bf16 v[12:15], v[36:39], v[240:247], v1
    ds_read_b128 v[56:59], v0 offset:0
    v_smfmac_f32_16x16x64_bf16 v[16:19], v[36:39], v[232:239], v1
    s_waitcnt vmcnt(2) lgkmcnt(2)
    s_barrier
    ds_read_b128 v[20:23], v3 offset:18432
    ds_read_b128 v[24:27], v3 offset:18496
    v_smfmac_f32_16x16x64_bf16 v[12:15], v[40:43], v[224:231], v1
    ds_read_b128 v[28:31], v3 offset:18560
    v_smfmac_f32_16x16x64_bf16 v[16:19], v[40:43], v[216:223], v1
    ds_read_b128 v[32:35], v3 offset:18624
    v_smfmac_f32_16x16x64_bf16 v[12:15], v[44:47], v[208:215], v1
    ds_read_b128 v[60:63], v0 offset:1024
    v_smfmac_f32_16x16x64_bf16 v[16:19], v[44:47], v[200:207], v1
    ds_read_b128 v[52:55], v6 offset:17408
    s_waitcnt lgkmcnt(5)
    v_mfma_f32_16x16x32_bf16 v[36:39], v[56:59], v[20:23], 0
    ds_read_b128 v[56:59], v0 offset:4096
    s_waitcnt lgkmcnt(2)
    v_mfma_f32_16x16x32_bf16 v[36:39], v[60:63], v[24:27], v[36:39]
    ds_read_b128 v[60:63], v0 offset:5120
    v_mfma_f32_16x16x32_bf16 v[36:39], v[64:67], v[28:31], v[36:39]
    ds_read_b128 v[64:67], v0 offset:6144
    v_mfma_f32_16x16x32_bf16 v[36:39], v[68:71], v[32:35], v[36:39]
    ds_read_b128 v[68:71], v0 offset:7168
    v_mov_b64 v[72:73], s[24:25]
    v_smfmac_f32_16x16x64_bf16 v[12:15], v[48:51], v[192:199], v1
    v_mov_b64 v[74:75], s[24:25]
    v_smfmac_f32_16x16x64_bf16 v[16:19], v[48:51], v[184:191], v1
    s_waitcnt lgkmcnt(3)
    v_mov_b64 v[10:11], s[16:17]
    v_mfma_f32_16x16x32_bf16 v[40:43], v[56:59], v[20:23], 0
    ds_read_b128 v[56:59], v3 offset:20736
    s_waitcnt lgkmcnt(3)
    v_exp_f32 v36, v36
    v_mfma_f32_16x16x32_bf16 v[40:43], v[60:63], v[24:27], v[40:43]
    ds_read_b128 v[60:63], v3 offset:20800
    s_waitcnt lgkmcnt(3)
    v_exp_f32 v37, v37
    v_mfma_f32_16x16x32_bf16 v[40:43], v[64:67], v[28:31], v[40:43]
    ds_read_b128 v[64:67], v3 offset:20864
    s_waitcnt lgkmcnt(3)
    v_exp_f32 v38, v38
    v_mfma_f32_16x16x32_bf16 v[40:43], v[68:71], v[32:35], v[40:43]
    ds_read_b128 v[68:71], v3 offset:20928
    v_exp_f32 v39, v39
    v_smfmac_f32_16x16x64_bf16 v[12:15], v[52:55], v[176:183], v1
    v_cvt_pk_bf16_f32 v36, v36, v37
    v_smfmac_f32_16x16x64_bf16 v[16:19], v[52:55], v[168:175], v1
    s_waitcnt lgkmcnt(3)
    v_cvt_pk_bf16_f32 v37, v38, v39
    v_mfma_f32_16x16x32_bf16 v[48:51], v[56:59], v[20:23], 0
    s_waitcnt lgkmcnt(2)
    v_exp_f32 v40, v40
    v_mfma_f32_16x16x32_bf16 v[48:51], v[60:63], v[24:27], v[48:51]
    s_waitcnt lgkmcnt(1)
    v_exp_f32 v41, v41
    v_mfma_f32_16x16x32_bf16 v[48:51], v[64:67], v[28:31], v[48:51]
    s_waitcnt lgkmcnt(0)
    v_exp_f32 v42, v42
    v_mfma_f32_16x16x32_bf16 v[48:51], v[68:71], v[32:35], v[48:51]
    v_exp_f32 v43, v43
    v_cvt_pk_bf16_f32 v38, v40, v41
    v_cvt_pk_bf16_f32 v39, v42, v43
    v_cvt_pk_bf16_f32 v12, v12, v13
    v_cvt_pk_bf16_f32 v13, v14, v15
    v_mfma_f32_16x16x32_bf16 v[28:31], v[72:75], v[36:39], 0
    v_cvt_pk_bf16_f32 v14, v16, v17
    s_nop 0
    v_exp_f32 v48, v48
    v_mfma_f32_16x16x32_bf16 v[20:23], v[80:83], v[36:39], 0
    v_exp_f32 v49, v49
    v_exp_f32 v50, v50
    v_mfma_f32_16x16x32_bf16 v[24:27], v[84:87], v[36:39], 0
    v_exp_f32 v51, v51
    v_cvt_pk_bf16_f32 v48, v48, v49
    v_cvt_pk_bf16_f32 v49, v50, v51
    v_cvt_pk_bf16_f32 v15, v18, v19
M_c0_3_fin:
    s_nop 0
    v_mfma_f32_16x16x16_bf16 v[28:31], v[10:11], v[48:49], v[28:31]
    s_cmp_eq_u32 s57, 63
    v_mfma_f32_16x16x16_bf16 v[20:23], v[12:13], v[48:49], v[20:23]
    ds_write_b128 v0, v[12:15] offset:11264
    v_mfma_f32_16x16x16_bf16 v[24:27], v[14:15], v[48:49], v[24:27]
    s_cbranch_scc1 M_c0_3_last
    v_mov_b64 v[56:57], 0
    v_mov_b64 v[58:59], 0
    s_nop 0
    v_rcp_f32 v30, v28
    v_subrev_u32 v29, s68, v28
    v_pk_mul_f32 v[20:21], v[20:21], v[30:31] op_sel_hi:[1,0]
    v_pk_mul_f32 v[22:23], v[22:23], v[30:31] op_sel_hi:[1,0]
    v_cvt_pk_bf16_f32 v20, v20, v21
    v_cvt_pk_bf16_f32 v21, v22, v23
    v_pk_mul_f32 v[24:25], v[24:25], v[30:31] op_sel_hi:[1,0]
    v_pk_mul_f32 v[26:27], v[26:27], v[30:31] op_sel_hi:[1,0]
    v_cvt_pk_bf16_f32 v22, v24, v25
    v_cvt_pk_bf16_f32 v23, v26, v27
    ds_write2_b64 v4, v[20:21], v[22:23] offset0:0 offset1:16
    v_cmp_lt_u32 vcc, s69, v29
    s_cbranch_vccnz M_c0_3_zbad
M_c0_3_zok:
    buffer_load_dwordx4 v[80:83], v0, s[8:11], s3 offen offset:0 sc1
    buffer_load_dwordx4 v[84:87], v0, s[8:11], s3 offen offset:1024 sc1
    s_waitcnt lgkmcnt(0)
    s_barrier
    ds_read_b128 v[40:43], v0 offset:13312
    ds_read_b128 v[48:51], v0 offset:14336
    s_mov_b32 m0, 6144
    s_nop 0
    buffer_load_dwordx4 v0, s[8:11], s26 offen offset:0 sc1 lds
    buffer_load_dwordx4 v0, s[8:11], s26 offen offset:1024 sc1 lds
    v_mov_b64 v[60:61], 0
    v_mov_b64 v[62:63], 0
    v_mov_b64 v[64:65], 0
    v_mov_b64 v[66:67], 0
    v_mov_b64 v[68:69], 0
    v_mov_b64 v[70:71], 0
    v_mov_b64 v[52:53], 0
    v_mov_b64 v[54:55], 0
    s_waitcnt lgkmcnt(1)
    v_smfmac_f32_16x16x64_bf16 v[56:59], v[40:43], v[160:167], v1
    v_smfmac_f32_16x16x64_bf16 v[60:63], v[40:43], v[144:151], v1
    s_waitcnt lgkmcnt(0)
    v_smfmac_f32_16x16x64_bf16 v[56:59], v[48:51], v[152:159], v1
    v_smfmac_f32_16x16x64_bf16 v[60:63], v[48:51], v[136:143], v1
    v_smfmac_f32_16x16x64_bf16 v[64:67], v[40:43], v[128:135], v1
    v_smfmac_f32_16x16x64_bf16 v[68:71], v[40:43], v[112:119], v1
    v_permlane32_swap_b32 v56, v57
    v_smfmac_f32_16x16x64_bf16 v[64:67], v[48:51], v[120:127], v1
    v_permlane32_swap_b32 v58, v59
    v_smfmac_f32_16x16x64_bf16 v[68:71], v[48:51], v[104:111], v1
    v_add_f32 v56, v56, v57
    v_add_f32 v58, v58, v59
    v_smfmac_f32_16x16x64_bf16 v[52:55], v[40:43], v[96:103], v1
    v_permlane32_swap_b32 v60, v61
    v_smfmac_f32_16x16x64_bf16 v[52:55], v[48:51], v[88:95], v1
    v_permlane32_swap_b32 v62, v63
    v_add_f32 v60, v60, v61
    v_add_f32 v62, v62, v63
    v_cvt_pk_bf16_f32 v36, v56, v60
    v_cvt_pk_bf16_f32 v38, v58, v62
    v_permlane32_swap_b32 v64, v65
    v_permlane32_swap_b32 v66, v67
    v_add_f32 v64, v64, v65
    v_add_f32 v66, v66, v67
    v_permlane32_swap_b32 v68, v69
    v_permlane32_swap_b32 v70, v71
    v_add_f32 v68, v68, v69
    v_add_f32 v70, v70, v71
    v_cvt_pk_bf16_f32 v37, v64, v68
    v_cvt_pk_bf16_f32 v39, v66, v70
    buffer_store_dwordx4 v[36:39], v0, s[8:11], s56 offen
    v_permlane32_swap_b32 v52, v53
    v_permlane32_swap_b32 v54, v55
    v_add_f32 v52, v52, v53
    v_add_f32 v54, v54, v55
    v_cvt_pk_bf16_f32 v52, v52, v54
    buffer_store_dword v52, v7, s[8:11], s55 offen
    s_add_u32 s27, s44, 1
    s_and_b32 s27, s27, 3
    s_mul_i32 s48, s27, 5120
    s_add_u32 s48, s48, s41
    s_lshl_b32 s27, s27, 15
    s_add_u32 s49, s27, s47
    v_add_u32 v10, 10240, v0
    v_add_u32 v11, 20864, v3
    v_cndmask_b32_e64 v10, v10, v11, s[42:43]
    ds_read_b128 v[72:75], v10 offset:0
    v_add_u32 v10, 11264, v0
    v_add_u32 v11, 20928, v3
    v_cndmask_b32_e64 v10, v10, v11, s[42:43]
    ds_read_b128 v[76:79], v10 offset:0
    s_lshl_b32 s4, s44, 18
    s_add_u32 s4, s4, s53
    ds_read_b128 v[56:59], v5 offset:0
    ds_read_b128 v[60:63], v5 offset:1024
    ds_read_b128 v[64:67], v5 offset:2048
    ds_read_b128 v[68:71], v5 offset:3072
    v_mov_b64 v[12:13], 0
    v_mov_b64 v[14:15], 0
    v_mov_b64 v[16:17], 0
    v_mov_b64 v[18:19], 0
    v_mov_b64 v[20:21], 0
    v_mov_b64 v[22:23], 0
    v_mov_b64 v[24:25], 0
    v_mov_b64 v[26:27], 0
    v_mov_b64 v[28:29], 0
    v_mov_b64 v[30:31], 0
    v_mov_b64 v[32:33], 0
    v_mov_b64 v[34:35], 0
    s_barrier
    s_and_b32 s26, s44, 63
    s_add_u32 s26, s26, 2
    s_min_u32 s26, s26, 63
    s_lshl_b32 s26, s26, 18
    s_add_u32 s26, s26, s50
    s_add_u32 s26, s26, 6144
    s_add_u32 s3, s26, 16777216
    s_nop 15
    s_nop 15
    s_nop 15
    s_nop 0
    s_mov_b32 m0, 13312
    s_nop 0
    buffer_load_dwordx4 v0, s[8:11], s48 offen offset:3072 sc1 lds
    s_mov_b32 m0, 17408
    s_add_u32 s59, s48, 4096
    buffer_load_dwordx4 v0, s[8:11], s59 offen offset:0 sc1 lds
    s_nop 11
    s_mov_b32 m0, 13312
    s_nop 0
    buffer_load_dwordx4 v0, s[8:11], s48 offen offset:3072 sc1 lds
    s_mov_b32 m0, 17408
    s_add_u32 s59, s48, 4096
    buffer_load_dwordx4 v0, s[8:11], s59 offen offset:0 sc1 lds
    s_nop 11
    s_mov_b32 m0, 13312
    s_nop 0
    buffer_load_dwordx4 v0, s[8:11], s48 offen offset:3072 sc1 lds
    s_mov_b32 m0, 17408
    s_add_u32 s59, s48, 4096
    buffer_load_dwordx4 v0, s[8:11], s59 offen offset:0 sc1 lds
    s_add_u32 s44, s44, 1
    s_mov_b32 s70, 0
    s_waitcnt lgkmcnt(0)
    s_branch M_c0_3_top
M_c0_3_restart:
    s_waitcnt vmcnt(0) lgkmcnt(0)
    s_nop 7
    s_barrier
    s_mov_b32 m0, 13312
    s_nop 0
    buffer_load_dwordx4 v0, s[8:11], s48 offen offset:3072 sc1 lds
    s_mov_b32 m0, 17408
    s_add_u32 s59, s48, 4096
    buffer_load_dwordx4 v0, s[8:11], s59 offen offset:0 sc1 lds
    ds_read_b128 v[56:59], v5 offset:0
    ds_read_b128 v[60:63], v5 offset:1024
    ds_read_b128 v[64:67], v5 offset:2048
    ds_read_b128 v[68:71], v5 offset:3072
    v_mov_b64 v[12:13], 0
    v_mov_b64 v[14:15], 0
    v_mov_b64 v[16:17], 0
    v_mov_b64 v[18:19], 0
    v_mov_b64 v[20:21], 0
    v_mov_b64 v[22:23], 0
    v_mov_b64 v[24:25], 0
    v_mov_b64 v[26:27], 0
    v_mov_b64 v[28:29], 0
    v_mov_b64 v[30:31], 0
    v_mov_b64 v[32:33], 0
    v_mov_b64 v[34:35], 0
    s_waitcnt vmcnt(0) lgkmcnt(0)
    s_branch M_c0_3_top
M_c0_3_zbad:
    s_cmp_eq_u32 s70, 2
    s_cbranch_scc1 M_c0_3_zok
    v_cmp_u_f32 vcc, v28, v28
    s_cbranch_vccz M_c0_3_exact
    s_cmp_eq_u32 s70, 1
    s_cbranch_scc1 M_c0_3_exact
M_c0_3_vfy0:
    s_mov_b32 s70, 1
    s_mov_b32 s30, 0
    s_waitcnt vmcnt(0) lgkmcnt(0)
    s_nop 7
M_c0_3_vfy:
    v_mov_b32 v10, 0
    s_add_u32 s59, s48, 4096
    buffer_load_dwordx4 v[36:39], v0, s[8:11], s48 offen offset:0 sc1
    buffer_load_dwordx4 v[40:43], v0, s[8:11], s48 offen offset:1024 sc1
    buffer_load_dwordx4 v[44:47], v0, s[8:11], s48 offen offset:2048 sc1
    buffer_load_dwordx4 v[48:51], v0, s[8:11], s48 offen offset:3072 sc1
    buffer_load_dwordx4 v[52:55], v0, s[8:11], s59 offen offset:0 sc1
    s_waitcnt vmcnt(4)
    v_max3_u32 v10, v10, v36, v37
    v_max3_u32 v10, v10, v38, v39
    s_waitcnt vmcnt(3)
    v_max3_u32 v10, v10, v40, v41
    v_max3_u32 v10, v10, v42, v43
    s_waitcnt vmcnt(2)
    v_max3_u32 v10, v10, v44, v45
    v_max3_u32 v10, v10, v46, v47
    s_waitcnt vmcnt(1)
    v_max3_u32 v10, v10, v48, v49
    v_max3_u32 v10, v10, v50, v51
    s_waitcnt vmcnt(0)
    v_max3_u32 v10, v10, v52, v53
    v_max3_u32 v10, v10, v54, v55
    s_add_u32 s59, s49, 4096
    buffer_load_dwordx4 v[36:39], v0, s[8:11], s49 offen offset:0 sc1
    buffer_load_dwordx4 v[40:43], v0, s[8:11], s49 offen offset:1024 sc1
    buffer_load_dwordx4 v[44:47], v0, s[8:11], s49 offen offset:2048 sc1
    buffer_load_dwordx4 v[48:51], v0, s[8:11], s49 offen offset:3072 sc1
    buffer_load_dwordx4 v[52:55], v0, s[8:11], s59 offen offset:0 sc1
    s_waitcnt vmcnt(4)
    v_max3_u32 v10, v10, v36, v37
    v_max3_u32 v10, v10, v38, v39
    s_waitcnt vmcnt(3)
    v_max3_u32 v10, v10, v40, v41
    v_max3_u32 v10, v10, v42, v43
    s_waitcnt vmcnt(2)
    v_max3_u32 v10, v10, v44, v45
    v_max3_u32 v10, v10, v46, v47
    s_waitcnt vmcnt(1)
    v_max3_u32 v10, v10, v48, v49
    v_max3_u32 v10, v10, v50, v51
    s_waitcnt vmcnt(0)
    v_max3_u32 v10, v10, v52, v53
    v_max3_u32 v10, v10, v54, v55
    v_cmp_eq_u32 vcc, -1, v10
    s_cbranch_vccz M_c0_3_restart
    s_add_u32 s30, s30, 1
    s_cmp_ge_u32 s30, 60000
    s_cbranch_scc1 M_fail
    s_branch M_c0_3_vfy
M_c0_3_exact:
    s_nop 7
    s_mov_b32 s70, 2
    s_waitcnt lgkmcnt(0)
    ds_read_b128 v[20:23], v3 offset:18432
    ds_read_b128 v[24:27], v3 offset:18496
    ds_read_b128 v[28:31], v3 offset:18560
    ds_read_b128 v[32:35], v3 offset:18624
    ds_read_b128 v[56:59], v0 offset:0
    s_waitcnt lgkmcnt(0)
    v_mfma_f32_16x16x32_bf16 v[36:39], v[56:59], v[20:23], 0
    s_nop 3
    ds_read_b128 v[60:63], v0 offset:1024
    s_waitcnt lgkmcnt(0)
    v_mfma_f32_16x16x32_bf16 v[36:39], v[60:63], v[24:27], v[36:39]
    s_nop 3
    ds_read_b128 v[56:59], v0 offset:2048
    s_waitcnt lgkmcnt(0)
    v_mfma_f32_16x16x32_bf16 v[36:39], v[56:59], v[28:31], v[36:39]
    s_nop 3
    ds_read_b128 v[60:63], v0 offset:3072
    s_waitcnt lgkmcnt(0)
    v_mfma_f32_16x16x32_bf16 v[36:39], v[60:63], v[32:35], v[36:39]
    s_nop 3
    ds_read_b128 v[56:59], v0 offset:4096
    s_waitcnt lgkmcnt(0)
    v_mfma_f32_16x16x32_bf16 v[40:43], v[56:59], v[20:23], 0
    s_nop 3
    ds_read_b128 v[60:63], v0 offset:5120
    s_waitcnt lgkmcnt(0)
    v_mfma_f32_16x16x32_bf16 v[40:43], v[60:63], v[24:27], v[40:43]
    s_nop 3
    ds_read_b128 v[56:59], v0 offset:6144
    s_waitcnt lgkmcnt(0)
    v_mfma_f32_16x16x32_bf16 v[40:43], v[56:59], v[28:31], v[40:43]
    s_nop 3
    ds_read_b128 v[60:63], v0 offset:7168
    s_waitcnt lgkmcnt(0)
    v_mfma_f32_16x16x32_bf16 v[40:43], v[60:63], v[32:35], v[40:43]
    s_nop 3
    ds_read_b128 v[56:59], v3 offset:20736
    s_waitcnt lgkmcnt(0)
    v_mfma_f32_16x16x32_bf16 v[48:51], v[56:59], v[20:23], 0
    s_nop 3
    ds_read_b128 v[60:63], v3 offset:20800
    s_waitcnt lgkmcnt(0)
    v_mfma_f32_16x16x32_bf16 v[48:51], v[60:63], v[24:27], v[48:51]
    s_nop 3
    ds_read_b128 v[56:59], v3 offset:20864
    s_waitcnt lgkmcnt(0)
    v_mfma_f32_16x16x32_bf16 v[48:51], v[56:59], v[28:31], v[48:51]
    s_nop 3
    ds_read_b128 v[60:63], v3 offset:20928
    s_waitcnt lgkmcnt(0)
    v_mfma_f32_16x16x32_bf16 v[48:51], v[60:63], v[32:35], v[48:51]
    s_nop 3
    v_max3_f32 v64, v36, v37, v38
    v_max3_f32 v64, v64, v39, v40
    v_max3_f32 v64, v64, v41, v42
    s_nop 0
    v_max3_f32 v64, v64, v43, v48
    v_max3_f32 v64, v64, v49, v50
    v_max_f32 v64, v64, v51
    v_mov_b32 v65, v64
    s_nop 1
    v_permlane16_swap_b32 v64, v65
    v_max_f32 v64, v64, v65
    v_mov_b32 v65, v64
    s_nop 1
    v_permlane32_swap_b32 v64, v65
    v_max_f32 v64, v64, v65
    v_sub_f32 v36, v36, v64
    v_exp_f32 v36, v36
    v_sub_f32 v37, v37, v64
    v_exp_f32 v37, v37
    v_sub_f32 v38, v38, v64
    v_exp_f32 v38, v38
    v_sub_f32 v39, v39, v64
    v_exp_f32 v39, v39
    v_sub_f32 v40, v40, v64
    v_exp_f32 v40, v40
    v_sub_f32 v41, v41, v64
    v_exp_f32 v41, v41
    v_sub_f32 v42, v42, v64
    v_exp_f32 v42, v42
    v_sub_f32 v43, v43, v64
    v_exp_f32 v43, v43
    v_sub_f32 v48, v48, v64
    v_exp_f32 v48, v48
    v_sub_f32 v49, v49, v64
    v_exp_f32 v49, v49
    v_sub_f32 v50, v50, v64
    v_exp_f32 v50, v50
    v_sub_f32 v51, v51, v64
    v_exp_f32 v51, v51
    v_cvt_pk_bf16_f32 v36, v36, v37
    v_cvt_pk_bf16_f32 v37, v38, v39
    v_cvt_pk_bf16_f32 v38, v40, v41
    v_cvt_pk_bf16_f32 v39, v42, v43
    v_cvt_pk_bf16_f32 v48, v48, v49
    v_cvt_pk_bf16_f32 v49, v50, v51
    v_mfma_f32_16x16x32_bf16 v[20:23], v[80:83], v[36:39], 0
    v_mfma_f32_16x16x32_bf16 v[24:27], v[84:87], v[36:39], 0
    v_mfma_f32_16x16x32_bf16 v[28:31], v[72:75], v[36:39], 0
    ds_read_b128 v[68:71], v3 offset:20928
    s_waitcnt lgkmcnt(0)
    s_nop 7
    s_branch M_c0_3_fin
M_c0_3_last:
    s_cmp_lg_u32 s70, 0
    s_cbranch_scc1 M_c0_3_last2
    v_cmp_u_f32 vcc, v40, v40
    s_cbranch_vccnz M_c0_3_vfy0
M_c0_3_last2:
    s_waitcnt vmcnt(0) lgkmcnt(0)
    s_barrier
    s_nop 7
    v_add_u32 v10, 10240, v0
    v_add_u32 v11, 20864, v3
    v_cndmask_b32_e64 v10, v10, v11, s[42:43]
    ds_read_b128 v[72:75], v10 offset:0
    v_add_u32 v10, 11264, v0
    v_add_u32 v11, 20928, v3
    v_cndmask_b32_e64 v10, v10, v11, s[42:43]
    ds_read_b128 v[76:79], v10 offset:0
    s_lshl_b32 s4, s44, 18
    s_add_u32 s4, s4, s53
    s_waitcnt lgkmcnt(1)
    buffer_store_dwordx4 v[72:75], v0, s[8:11], s4 offen offset:2048 sc1
    s_waitcnt lgkmcnt(0)
    buffer_store_dwordx4 v[76:79], v0, s[8:11], s4 offen offset:3072 sc1
    s_mov_b32 s4, 0x10000000
    s_waitcnt vmcnt(0)
    s_barrier
    s_nop 7
    v_mov_b64 v[72:73], -1
    v_mov_b64 v[74:75], -1
    s_add_u32 s28, s44, 3
    s_and_b32 s29, s28, 3
    s_mul_i32 s31, s22, 160
    s_waitcnt vmcnt(0)
    s_add_u32 s44, s44, 1
    s_cmp_eq_u32 s44, 128
    s_cbranch_scc1 M_end
    s_branch M_c0_3_layer
M_c0_3_lr:
    s_mov_b32 s30, 0
M_c0_3_lr_l:
    s_waitcnt lgkmcnt(0)
    s_and_b32 s27, s30, 1
    s_cbranch_scc0 M_c0_3_lr_n
    s_waitcnt vmcnt(2)
    s_mov_b32 m0, 13312
    s_nop 0
    buffer_load_dwordx4 v0, s[8:11], s48 offen offset:3072 sc1 lds
    s_mov_b32 m0, 17408
    s_add_u32 s59, s48, 4096
    buffer_load_dwordx4 v0, s[8:11], s59 offen offset:0 sc1 lds
M_c0_3_lr_n:
    ds_read_b128 v[36:39], v6 offset:13312
    ds_read_b128 v[40:43], v6 offset:14336
    ds_read_b128 v[44:47], v6 offset:15360
    ds_read_b128 v[48:51], v6 offset:16384
    ds_read_b128 v[52:55], v6 offset:17408
    s_waitcnt lgkmcnt(2)
    v_max3_u32 v10, v36, v40, v44
    s_waitcnt lgkmcnt(0)
    v_max3_u32 v10, v10, v48, v52
    v_cmp_eq_u32 vcc, -1, v10
    s_cbranch_vccz M_c0_3_lr_d
    s_add_u32 s30, s30, 1
    s_cmp_ge_u32 s30, 480000
    s_cbranch_scc1 M_fail
    s_branch M_c0_3_lr_l
M_c0_3_lr_d:
    ds_read_b128 v[56:59], v5 offset:0
    ds_read_b128 v[60:63], v5 offset:1024
    ds_read_b128 v[64:67], v5 offset:2048
    ds_read_b128 v[68:71], v5 offset:3072
    v_mov_b64 v[12:13], 0
    v_mov_b64 v[14:15], 0
    v_mov_b64 v[16:17], 0
    v_mov_b64 v[18:19], 0
    v_mov_b64 v[20:21], 0
    v_mov_b64 v[22:23], 0
    v_mov_b64 v[24:25], 0
    v_mov_b64 v[26:27], 0
    v_mov_b64 v[28:29], 0
    v_mov_b64 v[30:31], 0
    v_mov_b64 v[32:33], 0
    v_mov_b64 v[34:35], 0
    s_waitcnt lgkmcnt(0)
    s_branch M_c0_3_lr_r
M_c0_3_rr:
    s_mov_b32 s30, 0
M_c0_3_rr_l:
    s_waitcnt lgkmcnt(0)
    s_and_b32 s27, s30, 1
    s_cbranch_scc1 M_c0_3_rr_n
    s_waitcnt vmcnt(1)
    s_mov_b32 m0, 12288
    s_add_u32 s59, s49, 4096
    buffer_load_dwordx4 v0, s[8:11], s59 offen offset:0 sc1 lds
M_c0_3_rr_n:
    ds_read_b128 v[36:39], v6 offset:8192
    ds_read_b128 v[40:43], v6 offset:9216
    ds_read_b128 v[44:47], v6 offset:10240
    ds_read_b128 v[48:51], v6 offset:11264
    ds_read_b32 v11, v6 offset:12288
    s_waitcnt lgkmcnt(2)
    v_max3_u32 v10, v36, v40, v44
    s_waitcnt lgkmcnt(0)
    v_max3_u32 v10, v10, v48, v11
    v_cmp_eq_u32 vcc, -1, v10
    s_cbranch_vccz M_c0_3_rr_d
    s_add_u32 s30, s30, 1
    s_cmp_ge_u32 s30, 480000
    s_cbranch_scc1 M_fail
    s_branch M_c0_3_rr_l
M_c0_3_rr_d:
    s_branch M_c0_3_rr_r
M_c_slow:
    s_cmp_eq_u32 s21, 1
    s_cbranch_scc1 M_c1_1_layer
    s_cmp_eq_u32 s21, 2
    s_cbranch_scc1 M_c1_2_layer
    s_cmp_eq_u32 s21, 3
    s_cbranch_scc1 M_c1_3_layer
M_c1_0_layer:
    s_lshr_b32 s27, s44, 6
    s_mul_i32 s50, s27, 33554432
    s_lshl_b32 s27, s22, 13
    s_add_u32 s50, s50, s27
    s_add_u32 s50, s50, 37748736
    s_barrier
    s_and_b32 s26, s44, 63
    s_lshl_b32 s26, s26, 18
    s_add_u32 s26, s26, s50
    s_add_u32 s3, s26, 16777216
    s_mov_b32 m0, 0
    s_nop 0
    buffer_load_dwordx4 v0, s[8:11], s26 offen offset:0 sc1 lds
    buffer_load_dwordx4 v0, s[8:11], s26 offen offset:1024 sc1 lds
    buffer_load_dwordx4 v[80:83], v0, s[8:11], s3 offen offset:0 sc1
    buffer_load_dwordx4 v[84:87], v0, s[8:11], s3 offen offset:1024 sc1
    s_and_b32 s26, s44, 63
    s_add_u32 s26, s26, 1
    s_min_u32 s26, s26, 63
    s_lshl_b32 s26, s26, 18
    s_add_u32 s26, s26, s50
    s_add_u32 s3, s26, 16777216
    s_mul_i32 s27, s20, 5120
    s_add_u32 s48, s27, 167772160
    s_sub_u32 s49, 167777280, s27
    ds_read_b128 v[56:59], v5 offset:0
    ds_read_b128 v[60:63], v5 offset:1024
    ds_read_b128 v[64:67], v5 offset:2048
    ds_read_b128 v[68:71], v5 offset:3072
    v_mov_b64 v[12:13], 0
    v_mov_b64 v[14:15], 0
    v_mov_b64 v[16:17], 0
    v_mov_b64 v[18:19], 0
    v_mov_b64 v[20:21], 0
    v_mov_b64 v[22:23], 0
    v_mov_b64 v[24:25], 0
    v_mov_b64 v[26:27], 0
    v_mov_b64 v[28:29], 0
    v_mov_b64 v[30:31], 0
    v_mov_b64 v[32:33], 0
    v_mov_b64 v[34:35], 0
    s_mov_b32 s70, 0
    s_waitcnt vmcnt(0) lgkmcnt(0)
M_c1_0_top:
    s_nop 0
    s_barrier
    ds_read_b128 v[36:39], v6 offset:13312
    ds_read_b128 v[40:43], v6 offset:14336
    ds_read_b128 v[44:47], v6 offset:15360
    ds_read_b128 v[48:51], v6 offset:16384
    ds_read_b128 v[52:55], v6 offset:17408
    s_mov_b32 m0, 8192
    s_nop 0
    buffer_load_dwordx4 v0, s[8:11], s49 offen offset:0 sc1 lds
    buffer_load_dwordx4 v0, s[8:11], s49 offen offset:1024 sc1 lds
M_c1_0_lr_r:
    s_waitcnt lgkmcnt(4)
    v_smfmac_f32_16x16x64_bf16 v[20:23], v[36:39], v[56:63], v1
    ds_read_b128 v[56:59], v5 offset:4096
    s_and_b32 s55, s44, 3
    s_mul_i32 s55, s55, 167936
    v_smfmac_f32_16x16x64_bf16 v[24:27], v[36:39], v[64:71], v1
    ds_read_b128 v[64:67], v5 offset:6144
    s_add_u32 s55, s55, s34
    s_add_u32 s56, s55, s35
    v_smfmac_f32_16x16x64_bf16 v[28:31], v[36:39], a[248:255], v1
    ds_read_b128 v[68:71], v5 offset:7168
    s_and_b32 s57, s44, 63
    v_smfmac_f32_16x16x64_bf16 v[32:35], v[36:39], a[240:247], v1
    ds_read_b128 v[60:63], v5 offset:5120
    s_add_u32 s43, s55, s32
    s_waitcnt lgkmcnt(7)
    v_smfmac_f32_16x16x64_bf16 v[20:23], v[40:43], a[232:239], v1
    s_add_u32 s61, s43, 33792
    s_add_u32 s100, s43, 67584
    s_waitcnt lgkmcnt(0)
    v_smfmac_f32_16x16x64_bf16 v[24:27], v[40:43], v[56:63], v1
    ds_read_b128 v[56:59], v5 offset:8192
    s_add_u32 s101, s43, 101376
    v_smfmac_f32_16x16x64_bf16 v[28:31], v[40:43], a[224:231], v1
    ds_read_b128 v[60:63], v5 offset:9216
    v_smfmac_f32_16x16x64_bf16 v[32:35], v[40:43], a[216:223], v1
    v_smfmac_f32_16x16x64_bf16 v[20:23], v[44:47], v[64:71], v1
    ds_read_b128 v[64:67], v5 offset:10240
    v_max3_u32 v10, v36, v40, v44
    v_smfmac_f32_16x16x64_bf16 v[24:27], v[44:47], a[208:215], v1
    ds_read_b128 v[68:71], v5 offset:11264
    v_max3_u32 v10, v10, v48, v52
    v_smfmac_f32_16x16x64_bf16 v[28:31], v[44:47], a[200:207], v1
    s_waitcnt lgkmcnt(2)
    v_cmp_eq_u32 vcc, -1, v10
    v_smfmac_f32_16x16x64_bf16 v[32:35], v[44:47], v[56:63], v1
    ds_read_b128 v[56:59], v5 offset:12288
    s_cbranch_vccnz M_c1_0_lr
    v_smfmac_f32_16x16x64_bf16 v[20:23], v[48:51], a[192:199], v1
    ds_read_b128 v[60:63], v5 offset:13312
    v_smfmac_f32_16x16x64_bf16 v[24:27], v[48:51], a[184:191], v1
    s_waitcnt lgkmcnt(2)
    v_smfmac_f32_16x16x64_bf16 v[28:31], v[48:51], v[64:71], v1
    ds_read_b128 v[64:67], v5 offset:14336
    v_smfmac_f32_16x16x64_bf16 v[32:35], v[48:51], a[176:183], v1
    ds_read_b128 v[68:71], v5 offset:15360
    s_waitcnt vmcnt(0)
    s_barrier
    ds_read_b128 v[36:39], v6 offset:8192
    ds_read_b128 v[40:43], v6 offset:9216
    ds_read_b128 v[44:47], v6 offset:10240
    ds_read_b128 v[48:51], v6 offset:11264
    ds_read_b32 v11, v6 offset:12288
    v_smfmac_f32_16x16x64_bf16 v[20:23], v[52:55], a[168:175], v1
    s_waitcnt lgkmcnt(7)
    v_smfmac_f32_16x16x64_bf16 v[24:27], v[52:55], v[56:63], v1
    ds_read_b128 v[56:59], v5 offset:16384
    v_smfmac_f32_16x16x64_bf16 v[28:31], v[52:55], a[160:167], v1
    ds_read_b128 v[60:63], v5 offset:17408
    s_waitcnt lgkmcnt(4)
    v_max3_u32 v10, v36, v40, v44
    v_smfmac_f32_16x16x64_bf16 v[32:35], v[52:55], a[152:159], v1
    s_waitcnt lgkmcnt(2)
    v_max3_u32 v10, v10, v48, v11
    v_cmp_eq_u32 vcc, -1, v10
    s_cbranch_vccnz M_c1_0_rr
M_c1_0_rr_r:
    ds_read_b128 v[52:55], v6 offset:12288
    s_mov_b64 exec, 0x3ff
    buffer_store_dwordx4 v[72:75], v0, s[8:11], s60 offen sc1
    s_mov_b64 exec, -1
    s_mov_b32 s60, 0x10000000
    s_mov_b32 m0, 23040
    s_nop 0
    buffer_load_dword v9, s[8:11], s3 offen sc1 lds
    buffer_load_dword v9, s[8:11], s26 offen sc1 lds
    v_smfmac_f32_16x16x64_bf16 v[20:23], v[36:39], v[64:71], v1
    ds_read_b128 v[64:67], v5 offset:18432
    v_smfmac_f32_16x16x64_bf16 v[24:27], v[36:39], a[144:151], v1
    ds_read_b128 v[68:71], v5 offset:19456
    v_smfmac_f32_16x16x64_bf16 v[20:23], v[40:43], a[136:143], v1
    s_waitcnt lgkmcnt(3)
    v_smfmac_f32_16x16x64_bf16 v[24:27], v[40:43], v[56:63], v1
    ds_read_b128 v[56:59], v5 offset:20480
    v_smfmac_f32_16x16x64_bf16 v[20:23], v[44:47], a[128:135], v1
    ds_read_b128 v[60:63], v5 offset:21504
    v_smfmac_f32_16x16x64_bf16 v[24:27], v[44:47], a[120:127], v1
    s_waitcnt lgkmcnt(2)
    v_smfmac_f32_16x16x64_bf16 v[20:23], v[48:51], v[64:71], v1
    ds_read_b128 v[64:67], v5 offset:22528
    v_smfmac_f32_16x16x64_bf16 v[24:27], v[48:51], a[112:119], v1
    ds_read_b128 v[68:71], v5 offset:23552
    v_smfmac_f32_16x16x64_bf16 v[20:23], v[52:55], a[104:111], v1
    s_waitcnt lgkmcnt(2)
    v_smfmac_f32_16x16x64_bf16 v[24:27], v[52:55], v[56:63], v1
    ds_read_b128 v[56:59], v5 offset:24576
    v_smfmac_f32_16x16x64_bf16 v[28:31], v[36:39], a[96:103], v1
    ds_read_b128 v[60:63], v5 offset:25600
    v_smfmac_f32_16x16x64_bf16 v[32:35], v[36:39], a[88:95], v1
    s_waitcnt lgkmcnt(2)
    v_mov_b32 v5, v5
    v_mov_b32 v5, v5
    v_permlane32_swap_b32 v20, v21
    v_smfmac_f32_16x16x64_bf16 v[28:31], v[40:43], v[64:71], v1
    ds_read_b128 v[64:67], v5 offset:26624
    v_permlane32_swap_b32 v22, v23
    v_smfmac_f32_16x16x64_bf16 v[32:35], v[40:43], a[80:87], v1
    ds_read_b128 v[68:71], v5 offset:27648
    v_permlane32_swap_b32 v24, v25
    v_smfmac_f32_16x16x64_bf16 v[28:31], v[44:47], a[72:79], v1
    s_waitcnt lgkmcnt(2)
    v_permlane32_swap_b32 v26, v27
    v_smfmac_f32_16x16x64_bf16 v[32:35], v[44:47], v[56:63], v1
    ds_read_b128 v[56:59], v5 offset:28672
    v_add_f32 v20, v20, v21
    v_add_f32 v22, v22, v23
    v_smfmac_f32_16x16x64_bf16 v[28:31], v[48:51], a[64:71], v1
    ds_read_b128 v[60:63], v5 offset:29696
    v_add_f32 v24, v24, v25
    v_add_f32 v26, v26, v27
    v_smfmac_f32_16x16x64_bf16 v[32:35], v[48:51], a[56:63], v1
    s_waitcnt lgkmcnt(2)
    v_mul_f32 v20, s40, v20
    v_mul_f32 v24, s40, v24
    v_smfmac_f32_16x16x64_bf16 v[28:31], v[52:55], v[64:71], v1
    ds_read_b128 v[64:67], v5 offset:30720
    v_mul_f32 v22, s40, v22
    v_mul_f32 v26, s40, v26
    v_smfmac_f32_16x16x64_bf16 v[32:35], v[52:55], a[48:55], v1
    ds_read_b128 v[68:71], v5 offset:31744
    v_cvt_pk_bf16_f32 v20, v20, v24
    v_cvt_pk_bf16_f32 v21, v22, v26
    v_smfmac_f32_16x16x64_bf16 v[12:15], v[36:39], a[40:47], v1
    ds_write_b32 v2, v20 offset:18432
    ds_write_b32 v2, v21 offset:19008
    s_waitcnt lgkmcnt(4)
    v_smfmac_f32_16x16x64_bf16 v[16:19], v[36:39], v[56:63], v1
    ds_read_b128 v[56:59], v5 offset:32768
    v_permlane32_swap_b32 v28, v29
    v_smfmac_f32_16x16x64_bf16 v[12:15], v[40:43], a[32:39], v1
    ds_read_b128 v[60:63], v5 offset:33792
    v_permlane32_swap_b32 v30, v31
    v_smfmac_f32_16x16x64_bf16 v[16:19], v[40:43], a[24:31], v1
    ds_read_b128 v[36:39], v6 offset:13312
    s_waitcnt lgkmcnt(5)
    v_permlane32_swap_b32 v32, v33
    v_smfmac_f32_16x16x64_bf16 v[12:15], v[44:47], v[64:71], v1
    ds_read_b128 v[40:43], v6 offset:14336
    v_permlane32_swap_b32 v34, v35
    v_smfmac_f32_16x16x64_bf16 v[16:19], v[44:47], a[16:23], v1
    ds_read_b128 v[44:47], v6 offset:15360
    v_add_f32 v28, v28, v29
    v_add_f32 v30, v30, v31
    v_smfmac_f32_16x16x64_bf16 v[12:15], v[48:51], a[8:15], v1
    ds_read_b128 v[64:67], v0 offset:2048
    s_waitcnt lgkmcnt(4)
    v_add_f32 v32, v32, v33
    v_add_f32 v34, v34, v35
    v_smfmac_f32_16x16x64_bf16 v[16:19], v[48:51], v[56:63], v1
    ds_read_b128 v[68:71], v0 offset:3072
    v_cvt_pk_bf16_f32 v28, v28, v32
    v_cvt_pk_bf16_f32 v29, v30, v34
    v_smfmac_f32_16x16x64_bf16 v[12:15], v[52:55], a[0:7], v1
    ds_write_b32 v2, v28 offset:20736
    ds_write_b32 v2, v29 offset:21312
    v_smfmac_f32_16x16x64_bf16 v[16:19], v[52:55], v[248:255], v1
    ds_read_b128 v[48:51], v6 offset:16384
    s_waitcnt lgkmcnt(7)
    v_smfmac_f32_16x16x64_bf16 v[12:15], v[36:39], v[240:247], v1
    ds_read_b128 v[56:59], v0 offset:0
    v_smfmac_f32_16x16x64_bf16 v[16:19], v[36:39], v[232:239], v1
    s_waitcnt vmcnt(3) lgkmcnt(2)
    s_barrier
    ds_read_b128 v[20:23], v3 offset:18432
    ds_read_b128 v[24:27], v3 offset:18496
    v_smfmac_f32_16x16x64_bf16 v[12:15], v[40:43], v[224:231], v1
    ds_read_b128 v[28:31], v3 offset:18560
    v_smfmac_f32_16x16x64_bf16 v[16:19], v[40:43], v[216:223], v1
    ds_read_b128 v[32:35], v3 offset:18624
    v_smfmac_f32_16x16x64_bf16 v[12:15], v[44:47], v[208:215], v1
    ds_read_b128 v[60:63], v0 offset:1024
    v_smfmac_f32_16x16x64_bf16 v[16:19], v[44:47], v[200:207], v1
    ds_read_b128 v[52:55], v6 offset:17408
    s_waitcnt lgkmcnt(5)
    v_mfma_f32_16x16x32_bf16 v[36:39], v[56:59], v[20:23], 0
    ds_read_b128 v[56:59], v0 offset:4096
    s_waitcnt lgkmcnt(2)
    v_mfma_f32_16x16x32_bf16 v[36:39], v[60:63], v[24:27], v[36:39]
    ds_read_b128 v[60:63], v0 offset:5120
    v_mfma_f32_16x16x32_bf16 v[36:39], v[64:67], v[28:31], v[36:39]
    ds_read_b128 v[64:67], v0 offset:6144
    v_mfma_f32_16x16x32_bf16 v[36:39], v[68:71], v[32:35], v[36:39]
    ds_read_b128 v[68:71], v0 offset:7168
    v_mov_b64 v[72:73], s[24:25]
    v_smfmac_f32_16x16x64_bf16 v[12:15], v[48:51], v[192:199], v1
    v_mov_b64 v[74:75], s[24:25]
    v_smfmac_f32_16x16x64_bf16 v[16:19], v[48:51], v[184:191], v1
    s_waitcnt lgkmcnt(3)
    v_mov_b64 v[10:11], s[16:17]
    v_mfma_f32_16x16x32_bf16 v[40:43], v[56:59], v[20:23], 0
    ds_read_b128 v[56:59], v3 offset:20736
    s_waitcnt lgkmcnt(3)
    v_exp_f32 v36, v36
    v_mfma_f32_16x16x32_bf16 v[40:43], v[60:63], v[24:27], v[40:43]
    ds_read_b128 v[60:63], v3 offset:20800
    s_waitcnt lgkmcnt(3)
    v_exp_f32 v37, v37
    v_mfma_f32_16x16x32_bf16 v[40:43], v[64:67], v[28:31], v[40:43]
    ds_read_b128 v[64:67], v3 offset:20864
    s_waitcnt lgkmcnt(3)
    v_exp_f32 v38, v38
    v_mfma_f32_16x16x32_bf16 v[40:43], v[68:71], v[32:35], v[40:43]
    ds_read_b128 v[68:71], v3 offset:20928
    v_exp_f32 v39, v39
    v_smfmac_f32_16x16x64_bf16 v[12:15], v[52:55], v[176:183], v1
    v_cvt_pk_bf16_f32 v36, v36, v37
    v_smfmac_f32_16x16x64_bf16 v[16:19], v[52:55], v[168:175], v1
    s_waitcnt lgkmcnt(3)
    v_cvt_pk_bf16_f32 v37, v38, v39
    v_mfma_f32_16x16x32_bf16 v[48:51], v[56:59], v[20:23], 0
    s_waitcnt lgkmcnt(2)
    v_exp_f32 v40, v40
    v_mfma_f32_16x16x32_bf16 v[48:51], v[60:63], v[24:27], v[48:51]
    s_waitcnt lgkmcnt(1)
    v_exp_f32 v41, v41
    v_mfma_f32_16x16x32_bf16 v[48:51], v[64:67], v[28:31], v[48:51]
    s_waitcnt lgkmcnt(0)
    v_exp_f32 v42, v42
    v_mfma_f32_16x16x32_bf16 v[48:51], v[68:71], v[32:35], v[48:51]
    v_exp_f32 v43, v43
    v_cvt_pk_bf16_f32 v38, v40, v41
    v_cvt_pk_bf16_f32 v39, v42, v43
    v_cvt_pk_bf16_f32 v12, v12, v13
    v_cvt_pk_bf16_f32 v13, v14, v15
    v_mfma_f32_16x16x32_bf16 v[28:31], v[72:75], v[36:39], 0
    v_cvt_pk_bf16_f32 v14, v16, v17
    s_nop 0
    v_exp_f32 v48, v48
    v_mfma_f32_16x16x32_bf16 v[20:23], v[80:83], v[36:39], 0
    v_exp_f32 v49, v49
    v_exp_f32 v50, v50
    v_mfma_f32_16x16x32_bf16 v[24:27], v[84:87], v[36:39], 0
    v_exp_f32 v51, v51
    v_cvt_pk_bf16_f32 v48, v48, v49
    v_cvt_pk_bf16_f32 v49, v50, v51
    v_cvt_pk_bf16_f32 v15, v18, v19
M_c1_0_fin:
    s_nop 0
    v_mfma_f32_16x16x16_bf16 v[28:31], v[10:11], v[48:49], v[28:31]
    s_cmp_eq_u32 s57, 63
    v_mfma_f32_16x16x16_bf16 v[20:23], v[12:13], v[48:49], v[20:23]
    ds_write_b128 v0, v[12:15] offset:8192
    v_mfma_f32_16x16x16_bf16 v[24:27], v[14:15], v[48:49], v[24:27]
    s_cbranch_scc1 M_c1_0_last
    v_mov_b64 v[56:57], 0
    v_mov_b64 v[58:59], 0
    s_nop 0
    v_rcp_f32 v30, v28
    v_subrev_u32 v29, s68, v28
    v_pk_mul_f32 v[20:21], v[20:21], v[30:31] op_sel_hi:[1,0]
    v_pk_mul_f32 v[22:23], v[22:23], v[30:31] op_sel_hi:[1,0]
    v_cvt_pk_bf16_f32 v20, v20, v21
    v_cvt_pk_bf16_f32 v21, v22, v23
    v_pk_mul_f32 v[24:25], v[24:25], v[30:31] op_sel_hi:[1,0]
    v_pk_mul_f32 v[26:27], v[26:27], v[30:31] op_sel_hi:[1,0]
    v_cvt_pk_bf16_f32 v22, v24, v25
    v_cvt_pk_bf16_f32 v23, v26, v27
    ds_write2_b64 v4, v[20:21], v[22:23] offset0:0 offset1:16
    v_cmp_lt_u32 vcc, s69, v29
    s_cbranch_vccnz M_c1_0_zbad
M_c1_0_zok:
    buffer_load_dwordx4 v[80:83], v0, s[8:11], s3 offen offset:0 sc1
    buffer_load_dwordx4 v[84:87], v0, s[8:11], s3 offen offset:1024 sc1
    s_waitcnt vmcnt(4) lgkmcnt(0)
    s_barrier
    ds_read_b128 v[40:43], v0 offset:13312
    ds_read_b128 v[48:51], v0 offset:14336
    s_mov_b32 m0, 0
    s_nop 0
    buffer_load_dwordx4 v0, s[8:11], s26 offen offset:0 sc1 lds
    buffer_load_dwordx4 v0, s[8:11], s26 offen offset:1024 sc1 lds
    v_mov_b64 v[60:61], 0
    v_mov_b64 v[62:63], 0
    v_mov_b64 v[64:65], 0
    v_mov_b64 v[66:67], 0
    v_mov_b64 v[68:69], 0
    v_mov_b64 v[70:71], 0
    v_mov_b64 v[52:53], 0
    v_mov_b64 v[54:55], 0
    s_waitcnt lgkmcnt(1)
    v_smfmac_f32_16x16x64_bf16 v[56:59], v[40:43], v[160:167], v1
    v_smfmac_f32_16x16x64_bf16 v[60:63], v[40:43], v[144:151], v1
    s_waitcnt lgkmcnt(0)
    v_smfmac_f32_16x16x64_bf16 v[56:59], v[48:51], v[152:159], v1
    v_smfmac_f32_16x16x64_bf16 v[60:63], v[48:51], v[136:143], v1
    v_smfmac_f32_16x16x64_bf16 v[64:67], v[40:43], v[128:135], v1
    v_smfmac_f32_16x16x64_bf16 v[68:71], v[40:43], v[112:119], v1
    v_permlane32_swap_b32 v56, v57
    v_smfmac_f32_16x16x64_bf16 v[64:67], v[48:51], v[120:127], v1
    v_permlane32_swap_b32 v58, v59
    v_smfmac_f32_16x16x64_bf16 v[68:71], v[48:51], v[104:111], v1
    v_add_f32 v56, v56, v57
    v_add_f32 v58, v58, v59
    v_smfmac_f32_16x16x64_bf16 v[52:55], v[40:43], v[96:103], v1
    v_permlane32_swap_b32 v60, v61
    v_smfmac_f32_16x16x64_bf16 v[52:55], v[48:51], v[88:95], v1
    v_permlane32_swap_b32 v62, v63
    v_add_f32 v60, v60, v61
    v_add_f32 v62, v62, v63
    v_cvt_pk_bf16_f32 v36, v56, v60
    v_cvt_pk_bf16_f32 v38, v58, v62
    v_permlane32_swap_b32 v64, v65
    v_permlane32_swap_b32 v66, v67
    v_add_f32 v64, v64, v65
    v_add_f32 v66, v66, v67
    v_permlane32_swap_b32 v68, v69
    v_permlane32_swap_b32 v70, v71
    v_add_f32 v68, v68, v69
    v_add_f32 v70, v70, v71
    v_cvt_pk_bf16_f32 v37, v64, v68
    v_cvt_pk_bf16_f32 v39, v66, v70
    buffer_store_dwordx4 v[36:39], v0, s[8:11], s56 offen sc1
    v_permlane32_swap_b32 v52, v53
    v_permlane32_swap_b32 v54, v55
    v_add_f32 v52, v52, v53
    v_add_f32 v54, v54, v55
    v_cvt_pk_bf16_f32 v52, v52, v54
    buffer_store_dword v52, v7, s[8:11], s55 offen sc1
    v_and_b32 v32, 16, v0
    v_bfe_u32 v33, v0, 5, 2
    v_lshlrev_b32_e64 v32, v32, s45
    v_cmp_eq_u32_e64 s[64:65], 0, v33
    v_cmp_eq_u32_e64 vcc, 1, v33
    s_add_u32 s27, s44, 1
    s_and_b32 s27, s27, 3
    v_cndmask_b32_e64 v72, 0, v32, s[64:65]
    v_cndmask_b32_e64 v73, 0, v32, vcc
    v_cmp_eq_u32_e64 s[64:65], 2, v33
    v_cmp_eq_u32_e64 vcc, 3, v33
    s_mul_i32 s48, s27, 5120
    s_add_u32 s48, s48, s41
    v_cndmask_b32_e64 v74, 0, v32, s[64:65]
    v_cndmask_b32_e64 v75, 0, v32, vcc
    s_lshl_b32 s27, s27, 15
    s_add_u32 s49, s27, s47
    v_bfe_u32 v11, v0, 4, 3
    v_lshlrev_b32 v11, 3, v11
    v_lshrrev_b32 v32, 8, v0
    v_lshl_add_u32 v11, v32, 6, v11
    s_add_u32 s56, s27, s46
    s_add_u32 s56, s56, s33
    s_add_u32 s58, s48, s33
    v_mov_b32 v5, v5
    s_nop 1
    v_mov_b32 v5, v5
    s_nop 1
    v_mov_b32 v5, v5
    s_nop 1
    v_mov_b32 v5, v5
    s_nop 1
    v_mov_b32 v5, v5
    s_nop 1
    v_mov_b32 v5, v5
    s_nop 1
    v_mov_b32 v5, v5
    v_mov_b32 v5, v5
    buffer_load_dwordx4 v[40:43], v8, s[8:11], s43 offen sc1
    buffer_load_dwordx4 v[44:47], v8, s[8:11], s61 offen sc1
    buffer_load_dwordx4 v[48:51], v8, s[8:11], s100 offen sc1
    buffer_load_dwordx4 v[52:55], v8, s[8:11], s101 offen sc1
    v_mov_b32 v5, v5
    s_nop 1
    v_mov_b32 v5, v5
    s_nop 1
    v_mov_b32 v5, v5
    s_nop 1
    v_mov_b32 v5, v5
    s_nop 1
    v_mov_b32 v5, v5
    s_nop 1
    v_mov_b32 v5, v5
    s_nop 1
    v_mov_b32 v5, v5
    s_nop 1
    v_mov_b32 v5, v5
    s_nop 1
    buffer_load_dwordx4 v[12:15], v8, s[8:11], s43 offen sc1
    buffer_load_dwordx4 v[16:19], v8, s[8:11], s61 offen sc1
    buffer_load_dwordx4 v[20:23], v8, s[8:11], s100 offen sc1
    buffer_load_dwordx4 v[24:27], v8, s[8:11], s101 offen sc1
    v_mov_b32 v5, v5
    s_nop 1
    v_mov_b32 v5, v5
    s_nop 1
    v_mov_b32 v5, v5
    v_mov_b32 v5, v5
    s_waitcnt vmcnt(7)
    v_mfma_f32_16x16x32_bf16 v[76:79], v[72:75], v[40:43], 0
    s_waitcnt vmcnt(6)
    v_mfma_f32_16x16x32_bf16 v[76:79], v[72:75], v[44:47], v[76:79]
    s_waitcnt vmcnt(5)
    v_mfma_f32_16x16x32_bf16 v[76:79], v[72:75], v[48:51], v[76:79]
    s_waitcnt vmcnt(4)
    v_mfma_f32_16x16x32_bf16 v[76:79], v[72:75], v[52:55], v[76:79]
    v_max3_u32 v32, v40, v44, v48
    v_max_u32 v32, v32, v52
    v_cmp_eq_u32 vcc, -1, v32
    s_cbranch_vccnz M_c1_0_wrb_i0
    v_mov_b32 v5, v5
    v_mov_b32 v5, v5
    v_mov_b32 v5, v5
    v_mov_b32 v5, v5
    v_add_f32_dpp v76, v76, v76 row_ror:8 row_mask:0xf bank_mask:0xf
    v_add_f32_dpp v77, v77, v77 row_ror:8 row_mask:0xf bank_mask:0xf
    v_add_f32_dpp v78, v78, v78 row_ror:8 row_mask:0xf bank_mask:0xf
    v_add_f32_dpp v79, v79, v79 row_ror:8 row_mask:0xf bank_mask:0xf
    v_cmp_u_f32 vcc, v76, v76
    v_cvt_pk_bf16_f32 v76, v76, v77
    v_cvt_pk_bf16_f32 v77, v78, v79
    s_cbranch_vccnz M_c1_0_wrb_e0
    s_mov_b64 exec, s[38:39]
    buffer_store_dwordx2 v[76:77], v11, s[8:11], s58 offen sc1
M_c1_0_wrb_d:
    s_barrier
    buffer_store_dwordx2 v[76:77], v11, s[8:11], s56 offen sc1
    s_mov_b64 exec, -1
    s_waitcnt vmcnt(2)
    ds_read_b128 v[56:59], v5 offset:0
    ds_read_b128 v[60:63], v5 offset:1024
    ds_read_b128 v[64:67], v5 offset:2048
    ds_read_b128 v[68:71], v5 offset:3072
    v_mov_b64 v[12:13], 0
    v_mov_b64 v[14:15], 0
    v_mov_b64 v[16:17], 0
    v_mov_b64 v[18:19], 0
    v_mov_b64 v[20:21], 0
    v_mov_b64 v[22:23], 0
    v_mov_b64 v[24:25], 0
    v_mov_b64 v[26:27], 0
    v_mov_b64 v[28:29], 0
    v_mov_b64 v[30:31], 0
    v_mov_b64 v[32:33], 0
    v_mov_b64 v[34:35], 0
    s_and_b32 s26, s44, 63
    s_add_u32 s26, s26, 2
    s_min_u32 s26, s26, 63
    s_lshl_b32 s26, s26, 18
    s_add_u32 s26, s26, s50
    s_add_u32 s3, s26, 16777216
    v_mov_b64 v[72:73], -1
    v_mov_b64 v[74:75], -1
    s_add_u32 s28, s44, 3
    s_and_b32 s29, s28, 3
    s_mul_i32 s31, s22, 160
    s_mul_i32 s28, s29, 167936
    s_add_u32 s28, s28, s34
    s_add_u32 s64, s28, s35
    s_mul_i32 s65, s29, 5120
    s_add_u32 s65, s65, s41
    s_add_u32 s65, s65, s31
    s_lshl_b32 s60, s29, 15
    s_add_u32 s60, s60, s47
    s_add_u32 s60, s60, s31
    s_nop 15
    s_nop 15
    s_nop 15
    s_nop 8
    buffer_store_dwordx4 v[72:75], v0, s[8:11], s64 offen offset:0 sc1
    buffer_store_dwordx4 v[72:75], v0, s[8:11], s64 offen offset:1024 sc1
    s_mov_b64 exec, 0x3ff
    buffer_store_dwordx4 v[72:75], v0, s[8:11], s65 offen sc1
    s_mov_b64 exec, -1
    s_mov_b32 s65, 0x10000000
    s_mov_b32 s64, 0x10000000
    s_add_u32 s44, s44, 1
    s_mov_b32 s70, 0
    s_waitcnt lgkmcnt(0)
    s_branch M_c1_0_top
M_c1_0_restart:
    s_waitcnt vmcnt(0) lgkmcnt(0)
    s_nop 7
    s_barrier
    ds_read_b128 v[56:59], v5 offset:0
    ds_read_b128 v[60:63], v5 offset:1024
    ds_read_b128 v[64:67], v5 offset:2048
    ds_read_b128 v[68:71], v5 offset:3072
    v_mov_b64 v[12:13], 0
    v_mov_b64 v[14:15], 0
    v_mov_b64 v[16:17], 0
    v_mov_b64 v[18:19], 0
    v_mov_b64 v[20:21], 0
    v_mov_b64 v[22:23], 0
    v_mov_b64 v[24:25], 0
    v_mov_b64 v[26:27], 0
    v_mov_b64 v[28:29], 0
    v_mov_b64 v[30:31], 0
    v_mov_b64 v[32:33], 0
    v_mov_b64 v[34:35], 0
    s_waitcnt vmcnt(0) lgkmcnt(0)
    s_branch M_c1_0_top
M_c1_0_zbad:
    s_cmp_eq_u32 s70, 2
    s_cbranch_scc1 M_c1_0_zok
    v_cmp_u_f32 vcc, v28, v28
    s_cbranch_vccz M_c1_0_exact
    s_cmp_eq_u32 s70, 1
    s_cbranch_scc1 M_c1_0_exact
M_c1_0_vfy0:
    s_mov_b32 s70, 1
    s_mov_b32 s30, 0
    s_waitcnt vmcnt(0) lgkmcnt(0)
    s_nop 7
M_c1_0_vfy:
    v_mov_b32 v10, 0
    s_add_u32 s59, s48, 4096
    buffer_load_dwordx4 v[36:39], v0, s[8:11], s48 offen offset:0 sc1
    buffer_load_dwordx4 v[40:43], v0, s[8:11], s48 offen offset:1024 sc1
    buffer_load_dwordx4 v[44:47], v0, s[8:11], s48 offen offset:2048 sc1
    buffer_load_dwordx4 v[48:51], v0, s[8:11], s48 offen offset:3072 sc1
    buffer_load_dwordx4 v[52:55], v0, s[8:11], s59 offen offset:0 sc1
    s_waitcnt vmcnt(4)
    v_max3_u32 v10, v10, v36, v37
    v_max3_u32 v10, v10, v38, v39
    s_waitcnt vmcnt(3)
    v_max3_u32 v10, v10, v40, v41
    v_max3_u32 v10, v10, v42, v43
    s_waitcnt vmcnt(2)
    v_max3_u32 v10, v10, v44, v45
    v_max3_u32 v10, v10, v46, v47
    s_waitcnt vmcnt(1)
    v_max3_u32 v10, v10, v48, v49
    v_max3_u32 v10, v10, v50, v51
    s_waitcnt vmcnt(0)
    v_max3_u32 v10, v10, v52, v53
    v_max3_u32 v10, v10, v54, v55
    s_add_u32 s59, s49, 4096
    buffer_load_dwordx4 v[36:39], v0, s[8:11], s49 offen offset:0 sc1
    buffer_load_dwordx4 v[40:43], v0, s[8:11], s49 offen offset:1024 sc1
    buffer_load_dwordx4 v[44:47], v0, s[8:11], s49 offen offset:2048 sc1
    buffer_load_dwordx4 v[48:51], v0, s[8:11], s49 offen offset:3072 sc1
    buffer_load_dwordx4 v[52:55], v0, s[8:11], s59 offen offset:0 sc1
    s_waitcnt vmcnt(4)
    v_max3_u32 v10, v10, v36, v37
    v_max3_u32 v10, v10, v38, v39
    s_waitcnt vmcnt(3)
    v_max3_u32 v10, v10, v40, v41
    v_max3_u32 v10, v10, v42, v43
    s_waitcnt vmcnt(2)
    v_max3_u32 v10, v10, v44, v45
    v_max3_u32 v10, v10, v46, v47
    s_waitcnt vmcnt(1)
    v_max3_u32 v10, v10, v48, v49
    v_max3_u32 v10, v10, v50, v51
    s_waitcnt vmcnt(0)
    v_max3_u32 v10, v10, v52, v53
    v_max3_u32 v10, v10, v54, v55
    v_cmp_eq_u32 vcc, -1, v10
    s_cbranch_vccz M_c1_0_restart
    s_add_u32 s30, s30, 1
    s_cmp_ge_u32 s30, 60000
    s_cbranch_scc1 M_fail
    s_branch M_c1_0_vfy
M_c1_0_exact:
    s_nop 7
    s_mov_b32 s70, 2
    s_waitcnt lgkmcnt(0)
    ds_read_b128 v[20:23], v3 offset:18432
    ds_read_b128 v[24:27], v3 offset:18496
    ds_read_b128 v[28:31], v3 offset:18560
    ds_read_b128 v[32:35], v3 offset:18624
    ds_read_b128 v[56:59], v0 offset:0
    s_waitcnt lgkmcnt(0)
    v_mfma_f32_16x16x32_bf16 v[36:39], v[56:59], v[20:23], 0
    s_nop 3
    ds_read_b128 v[60:63], v0 offset:1024
    s_waitcnt lgkmcnt(0)
    v_mfma_f32_16x16x32_bf16 v[36:39], v[60:63], v[24:27], v[36:39]
    s_nop 3
    ds_read_b128 v[56:59], v0 offset:2048
    s_waitcnt lgkmcnt(0)
    v_mfma_f32_16x16x32_bf16 v[36:39], v[56:59], v[28:31], v[36:39]
    s_nop 3
    ds_read_b128 v[60:63], v0 offset:3072
    s_waitcnt lgkmcnt(0)
    v_mfma_f32_16x16x32_bf16 v[36:39], v[60:63], v[32:35], v[36:39]
    s_nop 3
    ds_read_b128 v[56:59], v0 offset:4096
    s_waitcnt lgkmcnt(0)
    v_mfma_f32_16x16x32_bf16 v[40:43], v[56:59], v[20:23], 0
    s_nop 3
    ds_read_b128 v[60:63], v0 offset:5120
    s_waitcnt lgkmcnt(0)
    v_mfma_f32_16x16x32_bf16 v[40:43], v[60:63], v[24:27], v[40:43]
    s_nop 3
    ds_read_b128 v[56:59], v0 offset:6144
    s_waitcnt lgkmcnt(0)
    v_mfma_f32_16x16x32_bf16 v[40:43], v[56:59], v[28:31], v[40:43]
    s_nop 3
    ds_read_b128 v[60:63], v0 offset:7168
    s_waitcnt lgkmcnt(0)
    v_mfma_f32_16x16x32_bf16 v[40:43], v[60:63], v[32:35], v[40:43]
    s_nop 3
    ds_read_b128 v[56:59], v3 offset:20736
    s_waitcnt lgkmcnt(0)
    v_mfma_f32_16x16x32_bf16 v[48:51], v[56:59], v[20:23], 0
    s_nop 3
    ds_read_b128 v[60:63], v3 offset:20800
    s_waitcnt lgkmcnt(0)
    v_mfma_f32_16x16x32_bf16 v[48:51], v[60:63], v[24:27], v[48:51]
    s_nop 3
    ds_read_b128 v[56:59], v3 offset:20864
    s_waitcnt lgkmcnt(0)
    v_mfma_f32_16x16x32_bf16 v[48:51], v[56:59], v[28:31], v[48:51]
    s_nop 3
    ds_read_b128 v[60:63], v3 offset:20928
    s_waitcnt lgkmcnt(0)
    v_mfma_f32_16x16x32_bf16 v[48:51], v[60:63], v[32:35], v[48:51]
    s_nop 3
    v_max3_f32 v64, v36, v37, v38
    v_max3_f32 v64, v64, v39, v40
    v_max3_f32 v64, v64, v41, v42
    s_nop 0
    v_max3_f32 v64, v64, v43, v48
    v_max3_f32 v64, v64, v49, v50
    v_max_f32 v64, v64, v51
    v_mov_b32 v65, v64
    s_nop 1
    v_permlane16_swap_b32 v64, v65
    v_max_f32 v64, v64, v65
    v_mov_b32 v65, v64
    s_nop 1
    v_permlane32_swap_b32 v64, v65
    v_max_f32 v64, v64, v65
    v_sub_f32 v36, v36, v64
    v_exp_f32 v36, v36
    v_sub_f32 v37, v37, v64
    v_exp_f32 v37, v37
    v_sub_f32 v38, v38, v64
    v_exp_f32 v38, v38
    v_sub_f32 v39, v39, v64
    v_exp_f32 v39, v39
    v_sub_f32 v40, v40, v64
    v_exp_f32 v40, v40
    v_sub_f32 v41, v41, v64
    v_exp_f32 v41, v41
    v_sub_f32 v42, v42, v64
    v_exp_f32 v42, v42
    v_sub_f32 v43, v43, v64
    v_exp_f32 v43, v43
    v_sub_f32 v48, v48, v64
    v_exp_f32 v48, v48
    v_sub_f32 v49, v49, v64
    v_exp_f32 v49, v49
    v_sub_f32 v50, v50, v64
    v_exp_f32 v50, v50
    v_sub_f32 v51, v51, v64
    v_exp_f32 v51, v51
    v_cvt_pk_bf16_f32 v36, v36, v37
    v_cvt_pk_bf16_f32 v37, v38, v39
    v_cvt_pk_bf16_f32 v38, v40, v41
    v_cvt_pk_bf16_f32 v39, v42, v43
    v_cvt_pk_bf16_f32 v48, v48, v49
    v_cvt_pk_bf16_f32 v49, v50, v51
    v_mfma_f32_16x16x32_bf16 v[20:23], v[80:83], v[36:39], 0
    v_mfma_f32_16x16x32_bf16 v[24:27], v[84:87], v[36:39], 0
    v_mfma_f32_16x16x32_bf16 v[28:31], v[72:75], v[36:39], 0
    ds_read_b128 v[56:59], v3 offset:20736
    s_waitcnt lgkmcnt(0)
    s_nop 7
    s_branch M_c1_0_fin
M_c1_0_last:
    s_cmp_lg_u32 s70, 0
    s_cbranch_scc1 M_c1_0_last2
    v_cmp_u_f32 vcc, v40, v40
    s_cbranch_vccnz M_c1_0_vfy0
M_c1_0_last2:
    s_waitcnt vmcnt(0) lgkmcnt(0)
    s_barrier
    s_barrier
    s_nop 7
    v_mov_b64 v[72:73], -1
    v_mov_b64 v[74:75], -1
    s_add_u32 s28, s44, 3
    s_and_b32 s29, s28, 3
    s_mul_i32 s31, s22, 160
    s_mul_i32 s28, s29, 167936
    s_add_u32 s28, s28, s34
    s_add_u32 s64, s28, s35
    s_mul_i32 s65, s29, 5120
    s_add_u32 s65, s65, s41
    s_add_u32 s65, s65, s31
    s_lshl_b32 s60, s29, 15
    s_add_u32 s60, s60, s47
    s_add_u32 s60, s60, s31
    buffer_store_dwordx4 v[72:75], v0, s[8:11], s64 offen offset:0 sc1
    buffer_store_dwordx4 v[72:75], v0, s[8:11], s64 offen offset:1024 sc1
    s_mov_b64 exec, 0x3ff
    buffer_store_dwordx4 v[72:75], v0, s[8:11], s65 offen sc1
    s_mov_b64 exec, -1
    s_mov_b32 s65, 0x10000000
    s_mov_b32 s64, 0x10000000
    s_mov_b64 exec, 0x3ff
    buffer_store_dwordx4 v[72:75], v0, s[8:11], s60 offen sc1
    s_mov_b64 exec, -1
    s_mov_b32 s60, 0x10000000
    s_waitcnt vmcnt(0)
    s_add_u32 s44, s44, 1
    s_cmp_eq_u32 s44, 128
    s_cbranch_scc1 M_end
    s_branch M_c1_0_layer
M_c1_0_lr:
    s_mov_b32 s30, 0
M_c1_0_lr_l:
    s_waitcnt lgkmcnt(0)
    ds_read_b128 v[36:39], v6 offset:13312
    ds_read_b128 v[40:43], v6 offset:14336
    ds_read_b128 v[44:47], v6 offset:15360
    ds_read_b128 v[48:51], v6 offset:16384
    ds_read_b128 v[52:55], v6 offset:17408
    s_waitcnt lgkmcnt(2)
    v_max3_u32 v10, v36, v40, v44
    s_waitcnt lgkmcnt(0)
    v_max3_u32 v10, v10, v48, v52
    v_cmp_eq_u32 vcc, -1, v10
    s_cbranch_vccz M_c1_0_lr_d
    s_add_u32 s30, s30, 1
    s_cmp_ge_u32 s30, 480000
    s_cbranch_scc1 M_fail
    s_branch M_c1_0_lr_l
M_c1_0_lr_d:
    ds_read_b128 v[56:59], v5 offset:0
    ds_read_b128 v[60:63], v5 offset:1024
    ds_read_b128 v[64:67], v5 offset:2048
    ds_read_b128 v[68:71], v5 offset:3072
    v_mov_b64 v[12:13], 0
    v_mov_b64 v[14:15], 0
    v_mov_b64 v[16:17], 0
    v_mov_b64 v[18:19], 0
    v_mov_b64 v[20:21], 0
    v_mov_b64 v[22:23], 0
    v_mov_b64 v[24:25], 0
    v_mov_b64 v[26:27], 0
    v_mov_b64 v[28:29], 0
    v_mov_b64 v[30:31], 0
    v_mov_b64 v[32:33], 0
    v_mov_b64 v[34:35], 0
    s_waitcnt lgkmcnt(0)
    s_branch M_c1_0_lr_r
M_c1_0_rr:
    s_mov_b32 s30, 0
M_c1_0_rr_l:
    s_waitcnt lgkmcnt(0)
    s_and_b32 s27, s30, 1
    s_cbranch_scc1 M_c1_0_rr_n
    s_waitcnt vmcnt(2)
    s_mov_b32 m0, 8192
    s_nop 0
    buffer_load_dwordx4 v0, s[8:11], s49 offen offset:0 sc1 lds
    buffer_load_dwordx4 v0, s[8:11], s49 offen offset:1024 sc1 lds
M_c1_0_rr_n:
    ds_read_b128 v[36:39], v6 offset:8192
    ds_read_b128 v[40:43], v6 offset:9216
    ds_read_b128 v[44:47], v6 offset:10240
    ds_read_b128 v[48:51], v6 offset:11264
    ds_read_b32 v11, v6 offset:12288
    s_waitcnt lgkmcnt(2)
    v_max3_u32 v10, v36, v40, v44
    s_waitcnt lgkmcnt(0)
    v_max3_u32 v10, v10, v48, v11
    v_cmp_eq_u32 vcc, -1, v10
    s_cbranch_vccz M_c1_0_rr_d
    s_add_u32 s30, s30, 1
    s_cmp_ge_u32 s30, 480000
    s_cbranch_scc1 M_fail
    s_branch M_c1_0_rr_l
M_c1_0_rr_d:
    s_branch M_c1_0_rr_r
M_c1_0_wrb_l:
    s_waitcnt vmcnt(4)
    v_mfma_f32_16x16x32_bf16 v[76:79], v[72:75], v[40:43], 0
    v_mfma_f32_16x16x32_bf16 v[76:79], v[72:75], v[44:47], v[76:79]
    v_mfma_f32_16x16x32_bf16 v[76:79], v[72:75], v[48:51], v[76:79]
    v_mfma_f32_16x16x32_bf16 v[76:79], v[72:75], v[52:55], v[76:79]
    v_max3_u32 v32, v40, v44, v48
    v_max_u32 v32, v32, v52
    v_cmp_eq_u32 vcc, -1, v32
    s_cbranch_vccz M_c1_0_wrb_x0
M_c1_0_wrb_i0:
    buffer_load_dwordx4 v[40:43], v8, s[8:11], s43 offen sc1
    buffer_load_dwordx4 v[44:47], v8, s[8:11], s61 offen sc1
    buffer_load_dwordx4 v[48:51], v8, s[8:11], s100 offen sc1
    buffer_load_dwordx4 v[52:55], v8, s[8:11], s101 offen sc1
    s_waitcnt vmcnt(4)
    v_mfma_f32_16x16x32_bf16 v[76:79], v[72:75], v[12:15], 0
    v_mfma_f32_16x16x32_bf16 v[76:79], v[72:75], v[16:19], v[76:79]
    v_mfma_f32_16x16x32_bf16 v[76:79], v[72:75], v[20:23], v[76:79]
    v_mfma_f32_16x16x32_bf16 v[76:79], v[72:75], v[24:27], v[76:79]
    v_max3_u32 v32, v12, v16, v20
    v_max_u32 v32, v32, v24
    v_cmp_eq_u32 vcc, -1, v32
    s_cbranch_vccz M_c1_0_wrb_x1
M_c1_0_wrb_i1:
    buffer_load_dwordx4 v[12:15], v8, s[8:11], s43 offen sc1
    buffer_load_dwordx4 v[16:19], v8, s[8:11], s61 offen sc1
    buffer_load_dwordx4 v[20:23], v8, s[8:11], s100 offen sc1
    buffer_load_dwordx4 v[24:27], v8, s[8:11], s101 offen sc1
    s_add_u32 s71, s71, 1
    s_cmp_lt_u32 s71, 240000
    s_cbranch_scc1 M_c1_0_wrb_l
    s_branch M_fail
M_c1_0_wrb_x0:
    s_nop 3
    v_add_f32_dpp v76, v76, v76 row_ror:8 row_mask:0xf bank_mask:0xf
    v_add_f32_dpp v77, v77, v77 row_ror:8 row_mask:0xf bank_mask:0xf
    v_add_f32_dpp v78, v78, v78 row_ror:8 row_mask:0xf bank_mask:0xf
    v_add_f32_dpp v79, v79, v79 row_ror:8 row_mask:0xf bank_mask:0xf
    v_cmp_u_f32 vcc, v76, v76
    v_cvt_pk_bf16_f32 v76, v76, v77
    v_cvt_pk_bf16_f32 v77, v78, v79
    s_cbranch_vccz M_c1_0_wrb_n
M_c1_0_wrb_e0:
    v_max3_u32 v32, v40, v41, v42
    v_max3_u32 v32, v32, v43, v44
    v_max3_u32 v32, v32, v45, v46
    v_max3_u32 v32, v32, v47, v48
    v_max3_u32 v32, v32, v49, v50
    v_max3_u32 v32, v32, v51, v52
    v_max3_u32 v32, v32, v53, v54
    v_max_u32 v32, v32, v55
    v_cmp_eq_u32 vcc, -1, v32
    s_cbranch_vccnz M_c1_0_wrb_i0
    v_min_u32 v76, -2, v76
    v_min_u32 v77, -2, v77
    s_branch M_c1_0_wrb_n
M_c1_0_wrb_x1:
    s_nop 3
    v_add_f32_dpp v76, v76, v76 row_ror:8 row_mask:0xf bank_mask:0xf
    v_add_f32_dpp v77, v77, v77 row_ror:8 row_mask:0xf bank_mask:0xf
    v_add_f32_dpp v78, v78, v78 row_ror:8 row_mask:0xf bank_mask:0xf
    v_add_f32_dpp v79, v79, v79 row_ror:8 row_mask:0xf bank_mask:0xf
    v_cmp_u_f32 vcc, v76, v76
    v_cvt_pk_bf16_f32 v76, v76, v77
    v_cvt_pk_bf16_f32 v77, v78, v79
    s_cbranch_vccz M_c1_0_wrb_n
M_c1_0_wrb_e1:
    v_max3_u32 v32, v12, v13, v14
    v_max3_u32 v32, v32, v15, v16
    v_max3_u32 v32, v32, v17, v18
    v_max3_u32 v32, v32, v19, v20
    v_max3_u32 v32, v32, v21, v22
    v_max3_u32 v32, v32, v23, v24
    v_max3_u32 v32, v32, v25, v26
    v_max_u32 v32, v32, v27
    v_cmp_eq_u32 vcc, -1, v32
    s_cbranch_vccnz M_c1_0_wrb_i1
    v_min_u32 v76, -2, v76
    v_min_u32 v77, -2, v77
M_c1_0_wrb_n:
    s_mov_b64 exec, s[38:39]
    buffer_store_dwordx2 v[76:77], v11, s[8:11], s58 offen sc1
    s_branch M_c1_0_wrb_d
M_c1_1_layer:
    s_lshr_b32 s27, s44, 6
    s_mul_i32 s50, s27, 33554432
    s_lshl_b32 s27, s22, 13
    s_add_u32 s50, s50, s27
    s_add_u32 s50, s50, 37748736
    s_add_u32 s27, s44, 1
    s_or_b32 s28, s44, 63
    s_add_u32 s28, s28, 1
    s_min_u32 s27, s27, s28
    s_cmp_lt_u32 s54, s27
    s_cbranch_scc1 M_c1_1_p1
M_c1_1_p1_r:
    s_barrier
    s_and_b32 s26, s44, 63
    s_lshl_b32 s26, s26, 18
    s_add_u32 s26, s26, s50
    s_add_u32 s26, s26, 2048
    s_add_u32 s3, s26, 16777216
    s_mov_b32 m0, 2048
    s_nop 0
    buffer_load_dwordx4 v0, s[8:11], s26 offen offset:0 sc1 lds
    buffer_load_dwordx4 v0, s[8:11], s26 offen offset:1024 sc1 lds
    buffer_load_dwordx4 v[80:83], v0, s[8:11], s3 offen offset:0 sc1
    buffer_load_dwordx4 v[84:87], v0, s[8:11], s3 offen offset:1024 sc1
    s_and_b32 s26, s44, 63
    s_add_u32 s26, s26, 1
    s_min_u32 s26, s26, 63
    s_lshl_b32 s26, s26, 18
    s_add_u32 s26, s26, s50
    s_add_u32 s26, s26, 2048
    s_add_u32 s3, s26, 16777216
    s_mul_i32 s27, s20, 5120
    s_add_u32 s48, s27, 167772160
    s_sub_u32 s49, 167777280, s27
    s_add_u32 s27, s44, 2
    s_or_b32 s28, s44, 63
    s_add_u32 s28, s28, 1
    s_min_u32 s27, s27, s28
    s_cmp_lt_u32 s54, s27
    s_cbranch_scc1 M_c1_1_p2
M_c1_1_p2_r:
    ds_read_b128 v[56:59], v5 offset:0
    ds_read_b128 v[60:63], v5 offset:1024
    ds_read_b128 v[64:67], v5 offset:2048
    ds_read_b128 v[68:71], v5 offset:3072
    v_mov_b64 v[12:13], 0
    v_mov_b64 v[14:15], 0
    v_mov_b64 v[16:17], 0
    v_mov_b64 v[18:19], 0
    v_mov_b64 v[20:21], 0
    v_mov_b64 v[22:23], 0
    v_mov_b64 v[24:25], 0
    v_mov_b64 v[26:27], 0
    v_mov_b64 v[28:29], 0
    v_mov_b64 v[30:31], 0
    v_mov_b64 v[32:33], 0
    v_mov_b64 v[34:35], 0
    s_mov_b32 s70, 0
    s_waitcnt vmcnt(0) lgkmcnt(0)
M_c1_1_top:
    s_nop 0
    s_barrier
    ds_read_b128 v[36:39], v6 offset:13312
    ds_read_b128 v[40:43], v6 offset:14336
    ds_read_b128 v[44:47], v6 offset:15360
    ds_read_b128 v[48:51], v6 offset:16384
    ds_read_b128 v[52:55], v6 offset:17408
    s_mov_b32 m0, 8192
    s_nop 0
    buffer_load_dwordx4 v0, s[8:11], s49 offen offset:2048 sc1 lds
M_c1_1_lr_r:
    s_waitcnt lgkmcnt(4)
    v_smfmac_f32_16x16x64_bf16 v[20:23], v[36:39], v[56:63], v1
    ds_read_b128 v[56:59], v5 offset:4096
    s_and_b32 s55, s44, 3
    s_mul_i32 s55, s55, 167936
    v_smfmac_f32_16x16x64_bf16 v[24:27], v[36:39], v[64:71], v1
    ds_read_b128 v[64:67], v5 offset:6144
    s_add_u32 s55, s55, s34
    s_add_u32 s56, s55, s35
    v_smfmac_f32_16x16x64_bf16 v[28:31], v[36:39], a[248:255], v1
    ds_read_b128 v[68:71], v5 offset:7168
    s_and_b32 s57, s44, 63
    v_smfmac_f32_16x16x64_bf16 v[32:35], v[36:39], a[240:247], v1
    ds_read_b128 v[60:63], v5 offset:5120
    s_add_u32 s43, s55, s32
    s_waitcnt lgkmcnt(7)
    v_smfmac_f32_16x16x64_bf16 v[20:23], v[40:43], a[232:239], v1
    s_sub_u32 s27, s57, 1
    s_max_i32 s27, s27, 0
    s_waitcnt lgkmcnt(0)
    v_smfmac_f32_16x16x64_bf16 v[24:27], v[40:43], v[56:63], v1
    ds_read_b128 v[56:59], v5 offset:8192
    s_lshl_b64 s[28:29], 1, s27
    s_lshl_b32 s27, s27, 7
    v_smfmac_f32_16x16x64_bf16 v[28:31], v[40:43], a[224:231], v1
    ds_read_b128 v[60:63], v5 offset:9216
    s_sub_u32 s31, s52, s27
    v_smfmac_f32_16x16x64_bf16 v[32:35], v[40:43], a[216:223], v1
    v_smfmac_f32_16x16x64_bf16 v[20:23], v[44:47], v[64:71], v1
    ds_read_b128 v[64:67], v5 offset:10240
    v_max3_u32 v10, v36, v40, v44
    v_smfmac_f32_16x16x64_bf16 v[24:27], v[44:47], a[208:215], v1
    ds_read_b128 v[68:71], v5 offset:11264
    v_max3_u32 v10, v10, v48, v52
    v_smfmac_f32_16x16x64_bf16 v[28:31], v[44:47], a[200:207], v1
    s_waitcnt lgkmcnt(2)
    v_cmp_eq_u32 vcc, -1, v10
    v_smfmac_f32_16x16x64_bf16 v[32:35], v[44:47], v[56:63], v1
    ds_read_b128 v[56:59], v5 offset:12288
    s_cbranch_vccnz M_c1_1_lr
    v_smfmac_f32_16x16x64_bf16 v[20:23], v[48:51], a[192:199], v1
    ds_read_b128 v[60:63], v5 offset:13312
    v_smfmac_f32_16x16x64_bf16 v[24:27], v[48:51], a[184:191], v1
    s_waitcnt lgkmcnt(2)
    v_smfmac_f32_16x16x64_bf16 v[28:31], v[48:51], v[64:71], v1
    ds_read_b128 v[64:67], v5 offset:14336
    v_smfmac_f32_16x16x64_bf16 v[32:35], v[48:51], a[176:183], v1
    ds_read_b128 v[68:71], v5 offset:15360
    s_waitcnt vmcnt(0)
    s_barrier
    ds_read_b128 v[36:39], v6 offset:8192
    ds_read_b128 v[40:43], v6 offset:9216
    ds_read_b128 v[44:47], v6 offset:10240
    ds_read_b128 v[48:51], v6 offset:11264
    ds_read_b32 v11, v6 offset:12288
    v_smfmac_f32_16x16x64_bf16 v[20:23], v[52:55], a[168:175], v1
    s_waitcnt lgkmcnt(7)
    v_smfmac_f32_16x16x64_bf16 v[24:27], v[52:55], v[56:63], v1
    ds_read_b128 v[56:59], v5 offset:16384
    v_smfmac_f32_16x16x64_bf16 v[28:31], v[52:55], a[160:167], v1
    ds_read_b128 v[60:63], v5 offset:17408
    s_waitcnt lgkmcnt(4)
    v_max3_u32 v10, v36, v40, v44
    v_smfmac_f32_16x16x64_bf16 v[32:35], v[52:55], a[152:159], v1
    s_waitcnt lgkmcnt(2)
    v_max3_u32 v10, v10, v48, v11
    v_cmp_eq_u32 vcc, -1, v10
    s_cbranch_vccnz M_c1_1_rr
M_c1_1_rr_r:
    ds_read_b128 v[52:55], v6 offset:12288
    s_mov_b32 m0, 23296
    s_mov_b64 exec, 3
    buffer_load_dword v9, s[8:11], s51 offen sc1 lds
    s_mov_b64 exec, s[28:29]
    buffer_store_dword v9, v9, s[8:11], s31 offen sc1
    s_mov_b64 exec, -1
    v_smfmac_f32_16x16x64_bf16 v[20:23], v[36:39], v[64:71], v1
    ds_read_b128 v[64:67], v5 offset:18432
    v_smfmac_f32_16x16x64_bf16 v[24:27], v[36:39], a[144:151], v1
    ds_read_b128 v[68:71], v5 offset:19456
    v_smfmac_f32_16x16x64_bf16 v[20:23], v[40:43], a[136:143], v1
    s_waitcnt lgkmcnt(3)
    v_smfmac_f32_16x16x64_bf16 v[24:27], v[40:43], v[56:63], v1
    ds_read_b128 v[56:59], v5 offset:20480
    v_smfmac_f32_16x16x64_bf16 v[20:23], v[44:47], a[128:135], v1
    ds_read_b128 v[60:63], v5 offset:21504
    v_smfmac_f32_16x16x64_bf16 v[24:27], v[44:47], a[120:127], v1
    s_waitcnt lgkmcnt(2)
    v_smfmac_f32_16x16x64_bf16 v[20:23], v[48:51], v[64:71], v1
    ds_read_b128 v[64:67], v5 offset:22528
    v_smfmac_f32_16x16x64_bf16 v[24:27], v[48:51], a[112:119], v1
    ds_read_b128 v[68:71], v5 offset:23552
    v_smfmac_f32_16x16x64_bf16 v[20:23], v[52:55], a[104:111], v1
    s_waitcnt lgkmcnt(2)
    v_smfmac_f32_16x16x64_bf16 v[24:27], v[52:55], v[56:63], v1
    ds_read_b128 v[56:59], v5 offset:24576
    v_smfmac_f32_16x16x64_bf16 v[28:31], v[36:39], a[96:103], v1
    ds_read_b128 v[60:63], v5 offset:25600
    v_smfmac_f32_16x16x64_bf16 v[32:35], v[36:39], a[88:95], v1
    s_waitcnt lgkmcnt(2)
    v_mov_b32 v5, v5
    v_mov_b32 v5, v5
    v_permlane32_swap_b32 v20, v21
    v_smfmac_f32_16x16x64_bf16 v[28:31], v[40:43], v[64:71], v1
    ds_read_b128 v[64:67], v5 offset:26624
    v_permlane32_swap_b32 v22, v23
    v_smfmac_f32_16x16x64_bf16 v[32:35], v[40:43], a[80:87], v1
    ds_read_b128 v[68:71], v5 offset:27648
    v_permlane32_swap_b32 v24, v25
    v_smfmac_f32_16x16x64_bf16 v[28:31], v[44:47], a[72:79], v1
    s_waitcnt lgkmcnt(2)
    v_permlane32_swap_b32 v26, v27
    v_smfmac_f32_16x16x64_bf16 v[32:35], v[44:47], v[56:63], v1
    ds_read_b128 v[56:59], v5 offset:28672
    v_add_f32 v20, v20, v21
    v_add_f32 v22, v22, v23
    v_smfmac_f32_16x16x64_bf16 v[28:31], v[48:51], a[64:71], v1
    ds_read_b128 v[60:63], v5 offset:29696
    v_add_f32 v24, v24, v25
    v_add_f32 v26, v26, v27
    v_smfmac_f32_16x16x64_bf16 v[32:35], v[48:51], a[56:63], v1
    s_waitcnt lgkmcnt(2)
    v_mul_f32 v20, s40, v20
    v_mul_f32 v24, s40, v24
    v_smfmac_f32_16x16x64_bf16 v[28:31], v[52:55], v[64:71], v1
    ds_read_b128 v[64:67], v5 offset:30720
    v_mul_f32 v22, s40, v22
    v_mul_f32 v26, s40, v26
    v_smfmac_f32_16x16x64_bf16 v[32:35], v[52:55], a[48:55], v1
    ds_read_b128 v[68:71], v5 offset:31744
    v_cvt_pk_bf16_f32 v20, v20, v24
    v_cvt_pk_bf16_f32 v21, v22, v26
    v_smfmac_f32_16x16x64_bf16 v[12:15], v[36:39], a[40:47], v1
    ds_write_b32 v2, v20 offset:18432
    ds_write_b32 v2, v21 offset:19008
    s_waitcnt lgkmcnt(4)
    v_smfmac_f32_16x16x64_bf16 v[16:19], v[36:39], v[56:63], v1
    ds_read_b128 v[56:59], v5 offset:32768
    v_permlane32_swap_b32 v28, v29
    v_smfmac_f32_16x16x64_bf16 v[12:15], v[40:43], a[32:39], v1
    ds_read_b128 v[60:63], v5 offset:33792
    v_permlane32_swap_b32 v30, v31
    v_smfmac_f32_16x16x64_bf16 v[16:19], v[40:43], a[24:31], v1
    ds_read_b128 v[36:39], v6 offset:13312
    s_waitcnt lgkmcnt(5)
    v_permlane32_swap_b32 v32, v33
    v_smfmac_f32_16x16x64_bf16 v[12:15], v[44:47], v[64:71], v1
    ds_read_b128 v[40:43], v6 offset:14336
    v_permlane32_swap_b32 v34, v35
    v_smfmac_f32_16x16x64_bf16 v[16:19], v[44:47], a[16:23], v1
    ds_read_b128 v[44:47], v6 offset:15360
    v_add_f32 v28, v28, v29
    v_add_f32 v30, v30, v31
    v_smfmac_f32_16x16x64_bf16 v[12:15], v[48:51], a[8:15], v1
    ds_read_b128 v[64:67], v0 offset:2048
    s_waitcnt lgkmcnt(4)
    v_add_f32 v32, v32, v33
    v_add_f32 v34, v34, v35
    v_smfmac_f32_16x16x64_bf16 v[16:19], v[48:51], v[56:63], v1
    ds_read_b128 v[68:71], v0 offset:3072
    v_cvt_pk_bf16_f32 v28, v28, v32
    v_cvt_pk_bf16_f32 v29, v30, v34
    v_smfmac_f32_16x16x64_bf16 v[12:15], v[52:55], a[0:7], v1
    ds_write_b32 v2, v28 offset:20736
    ds_write_b32 v2, v29 offset:21312
    v_smfmac_f32_16x16x64_bf16 v[16:19], v[52:55], v[248:255], v1
    ds_read_b128 v[48:51], v6 offset:16384
    s_waitcnt lgkmcnt(7)
    v_smfmac_f32_16x16x64_bf16 v[12:15], v[36:39], v[240:247], v1
    ds_read_b128 v[56:59], v0 offset:0
    v_smfmac_f32_16x16x64_bf16 v[16:19], v[36:39], v[232:239], v1
    s_waitcnt vmcnt(2) lgkmcnt(2)
    s_barrier
    ds_read_b128 v[20:23], v3 offset:18432
    ds_read_b128 v[24:27], v3 offset:18496
    v_smfmac_f32_16x16x64_bf16 v[12:15], v[40:43], v[224:231], v1
    ds_read_b128 v[28:31], v3 offset:18560
    v_smfmac_f32_16x16x64_bf16 v[16:19], v[40:43], v[216:223], v1
    ds_read_b128 v[32:35], v3 offset:18624
    v_smfmac_f32_16x16x64_bf16 v[12:15], v[44:47], v[208:215], v1
    ds_read_b128 v[60:63], v0 offset:1024
    v_smfmac_f32_16x16x64_bf16 v[16:19], v[44:47], v[200:207], v1
    ds_read_b128 v[52:55], v6 offset:17408
    s_waitcnt lgkmcnt(5)
    v_mfma_f32_16x16x32_bf16 v[36:39], v[56:59], v[20:23], 0
    ds_read_b128 v[56:59], v0 offset:4096
    s_waitcnt lgkmcnt(2)
    v_mfma_f32_16x16x32_bf16 v[36:39], v[60:63], v[24:27], v[36:39]
    ds_read_b128 v[60:63], v0 offset:5120
    v_mfma_f32_16x16x32_bf16 v[36:39], v[64:67], v[28:31], v[36:39]
    ds_read_b128 v[64:67], v0 offset:6144
    v_mfma_f32_16x16x32_bf16 v[36:39], v[68:71], v[32:35], v[36:39]
    ds_read_b128 v[68:71], v0 offset:7168
    v_mov_b64 v[72:73], s[24:25]
    v_smfmac_f32_16x16x64_bf16 v[12:15], v[48:51], v[192:199], v1
    v_mov_b64 v[74:75], s[24:25]
    v_smfmac_f32_16x16x64_bf16 v[16:19], v[48:51], v[184:191], v1
    s_waitcnt lgkmcnt(3)
    v_mov_b64 v[10:11], s[16:17]
    v_mfma_f32_16x16x32_bf16 v[40:43], v[56:59], v[20:23], 0
    ds_read_b128 v[56:59], v3 offset:20736
    s_waitcnt lgkmcnt(3)
    v_exp_f32 v36, v36
    v_mfma_f32_16x16x32_bf16 v[40:43], v[60:63], v[24:27], v[40:43]
    ds_read_b128 v[60:63], v3 offset:20800
    s_waitcnt lgkmcnt(3)
    v_exp_f32 v37, v37
    v_mfma_f32_16x16x32_bf16 v[40:43], v[64:67], v[28:31], v[40:43]
    ds_read_b128 v[64:67], v3 offset:20864
    s_waitcnt lgkmcnt(3)
    v_exp_f32 v38, v38
    v_mfma_f32_16x16x32_bf16 v[40:43], v[68:71], v[32:35], v[40:43]
    ds_read_b128 v[68:71], v3 offset:20928
    v_exp_f32 v39, v39
    v_smfmac_f32_16x16x64_bf16 v[12:15], v[52:55], v[176:183], v1
    v_cvt_pk_bf16_f32 v36, v36, v37
    v_smfmac_f32_16x16x64_bf16 v[16:19], v[52:55], v[168:175], v1
    s_waitcnt lgkmcnt(3)
    v_cvt_pk_bf16_f32 v37, v38, v39
    v_mfma_f32_16x16x32_bf16 v[48:51], v[56:59], v[20:23], 0
    s_waitcnt lgkmcnt(2)
    v_exp_f32 v40, v40
    v_mfma_f32_16x16x32_bf16 v[48:51], v[60:63], v[24:27], v[48:51]
    s_waitcnt lgkmcnt(1)
    v_exp_f32 v41, v41
    v_mfma_f32_16x16x32_bf16 v[48:51], v[64:67], v[28:31], v[48:51]
    s_waitcnt lgkmcnt(0)
    v_exp_f32 v42, v42
    v_mfma_f32_16x16x32_bf16 v[48:51], v[68:71], v[32:35], v[48:51]
    v_exp_f32 v43, v43
    v_cvt_pk_bf16_f32 v38, v40, v41
    v_cvt_pk_bf16_f32 v39, v42, v43
    v_cvt_pk_bf16_f32 v12, v12, v13
    v_cvt_pk_bf16_f32 v13, v14, v15
    v_mfma_f32_16x16x32_bf16 v[28:31], v[72:75], v[36:39], 0
    v_cvt_pk_bf16_f32 v14, v16, v17
    s_nop 0
    v_exp_f32 v48, v48
    v_mfma_f32_16x16x32_bf16 v[20:23], v[80:83], v[36:39], 0
    v_exp_f32 v49, v49
    v_exp_f32 v50, v50
    v_mfma_f32_16x16x32_bf16 v[24:27], v[84:87], v[36:39], 0
    v_exp_f32 v51, v51
    v_cvt_pk_bf16_f32 v48, v48, v49
    v_cvt_pk_bf16_f32 v49, v50, v51
    v_cvt_pk_bf16_f32 v15, v18, v19
M_c1_1_fin:
    s_nop 0
    v_mfma_f32_16x16x16_bf16 v[28:31], v[10:11], v[48:49], v[28:31]
    s_cmp_eq_u32 s57, 63
    v_mfma_f32_16x16x16_bf16 v[20:23], v[12:13], v[48:49], v[20:23]
    ds_write_b128 v0, v[12:15] offset:9216
    v_mfma_f32_16x16x16_bf16 v[24:27], v[14:15], v[48:49], v[24:27]
    s_cbranch_scc1 M_c1_1_last
    v_mov_b64 v[56:57], 0
    v_mov_b64 v[58:59], 0
    s_nop 0
    v_rcp_f32 v30, v28
    v_subrev_u32 v29, s68, v28
    v_pk_mul_f32 v[20:21], v[20:21], v[30:31] op_sel_hi:[1,0]
    v_pk_mul_f32 v[22:23], v[22:23], v[30:31] op_sel_hi:[1,0]
    v_cvt_pk_bf16_f32 v20, v20, v21
    v_cvt_pk_bf16_f32 v21, v22, v23
    v_pk_mul_f32 v[24:25], v[24:25], v[30:31] op_sel_hi:[1,0]
    v_pk_mul_f32 v[26:27], v[26:27], v[30:31] op_sel_hi:[1,0]
    v_cvt_pk_bf16_f32 v22, v24, v25
    v_cvt_pk_bf16_f32 v23, v26, v27
    ds_write2_b64 v4, v[20:21], v[22:23] offset0:0 offset1:16
    v_cmp_lt_u32 vcc, s69, v29
    s_cbranch_vccnz M_c1_1_zbad
M_c1_1_zok:
    buffer_load_dwordx4 v[80:83], v0, s[8:11], s3 offen offset:0 sc1
    buffer_load_dwordx4 v[84:87], v0, s[8:11], s3 offen offset:1024 sc1
    s_waitcnt lgkmcnt(0)
    s_barrier
    ds_read_b128 v[40:43], v0 offset:13312
    ds_read_b128 v[48:51], v0 offset:14336
    s_mov_b32 m0, 2048
    s_nop 0
    buffer_load_dwordx4 v0, s[8:11], s26 offen offset:0 sc1 lds
    buffer_load_dwordx4 v0, s[8:11], s26 offen offset:1024 sc1 lds
    v_mov_b64 v[60:61], 0
    v_mov_b64 v[62:63], 0
    v_mov_b64 v[64:65], 0
    v_mov_b64 v[66:67], 0
    v_mov_b64 v[68:69], 0
    v_mov_b64 v[70:71], 0
    v_mov_b64 v[52:53], 0
    v_mov_b64 v[54:55], 0
    s_waitcnt lgkmcnt(1)
    v_smfmac_f32_16x16x64_bf16 v[56:59], v[40:43], v[160:167], v1
    v_smfmac_f32_16x16x64_bf16 v[60:63], v[40:43], v[144:151], v1
    s_waitcnt lgkmcnt(0)
    v_smfmac_f32_16x16x64_bf16 v[56:59], v[48:51], v[152:159], v1
    v_smfmac_f32_16x16x64_bf16 v[60:63], v[48:51], v[136:143], v1
    v_smfmac_f32_16x16x64_bf16 v[64:67], v[40:43], v[128:135], v1
    v_smfmac_f32_16x16x64_bf16 v[68:71], v[40:43], v[112:119], v1
    v_permlane32_swap_b32 v56, v57
    v_smfmac_f32_16x16x64_bf16 v[64:67], v[48:51], v[120:127], v1
    v_permlane32_swap_b32 v58, v59
    v_smfmac_f32_16x16x64_bf16 v[68:71], v[48:51], v[104:111], v1
    v_add_f32 v56, v56, v57
    v_add_f32 v58, v58, v59
    v_smfmac_f32_16x16x64_bf16 v[52:55], v[40:43], v[96:103], v1
    v_permlane32_swap_b32 v60, v61
    v_smfmac_f32_16x16x64_bf16 v[52:55], v[48:51], v[88:95], v1
    v_permlane32_swap_b32 v62, v63
    v_add_f32 v60, v60, v61
    v_add_f32 v62, v62, v63
    v_cvt_pk_bf16_f32 v36, v56, v60
    v_cvt_pk_bf16_f32 v38, v58, v62
    v_permlane32_swap_b32 v64, v65
    v_permlane32_swap_b32 v66, v67
    v_add_f32 v64, v64, v65
    v_add_f32 v66, v66, v67
    v_permlane32_swap_b32 v68, v69
    v_permlane32_swap_b32 v70, v71
    v_add_f32 v68, v68, v69
    v_add_f32 v70, v70, v71
    v_cvt_pk_bf16_f32 v37, v64, v68
    v_cvt_pk_bf16_f32 v39, v66, v70
    buffer_store_dwordx4 v[36:39], v0, s[8:11], s56 offen sc1
    v_permlane32_swap_b32 v52, v53
    v_permlane32_swap_b32 v54, v55
    v_add_f32 v52, v52, v53
    v_add_f32 v54, v54, v55
    v_cvt_pk_bf16_f32 v52, v52, v54
    buffer_store_dword v52, v7, s[8:11], s55 offen sc1
    v_bfe_u32 v34, v0, 4, 1
    v_bfe_u32 v33, v0, 7, 1
    v_lshl_add_u32 v33, v33, 1, v34
    v_bfe_u32 v32, v0, 6, 1
    v_lshlrev_b32 v32, 4, v32
    v_lshlrev_b32_e64 v32, v32, s45
    v_cmp_eq_u32_e64 s[64:65], 0, v33
    v_cmp_eq_u32_e64 vcc, 1, v33
    s_add_u32 s27, s44, 1
    s_and_b32 s27, s27, 3
    v_cndmask_b32_e64 v72, 0, v32, s[64:65]
    v_cndmask_b32_e64 v73, 0, v32, vcc
    v_cmp_eq_u32_e64 s[64:65], 2, v33
    v_cmp_eq_u32_e64 vcc, 3, v33
    s_mul_i32 s48, s27, 5120
    s_add_u32 s48, s48, s41
    v_cndmask_b32_e64 v74, 0, v32, s[64:65]
    v_cndmask_b32_e64 v75, 0, v32, vcc
    s_lshl_b32 s27, s27, 15
    s_add_u32 s49, s27, s47
    v_bfe_u32 v32, v0, 8, 1
    v_lshlrev_b32 v11, 6, v32
    v_lshl_add_u32 v11, v34, 3, v11
    v_lshrrev_b32 v33, 9, v0
    v_lshl_add_u32 v11, v33, 2, v11
    s_add_u32 s56, s27, s46
    s_add_u32 s56, s56, s33
    s_add_u32 s58, s48, s33
    v_mov_b32 v5, v5
    s_nop 1
    v_mov_b32 v5, v5
    s_nop 1
    v_mov_b32 v5, v5
    s_nop 1
    v_mov_b32 v5, v5
    s_nop 1
    v_mov_b32 v5, v5
    s_nop 1
    v_mov_b32 v5, v5
    s_nop 1
    v_mov_b32 v5, v5
    v_mov_b32 v5, v5
    buffer_load_dwordx4 v[40:43], v0, s[8:11], s43 offen sc1
    v_mov_b32 v5, v5
    s_nop 1
    v_mov_b32 v5, v5
    s_nop 1
    v_mov_b32 v5, v5
    s_nop 1
    v_mov_b32 v5, v5
    s_nop 1
    v_mov_b32 v5, v5
    s_nop 1
    v_mov_b32 v5, v5
    s_nop 1
    v_mov_b32 v5, v5
    s_nop 1
    v_mov_b32 v5, v5
    s_nop 1
    v_mov_b32 v5, v5
    s_nop 1
    v_mov_b32 v5, v5
    s_nop 1
    v_mov_b32 v5, v5
    s_nop 1
    v_mov_b32 v5, v5
    s_nop 1
    v_mov_b32 v5, v5
    v_mov_b32 v5, v5
    buffer_load_dwordx4 v[44:47], v0, s[8:11], s43 offen sc1
    v_mov_b32 v5, v5
    s_nop 1
    v_mov_b32 v5, v5
    s_nop 1
    v_mov_b32 v5, v5
    v_mov_b32 v5, v5
    s_waitcnt vmcnt(1)
    v_mfma_f32_16x16x32_bf16 v[76:79], v[72:75], v[40:43], 0
    v_cmp_eq_u32 vcc, -1, v40
    s_cbranch_vccnz M_c1_1_wrb_i0
    v_mov_b32 v5, v5
    v_mov_b32 v5, v5
    v_mov_b32 v5, v5
    v_mov_b32 v5, v5
    v_mov_b32 v5, v5
    v_mov_b32 v5, v5
    v_add_f32_dpp v76, v76, v76 row_ror:8 row_mask:0xf bank_mask:0xf
    v_add_f32_dpp v77, v77, v77 row_ror:8 row_mask:0xf bank_mask:0xf
    s_nop 0
    v_add_f32_dpp v76, v76, v76 row_ror:4 row_mask:0xf bank_mask:0xf
    v_add_f32_dpp v77, v77, v77 row_ror:4 row_mask:0xf bank_mask:0xf
    s_nop 0
    v_add_f32_dpp v76, v76, v76 row_ror:2 row_mask:0xf bank_mask:0xf
    v_add_f32_dpp v77, v77, v77 row_ror:2 row_mask:0xf bank_mask:0xf
    v_cmp_u_f32 vcc, v76, v76
    v_cvt_pk_bf16_f32 v76, v76, v77
    s_cbranch_vccnz M_c1_1_wrb_e0
    s_mov_b64 exec, s[62:63]
    buffer_store_dword v76, v11, s[8:11], s58 offen sc1
M_c1_1_wrb_d:
    s_barrier
    buffer_store_dword v76, v11, s[8:11], s56 offen sc1
    s_mov_b64 exec, -1
    s_waitcnt vmcnt(2)
    ds_read_b128 v[56:59], v5 offset:0
    ds_read_b128 v[60:63], v5 offset:1024
    ds_read_b128 v[64:67], v5 offset:2048
    ds_read_b128 v[68:71], v5 offset:3072
    v_mov_b64 v[12:13], 0
    v_mov_b64 v[14:15], 0
    v_mov_b64 v[16:17], 0
    v_mov_b64 v[18:19], 0
    v_mov_b64 v[20:21], 0
    v_mov_b64 v[22:23], 0
    v_mov_b64 v[24:25], 0
    v_mov_b64 v[26:27], 0
    v_mov_b64 v[28:29], 0
    v_mov_b64 v[30:31], 0
    v_mov_b64 v[32:33], 0
    v_mov_b64 v[34:35], 0
    s_and_b32 s26, s44, 63
    s_add_u32 s26, s26, 2
    s_min_u32 s26, s26, 63
    s_lshl_b32 s26, s26, 18
    s_add_u32 s26, s26, s50
    s_add_u32 s26, s26, 2048
    s_add_u32 s3, s26, 16777216
    v_mov_b64 v[72:73], -1
    v_mov_b64 v[74:75], -1
    s_add_u32 s28, s44, 3
    s_and_b32 s29, s28, 3
    s_mul_i32 s31, s22, 160
    s_mul_i32 s28, s29, 167936
    s_add_u32 s28, s28, s34
    s_add_u32 s64, s28, s35
    s_lshl_b32 s65, s22, 10
    s_add_u32 s65, s65, s28
    s_add_u32 s65, s65, 135168
    ds_read_b64 v[78:79], v0 offset:23296
    s_waitcnt lgkmcnt(0)
    v_min_u32 v78, v78, v79
    s_nop 0
    v_readfirstlane_b32 s28, v78
    s_nop 0
    s_max_u32 s54, s54, s28
    s_add_u32 s27, s44, 3
    s_or_b32 s28, s44, 63
    s_add_u32 s28, s28, 1
    s_min_u32 s27, s27, s28
    s_cmp_lt_u32 s54, s27
    s_cbranch_scc1 M_c1_1_wkw
M_c1_1_wkw_r:
    s_nop 15
    s_nop 15
    s_nop 13
    buffer_store_dwordx4 v[72:75], v0, s[8:11], s64 offen offset:1024 sc1
    buffer_store_dwordx4 v[72:75], v0, s[8:11], s64 offen offset:2048 sc1
    buffer_store_dwordx4 v[72:75], v0, s[8:11], s65 offen sc1
    s_mov_b32 s65, 0x10000000
    s_mov_b32 s64, 0x10000000
    s_add_u32 s44, s44, 1
    s_mov_b32 s70, 0
    s_branch M_c1_1_top
M_c1_1_restart:
    s_waitcnt vmcnt(0) lgkmcnt(0)
    s_nop 7
    s_barrier
    ds_read_b128 v[56:59], v5 offset:0
    ds_read_b128 v[60:63], v5 offset:1024
    ds_read_b128 v[64:67], v5 offset:2048
    ds_read_b128 v[68:71], v5 offset:3072
    v_mov_b64 v[12:13], 0
    v_mov_b64 v[14:15], 0
    v_mov_b64 v[16:17], 0
    v_mov_b64 v[18:19], 0
    v_mov_b64 v[20:21], 0
    v_mov_b64 v[22:23], 0
    v_mov_b64 v[24:25], 0
    v_mov_b64 v[26:27], 0
    v_mov_b64 v[28:29], 0
    v_mov_b64 v[30:31], 0
    v_mov_b64 v[32:33], 0
    v_mov_b64 v[34:35], 0
    s_waitcnt vmcnt(0) lgkmcnt(0)
    s_branch M_c1_1_top
M_c1_1_zbad:
    s_cmp_eq_u32 s70, 2
    s_cbranch_scc1 M_c1_1_zok
    v_cmp_u_f32 vcc, v28, v28
    s_cbranch_vccz M_c1_1_exact
    s_cmp_eq_u32 s70, 1
    s_cbranch_scc1 M_c1_1_exact
M_c1_1_vfy0:
    s_mov_b32 s70, 1
    s_mov_b32 s30, 0
    s_waitcnt vmcnt(0) lgkmcnt(0)
    s_nop 7
M_c1_1_vfy:
    v_mov_b32 v10, 0
    s_add_u32 s59, s48, 4096
    buffer_load_dwordx4 v[36:39], v0, s[8:11], s48 offen offset:0 sc1
    buffer_load_dwordx4 v[40:43], v0, s[8:11], s48 offen offset:1024 sc1
    buffer_load_dwordx4 v[44:47], v0, s[8:11], s48 offen offset:2048 sc1
    buffer_load_dwordx4 v[48:51], v0, s[8:11], s48 offen offset:3072 sc1
    buffer_load_dwordx4 v[52:55], v0, s[8:11], s59 offen offset:0 sc1
    s_waitcnt vmcnt(4)
    v_max3_u32 v10, v10, v36, v37
    v_max3_u32 v10, v10, v38, v39
    s_waitcnt vmcnt(3)
    v_max3_u32 v10, v10, v40, v41
    v_max3_u32 v10, v10, v42, v43
    s_waitcnt vmcnt(2)
    v_max3_u32 v10, v10, v44, v45
    v_max3_u32 v10, v10, v46, v47
    s_waitcnt vmcnt(1)
    v_max3_u32 v10, v10, v48, v49
    v_max3_u32 v10, v10, v50, v51
    s_waitcnt vmcnt(0)
    v_max3_u32 v10, v10, v52, v53
    v_max3_u32 v10, v10, v54, v55
    s_add_u32 s59, s49, 4096
    buffer_load_dwordx4 v[36:39], v0, s[8:11], s49 offen offset:0 sc1
    buffer_load_dwordx4 v[40:43], v0, s[8:11], s49 offen offset:1024 sc1
    buffer_load_dwordx4 v[44:47], v0, s[8:11], s49 offen offset:2048 sc1
    buffer_load_dwordx4 v[48:51], v0, s[8:11], s49 offen offset:3072 sc1
    buffer_load_dwordx4 v[52:55], v0, s[8:11], s59 offen offset:0 sc1
    s_waitcnt vmcnt(4)
    v_max3_u32 v10, v10, v36, v37
    v_max3_u32 v10, v10, v38, v39
    s_waitcnt vmcnt(3)
    v_max3_u32 v10, v10, v40, v41
    v_max3_u32 v10, v10, v42, v43
    s_waitcnt vmcnt(2)
    v_max3_u32 v10, v10, v44, v45
    v_max3_u32 v10, v10, v46, v47
    s_waitcnt vmcnt(1)
    v_max3_u32 v10, v10, v48, v49
    v_max3_u32 v10, v10, v50, v51
    s_waitcnt vmcnt(0)
    v_max3_u32 v10, v10, v52, v53
    v_max3_u32 v10, v10, v54, v55
    v_cmp_eq_u32 vcc, -1, v10
    s_cbranch_vccz M_c1_1_restart
    s_add_u32 s30, s30, 1
    s_cmp_ge_u32 s30, 60000
    s_cbranch_scc1 M_fail
    s_branch M_c1_1_vfy
M_c1_1_exact:
    s_nop 7
    s_mov_b32 s70, 2
    s_waitcnt lgkmcnt(0)
    ds_read_b128 v[20:23], v3 offset:18432
    ds_read_b128 v[24:27], v3 offset:18496
    ds_read_b128 v[28:31], v3 offset:18560
    ds_read_b128 v[32:35], v3 offset:18624
    ds_read_b128 v[56:59], v0 offset:0
    s_waitcnt lgkmcnt(0)
    v_mfma_f32_16x16x32_bf16 v[36:39], v[56:59], v[20:23], 0
    s_nop 3
    ds_read_b128 v[60:63], v0 offset:1024
    s_waitcnt lgkmcnt(0)
    v_mfma_f32_16x16x32_bf16 v[36:39], v[60:63], v[24:27], v[36:39]
    s_nop 3
    ds_read_b128 v[56:59], v0 offset:2048
    s_waitcnt lgkmcnt(0)
    v_mfma_f32_16x16x32_bf16 v[36:39], v[56:59], v[28:31], v[36:39]
    s_nop 3
    ds_read_b128 v[60:63], v0 offset:3072
    s_waitcnt lgkmcnt(0)
    v_mfma_f32_16x16x32_bf16 v[36:39], v[60:63], v[32:35], v[36:39]
    s_nop 3
    ds_read_b128 v[56:59], v0 offset:4096
    s_waitcnt lgkmcnt(0)
    v_mfma_f32_16x16x32_bf16 v[40:43], v[56:59], v[20:23], 0
    s_nop 3
    ds_read_b128 v[60:63], v0 offset:5120
    s_waitcnt lgkmcnt(0)
    v_mfma_f32_16x16x32_bf16 v[40:43], v[60:63], v[24:27], v[40:43]
    s_nop 3
    ds_read_b128 v[56:59], v0 offset:6144
    s_waitcnt lgkmcnt(0)
    v_mfma_f32_16x16x32_bf16 v[40:43], v[56:59], v[28:31], v[40:43]
    s_nop 3
    ds_read_b128 v[60:63], v0 offset:7168
    s_waitcnt lgkmcnt(0)
    v_mfma_f32_16x16x32_bf16 v[40:43], v[60:63], v[32:35], v[40:43]
    s_nop 3
    ds_read_b128 v[56:59], v3 offset:20736
    s_waitcnt lgkmcnt(0)
    v_mfma_f32_16x16x32_bf16 v[48:51], v[56:59], v[20:23], 0
    s_nop 3
    ds_read_b128 v[60:63], v3 offset:20800
    s_waitcnt lgkmcnt(0)
    v_mfma_f32_16x16x32_bf16 v[48:51], v[60:63], v[24:27], v[48:51]
    s_nop 3
    ds_read_b128 v[56:59], v3 offset:20864
    s_waitcnt lgkmcnt(0)
    v_mfma_f32_16x16x32_bf16 v[48:51], v[56:59], v[28:31], v[48:51]
    s_nop 3
    ds_read_b128 v[60:63], v3 offset:20928
    s_waitcnt lgkmcnt(0)
    v_mfma_f32_16x16x32_bf16 v[48:51], v[60:63], v[32:35], v[48:51]
    s_nop 3
    v_max3_f32 v64, v36, v37, v38
    v_max3_f32 v64, v64, v39, v40
    v_max3_f32 v64, v64, v41, v42
    s_nop 0
    v_max3_f32 v64, v64, v43, v48
    v_max3_f32 v64, v64, v49, v50
    v_max_f32 v64, v64, v51
    v_mov_b32 v65, v64
    s_nop 1
    v_permlane16_swap_b32 v64, v65
    v_max_f32 v64, v64, v65
    v_mov_b32 v65, v64
    s_nop 1
    v_permlane32_swap_b32 v64, v65
    v_max_f32 v64, v64, v65
    v_sub_f32 v36, v36, v64
    v_exp_f32 v36, v36
    v_sub_f32 v37, v37, v64
    v_exp_f32 v37, v37
    v_sub_f32 v38, v38, v64
    v_exp_f32 v38, v38
    v_sub_f32 v39, v39, v64
    v_exp_f32 v39, v39
    v_sub_f32 v40, v40, v64
    v_exp_f32 v40, v40
    v_sub_f32 v41, v41, v64
    v_exp_f32 v41, v41
    v_sub_f32 v42, v42, v64
    v_exp_f32 v42, v42
    v_sub_f32 v43, v43, v64
    v_exp_f32 v43, v43
    v_sub_f32 v48, v48, v64
    v_exp_f32 v48, v48
    v_sub_f32 v49, v49, v64
    v_exp_f32 v49, v49
    v_sub_f32 v50, v50, v64
    v_exp_f32 v50, v50
    v_sub_f32 v51, v51, v64
    v_exp_f32 v51, v51
    v_cvt_pk_bf16_f32 v36, v36, v37
    v_cvt_pk_bf16_f32 v37, v38, v39
    v_cvt_pk_bf16_f32 v38, v40, v41
    v_cvt_pk_bf16_f32 v39, v42, v43
    v_cvt_pk_bf16_f32 v48, v48, v49
    v_cvt_pk_bf16_f32 v49, v50, v51
    v_mfma_f32_16x16x32_bf16 v[20:23], v[80:83], v[36:39], 0
    v_mfma_f32_16x16x32_bf16 v[24:27], v[84:87], v[36:39], 0
    v_mfma_f32_16x16x32_bf16 v[28:31], v[72:75], v[36:39], 0
    ds_read_b128 v[60:63], v3 offset:20800
    s_waitcnt lgkmcnt(0)
    s_nop 7
    s_branch M_c1_1_fin
M_c1_1_last:
    s_cmp_lg_u32 s70, 0
    s_cbranch_scc1 M_c1_1_last2
    v_cmp_u_f32 vcc, v40, v40
    s_cbranch_vccnz M_c1_1_vfy0
M_c1_1_last2:
    s_waitcnt vmcnt(0) lgkmcnt(0)
    s_barrier
    s_barrier
    v_mov_b32 v11, 8192
    s_mov_b64 exec, 1
    buffer_store_dword v11, v0, s[8:11], s52 offen sc1
    s_mov_b64 exec, -1
    s_add_u32 s52, s52, 4096
    s_nop 7
    v_mov_b64 v[72:73], -1
    v_mov_b64 v[74:75], -1
    s_add_u32 s28, s44, 3
    s_and_b32 s29, s28, 3
    s_mul_i32 s31, s22, 160
    s_mul_i32 s28, s29, 167936
    s_add_u32 s28, s28, s34
    s_add_u32 s64, s28, s35
    s_lshl_b32 s65, s22, 10
    s_add_u32 s65, s65, s28
    s_add_u32 s65, s65, 135168
    buffer_store_dwordx4 v[72:75], v0, s[8:11], s64 offen offset:1024 sc1
    buffer_store_dwordx4 v[72:75], v0, s[8:11], s64 offen offset:2048 sc1
    buffer_store_dwordx4 v[72:75], v0, s[8:11], s65 offen sc1
    s_mov_b32 s65, 0x10000000
    s_mov_b32 s64, 0x10000000
    s_waitcnt vmcnt(0)
    s_add_u32 s44, s44, 1
    s_cmp_eq_u32 s44, 128
    s_cbranch_scc1 M_end
    s_branch M_c1_1_layer
M_c1_1_p1:
    s_mov_b32 s30, 0
M_c1_1_p1_l:
    s_waitcnt lgkmcnt(0)
    s_mov_b64 exec, 3
    buffer_load_dword v11, v9, s[8:11], s51 offen sc1
    s_waitcnt vmcnt(0)
    s_mov_b64 exec, -1
    v_readlane_b32 s54, v11, 0
    v_readlane_b32 s28, v11, 1
    s_nop 3
    s_min_u32 s54, s54, s28
    s_cmp_ge_u32 s54, s27
    s_cbranch_scc1 M_c1_1_p1_r
    s_sleep 1
    s_add_u32 s30, s30, 1
    s_cmp_ge_u32 s30, 60000
    s_cbranch_scc1 M_fail
    s_branch M_c1_1_p1_l
M_c1_1_p2:
    s_mov_b32 s30, 0
M_c1_1_p2_l:
    s_waitcnt lgkmcnt(0)
    s_mov_b64 exec, 3
    buffer_load_dword v11, v9, s[8:11], s51 offen sc1
    s_waitcnt vmcnt(0)
    s_mov_b64 exec, -1
    v_readlane_b32 s54, v11, 0
    v_readlane_b32 s28, v11, 1
    s_nop 3
    s_min_u32 s54, s54, s28
    s_cmp_ge_u32 s54, s27
    s_cbranch_scc1 M_c1_1_p2_r
    s_sleep 1
    s_add_u32 s30, s30, 1
    s_cmp_ge_u32 s30, 60000
    s_cbranch_scc1 M_fail
    s_branch M_c1_1_p2_l
M_c1_1_lr:
    s_mov_b32 s30, 0
M_c1_1_lr_l:
    s_waitcnt lgkmcnt(0)
    ds_read_b128 v[36:39], v6 offset:13312
    ds_read_b128 v[40:43], v6 offset:14336
    ds_read_b128 v[44:47], v6 offset:15360
    ds_read_b128 v[48:51], v6 offset:16384
    ds_read_b128 v[52:55], v6 offset:17408
    s_waitcnt lgkmcnt(2)
    v_max3_u32 v10, v36, v40, v44
    s_waitcnt lgkmcnt(0)
    v_max3_u32 v10, v10, v48, v52
    v_cmp_eq_u32 vcc, -1, v10
    s_cbranch_vccz M_c1_1_lr_d
    s_add_u32 s30, s30, 1
    s_cmp_ge_u32 s30, 480000
    s_cbranch_scc1 M_fail
    s_branch M_c1_1_lr_l
M_c1_1_lr_d:
    ds_read_b128 v[56:59], v5 offset:0
    ds_read_b128 v[60:63], v5 offset:1024
    ds_read_b128 v[64:67], v5 offset:2048
    ds_read_b128 v[68:71], v5 offset:3072
    v_mov_b64 v[12:13], 0
    v_mov_b64 v[14:15], 0
    v_mov_b64 v[16:17], 0
    v_mov_b64 v[18:19], 0
    v_mov_b64 v[20:21], 0
    v_mov_b64 v[22:23], 0
    v_mov_b64 v[24:25], 0
    v_mov_b64 v[26:27], 0
    v_mov_b64 v[28:29], 0
    v_mov_b64 v[30:31], 0
    v_mov_b64 v[32:33], 0
    v_mov_b64 v[34:35], 0
    s_waitcnt lgkmcnt(0)
    s_branch M_c1_1_lr_r
M_c1_1_rr:
    s_mov_b32 s30, 0
M_c1_1_rr_l:
    s_waitcnt lgkmcnt(0)
    s_and_b32 s27, s30, 1
    s_cbranch_scc1 M_c1_1_rr_n
    s_waitcnt vmcnt(1)
    s_mov_b32 m0, 8192
    s_nop 0
    buffer_load_dwordx4 v0, s[8:11], s49 offen offset:2048 sc1 lds
M_c1_1_rr_n:
    ds_read_b128 v[36:39], v6 offset:8192
    ds_read_b128 v[40:43], v6 offset:9216
    ds_read_b128 v[44:47], v6 offset:10240
    ds_read_b128 v[48:51], v6 offset:11264
    ds_read_b32 v11, v6 offset:12288
    s_waitcnt lgkmcnt(2)
    v_max3_u32 v10, v36, v40, v44
    s_waitcnt lgkmcnt(0)
    v_max3_u32 v10, v10, v48, v11
    v_cmp_eq_u32 vcc, -1, v10
    s_cbranch_vccz M_c1_1_rr_d
    s_add_u32 s30, s30, 1
    s_cmp_ge_u32 s30, 480000
    s_cbranch_scc1 M_fail
    s_branch M_c1_1_rr_l
M_c1_1_rr_d:
    s_branch M_c1_1_rr_r
M_c1_1_wrb_l:
    s_waitcnt vmcnt(1)
    v_mfma_f32_16x16x32_bf16 v[76:79], v[72:75], v[40:43], 0
    v_cmp_eq_u32 vcc, -1, v40
    s_cbranch_vccz M_c1_1_wrb_x0
M_c1_1_wrb_i0:
    buffer_load_dwordx4 v[40:43], v0, s[8:11], s43 offen sc1
    s_waitcnt vmcnt(1)
    v_mfma_f32_16x16x32_bf16 v[76:79], v[72:75], v[44:47], 0
    v_cmp_eq_u32 vcc, -1, v44
    s_cbranch_vccz M_c1_1_wrb_x1
M_c1_1_wrb_i1:
    buffer_load_dwordx4 v[44:47], v0, s[8:11], s43 offen sc1
    s_add_u32 s71, s71, 1
    s_cmp_lt_u32 s71, 240000
    s_cbranch_scc1 M_c1_1_wrb_l
    s_branch M_fail
M_c1_1_wrb_x0:
    s_nop 5
    v_add_f32_dpp v76, v76, v76 row_ror:8 row_mask:0xf bank_mask:0xf
    v_add_f32_dpp v77, v77, v77 row_ror:8 row_mask:0xf bank_mask:0xf
    s_nop 0
    v_add_f32_dpp v76, v76, v76 row_ror:4 row_mask:0xf bank_mask:0xf
    v_add_f32_dpp v77, v77, v77 row_ror:4 row_mask:0xf bank_mask:0xf
    s_nop 0
    v_add_f32_dpp v76, v76, v76 row_ror:2 row_mask:0xf bank_mask:0xf
    v_add_f32_dpp v77, v77, v77 row_ror:2 row_mask:0xf bank_mask:0xf
    v_cmp_u_f32 vcc, v76, v76
    v_cvt_pk_bf16_f32 v76, v76, v77
    s_cbranch_vccz M_c1_1_wrb_n
M_c1_1_wrb_e0:
    v_max3_u32 v32, v40, v41, v42
    v_max_u32 v32, v32, v43
    v_cmp_eq_u32 vcc, -1, v32
    s_cbranch_vccnz M_c1_1_wrb_i0
    v_min_u32 v76, -2, v76
    v_min_u32 v77, -2, v77
    s_branch M_c1_1_wrb_n
M_c1_1_wrb_x1:
    s_nop 5
    v_add_f32_dpp v76, v76, v76 row_ror:8 row_mask:0xf bank_mask:0xf
    v_add_f32_dpp v77, v77, v77 row_ror:8 row_mask:0xf bank_mask:0xf
    s_nop 0
    v_add_f32_dpp v76, v76, v76 row_ror:4 row_mask:0xf bank_mask:0xf
    v_add_f32_dpp v77, v77, v77 row_ror:4 row_mask:0xf bank_mask:0xf
    s_nop 0
    v_add_f32_dpp v76, v76, v76 row_ror:2 row_mask:0xf bank_mask:0xf
    v_add_f32_dpp v77, v77, v77 row_ror:2 row_mask:0xf bank_mask:0xf
    v_cmp_u_f32 vcc, v76, v76
    v_cvt_pk_bf16_f32 v76, v76, v77
    s_cbranch_vccz M_c1_1_wrb_n
M_c1_1_wrb_e1:
    v_max3_u32 v32, v44, v45, v46
    v_max_u32 v32, v32, v47
    v_cmp_eq_u32 vcc, -1, v32
    s_cbranch_vccnz M_c1_1_wrb_i1
    v_min_u32 v76, -2, v76
    v_min_u32 v77, -2, v77
M_c1_1_wrb_n:
    s_mov_b64 exec, s[62:63]
    buffer_store_dword v76, v11, s[8:11], s58 offen sc1
    s_branch M_c1_1_wrb_d
M_c1_1_wkw:
    s_mov_b32 s30, 0
M_c1_1_wkw_l:
    s_waitcnt lgkmcnt(0)
    s_mov_b64 exec, 3
    buffer_load_dword v11, v9, s[8:11], s51 offen sc1
    s_waitcnt vmcnt(0)
    s_mov_b64 exec, -1
    v_readlane_b32 s54, v11, 0
    v_readlane_b32 s28, v11, 1
    s_nop 3
    s_min_u32 s54, s54, s28
    s_cmp_ge_u32 s54, s27
    s_cbranch_scc1 M_c1_1_wkw_r
    s_sleep 1
    s_add_u32 s30, s30, 1
    s_cmp_ge_u32 s30, 60000
    s_cbranch_scc1 M_fail
    s_branch M_c1_1_wkw_l
M_c1_2_layer:
    s_lshr_b32 s27, s44, 6
    s_mul_i32 s50, s27, 33554432
    s_lshl_b32 s27, s22, 13
    s_add_u32 s50, s50, s27
    s_add_u32 s50, s50, 37748736
    s_barrier
    s_and_b32 s26, s44, 63
    s_lshl_b32 s26, s26, 18
    s_add_u32 s26, s26, s50
    s_add_u32 s26, s26, 4096
    s_add_u32 s3, s26, 16777216
    s_mov_b32 m0, 4096
    s_nop 0
    buffer_load_dwordx4 v0, s[8:11], s26 offen offset:0 sc1 lds
    buffer_load_dwordx4 v0, s[8:11], s26 offen offset:1024 sc1 lds
    buffer_load_dwordx4 v[80:83], v0, s[8:11], s3 offen offset:0 sc1
    buffer_load_dwordx4 v[84:87], v0, s[8:11], s3 offen offset:1024 sc1
    s_and_b32 s26, s44, 63
    s_add_u32 s26, s26, 1
    s_min_u32 s26, s26, 63
    s_lshl_b32 s26, s26, 18
    s_add_u32 s26, s26, s50
    s_add_u32 s26, s26, 4096
    s_add_u32 s3, s26, 16777216
    s_mul_i32 s27, s20, 5120
    s_add_u32 s48, s27, 167772160
    s_sub_u32 s49, 167777280, s27
    s_mov_b32 m0, 13312
    s_nop 0
    buffer_load_dwordx4 v0, s[8:11], s48 offen offset:0 sc1 lds
    buffer_load_dwordx4 v0, s[8:11], s48 offen offset:1024 sc1 lds
    buffer_load_dwordx4 v0, s[8:11], s48 offen offset:2048 sc1 lds
    ds_read_b128 v[56:59], v5 offset:0
    ds_read_b128 v[60:63], v5 offset:1024
    ds_read_b128 v[64:67], v5 offset:2048
    ds_read_b128 v[68:71], v5 offset:3072
    v_mov_b64 v[12:13], 0
    v_mov_b64 v[14:15], 0
    v_mov_b64 v[16:17], 0
    v_mov_b64 v[18:19], 0
    v_mov_b64 v[20:21], 0
    v_mov_b64 v[22:23], 0
    v_mov_b64 v[24:25], 0
    v_mov_b64 v[26:27], 0
    v_mov_b64 v[28:29], 0
    v_mov_b64 v[30:31], 0
    v_mov_b64 v[32:33], 0
    v_mov_b64 v[34:35], 0
    s_mov_b32 s70, 0
    s_waitcnt vmcnt(0) lgkmcnt(0)
M_c1_2_top:
    s_waitcnt vmcnt(6)
    s_barrier
    ds_read_b128 v[36:39], v6 offset:13312
    ds_read_b128 v[40:43], v6 offset:14336
    ds_read_b128 v[44:47], v6 offset:15360
    ds_read_b128 v[48:51], v6 offset:16384
    ds_read_b128 v[52:55], v6 offset:17408
    s_mov_b32 m0, 8192
    s_nop 0
    buffer_load_dwordx4 v0, s[8:11], s49 offen offset:3072 sc1 lds
M_c1_2_lr_r:
    s_waitcnt lgkmcnt(4)
    v_smfmac_f32_16x16x64_bf16 v[20:23], v[36:39], v[56:63], v1
    ds_read_b128 v[56:59], v5 offset:4096
    s_and_b32 s55, s44, 3
    s_mul_i32 s55, s55, 167936
    v_smfmac_f32_16x16x64_bf16 v[24:27], v[36:39], v[64:71], v1
    ds_read_b128 v[64:67], v5 offset:6144
    s_add_u32 s55, s55, s34
    s_add_u32 s56, s55, s35
    v_smfmac_f32_16x16x64_bf16 v[28:31], v[36:39], a[248:255], v1
    ds_read_b128 v[68:71], v5 offset:7168
    s_and_b32 s57, s44, 63
    v_smfmac_f32_16x16x64_bf16 v[32:35], v[36:39], a[240:247], v1
    ds_read_b128 v[60:63], v5 offset:5120
    s_waitcnt lgkmcnt(7)
    v_smfmac_f32_16x16x64_bf16 v[20:23], v[40:43], a[232:239], v1
    s_waitcnt lgkmcnt(0)
    v_smfmac_f32_16x16x64_bf16 v[24:27], v[40:43], v[56:63], v1
    ds_read_b128 v[56:59], v5 offset:8192
    v_smfmac_f32_16x16x64_bf16 v[28:31], v[40:43], a[224:231], v1
    ds_read_b128 v[60:63], v5 offset:9216
    v_smfmac_f32_16x16x64_bf16 v[32:35], v[40:43], a[216:223], v1
    v_smfmac_f32_16x16x64_bf16 v[20:23], v[44:47], v[64:71], v1
    ds_read_b128 v[64:67], v5 offset:10240
    v_max3_u32 v10, v36, v40, v44
    v_smfmac_f32_16x16x64_bf16 v[24:27], v[44:47], a[208:215], v1
    ds_read_b128 v[68:71], v5 offset:11264
    v_max3_u32 v10, v10, v48, v52
    v_smfmac_f32_16x16x64_bf16 v[28:31], v[44:47], a[200:207], v1
    s_waitcnt lgkmcnt(2)
    v_cmp_eq_u32 vcc, -1, v10
    v_smfmac_f32_16x16x64_bf16 v[32:35], v[44:47], v[56:63], v1
    ds_read_b128 v[56:59], v5 offset:12288
    s_cbranch_vccnz M_c1_2_lr
    v_smfmac_f32_16x16x64_bf16 v[20:23], v[48:51], a[192:199], v1
    ds_read_b128 v[60:63], v5 offset:13312
    v_smfmac_f32_16x16x64_bf16 v[24:27], v[48:51], a[184:191], v1
    s_waitcnt lgkmcnt(2)
    v_smfmac_f32_16x16x64_bf16 v[28:31], v[48:51], v[64:71], v1
    ds_read_b128 v[64:67], v5 offset:14336
    v_smfmac_f32_16x16x64_bf16 v[32:35], v[48:51], a[176:183], v1
    ds_read_b128 v[68:71], v5 offset:15360
    s_waitcnt vmcnt(0)
    s_barrier
    ds_read_b128 v[36:39], v6 offset:8192
    ds_read_b128 v[40:43], v6 offset:9216
    ds_read_b128 v[44:47], v6 offset:10240
    ds_read_b128 v[48:51], v6 offset:11264
    ds_read_b32 v11, v6 offset:12288
    v_smfmac_f32_16x16x64_bf16 v[20:23], v[52:55], a[168:175], v1
    s_waitcnt lgkmcnt(7)
    v_smfmac_f32_16x16x64_bf16 v[24:27], v[52:55], v[56:63], v1
    ds_read_b128 v[56:59], v5 offset:16384
    v_smfmac_f32_16x16x64_bf16 v[28:31], v[52:55], a[160:167], v1
    ds_read_b128 v[60:63], v5 offset:17408
    s_waitcnt lgkmcnt(4)
    v_max3_u32 v10, v36, v40, v44
    v_smfmac_f32_16x16x64_bf16 v[32:35], v[52:55], a[152:159], v1
    s_waitcnt lgkmcnt(2)
    v_max3_u32 v10, v10, v48, v11
    v_cmp_eq_u32 vcc, -1, v10
    s_cbranch_vccnz M_c1_2_rr
M_c1_2_rr_r:
    ds_read_b128 v[52:55], v6 offset:12288
    buffer_store_dwordx4 v[72:75], v0, s[8:11], s4 offen offset:0 sc1
    buffer_store_dwordx4 v[76:79], v0, s[8:11], s4 offen offset:1024 sc1
    s_mov_b32 s4, 0x10000000
    v_smfmac_f32_16x16x64_bf16 v[20:23], v[36:39], v[64:71], v1
    ds_read_b128 v[64:67], v5 offset:18432
    v_smfmac_f32_16x16x64_bf16 v[24:27], v[36:39], a[144:151], v1
    ds_read_b128 v[68:71], v5 offset:19456
    v_smfmac_f32_16x16x64_bf16 v[20:23], v[40:43], a[136:143], v1
    s_waitcnt lgkmcnt(3)
    v_smfmac_f32_16x16x64_bf16 v[24:27], v[40:43], v[56:63], v1
    ds_read_b128 v[56:59], v5 offset:20480
    v_smfmac_f32_16x16x64_bf16 v[20:23], v[44:47], a[128:135], v1
    ds_read_b128 v[60:63], v5 offset:21504
    v_smfmac_f32_16x16x64_bf16 v[24:27], v[44:47], a[120:127], v1
    s_waitcnt lgkmcnt(2)
    v_smfmac_f32_16x16x64_bf16 v[20:23], v[48:51], v[64:71], v1
    ds_read_b128 v[64:67], v5 offset:22528
    v_smfmac_f32_16x16x64_bf16 v[24:27], v[48:51], a[112:119], v1
    ds_read_b128 v[68:71], v5 offset:23552
    v_smfmac_f32_16x16x64_bf16 v[20:23], v[52:55], a[104:111], v1
    s_waitcnt lgkmcnt(2)
    v_smfmac_f32_16x16x64_bf16 v[24:27], v[52:55], v[56:63], v1
    ds_read_b128 v[56:59], v5 offset:24576
    v_smfmac_f32_16x16x64_bf16 v[28:31], v[36:39], a[96:103], v1
    ds_read_b128 v[60:63], v5 offset:25600
    v_smfmac_f32_16x16x64_bf16 v[32:35], v[36:39], a[88:95], v1
    s_waitcnt lgkmcnt(2)
    v_mov_b32 v5, v5
    v_mov_b32 v5, v5
    v_permlane32_swap_b32 v20, v21
    v_smfmac_f32_16x16x64_bf16 v[28:31], v[40:43], v[64:71], v1
    ds_read_b128 v[64:67], v5 offset:26624
    v_permlane32_swap_b32 v22, v23
    v_smfmac_f32_16x16x64_bf16 v[32:35], v[40:43], a[80:87], v1
    ds_read_b128 v[68:71], v5 offset:27648
    v_permlane32_swap_b32 v24, v25
    v_smfmac_f32_16x16x64_bf16 v[28:31], v[44:47], a[72:79], v1
    s_waitcnt lgkmcnt(2)
    v_permlane32_swap_b32 v26, v27
    v_smfmac_f32_16x16x64_bf16 v[32:35], v[44:47], v[56:63], v1
    ds_read_b128 v[56:59], v5 offset:28672
    v_add_f32 v20, v20, v21
    v_add_f32 v22, v22, v23
    v_smfmac_f32_16x16x64_bf16 v[28:31], v[48:51], a[64:71], v1
    ds_read_b128 v[60:63], v5 offset:29696
    v_add_f32 v24, v24, v25
    v_add_f32 v26, v26, v27
    v_smfmac_f32_16x16x64_bf16 v[32:35], v[48:51], a[56:63], v1
    s_waitcnt lgkmcnt(2)
    v_mul_f32 v20, s40, v20
    v_mul_f32 v24, s40, v24
    v_smfmac_f32_16x16x64_bf16 v[28:31], v[52:55], v[64:71], v1
    ds_read_b128 v[64:67], v5 offset:30720
    v_mul_f32 v22, s40, v22
    v_mul_f32 v26, s40, v26
    v_smfmac_f32_16x16x64_bf16 v[32:35], v[52:55], a[48:55], v1
    ds_read_b128 v[68:71], v5 offset:31744
    v_cvt_pk_bf16_f32 v20, v20, v24
    v_cvt_pk_bf16_f32 v21, v22, v26
    v_smfmac_f32_16x16x64_bf16 v[12:15], v[36:39], a[40:47], v1
    ds_write_b32 v2, v20 offset:18432
    ds_write_b32 v2, v21 offset:19008
    s_waitcnt lgkmcnt(4)
    v_smfmac_f32_16x16x64_bf16 v[16:19], v[36:39], v[56:63], v1
    ds_read_b128 v[56:59], v5 offset:32768
    v_permlane32_swap_b32 v28, v29
    v_smfmac_f32_16x16x64_bf16 v[12:15], v[40:43], a[32:39], v1
    ds_read_b128 v[60:63], v5 offset:33792
    v_permlane32_swap_b32 v30, v31
    v_smfmac_f32_16x16x64_bf16 v[16:19], v[40:43], a[24:31], v1
    ds_read_b128 v[36:39], v6 offset:13312
    s_waitcnt lgkmcnt(5)
    v_permlane32_swap_b32 v32, v33
    v_smfmac_f32_16x16x64_bf16 v[12:15], v[44:47], v[64:71], v1
    ds_read_b128 v[40:43], v6 offset:14336
    v_permlane32_swap_b32 v34, v35
    v_smfmac_f32_16x16x64_bf16 v[16:19], v[44:47], a[16:23], v1
    ds_read_b128 v[44:47], v6 offset:15360
    v_add_f32 v28, v28, v29
    v_add_f32 v30, v30, v31
    v_smfmac_f32_16x16x64_bf16 v[12:15], v[48:51], a[8:15], v1
    ds_read_b128 v[64:67], v0 offset:2048
    s_waitcnt lgkmcnt(4)
    v_add_f32 v32, v32, v33
    v_add_f32 v34, v34, v35
    v_smfmac_f32_16x16x64_bf16 v[16:19], v[48:51], v[56:63], v1
    ds_read_b128 v[68:71], v0 offset:3072
    v_cvt_pk_bf16_f32 v28, v28, v32
    v_cvt_pk_bf16_f32 v29, v30, v34
    v_smfmac_f32_16x16x64_bf16 v[12:15], v[52:55], a[0:7], v1
    ds_write_b32 v2, v28 offset:20736
    ds_write_b32 v2, v29 offset:21312
    v_smfmac_f32_16x16x64_bf16 v[16:19], v[52:55], v[248:255], v1
    ds_read_b128 v[48:51], v6 offset:16384
    s_waitcnt lgkmcnt(7)
    v_smfmac_f32_16x16x64_bf16 v[12:15], v[36:39], v[240:247], v1
    ds_read_b128 v[56:59], v0 offset:0
    v_smfmac_f32_16x16x64_bf16 v[16:19], v[36:39], v[232:239], v1
    s_waitcnt vmcnt(2) lgkmcnt(2)
    s_barrier
    ds_read_b128 v[20:23], v3 offset:18432
    ds_read_b128 v[24:27], v3 offset:18496
    v_smfmac_f32_16x16x64_bf16 v[12:15], v[40:43], v[224:231], v1
    ds_read_b128 v[28:31], v3 offset:18560
    v_smfmac_f32_16x16x64_bf16 v[16:19], v[40:43], v[216:223], v1
    ds_read_b128 v[32:35], v3 offset:18624
    v_smfmac_f32_16x16x64_bf16 v[12:15], v[44:47], v[208:215], v1
    ds_read_b128 v[60:63], v0 offset:1024
    v_smfmac_f32_16x16x64_bf16 v[16:19], v[44:47], v[200:207], v1
    ds_read_b128 v[52:55], v6 offset:17408
    s_waitcnt lgkmcnt(5)
    v_mfma_f32_16x16x32_bf16 v[36:39], v[56:59], v[20:23], 0
    ds_read_b128 v[56:59], v0 offset:4096
    s_waitcnt lgkmcnt(2)
    v_mfma_f32_16x16x32_bf16 v[36:39], v[60:63], v[24:27], v[36:39]
    ds_read_b128 v[60:63], v0 offset:5120
    v_mfma_f32_16x16x32_bf16 v[36:39], v[64:67], v[28:31], v[36:39]
    ds_read_b128 v[64:67], v0 offset:6144
    v_mfma_f32_16x16x32_bf16 v[36:39], v[68:71], v[32:35], v[36:39]
    ds_read_b128 v[68:71], v0 offset:7168
    v_mov_b64 v[72:73], s[24:25]
    v_smfmac_f32_16x16x64_bf16 v[12:15], v[48:51], v[192:199], v1
    v_mov_b64 v[74:75], s[24:25]
    v_smfmac_f32_16x16x64_bf16 v[16:19], v[48:51], v[184:191], v1
    s_waitcnt lgkmcnt(3)
    v_mov_b64 v[10:11], s[16:17]
    v_mfma_f32_16x16x32_bf16 v[40:43], v[56:59], v[20:23], 0
    ds_read_b128 v[56:59], v3 offset:20736
    s_waitcnt lgkmcnt(3)
    v_exp_f32 v36, v36
    v_mfma_f32_16x16x32_bf16 v[40:43], v[60:63], v[24:27], v[40:43]
    ds_read_b128 v[60:63], v3 offset:20800
    s_waitcnt lgkmcnt(3)
    v_exp_f32 v37, v37
    v_mfma_f32_16x16x32_bf16 v[40:43], v[64:67], v[28:31], v[40:43]
    ds_read_b128 v[64:67], v3 offset:20864
    s_waitcnt lgkmcnt(3)
    v_exp_f32 v38, v38
    v_mfma_f32_16x16x32_bf16 v[40:43], v[68:71], v[32:35], v[40:43]
    ds_read_b128 v[68:71], v3 offset:20928
    v_exp_f32 v39, v39
    v_smfmac_f32_16x16x64_bf16 v[12:15], v[52:55], v[176:183], v1
    v_cvt_pk_bf16_f32 v36, v36, v37
    v_smfmac_f32_16x16x64_bf16 v[16:19], v[52:55], v[168:175], v1
    s_waitcnt lgkmcnt(3)
    v_cvt_pk_bf16_f32 v37, v38, v39
    v_mfma_f32_16x16x32_bf16 v[48:51], v[56:59], v[20:23], 0
    s_waitcnt lgkmcnt(2)
    v_exp_f32 v40, v40
    v_mfma_f32_16x16x32_bf16 v[48:51], v[60:63], v[24:27], v[48:51]
    s_waitcnt lgkmcnt(1)
    v_exp_f32 v41, v41
    v_mfma_f32_16x16x32_bf16 v[48:51], v[64:67], v[28:31], v[48:51]
    s_waitcnt lgkmcnt(0)
    v_exp_f32 v42, v42
    v_mfma_f32_16x16x32_bf16 v[48:51], v[68:71], v[32:35], v[48:51]
    v_exp_f32 v43, v43
    v_cvt_pk_bf16_f32 v38, v40, v41
    v_cvt_pk_bf16_f32 v39, v42, v43
    v_cvt_pk_bf16_f32 v12, v12, v13
    v_cvt_pk_bf16_f32 v13, v14, v15
    v_mfma_f32_16x16x32_bf16 v[28:31], v[72:75], v[36:39], 0
    v_cvt_pk_bf16_f32 v14, v16, v17
    s_nop 0
    v_exp_f32 v48, v48
    v_mfma_f32_16x16x32_bf16 v[20:23], v[80:83], v[36:39], 0
    v_exp_f32 v49, v49
    v_exp_f32 v50, v50
    v_mfma_f32_16x16x32_bf16 v[24:27], v[84:87], v[36:39], 0
    v_exp_f32 v51, v51
    v_cvt_pk_bf16_f32 v48, v48, v49
    v_cvt_pk_bf16_f32 v49, v50, v51
    v_cvt_pk_bf16_f32 v15, v18, v19
M_c1_2_fin:
    s_nop 0
    v_mfma_f32_16x16x16_bf16 v[28:31], v[10:11], v[48:49], v[28:31]
    s_cmp_eq_u32 s57, 63
    v_mfma_f32_16x16x16_bf16 v[20:23], v[12:13], v[48:49], v[20:23]
    ds_write_b128 v0, v[12:15] offset:10240
    v_mfma_f32_16x16x16_bf16 v[24:27], v[14:15], v[48:49], v[24:27]
    s_cbranch_scc1 M_c1_2_last
    v_mov_b64 v[56:57], 0
    v_mov_b64 v[58:59], 0
    s_nop 0
    v_rcp_f32 v30, v28
    v_subrev_u32 v29, s68, v28
    v_pk_mul_f32 v[20:21], v[20:21], v[30:31] op_sel_hi:[1,0]
    v_pk_mul_f32 v[22:23], v[22:23], v[30:31] op_sel_hi:[1,0]
    v_cvt_pk_bf16_f32 v20, v20, v21
    v_cvt_pk_bf16_f32 v21, v22, v23
    v_pk_mul_f32 v[24:25], v[24:25], v[30:31] op_sel_hi:[1,0]
    v_pk_mul_f32 v[26:27], v[26:27], v[30:31] op_sel_hi:[1,0]
    v_cvt_pk_bf16_f32 v22, v24, v25
    v_cvt_pk_bf16_f32 v23, v26, v27
    ds_write2_b64 v4, v[20:21], v[22:23] offset0:0 offset1:16
    v_cmp_lt_u32 vcc, s69, v29
    s_cbranch_vccnz M_c1_2_zbad
M_c1_2_zok:
    buffer_load_dwordx4 v[80:83], v0, s[8:11], s3 offen offset:0 sc1
    buffer_load_dwordx4 v[84:87], v0, s[8:11], s3 offen offset:1024 sc1
    s_waitcnt lgkmcnt(0)
    s_barrier
    ds_read_b128 v[40:43], v0 offset:13312
    ds_read_b128 v[48:51], v0 offset:14336
    s_mov_b32 m0, 4096
    s_nop 0
    buffer_load_dwordx4 v0, s[8:11], s26 offen offset:0 sc1 lds
    buffer_load_dwordx4 v0, s[8:11], s26 offen offset:1024 sc1 lds
    v_mov_b64 v[60:61], 0
    v_mov_b64 v[62:63], 0
    v_mov_b64 v[64:65], 0
    v_mov_b64 v[66:67], 0
    v_mov_b64 v[68:69], 0
    v_mov_b64 v[70:71], 0
    v_mov_b64 v[52:53], 0
    v_mov_b64 v[54:55], 0
    s_waitcnt lgkmcnt(1)
    v_smfmac_f32_16x16x64_bf16 v[56:59], v[40:43], v[160:167], v1
    v_smfmac_f32_16x16x64_bf16 v[60:63], v[40:43], v[144:151], v1
    s_waitcnt lgkmcnt(0)
    v_smfmac_f32_16x16x64_bf16 v[56:59], v[48:51], v[152:159], v1
    v_smfmac_f32_16x16x64_bf16 v[60:63], v[48:51], v[136:143], v1
    v_smfmac_f32_16x16x64_bf16 v[64:67], v[40:43], v[128:135], v1
    v_smfmac_f32_16x16x64_bf16 v[68:71], v[40:43], v[112:119], v1
    v_permlane32_swap_b32 v56, v57
    v_smfmac_f32_16x16x64_bf16 v[64:67], v[48:51], v[120:127], v1
    v_permlane32_swap_b32 v58, v59
    v_smfmac_f32_16x16x64_bf16 v[68:71], v[48:51], v[104:111], v1
    v_add_f32 v56, v56, v57
    v_add_f32 v58, v58, v59
    v_smfmac_f32_16x16x64_bf16 v[52:55], v[40:43], v[96:103], v1
    v_permlane32_swap_b32 v60, v61
    v_smfmac_f32_16x16x64_bf16 v[52:55], v[48:51], v[88:95], v1
    v_permlane32_swap_b32 v62, v63
    v_add_f32 v60, v60, v61
    v_add_f32 v62, v62, v63
    v_cvt_pk_bf16_f32 v36, v56, v60
    v_cvt_pk_bf16_f32 v38, v58, v62
    v_permlane32_swap_b32 v64, v65
    v_permlane32_swap_b32 v66, v67
    v_add_f32 v64, v64, v65
    v_add_f32 v66, v66, v67
    v_permlane32_swap_b32 v68, v69
    v_permlane32_swap_b32 v70, v71
    v_add_f32 v68, v68, v69
    v_add_f32 v70, v70, v71
    v_cvt_pk_bf16_f32 v37, v64, v68
    v_cvt_pk_bf16_f32 v39, v66, v70
    buffer_store_dwordx4 v[36:39], v0, s[8:11], s56 offen sc1
    v_permlane32_swap_b32 v52, v53
    v_permlane32_swap_b32 v54, v55
    v_add_f32 v52, v52, v53
    v_add_f32 v54, v54, v55
    v_cvt_pk_bf16_f32 v52, v52, v54
    buffer_store_dword v52, v7, s[8:11], s55 offen sc1
    s_add_u32 s27, s44, 1
    s_and_b32 s27, s27, 3
    s_mul_i32 s48, s27, 5120
    s_add_u32 s48, s48, s41
    s_lshl_b32 s27, s27, 15
    s_add_u32 s49, s27, s47
    v_add_u32 v10, 8192, v0
    v_add_u32 v11, 20736, v3
    v_cndmask_b32_e64 v10, v10, v11, s[42:43]
    ds_read_b128 v[72:75], v10 offset:0
    v_add_u32 v10, 9216, v0
    v_add_u32 v11, 20800, v3
    v_cndmask_b32_e64 v10, v10, v11, s[42:43]
    ds_read_b128 v[76:79], v10 offset:0
    s_lshl_b32 s4, s44, 18
    s_add_u32 s4, s4, s53
    ds_read_b128 v[56:59], v5 offset:0
    ds_read_b128 v[60:63], v5 offset:1024
    ds_read_b128 v[64:67], v5 offset:2048
    ds_read_b128 v[68:71], v5 offset:3072
    v_mov_b64 v[12:13], 0
    v_mov_b64 v[14:15], 0
    v_mov_b64 v[16:17], 0
    v_mov_b64 v[18:19], 0
    v_mov_b64 v[20:21], 0
    v_mov_b64 v[22:23], 0
    v_mov_b64 v[24:25], 0
    v_mov_b64 v[26:27], 0
    v_mov_b64 v[28:29], 0
    v_mov_b64 v[30:31], 0
    v_mov_b64 v[32:33], 0
    v_mov_b64 v[34:35], 0
    s_barrier
    s_and_b32 s26, s44, 63
    s_add_u32 s26, s26, 2
    s_min_u32 s26, s26, 63
    s_lshl_b32 s26, s26, 18
    s_add_u32 s26, s26, s50
    s_add_u32 s26, s26, 4096
    s_add_u32 s3, s26, 16777216
    s_nop 15
    s_nop 15
    s_nop 15
    s_nop 0
    s_mov_b32 m0, 13312
    s_nop 0
    buffer_load_dwordx4 v0, s[8:11], s48 offen offset:0 sc1 lds
    buffer_load_dwordx4 v0, s[8:11], s48 offen offset:1024 sc1 lds
    buffer_load_dwordx4 v0, s[8:11], s48 offen offset:2048 sc1 lds
    s_nop 11
    s_mov_b32 m0, 13312
    s_nop 0
    buffer_load_dwordx4 v0, s[8:11], s48 offen offset:0 sc1 lds
    buffer_load_dwordx4 v0, s[8:11], s48 offen offset:1024 sc1 lds
    buffer_load_dwordx4 v0, s[8:11], s48 offen offset:2048 sc1 lds
    s_nop 11
    s_mov_b32 m0, 13312
    s_nop 0
    buffer_load_dwordx4 v0, s[8:11], s48 offen offset:0 sc1 lds
    buffer_load_dwordx4 v0, s[8:11], s48 offen offset:1024 sc1 lds
    buffer_load_dwordx4 v0, s[8:11], s48 offen offset:2048 sc1 lds
    s_add_u32 s44, s44, 1
    s_mov_b32 s70, 0
    s_waitcnt lgkmcnt(0)
    s_branch M_c1_2_top
M_c1_2_restart:
    s_waitcnt vmcnt(0) lgkmcnt(0)
    s_nop 7
    s_barrier
    s_mov_b32 m0, 13312
    s_nop 0
    buffer_load_dwordx4 v0, s[8:11], s48 offen offset:0 sc1 lds
    buffer_load_dwordx4 v0, s[8:11], s48 offen offset:1024 sc1 lds
    buffer_load_dwordx4 v0, s[8:11], s48 offen offset:2048 sc1 lds
    ds_read_b128 v[56:59], v5 offset:0
    ds_read_b128 v[60:63], v5 offset:1024
    ds_read_b128 v[64:67], v5 offset:2048
    ds_read_b128 v[68:71], v5 offset:3072
    v_mov_b64 v[12:13], 0
    v_mov_b64 v[14:15], 0
    v_mov_b64 v[16:17], 0
    v_mov_b64 v[18:19], 0
    v_mov_b64 v[20:21], 0
    v_mov_b64 v[22:23], 0
    v_mov_b64 v[24:25], 0
    v_mov_b64 v[26:27], 0
    v_mov_b64 v[28:29], 0
    v_mov_b64 v[30:31], 0
    v_mov_b64 v[32:33], 0
    v_mov_b64 v[34:35], 0
    s_waitcnt vmcnt(0) lgkmcnt(0)
    s_branch M_c1_2_top
M_c1_2_zbad:
    s_cmp_eq_u32 s70, 2
    s_cbranch_scc1 M_c1_2_zok
    v_cmp_u_f32 vcc, v28, v28
    s_cbranch_vccz M_c1_2_exact
    s_cmp_eq_u32 s70, 1
    s_cbranch_scc1 M_c1_2_exact
M_c1_2_vfy0:
    s_mov_b32 s70, 1
    s_mov_b32 s30, 0
    s_waitcnt vmcnt(0) lgkmcnt(0)
    s_nop 7
M_c1_2_vfy:
    v_mov_b32 v10, 0
    s_add_u32 s59, s48, 4096
    buffer_load_dwordx4 v[36:39], v0, s[8:11], s48 offen offset:0 sc1
    buffer_load_dwordx4 v[40:43], v0, s[8:11], s48 offen offset:1024 sc1
    buffer_load_dwordx4 v[44:47], v0, s[8:11], s48 offen offset:2048 sc1
    buffer_load_dwordx4 v[48:51], v0, s[8:11], s48 offen offset:3072 sc1
    buffer_load_dwordx4 v[52:55], v0, s[8:11], s59 offen offset:0 sc1
    s_waitcnt vmcnt(4)
    v_max3_u32 v10, v10, v36, v37
    v_max3_u32 v10, v10, v38, v39
    s_waitcnt vmcnt(3)
    v_max3_u32 v10, v10, v40, v41
    v_max3_u32 v10, v10, v42, v43
    s_waitcnt vmcnt(2)
    v_max3_u32 v10, v10, v44, v45
    v_max3_u32 v10, v10, v46, v47
    s_waitcnt vmcnt(1)
    v_max3_u32 v10, v10, v48, v49
    v_max3_u32 v10, v10, v50, v51
    s_waitcnt vmcnt(0)
    v_max3_u32 v10, v10, v52, v53
    v_max3_u32 v10, v10, v54, v55
    s_add_u32 s59, s49, 4096
    buffer_load_dwordx4 v[36:39], v0, s[8:11], s49 offen offset:0 sc1
    buffer_load_dwordx4 v[40:43], v0, s[8:11], s49 offen offset:1024 sc1
    buffer_load_dwordx4 v[44:47], v0, s[8:11], s49 offen offset:2048 sc1
    buffer_load_dwordx4 v[48:51], v0, s[8:11], s49 offen offset:3072 sc1
    buffer_load_dwordx4 v[52:55], v0, s[8:11], s59 offen offset:0 sc1
    s_waitcnt vmcnt(4)
    v_max3_u32 v10, v10, v36, v37
    v_max3_u32 v10, v10, v38, v39
    s_waitcnt vmcnt(3)
    v_max3_u32 v10, v10, v40, v41
    v_max3_u32 v10, v10, v42, v43
    s_waitcnt vmcnt(2)
    v_max3_u32 v10, v10, v44, v45
    v_max3_u32 v10, v10, v46, v47
    s_waitcnt vmcnt(1)
    v_max3_u32 v10, v10, v48, v49
    v_max3_u32 v10, v10, v50, v51
    s_waitcnt vmcnt(0)
    v_max3_u32 v10, v10, v52, v53
    v_max3_u32 v10, v10, v54, v55
    v_cmp_eq_u32 vcc, -1, v10
    s_cbranch_vccz M_c1_2_restart
    s_add_u32 s30, s30, 1
    s_cmp_ge_u32 s30, 60000
    s_cbranch_scc1 M_fail
    s_branch M_c1_2_vfy
M_c1_2_exact:
    s_nop 7
    s_mov_b32 s70, 2
    s_waitcnt lgkmcnt(0)
    ds_read_b128 v[20:23], v3 offset:18432
    ds_read_b128 v[24:27], v3 offset:18496
    ds_read_b128 v[28:31], v3 offset:18560
    ds_read_b128 v[32:35], v3 offset:18624
    ds_read_b128 v[56:59], v0 offset:0
    s_waitcnt lgkmcnt(0)
    v_mfma_f32_16x16x32_bf16 v[36:39], v[56:59], v[20:23], 0
    s_nop 3
    ds_read_b128 v[60:63], v0 offset:1024
    s_waitcnt lgkmcnt(0)
    v_mfma_f32_16x16x32_bf16 v[36:39], v[60:63], v[24:27], v[36:39]
    s_nop 3
    ds_read_b128 v[56:59], v0 offset:2048
    s_waitcnt lgkmcnt(0)
    v_mfma_f32_16x16x32_bf16 v[36:39], v[56:59], v[28:31], v[36:39]
    s_nop 3
    ds_read_b128 v[60:63], v0 offset:3072
    s_waitcnt lgkmcnt(0)
    v_mfma_f32_16x16x32_bf16 v[36:39], v[60:63], v[32:35], v[36:39]
    s_nop 3
    ds_read_b128 v[56:59], v0 offset:4096
    s_waitcnt lgkmcnt(0)
    v_mfma_f32_16x16x32_bf16 v[40:43], v[56:59], v[20:23], 0
    s_nop 3
    ds_read_b128 v[60:63], v0 offset:5120
    s_waitcnt lgkmcnt(0)
    v_mfma_f32_16x16x32_bf16 v[40:43], v[60:63], v[24:27], v[40:43]
    s_nop 3
    ds_read_b128 v[56:59], v0 offset:6144
    s_waitcnt lgkmcnt(0)
    v_mfma_f32_16x16x32_bf16 v[40:43], v[56:59], v[28:31], v[40:43]
    s_nop 3
    ds_read_b128 v[60:63], v0 offset:7168
    s_waitcnt lgkmcnt(0)
    v_mfma_f32_16x16x32_bf16 v[40:43], v[60:63], v[32:35], v[40:43]
    s_nop 3
    ds_read_b128 v[56:59], v3 offset:20736
    s_waitcnt lgkmcnt(0)
    v_mfma_f32_16x16x32_bf16 v[48:51], v[56:59], v[20:23], 0
    s_nop 3
    ds_read_b128 v[60:63], v3 offset:20800
    s_waitcnt lgkmcnt(0)
    v_mfma_f32_16x16x32_bf16 v[48:51], v[60:63], v[24:27], v[48:51]
    s_nop 3
    ds_read_b128 v[56:59], v3 offset:20864
    s_waitcnt lgkmcnt(0)
    v_mfma_f32_16x16x32_bf16 v[48:51], v[56:59], v[28:31], v[48:51]
    s_nop 3
    ds_read_b128 v[60:63], v3 offset:20928
    s_waitcnt lgkmcnt(0)
    v_mfma_f32_16x16x32_bf16 v[48:51], v[60:63], v[32:35], v[48:51]
    s_nop 3
    v_max3_f32 v64, v36, v37, v38
    v_max3_f32 v64, v64, v39, v40
    v_max3_f32 v64, v64, v41, v42
    s_nop 0
    v_max3_f32 v64, v64, v43, v48
    v_max3_f32 v64, v64, v49, v50
    v_max_f32 v64, v64, v51
    v_mov_b32 v65, v64
    s_nop 1
    v_permlane16_swap_b32 v64, v65
    v_max_f32 v64, v64, v65
    v_mov_b32 v65, v64
    s_nop 1
    v_permlane32_swap_b32 v64, v65
    v_max_f32 v64, v64, v65
    v_sub_f32 v36, v36, v64
    v_exp_f32 v36, v36
    v_sub_f32 v37, v37, v64
    v_exp_f32 v37, v37
    v_sub_f32 v38, v38, v64
    v_exp_f32 v38, v38
    v_sub_f32 v39, v39, v64
    v_exp_f32 v39, v39
    v_sub_f32 v40, v40, v64
    v_exp_f32 v40, v40
    v_sub_f32 v41, v41, v64
    v_exp_f32 v41, v41
    v_sub_f32 v42, v42, v64
    v_exp_f32 v42, v42
    v_sub_f32 v43, v43, v64
    v_exp_f32 v43, v43
    v_sub_f32 v48, v48, v64
    v_exp_f32 v48, v48
    v_sub_f32 v49, v49, v64
    v_exp_f32 v49, v49
    v_sub_f32 v50, v50, v64
    v_exp_f32 v50, v50
    v_sub_f32 v51, v51, v64
    v_exp_f32 v51, v51
    v_cvt_pk_bf16_f32 v36, v36, v37
    v_cvt_pk_bf16_f32 v37, v38, v39
    v_cvt_pk_bf16_f32 v38, v40, v41
    v_cvt_pk_bf16_f32 v39, v42, v43
    v_cvt_pk_bf16_f32 v48, v48, v49
    v_cvt_pk_bf16_f32 v49, v50, v51
    v_mfma_f32_16x16x32_bf16 v[20:23], v[80:83], v[36:39], 0
    v_mfma_f32_16x16x32_bf16 v[24:27], v[84:87], v[36:39], 0
    v_mfma_f32_16x16x32_bf16 v[28:31], v[72:75], v[36:39], 0
    ds_read_b128 v[64:67], v3 offset:20864
    s_waitcnt lgkmcnt(0)
    s_nop 7
    s_branch M_c1_2_fin
M_c1_2_last:
    s_cmp_lg_u32 s70, 0
    s_cbranch_scc1 M_c1_2_last2
    v_cmp_u_f32 vcc, v40, v40
    s_cbranch_vccnz M_c1_2_vfy0
M_c1_2_last2:
    s_waitcnt vmcnt(0) lgkmcnt(0)
    s_barrier
    s_nop 7
    v_add_u32 v10, 8192, v0
    v_add_u32 v11, 20736, v3
    v_cndmask_b32_e64 v10, v10, v11, s[42:43]
    ds_read_b128 v[72:75], v10 offset:0
    v_add_u32 v10, 9216, v0
    v_add_u32 v11, 20800, v3
    v_cndmask_b32_e64 v10, v10, v11, s[42:43]
    ds_read_b128 v[76:79], v10 offset:0
    s_lshl_b32 s4, s44, 18
    s_add_u32 s4, s4, s53
    s_waitcnt lgkmcnt(1)
    buffer_store_dwordx4 v[72:75], v0, s[8:11], s4 offen offset:0 sc1
    s_waitcnt lgkmcnt(0)
    buffer_store_dwordx4 v[76:79], v0, s[8:11], s4 offen offset:1024 sc1
    s_mov_b32 s4, 0x10000000
    s_waitcnt vmcnt(0)
    s_barrier
    s_nop 7
    v_mov_b64 v[72:73], -1
    v_mov_b64 v[74:75], -1
    s_add_u32 s28, s44, 3
    s_and_b32 s29, s28, 3
    s_mul_i32 s31, s22, 160
    s_waitcnt vmcnt(0)
    s_add_u32 s44, s44, 1
    s_cmp_eq_u32 s44, 128
    s_cbranch_scc1 M_end
    s_branch M_c1_2_layer
M_c1_2_lr:
    s_mov_b32 s30, 0
M_c1_2_lr_l:
    s_waitcnt lgkmcnt(0)
    s_and_b32 s27, s30, 1
    s_cbranch_scc0 M_c1_2_lr_n
    s_waitcnt vmcnt(3)
    s_mov_b32 m0, 13312
    s_nop 0
    buffer_load_dwordx4 v0, s[8:11], s48 offen offset:0 sc1 lds
    buffer_load_dwordx4 v0, s[8:11], s48 offen offset:1024 sc1 lds
    buffer_load_dwordx4 v0, s[8:11], s48 offen offset:2048 sc1 lds
M_c1_2_lr_n:
    ds_read_b128 v[36:39], v6 offset:13312
    ds_read_b128 v[40:43], v6 offset:14336
    ds_read_b128 v[44:47], v6 offset:15360
    ds_read_b128 v[48:51], v6 offset:16384
    ds_read_b128 v[52:55], v6 offset:17408
    s_waitcnt lgkmcnt(2)
    v_max3_u32 v10, v36, v40, v44
    s_waitcnt lgkmcnt(0)
    v_max3_u32 v10, v10, v48, v52
    v_cmp_eq_u32 vcc, -1, v10
    s_cbranch_vccz M_c1_2_lr_d
    s_add_u32 s30, s30, 1
    s_cmp_ge_u32 s30, 480000
    s_cbranch_scc1 M_fail
    s_branch M_c1_2_lr_l
M_c1_2_lr_d:
    ds_read_b128 v[56:59], v5 offset:0
    ds_read_b128 v[60:63], v5 offset:1024
    ds_read_b128 v[64:67], v5 offset:2048
    ds_read_b128 v[68:71], v5 offset:3072
    v_mov_b64 v[12:13], 0
    v_mov_b64 v[14:15], 0
    v_mov_b64 v[16:17], 0
    v_mov_b64 v[18:19], 0
    v_mov_b64 v[20:21], 0
    v_mov_b64 v[22:23], 0
    v_mov_b64 v[24:25], 0
    v_mov_b64 v[26:27], 0
    v_mov_b64 v[28:29], 0
    v_mov_b64 v[30:31], 0
    v_mov_b64 v[32:33], 0
    v_mov_b64 v[34:35], 0
    s_waitcnt lgkmcnt(0)
    s_branch M_c1_2_lr_r
M_c1_2_rr:
    s_mov_b32 s30, 0
M_c1_2_rr_l:
    s_waitcnt lgkmcnt(0)
    s_and_b32 s27, s30, 1
    s_cbranch_scc1 M_c1_2_rr_n
    s_waitcnt vmcnt(1)
    s_mov_b32 m0, 8192
    s_nop 0
    buffer_load_dwordx4 v0, s[8:11], s49 offen offset:3072 sc1 lds
M_c1_2_rr_n:
    ds_read_b128 v[36:39], v6 offset:8192
    ds_read_b128 v[40:43], v6 offset:9216
    ds_read_b128 v[44:47], v6 offset:10240
    ds_read_b128 v[48:51], v6 offset:11264
    ds_read_b32 v11, v6 offset:12288
    s_waitcnt lgkmcnt(2)
    v_max3_u32 v10, v36, v40, v44
    s_waitcnt lgkmcnt(0)
    v_max3_u32 v10, v10, v48, v11
    v_cmp_eq_u32 vcc, -1, v10
    s_cbranch_vccz M_c1_2_rr_d
    s_add_u32 s30, s30, 1
    s_cmp_ge_u32 s30, 480000
    s_cbranch_scc1 M_fail
    s_branch M_c1_2_rr_l
M_c1_2_rr_d:
    s_branch M_c1_2_rr_r
M_c1_3_layer:
    s_lshr_b32 s27, s44, 6
    s_mul_i32 s50, s27, 33554432
    s_lshl_b32 s27, s22, 13
    s_add_u32 s50, s50, s27
    s_add_u32 s50, s50, 37748736
    s_barrier
    s_and_b32 s26, s44, 63
    s_lshl_b32 s26, s26, 18
    s_add_u32 s26, s26, s50
    s_add_u32 s26, s26, 6144
    s_add_u32 s3, s26, 16777216
    s_mov_b32 m0, 6144
    s_nop 0
    buffer_load_dwordx4 v0, s[8:11], s26 offen offset:0 sc1 lds
    buffer_load_dwordx4 v0, s[8:11], s26 offen offset:1024 sc1 lds
    buffer_load_dwordx4 v[80:83], v0, s[8:11], s3 offen offset:0 sc1
    buffer_load_dwordx4 v[84:87], v0, s[8:11], s3 offen offset:1024 sc1
    s_and_b32 s26, s44, 63
    s_add_u32 s26, s26, 1
    s_min_u32 s26, s26, 63
    s_lshl_b32 s26, s26, 18
    s_add_u32 s26, s26, s50
    s_add_u32 s26, s26, 6144
    s_add_u32 s3, s26, 16777216
    s_mul_i32 s27, s20, 5120
    s_add_u32 s48, s27, 167772160
    s_sub_u32 s49, 167777280, s27
    s_mov_b32 m0, 13312
    s_nop 0
    buffer_load_dwordx4 v0, s[8:11], s48 offen offset:3072 sc1 lds
    s_mov_b32 m0, 17408
    s_add_u32 s59, s48, 4096
    buffer_load_dwordx4 v0, s[8:11], s59 offen offset:0 sc1 lds
    ds_read_b128 v[56:59], v5 offset:0
    ds_read_b128 v[60:63], v5 offset:1024
    ds_read_b128 v[64:67], v5 offset:2048
    ds_read_b128 v[68:71], v5 offset:3072
    v_mov_b64 v[12:13], 0
    v_mov_b64 v[14:15], 0
    v_mov_b64 v[16:17], 0
    v_mov_b64 v[18:19], 0
    v_mov_b64 v[20:21], 0
    v_mov_b64 v[22:23], 0
    v_mov_b64 v[24:25], 0
    v_mov_b64 v[26:27], 0
    v_mov_b64 v[28:29], 0
    v_mov_b64 v[30:31], 0
    v_mov_b64 v[32:33], 0
    v_mov_b64 v[34:35], 0
    s_mov_b32 s70, 0
    s_waitcnt vmcnt(0) lgkmcnt(0)
M_c1_3_top:
    s_waitcnt vmcnt(4)
    s_barrier
    ds_read_b128 v[36:39], v6 offset:13312
    ds_read_b128 v[40:43], v6 offset:14336
    ds_read_b128 v[44:47], v6 offset:15360
    ds_read_b128 v[48:51], v6 offset:16384
    ds_read_b128 v[52:55], v6 offset:17408
    s_mov_b32 m0, 12288
    s_add_u32 s59, s49, 4096
    buffer_load_dwordx4 v0, s[8:11], s59 offen offset:0 sc1 lds
M_c1_3_lr_r:
    s_waitcnt lgkmcnt(4)
    v_smfmac_f32_16x16x64_bf16 v[20:23], v[36:39], v[56:63], v1
    ds_read_b128 v[56:59], v5 offset:4096
    s_and_b32 s55, s44, 3
    s_mul_i32 s55, s55, 167936
    v_smfmac_f32_16x16x64_bf16 v[24:27], v[36:39], v[64:71], v1
    ds_read_b128 v[64:67], v5 offset:6144
    s_add_u32 s55, s55, s34
    s_add_u32 s56, s55, s35
    v_smfmac_f32_16x16x64_bf16 v[28:31], v[36:39], a[248:255], v1
    ds_read_b128 v[68:71], v5 offset:7168
    s_and_b32 s57, s44, 63
    v_smfmac_f32_16x16x64_bf16 v[32:35], v[36:39], a[240:247], v1
    ds_read_b128 v[60:63], v5 offset:5120
    s_waitcnt lgkmcnt(7)
    v_smfmac_f32_16x16x64_bf16 v[20:23], v[40:43], a[232:239], v1
    s_waitcnt lgkmcnt(0)
    v_smfmac_f32_16x16x64_bf16 v[24:27], v[40:43], v[56:63], v1
    ds_read_b128 v[56:59], v5 offset:8192
    v_smfmac_f32_16x16x64_bf16 v[28:31], v[40:43], a[224:231], v1
    ds_read_b128 v[60:63], v5 offset:9216
    v_smfmac_f32_16x16x64_bf16 v[32:35], v[40:43], a[216:223], v1
    v_smfmac_f32_16x16x64_bf16 v[20:23], v[44:47], v[64:71], v1
    ds_read_b128 v[64:67], v5 offset:10240
    v_max3_u32 v10, v36, v40, v44
    v_smfmac_f32_16x16x64_bf16 v[24:27], v[44:47], a[208:215], v1
    ds_read_b128 v[68:71], v5 offset:11264
    v_max3_u32 v10, v10, v48, v52
    v_smfmac_f32_16x16x64_bf16 v[28:31], v[44:47], a[200:207], v1
    s_waitcnt lgkmcnt(2)
    v_cmp_eq_u32 vcc, -1, v10
    v_smfmac_f32_16x16x64_bf16 v[32:35], v[44:47], v[56:63], v1
    ds_read_b128 v[56:59], v5 offset:12288
    s_cbranch_vccnz M_c1_3_lr
    v_smfmac_f32_16x16x64_bf16 v[20:23], v[48:51], a[192:199], v1
    ds_read_b128 v[60:63], v5 offset:13312
    v_smfmac_f32_16x16x64_bf16 v[24:27], v[48:51], a[184:191], v1
    s_waitcnt lgkmcnt(2)
    v_smfmac_f32_16x16x64_bf16 v[28:31], v[48:51], v[64:71], v1
    ds_read_b128 v[64:67], v5 offset:14336
    v_smfmac_f32_16x16x64_bf16 v[32:35], v[48:51], a[176:183], v1
    ds_read_b128 v[68:71], v5 offset:15360
    s_waitcnt vmcnt(0)
    s_barrier
    ds_read_b128 v[36:39], v6 offset:8192
    ds_read_b128 v[40:43], v6 offset:9216
    ds_read_b128 v[44:47], v6 offset:10240
    ds_read_b128 v[48:51], v6 offset:11264
    ds_read_b32 v11, v6 offset:12288
    v_smfmac_f32_16x16x64_bf16 v[20:23], v[52:55], a[168:175], v1
    s_waitcnt lgkmcnt(7)
    v_smfmac_f32_16x16x64_bf16 v[24:27], v[52:55], v[56:63], v1
    ds_read_b128 v[56:59], v5 offset:16384
    v_smfmac_f32_16x16x64_bf16 v[28:31], v[52:55], a[160:167], v1
    ds_read_b128 v[60:63], v5 offset:17408
    s_waitcnt lgkmcnt(4)
    v_max3_u32 v10, v36, v40, v44
    v_smfmac_f32_16x16x64_bf16 v[32:35], v[52:55], a[152:159], v1
    s_waitcnt lgkmcnt(2)
    v_max3_u32 v10, v10, v48, v11
    v_cmp_eq_u32 vcc, -1, v10
    s_cbranch_vccnz M_c1_3_rr
M_c1_3_rr_r:
    ds_read_b128 v[52:55], v6 offset:12288
    buffer_store_dwordx4 v[72:75], v0, s[8:11], s4 offen offset:2048 sc1
    buffer_store_dwordx4 v[76:79], v0, s[8:11], s4 offen offset:3072 sc1
    s_mov_b32 s4, 0x10000000
    v_smfmac_f32_16x16x64_bf16 v[20:23], v[36:39], v[64:71], v1
    ds_read_b128 v[64:67], v5 offset:18432
    v_smfmac_f32_16x16x64_bf16 v[24:27], v[36:39], a[144:151], v1
    ds_read_b128 v[68:71], v5 offset:19456
    v_smfmac_f32_16x16x64_bf16 v[20:23], v[40:43], a[136:143], v1
    s_waitcnt lgkmcnt(3)
    v_smfmac_f32_16x16x64_bf16 v[24:27], v[40:43], v[56:63], v1
    ds_read_b128 v[56:59], v5 offset:20480
    v_smfmac_f32_16x16x64_bf16 v[20:23], v[44:47], a[128:135], v1
    ds_read_b128 v[60:63], v5 offset:21504
    v_smfmac_f32_16x16x64_bf16 v[24:27], v[44:47], a[120:127], v1
    s_waitcnt lgkmcnt(2)
    v_smfmac_f32_16x16x64_bf16 v[20:23], v[48:51], v[64:71], v1
    ds_read_b128 v[64:67], v5 offset:22528
    v_smfmac_f32_16x16x64_bf16 v[24:27], v[48:51], a[112:119], v1
    ds_read_b128 v[68:71], v5 offset:23552
    v_smfmac_f32_16x16x64_bf16 v[20:23], v[52:55], a[104:111], v1
    s_waitcnt lgkmcnt(2)
    v_smfmac_f32_16x16x64_bf16 v[24:27], v[52:55], v[56:63], v1
    ds_read_b128 v[56:59], v5 offset:24576
    v_smfmac_f32_16x16x64_bf16 v[28:31], v[36:39], a[96:103], v1
    ds_read_b128 v[60:63], v5 offset:25600
    v_smfmac_f32_16x16x64_bf16 v[32:35], v[36:39], a[88:95], v1
    s_waitcnt lgkmcnt(2)
    v_mov_b32 v5, v5
    v_mov_b32 v5, v5
    v_permlane32_swap_b32 v20, v21
    v_smfmac_f32_16x16x64_bf16 v[28:31], v[40:43], v[64:71], v1
    ds_read_b128 v[64:67], v5 offset:26624
    v_permlane32_swap_b32 v22, v23
    v_smfmac_f32_16x16x64_bf16 v[32:35], v[40:43], a[80:87], v1
    ds_read_b128 v[68:71], v5 offset:27648
    v_permlane32_swap_b32 v24, v25
    v_smfmac_f32_16x16x64_bf16 v[28:31], v[44:47], a[72:79], v1
    s_waitcnt lgkmcnt(2)
    v_permlane32_swap_b32 v26, v27
    v_smfmac_f32_16x16x64_bf16 v[32:35], v[44:47], v[56:63], v1
    ds_read_b128 v[56:59], v5 offset:28672
    v_add_f32 v20, v20, v21
    v_add_f32 v22, v22, v23
    v_smfmac_f32_16x16x64_bf16 v[28:31], v[48:51], a[64:71], v1
    ds_read_b128 v[60:63], v5 offset:29696
    v_add_f32 v24, v24, v25
    v_add_f32 v26, v26, v27
    v_smfmac_f32_16x16x64_bf16 v[32:35], v[48:51], a[56:63], v1
    s_waitcnt lgkmcnt(2)
    v_mul_f32 v20, s40, v20
    v_mul_f32 v24, s40, v24
    v_smfmac_f32_16x16x64_bf16 v[28:31], v[52:55], v[64:71], v1
    ds_read_b128 v[64:67], v5 offset:30720
    v_mul_f32 v22, s40, v22
    v_mul_f32 v26, s40, v26
    v_smfmac_f32_16x16x64_bf16 v[32:35], v[52:55], a[48:55], v1
    ds_read_b128 v[68:71], v5 offset:31744
    v_cvt_pk_bf16_f32 v20, v20, v24
    v_cvt_pk_bf16_f32 v21, v22, v26
    v_smfmac_f32_16x16x64_bf16 v[12:15], v[36:39], a[40:47], v1
    ds_write_b32 v2, v20 offset:18432
    ds_write_b32 v2, v21 offset:19008
    s_waitcnt lgkmcnt(4)
    v_smfmac_f32_16x16x64_bf16 v[16:19], v[36:39], v[56:63], v1
    ds_read_b128 v[56:59], v5 offset:32768
    v_permlane32_swap_b32 v28, v29
    v_smfmac_f32_16x16x64_bf16 v[12:15], v[40:43], a[32:39], v1
    ds_read_b128 v[60:63], v5 offset:33792
    v_permlane32_swap_b32 v30, v31
    v_smfmac_f32_16x16x64_bf16 v[16:19], v[40:43], a[24:31], v1
    ds_read_b128 v[36:39], v6 offset:13312
    s_waitcnt lgkmcnt(5)
    v_permlane32_swap_b32 v32, v33
    v_smfmac_f32_16x16x64_bf16 v[12:15], v[44:47], v[64:71], v1
    ds_read_b128 v[40:43], v6 offset:14336
    v_permlane32_swap_b32 v34, v35
    v_smfmac_f32_16x16x64_bf16 v[16:19], v[44:47], a[16:23], v1
    ds_read_b128 v[44:47], v6 offset:15360
    v_add_f32 v28, v28, v29
    v_add_f32 v30, v30, v31
    v_smfmac_f32_16x16x64_bf16 v[12:15], v[48:51], a[8:15], v1
    ds_read_b128 v[64:67], v0 offset:2048
    s_waitcnt lgkmcnt(4)
    v_add_f32 v32, v32, v33
    v_add_f32 v34, v34, v35
    v_smfmac_f32_16x16x64_bf16 v[16:19], v[48:51], v[56:63], v1
    ds_read_b128 v[68:71], v0 offset:3072
    v_cvt_pk_bf16_f32 v28, v28, v32
    v_cvt_pk_bf16_f32 v29, v30, v34
    v_smfmac_f32_16x16x64_bf16 v[12:15], v[52:55], a[0:7], v1
    ds_write_b32 v2, v28 offset:20736
    ds_write_b32 v2, v29 offset:21312
    v_smfmac_f32_16x16x64_bf16 v[16:19], v[52:55], v[248:255], v1
    ds_read_b128 v[48:51], v6 offset:16384
    s_waitcnt lgkmcnt(7)
    v_smfmac_f32_16x16x64_bf16 v[12:15], v[36:39], v[240:247], v1
    ds_read_b128 v[56:59], v0 offset:0
    v_smfmac_f32_16x16x64_bf16 v[16:19], v[36:39], v[232:239], v1
    s_waitcnt vmcnt(2) lgkmcnt(2)
    s_barrier
    ds_read_b128 v[20:23], v3 offset:18432
    ds_read_b128 v[24:27], v3 offset:18496
    v_smfmac_f32_16x16x64_bf16 v[12:15], v[40:43], v[224:231], v1
    ds_read_b128 v[28:31], v3 offset:18560
    v_smfmac_f32_16x16x64_bf16 v[16:19], v[40:43], v[216:223], v1
    ds_read_b128 v[32:35], v3 offset:18624
    v_smfmac_f32_16x16x64_bf16 v[12:15], v[44:47], v[208:215], v1
    ds_read_b128 v[60:63], v0 offset:1024
    v_smfmac_f32_16x16x64_bf16 v[16:19], v[44:47], v[200:207], v1
    ds_read_b128 v[52:55], v6 offset:17408
    s_waitcnt lgkmcnt(5)
    v_mfma_f32_16x16x32_bf16 v[36:39], v[56:59], v[20:23], 0
    ds_read_b128 v[56:59], v0 offset:4096
    s_waitcnt lgkmcnt(2)
    v_mfma_f32_16x16x32_bf16 v[36:39], v[60:63], v[24:27], v[36:39]
    ds_read_b128 v[60:63], v0 offset:5120
    v_mfma_f32_16x16x32_bf16 v[36:39], v[64:67], v[28:31], v[36:39]
    ds_read_b128 v[64:67], v0 offset:6144
    v_mfma_f32_16x16x32_bf16 v[36:39], v[68:71], v[32:35], v[36:39]
    ds_read_b128 v[68:71], v0 offset:7168
    v_mov_b64 v[72:73], s[24:25]
    v_smfmac_f32_16x16x64_bf16 v[12:15], v[48:51], v[192:199], v1
    v_mov_b64 v[74:75], s[24:25]
    v_smfmac_f32_16x16x64_bf16 v[16:19], v[48:51], v[184:191], v1
    s_waitcnt lgkmcnt(3)
    v_mov_b64 v[10:11], s[16:17]
    v_mfma_f32_16x16x32_bf16 v[40:43], v[56:59], v[20:23], 0
    ds_read_b128 v[56:59], v3 offset:20736
    s_waitcnt lgkmcnt(3)
    v_exp_f32 v36, v36
    v_mfma_f32_16x16x32_bf16 v[40:43], v[60:63], v[24:27], v[40:43]
    ds_read_b128 v[60:63], v3 offset:20800
    s_waitcnt lgkmcnt(3)
    v_exp_f32 v37, v37
    v_mfma_f32_16x16x32_bf16 v[40:43], v[64:67], v[28:31], v[40:43]
    ds_read_b128 v[64:67], v3 offset:20864
    s_waitcnt lgkmcnt(3)
    v_exp_f32 v38, v38
    v_mfma_f32_16x16x32_bf16 v[40:43], v[68:71], v[32:35], v[40:43]
    ds_read_b128 v[68:71], v3 offset:20928
    v_exp_f32 v39, v39
    v_smfmac_f32_16x16x64_bf16 v[12:15], v[52:55], v[176:183], v1
    v_cvt_pk_bf16_f32 v36, v36, v37
    v_smfmac_f32_16x16x64_bf16 v[16:19], v[52:55], v[168:175], v1
    s_waitcnt lgkmcnt(3)
    v_cvt_pk_bf16_f32 v37, v38, v39
    v_mfma_f32_16x16x32_bf16 v[48:51], v[56:59], v[20:23], 0
    s_waitcnt lgkmcnt(2)
    v_exp_f32 v40, v40
    v_mfma_f32_16x16x32_bf16 v[48:51], v[60:63], v[24:27], v[48:51]
    s_waitcnt lgkmcnt(1)
    v_exp_f32 v41, v41
    v_mfma_f32_16x16x32_bf16 v[48:51], v[64:67], v[28:31], v[48:51]
    s_waitcnt lgkmcnt(0)
    v_exp_f32 v42, v42
    v_mfma_f32_16x16x32_bf16 v[48:51], v[68:71], v[32:35], v[48:51]
    v_exp_f32 v43, v43
    v_cvt_pk_bf16_f32 v38, v40, v41
    v_cvt_pk_bf16_f32 v39, v42, v43
    v_cvt_pk_bf16_f32 v12, v12, v13
    v_cvt_pk_bf16_f32 v13, v14, v15
    v_mfma_f32_16x16x32_bf16 v[28:31], v[72:75], v[36:39], 0
    v_cvt_pk_bf16_f32 v14, v16, v17
    s_nop 0
    v_exp_f32 v48, v48
    v_mfma_f32_16x16x32_bf16 v[20:23], v[80:83], v[36:39], 0
    v_exp_f32 v49, v49
    v_exp_f32 v50, v50
    v_mfma_f32_16x16x32_bf16 v[24:27], v[84:87], v[36:39], 0
    v_exp_f32 v51, v51
    v_cvt_pk_bf16_f32 v48, v48, v49
    v_cvt_pk_bf16_f32 v49, v50, v51
    v_cvt_pk_bf16_f32 v15, v18, v19
M_c1_3_fin:
    s_nop 0
    v_mfma_f32_16x16x16_bf16 v[28:31], v[10:11], v[48:49], v[28:31]
    s_cmp_eq_u32 s57, 63
    v_mfma_f32_16x16x16_bf16 v[20:23], v[12:13], v[48:49], v[20:23]
    ds_write_b128 v0, v[12:15] offset:11264
    v_mfma_f32_16x16x16_bf16 v[24:27], v[14:15], v[48:49], v[24:27]
    s_cbranch_scc1 M_c1_3_last
    v_mov_b64 v[56:57], 0
    v_mov_b64 v[58:59], 0
    s_nop 0
    v_rcp_f32 v30, v28
    v_subrev_u32 v29, s68, v28
    v_pk_mul_f32 v[20:21], v[20:21], v[30:31] op_sel_hi:[1,0]
    v_pk_mul_f32 v[22:23], v[22:23], v[30:31] op_sel_hi:[1,0]
    v_cvt_pk_bf16_f32 v20, v20, v21
    v_cvt_pk_bf16_f32 v21, v22, v23
    v_pk_mul_f32 v[24:25], v[24:25], v[30:31] op_sel_hi:[1,0]
    v_pk_mul_f32 v[26:27], v[26:27], v[30:31] op_sel_hi:[1,0]
    v_cvt_pk_bf16_f32 v22, v24, v25
    v_cvt_pk_bf16_f32 v23, v26, v27
    ds_write2_b64 v4, v[20:21], v[22:23] offset0:0 offset1:16
    v_cmp_lt_u32 vcc, s69, v29
    s_cbranch_vccnz M_c1_3_zbad
M_c1_3_zok:
    buffer_load_dwordx4 v[80:83], v0, s[8:11], s3 offen offset:0 sc1
    buffer_load_dwordx4 v[84:87], v0, s[8:11], s3 offen offset:1024 sc1
    s_waitcnt lgkmcnt(0)
    s_barrier
    ds_read_b128 v[40:43], v0 offset:13312
    ds_read_b128 v[48:51], v0 offset:14336
    s_mov_b32 m0, 6144
    s_nop 0
    buffer_load_dwordx4 v0, s[8:11], s26 offen offset:0 sc1 lds
    buffer_load_dwordx4 v0, s[8:11], s26 offen offset:1024 sc1 lds
    v_mov_b64 v[60:61], 0
    v_mov_b64 v[62:63], 0
    v_mov_b64 v[64:65], 0
    v_mov_b64 v[66:67], 0
    v_mov_b64 v[68:69], 0
    v_mov_b64 v[70:71], 0
    v_mov_b64 v[52:53], 0
    v_mov_b64 v[54:55], 0
    s_waitcnt lgkmcnt(1)
    v_smfmac_f32_16x16x64_bf16 v[56:59], v[40:43], v[160:167], v1
    v_smfmac_f32_16x16x64_bf16 v[60:63], v[40:43], v[144:151], v1
    s_waitcnt lgkmcnt(0)
    v_smfmac_f32_16x16x64_bf16 v[56:59], v[48:51], v[152:159], v1
    v_smfmac_f32_16x16x64_bf16 v[60:63], v[48:51], v[136:143], v1
    v_smfmac_f32_16x16x64_bf16 v[64:67], v[40:43], v[128:135], v1
    v_smfmac_f32_16x16x64_bf16 v[68:71], v[40:43], v[112:119], v1
    v_permlane32_swap_b32 v56, v57
    v_smfmac_f32_16x16x64_bf16 v[64:67], v[48:51], v[120:127], v1
    v_permlane32_swap_b32 v58, v59
    v_smfmac_f32_16x16x64_bf16 v[68:71], v[48:51], v[104:111], v1
    v_add_f32 v56, v56, v57
    v_add_f32 v58, v58, v59
    v_smfmac_f32_16x16x64_bf16 v[52:55], v[40:43], v[96:103], v1
    v_permlane32_swap_b32 v60, v61
    v_smfmac_f32_16x16x64_bf16 v[52:55], v[48:51], v[88:95], v1
    v_permlane32_swap_b32 v62, v63
    v_add_f32 v60, v60, v61
    v_add_f32 v62, v62, v63
    v_cvt_pk_bf16_f32 v36, v56, v60
    v_cvt_pk_bf16_f32 v38, v58, v62
    v_permlane32_swap_b32 v64, v65
    v_permlane32_swap_b32 v66, v67
    v_add_f32 v64, v64, v65
    v_add_f32 v66, v66, v67
    v_permlane32_swap_b32 v68, v69
    v_permlane32_swap_b32 v70, v71
    v_add_f32 v68, v68, v69
    v_add_f32 v70, v70, v71
    v_cvt_pk_bf16_f32 v37, v64, v68
    v_cvt_pk_bf16_f32 v39, v66, v70
    buffer_store_dwordx4 v[36:39], v0, s[8:11], s56 offen sc1
    v_permlane32_swap_b32 v52, v53
    v_permlane32_swap_b32 v54, v55
    v_add_f32 v52, v52, v53
    v_add_f32 v54, v54, v55
    v_cvt_pk_bf16_f32 v52, v52, v54
    buffer_store_dword v52, v7, s[8:11], s55 offen sc1
    s_add_u32 s27, s44, 1
    s_and_b32 s27, s27, 3
    s_mul_i32 s48, s27, 5120
    s_add_u32 s48, s48, s41
    s_lshl_b32 s27, s27, 15
    s_add_u32 s49, s27, s47
    v_add_u32 v10, 10240, v0
    v_add_u32 v11, 20864, v3
    v_cndmask_b32_e64 v10, v10, v11, s[42:43]
    ds_read_b128 v[72:75], v10 offset:0
    v_add_u32 v10, 11264, v0
    v_add_u32 v11, 20928, v3
    v_cndmask_b32_e64 v10, v10, v11, s[42:43]
    ds_read_b128 v[76:79], v10 offset:0
    s_lshl_b32 s4, s44, 18
    s_add_u32 s4, s4, s53
    ds_read_b128 v[56:59], v5 offset:0
    ds_read_b128 v[60:63], v5 offset:1024
    ds_read_b128 v[64:67], v5 offset:2048
    ds_read_b128 v[68:71], v5 offset:3072
    v_mov_b64 v[12:13], 0
    v_mov_b64 v[14:15], 0
    v_mov_b64 v[16:17], 0
    v_mov_b64 v[18:19], 0
    v_mov_b64 v[20:21], 0
    v_mov_b64 v[22:23], 0
    v_mov_b64 v[24:25], 0
    v_mov_b64 v[26:27], 0
    v_mov_b64 v[28:29], 0
    v_mov_b64 v[30:31], 0
    v_mov_b64 v[32:33], 0
    v_mov_b64 v[34:35], 0
    s_barrier
    s_and_b32 s26, s44, 63
    s_add_u32 s26, s26, 2
    s_min_u32 s26, s26, 63
    s_lshl_b32 s26, s26, 18
    s_add_u32 s26, s26, s50
    s_add_u32 s26, s26, 6144
    s_add_u32 s3, s26, 16777216
    s_nop 15
    s_nop 15
    s_nop 15
    s_nop 0
    s_mov_b32 m0, 13312
    s_nop 0
    buffer_load_dwordx4 v0, s[8:11], s48 offen offset:3072 sc1 lds
    s_mov_b32 m0, 17408
    s_add_u32 s59, s48, 4096
    buffer_load_dwordx4 v0, s[8:11], s59 offen offset:0 sc1 lds
    s_nop 11
    s_mov_b32 m0, 13312
    s_nop 0
    buffer_load_dwordx4 v0, s[8:11], s48 offen offset:3072 sc1 lds
    s_mov_b32 m0, 17408
    s_add_u32 s59, s48, 4096
    buffer_load_dwordx4 v0, s[8:11], s59 offen offset:0 sc1 lds
    s_nop 11
    s_mov_b32 m0, 13312
    s_nop 0
    buffer_load_dwordx4 v0, s[8:11], s48 offen offset:3072 sc1 lds
    s_mov_b32 m0, 17408
    s_add_u32 s59, s48, 4096
    buffer_load_dwordx4 v0, s[8:11], s59 offen offset:0 sc1 lds
    s_add_u32 s44, s44, 1
    s_mov_b32 s70, 0
    s_waitcnt lgkmcnt(0)
    s_branch M_c1_3_top
M_c1_3_restart:
    s_waitcnt vmcnt(0) lgkmcnt(0)
    s_nop 7
    s_barrier
    s_mov_b32 m0, 13312
    s_nop 0
    buffer_load_dwordx4 v0, s[8:11], s48 offen offset:3072 sc1 lds
    s_mov_b32 m0, 17408
    s_add_u32 s59, s48, 4096
    buffer_load_dwordx4 v0, s[8:11], s59 offen offset:0 sc1 lds
    ds_read_b128 v[56:59], v5 offset:0
    ds_read_b128 v[60:63], v5 offset:1024
    ds_read_b128 v[64:67], v5 offset:2048
    ds_read_b128 v[68:71], v5 offset:3072
    v_mov_b64 v[12:13], 0
    v_mov_b64 v[14:15], 0
    v_mov_b64 v[16:17], 0
    v_mov_b64 v[18:19], 0
    v_mov_b64 v[20:21], 0
    v_mov_b64 v[22:23], 0
    v_mov_b64 v[24:25], 0
    v_mov_b64 v[26:27], 0
    v_mov_b64 v[28:29], 0
    v_mov_b64 v[30:31], 0
    v_mov_b64 v[32:33], 0
    v_mov_b64 v[34:35], 0
    s_waitcnt vmcnt(0) lgkmcnt(0)
    s_branch M_c1_3_top
M_c1_3_zbad:
    s_cmp_eq_u32 s70, 2
    s_cbranch_scc1 M_c1_3_zok
    v_cmp_u_f32 vcc, v28, v28
    s_cbranch_vccz M_c1_3_exact
    s_cmp_eq_u32 s70, 1
    s_cbranch_scc1 M_c1_3_exact
M_c1_3_vfy0:
    s_mov_b32 s70, 1
    s_mov_b32 s30, 0
    s_waitcnt vmcnt(0) lgkmcnt(0)
    s_nop 7
M_c1_3_vfy:
    v_mov_b32 v10, 0
    s_add_u32 s59, s48, 4096
    buffer_load_dwordx4 v[36:39], v0, s[8:11], s48 offen offset:0 sc1
    buffer_load_dwordx4 v[40:43], v0, s[8:11], s48 offen offset:1024 sc1
    buffer_load_dwordx4 v[44:47], v0, s[8:11], s48 offen offset:2048 sc1
    buffer_load_dwordx4 v[48:51], v0, s[8:11], s48 offen offset:3072 sc1
    buffer_load_dwordx4 v[52:55], v0, s[8:11], s59 offen offset:0 sc1
    s_waitcnt vmcnt(4)
    v_max3_u32 v10, v10, v36, v37
    v_max3_u32 v10, v10, v38, v39
    s_waitcnt vmcnt(3)
    v_max3_u32 v10, v10, v40, v41
    v_max3_u32 v10, v10, v42, v43
    s_waitcnt vmcnt(2)
    v_max3_u32 v10, v10, v44, v45
    v_max3_u32 v10, v10, v46, v47
    s_waitcnt vmcnt(1)
    v_max3_u32 v10, v10, v48, v49
    v_max3_u32 v10, v10, v50, v51
    s_waitcnt vmcnt(0)
    v_max3_u32 v10, v10, v52, v53
    v_max3_u32 v10, v10, v54, v55
    s_add_u32 s59, s49, 4096
    buffer_load_dwordx4 v[36:39], v0, s[8:11], s49 offen offset:0 sc1
    buffer_load_dwordx4 v[40:43], v0, s[8:11], s49 offen offset:1024 sc1
    buffer_load_dwordx4 v[44:47], v0, s[8:11], s49 offen offset:2048 sc1
    buffer_load_dwordx4 v[48:51], v0, s[8:11], s49 offen offset:3072 sc1
    buffer_load_dwordx4 v[52:55], v0, s[8:11], s59 offen offset:0 sc1
    s_waitcnt vmcnt(4)
    v_max3_u32 v10, v10, v36, v37
    v_max3_u32 v10, v10, v38, v39
    s_waitcnt vmcnt(3)
    v_max3_u32 v10, v10, v40, v41
    v_max3_u32 v10, v10, v42, v43
    s_waitcnt vmcnt(2)
    v_max3_u32 v10, v10, v44, v45
    v_max3_u32 v10, v10, v46, v47
    s_waitcnt vmcnt(1)
    v_max3_u32 v10, v10, v48, v49
    v_max3_u32 v10, v10, v50, v51
    s_waitcnt vmcnt(0)
    v_max3_u32 v10, v10, v52, v53
    v_max3_u32 v10, v10, v54, v55
    v_cmp_eq_u32 vcc, -1, v10
    s_cbranch_vccz M_c1_3_restart
    s_add_u32 s30, s30, 1
    s_cmp_ge_u32 s30, 60000
    s_cbranch_scc1 M_fail
    s_branch M_c1_3_vfy
M_c1_3_exact:
    s_nop 7
    s_mov_b32 s70, 2
    s_waitcnt lgkmcnt(0)
    ds_read_b128 v[20:23], v3 offset:18432
    ds_read_b128 v[24:27], v3 offset:18496
    ds_read_b128 v[28:31], v3 offset:18560
    ds_read_b128 v[32:35], v3 offset:18624
    ds_read_b128 v[56:59], v0 offset:0
    s_waitcnt lgkmcnt(0)
    v_mfma_f32_16x16x32_bf16 v[36:39], v[56:59], v[20:23], 0
    s_nop 3
    ds_read_b128 v[60:63], v0 offset:1024
    s_waitcnt lgkmcnt(0)
    v_mfma_f32_16x16x32_bf16 v[36:39], v[60:63], v[24:27], v[36:39]
    s_nop 3
    ds_read_b128 v[56:59], v0 offset:2048
    s_waitcnt lgkmcnt(0)
    v_mfma_f32_16x16x32_bf16 v[36:39], v[56:59], v[28:31], v[36:39]
    s_nop 3
    ds_read_b128 v[60:63], v0 offset:3072
    s_waitcnt lgkmcnt(0)
    v_mfma_f32_16x16x32_bf16 v[36:39], v[60:63], v[32:35], v[36:39]
    s_nop 3
    ds_read_b128 v[56:59], v0 offset:4096
    s_waitcnt lgkmcnt(0)
    v_mfma_f32_16x16x32_bf16 v[40:43], v[56:59], v[20:23], 0
    s_nop 3
    ds_read_b128 v[60:63], v0 offset:5120
    s_waitcnt lgkmcnt(0)
    v_mfma_f32_16x16x32_bf16 v[40:43], v[60:63], v[24:27], v[40:43]
    s_nop 3
    ds_read_b128 v[56:59], v0 offset:6144
    s_waitcnt lgkmcnt(0)
    v_mfma_f32_16x16x32_bf16 v[40:43], v[56:59], v[28:31], v[40:43]
    s_nop 3
    ds_read_b128 v[60:63], v0 offset:7168
    s_waitcnt lgkmcnt(0)
    v_mfma_f32_16x16x32_bf16 v[40:43], v[60:63], v[32:35], v[40:43]
    s_nop 3
    ds_read_b128 v[56:59], v3 offset:20736
    s_waitcnt lgkmcnt(0)
    v_mfma_f32_16x16x32_bf16 v[48:51], v[56:59], v[20:23], 0
    s_nop 3
    ds_read_b128 v[60:63], v3 offset:20800
    s_waitcnt lgkmcnt(0)
    v_mfma_f32_16x16x32_bf16 v[48:51], v[60:63], v[24:27], v[48:51]
    s_nop 3
    ds_read_b128 v[56:59], v3 offset:20864
    s_waitcnt lgkmcnt(0)
    v_mfma_f32_16x16x32_bf16 v[48:51], v[56:59], v[28:31], v[48:51]
    s_nop 3
    ds_read_b128 v[60:63], v3 offset:20928
    s_waitcnt lgkmcnt(0)
    v_mfma_f32_16x16x32_bf16 v[48:51], v[60:63], v[32:35], v[48:51]
    s_nop 3
    v_max3_f32 v64, v36, v37, v38
    v_max3_f32 v64, v64, v39, v40
    v_max3_f32 v64, v64, v41, v42
    s_nop 0
    v_max3_f32 v64, v64, v43, v48
    v_max3_f32 v64, v64, v49, v50
    v_max_f32 v64, v64, v51
    v_mov_b32 v65, v64
    s_nop 1
    v_permlane16_swap_b32 v64, v65
    v_max_f32 v64, v64, v65
    v_mov_b32 v65, v64
    s_nop 1
    v_permlane32_swap_b32 v64, v65
    v_max_f32 v64, v64, v65
    v_sub_f32 v36, v36, v64
    v_exp_f32 v36, v36
    v_sub_f32 v37, v37, v64
    v_exp_f32 v37, v37
    v_sub_f32 v38, v38, v64
    v_exp_f32 v38, v38
    v_sub_f32 v39, v39, v64
    v_exp_f32 v39, v39
    v_sub_f32 v40, v40, v64
    v_exp_f32 v40, v40
    v_sub_f32 v41, v41, v64
    v_exp_f32 v41, v41
    v_sub_f32 v42, v42, v64
    v_exp_f32 v42, v42
    v_sub_f32 v43, v43, v64
    v_exp_f32 v43, v43
    v_sub_f32 v48, v48, v64
    v_exp_f32 v48, v48
    v_sub_f32 v49, v49, v64
    v_exp_f32 v49, v49
    v_sub_f32 v50, v50, v64
    v_exp_f32 v50, v50
    v_sub_f32 v51, v51, v64
    v_exp_f32 v51, v51
    v_cvt_pk_bf16_f32 v36, v36, v37
    v_cvt_pk_bf16_f32 v37, v38, v39
    v_cvt_pk_bf16_f32 v38, v40, v41
    v_cvt_pk_bf16_f32 v39, v42, v43
    v_cvt_pk_bf16_f32 v48, v48, v49
    v_cvt_pk_bf16_f32 v49, v50, v51
    v_mfma_f32_16x16x32_bf16 v[20:23], v[80:83], v[36:39], 0
    v_mfma_f32_16x16x32_bf16 v[24:27], v[84:87], v[36:39], 0
    v_mfma_f32_16x16x32_bf16 v[28:31], v[72:75], v[36:39], 0
    ds_read_b128 v[68:71], v3 offset:20928
    s_waitcnt lgkmcnt(0)
    s_nop 7
    s_branch M_c1_3_fin
M_c1_3_last:
    s_cmp_lg_u32 s70, 0
    s_cbranch_scc1 M_c1_3_last2
    v_cmp_u_f32 vcc, v40, v40
    s_cbranch_vccnz M_c1_3_vfy0
M_c1_3_last2:
    s_waitcnt vmcnt(0) lgkmcnt(0)
    s_barrier
    s_nop 7
    v_add_u32 v10, 10240, v0
    v_add_u32 v11, 20864, v3
    v_cndmask_b32_e64 v10, v10, v11, s[42:43]
    ds_read_b128 v[72:75], v10 offset:0
    v_add_u32 v10, 11264, v0
    v_add_u32 v11, 20928, v3
    v_cndmask_b32_e64 v10, v10, v11, s[42:43]
    ds_read_b128 v[76:79], v10 offset:0
    s_lshl_b32 s4, s44, 18
    s_add_u32 s4, s4, s53
    s_waitcnt lgkmcnt(1)
    buffer_store_dwordx4 v[72:75], v0, s[8:11], s4 offen offset:2048 sc1
    s_waitcnt lgkmcnt(0)
    buffer_store_dwordx4 v[76:79], v0, s[8:11], s4 offen offset:3072 sc1
    s_mov_b32 s4, 0x10000000
    s_waitcnt vmcnt(0)
    s_barrier
    s_nop 7
    v_mov_b64 v[72:73], -1
    v_mov_b64 v[74:75], -1
    s_add_u32 s28, s44, 3
    s_and_b32 s29, s28, 3
    s_mul_i32 s31, s22, 160
    s_waitcnt vmcnt(0)
    s_add_u32 s44, s44, 1
    s_cmp_eq_u32 s44, 128
    s_cbranch_scc1 M_end
    s_branch M_c1_3_layer
M_c1_3_lr:
    s_mov_b32 s30, 0
M_c1_3_lr_l:
    s_waitcnt lgkmcnt(0)
    s_and_b32 s27, s30, 1
    s_cbranch_scc0 M_c1_3_lr_n
    s_waitcnt vmcnt(2)
    s_mov_b32 m0, 13312
    s_nop 0
    buffer_load_dwordx4 v0, s[8:11], s48 offen offset:3072 sc1 lds
    s_mov_b32 m0, 17408
    s_add_u32 s59, s48, 4096
    buffer_load_dwordx4 v0, s[8:11], s59 offen offset:0 sc1 lds
M_c1_3_lr_n:
    ds_read_b128 v[36:39], v6 offset:13312
    ds_read_b128 v[40:43], v6 offset:14336
    ds_read_b128 v[44:47], v6 offset:15360
    ds_read_b128 v[48:51], v6 offset:16384
    ds_read_b128 v[52:55], v6 offset:17408
    s_waitcnt lgkmcnt(2)
    v_max3_u32 v10, v36, v40, v44
    s_waitcnt lgkmcnt(0)
    v_max3_u32 v10, v10, v48, v52
    v_cmp_eq_u32 vcc, -1, v10
    s_cbranch_vccz M_c1_3_lr_d
    s_add_u32 s30, s30, 1
    s_cmp_ge_u32 s30, 480000
    s_cbranch_scc1 M_fail
    s_branch M_c1_3_lr_l
M_c1_3_lr_d:
    ds_read_b128 v[56:59], v5 offset:0
    ds_read_b128 v[60:63], v5 offset:1024
    ds_read_b128 v[64:67], v5 offset:2048
    ds_read_b128 v[68:71], v5 offset:3072
    v_mov_b64 v[12:13], 0
    v_mov_b64 v[14:15], 0
    v_mov_b64 v[16:17], 0
    v_mov_b64 v[18:19], 0
    v_mov_b64 v[20:21], 0
    v_mov_b64 v[22:23], 0
    v_mov_b64 v[24:25], 0
    v_mov_b64 v[26:27], 0
    v_mov_b64 v[28:29], 0
    v_mov_b64 v[30:31], 0
    v_mov_b64 v[32:33], 0
    v_mov_b64 v[34:35], 0
    s_waitcnt lgkmcnt(0)
    s_branch M_c1_3_lr_r
M_c1_3_rr:
    s_mov_b32 s30, 0
M_c1_3_rr_l:
    s_waitcnt lgkmcnt(0)
    s_and_b32 s27, s30, 1
    s_cbranch_scc1 M_c1_3_rr_n
    s_waitcnt vmcnt(1)
    s_mov_b32 m0, 12288
    s_add_u32 s59, s49, 4096
    buffer_load_dwordx4 v0, s[8:11], s59 offen offset:0 sc1 lds
M_c1_3_rr_n:
    ds_read_b128 v[36:39], v6 offset:8192
    ds_read_b128 v[40:43], v6 offset:9216
    ds_read_b128 v[44:47], v6 offset:10240
    ds_read_b128 v[48:51], v6 offset:11264
    ds_read_b32 v11, v6 offset:12288
    s_waitcnt lgkmcnt(2)
    v_max3_u32 v10, v36, v40, v44
    s_waitcnt lgkmcnt(0)
    v_max3_u32 v10, v10, v48, v11
    v_cmp_eq_u32 vcc, -1, v10
    s_cbranch_vccz M_c1_3_rr_d
    s_add_u32 s30, s30, 1
    s_cmp_ge_u32 s30, 480000
    s_cbranch_scc1 M_fail
    s_branch M_c1_3_rr_l
M_c1_3_rr_d:
    s_branch M_c1_3_rr_r
M_bulk:
    s_waitcnt vmcnt(0)
    s_barrier
    s_mul_i32 s42, s21, 10240
    s_mul_i32 s47, s101, 3145728
    s_add_u32 s47, s47, s42
    s_add_u32 s47, s47, 29360128
    s_mul_i32 s50, s101, 33554432
    s_lshl_b32 s27, s22, 13
    s_add_u32 s50, s50, s27
    s_add_u32 s50, s50, 37748736
    s_lshl_b32 s43, s101, 6
    s_cmp_ge_u32 s20, 4
    s_cbranch_scc1 M_qao
    s_sub_u32 s27, s20, 2
    s_mul_i32 s28, s27, 16777216
    s_add_u32 s50, s50, s28
    s_add_u32 s28, s27, 10
    s_lshl_b32 s28, s21, s28
    s_add_u32 s50, s50, s28
    s_lshl_b32 s51, s27, 7
    s_lshl_b32 s28, s22, 8
    s_add_u32 s51, s51, s28
    s_add_u32 s51, s51, 167886848
    s_mov_b32 s44, 0
    s_mov_b32 s45, 0
    s_cmp_lg_u32 s21, 0
    s_cbranch_scc1 M_kx_1
    v_lshlrev_b32 v190, 3, v0
    s_mov_b64 exec, 3
    s_mov_b32 s30, 0
    s_lshl_b32 s27, s101, 13
    s_add_u32 s27, s27, 167936000
M_kx_2:
    buffer_load_dwordx4 v[176:179], v190, s[8:11], s27 offen sc1
    buffer_load_dwordx4 v[180:183], v190, s[8:11], s27 offen offset:16 sc1
    buffer_load_dwordx2 v[184:185], v190, s[8:11], s27 offen offset:32 sc1
    s_add_u32 s30, s30, 1
    s_cmp_ge_u32 s30, 60000
    s_cbranch_scc1 M_fail
    s_waitcnt vmcnt(0)
    v_min3_u32 v176, v176, v177, v178
    v_min3_u32 v176, v176, v179, v180
    v_min3_u32 v176, v176, v181, v182
    v_min3_u32 v176, v176, v183, v184
    v_min_u32 v176, v176, v185
    v_cmp_eq_u32 vcc, 0, v176
    s_cbranch_vccnz M_kx_2
    s_mov_b64 exec, -1
M_kx_1:
    s_barrier
M_kx_3:
    s_min_u32 s27, s44, 63
    s_mul_i32 s27, s27, 40960
    s_add_u32 s27, s27, s47
    s_add_u32 s28, s45, s42
    s_mov_b32 m0, s28
    s_nop 0
    buffer_load_dwordx4 v0, s[8:11], s27 offen offset:0 sc1 lds
    buffer_load_dwordx4 v0, s[8:11], s27 offen offset:1024 sc1 lds
    buffer_load_dwordx4 v0, s[8:11], s27 offen offset:2048 sc1 lds
    buffer_load_dwordx4 v0, s[8:11], s27 offen offset:3072 sc1 lds
    s_add_u32 s27, s27, 4096
    s_add_u32 s28, s28, 4096
    s_mov_b32 m0, s28
    s_nop 0
    buffer_load_dwordx4 v0, s[8:11], s27 offen offset:0 sc1 lds
    buffer_load_dwordx4 v0, s[8:11], s27 offen offset:1024 sc1 lds
    buffer_load_dwordx4 v0, s[8:11], s27 offen offset:2048 sc1 lds
    buffer_load_dwordx4 v0, s[8:11], s27 offen offset:3072 sc1 lds
    s_add_u32 s27, s27, 4096
    s_add_u32 s28, s28, 4096
    s_mov_b32 m0, s28
    s_nop 0
    buffer_load_dwordx4 v0, s[8:11], s27 offen offset:0 sc1 lds
    buffer_load_dwordx4 v0, s[8:11], s27 offen offset:1024 sc1 lds
    s_waitcnt vmcnt(0)
    s_barrier
M_kv_top:
    v_add_u32 v1, s45, v0
    s_sub_u32 s45, 40960, s45
    s_add_u32 s44, s44, 1
    s_min_u32 s27, s44, 63
    s_mul_i32 s27, s27, 40960
    s_add_u32 s27, s27, s47
    s_add_u32 s28, s45, s42
    s_mov_b32 m0, s28
    s_nop 0
    buffer_load_dwordx4 v0, s[8:11], s27 offen offset:0 sc1 lds
    buffer_load_dwordx4 v0, s[8:11], s27 offen offset:1024 sc1 lds
    buffer_load_dwordx4 v0, s[8:11], s27 offen offset:2048 sc1 lds
    buffer_load_dwordx4 v0, s[8:11], s27 offen offset:3072 sc1 lds
    s_add_u32 s27, s27, 4096
    s_add_u32 s28, s28, 4096
    s_mov_b32 m0, s28
    s_nop 0
    buffer_load_dwordx4 v0, s[8:11], s27 offen offset:0 sc1 lds
    buffer_load_dwordx4 v0, s[8:11], s27 offen offset:1024 sc1 lds
    buffer_load_dwordx4 v0, s[8:11], s27 offen offset:2048 sc1 lds
    buffer_load_dwordx4 v0, s[8:11], s27 offen offset:3072 sc1 lds
    s_add_u32 s27, s27, 4096
    s_add_u32 s28, s28, 4096
    s_mov_b32 m0, s28
    s_nop 0
    buffer_load_dwordx4 v0, s[8:11], s27 offen offset:0 sc1 lds
    buffer_load_dwordx4 v0, s[8:11], s27 offen offset:1024 sc1 lds
    s_cmp_eq_u32 s20, 3
    s_cbranch_scc1 M_kv_v
    ds_read_b128 v[32:35], v1 offset:0
    ds_read_b128 v[36:39], v1 offset:1024
    ds_read_b128 v[40:43], v1 offset:2048
    ds_read_b128 v[44:47], v1 offset:3072
    ds_read_b128 v[48:51], v1 offset:4096
    ds_read_b128 v[52:55], v1 offset:5120
    s_waitcnt lgkmcnt(5)
    v_mfma_f32_16x16x32_bf16 v[8:11], a[0:3], v[32:35], 0
    v_mfma_f32_16x16x32_bf16 v[12:15], a[80:83], v[32:35], 0
    ds_read_b128 v[32:35], v1 offset:6144
    s_waitcnt lgkmcnt(5)
    v_mfma_f32_16x16x32_bf16 v[8:11], a[4:7], v[36:39], v[8:11]
    v_mfma_f32_16x16x32_bf16 v[12:15], a[84:87], v[36:39], v[12:15]
    ds_read_b128 v[36:39], v1 offset:7168
    s_waitcnt lgkmcnt(5)
    v_mfma_f32_16x16x32_bf16 v[8:11], a[8:11], v[40:43], v[8:11]
    v_mfma_f32_16x16x32_bf16 v[12:15], a[88:91], v[40:43], v[12:15]
    ds_read_b128 v[40:43], v1 offset:8192
    s_waitcnt lgkmcnt(5)
    v_mfma_f32_16x16x32_bf16 v[8:11], a[12:15], v[44:47], v[8:11]
    v_mfma_f32_16x16x32_bf16 v[12:15], a[92:95], v[44:47], v[12:15]
    ds_read_b128 v[44:47], v1 offset:9216
    s_waitcnt lgkmcnt(5)
    v_mfma_f32_16x16x32_bf16 v[8:11], a[16:19], v[48:51], v[8:11]
    v_mfma_f32_16x16x32_bf16 v[12:15], a[96:99], v[48:51], v[12:15]
    ds_read_b128 v[48:51], v1 offset:10240
    s_waitcnt lgkmcnt(5)
    v_mfma_f32_16x16x32_bf16 v[8:11], a[20:23], v[52:55], v[8:11]
    v_mfma_f32_16x16x32_bf16 v[12:15], a[100:103], v[52:55], v[12:15]
    ds_read_b128 v[52:55], v1 offset:11264
    s_waitcnt lgkmcnt(5)
    v_mfma_f32_16x16x32_bf16 v[8:11], a[24:27], v[32:35], v[8:11]
    v_mfma_f32_16x16x32_bf16 v[12:15], a[104:107], v[32:35], v[12:15]
    ds_read_b128 v[32:35], v1 offset:12288
    s_waitcnt lgkmcnt(5)
    v_mfma_f32_16x16x32_bf16 v[8:11], a[28:31], v[36:39], v[8:11]
    v_mfma_f32_16x16x32_bf16 v[12:15], a[108:111], v[36:39], v[12:15]
    ds_read_b128 v[36:39], v1 offset:13312
    s_waitcnt lgkmcnt(5)
    v_mfma_f32_16x16x32_bf16 v[8:11], a[32:35], v[40:43], v[8:11]
    v_mfma_f32_16x16x32_bf16 v[12:15], a[112:115], v[40:43], v[12:15]
    ds_read_b128 v[40:43], v1 offset:14336
    s_waitcnt lgkmcnt(5)
    v_mfma_f32_16x16x32_bf16 v[8:11], a[36:39], v[44:47], v[8:11]
    v_mfma_f32_16x16x32_bf16 v[12:15], a[116:119], v[44:47], v[12:15]
    ds_read_b128 v[44:47], v1 offset:15360
    s_waitcnt lgkmcnt(5)
    v_mfma_f32_16x16x32_bf16 v[8:11], a[40:43], v[48:51], v[8:11]
    v_mfma_f32_16x16x32_bf16 v[12:15], a[120:123], v[48:51], v[12:15]
    ds_read_b128 v[48:51], v1 offset:16384
    s_waitcnt lgkmcnt(5)
    v_mfma_f32_16x16x32_bf16 v[8:11], a[44:47], v[52:55], v[8:11]
    v_mfma_f32_16x16x32_bf16 v[12:15], a[124:127], v[52:55], v[12:15]
    ds_read_b128 v[52:55], v1 offset:17408
    s_waitcnt lgkmcnt(5)
    v_mfma_f32_16x16x32_bf16 v[8:11], a[48:51], v[32:35], v[8:11]
    v_mfma_f32_16x16x32_bf16 v[12:15], a[128:131], v[32:35], v[12:15]
    ds_read_b128 v[32:35], v1 offset:18432
    s_waitcnt lgkmcnt(5)
    v_mfma_f32_16x16x32_bf16 v[8:11], a[52:55], v[36:39], v[8:11]
    v_mfma_f32_16x16x32_bf16 v[12:15], a[132:135], v[36:39], v[12:15]
    ds_read_b128 v[36:39], v1 offset:19456
    s_waitcnt lgkmcnt(5)
    v_mfma_f32_16x16x32_bf16 v[8:11], a[56:59], v[40:43], v[8:11]
    v_mfma_f32_16x16x32_bf16 v[12:15], a[136:139], v[40:43], v[12:15]
    ds_read_b128 v[40:43], v1 offset:20480
    s_waitcnt lgkmcnt(5)
    v_mfma_f32_16x16x32_bf16 v[8:11], a[60:63], v[44:47], v[8:11]
    v_mfma_f32_16x16x32_bf16 v[12:15], a[140:143], v[44:47], v[12:15]
    ds_read_b128 v[44:47], v1 offset:21504
    s_waitcnt lgkmcnt(5)
    v_mfma_f32_16x16x32_bf16 v[8:11], a[64:67], v[48:51], v[8:11]
    v_mfma_f32_16x16x32_bf16 v[12:15], a[144:147], v[48:51], v[12:15]
    ds_read_b128 v[48:51], v1 offset:22528
    s_waitcnt lgkmcnt(5)
    v_mfma_f32_16x16x32_bf16 v[8:11], a[68:71], v[52:55], v[8:11]
    v_mfma_f32_16x16x32_bf16 v[12:15], a[148:151], v[52:55], v[12:15]
    ds_read_b128 v[52:55], v1 offset:23552
    s_waitcnt lgkmcnt(5)
    v_mfma_f32_16x16x32_bf16 v[8:11], a[72:75], v[32:35], v[8:11]
    v_mfma_f32_16x16x32_bf16 v[12:15], a[152:155], v[32:35], v[12:15]
    ds_read_b128 v[32:35], v1 offset:24576
    s_waitcnt lgkmcnt(5)
    v_mfma_f32_16x16x32_bf16 v[8:11], a[76:79], v[36:39], v[8:11]
    v_mfma_f32_16x16x32_bf16 v[12:15], a[156:159], v[36:39], v[12:15]
    ds_read_b128 v[36:39], v1 offset:25600
    s_waitcnt lgkmcnt(5)
    v_mfma_f32_16x16x32_bf16 v[16:19], a[0:3], v[40:43], 0
    v_mfma_f32_16x16x32_bf16 v[20:23], a[80:83], v[40:43], 0
    ds_read_b128 v[40:43], v1 offset:26624
    s_waitcnt lgkmcnt(5)
    v_mfma_f32_16x16x32_bf16 v[16:19], a[4:7], v[44:47], v[16:19]
    v_mfma_f32_16x16x32_bf16 v[20:23], a[84:87], v[44:47], v[20:23]
    ds_read_b128 v[44:47], v1 offset:27648
    s_waitcnt lgkmcnt(5)
    v_mfma_f32_16x16x32_bf16 v[16:19], a[8:11], v[48:51], v[16:19]
    v_mfma_f32_16x16x32_bf16 v[20:23], a[88:91], v[48:51], v[20:23]
    ds_read_b128 v[48:51], v1 offset:28672
    s_waitcnt lgkmcnt(5)
    v_mfma_f32_16x16x32_bf16 v[16:19], a[12:15], v[52:55], v[16:19]
    v_mfma_f32_16x16x32_bf16 v[20:23], a[92:95], v[52:55], v[20:23]
    ds_read_b128 v[52:55], v1 offset:29696
    s_waitcnt lgkmcnt(5)
    v_mfma_f32_16x16x32_bf16 v[16:19], a[16:19], v[32:35], v[16:19]
    v_mfma_f32_16x16x32_bf16 v[20:23], a[96:99], v[32:35], v[20:23]
    ds_read_b128 v[32:35], v1 offset:30720
    s_waitcnt lgkmcnt(5)
    v_mfma_f32_16x16x32_bf16 v[16:19], a[20:23], v[36:39], v[16:19]
    v_mfma_f32_16x16x32_bf16 v[20:23], a[100:103], v[36:39], v[20:23]
    ds_read_b128 v[36:39], v1 offset:31744
    s_waitcnt lgkmcnt(5)
    v_mfma_f32_16x16x32_bf16 v[16:19], a[24:27], v[40:43], v[16:19]
    v_mfma_f32_16x16x32_bf16 v[20:23], a[104:107], v[40:43], v[20:23]
    ds_read_b128 v[40:43], v1 offset:32768
    s_waitcnt lgkmcnt(5)
    v_mfma_f32_16x16x32_bf16 v[16:19], a[28:31], v[44:47], v[16:19]
    v_mfma_f32_16x16x32_bf16 v[20:23], a[108:111], v[44:47], v[20:23]
    ds_read_b128 v[44:47], v1 offset:33792
    s_waitcnt lgkmcnt(5)
    v_mfma_f32_16x16x32_bf16 v[16:19], a[32:35], v[48:51], v[16:19]
    v_mfma_f32_16x16x32_bf16 v[20:23], a[112:115], v[48:51], v[20:23]
    ds_read_b128 v[48:51], v1 offset:34816
    s_waitcnt lgkmcnt(5)
    v_mfma_f32_16x16x32_bf16 v[16:19], a[36:39], v[52:55], v[16:19]
    v_mfma_f32_16x16x32_bf16 v[20:23], a[116:119], v[52:55], v[20:23]
    ds_read_b128 v[52:55], v1 offset:35840
    s_waitcnt lgkmcnt(5)
    v_mfma_f32_16x16x32_bf16 v[16:19], a[40:43], v[32:35], v[16:19]
    v_mfma_f32_16x16x32_bf16 v[20:23], a[120:123], v[32:35], v[20:23]
    ds_read_b128 v[32:35], v1 offset:36864
    s_waitcnt lgkmcnt(5)
    v_mfma_f32_16x16x32_bf16 v[16:19], a[44:47], v[36:39], v[16:19]
    v_mfma_f32_16x16x32_bf16 v[20:23], a[124:127], v[36:39], v[20:23]
    ds_read_b128 v[36:39], v1 offset:37888
    s_waitcnt lgkmcnt(5)
    v_mfma_f32_16x16x32_bf16 v[16:19], a[48:51], v[40:43], v[16:19]
    v_mfma_f32_16x16x32_bf16 v[20:23], a[128:131], v[40:43], v[20:23]
    ds_read_b128 v[40:43], v1 offset:38912
    s_waitcnt lgkmcnt(5)
    v_mfma_f32_16x16x32_bf16 v[16:19], a[52:55], v[44:47], v[16:19]
    v_mfma_f32_16x16x32_bf16 v[20:23], a[132:135], v[44:47], v[20:23]
    ds_read_b128 v[44:47], v1 offset:39936
    s_waitcnt lgkmcnt(5)
    v_mfma_f32_16x16x32_bf16 v[16:19], a[56:59], v[48:51], v[16:19]
    v_mfma_f32_16x16x32_bf16 v[20:23], a[136:139], v[48:51], v[20:23]
    s_waitcnt lgkmcnt(4)
    v_mfma_f32_16x16x32_bf16 v[16:19], a[60:63], v[52:55], v[16:19]
    v_mfma_f32_16x16x32_bf16 v[20:23], a[140:143], v[52:55], v[20:23]
    s_waitcnt lgkmcnt(3)
    v_mfma_f32_16x16x32_bf16 v[16:19], a[64:67], v[32:35], v[16:19]
    v_mfma_f32_16x16x32_bf16 v[20:23], a[144:147], v[32:35], v[20:23]
    s_waitcnt lgkmcnt(2)
    v_mfma_f32_16x16x32_bf16 v[16:19], a[68:71], v[36:39], v[16:19]
    v_mfma_f32_16x16x32_bf16 v[20:23], a[148:151], v[36:39], v[20:23]
    s_waitcnt lgkmcnt(1)
    v_mfma_f32_16x16x32_bf16 v[16:19], a[72:75], v[40:43], v[16:19]
    v_mfma_f32_16x16x32_bf16 v[20:23], a[152:155], v[40:43], v[20:23]
    s_waitcnt lgkmcnt(0)
    v_mfma_f32_16x16x32_bf16 v[16:19], a[76:79], v[44:47], v[16:19]
    v_mfma_f32_16x16x32_bf16 v[20:23], a[156:159], v[44:47], v[20:23]
    s_add_u32 s27, s50, 4096
    v_cvt_pk_bf16_f32 v24, v8, v12
    v_cvt_pk_bf16_f32 v25, v9, v13
    v_cvt_pk_bf16_f32 v26, v10, v14
    v_cvt_pk_bf16_f32 v27, v11, v15
    buffer_store_dwordx4 v[24:27], v0, s[8:11], s50 offen sc1
    s_nop 1
    v_cvt_pk_bf16_f32 v28, v16, v20
    v_cvt_pk_bf16_f32 v29, v17, v21
    v_cvt_pk_bf16_f32 v30, v18, v22
    v_cvt_pk_bf16_f32 v31, v19, v23
    buffer_store_dwordx4 v[28:31], v0, s[8:11], s27 offen sc1
    s_branch M_kv_c
M_kv_v:
    ds_read_b128 v[32:35], v1 offset:0
    ds_read_b128 v[36:39], v1 offset:1024
    ds_read_b128 v[40:43], v1 offset:2048
    ds_read_b128 v[44:47], v1 offset:3072
    ds_read_b128 v[48:51], v1 offset:4096
    ds_read_b128 v[52:55], v1 offset:5120
    s_waitcnt lgkmcnt(5)
    v_mfma_f32_16x16x32_bf16 v[8:11], v[32:35], a[0:3], 0
    v_mfma_f32_16x16x32_bf16 v[12:15], v[32:35], a[80:83], 0
    ds_read_b128 v[32:35], v1 offset:6144
    s_waitcnt lgkmcnt(5)
    v_mfma_f32_16x16x32_bf16 v[8:11], v[36:39], a[4:7], v[8:11]
    v_mfma_f32_16x16x32_bf16 v[12:15], v[36:39], a[84:87], v[12:15]
    ds_read_b128 v[36:39], v1 offset:7168
    s_waitcnt lgkmcnt(5)
    v_mfma_f32_16x16x32_bf16 v[8:11], v[40:43], a[8:11], v[8:11]
    v_mfma_f32_16x16x32_bf16 v[12:15], v[40:43], a[88:91], v[12:15]
    ds_read_b128 v[40:43], v1 offset:8192
    s_waitcnt lgkmcnt(5)
    v_mfma_f32_16x16x32_bf16 v[8:11], v[44:47], a[12:15], v[8:11]
    v_mfma_f32_16x16x32_bf16 v[12:15], v[44:47], a[92:95], v[12:15]
    ds_read_b128 v[44:47], v1 offset:9216
    s_waitcnt lgkmcnt(5)
    v_mfma_f32_16x16x32_bf16 v[8:11], v[48:51], a[16:19], v[8:11]
    v_mfma_f32_16x16x32_bf16 v[12:15], v[48:51], a[96:99], v[12:15]
    ds_read_b128 v[48:51], v1 offset:10240
    s_waitcnt lgkmcnt(5)
    v_mfma_f32_16x16x32_bf16 v[8:11], v[52:55], a[20:23], v[8:11]
    v_mfma_f32_16x16x32_bf16 v[12:15], v[52:55], a[100:103], v[12:15]
    ds_read_b128 v[52:55], v1 offset:11264
    s_waitcnt lgkmcnt(5)
    v_mfma_f32_16x16x32_bf16 v[8:11], v[32:35], a[24:27], v[8:11]
    v_mfma_f32_16x16x32_bf16 v[12:15], v[32:35], a[104:107], v[12:15]
    ds_read_b128 v[32:35], v1 offset:12288
    s_waitcnt lgkmcnt(5)
    v_mfma_f32_16x16x32_bf16 v[8:11], v[36:39], a[28:31], v[8:11]
    v_mfma_f32_16x16x32_bf16 v[12:15], v[36:39], a[108:111], v[12:15]
    ds_read_b128 v[36:39], v1 offset:13312
    s_waitcnt lgkmcnt(5)
    v_mfma_f32_16x16x32_bf16 v[8:11], v[40:43], a[32:35], v[8:11]
    v_mfma_f32_16x16x32_bf16 v[12:15], v[40:43], a[112:115], v[12:15]
    ds_read_b128 v[40:43], v1 offset:14336
    s_waitcnt lgkmcnt(5)
    v_mfma_f32_16x16x32_bf16 v[8:11], v[44:47], a[36:39], v[8:11]
    v_mfma_f32_16x16x32_bf16 v[12:15], v[44:47], a[116:119], v[12:15]
    ds_read_b128 v[44:47], v1 offset:15360
    s_waitcnt lgkmcnt(5)
    v_mfma_f32_16x16x32_bf16 v[8:11], v[48:51], a[40:43], v[8:11]
    v_mfma_f32_16x16x32_bf16 v[12:15], v[48:51], a[120:123], v[12:15]
    ds_read_b128 v[48:51], v1 offset:16384
    s_waitcnt lgkmcnt(5)
    v_mfma_f32_16x16x32_bf16 v[8:11], v[52:55], a[44:47], v[8:11]
    v_mfma_f32_16x16x32_bf16 v[12:15], v[52:55], a[124:127], v[12:15]
    ds_read_b128 v[52:55], v1 offset:17408
    s_waitcnt lgkmcnt(5)
    v_mfma_f32_16x16x32_bf16 v[8:11], v[32:35], a[48:51], v[8:11]
    v_mfma_f32_16x16x32_bf16 v[12:15], v[32:35], a[128:131], v[12:15]
    ds_read_b128 v[32:35], v1 offset:18432
    s_waitcnt lgkmcnt(5)
    v_mfma_f32_16x16x32_bf16 v[8:11], v[36:39], a[52:55], v[8:11]
    v_mfma_f32_16x16x32_bf16 v[12:15], v[36:39], a[132:135], v[12:15]
    ds_read_b128 v[36:39], v1 offset:19456
    s_waitcnt lgkmcnt(5)
    v_mfma_f32_16x16x32_bf16 v[8:11], v[40:43], a[56:59], v[8:11]
    v_mfma_f32_16x16x32_bf16 v[12:15], v[40:43], a[136:139], v[12:15]
    ds_read_b128 v[40:43], v1 offset:20480
    s_waitcnt lgkmcnt(5)
    v_mfma_f32_16x16x32_bf16 v[8:11], v[44:47], a[60:63], v[8:11]
    v_mfma_f32_16x16x32_bf16 v[12:15], v[44:47], a[140:143], v[12:15]
    ds_read_b128 v[44:47], v1 offset:21504
    s_waitcnt lgkmcnt(5)
    v_mfma_f32_16x16x32_bf16 v[8:11], v[48:51], a[64:67], v[8:11]
    v_mfma_f32_16x16x32_bf16 v[12:15], v[48:51], a[144:147], v[12:15]
    ds_read_b128 v[48:51], v1 offset:22528
    s_waitcnt lgkmcnt(5)
    v_mfma_f32_16x16x32_bf16 v[8:11], v[52:55], a[68:71], v[8:11]
    v_mfma_f32_16x16x32_bf16 v[12:15], v[52:55], a[148:151], v[12:15]
    ds_read_b128 v[52:55], v1 offset:23552
    s_waitcnt lgkmcnt(5)
    v_mfma_f32_16x16x32_bf16 v[8:11], v[32:35], a[72:75], v[8:11]
    v_mfma_f32_16x16x32_bf16 v[12:15], v[32:35], a[152:155], v[12:15]
    ds_read_b128 v[32:35], v1 offset:24576
    s_waitcnt lgkmcnt(5)
    v_mfma_f32_16x16x32_bf16 v[8:11], v[36:39], a[76:79], v[8:11]
    v_mfma_f32_16x16x32_bf16 v[12:15], v[36:39], a[156:159], v[12:15]
    ds_read_b128 v[36:39], v1 offset:25600
    s_waitcnt lgkmcnt(5)
    v_mfma_f32_16x16x32_bf16 v[16:19], v[40:43], a[0:3], 0
    v_mfma_f32_16x16x32_bf16 v[20:23], v[40:43], a[80:83], 0
    ds_read_b128 v[40:43], v1 offset:26624
    s_waitcnt lgkmcnt(5)
    v_mfma_f32_16x16x32_bf16 v[16:19], v[44:47], a[4:7], v[16:19]
    v_mfma_f32_16x16x32_bf16 v[20:23], v[44:47], a[84:87], v[20:23]
    ds_read_b128 v[44:47], v1 offset:27648
    s_waitcnt lgkmcnt(5)
    v_mfma_f32_16x16x32_bf16 v[16:19], v[48:51], a[8:11], v[16:19]
    v_mfma_f32_16x16x32_bf16 v[20:23], v[48:51], a[88:91], v[20:23]
    ds_read_b128 v[48:51], v1 offset:28672
    s_waitcnt lgkmcnt(5)
    v_mfma_f32_16x16x32_bf16 v[16:19], v[52:55], a[12:15], v[16:19]
    v_mfma_f32_16x16x32_bf16 v[20:23], v[52:55], a[92:95], v[20:23]
    ds_read_b128 v[52:55], v1 offset:29696
    s_waitcnt lgkmcnt(5)
    v_mfma_f32_16x16x32_bf16 v[16:19], v[32:35], a[16:19], v[16:19]
    v_mfma_f32_16x16x32_bf16 v[20:23], v[32:35], a[96:99], v[20:23]
    ds_read_b128 v[32:35], v1 offset:30720
    s_waitcnt lgkmcnt(5)
    v_mfma_f32_16x16x32_bf16 v[16:19], v[36:39], a[20:23], v[16:19]
    v_mfma_f32_16x16x32_bf16 v[20:23], v[36:39], a[100:103], v[20:23]
    ds_read_b128 v[36:39], v1 offset:31744
    s_waitcnt lgkmcnt(5)
    v_mfma_f32_16x16x32_bf16 v[16:19], v[40:43], a[24:27], v[16:19]
    v_mfma_f32_16x16x32_bf16 v[20:23], v[40:43], a[104:107], v[20:23]
    ds_read_b128 v[40:43], v1 offset:32768
    s_waitcnt lgkmcnt(5)
    v_mfma_f32_16x16x32_bf16 v[16:19], v[44:47], a[28:31], v[16:19]
    v_mfma_f32_16x16x32_bf16 v[20:23], v[44:47], a[108:111], v[20:23]
    ds_read_b128 v[44:47], v1 offset:33792
    s_waitcnt lgkmcnt(5)
    v_mfma_f32_16x16x32_bf16 v[16:19], v[48:51], a[32:35], v[16:19]
    v_mfma_f32_16x16x32_bf16 v[20:23], v[48:51], a[112:115], v[20:23]
    ds_read_b128 v[48:51], v1 offset:34816
    s_waitcnt lgkmcnt(5)
    v_mfma_f32_16x16x32_bf16 v[16:19], v[52:55], a[36:39], v[16:19]
    v_mfma_f32_16x16x32_bf16 v[20:23], v[52:55], a[116:119], v[20:23]
    ds_read_b128 v[52:55], v1 offset:35840
    s_waitcnt lgkmcnt(5)
    v_mfma_f32_16x16x32_bf16 v[16:19], v[32:35], a[40:43], v[16:19]
    v_mfma_f32_16x16x32_bf16 v[20:23], v[32:35], a[120:123], v[20:23]
    ds_read_b128 v[32:35], v1 offset:36864
    s_waitcnt lgkmcnt(5)
    v_mfma_f32_16x16x32_bf16 v[16:19], v[36:39], a[44:47], v[16:19]
    v_mfma_f32_16x16x32_bf16 v[20:23], v[36:39], a[124:127], v[20:23]
    ds_read_b128 v[36:39], v1 offset:37888
    s_waitcnt lgkmcnt(5)
    v_mfma_f32_16x16x32_bf16 v[16:19], v[40:43], a[48:51], v[16:19]
    v_mfma_f32_16x16x32_bf16 v[20:23], v[40:43], a[128:131], v[20:23]
    ds_read_b128 v[40:43], v1 offset:38912
    s_waitcnt lgkmcnt(5)
    v_mfma_f32_16x16x32_bf16 v[16:19], v[44:47], a[52:55], v[16:19]
    v_mfma_f32_16x16x32_bf16 v[20:23], v[44:47], a[132:135], v[20:23]
    ds_read_b128 v[44:47], v1 offset:39936
    s_waitcnt lgkmcnt(5)
    v_mfma_f32_16x16x32_bf16 v[16:19], v[48:51], a[56:59], v[16:19]
    v_mfma_f32_16x16x32_bf16 v[20:23], v[48:51], a[136:139], v[20:23]
    s_waitcnt lgkmcnt(4)
    v_mfma_f32_16x16x32_bf16 v[16:19], v[52:55], a[60:63], v[16:19]
    v_mfma_f32_16x16x32_bf16 v[20:23], v[52:55], a[140:143], v[20:23]
    s_waitcnt lgkmcnt(3)
    v_mfma_f32_16x16x32_bf16 v[16:19], v[32:35], a[64:67], v[16:19]
    v_mfma_f32_16x16x32_bf16 v[20:23], v[32:35], a[144:147], v[20:23]
    s_waitcnt lgkmcnt(2)
    v_mfma_f32_16x16x32_bf16 v[16:19], v[36:39], a[68:71], v[16:19]
    v_mfma_f32_16x16x32_bf16 v[20:23], v[36:39], a[148:151], v[20:23]
    s_waitcnt lgkmcnt(1)
    v_mfma_f32_16x16x32_bf16 v[16:19], v[40:43], a[72:75], v[16:19]
    v_mfma_f32_16x16x32_bf16 v[20:23], v[40:43], a[152:155], v[20:23]
    s_waitcnt lgkmcnt(0)
    v_mfma_f32_16x16x32_bf16 v[16:19], v[44:47], a[76:79], v[16:19]
    v_mfma_f32_16x16x32_bf16 v[20:23], v[44:47], a[156:159], v[20:23]
    v_cvt_pk_bf16_f32 v24, v8, v9
    v_cvt_pk_bf16_f32 v25, v10, v11
    s_nop 4
    v_cvt_pk_bf16_f32 v26, v16, v17
    v_cvt_pk_bf16_f32 v27, v18, v19
    buffer_store_dwordx4 v[24:27], v0, s[8:11], s50 offen offset:0 sc1
    v_cvt_pk_bf16_f32 v28, v12, v13
    v_cvt_pk_bf16_f32 v29, v14, v15
    v_cvt_pk_bf16_f32 v30, v20, v21
    v_cvt_pk_bf16_f32 v31, v22, v23
    buffer_store_dwordx4 v[28:31], v0, s[8:11], s50 offen offset:1024 sc1
M_kv_c:
    s_add_u32 s50, s50, 262144
    s_add_u32 s27, s44, s43
    v_mov_b32 v2, s27
    s_waitcnt vmcnt(0)
    s_barrier
    s_cmp_lg_u32 s21, 0
    s_cbranch_scc1 M_kv_nf
    s_mov_b64 exec, 1
    buffer_store_dword v2, v0, s[8:11], s51 offen sc1
    s_mov_b64 exec, -1
M_kv_nf:
    s_cmp_lg_u32 s44, 1
    s_cbranch_scc1 M_kv_np
    s_cmp_lg_u32 s21, 0
    s_cbranch_scc1 M_kx_4
    v_lshlrev_b32 v190, 3, v0
    s_mov_b64 exec, -1
    s_mov_b32 s30, 0
    s_lshl_b32 s27, s101, 13
    s_add_u32 s27, s27, 167936000
M_kx_5:
    buffer_load_dwordx4 v[176:179], v190, s[8:11], s27 offen sc1
    buffer_load_dwordx4 v[180:183], v190, s[8:11], s27 offen offset:16 sc1
    buffer_load_dwordx2 v[184:185], v190, s[8:11], s27 offen offset:32 sc1
    s_add_u32 s30, s30, 1
    s_cmp_ge_u32 s30, 60000
    s_cbranch_scc1 M_fail
    s_waitcnt vmcnt(0)
    v_min3_u32 v176, v176, v177, v178
    v_min3_u32 v176, v176, v179, v180
    v_min3_u32 v176, v176, v181, v182
    v_min3_u32 v176, v176, v183, v184
    v_min_u32 v176, v176, v185
    v_cmp_eq_u32 vcc, 0, v176
    s_cbranch_vccnz M_kx_5
    s_mov_b64 exec, -1
M_kx_4:
    s_barrier
M_kx_6:
M_kv_np:
    s_cmp_lt_u32 s44, 64
    s_cbranch_scc1 M_kv_top
    s_cmp_lg_u32 s101, 0
    s_cbranch_scc1 M_bphase
    s_load_dwordx2 s[72:73], s[0:1], 64
    s_load_dwordx2 s[76:77], s[0:1], 72
    v_lshrrev_b32 v1, 4, v0
    v_lshrrev_b32 v3, 8, v0
    v_and_b32 v4, 15, v1
    v_mov_b32 v5, v0
    s_sub_u32 s27, s20, 2
    s_lshl_b32 s27, s27, 5
    s_add_u32 s27, s27, s22
    s_lshl_b32 s27, s27, 2
    s_add_u32 s35, s27, s21
    s_mov_b32 s36, s35
    s_waitcnt lgkmcnt(0)
    s_and_b32 s73, s73, 0xffff
    s_mov_b32 s74, 1314816
    s_mov_b32 s75, 0x00020000
    s_and_b32 s77, s77, 0xffff
    s_mov_b32 s78, 1314816
    s_mov_b32 s79, 0x00020000
M_kv_t2:
    s_mul_hi_u32 s37, s36, 0xccccccd
    s_mul_i32 s38, s37, 20
    s_sub_u32 s38, s36, s38
    s_lshl_b32 s37, s37, 4
    s_lshl_b32 s38, s38, 5
    v_lshlrev_b32 v7, 3, v3
    v_add_u32 v7, s38, v7
    s_mov_b32 s39, 0x666667
    s_movk_i32 s40, 640
    s_and_b32 s41, s37, 16
    s_sub_u32 s37, s37, s41
    s_lshr_b32 s41, s41, 2
    s_add_u32 s37, s37, s41
    v_and_b32 v6, 12, v4
    v_add_u32 v6, v6, v4
    v_add_u32 v6, s37, v6
    v_lshrrev_b32 v8, 1, v7
    v_cmp_eq_u32 vcc, 0, v7
    v_add_u32 v11, 0, v8
    v_mov_b32 v13, 0x00000000
    v_mov_b32 v14, 0x35cccccd
    v_mov_b32 v15, 0x354ccccd
    v_cndmask_b32 v14, v14, v15, vcc
    v_mul_u32_u24 v11, v11, v6
    v_mul_hi_u32 v12, v11, s39
    v_mul_lo_u32 v12, v12, s40
    v_sub_u32 v11, v11, v12
    v_cvt_f32_u32 v11, v11
    v_fmac_f32 v13, 0x3acccccd, v11
    v_cos_f32 v13, v13
    s_nop 0
    v_mul_f32 v16, v13, v14
    v_add_u32 v11, 0, v8
    v_mov_b32 v13, 0x3e800000
    v_mov_b32 v14, 0x35cccccd
    v_mov_b32 v15, 0x354ccccd
    v_cndmask_b32 v14, v14, v15, vcc
    v_mov_b32 v15, 320
    v_cndmask_b32 v11, v11, v15, vcc
    v_mov_b32 v15, 0
    v_cndmask_b32 v13, v13, v15, vcc
    v_mul_u32_u24 v11, v11, v6
    v_mul_hi_u32 v12, v11, s39
    v_mul_lo_u32 v12, v12, s40
    v_sub_u32 v11, v11, v12
    v_cvt_f32_u32 v11, v11
    v_fmac_f32 v13, 0x3acccccd, v11
    v_cos_f32 v13, v13
    s_nop 0
    v_mul_f32 v17, v13, v14
    v_add_u32 v11, 1, v8
    v_mov_b32 v13, 0x00000000
    v_mov_b32 v14, 0x35cccccd
    v_mul_u32_u24 v11, v11, v6
    v_mul_hi_u32 v12, v11, s39
    v_mul_lo_u32 v12, v12, s40
    v_sub_u32 v11, v11, v12
    v_cvt_f32_u32 v11, v11
    v_fmac_f32 v13, 0x3acccccd, v11
    v_cos_f32 v13, v13
    s_nop 0
    v_mul_f32 v18, v13, v14
    v_add_u32 v11, 1, v8
    v_mov_b32 v13, 0x3e800000
    v_mov_b32 v14, 0x35cccccd
    v_mul_u32_u24 v11, v11, v6
    v_mul_hi_u32 v12, v11, s39
    v_mul_lo_u32 v12, v12, s40
    v_sub_u32 v11, v11, v12
    v_cvt_f32_u32 v11, v11
    v_fmac_f32 v13, 0x3acccccd, v11
    v_cos_f32 v13, v13
    s_nop 0
    v_mul_f32 v19, v13, v14
    v_add_u32 v11, 2, v8
    v_mov_b32 v13, 0x00000000
    v_mov_b32 v14, 0x35cccccd
    v_mul_u32_u24 v11, v11, v6
    v_mul_hi_u32 v12, v11, s39
    v_mul_lo_u32 v12, v12, s40
    v_sub_u32 v11, v11, v12
    v_cvt_f32_u32 v11, v11
    v_fmac_f32 v13, 0x3acccccd, v11
    v_cos_f32 v13, v13
    s_nop 0
    v_mul_f32 v20, v13, v14
    v_add_u32 v11, 2, v8
    v_mov_b32 v13, 0x3e800000
    v_mov_b32 v14, 0x35cccccd
    v_mul_u32_u24 v11, v11, v6
    v_mul_hi_u32 v12, v11, s39
    v_mul_lo_u32 v12, v12, s40
    v_sub_u32 v11, v11, v12
    v_cvt_f32_u32 v11, v11
    v_fmac_f32 v13, 0x3acccccd, v11
    v_cos_f32 v13, v13
    s_nop 0
    v_mul_f32 v21, v13, v14
    v_add_u32 v11, 3, v8
    v_mov_b32 v13, 0x00000000
    v_mov_b32 v14, 0x35cccccd
    v_mul_u32_u24 v11, v11, v6
    v_mul_hi_u32 v12, v11, s39
    v_mul_lo_u32 v12, v12, s40
    v_sub_u32 v11, v11, v12
    v_cvt_f32_u32 v11, v11
    v_fmac_f32 v13, 0x3acccccd, v11
    v_cos_f32 v13, v13
    s_nop 0
    v_mul_f32 v22, v13, v14
    v_add_u32 v11, 3, v8
    v_mov_b32 v13, 0x3e800000
    v_mov_b32 v14, 0x35cccccd
    v_mul_u32_u24 v11, v11, v6
    v_mul_hi_u32 v12, v11, s39
    v_mul_lo_u32 v12, v12, s40
    v_sub_u32 v11, v11, v12
    v_cvt_f32_u32 v11, v11
    v_fmac_f32 v13, 0x3acccccd, v11
    v_cos_f32 v13, v13
    s_nop 0
    v_mul_f32 v23, v13, v14
    v_cvt_pk_bf16_f32 v24, v16, v17
    v_cvt_pk_bf16_f32 v25, v18, v19
    v_cvt_pk_bf16_f32 v26, v20, v21
    v_cvt_pk_bf16_f32 v27, v22, v23
    s_lshl_b32 s37, s36, 10
    s_add_u32 s37, s37, 147849216
    buffer_store_dwordx4 v[24:27], v5, s[8:11], s37 offen sc1
    s_add_u32 s36, s36, 256
    s_cmp_lt_u32 s36, 800
    s_cbranch_scc1 M_kv_t2
    s_mov_b32 s36, 0
    s_mov_b32 s37, s35
M_kv_wt:
    s_lshl_b32 s38, s36, 6
    v_add_u32 v6, s38, v1
    s_lshr_b32 s38, s37, 5
    s_bfe_u32 s39, s37, 0x30002
    s_lshl_b32 s39, s39, 3
    s_add_u32 s38, s38, s39
    s_and_b32 s39, s37, 3
    s_lshl_b32 s39, s39, 7
    s_add_u32 s38, s38, s39
    s_mul_i32 s38, s38, 642
    v_lshlrev_b32 v7, 1, v6
    v_lshlrev_b32 v2, 13, v6
    v_cmp_gt_u32 vcc, 321, v6
    s_and_saveexec_b64 s[52:53], vcc
    s_cbranch_execz M_kv_ws
    s_add_u32 s39, s38, 0
    buffer_load_ushort v8, v7, s[72:75], s39 offen
    buffer_load_ushort v16, v7, s[76:79], s39 offen
    s_add_u32 s39, s38, 328704
    buffer_load_ushort v9, v7, s[72:75], s39 offen
    buffer_load_ushort v17, v7, s[76:79], s39 offen
    s_add_u32 s39, s38, 657408
    buffer_load_ushort v10, v7, s[72:75], s39 offen
    buffer_load_ushort v18, v7, s[76:79], s39 offen
    s_add_u32 s39, s38, 986112
    buffer_load_ushort v11, v7, s[72:75], s39 offen
    buffer_load_ushort v19, v7, s[76:79], s39 offen
    s_add_u32 s39, s38, 41088
    buffer_load_ushort v12, v7, s[72:75], s39 offen
    buffer_load_ushort v20, v7, s[76:79], s39 offen
    s_add_u32 s39, s38, 369792
    buffer_load_ushort v13, v7, s[72:75], s39 offen
    buffer_load_ushort v21, v7, s[76:79], s39 offen
    s_add_u32 s39, s38, 698496
    buffer_load_ushort v14, v7, s[72:75], s39 offen
    buffer_load_ushort v22, v7, s[76:79], s39 offen
    s_add_u32 s39, s38, 1027200
    buffer_load_ushort v15, v7, s[72:75], s39 offen
    buffer_load_ushort v23, v7, s[76:79], s39 offen
    s_lshl_b32 s39, s37, 5
    s_add_u32 s39, s39, 148897792
    s_waitcnt vmcnt(0)
    v_lshl_or_b32 v8, v16, 16, v8
    v_lshl_or_b32 v9, v17, 16, v9
    v_lshl_or_b32 v10, v18, 16, v10
    v_lshl_or_b32 v11, v19, 16, v11
    v_lshl_or_b32 v12, v20, 16, v12
    v_lshl_or_b32 v13, v21, 16, v13
    v_lshl_or_b32 v14, v22, 16, v14
    v_lshl_or_b32 v15, v23, 16, v15
    buffer_store_dwordx4 v[8:11], v2, s[8:11], s39 offen sc1
    buffer_store_dwordx4 v[12:15], v2, s[8:11], s39 offen offset:16 sc1
M_kv_ws:
    s_mov_b64 exec, s[52:53]
    s_add_u32 s36, s36, 1
    s_cmp_lt_u32 s36, 6
    s_cbranch_scc1 M_kv_wt
    s_branch M_bphase
M_qao:
    s_cmp_lg_u32 s101, 0
    s_cbranch_scc1 M_q_ft
    v_lshrrev_b32 v1, 4, v0
    v_lshrrev_b32 v3, 8, v0
    v_and_b32 v4, 15, v1
    v_mov_b32 v5, v0
    s_min_u32 s36, s22, 19
    s_mul_i32 s36, s36, 40
    s_mul_i32 s27, s21, 10
    s_add_u32 s36, s36, s27
    s_add_u32 s35, s36, 10
    s_add_u32 s27, s42, 122880
    v_add_u32 v2, s27, v0
M_q_ftl:
    s_mul_hi_u32 s37, s36, 0xccccccd
    s_mul_i32 s38, s37, 20
    s_sub_u32 s38, s36, s38
    s_lshl_b32 s37, s37, 4
    s_lshl_b32 s38, s38, 5
    v_lshlrev_b32 v7, 3, v3
    v_add_u32 v7, s38, v7
    s_mov_b32 s39, 0x666667
    s_movk_i32 s40, 640
    v_add_u32 v6, s37, v4
    v_cmp_lt_u32 vcc, 320, v6
    v_subrev_u32 v8, 320, v6
    s_nop 1
    v_cndmask_b32 v8, v6, v8, vcc
    v_mov_b32 v9, 0
    v_mov_b32 v10, 0x3e800000
    v_cndmask_b32 v9, v9, v10, vcc
    v_add_u32 v11, 0, v7
    v_mul_u32_u24 v11, v11, v8
    v_mul_hi_u32 v12, v11, s39
    v_mul_lo_u32 v12, v12, s40
    v_sub_u32 v11, v11, v12
    v_cvt_f32_u32 v11, v11
    v_mov_b32 v12, v9
    v_fmac_f32 v12, 0x3acccccd, v11
    v_cos_f32 v16, v12
    v_add_u32 v11, 1, v7
    v_mul_u32_u24 v11, v11, v8
    v_mul_hi_u32 v12, v11, s39
    v_mul_lo_u32 v12, v12, s40
    v_sub_u32 v11, v11, v12
    v_cvt_f32_u32 v11, v11
    v_mov_b32 v12, v9
    v_fmac_f32 v12, 0x3acccccd, v11
    v_cos_f32 v17, v12
    v_add_u32 v11, 2, v7
    v_mul_u32_u24 v11, v11, v8
    v_mul_hi_u32 v12, v11, s39
    v_mul_lo_u32 v12, v12, s40
    v_sub_u32 v11, v11, v12
    v_cvt_f32_u32 v11, v11
    v_mov_b32 v12, v9
    v_fmac_f32 v12, 0x3acccccd, v11
    v_cos_f32 v18, v12
    v_add_u32 v11, 3, v7
    v_mul_u32_u24 v11, v11, v8
    v_mul_hi_u32 v12, v11, s39
    v_mul_lo_u32 v12, v12, s40
    v_sub_u32 v11, v11, v12
    v_cvt_f32_u32 v11, v11
    v_mov_b32 v12, v9
    v_fmac_f32 v12, 0x3acccccd, v11
    v_cos_f32 v19, v12
    v_add_u32 v11, 4, v7
    v_mul_u32_u24 v11, v11, v8
    v_mul_hi_u32 v12, v11, s39
    v_mul_lo_u32 v12, v12, s40
    v_sub_u32 v11, v11, v12
    v_cvt_f32_u32 v11, v11
    v_mov_b32 v12, v9
    v_fmac_f32 v12, 0x3acccccd, v11
    v_cos_f32 v20, v12
    v_add_u32 v11, 5, v7
    v_mul_u32_u24 v11, v11, v8
    v_mul_hi_u32 v12, v11, s39
    v_mul_lo_u32 v12, v12, s40
    v_sub_u32 v11, v11, v12
    v_cvt_f32_u32 v11, v11
    v_mov_b32 v12, v9
    v_fmac_f32 v12, 0x3acccccd, v11
    v_cos_f32 v21, v12
    v_add_u32 v11, 6, v7
    v_mul_u32_u24 v11, v11, v8
    v_mul_hi_u32 v12, v11, s39
    v_mul_lo_u32 v12, v12, s40
    v_sub_u32 v11, v11, v12
    v_cvt_f32_u32 v11, v11
    v_mov_b32 v12, v9
    v_fmac_f32 v12, 0x3acccccd, v11
    v_cos_f32 v22, v12
    v_add_u32 v11, 7, v7
    v_mul_u32_u24 v11, v11, v8
    v_mul_hi_u32 v12, v11, s39
    v_mul_lo_u32 v12, v12, s40
    v_sub_u32 v11, v11, v12
    v_cvt_f32_u32 v11, v11
    v_mov_b32 v12, v9
    v_fmac_f32 v12, 0x3acccccd, v11
    v_cos_f32 v23, v12
    s_nop 0
    v_cvt_pk_f16_f32 v24, v16, v17
    v_cvt_pk_f16_f32 v25, v18, v19
    v_cvt_pk_f16_f32 v26, v20, v21
    v_cvt_pk_f16_f32 v27, v22, v23
    ds_write_b128 v2, v[24:27]
    v_add_u32 v2, 1024, v2
    s_add_u32 s36, s36, 1
    s_cmp_lt_u32 s36, s35
    s_cbranch_scc1 M_q_ftl
    s_waitcnt lgkmcnt(0)
M_q_ft:
    v_lshrrev_b32 v1, 8, v0
    v_bfe_u32 v2, v0, 4, 4
    v_add_u32 v3, 81920, v0
    v_add_u32 v14, 122880, v0
    s_mul_i32 s28, s21, 320
    v_mul_u32_u24 v10, 40960, v2
    v_lshl_add_u32 v10, v1, 4, v10
    s_mul_i32 s27, s22, 1280
    s_add_u32 s29, s27, s28
    v_add_u32 v4, s29, v10
    v_mul_u32_u24 v10, 1280, v1
    s_mul_i32 s27, s22, 40960
    s_add_u32 s27, s27, s28
    v_add_u32 v10, s27, v10
    v_lshl_add_u32 v5, v2, 4, v10
    v_lshrrev_b32 v11, 2, v2
    v_mul_u32_u24 v15, 5120, v11
    v_add_u32 v10, v10, v15
    v_and_b32 v15, 0x30, v0
    v_add_u32 v6, v10, v15
    v_and_b32 v10, 1, v1
    v_lshlrev_b32 v10, 3, v10
    v_add_u32 v8, s29, v10
    v_lshl_add_u32 v7, v2, 4, v8
    v_add_u32 v8, v8, v15
    v_lshl_add_u32 v10, v11, 10, v10
    v_lshl_add_u32 v10, v15, 4, v10
    s_mul_i32 s27, s21, 5120
    s_and_b32 s28, s22, 15
    s_lshl_b32 s28, s28, 4
    s_add_u32 s27, s27, s28
    s_lshr_b32 s28, s22, 4
    s_mul_i32 s28, s28, 20480
    s_add_u32 s27, s27, s28
    v_add_u32 v12, s27, v10
    v_lshlrev_b32 v10, 13, v2
    v_lshl_add_u32 v10, v1, 4, v10
    s_lshl_b32 s27, s22, 18
    s_lshl_b32 s28, s21, 6
    s_add_u32 s27, s27, s28
    v_add_u32 v13, s27, v10
    s_and_b32 s58, s21, 1
    s_lshr_b32 s59, s21, 1
    v_lshlrev_b32 v10, 2, v1
    v_sub_u32 v10, v2, v10
    s_lshl_b32 s27, s58, 4
    v_add_u32 v9, s27, v10
    v_and_b32 v10, 16, v0
    s_movk_i32 s27, 0x3f80
    v_lshlrev_b32_e64 v10, v10, s27
    v_bfe_u32 v11, v0, 5, 2
    v_cmp_eq_u32 vcc, 0, v11
    s_nop 1
    v_cndmask_b32 v16, 0, v10, vcc
    v_cmp_eq_u32 vcc, 1, v11
    s_nop 1
    v_cndmask_b32 v17, 0, v10, vcc
    v_cmp_eq_u32 vcc, 2, v11
    s_nop 1
    v_cndmask_b32 v18, 0, v10, vcc
    v_cmp_eq_u32 vcc, 3, v11
    s_nop 1
    v_cndmask_b32 v19, 0, v10, vcc
    s_mov_b32 s40, 0x3e0293ee
    s_mov_b32 s41, s40
    s_sub_u32 s44, s20, 4
    s_mov_b32 s45, 0
    s_mul_i32 s48, s44, 2621440
    s_add_u32 s48, s48, 121634816
    s_mov_b32 s49, 1310720
    s_lshl_b32 s51, s44, 12
    s_lshl_b32 s27, s101, 11
    s_add_u32 s51, s51, s27
    s_add_u32 s51, s51, 167903232
    s_lshl_b32 s52, s22, 7
    s_lshl_b32 s27, s101, 12
    s_add_u32 s52, s52, s27
    s_add_u32 s52, s52, 167895040
    s_lshl_b32 s53, s22, 13
    s_add_u32 s53, s53, 218103808
    s_mul_i32 s54, s101, 8388608
    s_add_u32 s54, s54, 134217728
    s_lshl_b32 s60, s22, 8
    s_add_u32 s60, s60, 167886848
    s_mul_i32 s63, s44, 65536
    s_add_u32 s63, s63, 104857600
    s_add_u32 s64, s63, 4096
    s_cmp_lg_u32 s21, 0
    s_cbranch_scc1 M_qx_7
    v_lshlrev_b32 v190, 3, v0
    s_mov_b64 exec, -1
    s_mov_b32 s30, 0
    s_lshl_b32 s27, s101, 13
    s_add_u32 s27, s27, 167936000
M_qx_8:
    buffer_load_dwordx4 v[176:179], v190, s[8:11], s27 offen sc1
    buffer_load_dwordx4 v[180:183], v190, s[8:11], s27 offen offset:16 sc1
    buffer_load_dwordx2 v[184:185], v190, s[8:11], s27 offen offset:32 sc1
    s_add_u32 s30, s30, 1
    s_cmp_ge_u32 s30, 60000
    s_cbranch_scc1 M_fail
    s_waitcnt vmcnt(0)
    v_min3_u32 v176, v176, v177, v178
    v_min3_u32 v176, v176, v179, v180
    v_min3_u32 v176, v176, v181, v182
    v_min3_u32 v176, v176, v183, v184
    v_min_u32 v176, v176, v185
    v_cmp_eq_u32 vcc, 0, v176
    s_cbranch_vccnz M_qx_8
    s_mov_b64 exec, -1
M_qx_7:
    s_barrier
M_qx_9:
    s_min_u32 s27, s44, 63
    s_mul_i32 s27, s27, 40960
    s_add_u32 s27, s27, s47
    s_add_u32 s28, 0, s42
    s_mov_b32 m0, s28
    s_nop 0
    buffer_load_dwordx4 v0, s[8:11], s27 offen offset:0 sc1 lds
    buffer_load_dwordx4 v0, s[8:11], s27 offen offset:1024 sc1 lds
    buffer_load_dwordx4 v0, s[8:11], s27 offen offset:2048 sc1 lds
    buffer_load_dwordx4 v0, s[8:11], s27 offen offset:3072 sc1 lds
    s_add_u32 s27, s27, 4096
    s_add_u32 s28, s28, 4096
    s_mov_b32 m0, s28
    s_nop 0
    buffer_load_dwordx4 v0, s[8:11], s27 offen offset:0 sc1 lds
    buffer_load_dwordx4 v0, s[8:11], s27 offen offset:1024 sc1 lds
    buffer_load_dwordx4 v0, s[8:11], s27 offen offset:2048 sc1 lds
    buffer_load_dwordx4 v0, s[8:11], s27 offen offset:3072 sc1 lds
    s_add_u32 s27, s27, 4096
    s_add_u32 s28, s28, 4096
    s_mov_b32 m0, s28
    s_nop 0
    buffer_load_dwordx4 v0, s[8:11], s27 offen offset:0 sc1 lds
    buffer_load_dwordx4 v0, s[8:11], s27 offen offset:1024 sc1 lds
    s_add_u32 s46, s44, 4
    s_min_u32 s27, s46, 63
    s_mul_i32 s27, s27, 40960
    s_add_u32 s27, s27, s47
    s_add_u32 s28, 40960, s42
    s_mov_b32 m0, s28
    s_nop 0
    buffer_load_dwordx4 v0, s[8:11], s27 offen offset:0 sc1 lds
    buffer_load_dwordx4 v0, s[8:11], s27 offen offset:1024 sc1 lds
    buffer_load_dwordx4 v0, s[8:11], s27 offen offset:2048 sc1 lds
    buffer_load_dwordx4 v0, s[8:11], s27 offen offset:3072 sc1 lds
    s_add_u32 s27, s27, 4096
    s_add_u32 s28, s28, 4096
    s_mov_b32 m0, s28
    s_nop 0
    buffer_load_dwordx4 v0, s[8:11], s27 offen offset:0 sc1 lds
    buffer_load_dwordx4 v0, s[8:11], s27 offen offset:1024 sc1 lds
    buffer_load_dwordx4 v0, s[8:11], s27 offen offset:2048 sc1 lds
    buffer_load_dwordx4 v0, s[8:11], s27 offen offset:3072 sc1 lds
    s_add_u32 s27, s27, 4096
    s_add_u32 s28, s28, 4096
    s_mov_b32 m0, s28
    s_nop 0
    buffer_load_dwordx4 v0, s[8:11], s27 offen offset:0 sc1 lds
    buffer_load_dwordx4 v0, s[8:11], s27 offen offset:1024 sc1 lds
    s_waitcnt vmcnt(0)
    s_barrier
    s_mov_b32 s65, 0
    s_mov_b32 s66, s44
    s_mov_b32 s62, 0x10000000
    s_mov_b32 s67, 0x10000000
    s_mov_b32 s68, 0x10000000
M_q_front:
    s_add_u32 s56, s66, s43
    s_mov_b32 s30, 0
M_q_kf:
    s_cmp_gt_u32 s65, s56
    s_cbranch_scc1 M_q_kg
    v_lshlrev_b32 v10, 3, v0
    s_mov_b64 exec, 3
    buffer_load_dword v15, v10, s[8:11], s60 offen sc1
    s_mov_b64 exec, -1
    s_waitcnt vmcnt(0)
    v_readlane_b32 s65, v15, 0
    v_readlane_b32 s27, v15, 1
    s_nop 3
    s_min_u32 s65, s65, s27
    s_sleep 1
    s_add_u32 s30, s30, 1
    s_cmp_lt_u32 s30, 60000
    s_cbranch_scc1 M_q_kf
    s_branch M_fail
M_q_kg:
    s_nop 1
    s_lshl_b32 s27, s66, 18
    s_add_u32 s27, s27, s50
    s_add_u32 s28, s27, 4096
    buffer_load_dwordx4 v[72:75], v0, s[8:11], s27 offen offset:0 sc1
    buffer_load_dwordx4 v[76:79], v0, s[8:11], s27 offen offset:1024 sc1
    buffer_load_dwordx4 v[80:83], v0, s[8:11], s27 offen offset:2048 sc1
    buffer_load_dwordx4 v[84:87], v0, s[8:11], s27 offen offset:3072 sc1
    buffer_load_dwordx4 v[88:91], v0, s[8:11], s28 offen offset:0 sc1
    buffer_load_dwordx4 v[92:95], v0, s[8:11], s28 offen offset:1024 sc1
    buffer_load_dwordx4 v[96:99], v0, s[8:11], s28 offen offset:2048 sc1
    buffer_load_dwordx4 v[100:103], v0, s[8:11], s28 offen offset:3072 sc1
    s_lshl_b32 s28, s59, 12
    s_add_u32 s27, s27, s28
    s_add_u32 s27, s27, 16777216
    buffer_load_dwordx4 v[104:107], v0, s[8:11], s27 offen offset:0 sc1
    buffer_load_dwordx4 v[108:111], v0, s[8:11], s27 offen offset:1024 sc1
    buffer_load_dwordx4 v[112:115], v0, s[8:11], s27 offen offset:2048 sc1
    buffer_load_dwordx4 v[116:119], v0, s[8:11], s27 offen offset:3072 sc1
    s_mul_i32 s27, s66, 40960
    buffer_load_dwordx2 v[184:185], v7, s[16:19], s27 offen sc1
    buffer_load_dwordx2 v[186:187], v8, s[16:19], s27 offen offset:256 sc1
    v_lshlrev_b32 v10, 3, v0
    s_mov_b64 exec, 3
    buffer_load_dword v15, v10, s[8:11], s60 offen sc1
    s_mov_b64 exec, -1
    v_add_u32 v11, s45, v0
    s_sub_u32 s45, 40960, s45
    ds_read_b128 v[40:43], v11 offset:0
    ds_read_b128 v[44:47], v11 offset:1024
    ds_read_b128 v[48:51], v11 offset:2048
    ds_read_b128 v[52:55], v11 offset:3072
    ds_read_b128 v[56:59], v11 offset:4096
    ds_read_b128 v[60:63], v11 offset:5120
    s_waitcnt lgkmcnt(5)
    v_mfma_f32_16x16x32_bf16 v[24:27], a[0:3], v[40:43], 0
    v_mfma_f32_16x16x32_bf16 v[28:31], a[80:83], v[40:43], 0
    ds_read_b128 v[40:43], v11 offset:6144
    s_waitcnt lgkmcnt(5)
    v_mfma_f32_16x16x32_bf16 v[24:27], a[4:7], v[44:47], v[24:27]
    v_mfma_f32_16x16x32_bf16 v[28:31], a[84:87], v[44:47], v[28:31]
    ds_read_b128 v[44:47], v11 offset:7168
    s_waitcnt lgkmcnt(5)
    v_mfma_f32_16x16x32_bf16 v[24:27], a[8:11], v[48:51], v[24:27]
    v_mfma_f32_16x16x32_bf16 v[28:31], a[88:91], v[48:51], v[28:31]
    ds_read_b128 v[48:51], v11 offset:8192
    s_waitcnt lgkmcnt(5)
    v_mfma_f32_16x16x32_bf16 v[24:27], a[12:15], v[52:55], v[24:27]
    v_mfma_f32_16x16x32_bf16 v[28:31], a[92:95], v[52:55], v[28:31]
    ds_read_b128 v[52:55], v11 offset:9216
    s_waitcnt lgkmcnt(5)
    v_mfma_f32_16x16x32_bf16 v[24:27], a[16:19], v[56:59], v[24:27]
    v_mfma_f32_16x16x32_bf16 v[28:31], a[96:99], v[56:59], v[28:31]
    ds_read_b128 v[56:59], v11 offset:10240
    s_waitcnt lgkmcnt(5)
    v_mfma_f32_16x16x32_bf16 v[24:27], a[20:23], v[60:63], v[24:27]
    v_mfma_f32_16x16x32_bf16 v[28:31], a[100:103], v[60:63], v[28:31]
    ds_read_b128 v[60:63], v11 offset:11264
    s_waitcnt lgkmcnt(5)
    v_mfma_f32_16x16x32_bf16 v[24:27], a[24:27], v[40:43], v[24:27]
    v_mfma_f32_16x16x32_bf16 v[28:31], a[104:107], v[40:43], v[28:31]
    ds_read_b128 v[40:43], v11 offset:12288
    s_waitcnt lgkmcnt(5)
    v_mfma_f32_16x16x32_bf16 v[24:27], a[28:31], v[44:47], v[24:27]
    v_mfma_f32_16x16x32_bf16 v[28:31], a[108:111], v[44:47], v[28:31]
    ds_read_b128 v[44:47], v11 offset:13312
    s_waitcnt lgkmcnt(5)
    v_mfma_f32_16x16x32_bf16 v[24:27], a[32:35], v[48:51], v[24:27]
    v_mfma_f32_16x16x32_bf16 v[28:31], a[112:115], v[48:51], v[28:31]
    ds_read_b128 v[48:51], v11 offset:14336
    s_waitcnt lgkmcnt(5)
    v_mfma_f32_16x16x32_bf16 v[24:27], a[36:39], v[52:55], v[24:27]
    v_mfma_f32_16x16x32_bf16 v[28:31], a[116:119], v[52:55], v[28:31]
    ds_read_b128 v[52:55], v11 offset:15360
    s_waitcnt lgkmcnt(5)
    v_mfma_f32_16x16x32_bf16 v[24:27], a[40:43], v[56:59], v[24:27]
    v_mfma_f32_16x16x32_bf16 v[28:31], a[120:123], v[56:59], v[28:31]
    ds_read_b128 v[56:59], v11 offset:16384
    s_waitcnt lgkmcnt(5)
    v_mfma_f32_16x16x32_bf16 v[24:27], a[44:47], v[60:63], v[24:27]
    v_mfma_f32_16x16x32_bf16 v[28:31], a[124:127], v[60:63], v[28:31]
    ds_read_b128 v[60:63], v11 offset:17408
    s_waitcnt lgkmcnt(5)
    v_mfma_f32_16x16x32_bf16 v[24:27], a[48:51], v[40:43], v[24:27]
    v_mfma_f32_16x16x32_bf16 v[28:31], a[128:131], v[40:43], v[28:31]
    ds_read_b128 v[40:43], v11 offset:18432
    s_waitcnt lgkmcnt(5)
    v_mfma_f32_16x16x32_bf16 v[24:27], a[52:55], v[44:47], v[24:27]
    v_mfma_f32_16x16x32_bf16 v[28:31], a[132:135], v[44:47], v[28:31]
    ds_read_b128 v[44:47], v11 offset:19456
    s_waitcnt lgkmcnt(5)
    v_mfma_f32_16x16x32_bf16 v[24:27], a[56:59], v[48:51], v[24:27]
    v_mfma_f32_16x16x32_bf16 v[28:31], a[136:139], v[48:51], v[28:31]
    ds_read_b128 v[48:51], v11 offset:20480
    s_waitcnt lgkmcnt(5)
    v_mfma_f32_16x16x32_bf16 v[24:27], a[60:63], v[52:55], v[24:27]
    v_mfma_f32_16x16x32_bf16 v[28:31], a[140:143], v[52:55], v[28:31]
    ds_read_b128 v[52:55], v11 offset:21504
    s_waitcnt lgkmcnt(5)
    v_mfma_f32_16x16x32_bf16 v[24:27], a[64:67], v[56:59], v[24:27]
    v_mfma_f32_16x16x32_bf16 v[28:31], a[144:147], v[56:59], v[28:31]
    ds_read_b128 v[56:59], v11 offset:22528
    s_waitcnt lgkmcnt(5)
    v_mfma_f32_16x16x32_bf16 v[24:27], a[68:71], v[60:63], v[24:27]
    v_mfma_f32_16x16x32_bf16 v[28:31], a[148:151], v[60:63], v[28:31]
    ds_read_b128 v[60:63], v11 offset:23552
    s_waitcnt lgkmcnt(5)
    v_mfma_f32_16x16x32_bf16 v[24:27], a[72:75], v[40:43], v[24:27]
    v_mfma_f32_16x16x32_bf16 v[28:31], a[152:155], v[40:43], v[28:31]
    ds_read_b128 v[40:43], v11 offset:24576
    s_waitcnt lgkmcnt(5)
    v_mfma_f32_16x16x32_bf16 v[24:27], a[76:79], v[44:47], v[24:27]
    v_mfma_f32_16x16x32_bf16 v[28:31], a[156:159], v[44:47], v[28:31]
    ds_read_b128 v[44:47], v11 offset:25600
    s_waitcnt lgkmcnt(5)
    v_mfma_f32_16x16x32_bf16 v[32:35], a[0:3], v[48:51], 0
    v_mfma_f32_16x16x32_bf16 v[36:39], a[80:83], v[48:51], 0
    ds_read_b128 v[48:51], v11 offset:26624
    s_waitcnt lgkmcnt(5)
    v_mfma_f32_16x16x32_bf16 v[32:35], a[4:7], v[52:55], v[32:35]
    v_mfma_f32_16x16x32_bf16 v[36:39], a[84:87], v[52:55], v[36:39]
    ds_read_b128 v[52:55], v11 offset:27648
    s_waitcnt lgkmcnt(5)
    v_mfma_f32_16x16x32_bf16 v[32:35], a[8:11], v[56:59], v[32:35]
    v_mfma_f32_16x16x32_bf16 v[36:39], a[88:91], v[56:59], v[36:39]
    ds_read_b128 v[56:59], v11 offset:28672
    s_waitcnt lgkmcnt(5)
    v_mfma_f32_16x16x32_bf16 v[32:35], a[12:15], v[60:63], v[32:35]
    v_mfma_f32_16x16x32_bf16 v[36:39], a[92:95], v[60:63], v[36:39]
    ds_read_b128 v[60:63], v11 offset:29696
    s_waitcnt lgkmcnt(5)
    v_mfma_f32_16x16x32_bf16 v[32:35], a[16:19], v[40:43], v[32:35]
    v_mfma_f32_16x16x32_bf16 v[36:39], a[96:99], v[40:43], v[36:39]
    ds_read_b128 v[40:43], v11 offset:30720
    s_waitcnt lgkmcnt(5)
    v_mfma_f32_16x16x32_bf16 v[32:35], a[20:23], v[44:47], v[32:35]
    v_mfma_f32_16x16x32_bf16 v[36:39], a[100:103], v[44:47], v[36:39]
    ds_read_b128 v[44:47], v11 offset:31744
    s_waitcnt lgkmcnt(5)
    v_mfma_f32_16x16x32_bf16 v[32:35], a[24:27], v[48:51], v[32:35]
    v_mfma_f32_16x16x32_bf16 v[36:39], a[104:107], v[48:51], v[36:39]
    ds_read_b128 v[48:51], v11 offset:32768
    s_waitcnt lgkmcnt(5)
    v_mfma_f32_16x16x32_bf16 v[32:35], a[28:31], v[52:55], v[32:35]
    v_mfma_f32_16x16x32_bf16 v[36:39], a[108:111], v[52:55], v[36:39]
    ds_read_b128 v[52:55], v11 offset:33792
    s_waitcnt lgkmcnt(5)
    v_mfma_f32_16x16x32_bf16 v[32:35], a[32:35], v[56:59], v[32:35]
    v_mfma_f32_16x16x32_bf16 v[36:39], a[112:115], v[56:59], v[36:39]
    ds_read_b128 v[56:59], v11 offset:34816
    s_waitcnt lgkmcnt(5)
    v_mfma_f32_16x16x32_bf16 v[32:35], a[36:39], v[60:63], v[32:35]
    v_mfma_f32_16x16x32_bf16 v[36:39], a[116:119], v[60:63], v[36:39]
    ds_read_b128 v[60:63], v11 offset:35840
    s_waitcnt lgkmcnt(5)
    v_mfma_f32_16x16x32_bf16 v[32:35], a[40:43], v[40:43], v[32:35]
    v_mfma_f32_16x16x32_bf16 v[36:39], a[120:123], v[40:43], v[36:39]
    ds_read_b128 v[40:43], v11 offset:36864
    s_waitcnt lgkmcnt(5)
    v_mfma_f32_16x16x32_bf16 v[32:35], a[44:47], v[44:47], v[32:35]
    v_mfma_f32_16x16x32_bf16 v[36:39], a[124:127], v[44:47], v[36:39]
    ds_read_b128 v[44:47], v11 offset:37888
    s_waitcnt lgkmcnt(5)
    v_mfma_f32_16x16x32_bf16 v[32:35], a[48:51], v[48:51], v[32:35]
    v_mfma_f32_16x16x32_bf16 v[36:39], a[128:131], v[48:51], v[36:39]
    ds_read_b128 v[48:51], v11 offset:38912
    s_waitcnt lgkmcnt(5)
    v_mfma_f32_16x16x32_bf16 v[32:35], a[52:55], v[52:55], v[32:35]
    v_mfma_f32_16x16x32_bf16 v[36:39], a[132:135], v[52:55], v[36:39]
    ds_read_b128 v[52:55], v11 offset:39936
    s_waitcnt lgkmcnt(5)
    v_mfma_f32_16x16x32_bf16 v[32:35], a[56:59], v[56:59], v[32:35]
    v_mfma_f32_16x16x32_bf16 v[36:39], a[136:139], v[56:59], v[36:39]
    s_waitcnt lgkmcnt(4)
    v_mfma_f32_16x16x32_bf16 v[32:35], a[60:63], v[60:63], v[32:35]
    v_mfma_f32_16x16x32_bf16 v[36:39], a[140:143], v[60:63], v[36:39]
    s_waitcnt lgkmcnt(3)
    v_mfma_f32_16x16x32_bf16 v[32:35], a[64:67], v[40:43], v[32:35]
    v_mfma_f32_16x16x32_bf16 v[36:39], a[144:147], v[40:43], v[36:39]
    s_waitcnt lgkmcnt(2)
    v_mfma_f32_16x16x32_bf16 v[32:35], a[68:71], v[44:47], v[32:35]
    v_mfma_f32_16x16x32_bf16 v[36:39], a[148:151], v[44:47], v[36:39]
    s_waitcnt lgkmcnt(1)
    v_mfma_f32_16x16x32_bf16 v[32:35], a[72:75], v[48:51], v[32:35]
    v_mfma_f32_16x16x32_bf16 v[36:39], a[152:155], v[48:51], v[36:39]
    s_waitcnt lgkmcnt(0)
    v_mfma_f32_16x16x32_bf16 v[32:35], a[76:79], v[52:55], v[32:35]
    v_mfma_f32_16x16x32_bf16 v[36:39], a[156:159], v[52:55], v[36:39]
    v_pk_mul_f32 v[24:25], v[24:25], s[40:41]
    v_pk_mul_f32 v[26:27], v[26:27], s[40:41]
    v_pk_mul_f32 v[28:29], v[28:29], s[40:41]
    v_pk_mul_f32 v[30:31], v[30:31], s[40:41]
    s_nop 2
    v_pk_mul_f32 v[32:33], v[32:33], s[40:41]
    v_pk_mul_f32 v[34:35], v[34:35], s[40:41]
    v_pk_mul_f32 v[36:37], v[36:37], s[40:41]
    v_pk_mul_f32 v[38:39], v[38:39], s[40:41]
    s_lshl_b32 s27, s21, 10
    v_add_u32 v10, s27, v3
    v_cvt_pk_bf16_f32 v40, v24, v28
    v_cvt_pk_bf16_f32 v41, v25, v29
    v_cvt_pk_bf16_f32 v42, v26, v30
    v_cvt_pk_bf16_f32 v43, v27, v31
    ds_write_b128 v10, v[40:43] offset:0
    v_cvt_pk_bf16_f32 v44, v32, v36
    v_cvt_pk_bf16_f32 v45, v33, v37
    v_cvt_pk_bf16_f32 v46, v34, v38
    v_cvt_pk_bf16_f32 v47, v35, v39
    ds_write_b128 v10, v[44:47] offset:4096
    s_lshl_b32 s27, s58, 12
    v_add_u32 v10, s27, v3
    s_waitcnt vmcnt(15) lgkmcnt(0)
    s_barrier
    ds_read_b128 v[160:163], v10 offset:0
    ds_read_b128 v[164:167], v10 offset:1024
    ds_read_b128 v[168:171], v10 offset:2048
    ds_read_b128 v[172:175], v10 offset:3072
    s_waitcnt vmcnt(0)
    s_cmp_lg_u32 s21, 0
    s_cbranch_scc1 M_q_fa
    s_mov_b64 exec, 1
    v_mov_b32 v10, s22
    v_mov_b32 v11, 1
    s_cmp_lg_u32 s23, 0
    s_cbranch_scc1 M_ls_10
    buffer_store_byte v11, v10, s[8:11], s62 offen
M_ls_10_r:
    s_mov_b64 exec, -1
M_q_fa:
    v_mov_b32 v11, 0xf149f2ca
    v_cmp_gt_i32 vcc, 0, v9
    s_nop 1
    v_cndmask_b32 v120, 0, v11, vcc
    v_cmp_gt_i32 vcc, 1, v9
    s_nop 1
    v_cndmask_b32 v121, 0, v11, vcc
    v_cmp_gt_i32 vcc, 2, v9
    s_nop 1
    v_cndmask_b32 v122, 0, v11, vcc
    v_cmp_gt_i32 vcc, 3, v9
    s_nop 1
    v_cndmask_b32 v123, 0, v11, vcc
    v_cmp_gt_i32 vcc, 16, v9
    s_nop 1
    v_cndmask_b32 v124, 0, v11, vcc
    v_cmp_gt_i32 vcc, 17, v9
    s_nop 1
    v_cndmask_b32 v125, 0, v11, vcc
    v_cmp_gt_i32 vcc, 18, v9
    s_nop 1
    v_cndmask_b32 v126, 0, v11, vcc
    v_cmp_gt_i32 vcc, 19, v9
    s_nop 1
    v_cndmask_b32 v127, 0, v11, vcc
    s_waitcnt lgkmcnt(3)
    v_mfma_f32_16x16x32_bf16 v[120:123], v[72:75], v[160:163], v[120:123]
    v_mfma_f32_16x16x32_bf16 v[124:127], v[88:91], v[160:163], v[124:127]
    s_waitcnt lgkmcnt(2)
    v_mfma_f32_16x16x32_bf16 v[120:123], v[76:79], v[164:167], v[120:123]
    v_mfma_f32_16x16x32_bf16 v[124:127], v[92:95], v[164:167], v[124:127]
    s_waitcnt lgkmcnt(1)
    v_mfma_f32_16x16x32_bf16 v[120:123], v[80:83], v[168:171], v[120:123]
    v_mfma_f32_16x16x32_bf16 v[124:127], v[96:99], v[168:171], v[124:127]
    s_waitcnt lgkmcnt(0)
    v_mfma_f32_16x16x32_bf16 v[120:123], v[84:87], v[172:175], v[120:123]
    v_mfma_f32_16x16x32_bf16 v[124:127], v[100:103], v[172:175], v[124:127]
    v_readlane_b32 s65, v15, 0
    v_readlane_b32 s27, v15, 1
    s_nop 3
    s_min_u32 s65, s65, s27
    v_max3_f32 v176, v120, v121, v122
    v_max3_f32 v176, v176, v123, v124
    v_max3_f32 v176, v176, v125, v126
    v_max_f32 v176, v176, v127
    v_mov_b32 v178, v176
    s_nop 1
    v_permlane16_swap_b32 v176, v178
    v_max_f32 v176, v176, v178
    v_mov_b32 v178, v176
    s_nop 1
    v_permlane32_swap_b32 v176, v178
    v_max_f32 v176, v176, v178
    v_sub_f32 v120, v120, v176
    v_sub_f32 v121, v121, v176
    v_sub_f32 v122, v122, v176
    v_sub_f32 v123, v123, v176
    v_sub_f32 v124, v124, v176
    v_sub_f32 v125, v125, v176
    v_sub_f32 v126, v126, v176
    v_sub_f32 v127, v127, v176
    v_exp_f32 v120, v120
    v_exp_f32 v121, v121
    v_exp_f32 v122, v122
    v_exp_f32 v123, v123
    v_exp_f32 v124, v124
    v_exp_f32 v125, v125
    v_exp_f32 v126, v126
    v_exp_f32 v127, v127
    v_cvt_pk_bf16_f32 v128, v120, v121
    v_cvt_pk_bf16_f32 v129, v122, v123
    v_cvt_pk_bf16_f32 v130, v124, v125
    v_cvt_pk_bf16_f32 v131, v126, v127
    v_add_f32 v177, v120, v121
    v_add_f32 v177, v177, v122
    v_add_f32 v177, v177, v123
    v_add_f32 v177, v177, v124
    v_add_f32 v177, v177, v125
    v_add_f32 v177, v177, v126
    v_add_f32 v177, v177, v127
    v_mfma_f32_16x16x32_bf16 v[144:147], v[104:107], v[128:131], 0
    v_mfma_f32_16x16x32_bf16 v[148:151], v[108:111], v[128:131], 0
    v_mfma_f32_16x16x32_bf16 v[152:155], v[112:115], v[128:131], 0
    v_mfma_f32_16x16x32_bf16 v[156:159], v[116:119], v[128:131], 0
    v_mov_b32 v178, v177
    s_nop 1
    v_permlane16_swap_b32 v177, v178
    v_add_f32 v177, v177, v178
    v_mov_b32 v178, v177
    s_nop 1
    v_permlane32_swap_b32 v177, v178
    v_add_f32 v177, v177, v178
    s_cmp_lg_u32 s66, s44
    s_cbranch_scc1 M_q_back2
M_q_top:
    s_add_u32 s56, s44, s43
    s_lshl_b32 s57, s44, 7
    s_mul_i32 s55, s44, 40960
    s_lshl_b32 s26, s56, 18
    s_add_u32 s26, s26, s53
    s_lshl_b32 s28, s59, 11
    s_add_u32 s29, s26, s28
    s_add_u32 s29, s29, 4096
    s_lshl_b32 s27, s58, 12
    s_add_u32 s27, s27, s28
    v_add_u32 v10, s27, v3
    s_cmp_lg_u32 s21, 0
    s_cbranch_scc1 M_cf_11
    s_mov_b64 exec, 0x3
    s_mov_b32 s30, 0
    v_lshrrev_b32 v190, 2, v0
M_cf_12:
    buffer_load_dword v191, v190, s[8:11], s52 offen sc1
    s_add_u32 s30, s30, 1
    s_cmp_ge_u32 s30, 60000
    s_cbranch_scc1 M_fail
    s_waitcnt vmcnt(0)
    v_cmp_ge_u32 vcc, s57, v191
    s_cbranch_vccz M_cf_12d
    s_sleep 1
    s_branch M_cf_12
M_cf_12d:
    s_mov_b64 exec, -1
M_cf_11:
    s_barrier
    buffer_load_dwordx4 v[24:27], v0, s[8:11], s26 offen offset:0 sc1
    buffer_load_dwordx4 v[28:31], v0, s[8:11], s26 offen offset:1024 sc1
    buffer_load_dwordx4 v[32:35], v0, s[8:11], s26 offen offset:2048 sc1
    buffer_load_dwordx4 v[36:39], v0, s[8:11], s26 offen offset:3072 sc1
    buffer_load_dwordx4 v[40:43], v0, s[8:11], s29 offen offset:0 sc1
    buffer_load_dwordx4 v[44:47], v0, s[8:11], s29 offen offset:1024 sc1
    s_waitcnt vmcnt(5)
    v_mfma_f32_16x16x32_bf16 v[48:51], v[24:27], v[160:163], 0
    s_waitcnt vmcnt(4)
    v_mfma_f32_16x16x32_bf16 v[48:51], v[28:31], v[164:167], v[48:51]
    s_waitcnt vmcnt(3)
    v_mfma_f32_16x16x32_bf16 v[48:51], v[32:35], v[168:171], v[48:51]
    s_waitcnt vmcnt(2)
    v_mfma_f32_16x16x32_bf16 v[48:51], v[36:39], v[172:175], v[48:51]
    s_nop 7
    v_max3_f32 v179, v176, v48, v49
    v_max3_f32 v179, v179, v50, v51
    v_mov_b32 v178, v179
    s_nop 1
    v_permlane16_swap_b32 v179, v178
    v_max_f32 v179, v179, v178
    v_sub_f32 v180, v176, v179
    v_sub_f32 v48, v48, v179
    v_sub_f32 v49, v49, v179
    v_sub_f32 v50, v50, v179
    v_sub_f32 v51, v51, v179
    v_exp_f32 v180, v180
    v_exp_f32 v48, v48
    v_exp_f32 v49, v49
    v_exp_f32 v50, v50
    v_exp_f32 v51, v51
    v_add_f32 v179, v48, v49
    v_add_f32 v176, v50, v51
    v_add_f32 v179, v179, v176
    v_mov_b32 v178, v179
    s_nop 1
    v_permlane16_swap_b32 v179, v178
    v_add_f32 v179, v179, v178
    v_fmac_f32 v179, v180, v177
    v_rcp_f32 v179, v179
    s_nop 0
    v_mul_f32 v180, v180, v179
    v_mul_f32 v48, v48, v179
    v_mul_f32 v49, v49, v179
    v_mul_f32 v50, v50, v179
    v_mul_f32 v51, v51, v179
    v_cvt_pk_bf16_f32 v48, v48, v49
    v_cvt_pk_bf16_f32 v49, v50, v51
    v_pk_mul_f32 v[144:145], v[144:145], v[180:181] op_sel_hi:[1,0]
    v_pk_mul_f32 v[146:147], v[146:147], v[180:181] op_sel_hi:[1,0]
    v_pk_mul_f32 v[148:149], v[148:149], v[180:181] op_sel_hi:[1,0]
    v_pk_mul_f32 v[150:151], v[150:151], v[180:181] op_sel_hi:[1,0]
    v_pk_mul_f32 v[152:153], v[152:153], v[180:181] op_sel_hi:[1,0]
    v_pk_mul_f32 v[154:155], v[154:155], v[180:181] op_sel_hi:[1,0]
    v_pk_mul_f32 v[156:157], v[156:157], v[180:181] op_sel_hi:[1,0]
    v_pk_mul_f32 v[158:159], v[158:159], v[180:181] op_sel_hi:[1,0]
    s_waitcnt vmcnt(1)
    v_mfma_f32_16x16x16_bf16 v[144:147], v[40:41], v[48:49], v[144:147]
    v_mfma_f32_16x16x16_bf16 v[148:151], v[42:43], v[48:49], v[148:151]
    s_waitcnt vmcnt(0)
    v_mfma_f32_16x16x16_bf16 v[152:155], v[44:45], v[48:49], v[152:155]
    v_mfma_f32_16x16x16_bf16 v[156:159], v[46:47], v[48:49], v[156:159]
    s_nop 4
    v_cvt_pk_bf16_f32 v56, v144, v148
    v_cvt_pk_bf16_f32 v57, v145, v149
    v_cvt_pk_bf16_f32 v58, v146, v150
    v_cvt_pk_bf16_f32 v59, v147, v151
    ds_write_b128 v10, v[56:59] offset:8192
    v_cvt_pk_bf16_f32 v60, v152, v156
    v_cvt_pk_bf16_f32 v61, v153, v157
    v_cvt_pk_bf16_f32 v62, v154, v158
    v_cvt_pk_bf16_f32 v63, v155, v159
    ds_write_b128 v10, v[60:63] offset:9216
    s_waitcnt lgkmcnt(0)
    s_barrier
    ds_read_b128 v[24:27], v3 offset:8192
    ds_read_b128 v[40:43], v3 offset:12288
    ds_read_b128 v[28:31], v3 offset:9216
    ds_read_b128 v[44:47], v3 offset:13312
    ds_read_b128 v[32:35], v3 offset:10240
    ds_read_b128 v[48:51], v3 offset:14336
    ds_read_b128 v[36:39], v3 offset:11264
    ds_read_b128 v[52:55], v3 offset:15360
    s_add_u32 s28, s68, 131072
    buffer_store_dwordx4 v[104:107], v13, s[8:11], s68 offen sc1
    buffer_store_dwordx4 v[108:111], v13, s[8:11], s28 offen sc1
    s_mov_b32 exec_hi, 0
    buffer_store_dwordx2 v[20:21], v7, s[8:11], s67 offen sc1
    s_mov_b32 exec_lo, 0x000f000f
    buffer_store_dwordx2 v[22:23], v7, s[8:11], s67 offen offset:256 sc1
    s_mov_b64 exec, -1
    v_mov_b64 v[20:21], v[184:185]
    v_mov_b64 v[22:23], v[186:187]
    s_add_u32 s46, s44, 8
    s_cmp_ge_u32 s46, 64
    s_cbranch_scc1 M_q_nx
    s_sub_u32 s29, 40960, s45
    s_min_u32 s27, s46, 63
    s_mul_i32 s27, s27, 40960
    s_add_u32 s27, s27, s47
    s_add_u32 s28, s29, s42
    s_mov_b32 m0, s28
    s_nop 0
    buffer_load_dwordx4 v0, s[8:11], s27 offen offset:0 sc1 lds
    buffer_load_dwordx4 v0, s[8:11], s27 offen offset:1024 sc1 lds
    buffer_load_dwordx4 v0, s[8:11], s27 offen offset:2048 sc1 lds
    buffer_load_dwordx4 v0, s[8:11], s27 offen offset:3072 sc1 lds
    s_add_u32 s27, s27, 4096
    s_add_u32 s28, s28, 4096
    s_mov_b32 m0, s28
    s_nop 0
    buffer_load_dwordx4 v0, s[8:11], s27 offen offset:0 sc1 lds
    buffer_load_dwordx4 v0, s[8:11], s27 offen offset:1024 sc1 lds
    buffer_load_dwordx4 v0, s[8:11], s27 offen offset:2048 sc1 lds
    buffer_load_dwordx4 v0, s[8:11], s27 offen offset:3072 sc1 lds
    s_add_u32 s27, s27, 4096
    s_add_u32 s28, s28, 4096
    s_mov_b32 m0, s28
    s_nop 0
    buffer_load_dwordx4 v0, s[8:11], s27 offen offset:0 sc1 lds
    buffer_load_dwordx4 v0, s[8:11], s27 offen offset:1024 sc1 lds
M_q_nx:
    s_mov_b32 s62, s51
    s_add_u32 s27, s48, 655360
    s_waitcnt lgkmcnt(7)
    v_mfma_f32_16x16x32_bf16 v[64:67], a[160:163], v[24:27], 0
    v_mfma_f32_16x16x32_bf16 v[68:71], a[176:179], v[24:27], 0
    s_waitcnt lgkmcnt(6)
    v_mfma_f32_16x16x32_bf16 v[72:75], a[160:163], v[40:43], 0
    v_mfma_f32_16x16x32_bf16 v[76:79], a[176:179], v[40:43], 0
    s_waitcnt lgkmcnt(5)
    v_mfma_f32_16x16x32_bf16 v[64:67], a[164:167], v[28:31], v[64:67]
    v_mfma_f32_16x16x32_bf16 v[68:71], a[180:183], v[28:31], v[68:71]
    s_waitcnt lgkmcnt(4)
    v_mfma_f32_16x16x32_bf16 v[72:75], a[164:167], v[44:47], v[72:75]
    v_mfma_f32_16x16x32_bf16 v[76:79], a[180:183], v[44:47], v[76:79]
    s_waitcnt lgkmcnt(3)
    v_mfma_f32_16x16x32_bf16 v[64:67], a[168:171], v[32:35], v[64:67]
    v_mfma_f32_16x16x32_bf16 v[68:71], a[184:187], v[32:35], v[68:71]
    s_waitcnt lgkmcnt(2)
    v_mfma_f32_16x16x32_bf16 v[72:75], a[168:171], v[48:51], v[72:75]
    v_mfma_f32_16x16x32_bf16 v[76:79], a[184:187], v[48:51], v[76:79]
    s_waitcnt lgkmcnt(1)
    v_mfma_f32_16x16x32_bf16 v[64:67], a[172:175], v[36:39], v[64:67]
    v_mfma_f32_16x16x32_bf16 v[68:71], a[188:191], v[36:39], v[68:71]
    s_waitcnt lgkmcnt(0)
    v_mfma_f32_16x16x32_bf16 v[72:75], a[172:175], v[52:55], v[72:75]
    v_mfma_f32_16x16x32_bf16 v[76:79], a[188:191], v[52:55], v[76:79]
    v_mfma_f32_16x16x32_bf16 v[80:83], a[192:195], v[24:27], 0
    v_mfma_f32_16x16x32_bf16 v[84:87], a[208:211], v[24:27], 0
    v_mfma_f32_16x16x32_bf16 v[88:91], a[192:195], v[40:43], 0
    v_mfma_f32_16x16x32_bf16 v[92:95], a[208:211], v[40:43], 0
    v_mfma_f32_16x16x32_bf16 v[80:83], a[196:199], v[28:31], v[80:83]
    v_cvt_pk_bf16_f32 v64, v64, v65
    v_cvt_pk_bf16_f32 v65, v66, v67
    v_mfma_f32_16x16x32_bf16 v[84:87], a[212:215], v[28:31], v[84:87]
    v_cvt_pk_bf16_f32 v66, v68, v69
    v_cvt_pk_bf16_f32 v67, v70, v71
    v_mfma_f32_16x16x32_bf16 v[88:91], a[196:199], v[44:47], v[88:91]
    v_cvt_pk_bf16_f32 v72, v72, v73
    v_cvt_pk_bf16_f32 v73, v74, v75
    v_mfma_f32_16x16x32_bf16 v[92:95], a[212:215], v[44:47], v[92:95]
    v_cvt_pk_bf16_f32 v74, v76, v77
    v_cvt_pk_bf16_f32 v75, v78, v79
    s_cmp_lg_u32 s23, 0
    s_cbranch_scc1 M_ls_13
    buffer_store_dwordx4 v[64:67], v4, s[8:11], s48 offen offset:0
    buffer_store_dwordx4 v[72:75], v4, s[8:11], s27 offen offset:0
M_ls_13_r:
    v_mfma_f32_16x16x32_bf16 v[80:83], a[200:203], v[32:35], v[80:83]
    v_mfma_f32_16x16x32_bf16 v[84:87], a[216:219], v[32:35], v[84:87]
    v_mfma_f32_16x16x32_bf16 v[88:91], a[200:203], v[48:51], v[88:91]
    v_mfma_f32_16x16x32_bf16 v[92:95], a[216:219], v[48:51], v[92:95]
    v_mfma_f32_16x16x32_bf16 v[80:83], a[204:207], v[36:39], v[80:83]
    v_mfma_f32_16x16x32_bf16 v[84:87], a[220:223], v[36:39], v[84:87]
    v_mfma_f32_16x16x32_bf16 v[88:91], a[204:207], v[52:55], v[88:91]
    v_mfma_f32_16x16x32_bf16 v[92:95], a[220:223], v[52:55], v[92:95]
    v_mfma_f32_16x16x32_bf16 v[96:99], a[224:227], v[24:27], 0
    v_mfma_f32_16x16x32_bf16 v[100:103], a[240:243], v[24:27], 0
    v_mfma_f32_16x16x32_bf16 v[104:107], a[224:227], v[40:43], 0
    v_mfma_f32_16x16x32_bf16 v[108:111], a[240:243], v[40:43], 0
    v_mfma_f32_16x16x32_bf16 v[96:99], a[228:231], v[28:31], v[96:99]
    v_cvt_pk_bf16_f32 v80, v80, v81
    v_cvt_pk_bf16_f32 v81, v82, v83
    v_mfma_f32_16x16x32_bf16 v[100:103], a[244:247], v[28:31], v[100:103]
    v_cvt_pk_bf16_f32 v82, v84, v85
    v_cvt_pk_bf16_f32 v83, v86, v87
    v_mfma_f32_16x16x32_bf16 v[104:107], a[228:231], v[44:47], v[104:107]
    v_cvt_pk_bf16_f32 v88, v88, v89
    v_cvt_pk_bf16_f32 v89, v90, v91
    v_mfma_f32_16x16x32_bf16 v[108:111], a[244:247], v[44:47], v[108:111]
    v_cvt_pk_bf16_f32 v90, v92, v93
    v_cvt_pk_bf16_f32 v91, v94, v95
    s_cmp_lg_u32 s23, 0
    s_cbranch_scc1 M_ls_14
    buffer_store_dwordx4 v[80:83], v4, s[8:11], s48 offen offset:64
    buffer_store_dwordx4 v[88:91], v4, s[8:11], s27 offen offset:64
M_ls_14_r:
    v_mfma_f32_16x16x32_bf16 v[96:99], a[232:235], v[32:35], v[96:99]
    v_mfma_f32_16x16x32_bf16 v[100:103], a[248:251], v[32:35], v[100:103]
    v_mfma_f32_16x16x32_bf16 v[104:107], a[232:235], v[48:51], v[104:107]
    v_mfma_f32_16x16x32_bf16 v[108:111], a[248:251], v[48:51], v[108:111]
    v_mfma_f32_16x16x32_bf16 v[96:99], a[236:239], v[36:39], v[96:99]
    v_mfma_f32_16x16x32_bf16 v[100:103], a[252:255], v[36:39], v[100:103]
    v_mfma_f32_16x16x32_bf16 v[104:107], a[236:239], v[52:55], v[104:107]
    v_mfma_f32_16x16x32_bf16 v[108:111], a[252:255], v[52:55], v[108:111]
    v_mfma_f32_16x16x32_bf16 v[112:115], v[192:195], v[24:27], 0
    v_mfma_f32_16x16x32_bf16 v[116:119], v[208:211], v[24:27], 0
    v_mfma_f32_16x16x32_bf16 v[120:123], v[192:195], v[40:43], 0
    v_mfma_f32_16x16x32_bf16 v[124:127], v[208:211], v[40:43], 0
    v_mfma_f32_16x16x32_bf16 v[112:115], v[196:199], v[28:31], v[112:115]
    v_cvt_pk_bf16_f32 v96, v96, v97
    v_cvt_pk_bf16_f32 v97, v98, v99
    v_mfma_f32_16x16x32_bf16 v[116:119], v[212:215], v[28:31], v[116:119]
    v_cvt_pk_bf16_f32 v98, v100, v101
    v_cvt_pk_bf16_f32 v99, v102, v103
    v_mfma_f32_16x16x32_bf16 v[120:123], v[196:199], v[44:47], v[120:123]
    v_cvt_pk_bf16_f32 v104, v104, v105
    v_cvt_pk_bf16_f32 v105, v106, v107
    v_mfma_f32_16x16x32_bf16 v[124:127], v[212:215], v[44:47], v[124:127]
    v_cvt_pk_bf16_f32 v106, v108, v109
    v_cvt_pk_bf16_f32 v107, v110, v111
    s_cmp_lg_u32 s23, 0
    s_cbranch_scc1 M_ls_15
    buffer_store_dwordx4 v[96:99], v4, s[8:11], s48 offen offset:128
    buffer_store_dwordx4 v[104:107], v4, s[8:11], s27 offen offset:128
M_ls_15_r:
    v_mfma_f32_16x16x32_bf16 v[112:115], v[200:203], v[32:35], v[112:115]
    v_mfma_f32_16x16x32_bf16 v[116:119], v[216:219], v[32:35], v[116:119]
    v_mfma_f32_16x16x32_bf16 v[120:123], v[200:203], v[48:51], v[120:123]
    v_mfma_f32_16x16x32_bf16 v[124:127], v[216:219], v[48:51], v[124:127]
    v_mfma_f32_16x16x32_bf16 v[112:115], v[204:207], v[36:39], v[112:115]
    v_mfma_f32_16x16x32_bf16 v[116:119], v[220:223], v[36:39], v[116:119]
    v_mfma_f32_16x16x32_bf16 v[120:123], v[204:207], v[52:55], v[120:123]
    v_mfma_f32_16x16x32_bf16 v[124:127], v[220:223], v[52:55], v[124:127]
    v_mfma_f32_16x16x32_bf16 v[128:131], v[224:227], v[24:27], 0
    v_mfma_f32_16x16x32_bf16 v[132:135], v[240:243], v[24:27], 0
    v_mfma_f32_16x16x32_bf16 v[136:139], v[224:227], v[40:43], 0
    v_mfma_f32_16x16x32_bf16 v[140:143], v[240:243], v[40:43], 0
    v_mfma_f32_16x16x32_bf16 v[128:131], v[228:231], v[28:31], v[128:131]
    v_cvt_pk_bf16_f32 v112, v112, v113
    v_cvt_pk_bf16_f32 v113, v114, v115
    v_mfma_f32_16x16x32_bf16 v[132:135], v[244:247], v[28:31], v[132:135]
    v_cvt_pk_bf16_f32 v114, v116, v117
    v_cvt_pk_bf16_f32 v115, v118, v119
    v_mfma_f32_16x16x32_bf16 v[136:139], v[228:231], v[44:47], v[136:139]
    v_cvt_pk_bf16_f32 v120, v120, v121
    v_cvt_pk_bf16_f32 v121, v122, v123
    v_mfma_f32_16x16x32_bf16 v[140:143], v[244:247], v[44:47], v[140:143]
    v_cvt_pk_bf16_f32 v122, v124, v125
    v_cvt_pk_bf16_f32 v123, v126, v127
    s_cmp_lg_u32 s23, 0
    s_cbranch_scc1 M_ls_16
    buffer_store_dwordx4 v[112:115], v4, s[8:11], s48 offen offset:192
    buffer_store_dwordx4 v[120:123], v4, s[8:11], s27 offen offset:192
M_ls_16_r:
    v_mfma_f32_16x16x32_bf16 v[128:131], v[232:235], v[32:35], v[128:131]
    v_mfma_f32_16x16x32_bf16 v[132:135], v[248:251], v[32:35], v[132:135]
    v_mfma_f32_16x16x32_bf16 v[136:139], v[232:235], v[48:51], v[136:139]
    v_mfma_f32_16x16x32_bf16 v[140:143], v[248:251], v[48:51], v[140:143]
    v_mfma_f32_16x16x32_bf16 v[128:131], v[236:239], v[36:39], v[128:131]
    v_mfma_f32_16x16x32_bf16 v[132:135], v[252:255], v[36:39], v[132:135]
    v_mfma_f32_16x16x32_bf16 v[136:139], v[236:239], v[52:55], v[136:139]
    v_mfma_f32_16x16x32_bf16 v[140:143], v[252:255], v[52:55], v[140:143]
    s_nop 4
    v_cvt_pk_bf16_f32 v128, v128, v129
    v_cvt_pk_bf16_f32 v129, v130, v131
    v_cvt_pk_bf16_f32 v130, v132, v133
    v_cvt_pk_bf16_f32 v131, v134, v135
    v_cvt_pk_bf16_f32 v136, v136, v137
    v_cvt_pk_bf16_f32 v137, v138, v139
    v_cvt_pk_bf16_f32 v138, v140, v141
    v_cvt_pk_bf16_f32 v139, v142, v143
    s_cmp_lg_u32 s23, 0
    s_cbranch_scc1 M_ls_17
    buffer_store_dwordx4 v[128:131], v4, s[8:11], s48 offen offset:256
    buffer_store_dwordx4 v[136:139], v4, s[8:11], s27 offen offset:256
M_ls_17_r:
    s_add_u32 s66, s44, 4
    s_cmp_lt_u32 s66, 64
    s_cbranch_scc1 M_q_front
    s_waitcnt vmcnt(0)
    s_barrier
    s_cmp_lg_u32 s21, 0
    s_cbranch_scc1 M_q_na
    s_mov_b64 exec, 1
    v_mov_b32 v10, s22
    v_mov_b32 v11, 1
    s_cmp_lg_u32 s23, 0
    s_cbranch_scc1 M_ls_18
    buffer_store_byte v11, v10, s[8:11], s62 offen
M_ls_18_r:
    s_mov_b64 exec, -1
M_q_na:
M_q_back2:
    s_lshr_b32 s27, s44, 2
    s_lshl_b32 s28, s21, 8
    s_or_b32 s27, s27, s28
    s_cmp_lg_u32 s27, 782
    s_cbranch_scc1 M_q_nf1
    s_lshl_b32 s27, s20, 12
    s_lshl_b32 s28, s22, 7
    s_add_u32 s27, s27, s28
    s_add_u32 s27, s27, 167936000
    s_lshl_b32 s28, s101, 1
    s_add_u32 s28, s28, 1
    v_mov_b32 v11, s28
    s_mov_b64 exec, 1
    buffer_store_dword v11, v0, s[8:11], s27 offen sc1
    s_mov_b64 exec, -1
M_q_nf1:
    s_cmp_lg_u32 s21, 0
    s_cbranch_scc1 M_ar_19
    s_mov_b64 exec, 0xff
    s_mov_b32 s30, 0
    v_lshrrev_b32 v190, 2, v0
M_ar_20:
    buffer_load_dword v191, v190, s[8:11], s62 offen sc1
    s_add_u32 s30, s30, 1
    s_cmp_ge_u32 s30, 60000
    s_cbranch_scc1 M_fail
    s_waitcnt vmcnt(0)
    v_cmp_ne_u32 vcc, 0x01010101, v191
    s_cbranch_vccz M_ar_20d
    s_branch M_ar_20
M_ar_20d:
    s_mov_b64 exec, -1
M_ar_19:
    s_barrier
    buffer_load_dwordx4 v[24:27], v5, s[8:11], s48 offen sc1
    buffer_load_dwordx4 v[56:59], v6, s[8:11], s48 offen offset:256 sc1
    s_add_u32 s27, s48, 5120
    buffer_load_dwordx4 v[28:31], v5, s[8:11], s27 offen sc1
    s_add_u32 s27, s48, 10240
    buffer_load_dwordx4 v[32:35], v5, s[8:11], s27 offen sc1
    s_add_u32 s27, s48, 15360
    buffer_load_dwordx4 v[36:39], v5, s[8:11], s27 offen sc1
    s_add_u32 s27, s48, 20480
    buffer_load_dwordx4 v[40:43], v5, s[8:11], s27 offen sc1
    buffer_load_dwordx4 v[60:63], v6, s[8:11], s27 offen offset:256 sc1
    s_add_u32 s27, s48, 25600
    buffer_load_dwordx4 v[44:47], v5, s[8:11], s27 offen sc1
    s_add_u32 s27, s48, 30720
    buffer_load_dwordx4 v[48:51], v5, s[8:11], s27 offen sc1
    s_add_u32 s27, s48, 35840
    buffer_load_dwordx4 v[52:55], v5, s[8:11], s27 offen sc1
    v_lshlrev_b32 v72, 16, v20
    v_and_b32 v73, 0xffff0000, v20
    v_lshlrev_b32 v74, 16, v21
    v_and_b32 v75, 0xffff0000, v21
    v_lshlrev_b32 v76, 16, v22
    v_and_b32 v77, 0xffff0000, v22
    v_lshlrev_b32 v78, 16, v23
    v_and_b32 v79, 0xffff0000, v23
    s_add_u32 s67, s55, s54
    s_waitcnt vmcnt(9)
    v_mfma_f32_16x16x32_bf16 v[64:67], v[16:19], v[24:27], 0
    s_waitcnt vmcnt(8)
    v_mfma_f32_16x16x32_bf16 v[68:71], v[16:19], v[56:59], 0
    s_waitcnt vmcnt(7)
    v_mfma_f32_16x16x32_bf16 v[64:67], v[16:19], v[28:31], v[64:67]
    s_waitcnt vmcnt(6)
    v_mfma_f32_16x16x32_bf16 v[64:67], v[16:19], v[32:35], v[64:67]
    s_waitcnt vmcnt(5)
    v_mfma_f32_16x16x32_bf16 v[64:67], v[16:19], v[36:39], v[64:67]
    s_waitcnt vmcnt(4)
    v_mfma_f32_16x16x32_bf16 v[64:67], v[16:19], v[40:43], v[64:67]
    s_waitcnt vmcnt(3)
    v_mfma_f32_16x16x32_bf16 v[68:71], v[16:19], v[60:63], v[68:71]
    s_waitcnt vmcnt(2)
    v_mfma_f32_16x16x32_bf16 v[64:67], v[16:19], v[44:47], v[64:67]
    s_waitcnt vmcnt(1)
    v_mfma_f32_16x16x32_bf16 v[64:67], v[16:19], v[48:51], v[64:67]
    s_waitcnt vmcnt(0)
    v_mfma_f32_16x16x32_bf16 v[64:67], v[16:19], v[52:55], v[64:67]
    s_nop 1
    v_add_f32_dpp v68, v68, v68 row_ror:8 row_mask:0xf bank_mask:0xf
    v_add_f32_dpp v69, v69, v69 row_ror:8 row_mask:0xf bank_mask:0xf
    v_add_f32_dpp v70, v70, v70 row_ror:8 row_mask:0xf bank_mask:0xf
    v_add_f32_dpp v71, v71, v71 row_ror:8 row_mask:0xf bank_mask:0xf
    v_add_f32_dpp v68, v68, v68 row_ror:4 row_mask:0xf bank_mask:0xf
    v_add_f32_dpp v69, v69, v69 row_ror:4 row_mask:0xf bank_mask:0xf
    v_add_f32_dpp v70, v70, v70 row_ror:4 row_mask:0xf bank_mask:0xf
    v_add_f32_dpp v71, v71, v71 row_ror:4 row_mask:0xf bank_mask:0xf
    v_pk_add_f32 v[72:73], v[72:73], v[64:65]
    v_pk_add_f32 v[74:75], v[74:75], v[66:67]
    v_pk_add_f32 v[76:77], v[76:77], v[68:69]
    v_pk_add_f32 v[78:79], v[78:79], v[70:71]
    v_cvt_pk_bf16_f32 v20, v72, v73
    v_cvt_pk_bf16_f32 v21, v74, v75
    v_cvt_pk_bf16_f32 v22, v76, v77
    v_cvt_pk_bf16_f32 v23, v78, v79
    v_lshlrev_b32 v72, 16, v20
    v_and_b32 v73, 0xffff0000, v20
    v_lshlrev_b32 v74, 16, v21
    v_and_b32 v75, 0xffff0000, v21
    v_lshlrev_b32 v76, 16, v22
    v_and_b32 v77, 0xffff0000, v22
    v_lshlrev_b32 v78, 16, v23
    v_and_b32 v79, 0xffff0000, v23
    v_pk_add_f32 v[92:93], v[72:73], v[74:75]
    v_pk_add_f32 v[94:95], v[76:77], v[78:79]
    v_add_f32 v92, v92, v93
    v_add_f32 v94, v94, v95
    v_mul_f32 v94, 0x3e800000, v94
    v_add_f32 v80, v92, v94
    s_nop 1
    v_add_f32_dpp v80, v80, v80 row_ror:8 row_mask:0xf bank_mask:0xf
    s_nop 1
    v_add_f32_dpp v80, v80, v80 row_ror:4 row_mask:0xf bank_mask:0xf
    s_nop 1
    v_add_f32_dpp v80, v80, v80 row_ror:2 row_mask:0xf bank_mask:0xf
    s_nop 1
    v_add_f32_dpp v80, v80, v80 row_ror:1 row_mask:0xf bank_mask:0xf
    v_mov_b32 v178, v80
    s_nop 1
    v_permlane16_swap_b32 v80, v178
    v_add_f32 v80, v80, v178
    v_mul_f32 v80, 0x3bcccccd, v80
    v_pk_add_f32 v[84:85], v[72:73], v[80:81] op_sel_hi:[1,0] neg_lo:[0,1] neg_hi:[0,1]
    v_pk_add_f32 v[86:87], v[74:75], v[80:81] op_sel_hi:[1,0] neg_lo:[0,1] neg_hi:[0,1]
    v_pk_add_f32 v[88:89], v[76:77], v[80:81] op_sel_hi:[1,0] neg_lo:[0,1] neg_hi:[0,1]
    v_pk_add_f32 v[90:91], v[78:79], v[80:81] op_sel_hi:[1,0] neg_lo:[0,1] neg_hi:[0,1]
    v_pk_mul_f32 v[84:85], v[84:85], v[84:85]
    v_pk_mul_f32 v[86:87], v[86:87], v[86:87]
    v_pk_mul_f32 v[88:89], v[88:89], v[88:89]
    v_pk_mul_f32 v[90:91], v[90:91], v[90:91]
    v_pk_add_f32 v[92:93], v[84:85], v[86:87]
    v_pk_add_f32 v[94:95], v[88:89], v[90:91]
    v_add_f32 v92, v92, v93
    v_add_f32 v94, v94, v95
    v_mul_f32 v94, 0x3e800000, v94
    v_add_f32 v81, v92, v94
    s_nop 1
    v_add_f32_dpp v81, v81, v81 row_ror:8 row_mask:0xf bank_mask:0xf
    s_nop 1
    v_add_f32_dpp v81, v81, v81 row_ror:4 row_mask:0xf bank_mask:0xf
    s_nop 1
    v_add_f32_dpp v81, v81, v81 row_ror:2 row_mask:0xf bank_mask:0xf
    s_nop 1
    v_add_f32_dpp v81, v81, v81 row_ror:1 row_mask:0xf bank_mask:0xf
    v_mov_b32 v178, v81
    s_nop 1
    v_permlane16_swap_b32 v81, v178
    v_add_f32 v81, v81, v178
    s_lshl_b32 s27, s21, 3
    s_add_u32 s27, s27, 98304
    v_mov_b32 v10, s27
    v_mov_b32 v11, 98304
    ds_write_b64 v10, v[80:81]
    s_waitcnt lgkmcnt(0)
    s_barrier
    ds_read_b128 v[84:87], v11 offset:0
    ds_read_b128 v[88:91], v11 offset:16
    s_waitcnt lgkmcnt(1)
    v_pk_add_f32 v[80:81], v[84:85], v[86:87]
    s_waitcnt lgkmcnt(0)
    v_pk_add_f32 v[92:93], v[88:89], v[90:91]
    v_pk_add_f32 v[80:81], v[80:81], v[92:93]
    v_mul_f32 v80, 0x3e800000, v80
    v_sub_f32 v84, v84, v80
    v_sub_f32 v86, v86, v80
    v_sub_f32 v88, v88, v80
    v_sub_f32 v90, v90, v80
    v_mul_f32 v85, 0x43200000, v84
    v_mul_f32 v87, 0x43200000, v86
    v_mul_f32 v89, 0x43200000, v88
    v_mul_f32 v91, 0x43200000, v90
    v_fmac_f32 v81, v84, v85
    v_fmac_f32 v81, v86, v87
    v_fmac_f32 v81, v88, v89
    v_fmac_f32 v81, v90, v91
    v_mov_b32 v82, 0x3727c5ac
    v_fmac_f32 v82, 0x3acccccd, v81
    v_rsq_f32 v82, v82
    v_pk_add_f32 v[72:73], v[72:73], v[80:81] op_sel_hi:[1,0] neg_lo:[0,1] neg_hi:[0,1]
    v_pk_add_f32 v[74:75], v[74:75], v[80:81] op_sel_hi:[1,0] neg_lo:[0,1] neg_hi:[0,1]
    v_pk_add_f32 v[76:77], v[76:77], v[80:81] op_sel_hi:[1,0] neg_lo:[0,1] neg_hi:[0,1]
    v_pk_add_f32 v[78:79], v[78:79], v[80:81] op_sel_hi:[1,0] neg_lo:[0,1] neg_hi:[0,1]
    v_pk_mul_f32 v[72:73], v[72:73], v[82:83] op_sel_hi:[1,0]
    v_pk_mul_f32 v[74:75], v[74:75], v[82:83] op_sel_hi:[1,0]
    v_pk_mul_f32 v[76:77], v[76:77], v[82:83] op_sel_hi:[1,0]
    v_pk_mul_f32 v[78:79], v[78:79], v[82:83] op_sel_hi:[1,0]
    v_cvt_pk_f16_f32 v72, v72, v73
    v_cvt_pk_f16_f32 v73, v74, v75
    v_cvt_pk_f16_f32 v74, v76, v77
    v_cvt_pk_f16_f32 v75, v78, v79
    s_cmp_lg_u32 s23, 0
    s_cbranch_scc1 M_ls_21
    s_mov_b32 exec_hi, 0
    buffer_store_dwordx2 v[72:73], v12, s[8:11], s63 offen
    s_mov_b32 exec_lo, 0x000f000f
    buffer_store_dwordx2 v[74:75], v12, s[8:11], s64 offen
    s_mov_b64 exec, -1
M_ls_21_r:
    s_add_u32 s62, s51, 16384
    s_waitcnt vmcnt(0)
    s_barrier
    s_cmp_lg_u32 s21, 0
    s_cbranch_scc1 M_q_nb
    s_mov_b64 exec, 1
    v_mov_b32 v10, s22
    v_mov_b32 v11, 1
    s_cmp_lg_u32 s23, 0
    s_cbranch_scc1 M_ls_22
    buffer_store_byte v11, v10, s[8:11], s62 offen
M_ls_22_r:
    s_mov_b64 exec, -1
M_q_nb:
    s_cmp_ge_u32 s22, 20
    s_cbranch_scc1 M_q_nd
    s_cmp_lg_u32 s21, 0
    s_cbranch_scc1 M_ar_23
    s_mov_b64 exec, 0xff
    s_mov_b32 s30, 0
    v_lshrrev_b32 v190, 2, v0
M_ar_24:
    buffer_load_dword v191, v190, s[8:11], s62 offen sc1
    s_add_u32 s30, s30, 1
    s_cmp_ge_u32 s30, 60000
    s_cbranch_scc1 M_fail
    s_waitcnt vmcnt(0)
    v_cmp_ne_u32 vcc, 0x01010101, v191
    s_cbranch_vccz M_ar_24d
    s_branch M_ar_24
M_ar_24d:
    s_mov_b64 exec, -1
M_ar_23:
    s_barrier
    s_cmp_ge_u32 s21, 2
    s_cbranch_scc1 M_q_nd
    s_mul_i32 s27, s21, 20480
    s_add_u32 s27, s27, s63
    buffer_load_dwordx4 v[24:27], v0, s[8:11], s27 offen offset:0 sc1
    buffer_load_dwordx4 v[28:31], v0, s[8:11], s27 offen offset:1024 sc1
    buffer_load_dwordx4 v[32:35], v0, s[8:11], s27 offen offset:2048 sc1
    buffer_load_dwordx4 v[36:39], v0, s[8:11], s27 offen offset:3072 sc1
    s_add_u32 s27, s27, 4096
    buffer_load_dwordx4 v[40:43], v0, s[8:11], s27 offen offset:0 sc1
    buffer_load_dwordx4 v[44:47], v0, s[8:11], s27 offen offset:1024 sc1
    buffer_load_dwordx4 v[48:51], v0, s[8:11], s27 offen offset:2048 sc1
    buffer_load_dwordx4 v[52:55], v0, s[8:11], s27 offen offset:3072 sc1
    s_add_u32 s27, s27, 4096
    buffer_load_dwordx4 v[56:59], v0, s[8:11], s27 offen offset:0 sc1
    buffer_load_dwordx4 v[60:63], v0, s[8:11], s27 offen offset:1024 sc1
    buffer_load_dwordx4 v[64:67], v0, s[8:11], s27 offen offset:2048 sc1
    buffer_load_dwordx4 v[68:71], v0, s[8:11], s27 offen offset:3072 sc1
    s_add_u32 s27, s27, 4096
    buffer_load_dwordx4 v[72:75], v0, s[8:11], s27 offen offset:0 sc1
    buffer_load_dwordx4 v[76:79], v0, s[8:11], s27 offen offset:1024 sc1
    buffer_load_dwordx4 v[80:83], v0, s[8:11], s27 offen offset:2048 sc1
    buffer_load_dwordx4 v[84:87], v0, s[8:11], s27 offen offset:3072 sc1
    s_add_u32 s27, s27, 4096
    buffer_load_dwordx4 v[88:91], v0, s[8:11], s27 offen offset:0 sc1
    buffer_load_dwordx4 v[92:95], v0, s[8:11], s27 offen offset:1024 sc1
    buffer_load_dwordx4 v[96:99], v0, s[8:11], s27 offen offset:2048 sc1
    buffer_load_dwordx4 v[100:103], v0, s[8:11], s27 offen offset:3072 sc1
    s_add_u32 s27, s27, 4096
    ds_read_b128 v[112:115], v14 offset:0
    ds_read_b128 v[116:119], v14 offset:20480
    ds_read_b128 v[120:123], v14 offset:1024
    ds_read_b128 v[124:127], v14 offset:21504
    ds_read_b128 v[128:131], v14 offset:2048
    ds_read_b128 v[132:135], v14 offset:22528
    ds_read_b128 v[136:139], v14 offset:3072
    s_lshl_b32 s27, s44, 7
    s_mul_i32 s68, s101, 6291456
    s_add_u32 s68, s68, s27
    s_add_u32 s68, s68, 176160768
    s_waitcnt vmcnt(19) lgkmcnt(6)
    v_mfma_f32_16x16x32_f16 v[104:107], v[24:27], v[112:115], 0
    ds_read_b128 v[140:143], v14 offset:23552
    s_waitcnt lgkmcnt(6)
    v_mfma_f32_16x16x32_f16 v[108:111], v[24:27], v[116:119], 0
    ds_read_b128 v[112:115], v14 offset:4096
    s_waitcnt vmcnt(18) lgkmcnt(6)
    v_mfma_f32_16x16x32_f16 v[104:107], v[28:31], v[120:123], v[104:107]
    ds_read_b128 v[116:119], v14 offset:24576
    s_waitcnt lgkmcnt(6)
    v_mfma_f32_16x16x32_f16 v[108:111], v[28:31], v[124:127], v[108:111]
    ds_read_b128 v[120:123], v14 offset:5120
    s_waitcnt vmcnt(17) lgkmcnt(6)
    v_mfma_f32_16x16x32_f16 v[104:107], v[32:35], v[128:131], v[104:107]
    ds_read_b128 v[124:127], v14 offset:25600
    s_waitcnt lgkmcnt(6)
    v_mfma_f32_16x16x32_f16 v[108:111], v[32:35], v[132:135], v[108:111]
    ds_read_b128 v[128:131], v14 offset:6144
    s_waitcnt vmcnt(16) lgkmcnt(6)
    v_mfma_f32_16x16x32_f16 v[104:107], v[36:39], v[136:139], v[104:107]
    ds_read_b128 v[132:135], v14 offset:26624
    s_waitcnt lgkmcnt(6)
    v_mfma_f32_16x16x32_f16 v[108:111], v[36:39], v[140:143], v[108:111]
    ds_read_b128 v[136:139], v14 offset:7168
    s_waitcnt vmcnt(15) lgkmcnt(6)
    v_mfma_f32_16x16x32_f16 v[104:107], v[40:43], v[112:115], v[104:107]
    ds_read_b128 v[140:143], v14 offset:27648
    s_waitcnt lgkmcnt(6)
    v_mfma_f32_16x16x32_f16 v[108:111], v[40:43], v[116:119], v[108:111]
    ds_read_b128 v[112:115], v14 offset:8192
    s_waitcnt vmcnt(14) lgkmcnt(6)
    v_mfma_f32_16x16x32_f16 v[104:107], v[44:47], v[120:123], v[104:107]
    ds_read_b128 v[116:119], v14 offset:28672
    s_waitcnt lgkmcnt(6)
    v_mfma_f32_16x16x32_f16 v[108:111], v[44:47], v[124:127], v[108:111]
    ds_read_b128 v[120:123], v14 offset:9216
    s_waitcnt vmcnt(13) lgkmcnt(6)
    v_mfma_f32_16x16x32_f16 v[104:107], v[48:51], v[128:131], v[104:107]
    ds_read_b128 v[124:127], v14 offset:29696
    s_waitcnt lgkmcnt(6)
    v_mfma_f32_16x16x32_f16 v[108:111], v[48:51], v[132:135], v[108:111]
    ds_read_b128 v[128:131], v14 offset:10240
    s_waitcnt vmcnt(12) lgkmcnt(6)
    v_mfma_f32_16x16x32_f16 v[104:107], v[52:55], v[136:139], v[104:107]
    ds_read_b128 v[132:135], v14 offset:30720
    s_waitcnt lgkmcnt(6)
    v_mfma_f32_16x16x32_f16 v[108:111], v[52:55], v[140:143], v[108:111]
    ds_read_b128 v[136:139], v14 offset:11264
    s_waitcnt vmcnt(11) lgkmcnt(6)
    v_mfma_f32_16x16x32_f16 v[104:107], v[56:59], v[112:115], v[104:107]
    ds_read_b128 v[140:143], v14 offset:31744
    s_waitcnt lgkmcnt(6)
    v_mfma_f32_16x16x32_f16 v[108:111], v[56:59], v[116:119], v[108:111]
    ds_read_b128 v[112:115], v14 offset:12288
    s_waitcnt vmcnt(10) lgkmcnt(6)
    v_mfma_f32_16x16x32_f16 v[104:107], v[60:63], v[120:123], v[104:107]
    ds_read_b128 v[116:119], v14 offset:32768
    s_waitcnt lgkmcnt(6)
    v_mfma_f32_16x16x32_f16 v[108:111], v[60:63], v[124:127], v[108:111]
    ds_read_b128 v[120:123], v14 offset:13312
    s_waitcnt vmcnt(9) lgkmcnt(6)
    v_mfma_f32_16x16x32_f16 v[104:107], v[64:67], v[128:131], v[104:107]
    ds_read_b128 v[124:127], v14 offset:33792
    s_waitcnt lgkmcnt(6)
    v_mfma_f32_16x16x32_f16 v[108:111], v[64:67], v[132:135], v[108:111]
    ds_read_b128 v[128:131], v14 offset:14336
    s_waitcnt vmcnt(8) lgkmcnt(6)
    v_mfma_f32_16x16x32_f16 v[104:107], v[68:71], v[136:139], v[104:107]
    ds_read_b128 v[132:135], v14 offset:34816
    s_waitcnt lgkmcnt(6)
    v_mfma_f32_16x16x32_f16 v[108:111], v[68:71], v[140:143], v[108:111]
    ds_read_b128 v[136:139], v14 offset:15360
    s_waitcnt vmcnt(7) lgkmcnt(6)
    v_mfma_f32_16x16x32_f16 v[104:107], v[72:75], v[112:115], v[104:107]
    ds_read_b128 v[140:143], v14 offset:35840
    s_waitcnt lgkmcnt(6)
    v_mfma_f32_16x16x32_f16 v[108:111], v[72:75], v[116:119], v[108:111]
    ds_read_b128 v[112:115], v14 offset:16384
    s_waitcnt vmcnt(6) lgkmcnt(6)
    v_mfma_f32_16x16x32_f16 v[104:107], v[76:79], v[120:123], v[104:107]
    ds_read_b128 v[116:119], v14 offset:36864
    s_waitcnt lgkmcnt(6)
    v_mfma_f32_16x16x32_f16 v[108:111], v[76:79], v[124:127], v[108:111]
    ds_read_b128 v[120:123], v14 offset:17408
    s_waitcnt vmcnt(5) lgkmcnt(6)
    v_mfma_f32_16x16x32_f16 v[104:107], v[80:83], v[128:131], v[104:107]
    ds_read_b128 v[124:127], v14 offset:37888
    s_waitcnt lgkmcnt(6)
    v_mfma_f32_16x16x32_f16 v[108:111], v[80:83], v[132:135], v[108:111]
    ds_read_b128 v[128:131], v14 offset:18432
    s_waitcnt vmcnt(4) lgkmcnt(6)
    v_mfma_f32_16x16x32_f16 v[104:107], v[84:87], v[136:139], v[104:107]
    ds_read_b128 v[132:135], v14 offset:38912
    s_waitcnt lgkmcnt(6)
    v_mfma_f32_16x16x32_f16 v[108:111], v[84:87], v[140:143], v[108:111]
    ds_read_b128 v[136:139], v14 offset:19456
    s_waitcnt vmcnt(3) lgkmcnt(6)
    v_mfma_f32_16x16x32_f16 v[104:107], v[88:91], v[112:115], v[104:107]
    ds_read_b128 v[140:143], v14 offset:39936
    s_waitcnt lgkmcnt(6)
    v_mfma_f32_16x16x32_f16 v[108:111], v[88:91], v[116:119], v[108:111]
    s_waitcnt vmcnt(2) lgkmcnt(5)
    v_mfma_f32_16x16x32_f16 v[104:107], v[92:95], v[120:123], v[104:107]
    s_waitcnt lgkmcnt(4)
    v_mfma_f32_16x16x32_f16 v[108:111], v[92:95], v[124:127], v[108:111]
    s_waitcnt vmcnt(1) lgkmcnt(3)
    v_mfma_f32_16x16x32_f16 v[104:107], v[96:99], v[128:131], v[104:107]
    s_waitcnt lgkmcnt(2)
    v_mfma_f32_16x16x32_f16 v[108:111], v[96:99], v[132:135], v[108:111]
    s_waitcnt vmcnt(0) lgkmcnt(1)
    v_mfma_f32_16x16x32_f16 v[104:107], v[100:103], v[136:139], v[104:107]
    s_waitcnt lgkmcnt(0)
    v_mfma_f32_16x16x32_f16 v[108:111], v[100:103], v[140:143], v[108:111]
    s_nop 7
M_q_nd:
    s_add_u32 s48, s48, s49
    s_sub_u32 s49, 0, s49
    s_add_u32 s51, s51, 128
    s_add_u32 s44, s44, 4
    s_cmp_lt_u32 s44, 64
    s_cbranch_scc1 M_q_top
    s_cmp_ge_u32 s21, 2
    s_cbranch_scc1 M_q_e1
    s_add_u32 s28, s68, 131072
    buffer_store_dwordx4 v[104:107], v13, s[8:11], s68 offen sc1
    buffer_store_dwordx4 v[108:111], v13, s[8:11], s28 offen sc1
    s_mov_b32 exec_hi, 0
    buffer_store_dwordx2 v[20:21], v7, s[8:11], s67 offen sc1
    s_mov_b32 exec_lo, 0x000f000f
    buffer_store_dwordx2 v[22:23], v7, s[8:11], s67 offen offset:256 sc1
    s_mov_b64 exec, -1
    s_waitcnt vmcnt(2)
    s_barrier
    s_cmp_lg_u32 s21, 0
    s_cbranch_scc1 M_bphase
    s_lshl_b32 s27, s20, 12
    s_lshl_b32 s28, s22, 7
    s_add_u32 s27, s27, s28
    s_add_u32 s27, s27, 167936000
    s_lshl_b32 s28, s101, 1
    s_add_u32 s28, s28, 2
    v_mov_b32 v11, s28
    s_mov_b64 exec, 1
    buffer_store_dword v11, v0, s[8:11], s27 offen sc1
    s_mov_b64 exec, -1
    s_branch M_bphase
M_q_e1:
    s_barrier
    s_add_u32 s28, s68, 131072
    buffer_store_dwordx4 v[104:107], v13, s[8:11], s68 offen sc1
    buffer_store_dwordx4 v[108:111], v13, s[8:11], s28 offen sc1
    s_mov_b32 exec_hi, 0
    buffer_store_dwordx2 v[20:21], v7, s[8:11], s67 offen sc1
    s_mov_b32 exec_lo, 0x000f000f
    buffer_store_dwordx2 v[22:23], v7, s[8:11], s67 offen offset:256 sc1
    s_mov_b64 exec, -1
M_bphase:
    s_sub_u32 s82, s20, 2
    s_mov_b32 s83, s21
    s_mov_b32 s84, s22
    s_mov_b32 s85, s23
    s_lshl_b32 s87, s82, 5
    s_add_u32 s87, s87, s22
    s_mul_i32 s86, s101, 24576
    s_mul_i32 s80, s101, 8388608
    s_add_u32 s80, s80, 134217728
    s_load_dwordx2 s[16:17], s[0:1], 80
    s_waitcnt lgkmcnt(0)
    s_and_b32 s17, s17, 0xffff
    s_cmp_eq_u32 s101, 1
    s_cbranch_scc1 M_osrd
    s_add_u32 s16, s8, 138412032
    s_addc_u32 s17, s9, 0
M_osrd:
    s_mul_i32 s27, s84, 26
    s_lshr_b32 s27, s27, 8
    s_mul_i32 s28, s27, 10
    s_sub_u32 s88, s84, s28
    s_mul_i32 s28, s82, 3
    s_sub_u32 s28, s28, 6
    s_lshl_b32 s29, s82, 1
    s_add_u32 s29, s29, 12
    s_cmp_lt_u32 s82, 2
    s_cselect_b32 s28, s29, s28
    s_cselect_b32 s29, 2, 3
    s_add_u32 s28, s28, s27
    s_lshl_b32 s89, s28, 2
    s_add_u32 s89, s89, s83
    s_cmp_lt_u32 s27, s29
    s_cselect_b32 s89, s89, 64
    s_cmp_eq_u32 s87, 160
    s_cselect_b32 s81, 191, s87
    s_cmp_eq_u32 s87, 191
    s_cselect_b32 s81, 160, s81
    s_cmp_lg_u32 s101, 0
    s_cbranch_scc1 M_tabok
    s_cmp_ge_u32 s82, 2
    s_cbranch_scc1 M_gb_27
    s_waitcnt vmcnt(0) lgkmcnt(0)
    s_barrier
    s_cmp_lg_u32 s83, 0
    s_cbranch_scc1 M_gb_27
    s_mov_b32 s23, s85
    s_add_u32 s28, s86, 167837696
    s_lshl_b32 s27, s82, 7
    s_mov_b64 exec, 1
    s_add_u32 s31, s27, s84
    v_mov_b32 v190, s31
    v_mov_b32 v191, 1
    s_cmp_lg_u32 s23, 0
    s_cbranch_scc1 M_ls_28
    buffer_store_byte v191, v190, s[8:11], s28 offen
M_ls_28_r:
    s_cmp_lg_u32 s84, 31
    s_cbranch_scc1 M_gb_25
    s_mov_b64 exec, -1
    v_mbcnt_lo_u32_b32 v189, -1, 0
    s_mov_b64 exec, 0xff
    v_lshl_add_u32 v190, v189, 2, s27
    s_mov_b32 s30, 0
M_gs_29:
    buffer_load_dword v191, v190, s[8:11], s28 offen sc1
    s_add_u32 s30, s30, 1
    s_cmp_ge_u32 s30, 240000
    s_cbranch_scc1 M_fail
    s_waitcnt vmcnt(0)
    v_cmp_ne_u32 vcc, 0x1010101, v191
    s_cbranch_vccnz M_gs_29
    s_mov_b64 exec, 1
    v_mov_b32 v190, s27
    v_mov_b32 v191, 1
    buffer_store_dword v191, v190, s[8:11], s28 offen offset:1024 sc1
M_gb_25:
    s_mov_b64 exec, -1
M_gb_27:
    s_cmp_lg_u32 s83, 0
    s_cbranch_scc1 M_gb_26
    s_add_u32 s28, s86, 167837696
    v_mbcnt_lo_u32_b32 v189, -1, 0
    s_mov_b64 exec, 0x3
    v_lshlrev_b32 v190, 7, v189
    v_add_u32 v190, 1024, v190
    s_mov_b32 s30, 0
M_gs_30:
    buffer_load_dword v191, v190, s[8:11], s28 offen sc1
    s_add_u32 s30, s30, 1
    s_cmp_ge_u32 s30, 240000
    s_cbranch_scc1 M_fail
    s_waitcnt vmcnt(0)
    v_cmp_ne_u32 vcc, 0x1, v191
    s_cbranch_vccnz M_gs_30
    s_mov_b64 exec, -1
M_gb_26:
    s_barrier
M_tabok:
    v_mbcnt_lo_u32_b32 v0, -1, 0
    v_mbcnt_hi_u32_b32 v0, -1, v0
    s_lshl_b32 s27, s83, 6
    v_add_u32 v0, s27, v0
    s_mov_b32 s2, s81
    v_and_b32 v3, 255, v0
    v_cvt_f32_u32 v3, v3
    v_mul_f32 v4, 0xba000000, v3
    v_cos_f32 v48, v4
    v_sin_f32 v49, v4
    v_mul_f32 v4, 0xba800000, v3
    v_cos_f32 v50, v4
    v_sin_f32 v51, v4
    v_mul_f32 v4, 0xbac00000, v3
    v_cos_f32 v52, v4
    v_sin_f32 v53, v4
    v_mul_f32 v4, 0xbb000000, v3
    v_cos_f32 v54, v4
    v_sin_f32 v55, v4
    v_mul_f32 v4, 0xbb200000, v3
    v_cos_f32 v56, v4
    v_sin_f32 v57, v4
    v_mul_f32 v4, 0xbb400000, v3
    v_cos_f32 v58, v4
    v_sin_f32 v59, v4
    v_mul_f32 v4, 0xbb600000, v3
    v_cos_f32 v60, v4
    v_sin_f32 v61, v4
    v_and_b32 v3, 31, v0
    v_cvt_f32_u32 v3, v3
    v_mul_f32 v4, 0xbb800000, v3
    v_cos_f32 v62, v4
    v_sin_f32 v63, v4
    v_mul_f32 v4, 0xbc000000, v3
    v_cos_f32 v64, v4
    v_sin_f32 v65, v4
    v_mul_f32 v4, 0xbc400000, v3
    v_cos_f32 v66, v4
    v_sin_f32 v67, v4
    v_mul_f32 v4, 0xbc800000, v3
    v_cos_f32 v68, v4
    v_sin_f32 v69, v4
    v_mul_f32 v4, 0xbca00000, v3
    v_cos_f32 v70, v4
    v_sin_f32 v71, v4
    v_mul_f32 v4, 0xbcc00000, v3
    v_cos_f32 v72, v4
    v_sin_f32 v73, v4
    v_mul_f32 v4, 0xbce00000, v3
    v_cos_f32 v74, v4
    v_sin_f32 v75, v4
    v_and_b32 v3, 3, v0
    v_cvt_f32_u32 v3, v3
    v_mul_f32 v4, 0xbd000000, v3
    v_cos_f32 v76, v4
    v_sin_f32 v77, v4
    v_mul_f32 v4, 0xbd800000, v3
    v_cos_f32 v78, v4
    v_sin_f32 v79, v4
    v_mul_f32 v4, 0xbdc00000, v3
    v_cos_f32 v80, v4
    v_sin_f32 v81, v4
    v_mul_f32 v4, 0xbe000000, v3
    v_cos_f32 v82, v4
    v_sin_f32 v83, v4
    v_mul_f32 v4, 0xbe200000, v3
    v_cos_f32 v84, v4
    v_sin_f32 v85, v4
    v_mul_f32 v4, 0xbe400000, v3
    v_cos_f32 v86, v4
    v_sin_f32 v87, v4
    v_mul_f32 v4, 0xbe600000, v3
    v_cos_f32 v88, v4
    v_sin_f32 v89, v4
    v_lshlrev_b32 v3, 3, v0
    v_lshrrev_b32 v4, 5, v0
    v_mul_u32_u24 v4, 2304, v4
    v_add_u32 v3, 81920, v3
    v_add_u32 v4, 81920, v4
    v_and_b32 v5, 31, v0
    v_lshl_add_u32 v5, v5, 3, v4
    v_bfe_u32 v6, v0, 2, 3
    v_mul_u32_u24 v6, 288, v6
    v_add_u32 v6, v6, v4
    v_and_b32 v7, 3, v0
    v_lshl_add_u32 v100, v7, 6, v6
    v_lshl_add_u32 v6, v7, 3, v6
    v_lshrrev_b32 v101, 4, v0
    v_mul_u32_u24 v101, 20480, v101
    v_and_b32 v2, 15, v0
    v_lshl_add_u32 v101, v2, 4, v101
    v_lshlrev_b32 v1, 2, v0
    v_and_b32 v102, 63, v0
    v_lshlrev_b32 v102, 4, v102
    v_lshlrev_b32 v2, 5, v0
    s_cmp_lt_u32 s2, 161
    s_cbranch_scc1 M_fft_go
    s_barrier
    s_mul_i32 s29, s83, 20480
    s_mul_i32 s28, s88, 81920
    s_add_u32 s28, s28, s29
    s_add_u32 s28, s28, 147849216
    s_mov_b32 m0, s29
    s_nop 0
    buffer_load_dwordx4 v102, s[8:11], s28 offen offset:0 sc1 lds
    buffer_load_dwordx4 v102, s[8:11], s28 offen offset:1024 sc1 lds
    buffer_load_dwordx4 v102, s[8:11], s28 offen offset:2048 sc1 lds
    buffer_load_dwordx4 v102, s[8:11], s28 offen offset:3072 sc1 lds
    s_add_u32 s29, s29, 4096
    s_add_u32 s28, s28, 4096
    s_mov_b32 m0, s29
    s_nop 0
    buffer_load_dwordx4 v102, s[8:11], s28 offen offset:0 sc1 lds
    buffer_load_dwordx4 v102, s[8:11], s28 offen offset:1024 sc1 lds
    buffer_load_dwordx4 v102, s[8:11], s28 offen offset:2048 sc1 lds
    buffer_load_dwordx4 v102, s[8:11], s28 offen offset:3072 sc1 lds
    s_add_u32 s29, s29, 4096
    s_add_u32 s28, s28, 4096
    s_mov_b32 m0, s29
    s_nop 0
    buffer_load_dwordx4 v102, s[8:11], s28 offen offset:0 sc1 lds
    buffer_load_dwordx4 v102, s[8:11], s28 offen offset:1024 sc1 lds
    buffer_load_dwordx4 v102, s[8:11], s28 offen offset:2048 sc1 lds
    buffer_load_dwordx4 v102, s[8:11], s28 offen offset:3072 sc1 lds
    s_add_u32 s29, s29, 4096
    s_add_u32 s28, s28, 4096
    s_mov_b32 m0, s29
    s_nop 0
    buffer_load_dwordx4 v102, s[8:11], s28 offen offset:0 sc1 lds
    buffer_load_dwordx4 v102, s[8:11], s28 offen offset:1024 sc1 lds
    buffer_load_dwordx4 v102, s[8:11], s28 offen offset:2048 sc1 lds
    buffer_load_dwordx4 v102, s[8:11], s28 offen offset:3072 sc1 lds
    s_add_u32 s29, s29, 4096
    s_add_u32 s28, s28, 4096
    s_mov_b32 m0, s29
    s_nop 0
    buffer_load_dwordx4 v102, s[8:11], s28 offen offset:0 sc1 lds
    buffer_load_dwordx4 v102, s[8:11], s28 offen offset:1024 sc1 lds
    buffer_load_dwordx4 v102, s[8:11], s28 offen offset:2048 sc1 lds
    buffer_load_dwordx4 v102, s[8:11], s28 offen offset:3072 sc1 lds
    s_branch M_fft_end
M_fft_go:
    s_mov_b32 s26, 0x3f3504f3
    s_mov_b32 s27, s26
    s_lshl_b32 s20, s2, 14
    s_mul_i32 s21, s101, 6291456
    s_add_u32 s20, s20, s21
    s_add_u32 s20, s20, 176160768
    s_add_u32 s21, s20, 2621440
    s_add_u32 s36, s20, 8192
    s_add_u32 s37, s21, 8192
    s_cmp_eq_u32 s2, 0
    s_cselect_b32 s21, 0x10000000, s21
    s_cmp_eq_u32 s2, 160
    s_cselect_b32 s21, 0x10000000, s21
    s_cselect_b32 s36, 0x10000000, s36
    s_cselect_b32 s37, 0x10000000, s37
    s_add_u32 s22, s20, 4096
    s_add_u32 s23, s21, 4096
    s_add_u32 s38, s36, 4096
    s_add_u32 s39, s37, 4096
    s_lshl_b32 s24, s2, 14
    s_add_u32 s24, s24, 148897792
    s_add_u32 s25, s24, 8192
    buffer_load_dwordx4 v[92:95], v2, s[8:11], s24 offen sc1
    buffer_load_dwordx4 v[96:99], v2, s[8:11], s24 offen offset:16 sc1
    buffer_load_dwordx4 v[104:107], v2, s[8:11], s25 offen sc1
    buffer_load_dwordx4 v[108:111], v2, s[8:11], s25 offen offset:16 sc1
    s_cmp_lg_u32 s83, 0
    s_cbranch_scc1 M_dp_31
    v_and_b32 v190, 3, v0
    v_lshlrev_b32 v190, 12, v190
    v_bfe_u32 v191, v0, 2, 1
    v_mul_u32_u24 v191, 1280, v191
    v_add_u32 v190, v190, v191
    s_mov_b64 exec, 0xff
    s_cmp_eq_u32 s2, 160
    s_cselect_b32 exec_lo, 15, exec_lo
    s_lshr_b32 s31, s2, 4
    s_lshl_b32 s31, s31, 7
    s_add_u32 s31, s31, 167952384
    s_lshl_b32 s32, s101, 1
    s_add_u32 s32, s32, 1
    s_mov_b32 s30, 0
M_dp_32:
    buffer_load_dword v191, v190, s[8:11], s31 offen sc1
    s_add_u32 s30, s30, 1
    s_cmp_ge_u32 s30, 240000
    s_cbranch_scc1 M_fail
    s_sleep 4
    s_waitcnt vmcnt(0)
    v_cmp_gt_u32 vcc, s32, v191
    s_cbranch_vccnz M_dp_32
    s_mov_b64 exec, -1
M_dp_31:
    s_barrier
    buffer_load_dword v8, v1, s[8:11], s20 offen offset:0 sc1
    buffer_load_dword v9, v1, s[8:11], s21 offen offset:0 sc1
    buffer_load_dword v10, v1, s[8:11], s20 offen offset:1024 sc1
    buffer_load_dword v11, v1, s[8:11], s21 offen offset:1024 sc1
    buffer_load_dword v12, v1, s[8:11], s20 offen offset:2048 sc1
    buffer_load_dword v13, v1, s[8:11], s21 offen offset:2048 sc1
    buffer_load_dword v14, v1, s[8:11], s20 offen offset:3072 sc1
    buffer_load_dword v15, v1, s[8:11], s21 offen offset:3072 sc1
    buffer_load_dword v16, v1, s[8:11], s22 offen offset:0 sc1
    buffer_load_dword v17, v1, s[8:11], s23 offen offset:0 sc1
    buffer_load_dword v18, v1, s[8:11], s22 offen offset:1024 sc1
    buffer_load_dword v19, v1, s[8:11], s23 offen offset:1024 sc1
    buffer_load_dword v20, v1, s[8:11], s22 offen offset:2048 sc1
    buffer_load_dword v21, v1, s[8:11], s23 offen offset:2048 sc1
    buffer_load_dword v112, v1, s[8:11], s36 offen offset:0 sc1
    buffer_load_dword v113, v1, s[8:11], s37 offen offset:0 sc1
    buffer_load_dword v114, v1, s[8:11], s36 offen offset:1024 sc1
    buffer_load_dword v115, v1, s[8:11], s37 offen offset:1024 sc1
    buffer_load_dword v116, v1, s[8:11], s36 offen offset:2048 sc1
    buffer_load_dword v117, v1, s[8:11], s37 offen offset:2048 sc1
    buffer_load_dword v118, v1, s[8:11], s36 offen offset:3072 sc1
    buffer_load_dword v119, v1, s[8:11], s37 offen offset:3072 sc1
    buffer_load_dword v120, v1, s[8:11], s38 offen offset:0 sc1
    buffer_load_dword v121, v1, s[8:11], s39 offen offset:0 sc1
    buffer_load_dword v122, v1, s[8:11], s38 offen offset:1024 sc1
    buffer_load_dword v123, v1, s[8:11], s39 offen offset:1024 sc1
    buffer_load_dword v124, v1, s[8:11], s38 offen offset:2048 sc1
    buffer_load_dword v125, v1, s[8:11], s39 offen offset:2048 sc1
    s_cmp_lg_u32 s83, 0
    s_cbranch_scc1 M_dp_33
    v_and_b32 v190, 3, v0
    v_lshlrev_b32 v190, 12, v190
    v_bfe_u32 v191, v0, 2, 1
    v_mul_u32_u24 v191, 1280, v191
    v_add_u32 v190, v190, v191
    s_mov_b64 exec, 0xff
    s_cmp_eq_u32 s2, 160
    s_cselect_b32 exec_lo, 15, exec_lo
    s_lshr_b32 s31, s2, 4
    s_lshl_b32 s31, s31, 7
    s_add_u32 s31, s31, 167952384
    s_lshl_b32 s32, s101, 1
    s_add_u32 s32, s32, 2
    s_mov_b32 s30, 0
M_dp_34:
    buffer_load_dword v191, v190, s[8:11], s31 offen sc1
    s_add_u32 s30, s30, 1
    s_cmp_ge_u32 s30, 240000
    s_cbranch_scc1 M_fail
    s_waitcnt vmcnt(0)
    v_cmp_gt_u32 vcc, s32, v191
    s_cbranch_vccnz M_dp_34
    s_mov_b64 exec, -1
M_dp_33:
    s_barrier
    buffer_load_dword v22, v1, s[8:11], s22 offen offset:3072 sc1
    buffer_load_dword v23, v1, s[8:11], s23 offen offset:3072 sc1
    buffer_load_dword v126, v1, s[8:11], s38 offen offset:3072 sc1
    buffer_load_dword v127, v1, s[8:11], s39 offen offset:3072 sc1
    s_waitcnt vmcnt(22)
    v_pk_add_f32 v[24:25], v[8:9], v[16:17]
    v_pk_add_f32 v[26:27], v[8:9], v[16:17] neg_lo:[0,1] neg_hi:[0,1]
    s_waitcnt vmcnt(20)
    v_pk_add_f32 v[28:29], v[10:11], v[18:19]
    v_pk_add_f32 v[30:31], v[10:11], v[18:19] neg_lo:[0,1] neg_hi:[0,1]
    s_waitcnt vmcnt(18)
    v_pk_add_f32 v[32:33], v[12:13], v[20:21]
    v_pk_add_f32 v[34:35], v[12:13], v[20:21] neg_lo:[0,1] neg_hi:[0,1]
    s_waitcnt vmcnt(2)
    v_pk_add_f32 v[36:37], v[14:15], v[22:23]
    v_pk_add_f32 v[38:39], v[14:15], v[22:23] neg_lo:[0,1] neg_hi:[0,1]
    v_pk_add_f32 v[40:41], v[24:25], v[32:33]
    v_pk_add_f32 v[42:43], v[24:25], v[32:33] neg_lo:[0,1] neg_hi:[0,1]
    v_pk_add_f32 v[44:45], v[28:29], v[36:37]
    v_pk_add_f32 v[46:47], v[28:29], v[36:37] neg_lo:[0,1] neg_hi:[0,1]
    v_pk_add_f32 v[8:9], v[40:41], v[44:45]
    v_pk_add_f32 v[16:17], v[40:41], v[44:45] neg_lo:[0,1] neg_hi:[0,1]
    v_pk_add_f32 v[10:11], v[42:43], v[46:47] op_sel:[0,1] op_sel_hi:[1,0] neg_lo:[0,0] neg_hi:[0,1]
    v_pk_add_f32 v[18:19], v[42:43], v[46:47] op_sel:[0,1] op_sel_hi:[1,0] neg_lo:[0,1] neg_hi:[0,0]
    v_pk_add_f32 v[12:13], v[30:31], v[30:31] op_sel:[0,1] op_sel_hi:[1,0] neg_lo:[0,0] neg_hi:[0,1]
    v_pk_add_f32 v[20:21], v[38:39], v[38:39] op_sel:[0,1] op_sel_hi:[1,0] neg_lo:[1,0] neg_hi:[1,1]
    v_pk_add_f32 v[14:15], v[26:27], v[34:35] op_sel:[0,1] op_sel_hi:[1,0] neg_lo:[0,0] neg_hi:[0,1]
    v_pk_add_f32 v[22:23], v[26:27], v[34:35] op_sel:[0,1] op_sel_hi:[1,0] neg_lo:[0,1] neg_hi:[0,0]
    v_pk_add_f32 v[24:25], v[12:13], v[20:21]
    v_pk_add_f32 v[28:29], v[12:13], v[20:21] neg_lo:[0,1] neg_hi:[0,1]
    v_pk_fma_f32 v[32:33], v[24:25], s[26:27], v[14:15] neg_lo:[0,0,0] neg_hi:[0,0,0]
    v_pk_fma_f32 v[36:37], v[24:25], s[26:27], v[14:15] neg_lo:[1,0,0] neg_hi:[1,0,0]
    v_pk_fma_f32 v[40:41], v[28:29], s[26:27], v[22:23] op_sel:[1,0,0] op_sel_hi:[0,1,1] neg_lo:[0,0,0] neg_hi:[1,0,0]
    v_pk_fma_f32 v[42:43], v[28:29], s[26:27], v[22:23] op_sel:[1,0,0] op_sel_hi:[0,1,1] neg_lo:[1,0,0] neg_hi:[0,0,0]
    v_pk_mul_f32 v[44:45], v[32:33], v[48:49] op_sel:[0,0] op_sel_hi:[1,0]
    v_pk_mul_f32 v[46:47], v[10:11], v[50:51] op_sel:[0,0] op_sel_hi:[1,0]
    v_pk_mul_f32 v[26:27], v[40:41], v[52:53] op_sel:[0,0] op_sel_hi:[1,0]
    v_pk_mul_f32 v[30:31], v[16:17], v[54:55] op_sel:[0,0] op_sel_hi:[1,0]
    v_pk_mul_f32 v[34:35], v[36:37], v[56:57] op_sel:[0,0] op_sel_hi:[1,0]
    v_pk_mul_f32 v[38:39], v[18:19], v[58:59] op_sel:[0,0] op_sel_hi:[1,0]
    v_pk_mul_f32 v[12:13], v[42:43], v[60:61] op_sel:[0,0] op_sel_hi:[1,0]
    v_pk_fma_f32 v[44:45], v[32:33], v[48:49], v[44:45] op_sel:[1,1,0] op_sel_hi:[0,1,1] neg_lo:[1,0,0] neg_hi:[0,0,0]
    v_pk_fma_f32 v[46:47], v[10:11], v[50:51], v[46:47] op_sel:[1,1,0] op_sel_hi:[0,1,1] neg_lo:[1,0,0] neg_hi:[0,0,0]
    v_pk_fma_f32 v[26:27], v[40:41], v[52:53], v[26:27] op_sel:[1,1,0] op_sel_hi:[0,1,1] neg_lo:[1,0,0] neg_hi:[0,0,0]
    v_pk_fma_f32 v[30:31], v[16:17], v[54:55], v[30:31] op_sel:[1,1,0] op_sel_hi:[0,1,1] neg_lo:[1,0,0] neg_hi:[0,0,0]
    v_pk_fma_f32 v[34:35], v[36:37], v[56:57], v[34:35] op_sel:[1,1,0] op_sel_hi:[0,1,1] neg_lo:[1,0,0] neg_hi:[0,0,0]
    v_pk_fma_f32 v[38:39], v[18:19], v[58:59], v[38:39] op_sel:[1,1,0] op_sel_hi:[0,1,1] neg_lo:[1,0,0] neg_hi:[0,0,0]
    v_pk_fma_f32 v[12:13], v[42:43], v[60:61], v[12:13] op_sel:[1,1,0] op_sel_hi:[0,1,1] neg_lo:[1,0,0] neg_hi:[0,0,0]
    ds_write_b64 v3, v[8:9] offset:0
    ds_write_b64 v3, v[44:45] offset:2304
    ds_write_b64 v3, v[46:47] offset:4608
    ds_write_b64 v3, v[26:27] offset:6912
    ds_write_b64 v3, v[30:31] offset:9216
    ds_write_b64 v3, v[34:35] offset:11520
    ds_write_b64 v3, v[38:39] offset:13824
    ds_write_b64 v3, v[12:13] offset:16128
    v_pk_add_f32 v[128:129], v[112:113], v[120:121]
    v_pk_add_f32 v[130:131], v[112:113], v[120:121] neg_lo:[0,1] neg_hi:[0,1]
    v_pk_add_f32 v[132:133], v[114:115], v[122:123]
    v_pk_add_f32 v[134:135], v[114:115], v[122:123] neg_lo:[0,1] neg_hi:[0,1]
    v_pk_add_f32 v[136:137], v[116:117], v[124:125]
    v_pk_add_f32 v[138:139], v[116:117], v[124:125] neg_lo:[0,1] neg_hi:[0,1]
    s_waitcnt vmcnt(0)
    v_pk_add_f32 v[140:141], v[118:119], v[126:127]
    v_pk_add_f32 v[142:143], v[118:119], v[126:127] neg_lo:[0,1] neg_hi:[0,1]
    v_pk_add_f32 v[144:145], v[128:129], v[136:137]
    v_pk_add_f32 v[146:147], v[128:129], v[136:137] neg_lo:[0,1] neg_hi:[0,1]
    v_pk_add_f32 v[148:149], v[132:133], v[140:141]
    v_pk_add_f32 v[150:151], v[132:133], v[140:141] neg_lo:[0,1] neg_hi:[0,1]
    v_pk_add_f32 v[112:113], v[144:145], v[148:149]
    v_pk_add_f32 v[120:121], v[144:145], v[148:149] neg_lo:[0,1] neg_hi:[0,1]
    v_pk_add_f32 v[114:115], v[146:147], v[150:151] op_sel:[0,1] op_sel_hi:[1,0] neg_lo:[0,0] neg_hi:[0,1]
    v_pk_add_f32 v[122:123], v[146:147], v[150:151] op_sel:[0,1] op_sel_hi:[1,0] neg_lo:[0,1] neg_hi:[0,0]
    v_pk_add_f32 v[116:117], v[134:135], v[134:135] op_sel:[0,1] op_sel_hi:[1,0] neg_lo:[0,0] neg_hi:[0,1]
    v_pk_add_f32 v[124:125], v[142:143], v[142:143] op_sel:[0,1] op_sel_hi:[1,0] neg_lo:[1,0] neg_hi:[1,1]
    v_pk_add_f32 v[118:119], v[130:131], v[138:139] op_sel:[0,1] op_sel_hi:[1,0] neg_lo:[0,0] neg_hi:[0,1]
    v_pk_add_f32 v[126:127], v[130:131], v[138:139] op_sel:[0,1] op_sel_hi:[1,0] neg_lo:[0,1] neg_hi:[0,0]
    v_pk_add_f32 v[128:129], v[116:117], v[124:125]
    v_pk_add_f32 v[132:133], v[116:117], v[124:125] neg_lo:[0,1] neg_hi:[0,1]
    v_pk_fma_f32 v[136:137], v[128:129], s[26:27], v[118:119] neg_lo:[0,0,0] neg_hi:[0,0,0]
    v_pk_fma_f32 v[140:141], v[128:129], s[26:27], v[118:119] neg_lo:[1,0,0] neg_hi:[1,0,0]
    v_pk_fma_f32 v[144:145], v[132:133], s[26:27], v[126:127] op_sel:[1,0,0] op_sel_hi:[0,1,1] neg_lo:[0,0,0] neg_hi:[1,0,0]
    v_pk_fma_f32 v[146:147], v[132:133], s[26:27], v[126:127] op_sel:[1,0,0] op_sel_hi:[0,1,1] neg_lo:[1,0,0] neg_hi:[0,0,0]
    v_pk_mul_f32 v[148:149], v[136:137], v[48:49] op_sel:[0,0] op_sel_hi:[1,0]
    v_pk_mul_f32 v[150:151], v[114:115], v[50:51] op_sel:[0,0] op_sel_hi:[1,0]
    v_pk_mul_f32 v[130:131], v[144:145], v[52:53] op_sel:[0,0] op_sel_hi:[1,0]
    v_pk_mul_f32 v[134:135], v[120:121], v[54:55] op_sel:[0,0] op_sel_hi:[1,0]
    v_pk_mul_f32 v[138:139], v[140:141], v[56:57] op_sel:[0,0] op_sel_hi:[1,0]
    v_pk_mul_f32 v[142:143], v[122:123], v[58:59] op_sel:[0,0] op_sel_hi:[1,0]
    v_pk_mul_f32 v[116:117], v[146:147], v[60:61] op_sel:[0,0] op_sel_hi:[1,0]
    v_pk_fma_f32 v[148:149], v[136:137], v[48:49], v[148:149] op_sel:[1,1,0] op_sel_hi:[0,1,1] neg_lo:[1,0,0] neg_hi:[0,0,0]
    v_pk_fma_f32 v[150:151], v[114:115], v[50:51], v[150:151] op_sel:[1,1,0] op_sel_hi:[0,1,1] neg_lo:[1,0,0] neg_hi:[0,0,0]
    v_pk_fma_f32 v[130:131], v[144:145], v[52:53], v[130:131] op_sel:[1,1,0] op_sel_hi:[0,1,1] neg_lo:[1,0,0] neg_hi:[0,0,0]
    v_pk_fma_f32 v[134:135], v[120:121], v[54:55], v[134:135] op_sel:[1,1,0] op_sel_hi:[0,1,1] neg_lo:[1,0,0] neg_hi:[0,0,0]
    v_pk_fma_f32 v[138:139], v[140:141], v[56:57], v[138:139] op_sel:[1,1,0] op_sel_hi:[0,1,1] neg_lo:[1,0,0] neg_hi:[0,0,0]
    v_pk_fma_f32 v[142:143], v[122:123], v[58:59], v[142:143] op_sel:[1,1,0] op_sel_hi:[0,1,1] neg_lo:[1,0,0] neg_hi:[0,0,0]
    v_pk_fma_f32 v[116:117], v[146:147], v[60:61], v[116:117] op_sel:[1,1,0] op_sel_hi:[0,1,1] neg_lo:[1,0,0] neg_hi:[0,0,0]
    ds_write_b64 v3, v[112:113] offset:18432
    ds_write_b64 v3, v[148:149] offset:20736
    ds_write_b64 v3, v[150:151] offset:23040
    ds_write_b64 v3, v[130:131] offset:25344
    ds_write_b64 v3, v[134:135] offset:27648
    ds_write_b64 v3, v[138:139] offset:29952
    ds_write_b64 v3, v[142:143] offset:32256
    ds_write_b64 v3, v[116:117] offset:34560
    s_mul_i32 s29, s83, 20480
    s_mul_i32 s28, s88, 81920
    s_add_u32 s28, s28, s29
    s_add_u32 s28, s28, 147849216
    s_mov_b32 m0, s29
    s_nop 0
    buffer_load_dwordx4 v102, s[8:11], s28 offen offset:0 sc1 lds
    buffer_load_dwordx4 v102, s[8:11], s28 offen offset:1024 sc1 lds
    buffer_load_dwordx4 v102, s[8:11], s28 offen offset:2048 sc1 lds
    buffer_load_dwordx4 v102, s[8:11], s28 offen offset:3072 sc1 lds
    s_waitcnt lgkmcnt(0)
    s_barrier
    ds_read_b64 v[20:21], v5 offset:0
    ds_read_b64 v[14:15], v5 offset:256
    ds_read_b64 v[22:23], v5 offset:512
    ds_read_b64 v[24:25], v5 offset:768
    ds_read_b64 v[28:29], v5 offset:1024
    ds_read_b64 v[32:33], v5 offset:1280
    ds_read_b64 v[10:11], v5 offset:1536
    ds_read_b64 v[40:41], v5 offset:1792
    ds_read_b64 v[124:125], v5 offset:18432
    ds_read_b64 v[118:119], v5 offset:18688
    ds_read_b64 v[126:127], v5 offset:18944
    ds_read_b64 v[128:129], v5 offset:19200
    ds_read_b64 v[132:133], v5 offset:19456
    ds_read_b64 v[136:137], v5 offset:19712
    ds_read_b64 v[114:115], v5 offset:19968
    ds_read_b64 v[144:145], v5 offset:20224
    s_add_u32 s29, s29, 4096
    s_add_u32 s28, s28, 4096
    s_mov_b32 m0, s29
    s_nop 0
    buffer_load_dwordx4 v102, s[8:11], s28 offen offset:0 sc1 lds
    buffer_load_dwordx4 v102, s[8:11], s28 offen offset:1024 sc1 lds
    buffer_load_dwordx4 v102, s[8:11], s28 offen offset:2048 sc1 lds
    buffer_load_dwordx4 v102, s[8:11], s28 offen offset:3072 sc1 lds
    s_waitcnt lgkmcnt(11)
    v_pk_add_f32 v[16:17], v[20:21], v[28:29]
    v_pk_add_f32 v[36:37], v[20:21], v[28:29] neg_lo:[0,1] neg_hi:[0,1]
    s_waitcnt lgkmcnt(10)
    v_pk_add_f32 v[18:19], v[14:15], v[32:33]
    v_pk_add_f32 v[42:43], v[14:15], v[32:33] neg_lo:[0,1] neg_hi:[0,1]
    s_waitcnt lgkmcnt(9)
    v_pk_add_f32 v[8:9], v[22:23], v[10:11]
    v_pk_add_f32 v[44:45], v[22:23], v[10:11] neg_lo:[0,1] neg_hi:[0,1]
    s_waitcnt lgkmcnt(8)
    v_pk_add_f32 v[46:47], v[24:25], v[40:41]
    v_pk_add_f32 v[26:27], v[24:25], v[40:41] neg_lo:[0,1] neg_hi:[0,1]
    v_pk_add_f32 v[30:31], v[16:17], v[8:9]
    v_pk_add_f32 v[34:35], v[16:17], v[8:9] neg_lo:[0,1] neg_hi:[0,1]
    v_pk_add_f32 v[38:39], v[18:19], v[46:47]
    v_pk_add_f32 v[12:13], v[18:19], v[46:47] neg_lo:[0,1] neg_hi:[0,1]
    v_pk_add_f32 v[20:21], v[30:31], v[38:39]
    v_pk_add_f32 v[28:29], v[30:31], v[38:39] neg_lo:[0,1] neg_hi:[0,1]
    v_pk_add_f32 v[14:15], v[34:35], v[12:13] op_sel:[0,1] op_sel_hi:[1,0] neg_lo:[0,0] neg_hi:[0,1]
    v_pk_add_f32 v[32:33], v[34:35], v[12:13] op_sel:[0,1] op_sel_hi:[1,0] neg_lo:[0,1] neg_hi:[0,0]
    v_pk_add_f32 v[22:23], v[42:43], v[42:43] op_sel:[0,1] op_sel_hi:[1,0] neg_lo:[0,0] neg_hi:[0,1]
    v_pk_add_f32 v[10:11], v[26:27], v[26:27] op_sel:[0,1] op_sel_hi:[1,0] neg_lo:[1,0] neg_hi:[1,1]
    v_pk_add_f32 v[24:25], v[36:37], v[44:45] op_sel:[0,1] op_sel_hi:[1,0] neg_lo:[0,0] neg_hi:[0,1]
    v_pk_add_f32 v[40:41], v[36:37], v[44:45] op_sel:[0,1] op_sel_hi:[1,0] neg_lo:[0,1] neg_hi:[0,0]
    v_pk_add_f32 v[16:17], v[22:23], v[10:11]
    v_pk_add_f32 v[18:19], v[22:23], v[10:11] neg_lo:[0,1] neg_hi:[0,1]
    v_pk_fma_f32 v[8:9], v[16:17], s[26:27], v[24:25] neg_lo:[0,0,0] neg_hi:[0,0,0]
    v_pk_fma_f32 v[46:47], v[16:17], s[26:27], v[24:25] neg_lo:[1,0,0] neg_hi:[1,0,0]
    v_pk_fma_f32 v[30:31], v[18:19], s[26:27], v[40:41] op_sel:[1,0,0] op_sel_hi:[0,1,1] neg_lo:[0,0,0] neg_hi:[1,0,0]
    v_pk_fma_f32 v[34:35], v[18:19], s[26:27], v[40:41] op_sel:[1,0,0] op_sel_hi:[0,1,1] neg_lo:[1,0,0] neg_hi:[0,0,0]
    v_pk_mul_f32 v[38:39], v[8:9], v[62:63] op_sel:[0,0] op_sel_hi:[1,0]
    v_pk_mul_f32 v[12:13], v[14:15], v[64:65] op_sel:[0,0] op_sel_hi:[1,0]
    v_pk_mul_f32 v[36:37], v[30:31], v[66:67] op_sel:[0,0] op_sel_hi:[1,0]
    v_pk_mul_f32 v[42:43], v[28:29], v[68:69] op_sel:[0,0] op_sel_hi:[1,0]
    v_pk_mul_f32 v[44:45], v[46:47], v[70:71] op_sel:[0,0] op_sel_hi:[1,0]
    v_pk_mul_f32 v[26:27], v[32:33], v[72:73] op_sel:[0,0] op_sel_hi:[1,0]
    v_pk_mul_f32 v[22:23], v[34:35], v[74:75] op_sel:[0,0] op_sel_hi:[1,0]
    v_pk_fma_f32 v[38:39], v[8:9], v[62:63], v[38:39] op_sel:[1,1,0] op_sel_hi:[0,1,1] neg_lo:[1,0,0] neg_hi:[0,0,0]
    v_pk_fma_f32 v[12:13], v[14:15], v[64:65], v[12:13] op_sel:[1,1,0] op_sel_hi:[0,1,1] neg_lo:[1,0,0] neg_hi:[0,0,0]
    v_pk_fma_f32 v[36:37], v[30:31], v[66:67], v[36:37] op_sel:[1,1,0] op_sel_hi:[0,1,1] neg_lo:[1,0,0] neg_hi:[0,0,0]
    v_pk_fma_f32 v[42:43], v[28:29], v[68:69], v[42:43] op_sel:[1,1,0] op_sel_hi:[0,1,1] neg_lo:[1,0,0] neg_hi:[0,0,0]
    v_pk_fma_f32 v[44:45], v[46:47], v[70:71], v[44:45] op_sel:[1,1,0] op_sel_hi:[0,1,1] neg_lo:[1,0,0] neg_hi:[0,0,0]
    v_pk_fma_f32 v[26:27], v[32:33], v[72:73], v[26:27] op_sel:[1,1,0] op_sel_hi:[0,1,1] neg_lo:[1,0,0] neg_hi:[0,0,0]
    v_pk_fma_f32 v[22:23], v[34:35], v[74:75], v[22:23] op_sel:[1,1,0] op_sel_hi:[0,1,1] neg_lo:[1,0,0] neg_hi:[0,0,0]
    ds_write_b64 v5, v[20:21] offset:0
    ds_write_b64 v5, v[38:39] offset:288
    ds_write_b64 v5, v[12:13] offset:576
    ds_write_b64 v5, v[36:37] offset:864
    ds_write_b64 v5, v[42:43] offset:1152
    ds_write_b64 v5, v[44:45] offset:1440
    ds_write_b64 v5, v[26:27] offset:1728
    ds_write_b64 v5, v[22:23] offset:2016
    ds_read_b64 v[10:11], v6 offset:0
    ds_read_b64 v[24:25], v6 offset:32
    ds_read_b64 v[40:41], v6 offset:64
    ds_read_b64 v[16:17], v6 offset:96
    ds_read_b64 v[18:19], v6 offset:128
    ds_read_b64 v[8:9], v6 offset:160
    ds_read_b64 v[14:15], v6 offset:192
    ds_read_b64 v[30:31], v6 offset:224
    s_waitcnt lgkmcnt(14)
    v_pk_add_f32 v[120:121], v[124:125], v[132:133]
    v_pk_add_f32 v[140:141], v[124:125], v[132:133] neg_lo:[0,1] neg_hi:[0,1]
    v_pk_add_f32 v[122:123], v[118:119], v[136:137]
    v_pk_add_f32 v[146:147], v[118:119], v[136:137] neg_lo:[0,1] neg_hi:[0,1]
    v_pk_add_f32 v[112:113], v[126:127], v[114:115]
    v_pk_add_f32 v[148:149], v[126:127], v[114:115] neg_lo:[0,1] neg_hi:[0,1]
    v_pk_add_f32 v[150:151], v[128:129], v[144:145]
    v_pk_add_f32 v[130:131], v[128:129], v[144:145] neg_lo:[0,1] neg_hi:[0,1]
    v_pk_add_f32 v[134:135], v[120:121], v[112:113]
    v_pk_add_f32 v[138:139], v[120:121], v[112:113] neg_lo:[0,1] neg_hi:[0,1]
    v_pk_add_f32 v[142:143], v[122:123], v[150:151]
    v_pk_add_f32 v[116:117], v[122:123], v[150:151] neg_lo:[0,1] neg_hi:[0,1]
    v_pk_add_f32 v[124:125], v[134:135], v[142:143]
    v_pk_add_f32 v[132:133], v[134:135], v[142:143] neg_lo:[0,1] neg_hi:[0,1]
    v_pk_add_f32 v[118:119], v[138:139], v[116:117] op_sel:[0,1] op_sel_hi:[1,0] neg_lo:[0,0] neg_hi:[0,1]
    v_pk_add_f32 v[136:137], v[138:139], v[116:117] op_sel:[0,1] op_sel_hi:[1,0] neg_lo:[0,1] neg_hi:[0,0]
    v_pk_add_f32 v[126:127], v[146:147], v[146:147] op_sel:[0,1] op_sel_hi:[1,0] neg_lo:[0,0] neg_hi:[0,1]
    v_pk_add_f32 v[114:115], v[130:131], v[130:131] op_sel:[0,1] op_sel_hi:[1,0] neg_lo:[1,0] neg_hi:[1,1]
    v_pk_add_f32 v[128:129], v[140:141], v[148:149] op_sel:[0,1] op_sel_hi:[1,0] neg_lo:[0,0] neg_hi:[0,1]
    v_pk_add_f32 v[144:145], v[140:141], v[148:149] op_sel:[0,1] op_sel_hi:[1,0] neg_lo:[0,1] neg_hi:[0,0]
    v_pk_add_f32 v[120:121], v[126:127], v[114:115]
    v_pk_add_f32 v[122:123], v[126:127], v[114:115] neg_lo:[0,1] neg_hi:[0,1]
    v_pk_fma_f32 v[112:113], v[120:121], s[26:27], v[128:129] neg_lo:[0,0,0] neg_hi:[0,0,0]
    v_pk_fma_f32 v[150:151], v[120:121], s[26:27], v[128:129] neg_lo:[1,0,0] neg_hi:[1,0,0]
    v_pk_fma_f32 v[134:135], v[122:123], s[26:27], v[144:145] op_sel:[1,0,0] op_sel_hi:[0,1,1] neg_lo:[0,0,0] neg_hi:[1,0,0]
    v_pk_fma_f32 v[138:139], v[122:123], s[26:27], v[144:145] op_sel:[1,0,0] op_sel_hi:[0,1,1] neg_lo:[1,0,0] neg_hi:[0,0,0]
    v_pk_mul_f32 v[142:143], v[112:113], v[62:63] op_sel:[0,0] op_sel_hi:[1,0]
    v_pk_mul_f32 v[116:117], v[118:119], v[64:65] op_sel:[0,0] op_sel_hi:[1,0]
    v_pk_mul_f32 v[140:141], v[134:135], v[66:67] op_sel:[0,0] op_sel_hi:[1,0]
    v_pk_mul_f32 v[146:147], v[132:133], v[68:69] op_sel:[0,0] op_sel_hi:[1,0]
    v_pk_mul_f32 v[148:149], v[150:151], v[70:71] op_sel:[0,0] op_sel_hi:[1,0]
    v_pk_mul_f32 v[130:131], v[136:137], v[72:73] op_sel:[0,0] op_sel_hi:[1,0]
    v_pk_mul_f32 v[126:127], v[138:139], v[74:75] op_sel:[0,0] op_sel_hi:[1,0]
    v_pk_fma_f32 v[142:143], v[112:113], v[62:63], v[142:143] op_sel:[1,1,0] op_sel_hi:[0,1,1] neg_lo:[1,0,0] neg_hi:[0,0,0]
    v_pk_fma_f32 v[116:117], v[118:119], v[64:65], v[116:117] op_sel:[1,1,0] op_sel_hi:[0,1,1] neg_lo:[1,0,0] neg_hi:[0,0,0]
    v_pk_fma_f32 v[140:141], v[134:135], v[66:67], v[140:141] op_sel:[1,1,0] op_sel_hi:[0,1,1] neg_lo:[1,0,0] neg_hi:[0,0,0]
    v_pk_fma_f32 v[146:147], v[132:133], v[68:69], v[146:147] op_sel:[1,1,0] op_sel_hi:[0,1,1] neg_lo:[1,0,0] neg_hi:[0,0,0]
    v_pk_fma_f32 v[148:149], v[150:151], v[70:71], v[148:149] op_sel:[1,1,0] op_sel_hi:[0,1,1] neg_lo:[1,0,0] neg_hi:[0,0,0]
    v_pk_fma_f32 v[130:131], v[136:137], v[72:73], v[130:131] op_sel:[1,1,0] op_sel_hi:[0,1,1] neg_lo:[1,0,0] neg_hi:[0,0,0]
    v_pk_fma_f32 v[126:127], v[138:139], v[74:75], v[126:127] op_sel:[1,1,0] op_sel_hi:[0,1,1] neg_lo:[1,0,0] neg_hi:[0,0,0]
    ds_write_b64 v5, v[124:125] offset:18432
    ds_write_b64 v5, v[142:143] offset:18720
    ds_write_b64 v5, v[116:117] offset:19008
    ds_write_b64 v5, v[140:141] offset:19296
    ds_write_b64 v5, v[146:147] offset:19584
    ds_write_b64 v5, v[148:149] offset:19872
    ds_write_b64 v5, v[130:131] offset:20160
    ds_write_b64 v5, v[126:127] offset:20448
    ds_read_b64 v[114:115], v6 offset:18432
    ds_read_b64 v[128:129], v6 offset:18464
    ds_read_b64 v[144:145], v6 offset:18496
    ds_read_b64 v[120:121], v6 offset:18528
    ds_read_b64 v[122:123], v6 offset:18560
    ds_read_b64 v[112:113], v6 offset:18592
    ds_read_b64 v[118:119], v6 offset:18624
    ds_read_b64 v[134:135], v6 offset:18656
    s_add_u32 s29, s29, 4096
    s_add_u32 s28, s28, 4096
    s_mov_b32 m0, s29
    s_nop 0
    buffer_load_dwordx4 v102, s[8:11], s28 offen offset:0 sc1 lds
    buffer_load_dwordx4 v102, s[8:11], s28 offen offset:1024 sc1 lds
    buffer_load_dwordx4 v102, s[8:11], s28 offen offset:2048 sc1 lds
    buffer_load_dwordx4 v102, s[8:11], s28 offen offset:3072 sc1 lds
    s_waitcnt lgkmcnt(14)
    v_pk_add_f32 v[28:29], v[10:11], v[18:19]
    v_pk_add_f32 v[46:47], v[10:11], v[18:19] neg_lo:[0,1] neg_hi:[0,1]
    v_pk_add_f32 v[32:33], v[24:25], v[8:9]
    v_pk_add_f32 v[34:35], v[24:25], v[8:9] neg_lo:[0,1] neg_hi:[0,1]
    v_pk_add_f32 v[20:21], v[40:41], v[14:15]
    v_pk_add_f32 v[38:39], v[40:41], v[14:15] neg_lo:[0,1] neg_hi:[0,1]
    v_pk_add_f32 v[12:13], v[16:17], v[30:31]
    v_pk_add_f32 v[36:37], v[16:17], v[30:31] neg_lo:[0,1] neg_hi:[0,1]
    v_pk_add_f32 v[42:43], v[28:29], v[20:21]
    v_pk_add_f32 v[44:45], v[28:29], v[20:21] neg_lo:[0,1] neg_hi:[0,1]
    v_pk_add_f32 v[26:27], v[32:33], v[12:13]
    v_pk_add_f32 v[22:23], v[32:33], v[12:13] neg_lo:[0,1] neg_hi:[0,1]
    v_pk_add_f32 v[10:11], v[42:43], v[26:27]
    v_pk_add_f32 v[18:19], v[42:43], v[26:27] neg_lo:[0,1] neg_hi:[0,1]
    v_pk_add_f32 v[24:25], v[44:45], v[22:23] op_sel:[0,1] op_sel_hi:[1,0] neg_lo:[0,0] neg_hi:[0,1]
    v_pk_add_f32 v[8:9], v[44:45], v[22:23] op_sel:[0,1] op_sel_hi:[1,0] neg_lo:[0,1] neg_hi:[0,0]
    v_pk_add_f32 v[40:41], v[34:35], v[34:35] op_sel:[0,1] op_sel_hi:[1,0] neg_lo:[0,0] neg_hi:[0,1]
    v_pk_add_f32 v[14:15], v[36:37], v[36:37] op_sel:[0,1] op_sel_hi:[1,0] neg_lo:[1,0] neg_hi:[1,1]
    v_pk_add_f32 v[16:17], v[46:47], v[38:39] op_sel:[0,1] op_sel_hi:[1,0] neg_lo:[0,0] neg_hi:[0,1]
    v_pk_add_f32 v[30:31], v[46:47], v[38:39] op_sel:[0,1] op_sel_hi:[1,0] neg_lo:[0,1] neg_hi:[0,0]
    v_pk_add_f32 v[28:29], v[40:41], v[14:15]
    v_pk_add_f32 v[32:33], v[40:41], v[14:15] neg_lo:[0,1] neg_hi:[0,1]
    v_pk_fma_f32 v[20:21], v[28:29], s[26:27], v[16:17] neg_lo:[0,0,0] neg_hi:[0,0,0]
    v_pk_fma_f32 v[12:13], v[28:29], s[26:27], v[16:17] neg_lo:[1,0,0] neg_hi:[1,0,0]
    v_pk_fma_f32 v[42:43], v[32:33], s[26:27], v[30:31] op_sel:[1,0,0] op_sel_hi:[0,1,1] neg_lo:[0,0,0] neg_hi:[1,0,0]
    v_pk_fma_f32 v[44:45], v[32:33], s[26:27], v[30:31] op_sel:[1,0,0] op_sel_hi:[0,1,1] neg_lo:[1,0,0] neg_hi:[0,0,0]
    v_pk_mul_f32 v[26:27], v[20:21], v[76:77] op_sel:[0,0] op_sel_hi:[1,0]
    v_pk_mul_f32 v[22:23], v[24:25], v[78:79] op_sel:[0,0] op_sel_hi:[1,0]
    v_pk_mul_f32 v[46:47], v[42:43], v[80:81] op_sel:[0,0] op_sel_hi:[1,0]
    v_pk_mul_f32 v[34:35], v[18:19], v[82:83] op_sel:[0,0] op_sel_hi:[1,0]
    v_pk_mul_f32 v[38:39], v[12:13], v[84:85] op_sel:[0,0] op_sel_hi:[1,0]
    v_pk_mul_f32 v[36:37], v[8:9], v[86:87] op_sel:[0,0] op_sel_hi:[1,0]
    v_pk_mul_f32 v[40:41], v[44:45], v[88:89] op_sel:[0,0] op_sel_hi:[1,0]
    v_pk_fma_f32 v[26:27], v[20:21], v[76:77], v[26:27] op_sel:[1,1,0] op_sel_hi:[0,1,1] neg_lo:[1,0,0] neg_hi:[0,0,0]
    v_pk_fma_f32 v[22:23], v[24:25], v[78:79], v[22:23] op_sel:[1,1,0] op_sel_hi:[0,1,1] neg_lo:[1,0,0] neg_hi:[0,0,0]
    v_pk_fma_f32 v[46:47], v[42:43], v[80:81], v[46:47] op_sel:[1,1,0] op_sel_hi:[0,1,1] neg_lo:[1,0,0] neg_hi:[0,0,0]
    v_pk_fma_f32 v[34:35], v[18:19], v[82:83], v[34:35] op_sel:[1,1,0] op_sel_hi:[0,1,1] neg_lo:[1,0,0] neg_hi:[0,0,0]
    v_pk_fma_f32 v[38:39], v[12:13], v[84:85], v[38:39] op_sel:[1,1,0] op_sel_hi:[0,1,1] neg_lo:[1,0,0] neg_hi:[0,0,0]
    v_pk_fma_f32 v[36:37], v[8:9], v[86:87], v[36:37] op_sel:[1,1,0] op_sel_hi:[0,1,1] neg_lo:[1,0,0] neg_hi:[0,0,0]
    v_pk_fma_f32 v[40:41], v[44:45], v[88:89], v[40:41] op_sel:[1,1,0] op_sel_hi:[0,1,1] neg_lo:[1,0,0] neg_hi:[0,0,0]
    ds_write_b64 v6, v[10:11] offset:0
    ds_write_b64 v6, v[26:27] offset:32
    ds_write_b64 v6, v[22:23] offset:64
    ds_write_b64 v6, v[46:47] offset:96
    ds_write_b64 v6, v[34:35] offset:128
    ds_write_b64 v6, v[38:39] offset:160
    ds_write_b64 v6, v[36:37] offset:192
    ds_write_b64 v6, v[40:41] offset:224
    ds_read_b64 v[14:15], v100 offset:0
    ds_read_b64 v[16:17], v100 offset:8
    ds_read_b64 v[30:31], v100 offset:16
    ds_read_b64 v[28:29], v100 offset:24
    ds_read_b64 v[32:33], v100 offset:32
    ds_read_b64 v[20:21], v100 offset:40
    ds_read_b64 v[24:25], v100 offset:48
    ds_read_b64 v[42:43], v100 offset:56
    s_waitcnt lgkmcnt(14)
    v_pk_add_f32 v[132:133], v[114:115], v[122:123]
    v_pk_add_f32 v[150:151], v[114:115], v[122:123] neg_lo:[0,1] neg_hi:[0,1]
    v_pk_add_f32 v[136:137], v[128:129], v[112:113]
    v_pk_add_f32 v[138:139], v[128:129], v[112:113] neg_lo:[0,1] neg_hi:[0,1]
    v_pk_add_f32 v[124:125], v[144:145], v[118:119]
    v_pk_add_f32 v[142:143], v[144:145], v[118:119] neg_lo:[0,1] neg_hi:[0,1]
    v_pk_add_f32 v[116:117], v[120:121], v[134:135]
    v_pk_add_f32 v[140:141], v[120:121], v[134:135] neg_lo:[0,1] neg_hi:[0,1]
    v_pk_add_f32 v[146:147], v[132:133], v[124:125]
    v_pk_add_f32 v[148:149], v[132:133], v[124:125] neg_lo:[0,1] neg_hi:[0,1]
    v_pk_add_f32 v[130:131], v[136:137], v[116:117]
    v_pk_add_f32 v[126:127], v[136:137], v[116:117] neg_lo:[0,1] neg_hi:[0,1]
    v_pk_add_f32 v[114:115], v[146:147], v[130:131]
    v_pk_add_f32 v[122:123], v[146:147], v[130:131] neg_lo:[0,1] neg_hi:[0,1]
    v_pk_add_f32 v[128:129], v[148:149], v[126:127] op_sel:[0,1] op_sel_hi:[1,0] neg_lo:[0,0] neg_hi:[0,1]
    v_pk_add_f32 v[112:113], v[148:149], v[126:127] op_sel:[0,1] op_sel_hi:[1,0] neg_lo:[0,1] neg_hi:[0,0]
    v_pk_add_f32 v[144:145], v[138:139], v[138:139] op_sel:[0,1] op_sel_hi:[1,0] neg_lo:[0,0] neg_hi:[0,1]
    v_pk_add_f32 v[118:119], v[140:141], v[140:141] op_sel:[0,1] op_sel_hi:[1,0] neg_lo:[1,0] neg_hi:[1,1]
    v_pk_add_f32 v[120:121], v[150:151], v[142:143] op_sel:[0,1] op_sel_hi:[1,0] neg_lo:[0,0] neg_hi:[0,1]
    v_pk_add_f32 v[134:135], v[150:151], v[142:143] op_sel:[0,1] op_sel_hi:[1,0] neg_lo:[0,1] neg_hi:[0,0]
    v_pk_add_f32 v[132:133], v[144:145], v[118:119]
    v_pk_add_f32 v[136:137], v[144:145], v[118:119] neg_lo:[0,1] neg_hi:[0,1]
    v_pk_fma_f32 v[124:125], v[132:133], s[26:27], v[120:121] neg_lo:[0,0,0] neg_hi:[0,0,0]
    v_pk_fma_f32 v[116:117], v[132:133], s[26:27], v[120:121] neg_lo:[1,0,0] neg_hi:[1,0,0]
    v_pk_fma_f32 v[146:147], v[136:137], s[26:27], v[134:135] op_sel:[1,0,0] op_sel_hi:[0,1,1] neg_lo:[0,0,0] neg_hi:[1,0,0]
    v_pk_fma_f32 v[148:149], v[136:137], s[26:27], v[134:135] op_sel:[1,0,0] op_sel_hi:[0,1,1] neg_lo:[1,0,0] neg_hi:[0,0,0]
    v_pk_mul_f32 v[130:131], v[124:125], v[76:77] op_sel:[0,0] op_sel_hi:[1,0]
    v_pk_mul_f32 v[126:127], v[128:129], v[78:79] op_sel:[0,0] op_sel_hi:[1,0]
    v_pk_mul_f32 v[150:151], v[146:147], v[80:81] op_sel:[0,0] op_sel_hi:[1,0]
    v_pk_mul_f32 v[138:139], v[122:123], v[82:83] op_sel:[0,0] op_sel_hi:[1,0]
    v_pk_mul_f32 v[142:143], v[116:117], v[84:85] op_sel:[0,0] op_sel_hi:[1,0]
    v_pk_mul_f32 v[140:141], v[112:113], v[86:87] op_sel:[0,0] op_sel_hi:[1,0]
    v_pk_mul_f32 v[144:145], v[148:149], v[88:89] op_sel:[0,0] op_sel_hi:[1,0]
    v_pk_fma_f32 v[130:131], v[124:125], v[76:77], v[130:131] op_sel:[1,1,0] op_sel_hi:[0,1,1] neg_lo:[1,0,0] neg_hi:[0,0,0]
    v_pk_fma_f32 v[126:127], v[128:129], v[78:79], v[126:127] op_sel:[1,1,0] op_sel_hi:[0,1,1] neg_lo:[1,0,0] neg_hi:[0,0,0]
    v_pk_fma_f32 v[150:151], v[146:147], v[80:81], v[150:151] op_sel:[1,1,0] op_sel_hi:[0,1,1] neg_lo:[1,0,0] neg_hi:[0,0,0]
    v_pk_fma_f32 v[138:139], v[122:123], v[82:83], v[138:139] op_sel:[1,1,0] op_sel_hi:[0,1,1] neg_lo:[1,0,0] neg_hi:[0,0,0]
    v_pk_fma_f32 v[142:143], v[116:117], v[84:85], v[142:143] op_sel:[1,1,0] op_sel_hi:[0,1,1] neg_lo:[1,0,0] neg_hi:[0,0,0]
    v_pk_fma_f32 v[140:141], v[112:113], v[86:87], v[140:141] op_sel:[1,1,0] op_sel_hi:[0,1,1] neg_lo:[1,0,0] neg_hi:[0,0,0]
    v_pk_fma_f32 v[144:145], v[148:149], v[88:89], v[144:145] op_sel:[1,1,0] op_sel_hi:[0,1,1] neg_lo:[1,0,0] neg_hi:[0,0,0]
    ds_write_b64 v6, v[114:115] offset:18432
    ds_write_b64 v6, v[130:131] offset:18464
    ds_write_b64 v6, v[126:127] offset:18496
    ds_write_b64 v6, v[150:151] offset:18528
    ds_write_b64 v6, v[138:139] offset:18560
    ds_write_b64 v6, v[142:143] offset:18592
    ds_write_b64 v6, v[140:141] offset:18624
    ds_write_b64 v6, v[144:145] offset:18656
    ds_read_b64 v[118:119], v100 offset:18432
    ds_read_b64 v[120:121], v100 offset:18440
    ds_read_b64 v[134:135], v100 offset:18448
    ds_read_b64 v[132:133], v100 offset:18456
    ds_read_b64 v[136:137], v100 offset:18464
    ds_read_b64 v[124:125], v100 offset:18472
    ds_read_b64 v[128:129], v100 offset:18480
    ds_read_b64 v[146:147], v100 offset:18488
    s_add_u32 s29, s29, 4096
    s_add_u32 s28, s28, 4096
    s_mov_b32 m0, s29
    s_nop 0
    buffer_load_dwordx4 v102, s[8:11], s28 offen offset:0 sc1 lds
    buffer_load_dwordx4 v102, s[8:11], s28 offen offset:1024 sc1 lds
    buffer_load_dwordx4 v102, s[8:11], s28 offen offset:2048 sc1 lds
    buffer_load_dwordx4 v102, s[8:11], s28 offen offset:3072 sc1 lds
    s_waitcnt lgkmcnt(14)
    v_pk_add_f32 v[18:19], v[14:15], v[30:31]
    v_pk_add_f32 v[12:13], v[14:15], v[30:31] neg_lo:[0,1] neg_hi:[0,1]
    v_pk_add_f32 v[8:9], v[16:17], v[28:29]
    v_pk_add_f32 v[44:45], v[16:17], v[28:29] neg_lo:[0,1] neg_hi:[0,1]
    v_pk_add_f32 v[10:11], v[18:19], v[8:9]
    v_pk_add_f32 v[26:27], v[18:19], v[8:9] neg_lo:[0,1] neg_hi:[0,1]
    v_pk_add_f32 v[22:23], v[12:13], v[44:45] op_sel:[0,1] op_sel_hi:[1,0] neg_lo:[0,0] neg_hi:[0,1]
    v_pk_add_f32 v[46:47], v[12:13], v[44:45] op_sel:[0,1] op_sel_hi:[1,0] neg_lo:[0,1] neg_hi:[0,0]
    v_pk_add_f32 v[34:35], v[32:33], v[24:25]
    v_pk_add_f32 v[38:39], v[32:33], v[24:25] neg_lo:[0,1] neg_hi:[0,1]
    v_pk_add_f32 v[36:37], v[20:21], v[42:43]
    v_pk_add_f32 v[40:41], v[20:21], v[42:43] neg_lo:[0,1] neg_hi:[0,1]
    v_pk_add_f32 v[14:15], v[34:35], v[36:37]
    v_pk_add_f32 v[16:17], v[34:35], v[36:37] neg_lo:[0,1] neg_hi:[0,1]
    v_pk_add_f32 v[30:31], v[38:39], v[40:41] op_sel:[0,1] op_sel_hi:[1,0] neg_lo:[0,0] neg_hi:[0,1]
    v_pk_add_f32 v[28:29], v[38:39], v[40:41] op_sel:[0,1] op_sel_hi:[1,0] neg_lo:[0,1] neg_hi:[0,0]
    v_lshlrev_b32 v18, 16, v92
    v_and_b32 v19, 0xffff0000, v92
    v_lshlrev_b32 v12, 16, v93
    v_and_b32 v13, 0xffff0000, v93
    v_lshlrev_b32 v8, 16, v94
    v_and_b32 v9, 0xffff0000, v94
    v_lshlrev_b32 v44, 16, v95
    v_and_b32 v45, 0xffff0000, v95
    v_pk_mul_f32 v[32:33], v[10:11], v[18:19] op_sel:[0,0] op_sel_hi:[1,0]
    v_pk_mul_f32 v[20:21], v[22:23], v[12:13] op_sel:[0,0] op_sel_hi:[1,0]
    v_pk_mul_f32 v[24:25], v[26:27], v[8:9] op_sel:[0,0] op_sel_hi:[1,0]
    v_pk_mul_f32 v[42:43], v[46:47], v[44:45] op_sel:[0,0] op_sel_hi:[1,0]
    v_pk_fma_f32 v[32:33], v[10:11], v[18:19], v[32:33] op_sel:[1,1,0] op_sel_hi:[0,1,1] neg_lo:[1,0,0] neg_hi:[0,0,0]
    v_pk_fma_f32 v[20:21], v[22:23], v[12:13], v[20:21] op_sel:[1,1,0] op_sel_hi:[0,1,1] neg_lo:[1,0,0] neg_hi:[0,0,0]
    v_pk_fma_f32 v[24:25], v[26:27], v[8:9], v[24:25] op_sel:[1,1,0] op_sel_hi:[0,1,1] neg_lo:[1,0,0] neg_hi:[0,0,0]
    v_pk_fma_f32 v[42:43], v[46:47], v[44:45], v[42:43] op_sel:[1,1,0] op_sel_hi:[0,1,1] neg_lo:[1,0,0] neg_hi:[0,0,0]
    v_lshlrev_b32 v34, 16, v96
    v_and_b32 v35, 0xffff0000, v96
    v_lshlrev_b32 v38, 16, v97
    v_and_b32 v39, 0xffff0000, v97
    v_lshlrev_b32 v36, 16, v98
    v_and_b32 v37, 0xffff0000, v98
    v_lshlrev_b32 v40, 16, v99
    v_and_b32 v41, 0xffff0000, v99
    v_pk_mul_f32 v[10:11], v[14:15], v[34:35] op_sel:[0,0] op_sel_hi:[1,0]
    v_pk_mul_f32 v[22:23], v[30:31], v[38:39] op_sel:[0,0] op_sel_hi:[1,0]
    v_pk_mul_f32 v[26:27], v[16:17], v[36:37] op_sel:[0,0] op_sel_hi:[1,0]
    v_pk_mul_f32 v[46:47], v[28:29], v[40:41] op_sel:[0,0] op_sel_hi:[1,0]
    v_pk_fma_f32 v[10:11], v[14:15], v[34:35], v[10:11] op_sel:[1,1,0] op_sel_hi:[0,1,1] neg_lo:[1,0,0] neg_hi:[0,0,0]
    v_pk_fma_f32 v[22:23], v[30:31], v[38:39], v[22:23] op_sel:[1,1,0] op_sel_hi:[0,1,1] neg_lo:[1,0,0] neg_hi:[0,0,0]
    v_pk_fma_f32 v[26:27], v[16:17], v[36:37], v[26:27] op_sel:[1,1,0] op_sel_hi:[0,1,1] neg_lo:[1,0,0] neg_hi:[0,0,0]
    v_pk_fma_f32 v[46:47], v[28:29], v[40:41], v[46:47] op_sel:[1,1,0] op_sel_hi:[0,1,1] neg_lo:[1,0,0] neg_hi:[0,0,0]
    v_pk_add_f32 v[18:19], v[32:33], v[24:25]
    v_pk_add_f32 v[12:13], v[32:33], v[24:25] neg_lo:[0,1] neg_hi:[0,1]
    v_pk_add_f32 v[8:9], v[20:21], v[42:43]
    v_pk_add_f32 v[44:45], v[20:21], v[42:43] neg_lo:[0,1] neg_hi:[0,1]
    v_pk_add_f32 v[14:15], v[18:19], v[8:9]
    v_pk_add_f32 v[30:31], v[18:19], v[8:9] neg_lo:[0,1] neg_hi:[0,1]
    v_pk_add_f32 v[16:17], v[12:13], v[44:45] op_sel:[0,1] op_sel_hi:[1,0] neg_lo:[0,1] neg_hi:[0,0]
    v_pk_add_f32 v[28:29], v[12:13], v[44:45] op_sel:[0,1] op_sel_hi:[1,0] neg_lo:[0,0] neg_hi:[0,1]
    v_pk_add_f32 v[34:35], v[10:11], v[26:27]
    v_pk_add_f32 v[38:39], v[10:11], v[26:27] neg_lo:[0,1] neg_hi:[0,1]
    v_pk_add_f32 v[36:37], v[22:23], v[46:47]
    v_pk_add_f32 v[40:41], v[22:23], v[46:47] neg_lo:[0,1] neg_hi:[0,1]
    v_pk_add_f32 v[32:33], v[34:35], v[36:37]
    v_pk_add_f32 v[20:21], v[34:35], v[36:37] neg_lo:[0,1] neg_hi:[0,1]
    v_pk_add_f32 v[24:25], v[38:39], v[40:41] op_sel:[0,1] op_sel_hi:[1,0] neg_lo:[0,1] neg_hi:[0,0]
    v_pk_add_f32 v[42:43], v[38:39], v[40:41] op_sel:[0,1] op_sel_hi:[1,0] neg_lo:[0,0] neg_hi:[0,1]
    ds_write_b64 v100, v[14:15] offset:0
    ds_write_b64 v100, v[16:17] offset:8
    ds_write_b64 v100, v[30:31] offset:16
    ds_write_b64 v100, v[28:29] offset:24
    ds_write_b64 v100, v[32:33] offset:32
    ds_write_b64 v100, v[24:25] offset:40
    ds_write_b64 v100, v[20:21] offset:48
    ds_write_b64 v100, v[42:43] offset:56
    ds_read_b64 v[18:19], v6 offset:0
    ds_read_b64 v[12:13], v6 offset:32
    ds_read_b64 v[8:9], v6 offset:64
    ds_read_b64 v[44:45], v6 offset:96
    ds_read_b64 v[10:11], v6 offset:128
    ds_read_b64 v[22:23], v6 offset:160
    ds_read_b64 v[26:27], v6 offset:192
    ds_read_b64 v[46:47], v6 offset:224
    s_waitcnt lgkmcnt(14)
    v_pk_add_f32 v[122:123], v[118:119], v[134:135]
    v_pk_add_f32 v[116:117], v[118:119], v[134:135] neg_lo:[0,1] neg_hi:[0,1]
    v_pk_add_f32 v[112:113], v[120:121], v[132:133]
    v_pk_add_f32 v[148:149], v[120:121], v[132:133] neg_lo:[0,1] neg_hi:[0,1]
    v_pk_add_f32 v[114:115], v[122:123], v[112:113]
    v_pk_add_f32 v[130:131], v[122:123], v[112:113] neg_lo:[0,1] neg_hi:[0,1]
    v_pk_add_f32 v[126:127], v[116:117], v[148:149] op_sel:[0,1] op_sel_hi:[1,0] neg_lo:[0,0] neg_hi:[0,1]
    v_pk_add_f32 v[150:151], v[116:117], v[148:149] op_sel:[0,1] op_sel_hi:[1,0] neg_lo:[0,1] neg_hi:[0,0]
    v_pk_add_f32 v[138:139], v[136:137], v[128:129]
    v_pk_add_f32 v[142:143], v[136:137], v[128:129] neg_lo:[0,1] neg_hi:[0,1]
    v_pk_add_f32 v[140:141], v[124:125], v[146:147]
    v_pk_add_f32 v[144:145], v[124:125], v[146:147] neg_lo:[0,1] neg_hi:[0,1]
    v_pk_add_f32 v[118:119], v[138:139], v[140:141]
    v_pk_add_f32 v[120:121], v[138:139], v[140:141] neg_lo:[0,1] neg_hi:[0,1]
    v_pk_add_f32 v[134:135], v[142:143], v[144:145] op_sel:[0,1] op_sel_hi:[1,0] neg_lo:[0,0] neg_hi:[0,1]
    v_pk_add_f32 v[132:133], v[142:143], v[144:145] op_sel:[0,1] op_sel_hi:[1,0] neg_lo:[0,1] neg_hi:[0,0]
    v_lshlrev_b32 v122, 16, v104
    v_and_b32 v123, 0xffff0000, v104
    v_lshlrev_b32 v116, 16, v105
    v_and_b32 v117, 0xffff0000, v105
    v_lshlrev_b32 v112, 16, v106
    v_and_b32 v113, 0xffff0000, v106
    v_lshlrev_b32 v148, 16, v107
    v_and_b32 v149, 0xffff0000, v107
    v_pk_mul_f32 v[136:137], v[114:115], v[122:123] op_sel:[0,0] op_sel_hi:[1,0]
    v_pk_mul_f32 v[124:125], v[126:127], v[116:117] op_sel:[0,0] op_sel_hi:[1,0]
    v_pk_mul_f32 v[128:129], v[130:131], v[112:113] op_sel:[0,0] op_sel_hi:[1,0]
    v_pk_mul_f32 v[146:147], v[150:151], v[148:149] op_sel:[0,0] op_sel_hi:[1,0]
    v_pk_fma_f32 v[136:137], v[114:115], v[122:123], v[136:137] op_sel:[1,1,0] op_sel_hi:[0,1,1] neg_lo:[1,0,0] neg_hi:[0,0,0]
    v_pk_fma_f32 v[124:125], v[126:127], v[116:117], v[124:125] op_sel:[1,1,0] op_sel_hi:[0,1,1] neg_lo:[1,0,0] neg_hi:[0,0,0]
    v_pk_fma_f32 v[128:129], v[130:131], v[112:113], v[128:129] op_sel:[1,1,0] op_sel_hi:[0,1,1] neg_lo:[1,0,0] neg_hi:[0,0,0]
    v_pk_fma_f32 v[146:147], v[150:151], v[148:149], v[146:147] op_sel:[1,1,0] op_sel_hi:[0,1,1] neg_lo:[1,0,0] neg_hi:[0,0,0]
    v_lshlrev_b32 v138, 16, v108
    v_and_b32 v139, 0xffff0000, v108
    v_lshlrev_b32 v142, 16, v109
    v_and_b32 v143, 0xffff0000, v109
    v_lshlrev_b32 v140, 16, v110
    v_and_b32 v141, 0xffff0000, v110
    v_lshlrev_b32 v144, 16, v111
    v_and_b32 v145, 0xffff0000, v111
    v_pk_mul_f32 v[114:115], v[118:119], v[138:139] op_sel:[0,0] op_sel_hi:[1,0]
    v_pk_mul_f32 v[126:127], v[134:135], v[142:143] op_sel:[0,0] op_sel_hi:[1,0]
    v_pk_mul_f32 v[130:131], v[120:121], v[140:141] op_sel:[0,0] op_sel_hi:[1,0]
    v_pk_mul_f32 v[150:151], v[132:133], v[144:145] op_sel:[0,0] op_sel_hi:[1,0]
    v_pk_fma_f32 v[114:115], v[118:119], v[138:139], v[114:115] op_sel:[1,1,0] op_sel_hi:[0,1,1] neg_lo:[1,0,0] neg_hi:[0,0,0]
    v_pk_fma_f32 v[126:127], v[134:135], v[142:143], v[126:127] op_sel:[1,1,0] op_sel_hi:[0,1,1] neg_lo:[1,0,0] neg_hi:[0,0,0]
    v_pk_fma_f32 v[130:131], v[120:121], v[140:141], v[130:131] op_sel:[1,1,0] op_sel_hi:[0,1,1] neg_lo:[1,0,0] neg_hi:[0,0,0]
    v_pk_fma_f32 v[150:151], v[132:133], v[144:145], v[150:151] op_sel:[1,1,0] op_sel_hi:[0,1,1] neg_lo:[1,0,0] neg_hi:[0,0,0]
    v_pk_add_f32 v[122:123], v[136:137], v[128:129]
    v_pk_add_f32 v[116:117], v[136:137], v[128:129] neg_lo:[0,1] neg_hi:[0,1]
    v_pk_add_f32 v[112:113], v[124:125], v[146:147]
    v_pk_add_f32 v[148:149], v[124:125], v[146:147] neg_lo:[0,1] neg_hi:[0,1]
    v_pk_add_f32 v[118:119], v[122:123], v[112:113]
    v_pk_add_f32 v[134:135], v[122:123], v[112:113] neg_lo:[0,1] neg_hi:[0,1]
    v_pk_add_f32 v[120:121], v[116:117], v[148:149] op_sel:[0,1] op_sel_hi:[1,0] neg_lo:[0,1] neg_hi:[0,0]
    v_pk_add_f32 v[132:133], v[116:117], v[148:149] op_sel:[0,1] op_sel_hi:[1,0] neg_lo:[0,0] neg_hi:[0,1]
    v_pk_add_f32 v[138:139], v[114:115], v[130:131]
    v_pk_add_f32 v[142:143], v[114:115], v[130:131] neg_lo:[0,1] neg_hi:[0,1]
    v_pk_add_f32 v[140:141], v[126:127], v[150:151]
    v_pk_add_f32 v[144:145], v[126:127], v[150:151] neg_lo:[0,1] neg_hi:[0,1]
    v_pk_add_f32 v[136:137], v[138:139], v[140:141]
    v_pk_add_f32 v[124:125], v[138:139], v[140:141] neg_lo:[0,1] neg_hi:[0,1]
    v_pk_add_f32 v[128:129], v[142:143], v[144:145] op_sel:[0,1] op_sel_hi:[1,0] neg_lo:[0,1] neg_hi:[0,0]
    v_pk_add_f32 v[146:147], v[142:143], v[144:145] op_sel:[0,1] op_sel_hi:[1,0] neg_lo:[0,0] neg_hi:[0,1]
    ds_write_b64 v100, v[118:119] offset:18432
    ds_write_b64 v100, v[120:121] offset:18440
    ds_write_b64 v100, v[134:135] offset:18448
    ds_write_b64 v100, v[132:133] offset:18456
    ds_write_b64 v100, v[136:137] offset:18464
    ds_write_b64 v100, v[128:129] offset:18472
    ds_write_b64 v100, v[124:125] offset:18480
    ds_write_b64 v100, v[146:147] offset:18488
    ds_read_b64 v[122:123], v6 offset:18432
    ds_read_b64 v[116:117], v6 offset:18464
    ds_read_b64 v[112:113], v6 offset:18496
    ds_read_b64 v[148:149], v6 offset:18528
    ds_read_b64 v[114:115], v6 offset:18560
    ds_read_b64 v[126:127], v6 offset:18592
    ds_read_b64 v[130:131], v6 offset:18624
    ds_read_b64 v[150:151], v6 offset:18656
    s_add_u32 s29, s29, 4096
    s_add_u32 s28, s28, 4096
    s_mov_b32 m0, s29
    s_nop 0
    buffer_load_dwordx4 v102, s[8:11], s28 offen offset:0 sc1 lds
    buffer_load_dwordx4 v102, s[8:11], s28 offen offset:1024 sc1 lds
    buffer_load_dwordx4 v102, s[8:11], s28 offen offset:2048 sc1 lds
    buffer_load_dwordx4 v102, s[8:11], s28 offen offset:3072 sc1 lds
    s_waitcnt lgkmcnt(14)
    v_pk_mul_f32 v[34:35], v[12:13], v[76:77] op_sel:[0,0] op_sel_hi:[1,0]
    v_pk_mul_f32 v[38:39], v[8:9], v[78:79] op_sel:[0,0] op_sel_hi:[1,0]
    v_pk_mul_f32 v[36:37], v[44:45], v[80:81] op_sel:[0,0] op_sel_hi:[1,0]
    v_pk_mul_f32 v[40:41], v[10:11], v[82:83] op_sel:[0,0] op_sel_hi:[1,0]
    v_pk_mul_f32 v[14:15], v[22:23], v[84:85] op_sel:[0,0] op_sel_hi:[1,0]
    v_pk_mul_f32 v[16:17], v[26:27], v[86:87] op_sel:[0,0] op_sel_hi:[1,0]
    v_pk_mul_f32 v[30:31], v[46:47], v[88:89] op_sel:[0,0] op_sel_hi:[1,0]
    v_pk_fma_f32 v[34:35], v[12:13], v[76:77], v[34:35] op_sel:[1,1,0] op_sel_hi:[0,1,1] neg_lo:[0,0,0] neg_hi:[1,0,0]
    v_pk_fma_f32 v[38:39], v[8:9], v[78:79], v[38:39] op_sel:[1,1,0] op_sel_hi:[0,1,1] neg_lo:[0,0,0] neg_hi:[1,0,0]
    v_pk_fma_f32 v[36:37], v[44:45], v[80:81], v[36:37] op_sel:[1,1,0] op_sel_hi:[0,1,1] neg_lo:[0,0,0] neg_hi:[1,0,0]
    v_pk_fma_f32 v[40:41], v[10:11], v[82:83], v[40:41] op_sel:[1,1,0] op_sel_hi:[0,1,1] neg_lo:[0,0,0] neg_hi:[1,0,0]
    v_pk_fma_f32 v[14:15], v[22:23], v[84:85], v[14:15] op_sel:[1,1,0] op_sel_hi:[0,1,1] neg_lo:[0,0,0] neg_hi:[1,0,0]
    v_pk_fma_f32 v[16:17], v[26:27], v[86:87], v[16:17] op_sel:[1,1,0] op_sel_hi:[0,1,1] neg_lo:[0,0,0] neg_hi:[1,0,0]
    v_pk_fma_f32 v[30:31], v[46:47], v[88:89], v[30:31] op_sel:[1,1,0] op_sel_hi:[0,1,1] neg_lo:[0,0,0] neg_hi:[1,0,0]
    v_pk_add_f32 v[28:29], v[18:19], v[40:41]
    v_pk_add_f32 v[32:33], v[18:19], v[40:41] neg_lo:[0,1] neg_hi:[0,1]
    v_pk_add_f32 v[24:25], v[34:35], v[14:15]
    v_pk_add_f32 v[20:21], v[34:35], v[14:15] neg_lo:[0,1] neg_hi:[0,1]
    v_pk_add_f32 v[42:43], v[38:39], v[16:17]
    v_pk_add_f32 v[12:13], v[38:39], v[16:17] neg_lo:[0,1] neg_hi:[0,1]
    v_pk_add_f32 v[8:9], v[36:37], v[30:31]
    v_pk_add_f32 v[44:45], v[36:37], v[30:31] neg_lo:[0,1] neg_hi:[0,1]
    v_pk_add_f32 v[10:11], v[28:29], v[42:43]
    v_pk_add_f32 v[22:23], v[28:29], v[42:43] neg_lo:[0,1] neg_hi:[0,1]
    v_pk_add_f32 v[26:27], v[24:25], v[8:9]
    v_pk_add_f32 v[46:47], v[24:25], v[8:9] neg_lo:[0,1] neg_hi:[0,1]
    v_pk_add_f32 v[18:19], v[10:11], v[26:27]
    v_pk_add_f32 v[40:41], v[10:11], v[26:27] neg_lo:[0,1] neg_hi:[0,1]
    v_pk_add_f32 v[34:35], v[22:23], v[46:47] op_sel:[0,1] op_sel_hi:[1,0] neg_lo:[0,1] neg_hi:[0,0]
    v_pk_add_f32 v[14:15], v[22:23], v[46:47] op_sel:[0,1] op_sel_hi:[1,0] neg_lo:[0,0] neg_hi:[0,1]
    v_pk_add_f32 v[38:39], v[20:21], v[20:21] op_sel:[0,1] op_sel_hi:[1,0] neg_lo:[0,1] neg_hi:[0,0]
    v_pk_add_f32 v[16:17], v[44:45], v[44:45] op_sel:[0,1] op_sel_hi:[1,0] neg_lo:[1,1] neg_hi:[1,0]
    v_pk_add_f32 v[36:37], v[32:33], v[12:13] op_sel:[0,1] op_sel_hi:[1,0] neg_lo:[0,1] neg_hi:[0,0]
    v_pk_add_f32 v[30:31], v[32:33], v[12:13] op_sel:[0,1] op_sel_hi:[1,0] neg_lo:[0,0] neg_hi:[0,1]
    v_pk_add_f32 v[28:29], v[38:39], v[16:17]
    v_pk_add_f32 v[24:25], v[38:39], v[16:17] neg_lo:[0,1] neg_hi:[0,1]
    v_pk_fma_f32 v[42:43], v[28:29], s[26:27], v[36:37] neg_lo:[0,0,0] neg_hi:[0,0,0]
    v_pk_fma_f32 v[8:9], v[28:29], s[26:27], v[36:37] neg_lo:[1,0,0] neg_hi:[1,0,0]
    v_pk_fma_f32 v[10:11], v[24:25], s[26:27], v[30:31] op_sel:[1,0,0] op_sel_hi:[0,1,1] neg_lo:[1,0,0] neg_hi:[0,0,0]
    v_pk_fma_f32 v[22:23], v[24:25], s[26:27], v[30:31] op_sel:[1,0,0] op_sel_hi:[0,1,1] neg_lo:[0,0,0] neg_hi:[1,0,0]
    ds_write_b64 v6, v[18:19] offset:0
    ds_write_b64 v6, v[42:43] offset:32
    ds_write_b64 v6, v[34:35] offset:64
    ds_write_b64 v6, v[10:11] offset:96
    ds_write_b64 v6, v[40:41] offset:128
    ds_write_b64 v6, v[8:9] offset:160
    ds_write_b64 v6, v[14:15] offset:192
    ds_write_b64 v6, v[22:23] offset:224
    ds_read_b64 v[26:27], v5 offset:0
    ds_read_b64 v[46:47], v5 offset:288
    ds_read_b64 v[32:33], v5 offset:576
    ds_read_b64 v[20:21], v5 offset:864
    ds_read_b64 v[12:13], v5 offset:1152
    ds_read_b64 v[44:45], v5 offset:1440
    ds_read_b64 v[38:39], v5 offset:1728
    ds_read_b64 v[16:17], v5 offset:2016
    s_waitcnt lgkmcnt(14)
    v_pk_mul_f32 v[138:139], v[116:117], v[76:77] op_sel:[0,0] op_sel_hi:[1,0]
    v_pk_mul_f32 v[142:143], v[112:113], v[78:79] op_sel:[0,0] op_sel_hi:[1,0]
    v_pk_mul_f32 v[140:141], v[148:149], v[80:81] op_sel:[0,0] op_sel_hi:[1,0]
    v_pk_mul_f32 v[144:145], v[114:115], v[82:83] op_sel:[0,0] op_sel_hi:[1,0]
    v_pk_mul_f32 v[118:119], v[126:127], v[84:85] op_sel:[0,0] op_sel_hi:[1,0]
    v_pk_mul_f32 v[120:121], v[130:131], v[86:87] op_sel:[0,0] op_sel_hi:[1,0]
    v_pk_mul_f32 v[134:135], v[150:151], v[88:89] op_sel:[0,0] op_sel_hi:[1,0]
    v_pk_fma_f32 v[138:139], v[116:117], v[76:77], v[138:139] op_sel:[1,1,0] op_sel_hi:[0,1,1] neg_lo:[0,0,0] neg_hi:[1,0,0]
    v_pk_fma_f32 v[142:143], v[112:113], v[78:79], v[142:143] op_sel:[1,1,0] op_sel_hi:[0,1,1] neg_lo:[0,0,0] neg_hi:[1,0,0]
    v_pk_fma_f32 v[140:141], v[148:149], v[80:81], v[140:141] op_sel:[1,1,0] op_sel_hi:[0,1,1] neg_lo:[0,0,0] neg_hi:[1,0,0]
    v_pk_fma_f32 v[144:145], v[114:115], v[82:83], v[144:145] op_sel:[1,1,0] op_sel_hi:[0,1,1] neg_lo:[0,0,0] neg_hi:[1,0,0]
    v_pk_fma_f32 v[118:119], v[126:127], v[84:85], v[118:119] op_sel:[1,1,0] op_sel_hi:[0,1,1] neg_lo:[0,0,0] neg_hi:[1,0,0]
    v_pk_fma_f32 v[120:121], v[130:131], v[86:87], v[120:121] op_sel:[1,1,0] op_sel_hi:[0,1,1] neg_lo:[0,0,0] neg_hi:[1,0,0]
    v_pk_fma_f32 v[134:135], v[150:151], v[88:89], v[134:135] op_sel:[1,1,0] op_sel_hi:[0,1,1] neg_lo:[0,0,0] neg_hi:[1,0,0]
    v_pk_add_f32 v[132:133], v[122:123], v[144:145]
    v_pk_add_f32 v[136:137], v[122:123], v[144:145] neg_lo:[0,1] neg_hi:[0,1]
    v_pk_add_f32 v[128:129], v[138:139], v[118:119]
    v_pk_add_f32 v[124:125], v[138:139], v[118:119] neg_lo:[0,1] neg_hi:[0,1]
    v_pk_add_f32 v[146:147], v[142:143], v[120:121]
    v_pk_add_f32 v[116:117], v[142:143], v[120:121] neg_lo:[0,1] neg_hi:[0,1]
    v_pk_add_f32 v[112:113], v[140:141], v[134:135]
    v_pk_add_f32 v[148:149], v[140:141], v[134:135] neg_lo:[0,1] neg_hi:[0,1]
    v_pk_add_f32 v[114:115], v[132:133], v[146:147]
    v_pk_add_f32 v[126:127], v[132:133], v[146:147] neg_lo:[0,1] neg_hi:[0,1]
    v_pk_add_f32 v[130:131], v[128:129], v[112:113]
    v_pk_add_f32 v[150:151], v[128:129], v[112:113] neg_lo:[0,1] neg_hi:[0,1]
    v_pk_add_f32 v[122:123], v[114:115], v[130:131]
    v_pk_add_f32 v[144:145], v[114:115], v[130:131] neg_lo:[0,1] neg_hi:[0,1]
    v_pk_add_f32 v[138:139], v[126:127], v[150:151] op_sel:[0,1] op_sel_hi:[1,0] neg_lo:[0,1] neg_hi:[0,0]
    v_pk_add_f32 v[118:119], v[126:127], v[150:151] op_sel:[0,1] op_sel_hi:[1,0] neg_lo:[0,0] neg_hi:[0,1]
    v_pk_add_f32 v[142:143], v[124:125], v[124:125] op_sel:[0,1] op_sel_hi:[1,0] neg_lo:[0,1] neg_hi:[0,0]
    v_pk_add_f32 v[120:121], v[148:149], v[148:149] op_sel:[0,1] op_sel_hi:[1,0] neg_lo:[1,1] neg_hi:[1,0]
    v_pk_add_f32 v[140:141], v[136:137], v[116:117] op_sel:[0,1] op_sel_hi:[1,0] neg_lo:[0,1] neg_hi:[0,0]
    v_pk_add_f32 v[134:135], v[136:137], v[116:117] op_sel:[0,1] op_sel_hi:[1,0] neg_lo:[0,0] neg_hi:[0,1]
    v_pk_add_f32 v[132:133], v[142:143], v[120:121]
    v_pk_add_f32 v[128:129], v[142:143], v[120:121] neg_lo:[0,1] neg_hi:[0,1]
    v_pk_fma_f32 v[146:147], v[132:133], s[26:27], v[140:141] neg_lo:[0,0,0] neg_hi:[0,0,0]
    v_pk_fma_f32 v[112:113], v[132:133], s[26:27], v[140:141] neg_lo:[1,0,0] neg_hi:[1,0,0]
    v_pk_fma_f32 v[114:115], v[128:129], s[26:27], v[134:135] op_sel:[1,0,0] op_sel_hi:[0,1,1] neg_lo:[1,0,0] neg_hi:[0,0,0]
    v_pk_fma_f32 v[126:127], v[128:129], s[26:27], v[134:135] op_sel:[1,0,0] op_sel_hi:[0,1,1] neg_lo:[0,0,0] neg_hi:[1,0,0]
    ds_write_b64 v6, v[122:123] offset:18432
    ds_write_b64 v6, v[146:147] offset:18464
    ds_write_b64 v6, v[138:139] offset:18496
    ds_write_b64 v6, v[114:115] offset:18528
    ds_write_b64 v6, v[144:145] offset:18560
    ds_write_b64 v6, v[112:113] offset:18592
    ds_write_b64 v6, v[118:119] offset:18624
    ds_write_b64 v6, v[126:127] offset:18656
    ds_read_b64 v[130:131], v5 offset:18432
    ds_read_b64 v[150:151], v5 offset:18720
    ds_read_b64 v[136:137], v5 offset:19008
    ds_read_b64 v[124:125], v5 offset:19296
    ds_read_b64 v[116:117], v5 offset:19584
    ds_read_b64 v[148:149], v5 offset:19872
    ds_read_b64 v[142:143], v5 offset:20160
    ds_read_b64 v[120:121], v5 offset:20448
    s_waitcnt lgkmcnt(14)
    v_pk_mul_f32 v[36:37], v[46:47], v[62:63] op_sel:[0,0] op_sel_hi:[1,0]
    v_pk_mul_f32 v[30:31], v[32:33], v[64:65] op_sel:[0,0] op_sel_hi:[1,0]
    v_pk_mul_f32 v[28:29], v[20:21], v[66:67] op_sel:[0,0] op_sel_hi:[1,0]
    v_pk_mul_f32 v[24:25], v[12:13], v[68:69] op_sel:[0,0] op_sel_hi:[1,0]
    v_pk_mul_f32 v[18:19], v[44:45], v[70:71] op_sel:[0,0] op_sel_hi:[1,0]
    v_pk_mul_f32 v[42:43], v[38:39], v[72:73] op_sel:[0,0] op_sel_hi:[1,0]
    v_pk_mul_f32 v[34:35], v[16:17], v[74:75] op_sel:[0,0] op_sel_hi:[1,0]
    v_pk_fma_f32 v[36:37], v[46:47], v[62:63], v[36:37] op_sel:[1,1,0] op_sel_hi:[0,1,1] neg_lo:[0,0,0] neg_hi:[1,0,0]
    v_pk_fma_f32 v[30:31], v[32:33], v[64:65], v[30:31] op_sel:[1,1,0] op_sel_hi:[0,1,1] neg_lo:[0,0,0] neg_hi:[1,0,0]
    v_pk_fma_f32 v[28:29], v[20:21], v[66:67], v[28:29] op_sel:[1,1,0] op_sel_hi:[0,1,1] neg_lo:[0,0,0] neg_hi:[1,0,0]
    v_pk_fma_f32 v[24:25], v[12:13], v[68:69], v[24:25] op_sel:[1,1,0] op_sel_hi:[0,1,1] neg_lo:[0,0,0] neg_hi:[1,0,0]
    v_pk_fma_f32 v[18:19], v[44:45], v[70:71], v[18:19] op_sel:[1,1,0] op_sel_hi:[0,1,1] neg_lo:[0,0,0] neg_hi:[1,0,0]
    v_pk_fma_f32 v[42:43], v[38:39], v[72:73], v[42:43] op_sel:[1,1,0] op_sel_hi:[0,1,1] neg_lo:[0,0,0] neg_hi:[1,0,0]
    v_pk_fma_f32 v[34:35], v[16:17], v[74:75], v[34:35] op_sel:[1,1,0] op_sel_hi:[0,1,1] neg_lo:[0,0,0] neg_hi:[1,0,0]
    v_pk_add_f32 v[10:11], v[26:27], v[24:25]
    v_pk_add_f32 v[40:41], v[26:27], v[24:25] neg_lo:[0,1] neg_hi:[0,1]
    v_pk_add_f32 v[8:9], v[36:37], v[18:19]
    v_pk_add_f32 v[14:15], v[36:37], v[18:19] neg_lo:[0,1] neg_hi:[0,1]
    v_pk_add_f32 v[22:23], v[30:31], v[42:43]
    v_pk_add_f32 v[46:47], v[30:31], v[42:43] neg_lo:[0,1] neg_hi:[0,1]
    v_pk_add_f32 v[32:33], v[28:29], v[34:35]
    v_pk_add_f32 v[20:21], v[28:29], v[34:35] neg_lo:[0,1] neg_hi:[0,1]
    v_pk_add_f32 v[12:13], v[10:11], v[22:23]
    v_pk_add_f32 v[44:45], v[10:11], v[22:23] neg_lo:[0,1] neg_hi:[0,1]
    v_pk_add_f32 v[38:39], v[8:9], v[32:33]
    v_pk_add_f32 v[16:17], v[8:9], v[32:33] neg_lo:[0,1] neg_hi:[0,1]
    v_pk_add_f32 v[26:27], v[12:13], v[38:39]
    v_pk_add_f32 v[24:25], v[12:13], v[38:39] neg_lo:[0,1] neg_hi:[0,1]
    v_pk_add_f32 v[36:37], v[44:45], v[16:17] op_sel:[0,1] op_sel_hi:[1,0] neg_lo:[0,1] neg_hi:[0,0]
    v_pk_add_f32 v[18:19], v[44:45], v[16:17] op_sel:[0,1] op_sel_hi:[1,0] neg_lo:[0,0] neg_hi:[0,1]
    v_pk_add_f32 v[30:31], v[14:15], v[14:15] op_sel:[0,1] op_sel_hi:[1,0] neg_lo:[0,1] neg_hi:[0,0]
    v_pk_add_f32 v[42:43], v[20:21], v[20:21] op_sel:[0,1] op_sel_hi:[1,0] neg_lo:[1,1] neg_hi:[1,0]
    v_pk_add_f32 v[28:29], v[40:41], v[46:47] op_sel:[0,1] op_sel_hi:[1,0] neg_lo:[0,1] neg_hi:[0,0]
    v_pk_add_f32 v[34:35], v[40:41], v[46:47] op_sel:[0,1] op_sel_hi:[1,0] neg_lo:[0,0] neg_hi:[0,1]
    v_pk_add_f32 v[10:11], v[30:31], v[42:43]
    v_pk_add_f32 v[8:9], v[30:31], v[42:43] neg_lo:[0,1] neg_hi:[0,1]
    v_pk_fma_f32 v[22:23], v[10:11], s[26:27], v[28:29] neg_lo:[0,0,0] neg_hi:[0,0,0]
    v_pk_fma_f32 v[32:33], v[10:11], s[26:27], v[28:29] neg_lo:[1,0,0] neg_hi:[1,0,0]
    v_pk_fma_f32 v[12:13], v[8:9], s[26:27], v[34:35] op_sel:[1,0,0] op_sel_hi:[0,1,1] neg_lo:[1,0,0] neg_hi:[0,0,0]
    v_pk_fma_f32 v[44:45], v[8:9], s[26:27], v[34:35] op_sel:[1,0,0] op_sel_hi:[0,1,1] neg_lo:[0,0,0] neg_hi:[1,0,0]
    ds_write_b64 v5, v[26:27] offset:0
    ds_write_b64 v5, v[22:23] offset:256
    ds_write_b64 v5, v[36:37] offset:512
    ds_write_b64 v5, v[12:13] offset:768
    ds_write_b64 v5, v[24:25] offset:1024
    ds_write_b64 v5, v[32:33] offset:1280
    ds_write_b64 v5, v[18:19] offset:1536
    ds_write_b64 v5, v[44:45] offset:1792
    s_waitcnt lgkmcnt(14)
    v_pk_mul_f32 v[140:141], v[150:151], v[62:63] op_sel:[0,0] op_sel_hi:[1,0]
    s_waitcnt lgkmcnt(13)
    v_pk_mul_f32 v[134:135], v[136:137], v[64:65] op_sel:[0,0] op_sel_hi:[1,0]
    s_waitcnt lgkmcnt(12)
    v_pk_mul_f32 v[132:133], v[124:125], v[66:67] op_sel:[0,0] op_sel_hi:[1,0]
    s_waitcnt lgkmcnt(11)
    v_pk_mul_f32 v[128:129], v[116:117], v[68:69] op_sel:[0,0] op_sel_hi:[1,0]
    s_waitcnt lgkmcnt(10)
    v_pk_mul_f32 v[122:123], v[148:149], v[70:71] op_sel:[0,0] op_sel_hi:[1,0]
    s_waitcnt lgkmcnt(9)
    v_pk_mul_f32 v[146:147], v[142:143], v[72:73] op_sel:[0,0] op_sel_hi:[1,0]
    s_waitcnt lgkmcnt(8)
    v_pk_mul_f32 v[138:139], v[120:121], v[74:75] op_sel:[0,0] op_sel_hi:[1,0]
    v_pk_fma_f32 v[140:141], v[150:151], v[62:63], v[140:141] op_sel:[1,1,0] op_sel_hi:[0,1,1] neg_lo:[0,0,0] neg_hi:[1,0,0]
    v_pk_fma_f32 v[134:135], v[136:137], v[64:65], v[134:135] op_sel:[1,1,0] op_sel_hi:[0,1,1] neg_lo:[0,0,0] neg_hi:[1,0,0]
    v_pk_fma_f32 v[132:133], v[124:125], v[66:67], v[132:133] op_sel:[1,1,0] op_sel_hi:[0,1,1] neg_lo:[0,0,0] neg_hi:[1,0,0]
    v_pk_fma_f32 v[128:129], v[116:117], v[68:69], v[128:129] op_sel:[1,1,0] op_sel_hi:[0,1,1] neg_lo:[0,0,0] neg_hi:[1,0,0]
    v_pk_fma_f32 v[122:123], v[148:149], v[70:71], v[122:123] op_sel:[1,1,0] op_sel_hi:[0,1,1] neg_lo:[0,0,0] neg_hi:[1,0,0]
    v_pk_fma_f32 v[146:147], v[142:143], v[72:73], v[146:147] op_sel:[1,1,0] op_sel_hi:[0,1,1] neg_lo:[0,0,0] neg_hi:[1,0,0]
    v_pk_fma_f32 v[138:139], v[120:121], v[74:75], v[138:139] op_sel:[1,1,0] op_sel_hi:[0,1,1] neg_lo:[0,0,0] neg_hi:[1,0,0]
    v_pk_add_f32 v[114:115], v[130:131], v[128:129]
    v_pk_add_f32 v[144:145], v[130:131], v[128:129] neg_lo:[0,1] neg_hi:[0,1]
    v_pk_add_f32 v[112:113], v[140:141], v[122:123]
    v_pk_add_f32 v[118:119], v[140:141], v[122:123] neg_lo:[0,1] neg_hi:[0,1]
    v_pk_add_f32 v[126:127], v[134:135], v[146:147]
    v_pk_add_f32 v[150:151], v[134:135], v[146:147] neg_lo:[0,1] neg_hi:[0,1]
    v_pk_add_f32 v[136:137], v[132:133], v[138:139]
    v_pk_add_f32 v[124:125], v[132:133], v[138:139] neg_lo:[0,1] neg_hi:[0,1]
    v_pk_add_f32 v[116:117], v[114:115], v[126:127]
    v_pk_add_f32 v[148:149], v[114:115], v[126:127] neg_lo:[0,1] neg_hi:[0,1]
    v_pk_add_f32 v[142:143], v[112:113], v[136:137]
    v_pk_add_f32 v[120:121], v[112:113], v[136:137] neg_lo:[0,1] neg_hi:[0,1]
    v_pk_add_f32 v[130:131], v[116:117], v[142:143]
    v_pk_add_f32 v[128:129], v[116:117], v[142:143] neg_lo:[0,1] neg_hi:[0,1]
    v_pk_add_f32 v[140:141], v[148:149], v[120:121] op_sel:[0,1] op_sel_hi:[1,0] neg_lo:[0,1] neg_hi:[0,0]
    v_pk_add_f32 v[122:123], v[148:149], v[120:121] op_sel:[0,1] op_sel_hi:[1,0] neg_lo:[0,0] neg_hi:[0,1]
    v_pk_add_f32 v[134:135], v[118:119], v[118:119] op_sel:[0,1] op_sel_hi:[1,0] neg_lo:[0,1] neg_hi:[0,0]
    v_pk_add_f32 v[146:147], v[124:125], v[124:125] op_sel:[0,1] op_sel_hi:[1,0] neg_lo:[1,1] neg_hi:[1,0]
    v_pk_add_f32 v[132:133], v[144:145], v[150:151] op_sel:[0,1] op_sel_hi:[1,0] neg_lo:[0,1] neg_hi:[0,0]
    v_pk_add_f32 v[138:139], v[144:145], v[150:151] op_sel:[0,1] op_sel_hi:[1,0] neg_lo:[0,0] neg_hi:[0,1]
    v_pk_add_f32 v[114:115], v[134:135], v[146:147]
    v_pk_add_f32 v[112:113], v[134:135], v[146:147] neg_lo:[0,1] neg_hi:[0,1]
    v_pk_fma_f32 v[126:127], v[114:115], s[26:27], v[132:133] neg_lo:[0,0,0] neg_hi:[0,0,0]
    v_pk_fma_f32 v[136:137], v[114:115], s[26:27], v[132:133] neg_lo:[1,0,0] neg_hi:[1,0,0]
    v_pk_fma_f32 v[116:117], v[112:113], s[26:27], v[138:139] op_sel:[1,0,0] op_sel_hi:[0,1,1] neg_lo:[1,0,0] neg_hi:[0,0,0]
    v_pk_fma_f32 v[148:149], v[112:113], s[26:27], v[138:139] op_sel:[1,0,0] op_sel_hi:[0,1,1] neg_lo:[0,0,0] neg_hi:[1,0,0]
    ds_write_b64 v5, v[130:131] offset:18432
    ds_write_b64 v5, v[126:127] offset:18688
    ds_write_b64 v5, v[140:141] offset:18944
    ds_write_b64 v5, v[116:117] offset:19200
    ds_write_b64 v5, v[128:129] offset:19456
    ds_write_b64 v5, v[136:137] offset:19712
    ds_write_b64 v5, v[122:123] offset:19968
    ds_write_b64 v5, v[148:149] offset:20224
    s_waitcnt lgkmcnt(0)
    s_barrier
    ds_read_b64 v[38:39], v3 offset:0
    ds_read_b64 v[16:17], v3 offset:2304
    ds_read_b64 v[40:41], v3 offset:4608
    ds_read_b64 v[14:15], v3 offset:6912
    ds_read_b64 v[46:47], v3 offset:9216
    ds_read_b64 v[20:21], v3 offset:11520
    ds_read_b64 v[30:31], v3 offset:13824
    ds_read_b64 v[42:43], v3 offset:16128
    ds_read_b64 v[142:143], v3 offset:18432
    ds_read_b64 v[120:121], v3 offset:20736
    ds_read_b64 v[144:145], v3 offset:23040
    ds_read_b64 v[118:119], v3 offset:25344
    ds_read_b64 v[150:151], v3 offset:27648
    ds_read_b64 v[124:125], v3 offset:29952
    ds_read_b64 v[134:135], v3 offset:32256
    ds_read_b64 v[146:147], v3 offset:34560
    s_waitcnt lgkmcnt(14)
    v_pk_mul_f32 v[28:29], v[16:17], v[48:49] op_sel:[0,0] op_sel_hi:[1,0]
    s_waitcnt lgkmcnt(13)
    v_pk_mul_f32 v[34:35], v[40:41], v[50:51] op_sel:[0,0] op_sel_hi:[1,0]
    s_waitcnt lgkmcnt(12)
    v_pk_mul_f32 v[10:11], v[14:15], v[52:53] op_sel:[0,0] op_sel_hi:[1,0]
    s_waitcnt lgkmcnt(11)
    v_pk_mul_f32 v[8:9], v[46:47], v[54:55] op_sel:[0,0] op_sel_hi:[1,0]
    s_waitcnt lgkmcnt(10)
    v_pk_mul_f32 v[26:27], v[20:21], v[56:57] op_sel:[0,0] op_sel_hi:[1,0]
    s_waitcnt lgkmcnt(9)
    v_pk_mul_f32 v[22:23], v[30:31], v[58:59] op_sel:[0,0] op_sel_hi:[1,0]
    s_waitcnt lgkmcnt(8)
    v_pk_mul_f32 v[36:37], v[42:43], v[60:61] op_sel:[0,0] op_sel_hi:[1,0]
    v_pk_fma_f32 v[28:29], v[16:17], v[48:49], v[28:29] op_sel:[1,1,0] op_sel_hi:[0,1,1] neg_lo:[0,0,0] neg_hi:[1,0,0]
    v_pk_fma_f32 v[34:35], v[40:41], v[50:51], v[34:35] op_sel:[1,1,0] op_sel_hi:[0,1,1] neg_lo:[0,0,0] neg_hi:[1,0,0]
    v_pk_fma_f32 v[10:11], v[14:15], v[52:53], v[10:11] op_sel:[1,1,0] op_sel_hi:[0,1,1] neg_lo:[0,0,0] neg_hi:[1,0,0]
    v_pk_fma_f32 v[8:9], v[46:47], v[54:55], v[8:9] op_sel:[1,1,0] op_sel_hi:[0,1,1] neg_lo:[0,0,0] neg_hi:[1,0,0]
    v_pk_fma_f32 v[26:27], v[20:21], v[56:57], v[26:27] op_sel:[1,1,0] op_sel_hi:[0,1,1] neg_lo:[0,0,0] neg_hi:[1,0,0]
    v_pk_fma_f32 v[22:23], v[30:31], v[58:59], v[22:23] op_sel:[1,1,0] op_sel_hi:[0,1,1] neg_lo:[0,0,0] neg_hi:[1,0,0]
    v_pk_fma_f32 v[36:37], v[42:43], v[60:61], v[36:37] op_sel:[1,1,0] op_sel_hi:[0,1,1] neg_lo:[0,0,0] neg_hi:[1,0,0]
    v_pk_add_f32 v[12:13], v[38:39], v[8:9]
    v_pk_add_f32 v[24:25], v[38:39], v[8:9] neg_lo:[0,1] neg_hi:[0,1]
    v_pk_add_f32 v[32:33], v[28:29], v[26:27]
    v_pk_add_f32 v[18:19], v[28:29], v[26:27] neg_lo:[0,1] neg_hi:[0,1]
    v_pk_add_f32 v[44:45], v[34:35], v[22:23]
    v_pk_add_f32 v[16:17], v[34:35], v[22:23] neg_lo:[0,1] neg_hi:[0,1]
    v_pk_add_f32 v[40:41], v[10:11], v[36:37]
    v_pk_add_f32 v[14:15], v[10:11], v[36:37] neg_lo:[0,1] neg_hi:[0,1]
    v_pk_add_f32 v[46:47], v[12:13], v[44:45]
    v_pk_add_f32 v[20:21], v[12:13], v[44:45] neg_lo:[0,1] neg_hi:[0,1]
    v_pk_add_f32 v[30:31], v[32:33], v[40:41]
    v_pk_add_f32 v[42:43], v[32:33], v[40:41] neg_lo:[0,1] neg_hi:[0,1]
    v_pk_add_f32 v[38:39], v[46:47], v[30:31]
    v_pk_add_f32 v[8:9], v[46:47], v[30:31] neg_lo:[0,1] neg_hi:[0,1]
    v_pk_add_f32 v[28:29], v[20:21], v[42:43] op_sel:[0,1] op_sel_hi:[1,0] neg_lo:[0,1] neg_hi:[0,0]
    v_pk_add_f32 v[26:27], v[20:21], v[42:43] op_sel:[0,1] op_sel_hi:[1,0] neg_lo:[0,0] neg_hi:[0,1]
    v_pk_add_f32 v[34:35], v[18:19], v[18:19] op_sel:[0,1] op_sel_hi:[1,0] neg_lo:[0,1] neg_hi:[0,0]
    v_pk_add_f32 v[22:23], v[14:15], v[14:15] op_sel:[0,1] op_sel_hi:[1,0] neg_lo:[1,1] neg_hi:[1,0]
    v_pk_add_f32 v[10:11], v[24:25], v[16:17] op_sel:[0,1] op_sel_hi:[1,0] neg_lo:[0,1] neg_hi:[0,0]
    v_pk_add_f32 v[36:37], v[24:25], v[16:17] op_sel:[0,1] op_sel_hi:[1,0] neg_lo:[0,0] neg_hi:[0,1]
    v_pk_add_f32 v[12:13], v[34:35], v[22:23]
    v_pk_add_f32 v[32:33], v[34:35], v[22:23] neg_lo:[0,1] neg_hi:[0,1]
    v_pk_fma_f32 v[44:45], v[12:13], s[26:27], v[10:11] neg_lo:[0,0,0] neg_hi:[0,0,0]
    v_pk_fma_f32 v[40:41], v[12:13], s[26:27], v[10:11] neg_lo:[1,0,0] neg_hi:[1,0,0]
    v_pk_fma_f32 v[46:47], v[32:33], s[26:27], v[36:37] op_sel:[1,0,0] op_sel_hi:[0,1,1] neg_lo:[1,0,0] neg_hi:[0,0,0]
    v_pk_fma_f32 v[20:21], v[32:33], s[26:27], v[36:37] op_sel:[1,0,0] op_sel_hi:[0,1,1] neg_lo:[0,0,0] neg_hi:[1,0,0]
    s_waitcnt lgkmcnt(6)
    v_pk_mul_f32 v[132:133], v[120:121], v[48:49] op_sel:[0,0] op_sel_hi:[1,0]
    s_waitcnt lgkmcnt(5)
    v_pk_mul_f32 v[138:139], v[144:145], v[50:51] op_sel:[0,0] op_sel_hi:[1,0]
    s_waitcnt lgkmcnt(4)
    v_pk_mul_f32 v[114:115], v[118:119], v[52:53] op_sel:[0,0] op_sel_hi:[1,0]
    s_waitcnt lgkmcnt(3)
    v_pk_mul_f32 v[112:113], v[150:151], v[54:55] op_sel:[0,0] op_sel_hi:[1,0]
    s_waitcnt lgkmcnt(2)
    v_pk_mul_f32 v[130:131], v[124:125], v[56:57] op_sel:[0,0] op_sel_hi:[1,0]
    s_waitcnt lgkmcnt(1)
    v_pk_mul_f32 v[126:127], v[134:135], v[58:59] op_sel:[0,0] op_sel_hi:[1,0]
    s_waitcnt lgkmcnt(0)
    v_pk_mul_f32 v[140:141], v[146:147], v[60:61] op_sel:[0,0] op_sel_hi:[1,0]
    v_pk_fma_f32 v[132:133], v[120:121], v[48:49], v[132:133] op_sel:[1,1,0] op_sel_hi:[0,1,1] neg_lo:[0,0,0] neg_hi:[1,0,0]
    v_pk_fma_f32 v[138:139], v[144:145], v[50:51], v[138:139] op_sel:[1,1,0] op_sel_hi:[0,1,1] neg_lo:[0,0,0] neg_hi:[1,0,0]
    v_pk_fma_f32 v[114:115], v[118:119], v[52:53], v[114:115] op_sel:[1,1,0] op_sel_hi:[0,1,1] neg_lo:[0,0,0] neg_hi:[1,0,0]
    v_pk_fma_f32 v[112:113], v[150:151], v[54:55], v[112:113] op_sel:[1,1,0] op_sel_hi:[0,1,1] neg_lo:[0,0,0] neg_hi:[1,0,0]
    v_pk_fma_f32 v[130:131], v[124:125], v[56:57], v[130:131] op_sel:[1,1,0] op_sel_hi:[0,1,1] neg_lo:[0,0,0] neg_hi:[1,0,0]
    v_pk_fma_f32 v[126:127], v[134:135], v[58:59], v[126:127] op_sel:[1,1,0] op_sel_hi:[0,1,1] neg_lo:[0,0,0] neg_hi:[1,0,0]
    v_pk_fma_f32 v[140:141], v[146:147], v[60:61], v[140:141] op_sel:[1,1,0] op_sel_hi:[0,1,1] neg_lo:[0,0,0] neg_hi:[1,0,0]
    v_pk_add_f32 v[116:117], v[142:143], v[112:113]
    v_pk_add_f32 v[128:129], v[142:143], v[112:113] neg_lo:[0,1] neg_hi:[0,1]
    v_pk_add_f32 v[136:137], v[132:133], v[130:131]
    v_pk_add_f32 v[122:123], v[132:133], v[130:131] neg_lo:[0,1] neg_hi:[0,1]
    v_pk_add_f32 v[148:149], v[138:139], v[126:127]
    v_pk_add_f32 v[120:121], v[138:139], v[126:127] neg_lo:[0,1] neg_hi:[0,1]
    v_pk_add_f32 v[144:145], v[114:115], v[140:141]
    v_pk_add_f32 v[118:119], v[114:115], v[140:141] neg_lo:[0,1] neg_hi:[0,1]
    v_pk_add_f32 v[150:151], v[116:117], v[148:149]
    v_pk_add_f32 v[124:125], v[116:117], v[148:149] neg_lo:[0,1] neg_hi:[0,1]
    v_pk_add_f32 v[134:135], v[136:137], v[144:145]
    v_pk_add_f32 v[146:147], v[136:137], v[144:145] neg_lo:[0,1] neg_hi:[0,1]
    v_pk_add_f32 v[142:143], v[150:151], v[134:135]
    v_pk_add_f32 v[112:113], v[150:151], v[134:135] neg_lo:[0,1] neg_hi:[0,1]
    v_pk_add_f32 v[132:133], v[124:125], v[146:147] op_sel:[0,1] op_sel_hi:[1,0] neg_lo:[0,1] neg_hi:[0,0]
    v_pk_add_f32 v[130:131], v[124:125], v[146:147] op_sel:[0,1] op_sel_hi:[1,0] neg_lo:[0,0] neg_hi:[0,1]
    v_pk_add_f32 v[138:139], v[122:123], v[122:123] op_sel:[0,1] op_sel_hi:[1,0] neg_lo:[0,1] neg_hi:[0,0]
    v_pk_add_f32 v[126:127], v[118:119], v[118:119] op_sel:[0,1] op_sel_hi:[1,0] neg_lo:[1,1] neg_hi:[1,0]
    v_pk_add_f32 v[114:115], v[128:129], v[120:121] op_sel:[0,1] op_sel_hi:[1,0] neg_lo:[0,1] neg_hi:[0,0]
    v_pk_add_f32 v[140:141], v[128:129], v[120:121] op_sel:[0,1] op_sel_hi:[1,0] neg_lo:[0,0] neg_hi:[0,1]
    v_pk_add_f32 v[116:117], v[138:139], v[126:127]
    v_pk_add_f32 v[136:137], v[138:139], v[126:127] neg_lo:[0,1] neg_hi:[0,1]
    v_pk_fma_f32 v[148:149], v[116:117], s[26:27], v[114:115] neg_lo:[0,0,0] neg_hi:[0,0,0]
    v_pk_fma_f32 v[144:145], v[116:117], s[26:27], v[114:115] neg_lo:[1,0,0] neg_hi:[1,0,0]
    v_pk_fma_f32 v[150:151], v[136:137], s[26:27], v[140:141] op_sel:[1,0,0] op_sel_hi:[0,1,1] neg_lo:[1,0,0] neg_hi:[0,0,0]
    v_pk_fma_f32 v[124:125], v[136:137], s[26:27], v[140:141] op_sel:[1,0,0] op_sel_hi:[0,1,1] neg_lo:[0,0,0] neg_hi:[1,0,0]
    s_lshr_b32 s21, s2, 3
    s_lshl_b32 s21, s21, 10
    s_bfe_u32 s22, s2, 0x20001
    s_lshl_b32 s22, s22, 8
    s_add_u32 s21, s21, s22
    s_and_b32 s22, s2, 1
    s_lshl_b32 s22, s22, 3
    s_add_u32 s21, s21, s22
    s_mul_i32 s22, s101, 3145728
    s_add_u32 s22, s22, 157286400
    s_add_u32 s21, s21, s22
    v_cvt_pk_bf16_f32 v38, v38, v39
    v_cvt_pk_bf16_f32 v39, v142, v143
    v_cvt_pk_bf16_f32 v44, v44, v45
    v_cvt_pk_bf16_f32 v45, v148, v149
    v_cvt_pk_bf16_f32 v28, v28, v29
    v_cvt_pk_bf16_f32 v29, v132, v133
    v_cvt_pk_bf16_f32 v46, v46, v47
    v_cvt_pk_bf16_f32 v47, v150, v151
    v_cvt_pk_bf16_f32 v8, v8, v9
    v_cvt_pk_bf16_f32 v9, v112, v113
    v_cvt_pk_bf16_f32 v40, v40, v41
    v_cvt_pk_bf16_f32 v41, v144, v145
    v_cvt_pk_bf16_f32 v26, v26, v27
    v_cvt_pk_bf16_f32 v27, v130, v131
    v_cvt_pk_bf16_f32 v20, v20, v21
    v_cvt_pk_bf16_f32 v21, v124, v125
    s_cmp_eq_u32 s2, 0
    s_cbranch_scc1 M_fft_c0
    s_cmp_eq_u32 s2, 160
    s_cbranch_scc1 M_fft_c320
    buffer_store_dwordx2 v[38:39], v101, s[8:11], s21 offen sc1
    s_add_u32 s21, s21, 327680
    buffer_store_dwordx2 v[44:45], v101, s[8:11], s21 offen sc1
    s_add_u32 s21, s21, 327680
    buffer_store_dwordx2 v[28:29], v101, s[8:11], s21 offen sc1
    s_add_u32 s21, s21, 327680
    buffer_store_dwordx2 v[46:47], v101, s[8:11], s21 offen sc1
    s_add_u32 s21, s21, 327680
    buffer_store_dwordx2 v[8:9], v101, s[8:11], s21 offen sc1
    s_add_u32 s21, s21, 327680
    buffer_store_dwordx2 v[40:41], v101, s[8:11], s21 offen sc1
    s_add_u32 s21, s21, 327680
    buffer_store_dwordx2 v[26:27], v101, s[8:11], s21 offen sc1
    s_add_u32 s21, s21, 327680
    buffer_store_dwordx2 v[20:21], v101, s[8:11], s21 offen sc1
    s_add_u32 s21, s21, 327680
    s_branch M_fft_end
M_fft_c0:
    buffer_store_short v38, v101, s[8:11], s21 offen sc1
    buffer_store_dword v39, v101, s[8:11], s21 offen offset:4 sc1
    s_add_u32 s21, s21, 327680
    buffer_store_short v44, v101, s[8:11], s21 offen sc1
    buffer_store_dword v45, v101, s[8:11], s21 offen offset:4 sc1
    s_add_u32 s21, s21, 327680
    buffer_store_short v28, v101, s[8:11], s21 offen sc1
    buffer_store_dword v29, v101, s[8:11], s21 offen offset:4 sc1
    s_add_u32 s21, s21, 327680
    buffer_store_short v46, v101, s[8:11], s21 offen sc1
    buffer_store_dword v47, v101, s[8:11], s21 offen offset:4 sc1
    s_add_u32 s21, s21, 327680
    buffer_store_short v8, v101, s[8:11], s21 offen sc1
    buffer_store_dword v9, v101, s[8:11], s21 offen offset:4 sc1
    s_add_u32 s21, s21, 327680
    buffer_store_short v40, v101, s[8:11], s21 offen sc1
    buffer_store_dword v41, v101, s[8:11], s21 offen offset:4 sc1
    s_add_u32 s21, s21, 327680
    buffer_store_short v26, v101, s[8:11], s21 offen sc1
    buffer_store_dword v27, v101, s[8:11], s21 offen offset:4 sc1
    s_add_u32 s21, s21, 327680
    buffer_store_short v20, v101, s[8:11], s21 offen sc1
    buffer_store_dword v21, v101, s[8:11], s21 offen offset:4 sc1
    s_add_u32 s21, s21, 327680
    s_branch M_fft_end
M_fft_c320:
    s_add_u32 s21, s22, 2
    buffer_store_short v38, v101, s[8:11], s21 offen sc1
    s_add_u32 s21, s21, 327680
    buffer_store_short v44, v101, s[8:11], s21 offen sc1
    s_add_u32 s21, s21, 327680
    buffer_store_short v28, v101, s[8:11], s21 offen sc1
    s_add_u32 s21, s21, 327680
    buffer_store_short v46, v101, s[8:11], s21 offen sc1
    s_add_u32 s21, s21, 327680
    buffer_store_short v8, v101, s[8:11], s21 offen sc1
    s_add_u32 s21, s21, 327680
    buffer_store_short v40, v101, s[8:11], s21 offen sc1
    s_add_u32 s21, s21, 327680
    buffer_store_short v26, v101, s[8:11], s21 offen sc1
    s_add_u32 s21, s21, 327680
    buffer_store_short v20, v101, s[8:11], s21 offen sc1
    s_add_u32 s21, s21, 327680
M_fft_end:
    s_waitcnt vmcnt(0) lgkmcnt(0)
    s_barrier
    s_cmp_lg_u32 s83, 0
    s_cbranch_scc1 M_gb_37
    s_mov_b32 s23, s85
    s_add_u32 s28, s86, 167841792
    s_lshl_b32 s27, s82, 7
    s_mov_b64 exec, 1
    s_add_u32 s31, s27, s84
    v_mov_b32 v190, s31
    v_mov_b32 v191, 1
    s_cmp_lg_u32 s23, 0
    s_cbranch_scc1 M_ls_38
    buffer_store_byte v191, v190, s[8:11], s28 offen
M_ls_38_r:
    s_cmp_lg_u32 s84, 31
    s_cbranch_scc1 M_gb_35
    s_mov_b64 exec, -1
    v_mbcnt_lo_u32_b32 v189, -1, 0
    s_mov_b64 exec, 0xff
    v_lshl_add_u32 v190, v189, 2, s27
    s_mov_b32 s30, 0
M_gs_39:
    buffer_load_dword v191, v190, s[8:11], s28 offen sc1
    s_add_u32 s30, s30, 1
    s_cmp_ge_u32 s30, 240000
    s_cbranch_scc1 M_fail
    s_waitcnt vmcnt(0)
    v_cmp_ne_u32 vcc, 0x1010101, v191
    s_cbranch_vccnz M_gs_39
    s_mov_b64 exec, 1
    v_mov_b32 v190, s27
    v_mov_b32 v191, 1
    buffer_store_dword v191, v190, s[8:11], s28 offen offset:1024 sc1
M_gb_35:
    s_mov_b64 exec, -1
M_gb_37:
    s_cmp_lg_u32 s83, 0
    s_cbranch_scc1 M_gb_36
    s_add_u32 s28, s86, 167841792
    v_mbcnt_lo_u32_b32 v189, -1, 0
    s_mov_b64 exec, 0x3f
    v_lshlrev_b32 v190, 7, v189
    v_add_u32 v190, 1024, v190
    s_mov_b32 s30, 0
M_gs_40:
    buffer_load_dword v191, v190, s[8:11], s28 offen sc1
    s_add_u32 s30, s30, 1
    s_cmp_ge_u32 s30, 240000
    s_cbranch_scc1 M_fail
    s_waitcnt vmcnt(0)
    v_cmp_ne_u32 vcc, 0x1, v191
    s_cbranch_vccnz M_gs_40
    s_mov_b64 exec, -1
M_gb_36:
    s_barrier
    s_cmp_ge_u32 s89, 64
    s_cbranch_scc1 M_noid
    v_mbcnt_lo_u32_b32 v0, -1, 0
    v_mbcnt_hi_u32_b32 v0, -1, v0
    s_mov_b32 s23, s85
    v_lshlrev_b32 v1, 4, v0
    v_lshrrev_b32 v3, 4, v0
    v_and_b32 v4, 15, v0
    s_mul_i32 s29, s89, 40960
    s_mul_i32 s24, s101, 3145728
    s_add_u32 s24, s24, s29
    s_add_u32 s24, s24, 157286400
    s_add_u32 s25, s24, 0
    buffer_load_dwordx4 v[44:47], v1, s[8:11], s25 offen offset:0 sc1
    buffer_load_dwordx4 v[48:51], v1, s[8:11], s25 offen offset:1024 sc1
    buffer_load_dwordx4 v[52:55], v1, s[8:11], s25 offen offset:2048 sc1
    buffer_load_dwordx4 v[56:59], v1, s[8:11], s25 offen offset:3072 sc1
    s_add_u32 s25, s24, 4096
    buffer_load_dwordx4 v[60:63], v1, s[8:11], s25 offen offset:0 sc1
    buffer_load_dwordx4 v[64:67], v1, s[8:11], s25 offen offset:1024 sc1
    buffer_load_dwordx4 v[68:71], v1, s[8:11], s25 offen offset:2048 sc1
    buffer_load_dwordx4 v[72:75], v1, s[8:11], s25 offen offset:3072 sc1
    s_add_u32 s25, s24, 8192
    buffer_load_dwordx4 v[76:79], v1, s[8:11], s25 offen offset:0 sc1
    buffer_load_dwordx4 v[80:83], v1, s[8:11], s25 offen offset:1024 sc1
    buffer_load_dwordx4 v[84:87], v1, s[8:11], s25 offen offset:2048 sc1
    buffer_load_dwordx4 v[88:91], v1, s[8:11], s25 offen offset:3072 sc1
    s_add_u32 s25, s24, 12288
    buffer_load_dwordx4 v[92:95], v1, s[8:11], s25 offen offset:0 sc1
    buffer_load_dwordx4 v[96:99], v1, s[8:11], s25 offen offset:1024 sc1
    buffer_load_dwordx4 v[100:103], v1, s[8:11], s25 offen offset:2048 sc1
    buffer_load_dwordx4 v[104:107], v1, s[8:11], s25 offen offset:3072 sc1
    s_add_u32 s25, s24, 16384
    buffer_load_dwordx4 v[108:111], v1, s[8:11], s25 offen offset:0 sc1
    buffer_load_dwordx4 v[112:115], v1, s[8:11], s25 offen offset:1024 sc1
    buffer_load_dwordx4 v[116:119], v1, s[8:11], s25 offen offset:2048 sc1
    buffer_load_dwordx4 v[120:123], v1, s[8:11], s25 offen offset:3072 sc1
    s_add_u32 s25, s24, 20480
    buffer_load_dwordx4 v[124:127], v1, s[8:11], s25 offen offset:0 sc1
    buffer_load_dwordx4 v[128:131], v1, s[8:11], s25 offen offset:1024 sc1
    buffer_load_dwordx4 v[132:135], v1, s[8:11], s25 offen offset:2048 sc1
    buffer_load_dwordx4 v[136:139], v1, s[8:11], s25 offen offset:3072 sc1
    s_add_u32 s25, s24, 24576
    buffer_load_dwordx4 v[140:143], v1, s[8:11], s25 offen offset:0 sc1
    buffer_load_dwordx4 v[144:147], v1, s[8:11], s25 offen offset:1024 sc1
    buffer_load_dwordx4 v[148:151], v1, s[8:11], s25 offen offset:2048 sc1
    buffer_load_dwordx4 v[152:155], v1, s[8:11], s25 offen offset:3072 sc1
    s_add_u32 s25, s24, 28672
    buffer_load_dwordx4 v[156:159], v1, s[8:11], s25 offen offset:0 sc1
    buffer_load_dwordx4 v[160:163], v1, s[8:11], s25 offen offset:1024 sc1
    buffer_load_dwordx4 v[164:167], v1, s[8:11], s25 offen offset:2048 sc1
    buffer_load_dwordx4 v[168:171], v1, s[8:11], s25 offen offset:3072 sc1
    s_add_u32 s25, s24, 32768
    buffer_load_dwordx4 v[172:175], v1, s[8:11], s25 offen offset:0 sc1
    buffer_load_dwordx4 v[176:179], v1, s[8:11], s25 offen offset:1024 sc1
    buffer_load_dwordx4 v[180:183], v1, s[8:11], s25 offen offset:2048 sc1
    buffer_load_dwordx4 v[184:187], v1, s[8:11], s25 offen offset:3072 sc1
    v_mul_u32_u24 v5, 1280, v4
    v_lshl_add_u32 v5, v3, 4, v5
    v_add_u32 v6, 40960, v1
    s_lshl_b32 s31, s88, 7
    s_add_u32 s30, s29, s31
    s_add_u32 s31, s30, s80
    s_add_u32 s32, s31, 20480
    s_add_u32 s33, s30, 20480
    ds_read_b128 v[28:31], v1 offset:0
    ds_read_b128 v[32:35], v1 offset:20480
    ds_read_b128 v[36:39], v6 offset:0
    s_waitcnt vmcnt(35) lgkmcnt(2)
    v_mfma_f32_16x16x32_bf16 v[12:15], v[28:31], v[44:47], 0
    ds_read_b128 v[40:43], v6 offset:20480
    s_waitcnt lgkmcnt(2)
    v_mfma_f32_16x16x32_bf16 v[16:19], v[32:35], v[44:47], 0
    ds_read_b128 v[28:31], v1 offset:1024
    s_waitcnt lgkmcnt(2)
    v_mfma_f32_16x16x32_bf16 v[20:23], v[36:39], v[44:47], 0
    ds_read_b128 v[32:35], v1 offset:21504
    s_waitcnt lgkmcnt(2)
    v_mfma_f32_16x16x32_bf16 v[24:27], v[40:43], v[44:47], 0
    ds_read_b128 v[36:39], v6 offset:1024
    s_waitcnt vmcnt(34) lgkmcnt(2)
    v_mfma_f32_16x16x32_bf16 v[12:15], v[28:31], v[48:51], v[12:15]
    ds_read_b128 v[40:43], v6 offset:21504
    s_waitcnt lgkmcnt(2)
    v_mfma_f32_16x16x32_bf16 v[16:19], v[32:35], v[48:51], v[16:19]
    ds_read_b128 v[28:31], v1 offset:2048
    s_waitcnt lgkmcnt(2)
    v_mfma_f32_16x16x32_bf16 v[20:23], v[36:39], v[48:51], v[20:23]
    ds_read_b128 v[32:35], v1 offset:22528
    s_waitcnt lgkmcnt(2)
    v_mfma_f32_16x16x32_bf16 v[24:27], v[40:43], v[48:51], v[24:27]
    ds_read_b128 v[36:39], v6 offset:2048
    s_waitcnt vmcnt(33) lgkmcnt(2)
    v_mfma_f32_16x16x32_bf16 v[12:15], v[28:31], v[52:55], v[12:15]
    ds_read_b128 v[40:43], v6 offset:22528
    s_waitcnt lgkmcnt(2)
    v_mfma_f32_16x16x32_bf16 v[16:19], v[32:35], v[52:55], v[16:19]
    ds_read_b128 v[28:31], v1 offset:3072
    s_waitcnt lgkmcnt(2)
    v_mfma_f32_16x16x32_bf16 v[20:23], v[36:39], v[52:55], v[20:23]
    ds_read_b128 v[32:35], v1 offset:23552
    s_waitcnt lgkmcnt(2)
    v_mfma_f32_16x16x32_bf16 v[24:27], v[40:43], v[52:55], v[24:27]
    ds_read_b128 v[36:39], v6 offset:3072
    s_waitcnt vmcnt(32) lgkmcnt(2)
    v_mfma_f32_16x16x32_bf16 v[12:15], v[28:31], v[56:59], v[12:15]
    ds_read_b128 v[40:43], v6 offset:23552
    s_waitcnt lgkmcnt(2)
    v_mfma_f32_16x16x32_bf16 v[16:19], v[32:35], v[56:59], v[16:19]
    ds_read_b128 v[28:31], v1 offset:4096
    s_waitcnt lgkmcnt(2)
    v_mfma_f32_16x16x32_bf16 v[20:23], v[36:39], v[56:59], v[20:23]
    ds_read_b128 v[32:35], v1 offset:24576
    s_waitcnt lgkmcnt(2)
    v_mfma_f32_16x16x32_bf16 v[24:27], v[40:43], v[56:59], v[24:27]
    ds_read_b128 v[36:39], v6 offset:4096
    s_add_u32 s25, s24, 36864
    buffer_load_dwordx4 v[44:47], v1, s[8:11], s25 offen offset:0 sc1
    buffer_load_dwordx4 v[48:51], v1, s[8:11], s25 offen offset:1024 sc1
    buffer_load_dwordx4 v[52:55], v1, s[8:11], s25 offen offset:2048 sc1
    buffer_load_dwordx4 v[56:59], v1, s[8:11], s25 offen offset:3072 sc1
    s_waitcnt vmcnt(35) lgkmcnt(2)
    v_mfma_f32_16x16x32_bf16 v[12:15], v[28:31], v[60:63], v[12:15]
    ds_read_b128 v[40:43], v6 offset:24576
    s_waitcnt lgkmcnt(2)
    v_mfma_f32_16x16x32_bf16 v[16:19], v[32:35], v[60:63], v[16:19]
    ds_read_b128 v[28:31], v1 offset:5120
    s_waitcnt lgkmcnt(2)
    v_mfma_f32_16x16x32_bf16 v[20:23], v[36:39], v[60:63], v[20:23]
    ds_read_b128 v[32:35], v1 offset:25600
    s_waitcnt lgkmcnt(2)
    v_mfma_f32_16x16x32_bf16 v[24:27], v[40:43], v[60:63], v[24:27]
    ds_read_b128 v[36:39], v6 offset:5120
    s_waitcnt vmcnt(34) lgkmcnt(2)
    v_mfma_f32_16x16x32_bf16 v[12:15], v[28:31], v[64:67], v[12:15]
    ds_read_b128 v[40:43], v6 offset:25600
    s_waitcnt lgkmcnt(2)
    v_mfma_f32_16x16x32_bf16 v[16:19], v[32:35], v[64:67], v[16:19]
    ds_read_b128 v[28:31], v1 offset:6144
    s_waitcnt lgkmcnt(2)
    v_mfma_f32_16x16x32_bf16 v[20:23], v[36:39], v[64:67], v[20:23]
    ds_read_b128 v[32:35], v1 offset:26624
    s_waitcnt lgkmcnt(2)
    v_mfma_f32_16x16x32_bf16 v[24:27], v[40:43], v[64:67], v[24:27]
    ds_read_b128 v[36:39], v6 offset:6144
    s_waitcnt vmcnt(33) lgkmcnt(2)
    v_mfma_f32_16x16x32_bf16 v[12:15], v[28:31], v[68:71], v[12:15]
    ds_read_b128 v[40:43], v6 offset:26624
    s_waitcnt lgkmcnt(2)
    v_mfma_f32_16x16x32_bf16 v[16:19], v[32:35], v[68:71], v[16:19]
    ds_read_b128 v[28:31], v1 offset:7168
    s_waitcnt lgkmcnt(2)
    v_mfma_f32_16x16x32_bf16 v[20:23], v[36:39], v[68:71], v[20:23]
    ds_read_b128 v[32:35], v1 offset:27648
    s_waitcnt lgkmcnt(2)
    v_mfma_f32_16x16x32_bf16 v[24:27], v[40:43], v[68:71], v[24:27]
    ds_read_b128 v[36:39], v6 offset:7168
    s_waitcnt vmcnt(32) lgkmcnt(2)
    v_mfma_f32_16x16x32_bf16 v[12:15], v[28:31], v[72:75], v[12:15]
    ds_read_b128 v[40:43], v6 offset:27648
    s_waitcnt lgkmcnt(2)
    v_mfma_f32_16x16x32_bf16 v[16:19], v[32:35], v[72:75], v[16:19]
    ds_read_b128 v[28:31], v1 offset:8192
    s_waitcnt lgkmcnt(2)
    v_mfma_f32_16x16x32_bf16 v[20:23], v[36:39], v[72:75], v[20:23]
    ds_read_b128 v[32:35], v1 offset:28672
    s_waitcnt lgkmcnt(2)
    v_mfma_f32_16x16x32_bf16 v[24:27], v[40:43], v[72:75], v[24:27]
    ds_read_b128 v[36:39], v6 offset:8192
    s_waitcnt vmcnt(31) lgkmcnt(2)
    v_mfma_f32_16x16x32_bf16 v[12:15], v[28:31], v[76:79], v[12:15]
    ds_read_b128 v[40:43], v6 offset:28672
    s_waitcnt lgkmcnt(2)
    v_mfma_f32_16x16x32_bf16 v[16:19], v[32:35], v[76:79], v[16:19]
    ds_read_b128 v[28:31], v1 offset:9216
    s_waitcnt lgkmcnt(2)
    v_mfma_f32_16x16x32_bf16 v[20:23], v[36:39], v[76:79], v[20:23]
    ds_read_b128 v[32:35], v1 offset:29696
    s_waitcnt lgkmcnt(2)
    v_mfma_f32_16x16x32_bf16 v[24:27], v[40:43], v[76:79], v[24:27]
    ds_read_b128 v[36:39], v6 offset:9216
    s_waitcnt vmcnt(30) lgkmcnt(2)
    v_mfma_f32_16x16x32_bf16 v[12:15], v[28:31], v[80:83], v[12:15]
    ds_read_b128 v[40:43], v6 offset:29696
    s_waitcnt lgkmcnt(2)
    v_mfma_f32_16x16x32_bf16 v[16:19], v[32:35], v[80:83], v[16:19]
    ds_read_b128 v[28:31], v1 offset:10240
    s_waitcnt lgkmcnt(2)
    v_mfma_f32_16x16x32_bf16 v[20:23], v[36:39], v[80:83], v[20:23]
    ds_read_b128 v[32:35], v1 offset:30720
    s_waitcnt lgkmcnt(2)
    v_mfma_f32_16x16x32_bf16 v[24:27], v[40:43], v[80:83], v[24:27]
    ds_read_b128 v[36:39], v6 offset:10240
    s_waitcnt vmcnt(29) lgkmcnt(2)
    v_mfma_f32_16x16x32_bf16 v[12:15], v[28:31], v[84:87], v[12:15]
    ds_read_b128 v[40:43], v6 offset:30720
    s_waitcnt lgkmcnt(2)
    v_mfma_f32_16x16x32_bf16 v[16:19], v[32:35], v[84:87], v[16:19]
    ds_read_b128 v[28:31], v1 offset:11264
    s_waitcnt lgkmcnt(2)
    v_mfma_f32_16x16x32_bf16 v[20:23], v[36:39], v[84:87], v[20:23]
    ds_read_b128 v[32:35], v1 offset:31744
    s_waitcnt lgkmcnt(2)
    v_mfma_f32_16x16x32_bf16 v[24:27], v[40:43], v[84:87], v[24:27]
    ds_read_b128 v[36:39], v6 offset:11264
    s_waitcnt vmcnt(28) lgkmcnt(2)
    v_mfma_f32_16x16x32_bf16 v[12:15], v[28:31], v[88:91], v[12:15]
    ds_read_b128 v[40:43], v6 offset:31744
    s_waitcnt lgkmcnt(2)
    v_mfma_f32_16x16x32_bf16 v[16:19], v[32:35], v[88:91], v[16:19]
    ds_read_b128 v[28:31], v1 offset:12288
    s_waitcnt lgkmcnt(2)
    v_mfma_f32_16x16x32_bf16 v[20:23], v[36:39], v[88:91], v[20:23]
    ds_read_b128 v[32:35], v1 offset:32768
    s_waitcnt lgkmcnt(2)
    v_mfma_f32_16x16x32_bf16 v[24:27], v[40:43], v[88:91], v[24:27]
    ds_read_b128 v[36:39], v6 offset:12288
    s_waitcnt vmcnt(27) lgkmcnt(2)
    v_mfma_f32_16x16x32_bf16 v[12:15], v[28:31], v[92:95], v[12:15]
    ds_read_b128 v[40:43], v6 offset:32768
    s_waitcnt lgkmcnt(2)
    v_mfma_f32_16x16x32_bf16 v[16:19], v[32:35], v[92:95], v[16:19]
    ds_read_b128 v[28:31], v1 offset:13312
    s_waitcnt lgkmcnt(2)
    v_mfma_f32_16x16x32_bf16 v[20:23], v[36:39], v[92:95], v[20:23]
    ds_read_b128 v[32:35], v1 offset:33792
    s_waitcnt lgkmcnt(2)
    v_mfma_f32_16x16x32_bf16 v[24:27], v[40:43], v[92:95], v[24:27]
    ds_read_b128 v[36:39], v6 offset:13312
    s_waitcnt vmcnt(26) lgkmcnt(2)
    v_mfma_f32_16x16x32_bf16 v[12:15], v[28:31], v[96:99], v[12:15]
    ds_read_b128 v[40:43], v6 offset:33792
    s_waitcnt lgkmcnt(2)
    v_mfma_f32_16x16x32_bf16 v[16:19], v[32:35], v[96:99], v[16:19]
    ds_read_b128 v[28:31], v1 offset:14336
    s_waitcnt lgkmcnt(2)
    v_mfma_f32_16x16x32_bf16 v[20:23], v[36:39], v[96:99], v[20:23]
    ds_read_b128 v[32:35], v1 offset:34816
    s_waitcnt lgkmcnt(2)
    v_mfma_f32_16x16x32_bf16 v[24:27], v[40:43], v[96:99], v[24:27]
    ds_read_b128 v[36:39], v6 offset:14336
    s_waitcnt vmcnt(25) lgkmcnt(2)
    v_mfma_f32_16x16x32_bf16 v[12:15], v[28:31], v[100:103], v[12:15]
    ds_read_b128 v[40:43], v6 offset:34816
    s_waitcnt lgkmcnt(2)
    v_mfma_f32_16x16x32_bf16 v[16:19], v[32:35], v[100:103], v[16:19]
    ds_read_b128 v[28:31], v1 offset:15360
    s_waitcnt lgkmcnt(2)
    v_mfma_f32_16x16x32_bf16 v[20:23], v[36:39], v[100:103], v[20:23]
    ds_read_b128 v[32:35], v1 offset:35840
    s_waitcnt lgkmcnt(2)
    v_mfma_f32_16x16x32_bf16 v[24:27], v[40:43], v[100:103], v[24:27]
    ds_read_b128 v[36:39], v6 offset:15360
    s_waitcnt vmcnt(24) lgkmcnt(2)
    v_mfma_f32_16x16x32_bf16 v[12:15], v[28:31], v[104:107], v[12:15]
    ds_read_b128 v[40:43], v6 offset:35840
    s_waitcnt lgkmcnt(2)
    v_mfma_f32_16x16x32_bf16 v[16:19], v[32:35], v[104:107], v[16:19]
    ds_read_b128 v[28:31], v1 offset:16384
    s_waitcnt lgkmcnt(2)
    v_mfma_f32_16x16x32_bf16 v[20:23], v[36:39], v[104:107], v[20:23]
    ds_read_b128 v[32:35], v1 offset:36864
    s_waitcnt lgkmcnt(2)
    v_mfma_f32_16x16x32_bf16 v[24:27], v[40:43], v[104:107], v[24:27]
    ds_read_b128 v[36:39], v6 offset:16384
    s_waitcnt vmcnt(23) lgkmcnt(2)
    v_mfma_f32_16x16x32_bf16 v[12:15], v[28:31], v[108:111], v[12:15]
    ds_read_b128 v[40:43], v6 offset:36864
    s_waitcnt lgkmcnt(2)
    v_mfma_f32_16x16x32_bf16 v[16:19], v[32:35], v[108:111], v[16:19]
    ds_read_b128 v[28:31], v1 offset:17408
    s_waitcnt lgkmcnt(2)
    v_mfma_f32_16x16x32_bf16 v[20:23], v[36:39], v[108:111], v[20:23]
    ds_read_b128 v[32:35], v1 offset:37888
    s_waitcnt lgkmcnt(2)
    v_mfma_f32_16x16x32_bf16 v[24:27], v[40:43], v[108:111], v[24:27]
    ds_read_b128 v[36:39], v6 offset:17408
    s_waitcnt vmcnt(22) lgkmcnt(2)
    v_mfma_f32_16x16x32_bf16 v[12:15], v[28:31], v[112:115], v[12:15]
    ds_read_b128 v[40:43], v6 offset:37888
    s_waitcnt lgkmcnt(2)
    v_mfma_f32_16x16x32_bf16 v[16:19], v[32:35], v[112:115], v[16:19]
    ds_read_b128 v[28:31], v1 offset:18432
    s_waitcnt lgkmcnt(2)
    v_mfma_f32_16x16x32_bf16 v[20:23], v[36:39], v[112:115], v[20:23]
    ds_read_b128 v[32:35], v1 offset:38912
    s_waitcnt lgkmcnt(2)
    v_mfma_f32_16x16x32_bf16 v[24:27], v[40:43], v[112:115], v[24:27]
    ds_read_b128 v[36:39], v6 offset:18432
    s_waitcnt vmcnt(21) lgkmcnt(2)
    v_mfma_f32_16x16x32_bf16 v[12:15], v[28:31], v[116:119], v[12:15]
    ds_read_b128 v[40:43], v6 offset:38912
    s_waitcnt lgkmcnt(2)
    v_mfma_f32_16x16x32_bf16 v[16:19], v[32:35], v[116:119], v[16:19]
    ds_read_b128 v[28:31], v1 offset:19456
    s_waitcnt lgkmcnt(2)
    v_mfma_f32_16x16x32_bf16 v[20:23], v[36:39], v[116:119], v[20:23]
    ds_read_b128 v[32:35], v1 offset:39936
    s_waitcnt lgkmcnt(2)
    v_mfma_f32_16x16x32_bf16 v[24:27], v[40:43], v[116:119], v[24:27]
    ds_read_b128 v[36:39], v6 offset:19456
    s_waitcnt vmcnt(20) lgkmcnt(2)
    v_mfma_f32_16x16x32_bf16 v[12:15], v[28:31], v[120:123], v[12:15]
    ds_read_b128 v[40:43], v6 offset:39936
    s_waitcnt lgkmcnt(2)
    v_mfma_f32_16x16x32_bf16 v[16:19], v[32:35], v[120:123], v[16:19]
    ds_read_b128 v[28:31], v1 offset:0
    s_waitcnt lgkmcnt(2)
    v_mfma_f32_16x16x32_bf16 v[20:23], v[36:39], v[120:123], v[20:23]
    ds_read_b128 v[32:35], v1 offset:20480
    s_waitcnt lgkmcnt(2)
    v_mfma_f32_16x16x32_bf16 v[24:27], v[40:43], v[120:123], v[24:27]
    ds_read_b128 v[36:39], v6 offset:0
    buffer_load_dwordx4 v[108:111], v5, s[8:11], s31 offen offset:0 sc1
    buffer_load_dwordx4 v[112:115], v5, s[8:11], s31 offen offset:64 sc1
    buffer_load_dwordx4 v[116:119], v5, s[8:11], s32 offen offset:0 sc1
    buffer_load_dwordx4 v[120:123], v5, s[8:11], s32 offen offset:64 sc1
    s_waitcnt vmcnt(23) lgkmcnt(2)
    v_mfma_f32_16x16x32_bf16 v[60:63], v[28:31], v[124:127], 0
    ds_read_b128 v[40:43], v6 offset:20480
    s_waitcnt lgkmcnt(2)
    v_mfma_f32_16x16x32_bf16 v[64:67], v[32:35], v[124:127], 0
    ds_read_b128 v[28:31], v1 offset:1024
    s_waitcnt lgkmcnt(2)
    v_mfma_f32_16x16x32_bf16 v[68:71], v[36:39], v[124:127], 0
    ds_read_b128 v[32:35], v1 offset:21504
    s_waitcnt lgkmcnt(2)
    v_mfma_f32_16x16x32_bf16 v[72:75], v[40:43], v[124:127], 0
    ds_read_b128 v[36:39], v6 offset:1024
    s_waitcnt vmcnt(22) lgkmcnt(2)
    v_mfma_f32_16x16x32_bf16 v[60:63], v[28:31], v[128:131], v[60:63]
    ds_read_b128 v[40:43], v6 offset:21504
    s_waitcnt lgkmcnt(2)
    v_mfma_f32_16x16x32_bf16 v[64:67], v[32:35], v[128:131], v[64:67]
    ds_read_b128 v[28:31], v1 offset:2048
    s_waitcnt lgkmcnt(2)
    v_mfma_f32_16x16x32_bf16 v[68:71], v[36:39], v[128:131], v[68:71]
    ds_read_b128 v[32:35], v1 offset:22528
    s_waitcnt lgkmcnt(2)
    v_mfma_f32_16x16x32_bf16 v[72:75], v[40:43], v[128:131], v[72:75]
    ds_read_b128 v[36:39], v6 offset:2048
    s_waitcnt vmcnt(21) lgkmcnt(2)
    v_mfma_f32_16x16x32_bf16 v[60:63], v[28:31], v[132:135], v[60:63]
    ds_read_b128 v[40:43], v6 offset:22528
    s_waitcnt lgkmcnt(2)
    v_mfma_f32_16x16x32_bf16 v[64:67], v[32:35], v[132:135], v[64:67]
    ds_read_b128 v[28:31], v1 offset:3072
    s_waitcnt lgkmcnt(2)
    v_mfma_f32_16x16x32_bf16 v[68:71], v[36:39], v[132:135], v[68:71]
    ds_read_b128 v[32:35], v1 offset:23552
    s_waitcnt lgkmcnt(2)
    v_mfma_f32_16x16x32_bf16 v[72:75], v[40:43], v[132:135], v[72:75]
    ds_read_b128 v[36:39], v6 offset:3072
    s_waitcnt vmcnt(20) lgkmcnt(2)
    v_mfma_f32_16x16x32_bf16 v[60:63], v[28:31], v[136:139], v[60:63]
    ds_read_b128 v[40:43], v6 offset:23552
    s_waitcnt lgkmcnt(2)
    v_mfma_f32_16x16x32_bf16 v[64:67], v[32:35], v[136:139], v[64:67]
    ds_read_b128 v[28:31], v1 offset:4096
    s_waitcnt lgkmcnt(2)
    v_mfma_f32_16x16x32_bf16 v[68:71], v[36:39], v[136:139], v[68:71]
    ds_read_b128 v[32:35], v1 offset:24576
    s_waitcnt lgkmcnt(2)
    v_mfma_f32_16x16x32_bf16 v[72:75], v[40:43], v[136:139], v[72:75]
    ds_read_b128 v[36:39], v6 offset:4096
    s_waitcnt vmcnt(19) lgkmcnt(2)
    v_mfma_f32_16x16x32_bf16 v[60:63], v[28:31], v[140:143], v[60:63]
    ds_read_b128 v[40:43], v6 offset:24576
    s_waitcnt lgkmcnt(2)
    v_mfma_f32_16x16x32_bf16 v[64:67], v[32:35], v[140:143], v[64:67]
    ds_read_b128 v[28:31], v1 offset:5120
    s_waitcnt lgkmcnt(2)
    v_mfma_f32_16x16x32_bf16 v[68:71], v[36:39], v[140:143], v[68:71]
    ds_read_b128 v[32:35], v1 offset:25600
    s_waitcnt lgkmcnt(2)
    v_mfma_f32_16x16x32_bf16 v[72:75], v[40:43], v[140:143], v[72:75]
    ds_read_b128 v[36:39], v6 offset:5120
    s_waitcnt vmcnt(18) lgkmcnt(2)
    v_mfma_f32_16x16x32_bf16 v[60:63], v[28:31], v[144:147], v[60:63]
    ds_read_b128 v[40:43], v6 offset:25600
    s_waitcnt lgkmcnt(2)
    v_mfma_f32_16x16x32_bf16 v[64:67], v[32:35], v[144:147], v[64:67]
    ds_read_b128 v[28:31], v1 offset:6144
    s_waitcnt lgkmcnt(2)
    v_mfma_f32_16x16x32_bf16 v[68:71], v[36:39], v[144:147], v[68:71]
    ds_read_b128 v[32:35], v1 offset:26624
    s_waitcnt lgkmcnt(2)
    v_mfma_f32_16x16x32_bf16 v[72:75], v[40:43], v[144:147], v[72:75]
    ds_read_b128 v[36:39], v6 offset:6144
    s_waitcnt vmcnt(17) lgkmcnt(2)
    v_mfma_f32_16x16x32_bf16 v[60:63], v[28:31], v[148:151], v[60:63]
    ds_read_b128 v[40:43], v6 offset:26624
    s_waitcnt lgkmcnt(2)
    v_mfma_f32_16x16x32_bf16 v[64:67], v[32:35], v[148:151], v[64:67]
    ds_read_b128 v[28:31], v1 offset:7168
    s_waitcnt lgkmcnt(2)
    v_mfma_f32_16x16x32_bf16 v[68:71], v[36:39], v[148:151], v[68:71]
    ds_read_b128 v[32:35], v1 offset:27648
    s_waitcnt lgkmcnt(2)
    v_mfma_f32_16x16x32_bf16 v[72:75], v[40:43], v[148:151], v[72:75]
    ds_read_b128 v[36:39], v6 offset:7168
    s_waitcnt vmcnt(16) lgkmcnt(2)
    v_mfma_f32_16x16x32_bf16 v[60:63], v[28:31], v[152:155], v[60:63]
    ds_read_b128 v[40:43], v6 offset:27648
    s_waitcnt lgkmcnt(2)
    v_mfma_f32_16x16x32_bf16 v[64:67], v[32:35], v[152:155], v[64:67]
    ds_read_b128 v[28:31], v1 offset:8192
    s_waitcnt lgkmcnt(2)
    v_mfma_f32_16x16x32_bf16 v[68:71], v[36:39], v[152:155], v[68:71]
    ds_read_b128 v[32:35], v1 offset:28672
    s_waitcnt lgkmcnt(2)
    v_mfma_f32_16x16x32_bf16 v[72:75], v[40:43], v[152:155], v[72:75]
    ds_read_b128 v[36:39], v6 offset:8192
    s_waitcnt vmcnt(15) lgkmcnt(2)
    v_mfma_f32_16x16x32_bf16 v[60:63], v[28:31], v[156:159], v[60:63]
    ds_read_b128 v[40:43], v6 offset:28672
    s_waitcnt lgkmcnt(2)
    v_mfma_f32_16x16x32_bf16 v[64:67], v[32:35], v[156:159], v[64:67]
    ds_read_b128 v[28:31], v1 offset:9216
    s_waitcnt lgkmcnt(2)
    v_mfma_f32_16x16x32_bf16 v[68:71], v[36:39], v[156:159], v[68:71]
    ds_read_b128 v[32:35], v1 offset:29696
    s_waitcnt lgkmcnt(2)
    v_mfma_f32_16x16x32_bf16 v[72:75], v[40:43], v[156:159], v[72:75]
    ds_read_b128 v[36:39], v6 offset:9216
    s_waitcnt vmcnt(14) lgkmcnt(2)
    v_mfma_f32_16x16x32_bf16 v[60:63], v[28:31], v[160:163], v[60:63]
    ds_read_b128 v[40:43], v6 offset:29696
    s_waitcnt lgkmcnt(2)
    v_mfma_f32_16x16x32_bf16 v[64:67], v[32:35], v[160:163], v[64:67]
    ds_read_b128 v[28:31], v1 offset:10240
    s_waitcnt lgkmcnt(2)
    v_mfma_f32_16x16x32_bf16 v[68:71], v[36:39], v[160:163], v[68:71]
    ds_read_b128 v[32:35], v1 offset:30720
    s_waitcnt lgkmcnt(2)
    v_mfma_f32_16x16x32_bf16 v[72:75], v[40:43], v[160:163], v[72:75]
    ds_read_b128 v[36:39], v6 offset:10240
    s_waitcnt vmcnt(13) lgkmcnt(2)
    v_mfma_f32_16x16x32_bf16 v[60:63], v[28:31], v[164:167], v[60:63]
    ds_read_b128 v[40:43], v6 offset:30720
    s_waitcnt lgkmcnt(2)
    v_mfma_f32_16x16x32_bf16 v[64:67], v[32:35], v[164:167], v[64:67]
    ds_read_b128 v[28:31], v1 offset:11264
    s_waitcnt lgkmcnt(2)
    v_mfma_f32_16x16x32_bf16 v[68:71], v[36:39], v[164:167], v[68:71]
    ds_read_b128 v[32:35], v1 offset:31744
    s_waitcnt lgkmcnt(2)
    v_mfma_f32_16x16x32_bf16 v[72:75], v[40:43], v[164:167], v[72:75]
    ds_read_b128 v[36:39], v6 offset:11264
    s_waitcnt vmcnt(12) lgkmcnt(2)
    v_mfma_f32_16x16x32_bf16 v[60:63], v[28:31], v[168:171], v[60:63]
    ds_read_b128 v[40:43], v6 offset:31744
    s_waitcnt lgkmcnt(2)
    v_mfma_f32_16x16x32_bf16 v[64:67], v[32:35], v[168:171], v[64:67]
    ds_read_b128 v[28:31], v1 offset:12288
    s_waitcnt lgkmcnt(2)
    v_mfma_f32_16x16x32_bf16 v[68:71], v[36:39], v[168:171], v[68:71]
    ds_read_b128 v[32:35], v1 offset:32768
    s_waitcnt lgkmcnt(2)
    v_mfma_f32_16x16x32_bf16 v[72:75], v[40:43], v[168:171], v[72:75]
    ds_read_b128 v[36:39], v6 offset:12288
    s_waitcnt vmcnt(11) lgkmcnt(2)
    v_mfma_f32_16x16x32_bf16 v[60:63], v[28:31], v[172:175], v[60:63]
    ds_read_b128 v[40:43], v6 offset:32768
    s_waitcnt lgkmcnt(2)
    v_mfma_f32_16x16x32_bf16 v[64:67], v[32:35], v[172:175], v[64:67]
    ds_read_b128 v[28:31], v1 offset:13312
    s_waitcnt lgkmcnt(2)
    v_mfma_f32_16x16x32_bf16 v[68:71], v[36:39], v[172:175], v[68:71]
    ds_read_b128 v[32:35], v1 offset:33792
    s_waitcnt lgkmcnt(2)
    v_mfma_f32_16x16x32_bf16 v[72:75], v[40:43], v[172:175], v[72:75]
    ds_read_b128 v[36:39], v6 offset:13312
    s_waitcnt vmcnt(10) lgkmcnt(2)
    v_mfma_f32_16x16x32_bf16 v[60:63], v[28:31], v[176:179], v[60:63]
    ds_read_b128 v[40:43], v6 offset:33792
    s_waitcnt lgkmcnt(2)
    v_mfma_f32_16x16x32_bf16 v[64:67], v[32:35], v[176:179], v[64:67]
    ds_read_b128 v[28:31], v1 offset:14336
    s_waitcnt lgkmcnt(2)
    v_mfma_f32_16x16x32_bf16 v[68:71], v[36:39], v[176:179], v[68:71]
    ds_read_b128 v[32:35], v1 offset:34816
    s_waitcnt lgkmcnt(2)
    v_mfma_f32_16x16x32_bf16 v[72:75], v[40:43], v[176:179], v[72:75]
    ds_read_b128 v[36:39], v6 offset:14336
    s_waitcnt vmcnt(9) lgkmcnt(2)
    v_mfma_f32_16x16x32_bf16 v[60:63], v[28:31], v[180:183], v[60:63]
    ds_read_b128 v[40:43], v6 offset:34816
    s_waitcnt lgkmcnt(2)
    v_mfma_f32_16x16x32_bf16 v[64:67], v[32:35], v[180:183], v[64:67]
    ds_read_b128 v[28:31], v1 offset:15360
    s_waitcnt lgkmcnt(2)
    v_mfma_f32_16x16x32_bf16 v[68:71], v[36:39], v[180:183], v[68:71]
    ds_read_b128 v[32:35], v1 offset:35840
    s_waitcnt lgkmcnt(2)
    v_mfma_f32_16x16x32_bf16 v[72:75], v[40:43], v[180:183], v[72:75]
    ds_read_b128 v[36:39], v6 offset:15360
    s_waitcnt vmcnt(8) lgkmcnt(2)
    v_mfma_f32_16x16x32_bf16 v[60:63], v[28:31], v[184:187], v[60:63]
    ds_read_b128 v[40:43], v6 offset:35840
    s_waitcnt lgkmcnt(2)
    v_mfma_f32_16x16x32_bf16 v[64:67], v[32:35], v[184:187], v[64:67]
    ds_read_b128 v[28:31], v1 offset:16384
    s_waitcnt lgkmcnt(2)
    v_mfma_f32_16x16x32_bf16 v[68:71], v[36:39], v[184:187], v[68:71]
    ds_read_b128 v[32:35], v1 offset:36864
    s_waitcnt lgkmcnt(2)
    v_mfma_f32_16x16x32_bf16 v[72:75], v[40:43], v[184:187], v[72:75]
    ds_read_b128 v[36:39], v6 offset:16384
    s_waitcnt vmcnt(7) lgkmcnt(2)
    v_mfma_f32_16x16x32_bf16 v[60:63], v[28:31], v[44:47], v[60:63]
    ds_read_b128 v[40:43], v6 offset:36864
    s_waitcnt lgkmcnt(2)
    v_mfma_f32_16x16x32_bf16 v[64:67], v[32:35], v[44:47], v[64:67]
    ds_read_b128 v[28:31], v1 offset:17408
    s_waitcnt lgkmcnt(2)
    v_mfma_f32_16x16x32_bf16 v[68:71], v[36:39], v[44:47], v[68:71]
    ds_read_b128 v[32:35], v1 offset:37888
    s_waitcnt lgkmcnt(2)
    v_mfma_f32_16x16x32_bf16 v[72:75], v[40:43], v[44:47], v[72:75]
    ds_read_b128 v[36:39], v6 offset:17408
    s_waitcnt vmcnt(6) lgkmcnt(2)
    v_mfma_f32_16x16x32_bf16 v[60:63], v[28:31], v[48:51], v[60:63]
    ds_read_b128 v[40:43], v6 offset:37888
    s_waitcnt lgkmcnt(2)
    v_mfma_f32_16x16x32_bf16 v[64:67], v[32:35], v[48:51], v[64:67]
    ds_read_b128 v[28:31], v1 offset:18432
    s_waitcnt lgkmcnt(2)
    v_mfma_f32_16x16x32_bf16 v[68:71], v[36:39], v[48:51], v[68:71]
    ds_read_b128 v[32:35], v1 offset:38912
    s_waitcnt lgkmcnt(2)
    v_mfma_f32_16x16x32_bf16 v[72:75], v[40:43], v[48:51], v[72:75]
    ds_read_b128 v[36:39], v6 offset:18432
    s_waitcnt vmcnt(5) lgkmcnt(2)
    v_mfma_f32_16x16x32_bf16 v[60:63], v[28:31], v[52:55], v[60:63]
    ds_read_b128 v[40:43], v6 offset:38912
    s_waitcnt lgkmcnt(2)
    v_mfma_f32_16x16x32_bf16 v[64:67], v[32:35], v[52:55], v[64:67]
    ds_read_b128 v[28:31], v1 offset:19456
    s_waitcnt lgkmcnt(2)
    v_mfma_f32_16x16x32_bf16 v[68:71], v[36:39], v[52:55], v[68:71]
    ds_read_b128 v[32:35], v1 offset:39936
    s_waitcnt lgkmcnt(2)
    v_mfma_f32_16x16x32_bf16 v[72:75], v[40:43], v[52:55], v[72:75]
    ds_read_b128 v[36:39], v6 offset:19456
    s_waitcnt vmcnt(4) lgkmcnt(2)
    v_mfma_f32_16x16x32_bf16 v[60:63], v[28:31], v[56:59], v[60:63]
    ds_read_b128 v[40:43], v6 offset:39936
    s_waitcnt lgkmcnt(2)
    v_mfma_f32_16x16x32_bf16 v[64:67], v[32:35], v[56:59], v[64:67]
    s_waitcnt lgkmcnt(1)
    v_mfma_f32_16x16x32_bf16 v[68:71], v[36:39], v[56:59], v[68:71]
    s_waitcnt lgkmcnt(0)
    v_mfma_f32_16x16x32_bf16 v[72:75], v[40:43], v[56:59], v[72:75]
    s_waitcnt vmcnt(3)
    v_lshlrev_b32 v8, 16, v108
    v_and_b32 v9, 0xffff0000, v108
    v_pk_add_f32 v[12:13], v[12:13], v[8:9]
    v_cvt_pk_bf16_f32 v108, v12, v13
    v_lshlrev_b32 v8, 16, v109
    v_and_b32 v9, 0xffff0000, v109
    v_pk_add_f32 v[14:15], v[14:15], v[8:9]
    v_cvt_pk_bf16_f32 v109, v14, v15
    v_lshlrev_b32 v8, 16, v110
    v_and_b32 v9, 0xffff0000, v110
    v_pk_add_f32 v[16:17], v[16:17], v[8:9]
    v_cvt_pk_bf16_f32 v110, v16, v17
    v_lshlrev_b32 v8, 16, v111
    v_and_b32 v9, 0xffff0000, v111
    v_pk_add_f32 v[18:19], v[18:19], v[8:9]
    v_cvt_pk_bf16_f32 v111, v18, v19
    s_waitcnt vmcnt(2)
    v_lshlrev_b32 v8, 16, v112
    v_and_b32 v9, 0xffff0000, v112
    v_pk_add_f32 v[20:21], v[20:21], v[8:9]
    v_cvt_pk_bf16_f32 v112, v20, v21
    v_lshlrev_b32 v8, 16, v113
    v_and_b32 v9, 0xffff0000, v113
    v_pk_add_f32 v[22:23], v[22:23], v[8:9]
    v_cvt_pk_bf16_f32 v113, v22, v23
    v_lshlrev_b32 v8, 16, v114
    v_and_b32 v9, 0xffff0000, v114
    v_pk_add_f32 v[24:25], v[24:25], v[8:9]
    v_cvt_pk_bf16_f32 v114, v24, v25
    v_lshlrev_b32 v8, 16, v115
    v_and_b32 v9, 0xffff0000, v115
    v_pk_add_f32 v[26:27], v[26:27], v[8:9]
    v_cvt_pk_bf16_f32 v115, v26, v27
    s_waitcnt vmcnt(1)
    v_lshlrev_b32 v8, 16, v116
    v_and_b32 v9, 0xffff0000, v116
    v_pk_add_f32 v[60:61], v[60:61], v[8:9]
    v_cvt_pk_bf16_f32 v116, v60, v61
    v_lshlrev_b32 v8, 16, v117
    v_and_b32 v9, 0xffff0000, v117
    v_pk_add_f32 v[62:63], v[62:63], v[8:9]
    v_cvt_pk_bf16_f32 v117, v62, v63
    v_lshlrev_b32 v8, 16, v118
    v_and_b32 v9, 0xffff0000, v118
    v_pk_add_f32 v[64:65], v[64:65], v[8:9]
    v_cvt_pk_bf16_f32 v118, v64, v65
    v_lshlrev_b32 v8, 16, v119
    v_and_b32 v9, 0xffff0000, v119
    v_pk_add_f32 v[66:67], v[66:67], v[8:9]
    v_cvt_pk_bf16_f32 v119, v66, v67
    s_waitcnt vmcnt(0)
    v_lshlrev_b32 v8, 16, v120
    v_and_b32 v9, 0xffff0000, v120
    v_pk_add_f32 v[68:69], v[68:69], v[8:9]
    v_cvt_pk_bf16_f32 v120, v68, v69
    v_lshlrev_b32 v8, 16, v121
    v_and_b32 v9, 0xffff0000, v121
    v_pk_add_f32 v[70:71], v[70:71], v[8:9]
    v_cvt_pk_bf16_f32 v121, v70, v71
    v_lshlrev_b32 v8, 16, v122
    v_and_b32 v9, 0xffff0000, v122
    v_pk_add_f32 v[72:73], v[72:73], v[8:9]
    v_cvt_pk_bf16_f32 v122, v72, v73
    v_lshlrev_b32 v8, 16, v123
    v_and_b32 v9, 0xffff0000, v123
    v_pk_add_f32 v[74:75], v[74:75], v[8:9]
    v_cvt_pk_bf16_f32 v123, v74, v75
    s_cmp_eq_u32 s101, 1
    s_cbranch_scc1 M_id_out
    v_lshlrev_b32 v12, 16, v108
    v_and_b32 v13, 0xffff0000, v108
    v_lshlrev_b32 v14, 16, v109
    v_and_b32 v15, 0xffff0000, v109
    v_lshlrev_b32 v16, 16, v110
    v_and_b32 v17, 0xffff0000, v110
    v_lshlrev_b32 v18, 16, v111
    v_and_b32 v19, 0xffff0000, v111
    v_lshlrev_b32 v20, 16, v112
    v_and_b32 v21, 0xffff0000, v112
    v_lshlrev_b32 v22, 16, v113
    v_and_b32 v23, 0xffff0000, v113
    v_lshlrev_b32 v24, 16, v114
    v_and_b32 v25, 0xffff0000, v114
    v_lshlrev_b32 v26, 16, v115
    v_and_b32 v27, 0xffff0000, v115
    v_lshlrev_b32 v60, 16, v116
    v_and_b32 v61, 0xffff0000, v116
    v_lshlrev_b32 v62, 16, v117
    v_and_b32 v63, 0xffff0000, v117
    v_lshlrev_b32 v64, 16, v118
    v_and_b32 v65, 0xffff0000, v118
    v_lshlrev_b32 v66, 16, v119
    v_and_b32 v67, 0xffff0000, v119
    v_lshlrev_b32 v68, 16, v120
    v_and_b32 v69, 0xffff0000, v120
    v_lshlrev_b32 v70, 16, v121
    v_and_b32 v71, 0xffff0000, v121
    v_lshlrev_b32 v72, 16, v122
    v_and_b32 v73, 0xffff0000, v122
    v_lshlrev_b32 v74, 16, v123
    v_and_b32 v75, 0xffff0000, v123
    v_pk_add_f32 v[124:125], v[12:13], v[14:15]
    v_pk_add_f32 v[128:129], v[60:61], v[62:63]
    v_pk_add_f32 v[124:125], v[124:125], v[16:17]
    v_pk_add_f32 v[128:129], v[128:129], v[64:65]
    v_pk_add_f32 v[124:125], v[124:125], v[18:19]
    v_pk_add_f32 v[128:129], v[128:129], v[66:67]
    v_pk_add_f32 v[124:125], v[124:125], v[20:21]
    v_pk_add_f32 v[128:129], v[128:129], v[68:69]
    v_pk_add_f32 v[124:125], v[124:125], v[22:23]
    v_pk_add_f32 v[128:129], v[128:129], v[70:71]
    v_pk_add_f32 v[124:125], v[124:125], v[24:25]
    v_pk_add_f32 v[128:129], v[128:129], v[72:73]
    v_pk_add_f32 v[124:125], v[124:125], v[26:27]
    v_pk_add_f32 v[128:129], v[128:129], v[74:75]
    v_add_f32 v124, v124, v125
    v_add_f32 v128, v128, v129
    v_mov_b32 v132, v124
    v_mov_b32 v133, v128
    s_nop 0
    v_permlane16_swap_b32 v124, v132
    v_permlane16_swap_b32 v128, v133
    v_add_f32 v124, v124, v132
    v_add_f32 v128, v128, v133
    v_mov_b32 v132, v124
    v_mov_b32 v133, v128
    s_nop 0
    v_permlane32_swap_b32 v124, v132
    v_permlane32_swap_b32 v128, v133
    v_add_f32 v124, v124, v132
    v_add_f32 v128, v128, v133
    v_mul_f32 v124, 0x3c800000, v124
    v_mov_b64 v[126:127], 0
    v_mul_f32 v128, 0x3c800000, v128
    v_mov_b64 v[130:131], 0
    v_pk_add_f32 v[8:9], v[12:13], v[124:125] op_sel_hi:[1,0] neg_lo:[0,1] neg_hi:[0,1]
    v_pk_add_f32 v[10:11], v[60:61], v[128:129] op_sel_hi:[1,0] neg_lo:[0,1] neg_hi:[0,1]
    v_pk_fma_f32 v[126:127], v[8:9], v[8:9], v[126:127]
    v_pk_fma_f32 v[130:131], v[10:11], v[10:11], v[130:131]
    v_pk_add_f32 v[8:9], v[14:15], v[124:125] op_sel_hi:[1,0] neg_lo:[0,1] neg_hi:[0,1]
    v_pk_add_f32 v[10:11], v[62:63], v[128:129] op_sel_hi:[1,0] neg_lo:[0,1] neg_hi:[0,1]
    v_pk_fma_f32 v[126:127], v[8:9], v[8:9], v[126:127]
    v_pk_fma_f32 v[130:131], v[10:11], v[10:11], v[130:131]
    v_pk_add_f32 v[8:9], v[16:17], v[124:125] op_sel_hi:[1,0] neg_lo:[0,1] neg_hi:[0,1]
    v_pk_add_f32 v[10:11], v[64:65], v[128:129] op_sel_hi:[1,0] neg_lo:[0,1] neg_hi:[0,1]
    v_pk_fma_f32 v[126:127], v[8:9], v[8:9], v[126:127]
    v_pk_fma_f32 v[130:131], v[10:11], v[10:11], v[130:131]
    v_pk_add_f32 v[8:9], v[18:19], v[124:125] op_sel_hi:[1,0] neg_lo:[0,1] neg_hi:[0,1]
    v_pk_add_f32 v[10:11], v[66:67], v[128:129] op_sel_hi:[1,0] neg_lo:[0,1] neg_hi:[0,1]
    v_pk_fma_f32 v[126:127], v[8:9], v[8:9], v[126:127]
    v_pk_fma_f32 v[130:131], v[10:11], v[10:11], v[130:131]
    v_pk_add_f32 v[8:9], v[20:21], v[124:125] op_sel_hi:[1,0] neg_lo:[0,1] neg_hi:[0,1]
    v_pk_add_f32 v[10:11], v[68:69], v[128:129] op_sel_hi:[1,0] neg_lo:[0,1] neg_hi:[0,1]
    v_pk_fma_f32 v[126:127], v[8:9], v[8:9], v[126:127]
    v_pk_fma_f32 v[130:131], v[10:11], v[10:11], v[130:131]
    v_pk_add_f32 v[8:9], v[22:23], v[124:125] op_sel_hi:[1,0] neg_lo:[0,1] neg_hi:[0,1]
    v_pk_add_f32 v[10:11], v[70:71], v[128:129] op_sel_hi:[1,0] neg_lo:[0,1] neg_hi:[0,1]
    v_pk_fma_f32 v[126:127], v[8:9], v[8:9], v[126:127]
    v_pk_fma_f32 v[130:131], v[10:11], v[10:11], v[130:131]
    v_pk_add_f32 v[8:9], v[24:25], v[124:125] op_sel_hi:[1,0] neg_lo:[0,1] neg_hi:[0,1]
    v_pk_add_f32 v[10:11], v[72:73], v[128:129] op_sel_hi:[1,0] neg_lo:[0,1] neg_hi:[0,1]
    v_pk_fma_f32 v[126:127], v[8:9], v[8:9], v[126:127]
    v_pk_fma_f32 v[130:131], v[10:11], v[10:11], v[130:131]
    v_pk_add_f32 v[8:9], v[26:27], v[124:125] op_sel_hi:[1,0] neg_lo:[0,1] neg_hi:[0,1]
    v_pk_add_f32 v[10:11], v[74:75], v[128:129] op_sel_hi:[1,0] neg_lo:[0,1] neg_hi:[0,1]
    v_pk_fma_f32 v[126:127], v[8:9], v[8:9], v[126:127]
    v_pk_fma_f32 v[130:131], v[10:11], v[10:11], v[130:131]
    v_add_f32 v125, v126, v127
    v_add_f32 v129, v130, v131
    v_mov_b32 v132, v125
    v_mov_b32 v133, v129
    s_nop 0
    v_permlane16_swap_b32 v125, v132
    v_permlane16_swap_b32 v129, v133
    v_add_f32 v125, v125, v132
    v_add_f32 v129, v129, v133
    v_mov_b32 v132, v125
    v_mov_b32 v133, v129
    s_nop 0
    v_permlane32_swap_b32 v125, v132
    v_permlane32_swap_b32 v129, v133
    v_add_f32 v125, v125, v132
    v_add_f32 v129, v129, v133
    v_min_u32 v124, -2, v124
    v_min_u32 v125, -2, v125
    v_min_u32 v128, -2, v128
    v_min_u32 v129, -2, v129
    s_lshl_b32 s24, s89, 12
    s_add_u32 s24, s24, 173625344
    s_lshl_b32 s25, s88, 3
    s_add_u32 s25, s25, s24
    v_lshlrev_b32 v7, 7, v4
    v_lshl_add_u32 v2, v3, 5, v7
    s_mov_b64 exec, 0xffff
    s_cmp_lg_u32 s23, 0
    s_cbranch_scc1 M_ls_41
    buffer_store_dwordx2 v[124:125], v7, s[8:11], s25 offen offset:0
    buffer_store_dwordx2 v[128:129], v7, s[8:11], s25 offen offset:2048
M_ls_41_r:
    s_mov_b64 exec, -1
    v_cmp_gt_u32_e64 s[36:37], 3, v3
    v_cmp_gt_u32_e64 s[38:39], 2, v3
    s_mov_b32 s34, 0
M_id_poll:
    buffer_load_dwordx4 v[136:139], v2, s[8:11], s24 offen offset:0 sc1
    buffer_load_dwordx4 v[140:143], v2, s[8:11], s24 offen offset:16 sc1
    buffer_load_dwordx4 v[144:147], v2, s[8:11], s24 offen offset:2048 sc1
    buffer_load_dwordx4 v[148:151], v2, s[8:11], s24 offen offset:2064 sc1
    s_add_u32 s34, s34, 1
    s_cmp_ge_u32 s34, 60000
    s_cbranch_scc1 M_fail
    s_waitcnt vmcnt(3)
    v_cndmask_b32_e64 v136, 0, v136, s[36:37]
    v_cndmask_b32_e64 v137, 0, v137, s[36:37]
    v_cndmask_b32_e64 v138, 0, v138, s[36:37]
    v_cndmask_b32_e64 v139, 0, v139, s[36:37]
    s_waitcnt vmcnt(2)
    v_cndmask_b32_e64 v140, 0, v140, s[38:39]
    v_cndmask_b32_e64 v141, 0, v141, s[38:39]
    v_cndmask_b32_e64 v142, 0, v142, s[38:39]
    v_cndmask_b32_e64 v143, 0, v143, s[38:39]
    s_waitcnt vmcnt(1)
    v_cndmask_b32_e64 v144, 0, v144, s[36:37]
    v_cndmask_b32_e64 v145, 0, v145, s[36:37]
    v_cndmask_b32_e64 v146, 0, v146, s[36:37]
    v_cndmask_b32_e64 v147, 0, v147, s[36:37]
    s_waitcnt vmcnt(0)
    v_cndmask_b32_e64 v148, 0, v148, s[38:39]
    v_cndmask_b32_e64 v149, 0, v149, s[38:39]
    v_cndmask_b32_e64 v150, 0, v150, s[38:39]
    v_cndmask_b32_e64 v151, 0, v151, s[38:39]
    v_max3_u32 v8, v136, v137, v138
    v_max3_u32 v8, v8, v139, v140
    v_max3_u32 v8, v8, v141, v142
    v_max3_u32 v8, v8, v143, v144
    v_max3_u32 v8, v8, v145, v146
    v_max3_u32 v8, v8, v147, v148
    v_max3_u32 v8, v8, v149, v150
    v_max_u32 v8, v8, v151
    v_cmp_eq_u32 vcc, -1, v8
    s_cbranch_vccnz M_id_poll
    v_add_f32 v124, v136, v138
    v_add_f32 v125, v140, v142
    v_add_f32 v124, v124, v125
    v_add_f32 v128, v144, v146
    v_add_f32 v129, v148, v150
    v_add_f32 v128, v128, v129
    v_mov_b32 v132, v124
    v_mov_b32 v133, v128
    s_nop 0
    v_permlane16_swap_b32 v124, v132
    v_permlane16_swap_b32 v128, v133
    v_add_f32 v124, v124, v132
    v_add_f32 v128, v128, v133
    v_mov_b32 v132, v124
    v_mov_b32 v133, v128
    s_nop 0
    v_permlane32_swap_b32 v124, v132
    v_permlane32_swap_b32 v128, v133
    v_add_f32 v124, v124, v132
    v_add_f32 v128, v128, v133
    v_mul_f32 v124, 0x3dcccccd, v124
    v_add_f32 v125, v137, v139
    v_add_f32 v126, v141, v143
    v_add_f32 v125, v125, v126
    v_sub_f32 v8, v136, v124
    v_cndmask_b32_e64 v8, 0, v8, s[36:37]
    v_mul_f32 v9, 0x42800000, v8
    v_fmac_f32 v125, v8, v9
    v_sub_f32 v8, v138, v124
    v_cndmask_b32_e64 v8, 0, v8, s[36:37]
    v_mul_f32 v9, 0x42800000, v8
    v_fmac_f32 v125, v8, v9
    v_sub_f32 v8, v140, v124
    v_cndmask_b32_e64 v8, 0, v8, s[38:39]
    v_mul_f32 v9, 0x42800000, v8
    v_fmac_f32 v125, v8, v9
    v_sub_f32 v8, v142, v124
    v_cndmask_b32_e64 v8, 0, v8, s[38:39]
    v_mul_f32 v9, 0x42800000, v8
    v_fmac_f32 v125, v8, v9
    v_mul_f32 v128, 0x3dcccccd, v128
    v_add_f32 v129, v145, v147
    v_add_f32 v130, v149, v151
    v_add_f32 v129, v129, v130
    v_sub_f32 v8, v144, v128
    v_cndmask_b32_e64 v8, 0, v8, s[36:37]
    v_mul_f32 v9, 0x42800000, v8
    v_fmac_f32 v129, v8, v9
    v_sub_f32 v8, v146, v128
    v_cndmask_b32_e64 v8, 0, v8, s[36:37]
    v_mul_f32 v9, 0x42800000, v8
    v_fmac_f32 v129, v8, v9
    v_sub_f32 v8, v148, v128
    v_cndmask_b32_e64 v8, 0, v8, s[38:39]
    v_mul_f32 v9, 0x42800000, v8
    v_fmac_f32 v129, v8, v9
    v_sub_f32 v8, v150, v128
    v_cndmask_b32_e64 v8, 0, v8, s[38:39]
    v_mul_f32 v9, 0x42800000, v8
    v_fmac_f32 v129, v8, v9
    v_mov_b32 v132, v125
    v_mov_b32 v133, v129
    s_nop 0
    v_permlane16_swap_b32 v125, v132
    v_permlane16_swap_b32 v129, v133
    v_add_f32 v125, v125, v132
    v_add_f32 v129, v129, v133
    v_mov_b32 v132, v125
    v_mov_b32 v133, v129
    s_nop 0
    v_permlane32_swap_b32 v125, v132
    v_permlane32_swap_b32 v129, v133
    v_add_f32 v125, v125, v132
    v_add_f32 v129, v129, v133
    v_mov_b32 v126, 0x3727c5ac
    v_fmac_f32 v126, 0x3acccccd, v125
    v_rsq_f32 v126, v126
    v_mov_b32 v130, 0x3727c5ac
    v_fmac_f32 v130, 0x3acccccd, v129
    v_rsq_f32 v130, v130
    s_lshl_b32 s25, s88, 11
    s_add_u32 s25, s25, s29
    s_add_u32 s25, s25, 32505856
    s_add_u32 s24, s25, 20480
    v_pk_add_f32 v[12:13], v[12:13], v[124:125] op_sel_hi:[1,0] neg_lo:[0,1] neg_hi:[0,1]
    v_pk_add_f32 v[14:15], v[14:15], v[124:125] op_sel_hi:[1,0] neg_lo:[0,1] neg_hi:[0,1]
    v_pk_add_f32 v[16:17], v[16:17], v[124:125] op_sel_hi:[1,0] neg_lo:[0,1] neg_hi:[0,1]
    v_pk_add_f32 v[18:19], v[18:19], v[124:125] op_sel_hi:[1,0] neg_lo:[0,1] neg_hi:[0,1]
    v_pk_add_f32 v[20:21], v[20:21], v[124:125] op_sel_hi:[1,0] neg_lo:[0,1] neg_hi:[0,1]
    v_pk_add_f32 v[22:23], v[22:23], v[124:125] op_sel_hi:[1,0] neg_lo:[0,1] neg_hi:[0,1]
    v_pk_add_f32 v[24:25], v[24:25], v[124:125] op_sel_hi:[1,0] neg_lo:[0,1] neg_hi:[0,1]
    v_pk_add_f32 v[26:27], v[26:27], v[124:125] op_sel_hi:[1,0] neg_lo:[0,1] neg_hi:[0,1]
    v_pk_mul_f32 v[12:13], v[12:13], v[126:127] op_sel_hi:[1,0]
    v_pk_mul_f32 v[14:15], v[14:15], v[126:127] op_sel_hi:[1,0]
    v_pk_mul_f32 v[16:17], v[16:17], v[126:127] op_sel_hi:[1,0]
    v_pk_mul_f32 v[18:19], v[18:19], v[126:127] op_sel_hi:[1,0]
    v_pk_mul_f32 v[20:21], v[20:21], v[126:127] op_sel_hi:[1,0]
    v_pk_mul_f32 v[22:23], v[22:23], v[126:127] op_sel_hi:[1,0]
    v_pk_mul_f32 v[24:25], v[24:25], v[126:127] op_sel_hi:[1,0]
    v_pk_mul_f32 v[26:27], v[26:27], v[126:127] op_sel_hi:[1,0]
    v_cvt_pk_bf16_f32 v12, v12, v13
    v_cvt_pk_bf16_f32 v13, v14, v15
    v_cvt_pk_bf16_f32 v14, v16, v17
    v_cvt_pk_bf16_f32 v15, v18, v19
    v_cvt_pk_bf16_f32 v16, v20, v21
    v_cvt_pk_bf16_f32 v17, v22, v23
    v_cvt_pk_bf16_f32 v18, v24, v25
    v_cvt_pk_bf16_f32 v19, v26, v27
    buffer_store_dwordx4 v[12:15], v1, s[8:11], s25 offen offset:0 sc1
    buffer_store_dwordx4 v[16:19], v1, s[8:11], s25 offen offset:1024 sc1
    v_pk_add_f32 v[60:61], v[60:61], v[128:129] op_sel_hi:[1,0] neg_lo:[0,1] neg_hi:[0,1]
    v_pk_add_f32 v[62:63], v[62:63], v[128:129] op_sel_hi:[1,0] neg_lo:[0,1] neg_hi:[0,1]
    v_pk_add_f32 v[64:65], v[64:65], v[128:129] op_sel_hi:[1,0] neg_lo:[0,1] neg_hi:[0,1]
    v_pk_add_f32 v[66:67], v[66:67], v[128:129] op_sel_hi:[1,0] neg_lo:[0,1] neg_hi:[0,1]
    v_pk_add_f32 v[68:69], v[68:69], v[128:129] op_sel_hi:[1,0] neg_lo:[0,1] neg_hi:[0,1]
    v_pk_add_f32 v[70:71], v[70:71], v[128:129] op_sel_hi:[1,0] neg_lo:[0,1] neg_hi:[0,1]
    v_pk_add_f32 v[72:73], v[72:73], v[128:129] op_sel_hi:[1,0] neg_lo:[0,1] neg_hi:[0,1]
    v_pk_add_f32 v[74:75], v[74:75], v[128:129] op_sel_hi:[1,0] neg_lo:[0,1] neg_hi:[0,1]
    v_pk_mul_f32 v[60:61], v[60:61], v[130:131] op_sel_hi:[1,0]
    v_pk_mul_f32 v[62:63], v[62:63], v[130:131] op_sel_hi:[1,0]
    v_pk_mul_f32 v[64:65], v[64:65], v[130:131] op_sel_hi:[1,0]
    v_pk_mul_f32 v[66:67], v[66:67], v[130:131] op_sel_hi:[1,0]
    v_pk_mul_f32 v[68:69], v[68:69], v[130:131] op_sel_hi:[1,0]
    v_pk_mul_f32 v[70:71], v[70:71], v[130:131] op_sel_hi:[1,0]
    v_pk_mul_f32 v[72:73], v[72:73], v[130:131] op_sel_hi:[1,0]
    v_pk_mul_f32 v[74:75], v[74:75], v[130:131] op_sel_hi:[1,0]
    v_cvt_pk_bf16_f32 v60, v60, v61
    v_cvt_pk_bf16_f32 v61, v62, v63
    v_cvt_pk_bf16_f32 v62, v64, v65
    v_cvt_pk_bf16_f32 v63, v66, v67
    v_cvt_pk_bf16_f32 v64, v68, v69
    v_cvt_pk_bf16_f32 v65, v70, v71
    v_cvt_pk_bf16_f32 v66, v72, v73
    v_cvt_pk_bf16_f32 v67, v74, v75
    buffer_store_dwordx4 v[60:63], v1, s[8:11], s24 offen offset:0 sc1
    buffer_store_dwordx4 v[64:67], v1, s[8:11], s24 offen offset:1024 sc1
M_id_out:
    buffer_store_dwordx4 v[108:111], v5, s[16:19], s30 offen offset:0 sc1
    buffer_store_dwordx4 v[112:115], v5, s[16:19], s30 offen offset:64 sc1
    buffer_store_dwordx4 v[116:119], v5, s[16:19], s33 offen offset:0 sc1
    buffer_store_dwordx4 v[120:123], v5, s[16:19], s33 offen offset:64 sc1
    s_cmp_eq_u32 s101, 1
    s_cbranch_scc1 M_end
    s_lshl_b32 s24, s89, 7
    s_lshl_b32 s25, s88, 2
    s_add_u32 s24, s24, s25
    s_add_u32 s24, s24, 167944192
    v_mov_b32 v8, 1
    s_waitcnt vmcnt(0)
    s_mov_b64 exec, 1
    buffer_store_dword v8, v1, s[8:11], s24 offen sc1
    s_mov_b64 exec, -1
M_noid:
    s_add_u32 s20, s82, 2
    s_mov_b32 s21, s83
    s_mov_b32 s22, s84
    s_mov_b32 s23, s85
    s_cmp_eq_u32 s101, 1
    s_cbranch_scc1 M_end
    s_mov_b32 s101, 1
    v_mbcnt_lo_u32_b32 v0, -1, 0
    v_mbcnt_hi_u32_b32 v0, -1, v0
    v_lshlrev_b32 v0, 4, v0
    s_waitcnt lgkmcnt(0)
    s_barrier
    s_branch M_bulk
M_ls_10:
    s_nop 7
    buffer_store_byte v11, v10, s[8:11], s62 offen sc1
    s_branch M_ls_10_r
M_ls_13:
    s_nop 7
    buffer_store_dwordx4 v[64:67], v4, s[8:11], s48 offen offset:0 sc1
    buffer_store_dwordx4 v[72:75], v4, s[8:11], s27 offen offset:0 sc1
    s_branch M_ls_13_r
M_ls_14:
    s_nop 7
    buffer_store_dwordx4 v[80:83], v4, s[8:11], s48 offen offset:64 sc1
    buffer_store_dwordx4 v[88:91], v4, s[8:11], s27 offen offset:64 sc1
    s_branch M_ls_14_r
M_ls_15:
    s_nop 7
    buffer_store_dwordx4 v[96:99], v4, s[8:11], s48 offen offset:128 sc1
    buffer_store_dwordx4 v[104:107], v4, s[8:11], s27 offen offset:128 sc1
    s_branch M_ls_15_r
M_ls_16:
    s_nop 7
    buffer_store_dwordx4 v[112:115], v4, s[8:11], s48 offen offset:192 sc1
    buffer_store_dwordx4 v[120:123], v4, s[8:11], s27 offen offset:192 sc1
    s_branch M_ls_16_r
M_ls_17:
    s_nop 7
    buffer_store_dwordx4 v[128:131], v4, s[8:11], s48 offen offset:256 sc1
    buffer_store_dwordx4 v[136:139], v4, s[8:11], s27 offen offset:256 sc1
    s_branch M_ls_17_r
M_ls_18:
    s_nop 7
    buffer_store_byte v11, v10, s[8:11], s62 offen sc1
    s_branch M_ls_18_r
M_ls_21:
    s_nop 7
    s_mov_b32 exec_hi, 0
    buffer_store_dwordx2 v[72:73], v12, s[8:11], s63 offen sc1
    s_mov_b32 exec_lo, 0x000f000f
    buffer_store_dwordx2 v[74:75], v12, s[8:11], s64 offen sc1
    s_mov_b64 exec, -1
    s_branch M_ls_21_r
M_ls_22:
    s_nop 7
    buffer_store_byte v11, v10, s[8:11], s62 offen sc1
    s_branch M_ls_22_r
M_ls_28:
    s_nop 7
    buffer_store_byte v191, v190, s[8:11], s28 offen sc1
    s_branch M_ls_28_r
M_ls_38:
    s_nop 7
    buffer_store_byte v191, v190, s[8:11], s28 offen sc1
    s_branch M_ls_38_r
M_ls_41:
    s_nop 7
    buffer_store_dwordx2 v[124:125], v7, s[8:11], s25 offen offset:0 sc1
    buffer_store_dwordx2 v[128:129], v7, s[8:11], s25 offen offset:2048 sc1
    s_branch M_ls_41_r
M_fail:
    s_mov_b64 exec, 1
    v_mov_b32 v12, 1
    v_mov_b32 v13, 48
    buffer_atomic_add v12, v13, s[12:15], 0 offen
M_end:
    s_endpgm

.section .rodata,"a"
.p2align 6
.amdhsa_kernel interleave_layers__memory_aug_recurrent_mem_tr__spectral_gfnet__prompt_kernel
  .amdhsa_next_free_vgpr 512
  .amdhsa_next_free_sgpr 102
  .amdhsa_accum_offset 256
  .amdhsa_group_segment_fixed_size 0
  .amdhsa_kernarg_size 104
  .amdhsa_user_sgpr_count 2
  .amdhsa_user_sgpr_kernarg_segment_ptr 1
  .amdhsa_system_sgpr_workgroup_id_x 1
  .amdhsa_float_denorm_mode_32 3
  .amdhsa_float_denorm_mode_16_64 3
.end_amdhsa_kernel
```

```asm
; @launch kernel=interleave_layers__memory_aug_recurrent_mem_tr__spectral_gfnet__prompt_kernel grid=(256,1,1) block=(256,1,1) lds=163840
.amdgcn_target "amdgcn-amd-amdhsa--gfx950"
.text
.globl interleave_layers__memory_aug_recurrent_mem_tr__spectral_gfnet__prompt_kernel
.p2align 8
.type interleave_layers__memory_aug_recurrent_mem_tr__spectral_gfnet__prompt_kernel,@function
interleave_layers__memory_aug_recurrent_mem_tr__spectral_gfnet__prompt_kernel:
    s_cmp_ge_u32 s2, 256
    s_cbranch_scc1 M_end
    s_load_dwordx2 s[16:17], s[0:1], 0
    s_load_dwordx2 s[8:9], s[0:1], 96
    s_load_dwordx2 s[12:13], s[0:1], 88
    s_load_dwordx2 s[72:73], s[0:1], 16
    s_load_dwordx2 s[76:77], s[0:1], 24
    s_load_dwordx2 s[80:81], s[0:1], 32
    s_load_dwordx2 s[84:85], s[0:1], 40
    s_load_dwordx2 s[68:69], s[0:1], 8
    s_getreg_b32 s24, hwreg(HW_REG_XCC_ID)
    s_and_b32 s24, s24, 7
    s_getpc_b64 s[26:27]
M_cpf:
    s_lshr_b32 s28, s2, 3
    s_lshl_b32 s28, s28, 8
    v_add_u32 v13, s28, v0
    v_lshlrev_b32 v13, 6, v13
    v_cmp_gt_u32 vcc, M_end - M_cpf, v13
    s_and_saveexec_b64 s[28:29], vcc
    s_cbranch_execz M_cpfd
    global_load_dword v14, v13, s[26:27]
M_cpfd:
    s_mov_b64 exec, s[28:29]
    v_lshrrev_b32 v12, 6, v0
    v_and_b32 v0, 63, v0
    v_readfirstlane_b32 s21, v12
    v_lshlrev_b32 v0, 4, v0
    s_waitcnt lgkmcnt(0)
    s_and_b32 s9, s9, 0xffff
    s_mov_b32 s10, 268435456
    s_mov_b32 s11, 0x00020000
    s_and_b32 s13, s13, 0xffff
    s_mov_b32 s14, 256
    s_mov_b32 s15, 0x00020000
    s_and_b32 s17, s17, 0xffff
    s_mov_b32 s18, 2621440
    s_mov_b32 s19, 0x00020000
    s_and_b32 s73, s73, 0xffff
    s_mov_b32 s74, 5242880
    s_mov_b32 s75, 0x00020000
    s_and_b32 s77, s77, 0xffff
    s_mov_b32 s78, 5242880
    s_mov_b32 s79, 0x00020000
    s_and_b32 s81, s81, 0xffff
    s_mov_b32 s82, 5242880
    s_mov_b32 s83, 0x00020000
    s_and_b32 s85, s85, 0xffff
    s_mov_b32 s86, 5242880
    s_mov_b32 s87, 0x00020000
    s_and_b32 s69, s69, 0xffff
    s_mov_b32 s70, 10240
    s_mov_b32 s71, 0x00020000
    s_mov_b32 s5, 0
    s_mov_b32 s101, 0
    s_cmp_eq_u32 s21, 0
    s_cbranch_scc1 M_tick
    s_cmp_eq_u32 s21, 3
    s_cbranch_scc1 M_zero
    v_mov_b32 v28, -1
    v_mov_b32 v29, -1
    v_mov_b32 v30, -1
    v_mov_b32 v31, -1
    s_lshl_b32 s26, s2, 1
    s_add_u32 s26, s26, s21
    s_lshl_b32 s26, s26, 12
    s_add_u32 s26, s26, 171962368
    buffer_store_dwordx4 v[28:31], v0, s[8:11], s26 offen offset:0 sc1
    buffer_store_dwordx4 v[28:31], v0, s[8:11], s26 offen offset:1024 sc1
    buffer_store_dwordx4 v[28:31], v0, s[8:11], s26 offen offset:2048 sc1
    buffer_store_dwordx4 v[28:31], v0, s[8:11], s26 offen offset:3072 sc1
    s_branch M_notick
M_zero:
    v_mov_b32 v28, 0
    v_mov_b32 v29, 0
    v_mov_b32 v30, 0
    v_mov_b32 v31, 0
    s_lshl_b32 s26, s2, 9
    s_add_u32 s26, s26, 167837696
    s_mov_b32 exec_hi, 0
    buffer_store_dwordx4 v[28:31], v0, s[8:11], s26 offen sc1
    s_mov_b64 exec, -1
    s_cmp_ge_u32 s2, 10
    s_cbranch_scc1 M_notick
    v_bfe_u32 v6, v0, 4, 3
    v_mul_u32_u24 v6, 1280, v6
    v_lshrrev_b32 v7, 8, v0
    v_lshl_add_u32 v6, v7, 5, v6
    v_bfe_u32 v7, v0, 7, 1
    v_lshl_add_u32 v6, v7, 2, v6
    s_lshl_b32 s26, s2, 7
    buffer_load_dword v32, v6, s[68:71], s26 offen offset:0
    buffer_load_dword v33, v6, s[68:71], s26 offen offset:8
    buffer_load_dword v34, v6, s[68:71], s26 offen offset:16
    buffer_load_dword v35, v6, s[68:71], s26 offen offset:24
    v_and_b32 v7, 0x200, v0
    v_bfe_u32 v12, v0, 6, 1
    v_lshl_or_b32 v7, v12, 8, v7
    v_bfe_u32 v12, v0, 4, 1
    v_lshl_or_b32 v7, v12, 7, v7
    v_bfe_u32 v12, v0, 5, 1
    v_lshl_or_b32 v7, v12, 6, v7
    v_bfe_u32 v12, v0, 8, 1
    v_lshl_or_b32 v7, v12, 5, v7
    v_bfe_u32 v12, v0, 7, 1
    v_lshl_or_b32 v7, v12, 4, v7
    s_lshl_b32 s26, s2, 10
    s_add_u32 s26, s26, 167772160
    s_waitcnt vmcnt(0)
    v_min_u32 v32, -2, v32
    v_min_u32 v33, -2, v33
    v_min_u32 v34, -2, v34
    v_min_u32 v35, -2, v35
    buffer_store_dwordx4 v[32:35], v7, s[8:11], s26 offen sc1
    s_branch M_notick
M_tick:
    s_and_b32 s25, s24, 5
    s_cmp_lg_u32 s25, 1
    s_cbranch_scc1 M_nocal
    s_bfe_u32 s25, s2, 0x20003
    s_lshl_b32 s26, s25, 13
    s_lshr_b32 s27, s2, 5
    s_lshl_b32 s27, s27, 15
    s_add_u32 s26, s26, s27
    s_lshl_b32 s27, s24, 8
    s_add_u32 s26, s26, s27
    s_add_u32 s26, s26, 171966464
    v_mov_b32 v28, -1
    v_mov_b32 v29, -1
    v_mov_b32 v30, -1
    v_mov_b32 v31, -1
    s_mov_b64 exec, 0xff
    s_mov_b32 s27, -1
    s_waitcnt vmcnt(0)
    s_memtime s[28:29]
    buffer_store_dwordx4 v[28:31], v0, s[8:11], s26 offen sc1
    s_waitcnt vmcnt(0)
    s_memtime s[30:31]
    s_waitcnt lgkmcnt(0)
    s_sub_u32 s28, s30, s28
    s_min_u32 s27, s27, s28
    s_memtime s[28:29]
    buffer_store_dwordx4 v[28:31], v0, s[8:11], s26 offen sc1
    s_waitcnt vmcnt(0)
    s_memtime s[30:31]
    s_waitcnt lgkmcnt(0)
    s_sub_u32 s28, s30, s28
    s_min_u32 s27, s27, s28
    s_memtime s[28:29]
    buffer_store_dwordx4 v[28:31], v0, s[8:11], s26 offen sc1
    s_waitcnt vmcnt(0)
    s_memtime s[30:31]
    s_waitcnt lgkmcnt(0)
    s_sub_u32 s28, s30, s28
    s_min_u32 s27, s27, s28
    s_memtime s[28:29]
    buffer_store_dwordx4 v[28:31], v0, s[8:11], s26 offen sc1
    s_waitcnt vmcnt(0)
    s_memtime s[30:31]
    s_waitcnt lgkmcnt(0)
    s_sub_u32 s28, s30, s28
    s_min_u32 s27, s27, s28
    s_mov_b64 exec, 1
    s_not_b32 s27, s27
    v_mov_b32 v28, s27
    s_lshl_b32 s25, s25, 2
    s_add_u32 s25, s25, 128
    v_mov_b32 v29, s25
    buffer_atomic_umax v28, v29, s[12:15], 0 offen
M_nocal:
    s_mov_b64 exec, 1
    v_mov_b32 v28, 1
    s_lshl_b32 s25, s24, 2
    v_mov_b32 v29, s25
    buffer_atomic_add v28, v29, s[12:15], 0 offen sc0
    s_waitcnt vmcnt(0)
    v_mov_b32 v29, 23296
    ds_write_b32 v29, v28
    s_waitcnt lgkmcnt(0)
    s_mov_b64 exec, -1
M_notick:
    s_waitcnt vmcnt(0)
    s_barrier
    s_cmp_lg_u32 s21, 0
    s_cbranch_scc1 M_noarr
    s_mov_b64 exec, 1
    v_mov_b32 v30, 1
    v_mov_b32 v29, 32
    buffer_atomic_add v30, v29, s[12:15], 0 offen
    s_mov_b64 exec, -1
M_noarr:
    v_mov_b32 v29, 23296
    ds_read_b32 v28, v29
    s_waitcnt lgkmcnt(0)
    v_readfirstlane_b32 s25, v28
    s_lshl_b32 s20, s24, 2
    s_lshr_b32 s20, 0x76524130, s20
    s_and_b32 s20, s20, 7
    s_and_b32 s22, s25, 31
    s_mov_b32 s23, 0
    s_mov_b32 s32, 0
    s_cmp_ge_u32 s20, 3
    s_cbranch_scc1 M_lw_done
M_loadw:
    s_barrier
    s_cmp_lt_u32 s20, 2
    s_cbranch_scc1 M_lw_chain
    s_cmp_lt_u32 s20, 4
    s_cbranch_scc1 M_lw_bulk
    s_lshl_b32 s34, s22, 2
    s_add_u32 s34, s34, s20
    s_sub_u32 s34, s34, 4
    s_mov_b32 s92, s33
    s_mov_b32 s33, s21
    v_lshrrev_b32 v1, 4, v0
    v_lshrrev_b32 v3, 8, v0
    v_and_b32 v4, 15, v1
    v_mov_b32 v5, v0
    v_mul_u32_u24 v6, 1280, v4
    v_lshl_add_u32 v6, v3, 4, v6
    s_mul_i32 s36, s34, 20480
    s_mul_i32 s35, s33, 320
    s_add_u32 s36, s36, s35
    buffer_load_dwordx4 v[8:11], v6, s[16:19], s36 offen offset:0
    buffer_load_dwordx4 v[12:15], v6, s[16:19], s36 offen offset:64
    buffer_load_dwordx4 v[16:19], v6, s[16:19], s36 offen offset:128
    buffer_load_dwordx4 v[20:23], v6, s[16:19], s36 offen offset:192
    buffer_load_dwordx4 v[24:27], v6, s[16:19], s36 offen offset:256
    s_waitcnt vmcnt(4)
    v_lshlrev_b32 v32, 16, v8
    v_and_b32 v33, 0xffff0000, v8
    v_lshlrev_b32 v34, 16, v9
    v_and_b32 v35, 0xffff0000, v9
    v_lshlrev_b32 v36, 16, v10
    v_and_b32 v37, 0xffff0000, v10
    v_lshlrev_b32 v38, 16, v11
    v_and_b32 v39, 0xffff0000, v11
    s_waitcnt vmcnt(3)
    v_lshlrev_b32 v40, 16, v12
    v_and_b32 v41, 0xffff0000, v12
    v_lshlrev_b32 v42, 16, v13
    v_and_b32 v43, 0xffff0000, v13
    v_lshlrev_b32 v44, 16, v14
    v_and_b32 v45, 0xffff0000, v14
    v_lshlrev_b32 v46, 16, v15
    v_and_b32 v47, 0xffff0000, v15
    s_waitcnt vmcnt(2)
    v_lshlrev_b32 v48, 16, v16
    v_and_b32 v49, 0xffff0000, v16
    v_lshlrev_b32 v50, 16, v17
    v_and_b32 v51, 0xffff0000, v17
    v_lshlrev_b32 v52, 16, v18
    v_and_b32 v53, 0xffff0000, v18
    v_lshlrev_b32 v54, 16, v19
    v_and_b32 v55, 0xffff0000, v19
    s_waitcnt vmcnt(1)
    v_lshlrev_b32 v56, 16, v20
    v_and_b32 v57, 0xffff0000, v20
    v_lshlrev_b32 v58, 16, v21
    v_and_b32 v59, 0xffff0000, v21
    v_lshlrev_b32 v60, 16, v22
    v_and_b32 v61, 0xffff0000, v22
    v_lshlrev_b32 v62, 16, v23
    v_and_b32 v63, 0xffff0000, v23
    s_waitcnt vmcnt(0)
    v_lshlrev_b32 v64, 16, v24
    v_and_b32 v65, 0xffff0000, v24
    v_lshlrev_b32 v66, 16, v25
    v_and_b32 v67, 0xffff0000, v25
    v_lshlrev_b32 v68, 16, v26
    v_and_b32 v69, 0xffff0000, v26
    v_lshlrev_b32 v70, 16, v27
    v_and_b32 v71, 0xffff0000, v27
    v_add_f32 v72, v32, v33
    v_add_f32 v72, v72, v34
    v_add_f32 v72, v72, v35
    v_add_f32 v72, v72, v36
    v_add_f32 v72, v72, v37
    v_add_f32 v72, v72, v38
    v_add_f32 v72, v72, v39
    v_add_f32 v72, v72, v40
    v_add_f32 v72, v72, v41
    v_add_f32 v72, v72, v42
    v_add_f32 v72, v72, v43
    v_add_f32 v72, v72, v44
    v_add_f32 v72, v72, v45
    v_add_f32 v72, v72, v46
    v_add_f32 v72, v72, v47
    v_add_f32 v72, v72, v48
    v_add_f32 v72, v72, v49
    v_add_f32 v72, v72, v50
    v_add_f32 v72, v72, v51
    v_add_f32 v72, v72, v52
    v_add_f32 v72, v72, v53
    v_add_f32 v72, v72, v54
    v_add_f32 v72, v72, v55
    v_add_f32 v72, v72, v56
    v_add_f32 v72, v72, v57
    v_add_f32 v72, v72, v58
    v_add_f32 v72, v72, v59
    v_add_f32 v72, v72, v60
    v_add_f32 v72, v72, v61
    v_add_f32 v72, v72, v62
    v_add_f32 v72, v72, v63
    v_add_f32 v72, v72, v64
    v_add_f32 v72, v72, v65
    v_add_f32 v72, v72, v66
    v_add_f32 v72, v72, v67
    v_add_f32 v72, v72, v68
    v_add_f32 v72, v72, v69
    v_add_f32 v72, v72, v70
    v_add_f32 v72, v72, v71
    v_lshlrev_b32 v77, 4, v4
    s_lshl_b32 s35, s33, 2
    v_add_u32 v76, s35, v77
    v_mov_b32 v73, v72
    s_nop 1
    v_permlane16_swap_b32 v72, v73
    v_add_f32 v72, v72, v73
    v_mov_b32 v73, v72
    s_nop 1
    v_permlane32_swap_b32 v72, v73
    v_add_f32 v72, v72, v73
    ds_write_b32 v76, v72 offset:0
    s_waitcnt lgkmcnt(0)
    s_barrier
    ds_read_b128 v[80:83], v77 offset:0
    s_waitcnt lgkmcnt(0)
    v_add_f32 v80, v80, v81
    v_add_f32 v82, v82, v83
    v_add_f32 v72, v80, v82
    v_mul_f32 v72, 0x3acccccd, v72
    v_sub_f32 v32, v32, v72
    v_sub_f32 v33, v33, v72
    v_sub_f32 v34, v34, v72
    v_sub_f32 v35, v35, v72
    v_sub_f32 v36, v36, v72
    v_sub_f32 v37, v37, v72
    v_sub_f32 v38, v38, v72
    v_sub_f32 v39, v39, v72
    v_sub_f32 v40, v40, v72
    v_sub_f32 v41, v41, v72
    v_sub_f32 v42, v42, v72
    v_sub_f32 v43, v43, v72
    v_sub_f32 v44, v44, v72
    v_sub_f32 v45, v45, v72
    v_sub_f32 v46, v46, v72
    v_sub_f32 v47, v47, v72
    v_sub_f32 v48, v48, v72
    v_sub_f32 v49, v49, v72
    v_sub_f32 v50, v50, v72
    v_sub_f32 v51, v51, v72
    v_sub_f32 v52, v52, v72
    v_sub_f32 v53, v53, v72
    v_sub_f32 v54, v54, v72
    v_sub_f32 v55, v55, v72
    v_sub_f32 v56, v56, v72
    v_sub_f32 v57, v57, v72
    v_sub_f32 v58, v58, v72
    v_sub_f32 v59, v59, v72
    v_sub_f32 v60, v60, v72
    v_sub_f32 v61, v61, v72
    v_sub_f32 v62, v62, v72
    v_sub_f32 v63, v63, v72
    v_sub_f32 v64, v64, v72
    v_sub_f32 v65, v65, v72
    v_sub_f32 v66, v66, v72
    v_sub_f32 v67, v67, v72
    v_sub_f32 v68, v68, v72
    v_sub_f32 v69, v69, v72
    v_sub_f32 v70, v70, v72
    v_sub_f32 v71, v71, v72
    v_mul_f32 v74, v32, v32
    v_fmac_f32 v74, v33, v33
    v_fmac_f32 v74, v34, v34
    v_fmac_f32 v74, v35, v35
    v_fmac_f32 v74, v36, v36
    v_fmac_f32 v74, v37, v37
    v_fmac_f32 v74, v38, v38
    v_fmac_f32 v74, v39, v39
    v_fmac_f32 v74, v40, v40
    v_fmac_f32 v74, v41, v41
    v_fmac_f32 v74, v42, v42
    v_fmac_f32 v74, v43, v43
    v_fmac_f32 v74, v44, v44
    v_fmac_f32 v74, v45, v45
    v_fmac_f32 v74, v46, v46
    v_fmac_f32 v74, v47, v47
    v_fmac_f32 v74, v48, v48
    v_fmac_f32 v74, v49, v49
    v_fmac_f32 v74, v50, v50
    v_fmac_f32 v74, v51, v51
    v_fmac_f32 v74, v52, v52
    v_fmac_f32 v74, v53, v53
    v_fmac_f32 v74, v54, v54
    v_fmac_f32 v74, v55, v55
    v_fmac_f32 v74, v56, v56
    v_fmac_f32 v74, v57, v57
    v_fmac_f32 v74, v58, v58
    v_fmac_f32 v74, v59, v59
    v_fmac_f32 v74, v60, v60
    v_fmac_f32 v74, v61, v61
    v_fmac_f32 v74, v62, v62
    v_fmac_f32 v74, v63, v63
    v_fmac_f32 v74, v64, v64
    v_fmac_f32 v74, v65, v65
    v_fmac_f32 v74, v66, v66
    v_fmac_f32 v74, v67, v67
    v_fmac_f32 v74, v68, v68
    v_fmac_f32 v74, v69, v69
    v_fmac_f32 v74, v70, v70
    v_fmac_f32 v74, v71, v71
    v_mov_b32 v73, v74
    s_nop 1
    v_permlane16_swap_b32 v74, v73
    v_add_f32 v74, v74, v73
    v_mov_b32 v73, v74
    s_nop 1
    v_permlane32_swap_b32 v74, v73
    v_add_f32 v74, v74, v73
    ds_write_b32 v76, v74 offset:512
    s_waitcnt lgkmcnt(0)
    s_barrier
    ds_read_b128 v[80:83], v77 offset:512
    s_waitcnt lgkmcnt(0)
    v_add_f32 v80, v80, v81
    v_add_f32 v82, v82, v83
    v_add_f32 v74, v80, v82
    v_mov_b32 v75, 0x3727c5ac
    v_fmac_f32 v75, 0x3acccccd, v74
    v_rsq_f32 v75, v75
    s_nop 0
    v_mul_f32 v32, v32, v75
    v_mul_f32 v33, v33, v75
    v_mul_f32 v34, v34, v75
    v_mul_f32 v35, v35, v75
    v_mul_f32 v36, v36, v75
    v_mul_f32 v37, v37, v75
    v_mul_f32 v38, v38, v75
    v_mul_f32 v39, v39, v75
    v_mul_f32 v40, v40, v75
    v_mul_f32 v41, v41, v75
    v_mul_f32 v42, v42, v75
    v_mul_f32 v43, v43, v75
    v_mul_f32 v44, v44, v75
    v_mul_f32 v45, v45, v75
    v_mul_f32 v46, v46, v75
    v_mul_f32 v47, v47, v75
    v_mul_f32 v48, v48, v75
    v_mul_f32 v49, v49, v75
    v_mul_f32 v50, v50, v75
    v_mul_f32 v51, v51, v75
    v_mul_f32 v52, v52, v75
    v_mul_f32 v53, v53, v75
    v_mul_f32 v54, v54, v75
    v_mul_f32 v55, v55, v75
    v_mul_f32 v56, v56, v75
    v_mul_f32 v57, v57, v75
    v_mul_f32 v58, v58, v75
    v_mul_f32 v59, v59, v75
    v_mul_f32 v60, v60, v75
    v_mul_f32 v61, v61, v75
    v_mul_f32 v62, v62, v75
    v_mul_f32 v63, v63, v75
    v_mul_f32 v64, v64, v75
    v_mul_f32 v65, v65, v75
    v_mul_f32 v66, v66, v75
    v_mul_f32 v67, v67, v75
    v_mul_f32 v68, v68, v75
    v_mul_f32 v69, v69, v75
    v_mul_f32 v70, v70, v75
    v_mul_f32 v71, v71, v75
    v_cvt_pk_bf16_f32 v8, v32, v33
    v_cvt_pk_bf16_f32 v9, v34, v35
    v_cvt_pk_bf16_f32 v10, v36, v37
    v_cvt_pk_bf16_f32 v11, v38, v39
    v_cvt_pk_bf16_f32 v12, v40, v41
    v_cvt_pk_bf16_f32 v13, v42, v43
    v_cvt_pk_bf16_f32 v14, v44, v45
    v_cvt_pk_bf16_f32 v15, v46, v47
    v_cvt_pk_bf16_f32 v16, v48, v49
    v_cvt_pk_bf16_f32 v17, v50, v51
    v_cvt_pk_bf16_f32 v18, v52, v53
    v_cvt_pk_bf16_f32 v19, v54, v55
    v_cvt_pk_bf16_f32 v20, v56, v57
    v_cvt_pk_bf16_f32 v21, v58, v59
    v_cvt_pk_bf16_f32 v22, v60, v61
    v_cvt_pk_bf16_f32 v23, v62, v63
    v_cvt_pk_bf16_f32 v24, v64, v65
    v_cvt_pk_bf16_f32 v25, v66, v67
    v_cvt_pk_bf16_f32 v26, v68, v69
    v_cvt_pk_bf16_f32 v27, v70, v71
    s_mul_i32 s36, s34, 20480
    s_mul_i32 s35, s33, 5120
    s_add_u32 s36, s36, s35
    s_add_u32 s36, s36, 29360128
    s_add_u32 s35, s36, 4096
    buffer_store_dwordx4 v[8:11], v5, s[8:11], s36 offen offset:0 sc1
    buffer_store_dwordx4 v[12:15], v5, s[8:11], s36 offen offset:1024 sc1
    buffer_store_dwordx4 v[16:19], v5, s[8:11], s36 offen offset:2048 sc1
    buffer_store_dwordx4 v[20:23], v5, s[8:11], s36 offen offset:3072 sc1
    buffer_store_dwordx4 v[24:27], v5, s[8:11], s35 offen offset:0 sc1
    s_mov_b32 s33, s92
    s_waitcnt vmcnt(0)
    s_barrier
    s_cmp_lg_u32 s21, 0
    s_cbranch_scc1 M_lw_bulk
    s_lshr_b32 s27, s34, 1
    s_lshl_b32 s27, s27, 7
    s_and_b32 s28, s34, 1
    s_mul_i32 s28, s28, 20
    s_add_u32 s27, s27, s28
    s_add_u32 s27, s27, 167911424
    v_lshrrev_b32 v12, 2, v0
    v_mov_b32 v13, 1
    s_mov_b64 exec, 31
    buffer_store_dword v13, v12, s[8:11], s27 offen sc1
    s_mov_b64 exec, -1
M_lw_bulk:
    v_lshrrev_b32 v12, 8, v0
    v_lshlrev_b32 v12, 16, v12
    v_and_b32 v14, 0xf0, v0
    v_add_u32 v12, v12, v14
    s_lshl_b32 s46, s22, 8
    s_lshl_b32 s27, s21, 13
    v_add_u32 v4, s27, v0
    v_add_u32 v5, 32768, v4
    s_cmp_eq_u32 s20, 2
    s_cbranch_scc1 M_bl_kv
    s_mul_i32 s27, s21, 40960
    v_add_u32 v7, s27, v0
    v_lshrrev_b32 v8, 8, v0
    v_mul_u32_u24 v8, 40960, v8
    s_lshl_b32 s47, s22, 6
    s_add_u32 s47, s47, s21
    s_mul_i32 s47, s47, 2560
    v_and_b32 v14, 0xf0, v0
    v_add_u32 v8, v8, v14
    s_mov_b32 s44, 0x05040100
    s_mov_b32 s45, 0x07060302
    s_add_u32 s27, s47, 0
    buffer_load_dwordx4 v[16:19], v8, s[84:87], s27 offen
    s_add_u32 s27, s47, 1280
    buffer_load_dwordx4 v[20:23], v8, s[84:87], s27 offen
    s_add_u32 s27, s47, 10240
    buffer_load_dwordx4 v[24:27], v8, s[84:87], s27 offen
    s_add_u32 s27, s47, 11520
    buffer_load_dwordx4 v[28:31], v8, s[84:87], s27 offen
    s_add_u32 s27, s47, 20480
    buffer_load_dwordx4 v[32:35], v8, s[84:87], s27 offen
    s_add_u32 s27, s47, 21760
    buffer_load_dwordx4 v[36:39], v8, s[84:87], s27 offen
    s_add_u32 s27, s47, 30720
    buffer_load_dwordx4 v[40:43], v8, s[84:87], s27 offen
    s_add_u32 s27, s47, 32000
    buffer_load_dwordx4 v[44:47], v8, s[84:87], s27 offen
    s_add_u32 s27, s47, 256
    buffer_load_dwordx4 v[48:51], v8, s[84:87], s27 offen
    s_add_u32 s27, s47, 1536
    buffer_load_dwordx4 v[52:55], v8, s[84:87], s27 offen
    s_add_u32 s27, s47, 10496
    buffer_load_dwordx4 v[56:59], v8, s[84:87], s27 offen
    s_add_u32 s27, s47, 11776
    buffer_load_dwordx4 v[60:63], v8, s[84:87], s27 offen
    s_add_u32 s27, s47, 20736
    buffer_load_dwordx4 v[64:67], v8, s[84:87], s27 offen
    s_add_u32 s27, s47, 22016
    buffer_load_dwordx4 v[68:71], v8, s[84:87], s27 offen
    s_add_u32 s27, s47, 30976
    buffer_load_dwordx4 v[72:75], v8, s[84:87], s27 offen
    s_add_u32 s27, s47, 32256
    buffer_load_dwordx4 v[76:79], v8, s[84:87], s27 offen
    v_and_b32 v13, 0x300, v0
    s_lshl_b32 s27, s21, 10
    s_add_u32 s27, s27, 0
    v_add_u32 v13, s27, v13
    v_bfe_u32 v14, v0, 6, 2
    v_lshl_add_u32 v13, v14, 13, v13
    v_bfe_u32 v14, v0, 4, 2
    v_lshl_add_u32 v13, v14, 6, v13
    s_waitcnt vmcnt(14)
    v_perm_b32 v80, v20, v16, s44
    s_waitcnt vmcnt(12)
    v_perm_b32 v81, v28, v24, s44
    s_waitcnt vmcnt(10)
    v_perm_b32 v82, v36, v32, s44
    s_waitcnt vmcnt(8)
    v_perm_b32 v83, v44, v40, s44
    ds_write_b128 v13, v[80:83] offset:0
    v_perm_b32 v84, v20, v16, s45
    v_perm_b32 v85, v28, v24, s45
    v_perm_b32 v86, v36, v32, s45
    v_perm_b32 v87, v44, v40, s45
    ds_write_b128 v13, v[84:87] offset:16
    v_perm_b32 v80, v21, v17, s44
    v_perm_b32 v81, v29, v25, s44
    v_perm_b32 v82, v37, v33, s44
    v_perm_b32 v83, v45, v41, s44
    ds_write_b128 v13, v[80:83] offset:32
    v_perm_b32 v84, v21, v17, s45
    v_perm_b32 v85, v29, v25, s45
    v_perm_b32 v86, v37, v33, s45
    v_perm_b32 v87, v45, v41, s45
    ds_write_b128 v13, v[84:87] offset:48
    v_perm_b32 v80, v22, v18, s44
    v_perm_b32 v81, v30, v26, s44
    v_perm_b32 v82, v38, v34, s44
    v_perm_b32 v83, v46, v42, s44
    ds_write_b128 v13, v[80:83] offset:4096
    v_perm_b32 v84, v22, v18, s45
    v_perm_b32 v85, v30, v26, s45
    v_perm_b32 v86, v38, v34, s45
    v_perm_b32 v87, v46, v42, s45
    ds_write_b128 v13, v[84:87] offset:4112
    v_perm_b32 v80, v23, v19, s44
    v_perm_b32 v81, v31, v27, s44
    v_perm_b32 v82, v39, v35, s44
    v_perm_b32 v83, v47, v43, s44
    ds_write_b128 v13, v[80:83] offset:4128
    v_perm_b32 v84, v23, v19, s45
    v_perm_b32 v85, v31, v27, s45
    v_perm_b32 v86, v39, v35, s45
    v_perm_b32 v87, v47, v43, s45
    ds_write_b128 v13, v[84:87] offset:4144
    s_add_u32 s27, s47, 512
    buffer_load_dwordx4 v[16:19], v8, s[84:87], s27 offen
    s_add_u32 s27, s47, 1792
    buffer_load_dwordx4 v[20:23], v8, s[84:87], s27 offen
    s_add_u32 s27, s47, 10752
    buffer_load_dwordx4 v[24:27], v8, s[84:87], s27 offen
    s_add_u32 s27, s47, 12032
    buffer_load_dwordx4 v[28:31], v8, s[84:87], s27 offen
    s_add_u32 s27, s47, 20992
    buffer_load_dwordx4 v[32:35], v8, s[84:87], s27 offen
    s_add_u32 s27, s47, 22272
    buffer_load_dwordx4 v[36:39], v8, s[84:87], s27 offen
    s_add_u32 s27, s47, 31232
    buffer_load_dwordx4 v[40:43], v8, s[84:87], s27 offen
    s_add_u32 s27, s47, 32512
    buffer_load_dwordx4 v[44:47], v8, s[84:87], s27 offen
    v_and_b32 v13, 0x300, v0
    s_lshl_b32 s27, s21, 10
    s_add_u32 s27, s27, 32768
    v_add_u32 v13, s27, v13
    v_bfe_u32 v14, v0, 6, 2
    v_lshl_add_u32 v13, v14, 13, v13
    v_bfe_u32 v14, v0, 4, 2
    v_lshl_add_u32 v13, v14, 6, v13
    s_waitcnt vmcnt(14)
    v_perm_b32 v80, v52, v48, s44
    s_waitcnt vmcnt(12)
    v_perm_b32 v81, v60, v56, s44
    s_waitcnt vmcnt(10)
    v_perm_b32 v82, v68, v64, s44
    s_waitcnt vmcnt(8)
    v_perm_b32 v83, v76, v72, s44
    ds_write_b128 v13, v[80:83] offset:0
    v_perm_b32 v84, v52, v48, s45
    v_perm_b32 v85, v60, v56, s45
    v_perm_b32 v86, v68, v64, s45
    v_perm_b32 v87, v76, v72, s45
    ds_write_b128 v13, v[84:87] offset:16
    v_perm_b32 v80, v53, v49, s44
    v_perm_b32 v81, v61, v57, s44
    v_perm_b32 v82, v69, v65, s44
    v_perm_b32 v83, v77, v73, s44
    ds_write_b128 v13, v[80:83] offset:32
    v_perm_b32 v84, v53, v49, s45
    v_perm_b32 v85, v61, v57, s45
    v_perm_b32 v86, v69, v65, s45
    v_perm_b32 v87, v77, v73, s45
    ds_write_b128 v13, v[84:87] offset:48
    v_perm_b32 v80, v54, v50, s44
    v_perm_b32 v81, v62, v58, s44
    v_perm_b32 v82, v70, v66, s44
    v_perm_b32 v83, v78, v74, s44
    ds_write_b128 v13, v[80:83] offset:4096
    v_perm_b32 v84, v54, v50, s45
    v_perm_b32 v85, v62, v58, s45
    v_perm_b32 v86, v70, v66, s45
    v_perm_b32 v87, v78, v74, s45
    ds_write_b128 v13, v[84:87] offset:4112
    v_perm_b32 v80, v55, v51, s44
    v_perm_b32 v81, v63, v59, s44
    v_perm_b32 v82, v71, v67, s44
    v_perm_b32 v83, v79, v75, s44
    ds_write_b128 v13, v[80:83] offset:4128
    v_perm_b32 v84, v55, v51, s45
    v_perm_b32 v85, v63, v59, s45
    v_perm_b32 v86, v71, v67, s45
    v_perm_b32 v87, v79, v75, s45
    ds_write_b128 v13, v[84:87] offset:4144
    s_add_u32 s27, s47, 768
    buffer_load_dwordx4 v[48:51], v8, s[84:87], s27 offen
    s_add_u32 s27, s47, 2048
    buffer_load_dwordx4 v[52:55], v8, s[84:87], s27 offen
    s_add_u32 s27, s47, 11008
    buffer_load_dwordx4 v[56:59], v8, s[84:87], s27 offen
    s_add_u32 s27, s47, 12288
    buffer_load_dwordx4 v[60:63], v8, s[84:87], s27 offen
    s_add_u32 s27, s47, 21248
    buffer_load_dwordx4 v[64:67], v8, s[84:87], s27 offen
    s_add_u32 s27, s47, 22528
    buffer_load_dwordx4 v[68:71], v8, s[84:87], s27 offen
    s_add_u32 s27, s47, 31488
    buffer_load_dwordx4 v[72:75], v8, s[84:87], s27 offen
    s_add_u32 s27, s47, 32768
    buffer_load_dwordx4 v[76:79], v8, s[84:87], s27 offen
    v_and_b32 v13, 0x300, v0
    s_lshl_b32 s27, s21, 10
    s_add_u32 s27, s27, 65536
    v_add_u32 v13, s27, v13
    v_bfe_u32 v14, v0, 6, 2
    v_lshl_add_u32 v13, v14, 13, v13
    v_bfe_u32 v14, v0, 4, 2
    v_lshl_add_u32 v13, v14, 6, v13
    s_waitcnt vmcnt(14)
    v_perm_b32 v80, v20, v16, s44
    s_waitcnt vmcnt(12)
    v_perm_b32 v81, v28, v24, s44
    s_waitcnt vmcnt(10)
    v_perm_b32 v82, v36, v32, s44
    s_waitcnt vmcnt(8)
    v_perm_b32 v83, v44, v40, s44
    ds_write_b128 v13, v[80:83] offset:0
    v_perm_b32 v84, v20, v16, s45
    v_perm_b32 v85, v28, v24, s45
    v_perm_b32 v86, v36, v32, s45
    v_perm_b32 v87, v44, v40, s45
    ds_write_b128 v13, v[84:87] offset:16
    v_perm_b32 v80, v21, v17, s44
    v_perm_b32 v81, v29, v25, s44
    v_perm_b32 v82, v37, v33, s44
    v_perm_b32 v83, v45, v41, s44
    ds_write_b128 v13, v[80:83] offset:32
    v_perm_b32 v84, v21, v17, s45
    v_perm_b32 v85, v29, v25, s45
    v_perm_b32 v86, v37, v33, s45
    v_perm_b32 v87, v45, v41, s45
    ds_write_b128 v13, v[84:87] offset:48
    v_perm_b32 v80, v22, v18, s44
    v_perm_b32 v81, v30, v26, s44
    v_perm_b32 v82, v38, v34, s44
    v_perm_b32 v83, v46, v42, s44
    ds_write_b128 v13, v[80:83] offset:4096
    v_perm_b32 v84, v22, v18, s45
    v_perm_b32 v85, v30, v26, s45
    v_perm_b32 v86, v38, v34, s45
    v_perm_b32 v87, v46, v42, s45
    ds_write_b128 v13, v[84:87] offset:4112
    v_perm_b32 v80, v23, v19, s44
    v_perm_b32 v81, v31, v27, s44
    v_perm_b32 v82, v39, v35, s44
    v_perm_b32 v83, v47, v43, s44
    ds_write_b128 v13, v[80:83] offset:4128
    v_perm_b32 v84, v23, v19, s45
    v_perm_b32 v85, v31, v27, s45
    v_perm_b32 v86, v39, v35, s45
    v_perm_b32 v87, v47, v43, s45
    ds_write_b128 v13, v[84:87] offset:4144
    s_add_u32 s27, s47, 1024
    buffer_load_dwordx4 v[16:19], v8, s[84:87], s27 offen
    s_add_u32 s27, s47, 2304
    buffer_load_dwordx4 v[20:23], v8, s[84:87], s27 offen
    s_add_u32 s27, s47, 11264
    buffer_load_dwordx4 v[24:27], v8, s[84:87], s27 offen
    s_add_u32 s27, s47, 12544
    buffer_load_dwordx4 v[28:31], v8, s[84:87], s27 offen
    s_add_u32 s27, s47, 21504
    buffer_load_dwordx4 v[32:35], v8, s[84:87], s27 offen
    s_add_u32 s27, s47, 22784
    buffer_load_dwordx4 v[36:39], v8, s[84:87], s27 offen
    s_add_u32 s27, s47, 31744
    buffer_load_dwordx4 v[40:43], v8, s[84:87], s27 offen
    s_add_u32 s27, s47, 33024
    buffer_load_dwordx4 v[44:47], v8, s[84:87], s27 offen
    v_and_b32 v13, 0x300, v0
    s_lshl_b32 s27, s21, 10
    s_add_u32 s27, s27, 98304
    v_add_u32 v13, s27, v13
    v_bfe_u32 v14, v0, 6, 2
    v_lshl_add_u32 v13, v14, 13, v13
    v_bfe_u32 v14, v0, 4, 2
    v_lshl_add_u32 v13, v14, 6, v13
    s_waitcnt vmcnt(14)
    v_perm_b32 v80, v52, v48, s44
    s_waitcnt vmcnt(12)
    v_perm_b32 v81, v60, v56, s44
    s_waitcnt vmcnt(10)
    v_perm_b32 v82, v68, v64, s44
    s_waitcnt vmcnt(8)
    v_perm_b32 v83, v76, v72, s44
    ds_write_b128 v13, v[80:83] offset:0
    v_perm_b32 v84, v52, v48, s45
    v_perm_b32 v85, v60, v56, s45
    v_perm_b32 v86, v68, v64, s45
    v_perm_b32 v87, v76, v72, s45
    ds_write_b128 v13, v[84:87] offset:16
    v_perm_b32 v80, v53, v49, s44
    v_perm_b32 v81, v61, v57, s44
    v_perm_b32 v82, v69, v65, s44
    v_perm_b32 v83, v77, v73, s44
    ds_write_b128 v13, v[80:83] offset:32
    v_perm_b32 v84, v53, v49, s45
    v_perm_b32 v85, v61, v57, s45
    v_perm_b32 v86, v69, v65, s45
    v_perm_b32 v87, v77, v73, s45
    ds_write_b128 v13, v[84:87] offset:48
    v_perm_b32 v80, v54, v50, s44
    v_perm_b32 v81, v62, v58, s44
    v_perm_b32 v82, v70, v66, s44
    v_perm_b32 v83, v78, v74, s44
    ds_write_b128 v13, v[80:83] offset:4096
    v_perm_b32 v84, v54, v50, s45
    v_perm_b32 v85, v62, v58, s45
    v_perm_b32 v86, v70, v66, s45
    v_perm_b32 v87, v78, v74, s45
    ds_write_b128 v13, v[84:87] offset:4112
    v_perm_b32 v80, v55, v51, s44
    v_perm_b32 v81, v63, v59, s44
    v_perm_b32 v82, v71, v67, s44
    v_perm_b32 v83, v79, v75, s44
    ds_write_b128 v13, v[80:83] offset:4128
    v_perm_b32 v84, v55, v51, s45
    v_perm_b32 v85, v63, v59, s45
    v_perm_b32 v86, v71, v67, s45
    v_perm_b32 v87, v79, v75, s45
    ds_write_b128 v13, v[84:87] offset:4144
    v_and_b32 v13, 0x300, v0
    s_lshl_b32 s27, s21, 10
    s_add_u32 s27, s27, 131072
    v_add_u32 v13, s27, v13
    v_bfe_u32 v14, v0, 6, 2
    v_lshl_add_u32 v13, v14, 13, v13
    v_bfe_u32 v14, v0, 4, 2
    v_lshl_add_u32 v13, v14, 6, v13
    s_waitcnt vmcnt(6)
    v_perm_b32 v80, v20, v16, s44
    s_waitcnt vmcnt(4)
    v_perm_b32 v81, v28, v24, s44
    s_waitcnt vmcnt(2)
    v_perm_b32 v82, v36, v32, s44
    s_waitcnt vmcnt(0)
    v_perm_b32 v83, v44, v40, s44
    ds_write_b128 v13, v[80:83] offset:0
    v_perm_b32 v84, v20, v16, s45
    v_perm_b32 v85, v28, v24, s45
    v_perm_b32 v86, v36, v32, s45
    v_perm_b32 v87, v44, v40, s45
    ds_write_b128 v13, v[84:87] offset:16
    v_perm_b32 v80, v21, v17, s44
    v_perm_b32 v81, v29, v25, s44
    v_perm_b32 v82, v37, v33, s44
    v_perm_b32 v83, v45, v41, s44
    ds_write_b128 v13, v[80:83] offset:32
    v_perm_b32 v84, v21, v17, s45
    v_perm_b32 v85, v29, v25, s45
    v_perm_b32 v86, v37, v33, s45
    v_perm_b32 v87, v45, v41, s45
    ds_write_b128 v13, v[84:87] offset:48
    v_perm_b32 v80, v22, v18, s44
    v_perm_b32 v81, v30, v26, s44
    v_perm_b32 v82, v38, v34, s44
    v_perm_b32 v83, v46, v42, s44
    ds_write_b128 v13, v[80:83] offset:4096
    v_perm_b32 v84, v22, v18, s45
    v_perm_b32 v85, v30, v26, s45
    v_perm_b32 v86, v38, v34, s45
    v_perm_b32 v87, v46, v42, s45
    ds_write_b128 v13, v[84:87] offset:4112
    v_perm_b32 v80, v23, v19, s44
    v_perm_b32 v81, v31, v27, s44
    v_perm_b32 v82, v39, v35, s44
    v_perm_b32 v83, v47, v43, s44
    ds_write_b128 v13, v[80:83] offset:4128
    v_perm_b32 v84, v23, v19, s45
    v_perm_b32 v85, v31, v27, s45
    v_perm_b32 v86, v39, v35, s45
    v_perm_b32 v87, v47, v43, s45
    ds_write_b128 v13, v[84:87] offset:4144
    s_waitcnt lgkmcnt(0)
    s_barrier
    ds_read_b128 a[160:163], v7 offset:0
    ds_read_b128 a[164:167], v7 offset:1024
    ds_read_b128 a[168:171], v7 offset:2048
    ds_read_b128 a[172:175], v7 offset:3072
    ds_read_b128 a[176:179], v7 offset:4096
    ds_read_b128 a[180:183], v7 offset:5120
    ds_read_b128 a[184:187], v7 offset:6144
    ds_read_b128 a[188:191], v7 offset:7168
    ds_read_b128 a[192:195], v7 offset:8192
    ds_read_b128 a[196:199], v7 offset:9216
    ds_read_b128 a[200:203], v7 offset:10240
    ds_read_b128 a[204:207], v7 offset:11264
    ds_read_b128 a[208:211], v7 offset:12288
    ds_read_b128 a[212:215], v7 offset:13312
    ds_read_b128 a[216:219], v7 offset:14336
    ds_read_b128 a[220:223], v7 offset:15360
    ds_read_b128 a[224:227], v7 offset:16384
    ds_read_b128 a[228:231], v7 offset:17408
    ds_read_b128 a[232:235], v7 offset:18432
    ds_read_b128 a[236:239], v7 offset:19456
    ds_read_b128 a[240:243], v7 offset:20480
    ds_read_b128 a[244:247], v7 offset:21504
    ds_read_b128 a[248:251], v7 offset:22528
    ds_read_b128 a[252:255], v7 offset:23552
    ds_read_b128 v[192:195], v7 offset:24576
    ds_read_b128 v[196:199], v7 offset:25600
    ds_read_b128 v[200:203], v7 offset:26624
    ds_read_b128 v[204:207], v7 offset:27648
    ds_read_b128 v[208:211], v7 offset:28672
    ds_read_b128 v[212:215], v7 offset:29696
    ds_read_b128 v[216:219], v7 offset:30720
    ds_read_b128 v[220:223], v7 offset:31744
    ds_read_b128 v[224:227], v7 offset:32768
    ds_read_b128 v[228:231], v7 offset:33792
    ds_read_b128 v[232:235], v7 offset:34816
    ds_read_b128 v[236:239], v7 offset:35840
    ds_read_b128 v[240:243], v7 offset:36864
    ds_read_b128 v[244:247], v7 offset:37888
    ds_read_b128 v[248:251], v7 offset:38912
    ds_read_b128 v[252:255], v7 offset:39936
    s_waitcnt lgkmcnt(0)
    s_barrier
    s_mov_b32 s44, 0x05040100
    s_mov_b32 s45, 0x07060302
    s_add_u32 s26, s21, 0
    s_lshl_b32 s27, s26, 18
    s_add_u32 s27, s27, s46
    buffer_load_dwordx4 v[16:19], v12, s[72:75], s27 offen
    s_add_u32 s27, s27, 8192
    buffer_load_dwordx4 v[20:23], v12, s[72:75], s27 offen
    s_add_u32 s27, s27, 8192
    buffer_load_dwordx4 v[24:27], v12, s[72:75], s27 offen
    s_add_u32 s27, s27, 8192
    buffer_load_dwordx4 v[28:31], v12, s[72:75], s27 offen
    s_add_u32 s27, s27, 8192
    buffer_load_dwordx4 v[32:35], v12, s[72:75], s27 offen
    s_add_u32 s27, s27, 8192
    buffer_load_dwordx4 v[36:39], v12, s[72:75], s27 offen
    s_add_u32 s27, s27, 8192
    buffer_load_dwordx4 v[40:43], v12, s[72:75], s27 offen
    s_add_u32 s27, s27, 8192
    buffer_load_dwordx4 v[44:47], v12, s[72:75], s27 offen
    s_add_u32 s26, s21, 4
    s_lshl_b32 s27, s26, 18
    s_add_u32 s27, s27, s46
    buffer_load_dwordx4 v[48:51], v12, s[72:75], s27 offen
    s_add_u32 s27, s27, 8192
    buffer_load_dwordx4 v[52:55], v12, s[72:75], s27 offen
    s_add_u32 s27, s27, 8192
    buffer_load_dwordx4 v[56:59], v12, s[72:75], s27 offen
    s_add_u32 s27, s27, 8192
    buffer_load_dwordx4 v[60:63], v12, s[72:75], s27 offen
    s_add_u32 s27, s27, 8192
    buffer_load_dwordx4 v[64:67], v12, s[72:75], s27 offen
    s_add_u32 s27, s27, 8192
    buffer_load_dwordx4 v[68:71], v12, s[72:75], s27 offen
    s_add_u32 s27, s27, 8192
    buffer_load_dwordx4 v[72:75], v12, s[72:75], s27 offen
    s_add_u32 s27, s27, 8192
    buffer_load_dwordx4 v[76:79], v12, s[72:75], s27 offen
    s_lshl_b32 s27, s21, 11
    s_add_u32 s27, s27, 0
    v_add_u32 v13, s27, v0
    s_waitcnt vmcnt(14)
    v_perm_b32 v80, v20, v16, s44
    s_waitcnt vmcnt(12)
    v_perm_b32 v81, v28, v24, s44
    s_waitcnt vmcnt(10)
    v_perm_b32 v82, v36, v32, s44
    s_waitcnt vmcnt(8)
    v_perm_b32 v83, v44, v40, s44
    ds_write_b128 v13, v[80:83] offset:0
    v_perm_b32 v84, v20, v16, s45
    v_perm_b32 v85, v28, v24, s45
    v_perm_b32 v86, v36, v32, s45
    v_perm_b32 v87, v44, v40, s45
    ds_write_b128 v13, v[84:87] offset:1024
    v_perm_b32 v80, v21, v17, s44
    v_perm_b32 v81, v29, v25, s44
    v_perm_b32 v82, v37, v33, s44
    v_perm_b32 v83, v45, v41, s44
    ds_write_b128 v13, v[80:83] offset:8192
    v_perm_b32 v84, v21, v17, s45
    v_perm_b32 v85, v29, v25, s45
    v_perm_b32 v86, v37, v33, s45
    v_perm_b32 v87, v45, v41, s45
    ds_write_b128 v13, v[84:87] offset:9216
    v_perm_b32 v80, v22, v18, s44
    v_perm_b32 v81, v30, v26, s44
    v_perm_b32 v82, v38, v34, s44
    v_perm_b32 v83, v46, v42, s44
    ds_write_b128 v13, v[80:83] offset:16384
    v_perm_b32 v84, v22, v18, s45
    v_perm_b32 v85, v30, v26, s45
    v_perm_b32 v86, v38, v34, s45
    v_perm_b32 v87, v46, v42, s45
    ds_write_b128 v13, v[84:87] offset:17408
    v_perm_b32 v80, v23, v19, s44
    v_perm_b32 v81, v31, v27, s44
    v_perm_b32 v82, v39, v35, s44
    v_perm_b32 v83, v47, v43, s44
    ds_write_b128 v13, v[80:83] offset:24576
    v_perm_b32 v84, v23, v19, s45
    v_perm_b32 v85, v31, v27, s45
    v_perm_b32 v86, v39, v35, s45
    v_perm_b32 v87, v47, v43, s45
    ds_write_b128 v13, v[84:87] offset:25600
    s_add_u32 s26, s21, 8
    s_lshl_b32 s27, s26, 18
    s_add_u32 s27, s27, s46
    buffer_load_dwordx4 v[16:19], v12, s[72:75], s27 offen
    s_add_u32 s27, s27, 8192
    buffer_load_dwordx4 v[20:23], v12, s[72:75], s27 offen
    s_add_u32 s27, s27, 8192
    buffer_load_dwordx4 v[24:27], v12, s[72:75], s27 offen
    s_add_u32 s27, s27, 8192
    buffer_load_dwordx4 v[28:31], v12, s[72:75], s27 offen
    s_add_u32 s27, s27, 8192
    buffer_load_dwordx4 v[32:35], v12, s[72:75], s27 offen
    s_add_u32 s27, s27, 8192
    buffer_load_dwordx4 v[36:39], v12, s[72:75], s27 offen
    s_add_u32 s27, s27, 8192
    buffer_load_dwordx4 v[40:43], v12, s[72:75], s27 offen
    s_add_u32 s27, s27, 8192
    buffer_load_dwordx4 v[44:47], v12, s[72:75], s27 offen
    s_waitcnt lgkmcnt(0)
    s_barrier
    ds_read_b128 a[0:3], v4 offset:0
    ds_read_b128 a[80:83], v4 offset:1024
    ds_read_b128 a[4:7], v4 offset:2048
    ds_read_b128 a[84:87], v4 offset:3072
    ds_read_b128 a[8:11], v4 offset:4096
    ds_read_b128 a[88:91], v4 offset:5120
    ds_read_b128 a[12:15], v4 offset:6144
    ds_read_b128 a[92:95], v4 offset:7168
    s_lshl_b32 s27, s21, 11
    s_add_u32 s27, s27, 32768
    v_add_u32 v13, s27, v0
    s_waitcnt vmcnt(14)
    v_perm_b32 v80, v52, v48, s44
    s_waitcnt vmcnt(12)
    v_perm_b32 v81, v60, v56, s44
    s_waitcnt vmcnt(10)
    v_perm_b32 v82, v68, v64, s44
    s_waitcnt vmcnt(8)
    v_perm_b32 v83, v76, v72, s44
    ds_write_b128 v13, v[80:83] offset:0
    v_perm_b32 v84, v52, v48, s45
    v_perm_b32 v85, v60, v56, s45
    v_perm_b32 v86, v68, v64, s45
    v_perm_b32 v87, v76, v72, s45
    ds_write_b128 v13, v[84:87] offset:1024
    v_perm_b32 v80, v53, v49, s44
    v_perm_b32 v81, v61, v57, s44
    v_perm_b32 v82, v69, v65, s44
    v_perm_b32 v83, v77, v73, s44
    ds_write_b128 v13, v[80:83] offset:8192
    v_perm_b32 v84, v53, v49, s45
    v_perm_b32 v85, v61, v57, s45
    v_perm_b32 v86, v69, v65, s45
    v_perm_b32 v87, v77, v73, s45
    ds_write_b128 v13, v[84:87] offset:9216
    v_perm_b32 v80, v54, v50, s44
    v_perm_b32 v81, v62, v58, s44
    v_perm_b32 v82, v70, v66, s44
    v_perm_b32 v83, v78, v74, s44
    ds_write_b128 v13, v[80:83] offset:16384
    v_perm_b32 v84, v54, v50, s45
    v_perm_b32 v85, v62, v58, s45
    v_perm_b32 v86, v70, v66, s45
    v_perm_b32 v87, v78, v74, s45
    ds_write_b128 v13, v[84:87] offset:17408
    v_perm_b32 v80, v55, v51, s44
    v_perm_b32 v81, v63, v59, s44
    v_perm_b32 v82, v71, v67, s44
    v_perm_b32 v83, v79, v75, s44
    ds_write_b128 v13, v[80:83] offset:24576
    v_perm_b32 v84, v55, v51, s45
    v_perm_b32 v85, v63, v59, s45
    v_perm_b32 v86, v71, v67, s45
    v_perm_b32 v87, v79, v75, s45
    ds_write_b128 v13, v[84:87] offset:25600
    s_add_u32 s26, s21, 12
    s_lshl_b32 s27, s26, 18
    s_add_u32 s27, s27, s46
    buffer_load_dwordx4 v[48:51], v12, s[72:75], s27 offen
    s_add_u32 s27, s27, 8192
    buffer_load_dwordx4 v[52:55], v12, s[72:75], s27 offen
    s_add_u32 s27, s27, 8192
    buffer_load_dwordx4 v[56:59], v12, s[72:75], s27 offen
    s_add_u32 s27, s27, 8192
    buffer_load_dwordx4 v[60:63], v12, s[72:75], s27 offen
    s_add_u32 s27, s27, 8192
    buffer_load_dwordx4 v[64:67], v12, s[72:75], s27 offen
    s_add_u32 s27, s27, 8192
    buffer_load_dwordx4 v[68:71], v12, s[72:75], s27 offen
    s_add_u32 s27, s27, 8192
    buffer_load_dwordx4 v[72:75], v12, s[72:75], s27 offen
    s_add_u32 s27, s27, 8192
    buffer_load_dwordx4 v[76:79], v12, s[72:75], s27 offen
    s_waitcnt lgkmcnt(0)
    s_barrier
    ds_read_b128 a[16:19], v5 offset:0
    ds_read_b128 a[96:99], v5 offset:1024
    ds_read_b128 a[20:23], v5 offset:2048
    ds_read_b128 a[100:103], v5 offset:3072
    ds_read_b128 a[24:27], v5 offset:4096
    ds_read_b128 a[104:107], v5 offset:5120
    ds_read_b128 a[28:31], v5 offset:6144
    ds_read_b128 a[108:111], v5 offset:7168
    s_lshl_b32 s27, s21, 11
    s_add_u32 s27, s27, 0
    v_add_u32 v13, s27, v0
    s_waitcnt vmcnt(14)
    v_perm_b32 v80, v20, v16, s44
    s_waitcnt vmcnt(12)
    v_perm_b32 v81, v28, v24, s44
    s_waitcnt vmcnt(10)
    v_perm_b32 v82, v36, v32, s44
    s_waitcnt vmcnt(8)
    v_perm_b32 v83, v44, v40, s44
    ds_write_b128 v13, v[80:83] offset:0
    v_perm_b32 v84, v20, v16, s45
    v_perm_b32 v85, v28, v24, s45
    v_perm_b32 v86, v36, v32, s45
    v_perm_b32 v87, v44, v40, s45
    ds_write_b128 v13, v[84:87] offset:1024
    v_perm_b32 v80, v21, v17, s44
    v_perm_b32 v81, v29, v25, s44
    v_perm_b32 v82, v37, v33, s44
    v_perm_b32 v83, v45, v41, s44
    ds_write_b128 v13, v[80:83] offset:8192
    v_perm_b32 v84, v21, v17, s45
    v_perm_b32 v85, v29, v25, s45
    v_perm_b32 v86, v37, v33, s45
    v_perm_b32 v87, v45, v41, s45
    ds_write_b128 v13, v[84:87] offset:9216
    v_perm_b32 v80, v22, v18, s44
    v_perm_b32 v81, v30, v26, s44
    v_perm_b32 v82, v38, v34, s44
    v_perm_b32 v83, v46, v42, s44
    ds_write_b128 v13, v[80:83] offset:16384
    v_perm_b32 v84, v22, v18, s45
    v_perm_b32 v85, v30, v26, s45
    v_perm_b32 v86, v38, v34, s45
    v_perm_b32 v87, v46, v42, s45
    ds_write_b128 v13, v[84:87] offset:17408
    v_perm_b32 v80, v23, v19, s44
    v_perm_b32 v81, v31, v27, s44
    v_perm_b32 v82, v39, v35, s44
    v_perm_b32 v83, v47, v43, s44
    ds_write_b128 v13, v[80:83] offset:24576
    v_perm_b32 v84, v23, v19, s45
    v_perm_b32 v85, v31, v27, s45
    v_perm_b32 v86, v39, v35, s45
    v_perm_b32 v87, v47, v43, s45
    ds_write_b128 v13, v[84:87] offset:25600
    s_add_u32 s26, s21, 16
    s_lshl_b32 s27, s26, 18
    s_add_u32 s27, s27, s46
    buffer_load_dwordx4 v[16:19], v12, s[72:75], s27 offen
    s_add_u32 s27, s27, 8192
    buffer_load_dwordx4 v[20:23], v12, s[72:75], s27 offen
    s_add_u32 s27, s27, 8192
    buffer_load_dwordx4 v[24:27], v12, s[72:75], s27 offen
    s_add_u32 s27, s27, 8192
    buffer_load_dwordx4 v[28:31], v12, s[72:75], s27 offen
    s_add_u32 s27, s27, 8192
    buffer_load_dwordx4 v[32:35], v12, s[72:75], s27 offen
    s_add_u32 s27, s27, 8192
    buffer_load_dwordx4 v[36:39], v12, s[72:75], s27 offen
    s_add_u32 s27, s27, 8192
    buffer_load_dwordx4 v[40:43], v12, s[72:75], s27 offen
    s_add_u32 s27, s27, 8192
    buffer_load_dwordx4 v[44:47], v12, s[72:75], s27 offen
    s_waitcnt lgkmcnt(0)
    s_barrier
    ds_read_b128 a[32:35], v4 offset:0
    ds_read_b128 a[112:115], v4 offset:1024
    ds_read_b128 a[36:39], v4 offset:2048
    ds_read_b128 a[116:119], v4 offset:3072
    ds_read_b128 a[40:43], v4 offset:4096
    ds_read_b128 a[120:123], v4 offset:5120
    ds_read_b128 a[44:47], v4 offset:6144
    ds_read_b128 a[124:127], v4 offset:7168
    s_lshl_b32 s27, s21, 11
    s_add_u32 s27, s27, 32768
    v_add_u32 v13, s27, v0
    s_waitcnt vmcnt(14)
    v_perm_b32 v80, v52, v48, s44
    s_waitcnt vmcnt(12)
    v_perm_b32 v81, v60, v56, s44
    s_waitcnt vmcnt(10)
    v_perm_b32 v82, v68, v64, s44
    s_waitcnt vmcnt(8)
    v_perm_b32 v83, v76, v72, s44
    ds_write_b128 v13, v[80:83] offset:0
    v_perm_b32 v84, v52, v48, s45
    v_perm_b32 v85, v60, v56, s45
    v_perm_b32 v86, v68, v64, s45
    v_perm_b32 v87, v76, v72, s45
    ds_write_b128 v13, v[84:87] offset:1024
    v_perm_b32 v80, v53, v49, s44
    v_perm_b32 v81, v61, v57, s44
    v_perm_b32 v82, v69, v65, s44
    v_perm_b32 v83, v77, v73, s44
    ds_write_b128 v13, v[80:83] offset:8192
    v_perm_b32 v84, v53, v49, s45
    v_perm_b32 v85, v61, v57, s45
    v_perm_b32 v86, v69, v65, s45
    v_perm_b32 v87, v77, v73, s45
    ds_write_b128 v13, v[84:87] offset:9216
    v_perm_b32 v80, v54, v50, s44
    v_perm_b32 v81, v62, v58, s44
    v_perm_b32 v82, v70, v66, s44
    v_perm_b32 v83, v78, v74, s44
    ds_write_b128 v13, v[80:83] offset:16384
    v_perm_b32 v84, v54, v50, s45
    v_perm_b32 v85, v62, v58, s45
    v_perm_b32 v86, v70, v66, s45
    v_perm_b32 v87, v78, v74, s45
    ds_write_b128 v13, v[84:87] offset:17408
    v_perm_b32 v80, v55, v51, s44
    v_perm_b32 v81, v63, v59, s44
    v_perm_b32 v82, v71, v67, s44
    v_perm_b32 v83, v79, v75, s44
    ds_write_b128 v13, v[80:83] offset:24576
    v_perm_b32 v84, v55, v51, s45
    v_perm_b32 v85, v63, v59, s45
    v_perm_b32 v86, v71, v67, s45
    v_perm_b32 v87, v79, v75, s45
    ds_write_b128 v13, v[84:87] offset:25600
    s_waitcnt lgkmcnt(0)
    s_barrier
    ds_read_b128 a[48:51], v5 offset:0
    ds_read_b128 a[128:131], v5 offset:1024
    ds_read_b128 a[52:55], v5 offset:2048
    ds_read_b128 a[132:135], v5 offset:3072
    ds_read_b128 a[56:59], v5 offset:4096
    ds_read_b128 a[136:139], v5 offset:5120
    ds_read_b128 a[60:63], v5 offset:6144
    ds_read_b128 a[140:143], v5 offset:7168
    s_lshl_b32 s27, s21, 11
    s_add_u32 s27, s27, 0
    v_add_u32 v13, s27, v0
    s_waitcnt vmcnt(6)
    v_perm_b32 v80, v20, v16, s44
    s_waitcnt vmcnt(4)
    v_perm_b32 v81, v28, v24, s44
    s_waitcnt vmcnt(2)
    v_perm_b32 v82, v36, v32, s44
    s_waitcnt vmcnt(0)
    v_perm_b32 v83, v44, v40, s44
    ds_write_b128 v13, v[80:83] offset:0
    v_perm_b32 v84, v20, v16, s45
    v_perm_b32 v85, v28, v24, s45
    v_perm_b32 v86, v36, v32, s45
    v_perm_b32 v87, v44, v40, s45
    ds_write_b128 v13, v[84:87] offset:1024
    v_perm_b32 v80, v21, v17, s44
    v_perm_b32 v81, v29, v25, s44
    v_perm_b32 v82, v37, v33, s44
    v_perm_b32 v83, v45, v41, s44
    ds_write_b128 v13, v[80:83] offset:8192
    v_perm_b32 v84, v21, v17, s45
    v_perm_b32 v85, v29, v25, s45
    v_perm_b32 v86, v37, v33, s45
    v_perm_b32 v87, v45, v41, s45
    ds_write_b128 v13, v[84:87] offset:9216
    v_perm_b32 v80, v22, v18, s44
    v_perm_b32 v81, v30, v26, s44
    v_perm_b32 v82, v38, v34, s44
    v_perm_b32 v83, v46, v42, s44
    ds_write_b128 v13, v[80:83] offset:16384
    v_perm_b32 v84, v22, v18, s45
    v_perm_b32 v85, v30, v26, s45
    v_perm_b32 v86, v38, v34, s45
    v_perm_b32 v87, v46, v42, s45
    ds_write_b128 v13, v[84:87] offset:17408
    v_perm_b32 v80, v23, v19, s44
    v_perm_b32 v81, v31, v27, s44
    v_perm_b32 v82, v39, v35, s44
    v_perm_b32 v83, v47, v43, s44
    ds_write_b128 v13, v[80:83] offset:24576
    v_perm_b32 v84, v23, v19, s45
    v_perm_b32 v85, v31, v27, s45
    v_perm_b32 v86, v39, v35, s45
    v_perm_b32 v87, v47, v43, s45
    ds_write_b128 v13, v[84:87] offset:25600
    s_waitcnt lgkmcnt(0)
    s_barrier
    ds_read_b128 a[64:67], v4 offset:0
    ds_read_b128 a[144:147], v4 offset:1024
    ds_read_b128 a[68:71], v4 offset:2048
    ds_read_b128 a[148:151], v4 offset:3072
    ds_read_b128 a[72:75], v4 offset:4096
    ds_read_b128 a[152:155], v4 offset:5120
    ds_read_b128 a[76:79], v4 offset:6144
    ds_read_b128 a[156:159], v4 offset:7168
    s_waitcnt lgkmcnt(0)
    s_branch M_lw_done
M_bl_kv:
    s_mov_b32 s44, 0x05040100
    s_mov_b32 s45, 0x07060302
    s_add_u32 s26, s21, 0
    s_lshl_b32 s27, s26, 18
    s_add_u32 s27, s27, s46
    buffer_load_dwordx4 v[16:19], v12, s[76:79], s27 offen
    s_add_u32 s27, s27, 8192
    buffer_load_dwordx4 v[20:23], v12, s[76:79], s27 offen
    s_add_u32 s27, s27, 8192
    buffer_load_dwordx4 v[24:27], v12, s[76:79], s27 offen
    s_add_u32 s27, s27, 8192
    buffer_load_dwordx4 v[28:31], v12, s[76:79], s27 offen
    s_add_u32 s27, s27, 8192
    buffer_load_dwordx4 v[32:35], v12, s[76:79], s27 offen
    s_add_u32 s27, s27, 8192
    buffer_load_dwordx4 v[36:39], v12, s[76:79], s27 offen
    s_add_u32 s27, s27, 8192
    buffer_load_dwordx4 v[40:43], v12, s[76:79], s27 offen
    s_add_u32 s27, s27, 8192
    buffer_load_dwordx4 v[44:47], v12, s[76:79], s27 offen
    s_add_u32 s26, s21, 4
    s_lshl_b32 s27, s26, 18
    s_add_u32 s27, s27, s46
    buffer_load_dwordx4 v[48:51], v12, s[76:79], s27 offen
    s_add_u32 s27, s27, 8192
    buffer_load_dwordx4 v[52:55], v12, s[76:79], s27 offen
    s_add_u32 s27, s27, 8192
    buffer_load_dwordx4 v[56:59], v12, s[76:79], s27 offen
    s_add_u32 s27, s27, 8192
    buffer_load_dwordx4 v[60:63], v12, s[76:79], s27 offen
    s_add_u32 s27, s27, 8192
    buffer_load_dwordx4 v[64:67], v12, s[76:79], s27 offen
    s_add_u32 s27, s27, 8192
    buffer_load_dwordx4 v[68:71], v12, s[76:79], s27 offen
    s_add_u32 s27, s27, 8192
    buffer_load_dwordx4 v[72:75], v12, s[76:79], s27 offen
    s_add_u32 s27, s27, 8192
    buffer_load_dwordx4 v[76:79], v12, s[76:79], s27 offen
    s_lshl_b32 s27, s21, 11
    s_add_u32 s27, s27, 0
    v_add_u32 v13, s27, v0
    s_waitcnt vmcnt(14)
    v_perm_b32 v80, v20, v16, s44
    s_waitcnt vmcnt(12)
    v_perm_b32 v81, v28, v24, s44
    s_waitcnt vmcnt(10)
    v_perm_b32 v82, v36, v32, s44
    s_waitcnt vmcnt(8)
    v_perm_b32 v83, v44, v40, s44
    ds_write_b128 v13, v[80:83] offset:0
    v_perm_b32 v84, v20, v16, s45
    v_perm_b32 v85, v28, v24, s45
    v_perm_b32 v86, v36, v32, s45
    v_perm_b32 v87, v44, v40, s45
    ds_write_b128 v13, v[84:87] offset:1024
    v_perm_b32 v80, v21, v17, s44
    v_perm_b32 v81, v29, v25, s44
    v_perm_b32 v82, v37, v33, s44
    v_perm_b32 v83, v45, v41, s44
    ds_write_b128 v13, v[80:83] offset:8192
    v_perm_b32 v84, v21, v17, s45
    v_perm_b32 v85, v29, v25, s45
    v_perm_b32 v86, v37, v33, s45
    v_perm_b32 v87, v45, v41, s45
    ds_write_b128 v13, v[84:87] offset:9216
    v_perm_b32 v80, v22, v18, s44
    v_perm_b32 v81, v30, v26, s44
    v_perm_b32 v82, v38, v34, s44
    v_perm_b32 v83, v46, v42, s44
    ds_write_b128 v13, v[80:83] offset:16384
    v_perm_b32 v84, v22, v18, s45
    v_perm_b32 v85, v30, v26, s45
    v_perm_b32 v86, v38, v34, s45
    v_perm_b32 v87, v46, v42, s45
    ds_write_b128 v13, v[84:87] offset:17408
    v_perm_b32 v80, v23, v19, s44
    v_perm_b32 v81, v31, v27, s44
    v_perm_b32 v82, v39, v35, s44
    v_perm_b32 v83, v47, v43, s44
    ds_write_b128 v13, v[80:83] offset:24576
    v_perm_b32 v84, v23, v19, s45
    v_perm_b32 v85, v31, v27, s45
    v_perm_b32 v86, v39, v35, s45
    v_perm_b32 v87, v47, v43, s45
    ds_write_b128 v13, v[84:87] offset:25600
    s_add_u32 s26, s21, 8
    s_lshl_b32 s27, s26, 18
    s_add_u32 s27, s27, s46
    buffer_load_dwordx4 v[16:19], v12, s[76:79], s27 offen
    s_add_u32 s27, s27, 8192
    buffer_load_dwordx4 v[20:23], v12, s[76:79], s27 offen
    s_add_u32 s27, s27, 8192
    buffer_load_dwordx4 v[24:27], v12, s[76:79], s27 offen
    s_add_u32 s27, s27, 8192
    buffer_load_dwordx4 v[28:31], v12, s[76:79], s27 offen
    s_add_u32 s27, s27, 8192
    buffer_load_dwordx4 v[32:35], v12, s[76:79], s27 offen
    s_add_u32 s27, s27, 8192
    buffer_load_dwordx4 v[36:39], v12, s[76:79], s27 offen
    s_add_u32 s27, s27, 8192
    buffer_load_dwordx4 v[40:43], v12, s[76:79], s27 offen
    s_add_u32 s27, s27, 8192
    buffer_load_dwordx4 v[44:47], v12, s[76:79], s27 offen
    s_waitcnt lgkmcnt(0)
    s_barrier
    ds_read_b128 a[0:3], v4 offset:0
    ds_read_b128 a[80:83], v4 offset:1024
    ds_read_b128 a[4:7], v4 offset:2048
    ds_read_b128 a[84:87], v4 offset:3072
    ds_read_b128 a[8:11], v4 offset:4096
    ds_read_b128 a[88:91], v4 offset:5120
    ds_read_b128 a[12:15], v4 offset:6144
    ds_read_b128 a[92:95], v4 offset:7168
    s_lshl_b32 s27, s21, 11
    s_add_u32 s27, s27, 32768
    v_add_u32 v13, s27, v0
    s_waitcnt vmcnt(14)
    v_perm_b32 v80, v52, v48, s44
    s_waitcnt vmcnt(12)
    v_perm_b32 v81, v60, v56, s44
    s_waitcnt vmcnt(10)
    v_perm_b32 v82, v68, v64, s44
    s_waitcnt vmcnt(8)
    v_perm_b32 v83, v76, v72, s44
    ds_write_b128 v13, v[80:83] offset:0
    v_perm_b32 v84, v52, v48, s45
    v_perm_b32 v85, v60, v56, s45
    v_perm_b32 v86, v68, v64, s45
    v_perm_b32 v87, v76, v72, s45
    ds_write_b128 v13, v[84:87] offset:1024
    v_perm_b32 v80, v53, v49, s44
    v_perm_b32 v81, v61, v57, s44
    v_perm_b32 v82, v69, v65, s44
    v_perm_b32 v83, v77, v73, s44
    ds_write_b128 v13, v[80:83] offset:8192
    v_perm_b32 v84, v53, v49, s45
    v_perm_b32 v85, v61, v57, s45
    v_perm_b32 v86, v69, v65, s45
    v_perm_b32 v87, v77, v73, s45
    ds_write_b128 v13, v[84:87] offset:9216
    v_perm_b32 v80, v54, v50, s44
    v_perm_b32 v81, v62, v58, s44
    v_perm_b32 v82, v70, v66, s44
    v_perm_b32 v83, v78, v74, s44
    ds_write_b128 v13, v[80:83] offset:16384
    v_perm_b32 v84, v54, v50, s45
    v_perm_b32 v85, v62, v58, s45
    v_perm_b32 v86, v70, v66, s45
    v_perm_b32 v87, v78, v74, s45
    ds_write_b128 v13, v[84:87] offset:17408
    v_perm_b32 v80, v55, v51, s44
    v_perm_b32 v81, v63, v59, s44
    v_perm_b32 v82, v71, v67, s44
    v_perm_b32 v83, v79, v75, s44
    ds_write_b128 v13, v[80:83] offset:24576
    v_perm_b32 v84, v55, v51, s45
    v_perm_b32 v85, v63, v59, s45
    v_perm_b32 v86, v71, v67, s45
    v_perm_b32 v87, v79, v75, s45
    ds_write_b128 v13, v[84:87] offset:25600
    s_add_u32 s26, s21, 12
    s_lshl_b32 s27, s26, 18
    s_add_u32 s27, s27, s46
    buffer_load_dwordx4 v[48:51], v12, s[76:79], s27 offen
    s_add_u32 s27, s27, 8192
    buffer_load_dwordx4 v[52:55], v12, s[76:79], s27 offen
    s_add_u32 s27, s27, 8192
    buffer_load_dwordx4 v[56:59], v12, s[76:79], s27 offen
    s_add_u32 s27, s27, 8192
    buffer_load_dwordx4 v[60:63], v12, s[76:79], s27 offen
    s_add_u32 s27, s27, 8192
    buffer_load_dwordx4 v[64:67], v12, s[76:79], s27 offen
    s_add_u32 s27, s27, 8192
    buffer_load_dwordx4 v[68:71], v12, s[76:79], s27 offen
    s_add_u32 s27, s27, 8192
    buffer_load_dwordx4 v[72:75], v12, s[76:79], s27 offen
    s_add_u32 s27, s27, 8192
    buffer_load_dwordx4 v[76:79], v12, s[76:79], s27 offen
    s_waitcnt lgkmcnt(0)
    s_barrier
    ds_read_b128 a[16:19], v5 offset:0
    ds_read_b128 a[96:99], v5 offset:1024
    ds_read_b128 a[20:23], v5 offset:2048
    ds_read_b128 a[100:103], v5 offset:3072
    ds_read_b128 a[24:27], v5 offset:4096
    ds_read_b128 a[104:107], v5 offset:5120
    ds_read_b128 a[28:31], v5 offset:6144
    ds_read_b128 a[108:111], v5 offset:7168
    s_lshl_b32 s27, s21, 11
    s_add_u32 s27, s27, 0
    v_add_u32 v13, s27, v0
    s_waitcnt vmcnt(14)
    v_perm_b32 v80, v20, v16, s44
    s_waitcnt vmcnt(12)
    v_perm_b32 v81, v28, v24, s44
    s_waitcnt vmcnt(10)
    v_perm_b32 v82, v36, v32, s44
    s_waitcnt vmcnt(8)
    v_perm_b32 v83, v44, v40, s44
    ds_write_b128 v13, v[80:83] offset:0
    v_perm_b32 v84, v20, v16, s45
    v_perm_b32 v85, v28, v24, s45
    v_perm_b32 v86, v36, v32, s45
    v_perm_b32 v87, v44, v40, s45
    ds_write_b128 v13, v[84:87] offset:1024
    v_perm_b32 v80, v21, v17, s44
    v_perm_b32 v81, v29, v25, s44
    v_perm_b32 v82, v37, v33, s44
    v_perm_b32 v83, v45, v41, s44
    ds_write_b128 v13, v[80:83] offset:8192
    v_perm_b32 v84, v21, v17, s45
    v_perm_b32 v85, v29, v25, s45
    v_perm_b32 v86, v37, v33, s45
    v_perm_b32 v87, v45, v41, s45
    ds_write_b128 v13, v[84:87] offset:9216
    v_perm_b32 v80, v22, v18, s44
    v_perm_b32 v81, v30, v26, s44
    v_perm_b32 v82, v38, v34, s44
    v_perm_b32 v83, v46, v42, s44
    ds_write_b128 v13, v[80:83] offset:16384
    v_perm_b32 v84, v22, v18, s45
    v_perm_b32 v85, v30, v26, s45
    v_perm_b32 v86, v38, v34, s45
    v_perm_b32 v87, v46, v42, s45
    ds_write_b128 v13, v[84:87] offset:17408
    v_perm_b32 v80, v23, v19, s44
    v_perm_b32 v81, v31, v27, s44
    v_perm_b32 v82, v39, v35, s44
    v_perm_b32 v83, v47, v43, s44
    ds_write_b128 v13, v[80:83] offset:24576
    v_perm_b32 v84, v23, v19, s45
    v_perm_b32 v85, v31, v27, s45
    v_perm_b32 v86, v39, v35, s45
    v_perm_b32 v87, v47, v43, s45
    ds_write_b128 v13, v[84:87] offset:25600
    s_add_u32 s26, s21, 16
    s_lshl_b32 s27, s26, 18
    s_add_u32 s27, s27, s46
    buffer_load_dwordx4 v[16:19], v12, s[76:79], s27 offen
    s_add_u32 s27, s27, 8192
    buffer_load_dwordx4 v[20:23], v12, s[76:79], s27 offen
    s_add_u32 s27, s27, 8192
    buffer_load_dwordx4 v[24:27], v12, s[76:79], s27 offen
    s_add_u32 s27, s27, 8192
    buffer_load_dwordx4 v[28:31], v12, s[76:79], s27 offen
    s_add_u32 s27, s27, 8192
    buffer_load_dwordx4 v[32:35], v12, s[76:79], s27 offen
    s_add_u32 s27, s27, 8192
    buffer_load_dwordx4 v[36:39], v12, s[76:79], s27 offen
    s_add_u32 s27, s27, 8192
    buffer_load_dwordx4 v[40:43], v12, s[76:79], s27 offen
    s_add_u32 s27, s27, 8192
    buffer_load_dwordx4 v[44:47], v12, s[76:79], s27 offen
    s_waitcnt lgkmcnt(0)
    s_barrier
    ds_read_b128 a[32:35], v4 offset:0
    ds_read_b128 a[112:115], v4 offset:1024
    ds_read_b128 a[36:39], v4 offset:2048
    ds_read_b128 a[116:119], v4 offset:3072
    ds_read_b128 a[40:43], v4 offset:4096
    ds_read_b128 a[120:123], v4 offset:5120
    ds_read_b128 a[44:47], v4 offset:6144
    ds_read_b128 a[124:127], v4 offset:7168
    s_lshl_b32 s27, s21, 11
    s_add_u32 s27, s27, 32768
    v_add_u32 v13, s27, v0
    s_waitcnt vmcnt(14)
    v_perm_b32 v80, v52, v48, s44
    s_waitcnt vmcnt(12)
    v_perm_b32 v81, v60, v56, s44
    s_waitcnt vmcnt(10)
    v_perm_b32 v82, v68, v64, s44
    s_waitcnt vmcnt(8)
    v_perm_b32 v83, v76, v72, s44
    ds_write_b128 v13, v[80:83] offset:0
    v_perm_b32 v84, v52, v48, s45
    v_perm_b32 v85, v60, v56, s45
    v_perm_b32 v86, v68, v64, s45
    v_perm_b32 v87, v76, v72, s45
    ds_write_b128 v13, v[84:87] offset:1024
    v_perm_b32 v80, v53, v49, s44
    v_perm_b32 v81, v61, v57, s44
    v_perm_b32 v82, v69, v65, s44
    v_perm_b32 v83, v77, v73, s44
    ds_write_b128 v13, v[80:83] offset:8192
    v_perm_b32 v84, v53, v49, s45
    v_perm_b32 v85, v61, v57, s45
    v_perm_b32 v86, v69, v65, s45
    v_perm_b32 v87, v77, v73, s45
    ds_write_b128 v13, v[84:87] offset:9216
    v_perm_b32 v80, v54, v50, s44
    v_perm_b32 v81, v62, v58, s44
    v_perm_b32 v82, v70, v66, s44
    v_perm_b32 v83, v78, v74, s44
    ds_write_b128 v13, v[80:83] offset:16384
    v_perm_b32 v84, v54, v50, s45
    v_perm_b32 v85, v62, v58, s45
    v_perm_b32 v86, v70, v66, s45
    v_perm_b32 v87, v78, v74, s45
    ds_write_b128 v13, v[84:87] offset:17408
    v_perm_b32 v80, v55, v51, s44
    v_perm_b32 v81, v63, v59, s44
    v_perm_b32 v82, v71, v67, s44
    v_perm_b32 v83, v79, v75, s44
    ds_write_b128 v13, v[80:83] offset:24576
    v_perm_b32 v84, v55, v51, s45
    v_perm_b32 v85, v63, v59, s45
    v_perm_b32 v86, v71, v67, s45
    v_perm_b32 v87, v79, v75, s45
    ds_write_b128 v13, v[84:87] offset:25600
    s_add_u32 s26, s21, 0
    s_lshl_b32 s27, s26, 18
    s_add_u32 s27, s27, s46
    buffer_load_dwordx4 v[48:51], v12, s[80:83], s27 offen
    s_add_u32 s27, s27, 8192
    buffer_load_dwordx4 v[52:55], v12, s[80:83], s27 offen
    s_add_u32 s27, s27, 8192
    buffer_load_dwordx4 v[56:59], v12, s[80:83], s27 offen
    s_add_u32 s27, s27, 8192
    buffer_load_dwordx4 v[60:63], v12, s[80:83], s27 offen
    s_add_u32 s27, s27, 8192
    buffer_load_dwordx4 v[64:67], v12, s[80:83], s27 offen
    s_add_u32 s27, s27, 8192
    buffer_load_dwordx4 v[68:71], v12, s[80:83], s27 offen
    s_add_u32 s27, s27, 8192
    buffer_load_dwordx4 v[72:75], v12, s[80:83], s27 offen
    s_add_u32 s27, s27, 8192
    buffer_load_dwordx4 v[76:79], v12, s[80:83], s27 offen
    s_waitcnt lgkmcnt(0)
    s_barrier
    ds_read_b128 a[48:51], v5 offset:0
    ds_read_b128 a[128:131], v5 offset:1024
    ds_read_b128 a[52:55], v5 offset:2048
    ds_read_b128 a[132:135], v5 offset:3072
    ds_read_b128 a[56:59], v5 offset:4096
    ds_read_b128 a[136:139], v5 offset:5120
    ds_read_b128 a[60:63], v5 offset:6144
    ds_read_b128 a[140:143], v5 offset:7168
    s_lshl_b32 s27, s21, 11
    s_add_u32 s27, s27, 0
    v_add_u32 v13, s27, v0
    s_waitcnt vmcnt(14)
    v_perm_b32 v80, v20, v16, s44
    s_waitcnt vmcnt(12)
    v_perm_b32 v81, v28, v24, s44
    s_waitcnt vmcnt(10)
    v_perm_b32 v82, v36, v32, s44
    s_waitcnt vmcnt(8)
    v_perm_b32 v83, v44, v40, s44
    ds_write_b128 v13, v[80:83] offset:0
    v_perm_b32 v84, v20, v16, s45
    v_perm_b32 v85, v28, v24, s45
    v_perm_b32 v86, v36, v32, s45
    v_perm_b32 v87, v44, v40, s45
    ds_write_b128 v13, v[84:87] offset:1024
    v_perm_b32 v80, v21, v17, s44
    v_perm_b32 v81, v29, v25, s44
    v_perm_b32 v82, v37, v33, s44
    v_perm_b32 v83, v45, v41, s44
    ds_write_b128 v13, v[80:83] offset:8192
    v_perm_b32 v84, v21, v17, s45
    v_perm_b32 v85, v29, v25, s45
    v_perm_b32 v86, v37, v33, s45
    v_perm_b32 v87, v45, v41, s45
    ds_write_b128 v13, v[84:87] offset:9216
    v_perm_b32 v80, v22, v18, s44
    v_perm_b32 v81, v30, v26, s44
    v_perm_b32 v82, v38, v34, s44
    v_perm_b32 v83, v46, v42, s44
    ds_write_b128 v13, v[80:83] offset:16384
    v_perm_b32 v84, v22, v18, s45
    v_perm_b32 v85, v30, v26, s45
    v_perm_b32 v86, v38, v34, s45
    v_perm_b32 v87, v46, v42, s45
    ds_write_b128 v13, v[84:87] offset:17408
    v_perm_b32 v80, v23, v19, s44
    v_perm_b32 v81, v31, v27, s44
    v_perm_b32 v82, v39, v35, s44
    v_perm_b32 v83, v47, v43, s44
    ds_write_b128 v13, v[80:83] offset:24576
    v_perm_b32 v84, v23, v19, s45
    v_perm_b32 v85, v31, v27, s45
    v_perm_b32 v86, v39, v35, s45
    v_perm_b32 v87, v47, v43, s45
    ds_write_b128 v13, v[84:87] offset:25600
    s_add_u32 s26, s21, 4
    s_lshl_b32 s27, s26, 18
    s_add_u32 s27, s27, s46
    buffer_load_dwordx4 v[16:19], v12, s[80:83], s27 offen
    s_add_u32 s27, s27, 8192
    buffer_load_dwordx4 v[20:23], v12, s[80:83], s27 offen
    s_add_u32 s27, s27, 8192
    buffer_load_dwordx4 v[24:27], v12, s[80:83], s27 offen
    s_add_u32 s27, s27, 8192
    buffer_load_dwordx4 v[28:31], v12, s[80:83], s27 offen
    s_add_u32 s27, s27, 8192
    buffer_load_dwordx4 v[32:35], v12, s[80:83], s27 offen
    s_add_u32 s27, s27, 8192
    buffer_load_dwordx4 v[36:39], v12, s[80:83], s27 offen
    s_add_u32 s27, s27, 8192
    buffer_load_dwordx4 v[40:43], v12, s[80:83], s27 offen
    s_add_u32 s27, s27, 8192
    buffer_load_dwordx4 v[44:47], v12, s[80:83], s27 offen
    s_waitcnt lgkmcnt(0)
    s_barrier
    ds_read_b128 a[64:67], v4 offset:0
    ds_read_b128 a[144:147], v4 offset:1024
    ds_read_b128 a[68:71], v4 offset:2048
    ds_read_b128 a[148:151], v4 offset:3072
    ds_read_b128 a[72:75], v4 offset:4096
    ds_read_b128 a[152:155], v4 offset:5120
    ds_read_b128 a[76:79], v4 offset:6144
    ds_read_b128 a[156:159], v4 offset:7168
    s_lshl_b32 s27, s21, 11
    s_add_u32 s27, s27, 32768
    v_add_u32 v13, s27, v0
    s_waitcnt vmcnt(14)
    v_perm_b32 v80, v52, v48, s44
    s_waitcnt vmcnt(12)
    v_perm_b32 v81, v60, v56, s44
    s_waitcnt vmcnt(10)
    v_perm_b32 v82, v68, v64, s44
    s_waitcnt vmcnt(8)
    v_perm_b32 v83, v76, v72, s44
    ds_write_b128 v13, v[80:83] offset:0
    v_perm_b32 v84, v52, v48, s45
    v_perm_b32 v85, v60, v56, s45
    v_perm_b32 v86, v68, v64, s45
    v_perm_b32 v87, v76, v72, s45
    ds_write_b128 v13, v[84:87] offset:1024
    v_perm_b32 v80, v53, v49, s44
    v_perm_b32 v81, v61, v57, s44
    v_perm_b32 v82, v69, v65, s44
    v_perm_b32 v83, v77, v73, s44
    ds_write_b128 v13, v[80:83] offset:8192
    v_perm_b32 v84, v53, v49, s45
    v_perm_b32 v85, v61, v57, s45
    v_perm_b32 v86, v69, v65, s45
    v_perm_b32 v87, v77, v73, s45
    ds_write_b128 v13, v[84:87] offset:9216
    v_perm_b32 v80, v54, v50, s44
    v_perm_b32 v81, v62, v58, s44
    v_perm_b32 v82, v70, v66, s44
    v_perm_b32 v83, v78, v74, s44
    ds_write_b128 v13, v[80:83] offset:16384
    v_perm_b32 v84, v54, v50, s45
    v_perm_b32 v85, v62, v58, s45
    v_perm_b32 v86, v70, v66, s45
    v_perm_b32 v87, v78, v74, s45
    ds_write_b128 v13, v[84:87] offset:17408
    v_perm_b32 v80, v55, v51, s44
    v_perm_b32 v81, v63, v59, s44
    v_perm_b32 v82, v71, v67, s44
    v_perm_b32 v83, v79, v75, s44
    ds_write_b128 v13, v[80:83] offset:24576
    v_perm_b32 v84, v55, v51, s45
    v_perm_b32 v85, v63, v59, s45
    v_perm_b32 v86, v71, v67, s45
    v_perm_b32 v87, v79, v75, s45
    ds_write_b128 v13, v[84:87] offset:25600
    s_add_u32 s26, s21, 8
    s_lshl_b32 s27, s26, 18
    s_add_u32 s27, s27, s46
    buffer_load_dwordx4 v[48:51], v12, s[80:83], s27 offen
    s_add_u32 s27, s27, 8192
    buffer_load_dwordx4 v[52:55], v12, s[80:83], s27 offen
    s_add_u32 s27, s27, 8192
    buffer_load_dwordx4 v[56:59], v12, s[80:83], s27 offen
    s_add_u32 s27, s27, 8192
    buffer_load_dwordx4 v[60:63], v12, s[80:83], s27 offen
    s_add_u32 s27, s27, 8192
    buffer_load_dwordx4 v[64:67], v12, s[80:83], s27 offen
    s_add_u32 s27, s27, 8192
    buffer_load_dwordx4 v[68:71], v12, s[80:83], s27 offen
    s_add_u32 s27, s27, 8192
    buffer_load_dwordx4 v[72:75], v12, s[80:83], s27 offen
    s_add_u32 s27, s27, 8192
    buffer_load_dwordx4 v[76:79], v12, s[80:83], s27 offen
    s_waitcnt lgkmcnt(0)
    s_barrier
    ds_read_b128 a[160:163], v5 offset:0
    ds_read_b128 a[240:243], v5 offset:1024
    ds_read_b128 a[164:167], v5 offset:2048
    ds_read_b128 a[244:247], v5 offset:3072
    ds_read_b128 a[168:171], v5 offset:4096
    ds_read_b128 a[248:251], v5 offset:5120
    ds_read_b128 a[172:175], v5 offset:6144
    ds_read_b128 a[252:255], v5 offset:7168
    s_lshl_b32 s27, s21, 11
    s_add_u32 s27, s27, 0
    v_add_u32 v13, s27, v0
    s_waitcnt vmcnt(14)
    v_perm_b32 v80, v20, v16, s44
    s_waitcnt vmcnt(12)
    v_perm_b32 v81, v28, v24, s44
    s_waitcnt vmcnt(10)
    v_perm_b32 v82, v36, v32, s44
    s_waitcnt vmcnt(8)
    v_perm_b32 v83, v44, v40, s44
    ds_write_b128 v13, v[80:83] offset:0
    v_perm_b32 v84, v20, v16, s45
    v_perm_b32 v85, v28, v24, s45
    v_perm_b32 v86, v36, v32, s45
    v_perm_b32 v87, v44, v40, s45
    ds_write_b128 v13, v[84:87] offset:1024
    v_perm_b32 v80, v21, v17, s44
    v_perm_b32 v81, v29, v25, s44
    v_perm_b32 v82, v37, v33, s44
    v_perm_b32 v83, v45, v41, s44
    ds_write_b128 v13, v[80:83] offset:8192
    v_perm_b32 v84, v21, v17, s45
    v_perm_b32 v85, v29, v25, s45
    v_perm_b32 v86, v37, v33, s45
    v_perm_b32 v87, v45, v41, s45
    ds_write_b128 v13, v[84:87] offset:9216
    v_perm_b32 v80, v22, v18, s44
    v_perm_b32 v81, v30, v26, s44
    v_perm_b32 v82, v38, v34, s44
    v_perm_b32 v83, v46, v42, s44
    ds_write_b128 v13, v[80:83] offset:16384
    v_perm_b32 v84, v22, v18, s45
    v_perm_b32 v85, v30, v26, s45
    v_perm_b32 v86, v38, v34, s45
    v_perm_b32 v87, v46, v42, s45
    ds_write_b128 v13, v[84:87] offset:17408
    v_perm_b32 v80, v23, v19, s44
    v_perm_b32 v81, v31, v27, s44
    v_perm_b32 v82, v39, v35, s44
    v_perm_b32 v83, v47, v43, s44
    ds_write_b128 v13, v[80:83] offset:24576
    v_perm_b32 v84, v23, v19, s45
    v_perm_b32 v85, v31, v27, s45
    v_perm_b32 v86, v39, v35, s45
    v_perm_b32 v87, v47, v43, s45
    ds_write_b128 v13, v[84:87] offset:25600
    s_add_u32 s26, s21, 12
    s_lshl_b32 s27, s26, 18
    s_add_u32 s27, s27, s46
    buffer_load_dwordx4 v[16:19], v12, s[80:83], s27 offen
    s_add_u32 s27, s27, 8192
    buffer_load_dwordx4 v[20:23], v12, s[80:83], s27 offen
    s_add_u32 s27, s27, 8192
    buffer_load_dwordx4 v[24:27], v12, s[80:83], s27 offen
    s_add_u32 s27, s27, 8192
    buffer_load_dwordx4 v[28:31], v12, s[80:83], s27 offen
    s_add_u32 s27, s27, 8192
    buffer_load_dwordx4 v[32:35], v12, s[80:83], s27 offen
    s_add_u32 s27, s27, 8192
    buffer_load_dwordx4 v[36:39], v12, s[80:83], s27 offen
    s_add_u32 s27, s27, 8192
    buffer_load_dwordx4 v[40:43], v12, s[80:83], s27 offen
    s_add_u32 s27, s27, 8192
    buffer_load_dwordx4 v[44:47], v12, s[80:83], s27 offen
    s_waitcnt lgkmcnt(0)
    s_barrier
    ds_read_b128 a[176:179], v4 offset:0
    ds_read_b128 v[192:195], v4 offset:1024
    ds_read_b128 a[180:183], v4 offset:2048
    ds_read_b128 v[196:199], v4 offset:3072
    ds_read_b128 a[184:187], v4 offset:4096
    ds_read_b128 v[200:203], v4 offset:5120
    ds_read_b128 a[188:191], v4 offset:6144
    ds_read_b128 v[204:207], v4 offset:7168
    s_lshl_b32 s27, s21, 11
    s_add_u32 s27, s27, 32768
    v_add_u32 v13, s27, v0
    s_waitcnt vmcnt(14)
    v_perm_b32 v80, v52, v48, s44
    s_waitcnt vmcnt(12)
    v_perm_b32 v81, v60, v56, s44
    s_waitcnt vmcnt(10)
    v_perm_b32 v82, v68, v64, s44
    s_waitcnt vmcnt(8)
    v_perm_b32 v83, v76, v72, s44
    ds_write_b128 v13, v[80:83] offset:0
    v_perm_b32 v84, v52, v48, s45
    v_perm_b32 v85, v60, v56, s45
    v_perm_b32 v86, v68, v64, s45
    v_perm_b32 v87, v76, v72, s45
    ds_write_b128 v13, v[84:87] offset:1024
    v_perm_b32 v80, v53, v49, s44
    v_perm_b32 v81, v61, v57, s44
    v_perm_b32 v82, v69, v65, s44
    v_perm_b32 v83, v77, v73, s44
    ds_write_b128 v13, v[80:83] offset:8192
    v_perm_b32 v84, v53, v49, s45
    v_perm_b32 v85, v61, v57, s45
    v_perm_b32 v86, v69, v65, s45
    v_perm_b32 v87, v77, v73, s45
    ds_write_b128 v13, v[84:87] offset:9216
    v_perm_b32 v80, v54, v50, s44
    v_perm_b32 v81, v62, v58, s44
    v_perm_b32 v82, v70, v66, s44
    v_perm_b32 v83, v78, v74, s44
    ds_write_b128 v13, v[80:83] offset:16384
    v_perm_b32 v84, v54, v50, s45
    v_perm_b32 v85, v62, v58, s45
    v_perm_b32 v86, v70, v66, s45
    v_perm_b32 v87, v78, v74, s45
    ds_write_b128 v13, v[84:87] offset:17408
    v_perm_b32 v80, v55, v51, s44
    v_perm_b32 v81, v63, v59, s44
    v_perm_b32 v82, v71, v67, s44
    v_perm_b32 v83, v79, v75, s44
    ds_write_b128 v13, v[80:83] offset:24576
    v_perm_b32 v84, v55, v51, s45
    v_perm_b32 v85, v63, v59, s45
    v_perm_b32 v86, v71, v67, s45
    v_perm_b32 v87, v79, v75, s45
    ds_write_b128 v13, v[84:87] offset:25600
    s_add_u32 s26, s21, 16
    s_lshl_b32 s27, s26, 18
    s_add_u32 s27, s27, s46
    buffer_load_dwordx4 v[48:51], v12, s[80:83], s27 offen
    s_add_u32 s27, s27, 8192
    buffer_load_dwordx4 v[52:55], v12, s[80:83], s27 offen
    s_add_u32 s27, s27, 8192
    buffer_load_dwordx4 v[56:59], v12, s[80:83], s27 offen
    s_add_u32 s27, s27, 8192
    buffer_load_dwordx4 v[60:63], v12, s[80:83], s27 offen
    s_add_u32 s27, s27, 8192
    buffer_load_dwordx4 v[64:67], v12, s[80:83], s27 offen
    s_add_u32 s27, s27, 8192
    buffer_load_dwordx4 v[68:71], v12, s[80:83], s27 offen
    s_add_u32 s27, s27, 8192
    buffer_load_dwordx4 v[72:75], v12, s[80:83], s27 offen
    s_add_u32 s27, s27, 8192
    buffer_load_dwordx4 v[76:79], v12, s[80:83], s27 offen
    s_waitcnt lgkmcnt(0)
    s_barrier
    ds_read_b128 a[192:195], v5 offset:0
    ds_read_b128 v[208:211], v5 offset:1024
    ds_read_b128 a[196:199], v5 offset:2048
    ds_read_b128 v[212:215], v5 offset:3072
    ds_read_b128 a[200:203], v5 offset:4096
    ds_read_b128 v[216:219], v5 offset:5120
    ds_read_b128 a[204:207], v5 offset:6144
    ds_read_b128 v[220:223], v5 offset:7168
    s_lshl_b32 s27, s21, 11
    s_add_u32 s27, s27, 0
    v_add_u32 v13, s27, v0
    s_waitcnt vmcnt(14)
    v_perm_b32 v80, v20, v16, s44
    s_waitcnt vmcnt(12)
    v_perm_b32 v81, v28, v24, s44
    s_waitcnt vmcnt(10)
    v_perm_b32 v82, v36, v32, s44
    s_waitcnt vmcnt(8)
    v_perm_b32 v83, v44, v40, s44
    ds_write_b128 v13, v[80:83] offset:0
    v_perm_b32 v84, v20, v16, s45
    v_perm_b32 v85, v28, v24, s45
    v_perm_b32 v86, v36, v32, s45
    v_perm_b32 v87, v44, v40, s45
    ds_write_b128 v13, v[84:87] offset:1024
    v_perm_b32 v80, v21, v17, s44
    v_perm_b32 v81, v29, v25, s44
    v_perm_b32 v82, v37, v33, s44
    v_perm_b32 v83, v45, v41, s44
    ds_write_b128 v13, v[80:83] offset:8192
    v_perm_b32 v84, v21, v17, s45
    v_perm_b32 v85, v29, v25, s45
    v_perm_b32 v86, v37, v33, s45
    v_perm_b32 v87, v45, v41, s45
    ds_write_b128 v13, v[84:87] offset:9216
    v_perm_b32 v80, v22, v18, s44
    v_perm_b32 v81, v30, v26, s44
    v_perm_b32 v82, v38, v34, s44
    v_perm_b32 v83, v46, v42, s44
    ds_write_b128 v13, v[80:83] offset:16384
    v_perm_b32 v84, v22, v18, s45
    v_perm_b32 v85, v30, v26, s45
    v_perm_b32 v86, v38, v34, s45
    v_perm_b32 v87, v46, v42, s45
    ds_write_b128 v13, v[84:87] offset:17408
    v_perm_b32 v80, v23, v19, s44
    v_perm_b32 v81, v31, v27, s44
    v_perm_b32 v82, v39, v35, s44
    v_perm_b32 v83, v47, v43, s44
    ds_write_b128 v13, v[80:83] offset:24576
    v_perm_b32 v84, v23, v19, s45
    v_perm_b32 v85, v31, v27, s45
    v_perm_b32 v86, v39, v35, s45
    v_perm_b32 v87, v47, v43, s45
    ds_write_b128 v13, v[84:87] offset:25600
    s_waitcnt lgkmcnt(0)
    s_barrier
    ds_read_b128 a[208:211], v4 offset:0
    ds_read_b128 v[224:227], v4 offset:1024
    ds_read_b128 a[212:215], v4 offset:2048
    ds_read_b128 v[228:231], v4 offset:3072
    ds_read_b128 a[216:219], v4 offset:4096
    ds_read_b128 v[232:235], v4 offset:5120
    ds_read_b128 a[220:223], v4 offset:6144
    ds_read_b128 v[236:239], v4 offset:7168
    s_lshl_b32 s27, s21, 11
    s_add_u32 s27, s27, 32768
    v_add_u32 v13, s27, v0
    s_waitcnt vmcnt(6)
    v_perm_b32 v80, v52, v48, s44
    s_waitcnt vmcnt(4)
    v_perm_b32 v81, v60, v56, s44
    s_waitcnt vmcnt(2)
    v_perm_b32 v82, v68, v64, s44
    s_waitcnt vmcnt(0)
    v_perm_b32 v83, v76, v72, s44
    ds_write_b128 v13, v[80:83] offset:0
    v_perm_b32 v84, v52, v48, s45
    v_perm_b32 v85, v60, v56, s45
    v_perm_b32 v86, v68, v64, s45
    v_perm_b32 v87, v76, v72, s45
    ds_write_b128 v13, v[84:87] offset:1024
    v_perm_b32 v80, v53, v49, s44
    v_perm_b32 v81, v61, v57, s44
    v_perm_b32 v82, v69, v65, s44
    v_perm_b32 v83, v77, v73, s44
    ds_write_b128 v13, v[80:83] offset:8192
    v_perm_b32 v84, v53, v49, s45
    v_perm_b32 v85, v61, v57, s45
    v_perm_b32 v86, v69, v65, s45
    v_perm_b32 v87, v77, v73, s45
    ds_write_b128 v13, v[84:87] offset:9216
    v_perm_b32 v80, v54, v50, s44
    v_perm_b32 v81, v62, v58, s44
    v_perm_b32 v82, v70, v66, s44
    v_perm_b32 v83, v78, v74, s44
    ds_write_b128 v13, v[80:83] offset:16384
    v_perm_b32 v84, v54, v50, s45
    v_perm_b32 v85, v62, v58, s45
    v_perm_b32 v86, v70, v66, s45
    v_perm_b32 v87, v78, v74, s45
    ds_write_b128 v13, v[84:87] offset:17408
    v_perm_b32 v80, v55, v51, s44
    v_perm_b32 v81, v63, v59, s44
    v_perm_b32 v82, v71, v67, s44
    v_perm_b32 v83, v79, v75, s44
    ds_write_b128 v13, v[80:83] offset:24576
    v_perm_b32 v84, v55, v51, s45
    v_perm_b32 v85, v63, v59, s45
    v_perm_b32 v86, v71, v67, s45
    v_perm_b32 v87, v79, v75, s45
    ds_write_b128 v13, v[84:87] offset:25600
    s_waitcnt lgkmcnt(0)
    s_barrier
    ds_read_b128 a[224:227], v5 offset:0
    ds_read_b128 v[240:243], v5 offset:1024
    ds_read_b128 a[228:231], v5 offset:2048
    ds_read_b128 v[244:247], v5 offset:3072
    ds_read_b128 a[232:235], v5 offset:4096
    ds_read_b128 v[248:251], v5 offset:5120
    ds_read_b128 a[236:239], v5 offset:6144
    ds_read_b128 v[252:255], v5 offset:7168
    s_waitcnt lgkmcnt(0)
    s_branch M_lw_done
M_lw_chain:
    v_lshrrev_b32 v12, 8, v0
    v_lshlrev_b32 v12, 16, v12
    v_and_b32 v14, 0xf0, v0
    v_add_u32 v12, v12, v14
    s_lshl_b32 s46, s22, 8
    s_lshl_b32 s27, s21, 13
    s_add_u32 s28, s27, 106496
    v_add_u32 v4, s28, v0
    s_add_u32 s28, s27, 24576
    v_add_u32 v5, s28, v0
    s_lshl_b32 s27, s21, 12
    v_add_u32 v6, s27, v0
    s_mul_i32 s27, s21, 20480
    s_add_u32 s27, s27, 24576
    v_add_u32 v7, s27, v0
    s_mul_i32 s48, s20, 10
    s_and_b32 s27, s21, 1
    s_add_u32 s49, s27, 10
    s_sub_u32 s49, s49, s48
    s_add_u32 s48, s48, s27
    v_lshrrev_b32 v8, 9, v0
    v_lshlrev_b32 v8, 4, v8
    v_bfe_u32 v14, v0, 8, 1
    v_add_u32 v8, v8, v14
    v_mul_u32_u24 v8, 2560, v8
    s_and_b32 s47, s21, 1
    s_lshl_b32 s47, s47, 6
    s_lshr_b32 s27, s21, 1
    s_lshl_b32 s27, s27, 2
    s_add_u32 s47, s47, s27
    s_lshl_b32 s27, s22, 7
    s_add_u32 s47, s47, s27
    s_mul_i32 s47, s47, 1280
    s_mul_i32 s27, s20, 640
    s_add_u32 s47, s47, s27
    v_and_b32 v14, 0xf0, v0
    v_add_u32 v8, v8, v14
    s_mov_b32 s90, 5242880
    s_mov_b32 s91, 0x00020000
    s_mov_b32 s44, 0x05040100
    s_mov_b32 s45, 0x07060302
    s_add_u32 s27, s47, 0
    buffer_load_dwordx4 v[16:19], v8, s[84:87], s27 offen
    s_add_u32 s27, s47, 10240
    buffer_load_dwordx4 v[20:23], v8, s[84:87], s27 offen
    s_add_u32 s27, s47, 1280
    buffer_load_dwordx4 v[24:27], v8, s[84:87], s27 offen
    s_add_u32 s27, s47, 11520
    buffer_load_dwordx4 v[28:31], v8, s[84:87], s27 offen
    s_add_u32 s27, s47, 20480
    buffer_load_dwordx4 v[32:35], v8, s[84:87], s27 offen
    s_add_u32 s27, s47, 30720
    buffer_load_dwordx4 v[36:39], v8, s[84:87], s27 offen
    s_add_u32 s27, s47, 21760
    buffer_load_dwordx4 v[40:43], v8, s[84:87], s27 offen
    s_add_u32 s27, s47, 32000
    buffer_load_dwordx4 v[44:47], v8, s[84:87], s27 offen
    s_add_u32 s27, s47, 256
    buffer_load_dwordx4 v[48:51], v8, s[84:87], s27 offen
    s_add_u32 s27, s47, 10496
    buffer_load_dwordx4 v[52:55], v8, s[84:87], s27 offen
    s_add_u32 s27, s47, 1536
    buffer_load_dwordx4 v[56:59], v8, s[84:87], s27 offen
    s_add_u32 s27, s47, 11776
    buffer_load_dwordx4 v[60:63], v8, s[84:87], s27 offen
    s_add_u32 s27, s47, 20736
    buffer_load_dwordx4 v[64:67], v8, s[84:87], s27 offen
    s_add_u32 s27, s47, 30976
    buffer_load_dwordx4 v[68:71], v8, s[84:87], s27 offen
    s_add_u32 s27, s47, 22016
    buffer_load_dwordx4 v[72:75], v8, s[84:87], s27 offen
    s_add_u32 s27, s47, 32256
    buffer_load_dwordx4 v[76:79], v8, s[84:87], s27 offen
    v_and_b32 v13, 0x300, v0
    s_lshl_b32 s27, s21, 10
    s_add_u32 s27, s27, 24576
    v_add_u32 v13, s27, v13
    v_bfe_u32 v14, v0, 7, 1
    v_mul_u32_u24 v14, 20480, v14
    v_add_u32 v13, v13, v14
    v_bfe_u32 v14, v0, 5, 2
    v_lshl_add_u32 v13, v14, 6, v13
    v_and_b32 v14, 16, v0
    v_add_u32 v13, v13, v14
    s_waitcnt vmcnt(14)
    v_perm_b32 v80, v20, v16, s44
    s_waitcnt vmcnt(12)
    v_perm_b32 v81, v28, v24, s44
    s_waitcnt vmcnt(10)
    v_perm_b32 v82, v36, v32, s44
    s_waitcnt vmcnt(8)
    v_perm_b32 v83, v44, v40, s44
    ds_write_b128 v13, v[80:83] offset:0
    v_perm_b32 v84, v20, v16, s45
    v_perm_b32 v85, v28, v24, s45
    v_perm_b32 v86, v36, v32, s45
    v_perm_b32 v87, v44, v40, s45
    ds_write_b128 v13, v[84:87] offset:4096
    v_perm_b32 v80, v21, v17, s44
    v_perm_b32 v81, v29, v25, s44
    v_perm_b32 v82, v37, v33, s44
    v_perm_b32 v83, v45, v41, s44
    ds_write_b128 v13, v[80:83] offset:32
    v_perm_b32 v84, v21, v17, s45
    v_perm_b32 v85, v29, v25, s45
    v_perm_b32 v86, v37, v33, s45
    v_perm_b32 v87, v45, v41, s45
    ds_write_b128 v13, v[84:87] offset:4128
    v_perm_b32 v80, v22, v18, s44
    v_perm_b32 v81, v30, v26, s44
    v_perm_b32 v82, v38, v34, s44
    v_perm_b32 v83, v46, v42, s44
    ds_write_b128 v13, v[80:83] offset:8192
    v_perm_b32 v84, v22, v18, s45
    v_perm_b32 v85, v30, v26, s45
    v_perm_b32 v86, v38, v34, s45
    v_perm_b32 v87, v46, v42, s45
    ds_write_b128 v13, v[84:87] offset:12288
    v_perm_b32 v80, v23, v19, s44
    v_perm_b32 v81, v31, v27, s44
    v_perm_b32 v82, v39, v35, s44
    v_perm_b32 v83, v47, v43, s44
    ds_write_b128 v13, v[80:83] offset:8224
    v_perm_b32 v84, v23, v19, s45
    v_perm_b32 v85, v31, v27, s45
    v_perm_b32 v86, v39, v35, s45
    v_perm_b32 v87, v47, v43, s45
    ds_write_b128 v13, v[84:87] offset:12320
    s_mov_b32 exec_lo, 0x00ff00ff
    s_mov_b32 exec_hi, 0x00ff00ff
    s_add_u32 s27, s47, 512
    buffer_load_dwordx4 v[16:19], v8, s[84:87], s27 offen
    s_add_u32 s27, s47, 10752
    buffer_load_dwordx4 v[20:23], v8, s[84:87], s27 offen
    s_add_u32 s27, s47, 1792
    buffer_load_dwordx4 v[24:27], v8, s[84:87], s27 offen
    s_add_u32 s27, s47, 12032
    buffer_load_dwordx4 v[28:31], v8, s[84:87], s27 offen
    s_add_u32 s27, s47, 20992
    buffer_load_dwordx4 v[32:35], v8, s[84:87], s27 offen
    s_add_u32 s27, s47, 31232
    buffer_load_dwordx4 v[36:39], v8, s[84:87], s27 offen
    s_add_u32 s27, s47, 22272
    buffer_load_dwordx4 v[40:43], v8, s[84:87], s27 offen
    s_add_u32 s27, s47, 32512
    buffer_load_dwordx4 v[44:47], v8, s[84:87], s27 offen
    s_mov_b64 exec, -1
    v_and_b32 v13, 0x300, v0
    s_lshl_b32 s27, s21, 10
    s_add_u32 s27, s27, 65536
    v_add_u32 v13, s27, v13
    v_bfe_u32 v14, v0, 7, 1
    v_mul_u32_u24 v14, 20480, v14
    v_add_u32 v13, v13, v14
    v_bfe_u32 v14, v0, 5, 2
    v_lshl_add_u32 v13, v14, 6, v13
    v_and_b32 v14, 16, v0
    v_add_u32 v13, v13, v14
    s_waitcnt vmcnt(14)
    v_perm_b32 v80, v52, v48, s44
    s_waitcnt vmcnt(12)
    v_perm_b32 v81, v60, v56, s44
    s_waitcnt vmcnt(10)
    v_perm_b32 v82, v68, v64, s44
    s_waitcnt vmcnt(8)
    v_perm_b32 v83, v76, v72, s44
    ds_write_b128 v13, v[80:83] offset:0
    v_perm_b32 v84, v52, v48, s45
    v_perm_b32 v85, v60, v56, s45
    v_perm_b32 v86, v68, v64, s45
    v_perm_b32 v87, v76, v72, s45
    ds_write_b128 v13, v[84:87] offset:4096
    v_perm_b32 v80, v53, v49, s44
    v_perm_b32 v81, v61, v57, s44
    v_perm_b32 v82, v69, v65, s44
    v_perm_b32 v83, v77, v73, s44
    ds_write_b128 v13, v[80:83] offset:32
    v_perm_b32 v84, v53, v49, s45
    v_perm_b32 v85, v61, v57, s45
    v_perm_b32 v86, v69, v65, s45
    v_perm_b32 v87, v77, v73, s45
    ds_write_b128 v13, v[84:87] offset:4128
    v_perm_b32 v80, v54, v50, s44
    v_perm_b32 v81, v62, v58, s44
    v_perm_b32 v82, v70, v66, s44
    v_perm_b32 v83, v78, v74, s44
    ds_write_b128 v13, v[80:83] offset:8192
    v_perm_b32 v84, v54, v50, s45
    v_perm_b32 v85, v62, v58, s45
    v_perm_b32 v86, v70, v66, s45
    v_perm_b32 v87, v78, v74, s45
    ds_write_b128 v13, v[84:87] offset:12288
    v_perm_b32 v80, v55, v51, s44
    v_perm_b32 v81, v63, v59, s44
    v_perm_b32 v82, v71, v67, s44
    v_perm_b32 v83, v79, v75, s44
    ds_write_b128 v13, v[80:83] offset:8224
    v_perm_b32 v84, v55, v51, s45
    v_perm_b32 v85, v63, v59, s45
    v_perm_b32 v86, v71, v67, s45
    v_perm_b32 v87, v79, v75, s45
    ds_write_b128 v13, v[84:87] offset:12320
    s_cmp_lt_u32 s21, 2
    s_cselect_b32 s26, s48, s48
    s_cselect_b32 s27, 0, 2
    s_cselect_b64 s[88:89], s[76:77], s[72:73]
    s_add_u32 s26, s26, s27
    s_lshl_b32 s27, s26, 18
    s_add_u32 s27, s27, s46
    buffer_load_dwordx4 v[48:51], v12, s[88:91], s27 offen
    s_add_u32 s27, s27, 8192
    buffer_load_dwordx4 v[52:55], v12, s[88:91], s27 offen
    s_add_u32 s27, s27, 8192
    buffer_load_dwordx4 v[56:59], v12, s[88:91], s27 offen
    s_add_u32 s27, s27, 8192
    buffer_load_dwordx4 v[60:63], v12, s[88:91], s27 offen
    s_add_u32 s27, s27, 8192
    buffer_load_dwordx4 v[64:67], v12, s[88:91], s27 offen
    s_add_u32 s27, s27, 8192
    buffer_load_dwordx4 v[68:71], v12, s[88:91], s27 offen
    s_add_u32 s27, s27, 8192
    buffer_load_dwordx4 v[72:75], v12, s[88:91], s27 offen
    s_add_u32 s27, s27, 8192
    buffer_load_dwordx4 v[76:79], v12, s[88:91], s27 offen
    v_and_b32 v13, 0x300, v0
    s_lshl_b32 s27, s21, 10
    s_add_u32 s27, s27, 40960
    v_add_u32 v13, s27, v13
    v_bfe_u32 v14, v0, 5, 2
    v_mul_u32_u24 v14, 20480, v14
    v_add_u32 v13, v13, v14
    v_bfe_u32 v14, v0, 4, 1
    v_lshl_add_u32 v13, v14, 6, v13
    s_mov_b32 exec_lo, 0x00ff00ff
    s_mov_b32 exec_hi, 0x00ff00ff
    s_waitcnt vmcnt(14)
    v_perm_b32 v80, v20, v16, s44
    s_waitcnt vmcnt(12)
    v_perm_b32 v81, v28, v24, s44
    s_waitcnt vmcnt(10)
    v_perm_b32 v82, v36, v32, s44
    s_waitcnt vmcnt(8)
    v_perm_b32 v83, v44, v40, s44
    ds_write_b128 v13, v[80:83] offset:0
    v_perm_b32 v84, v20, v16, s45
    v_perm_b32 v85, v28, v24, s45
    v_perm_b32 v86, v36, v32, s45
    v_perm_b32 v87, v44, v40, s45
    ds_write_b128 v13, v[84:87] offset:16
    v_perm_b32 v80, v21, v17, s44
    v_perm_b32 v81, v29, v25, s44
    v_perm_b32 v82, v37, v33, s44
    v_perm_b32 v83, v45, v41, s44
    ds_write_b128 v13, v[80:83] offset:128
    v_perm_b32 v84, v21, v17, s45
    v_perm_b32 v85, v29, v25, s45
    v_perm_b32 v86, v37, v33, s45
    v_perm_b32 v87, v45, v41, s45
    ds_write_b128 v13, v[84:87] offset:144
    v_perm_b32 v80, v22, v18, s44
    v_perm_b32 v81, v30, v26, s44
    v_perm_b32 v82, v38, v34, s44
    v_perm_b32 v83, v46, v42, s44
    ds_write_b128 v13, v[80:83] offset:32
    v_perm_b32 v84, v22, v18, s45
    v_perm_b32 v85, v30, v26, s45
    v_perm_b32 v86, v38, v34, s45
    v_perm_b32 v87, v46, v42, s45
    ds_write_b128 v13, v[84:87] offset:48
    v_perm_b32 v80, v23, v19, s44
    v_perm_b32 v81, v31, v27, s44
    v_perm_b32 v82, v39, v35, s44
    v_perm_b32 v83, v47, v43, s44
    ds_write_b128 v13, v[80:83] offset:160
    v_perm_b32 v84, v23, v19, s45
    v_perm_b32 v85, v31, v27, s45
    v_perm_b32 v86, v39, v35, s45
    v_perm_b32 v87, v47, v43, s45
    ds_write_b128 v13, v[84:87] offset:176
    s_mov_b64 exec, -1
    s_cmp_lt_u32 s21, 2
    s_cselect_b32 s26, s48, s48
    s_cselect_b32 s27, 4, 6
    s_cselect_b64 s[88:89], s[72:73], s[76:77]
    s_add_u32 s26, s26, s27
    s_lshl_b32 s27, s26, 18
    s_add_u32 s27, s27, s46
    buffer_load_dwordx4 v[16:19], v12, s[88:91], s27 offen
    s_add_u32 s27, s27, 8192
    buffer_load_dwordx4 v[20:23], v12, s[88:91], s27 offen
    s_add_u32 s27, s27, 8192
    buffer_load_dwordx4 v[24:27], v12, s[88:91], s27 offen
    s_add_u32 s27, s27, 8192
    buffer_load_dwordx4 v[28:31], v12, s[88:91], s27 offen
    s_add_u32 s27, s27, 8192
    buffer_load_dwordx4 v[32:35], v12, s[88:91], s27 offen
    s_add_u32 s27, s27, 8192
    buffer_load_dwordx4 v[36:39], v12, s[88:91], s27 offen
    s_add_u32 s27, s27, 8192
    buffer_load_dwordx4 v[40:43], v12, s[88:91], s27 offen
    s_add_u32 s27, s27, 8192
    buffer_load_dwordx4 v[44:47], v12, s[88:91], s27 offen
    s_waitcnt lgkmcnt(0)
    s_barrier
    ds_read_b128 v[160:163], v7 offset:0
    ds_read_b128 v[164:167], v7 offset:1024
    ds_read_b128 v[152:155], v7 offset:2048
    ds_read_b128 v[156:159], v7 offset:3072
    ds_read_b128 v[144:147], v7 offset:4096
    ds_read_b128 v[148:151], v7 offset:5120
    ds_read_b128 v[136:139], v7 offset:6144
    ds_read_b128 v[140:143], v7 offset:7168
    ds_read_b128 v[128:131], v7 offset:8192
    ds_read_b128 v[132:135], v7 offset:9216
    ds_read_b128 v[120:123], v7 offset:10240
    ds_read_b128 v[124:127], v7 offset:11264
    ds_read_b128 v[112:115], v7 offset:12288
    ds_read_b128 v[116:119], v7 offset:13312
    ds_read_b128 v[104:107], v7 offset:14336
    ds_read_b128 v[108:111], v7 offset:15360
    ds_read_b128 v[96:99], v7 offset:16384
    ds_read_b128 v[100:103], v7 offset:17408
    ds_read_b128 v[88:91], v7 offset:18432
    ds_read_b128 v[92:95], v7 offset:19456
    s_lshl_b32 s27, s21, 11
    s_add_u32 s27, s27, 106496
    v_add_u32 v13, s27, v0
    s_waitcnt vmcnt(14)
    v_perm_b32 v80, v52, v48, s44
    s_waitcnt vmcnt(12)
    v_perm_b32 v81, v60, v56, s44
    s_waitcnt vmcnt(10)
    v_perm_b32 v82, v68, v64, s44
    s_waitcnt vmcnt(8)
    v_perm_b32 v83, v76, v72, s44
    ds_write_b128 v13, v[80:83] offset:0
    v_perm_b32 v84, v52, v48, s45
    v_perm_b32 v85, v60, v56, s45
    v_perm_b32 v86, v68, v64, s45
    v_perm_b32 v87, v76, v72, s45
    ds_write_b128 v13, v[84:87] offset:1024
    v_perm_b32 v80, v53, v49, s44
    v_perm_b32 v81, v61, v57, s44
    v_perm_b32 v82, v69, v65, s44
    v_perm_b32 v83, v77, v73, s44
    ds_write_b128 v13, v[80:83] offset:8192
    v_perm_b32 v84, v53, v49, s45
    v_perm_b32 v85, v61, v57, s45
    v_perm_b32 v86, v69, v65, s45
    v_perm_b32 v87, v77, v73, s45
    ds_write_b128 v13, v[84:87] offset:9216
    v_perm_b32 v80, v54, v50, s44
    v_perm_b32 v81, v62, v58, s44
    v_perm_b32 v82, v70, v66, s44
    v_perm_b32 v83, v78, v74, s44
    ds_write_b128 v13, v[80:83] offset:16384
    v_perm_b32 v84, v54, v50, s45
    v_perm_b32 v85, v62, v58, s45
    v_perm_b32 v86, v70, v66, s45
    v_perm_b32 v87, v78, v74, s45
    ds_write_b128 v13, v[84:87] offset:17408
    v_perm_b32 v80, v55, v51, s44
    v_perm_b32 v81, v63, v59, s44
    v_perm_b32 v82, v71, v67, s44
    v_perm_b32 v83, v79, v75, s44
    ds_write_b128 v13, v[80:83] offset:24576
    v_perm_b32 v84, v55, v51, s45
    v_perm_b32 v85, v63, v59, s45
    v_perm_b32 v86, v71, v67, s45
    v_perm_b32 v87, v79, v75, s45
    ds_write_b128 v13, v[84:87] offset:25600
    s_cmp_lt_u32 s21, 2
    s_cselect_b32 s26, s49, s49
    s_cselect_b32 s27, 0, 6
    s_cselect_b64 s[88:89], s[72:73], s[72:73]
    s_add_u32 s26, s26, s27
    s_lshl_b32 s27, s26, 18
    s_add_u32 s27, s27, s46
    buffer_load_dwordx4 v[48:51], v12, s[88:91], s27 offen
    s_add_u32 s27, s27, 8192
    buffer_load_dwordx4 v[52:55], v12, s[88:91], s27 offen
    s_add_u32 s27, s27, 8192
    buffer_load_dwordx4 v[56:59], v12, s[88:91], s27 offen
    s_add_u32 s27, s27, 8192
    buffer_load_dwordx4 v[60:63], v12, s[88:91], s27 offen
    s_add_u32 s27, s27, 8192
    buffer_load_dwordx4 v[64:67], v12, s[88:91], s27 offen
    s_add_u32 s27, s27, 8192
    buffer_load_dwordx4 v[68:71], v12, s[88:91], s27 offen
    s_add_u32 s27, s27, 8192
    buffer_load_dwordx4 v[72:75], v12, s[88:91], s27 offen
    s_add_u32 s27, s27, 8192
    buffer_load_dwordx4 v[76:79], v12, s[88:91], s27 offen
    s_waitcnt lgkmcnt(0)
    s_barrier
    ds_read_b128 a[248:251], v4 offset:0
    ds_read_b128 a[240:243], v4 offset:1024
    ds_read_b128 a[252:255], v4 offset:2048
    ds_read_b128 a[244:247], v4 offset:3072
    ds_read_b128 a[224:227], v4 offset:4096
    ds_read_b128 a[216:219], v4 offset:5120
    ds_read_b128 a[228:231], v4 offset:6144
    ds_read_b128 a[220:223], v4 offset:7168
    s_lshl_b32 s27, s21, 11
    s_add_u32 s27, s27, 24576
    v_add_u32 v13, s27, v0
    s_waitcnt vmcnt(14)
    v_perm_b32 v80, v20, v16, s44
    s_waitcnt vmcnt(12)
    v_perm_b32 v81, v28, v24, s44
    s_waitcnt vmcnt(10)
    v_perm_b32 v82, v36, v32, s44
    s_waitcnt vmcnt(8)
    v_perm_b32 v83, v44, v40, s44
    ds_write_b128 v13, v[80:83] offset:0
    v_perm_b32 v84, v20, v16, s45
    v_perm_b32 v85, v28, v24, s45
    v_perm_b32 v86, v36, v32, s45
    v_perm_b32 v87, v44, v40, s45
    ds_write_b128 v13, v[84:87] offset:1024
    v_perm_b32 v80, v21, v17, s44
    v_perm_b32 v81, v29, v25, s44
    v_perm_b32 v82, v37, v33, s44
    v_perm_b32 v83, v45, v41, s44
    ds_write_b128 v13, v[80:83] offset:8192
    v_perm_b32 v84, v21, v17, s45
    v_perm_b32 v85, v29, v25, s45
    v_perm_b32 v86, v37, v33, s45
    v_perm_b32 v87, v45, v41, s45
    ds_write_b128 v13, v[84:87] offset:9216
    v_perm_b32 v80, v22, v18, s44
    v_perm_b32 v81, v30, v26, s44
    v_perm_b32 v82, v38, v34, s44
    v_perm_b32 v83, v46, v42, s44
    ds_write_b128 v13, v[80:83] offset:16384
    v_perm_b32 v84, v22, v18, s45
    v_perm_b32 v85, v30, v26, s45
    v_perm_b32 v86, v38, v34, s45
    v_perm_b32 v87, v46, v42, s45
    ds_write_b128 v13, v[84:87] offset:17408
    v_perm_b32 v80, v23, v19, s44
    v_perm_b32 v81, v31, v27, s44
    v_perm_b32 v82, v39, v35, s44
    v_perm_b32 v83, v47, v43, s44
    ds_write_b128 v13, v[80:83] offset:24576
    v_perm_b32 v84, v23, v19, s45
    v_perm_b32 v85, v31, v27, s45
    v_perm_b32 v86, v39, v35, s45
    v_perm_b32 v87, v47, v43, s45
    ds_write_b128 v13, v[84:87] offset:25600
    s_cmp_lt_u32 s21, 2
    s_cselect_b32 s26, s49, s49
    s_cselect_b32 s27, 2, 8
    s_cselect_b64 s[88:89], s[76:77], s[76:77]
    s_add_u32 s26, s26, s27
    s_lshl_b32 s27, s26, 18
    s_add_u32 s27, s27, s46
    buffer_load_dwordx4 v[16:19], v12, s[88:91], s27 offen
    s_add_u32 s27, s27, 8192
    buffer_load_dwordx4 v[20:23], v12, s[88:91], s27 offen
    s_add_u32 s27, s27, 8192
    buffer_load_dwordx4 v[24:27], v12, s[88:91], s27 offen
    s_add_u32 s27, s27, 8192
    buffer_load_dwordx4 v[28:31], v12, s[88:91], s27 offen
    s_add_u32 s27, s27, 8192
    buffer_load_dwordx4 v[32:35], v12, s[88:91], s27 offen
    s_add_u32 s27, s27, 8192
    buffer_load_dwordx4 v[36:39], v12, s[88:91], s27 offen
    s_add_u32 s27, s27, 8192
    buffer_load_dwordx4 v[40:43], v12, s[88:91], s27 offen
    s_add_u32 s27, s27, 8192
    buffer_load_dwordx4 v[44:47], v12, s[88:91], s27 offen
    s_waitcnt lgkmcnt(0)
    s_barrier
    ds_read_b128 a[192:195], v5 offset:0
    ds_read_b128 a[184:187], v5 offset:1024
    ds_read_b128 a[196:199], v5 offset:2048
    ds_read_b128 a[188:191], v5 offset:3072
    ds_read_b128 a[160:163], v5 offset:4096
    ds_read_b128 a[152:155], v5 offset:5120
    ds_read_b128 a[164:167], v5 offset:6144
    ds_read_b128 a[156:159], v5 offset:7168
    s_lshl_b32 s27, s21, 11
    s_add_u32 s27, s27, 106496
    v_add_u32 v13, s27, v0
    s_waitcnt vmcnt(14)
    v_perm_b32 v80, v52, v48, s44
    s_waitcnt vmcnt(12)
    v_perm_b32 v81, v60, v56, s44
    s_waitcnt vmcnt(10)
    v_perm_b32 v82, v68, v64, s44
    s_waitcnt vmcnt(8)
    v_perm_b32 v83, v76, v72, s44
    ds_write_b128 v13, v[80:83] offset:0
    v_perm_b32 v84, v52, v48, s45
    v_perm_b32 v85, v60, v56, s45
    v_perm_b32 v86, v68, v64, s45
    v_perm_b32 v87, v76, v72, s45
    ds_write_b128 v13, v[84:87] offset:1024
    v_perm_b32 v80, v53, v49, s44
    v_perm_b32 v81, v61, v57, s44
    v_perm_b32 v82, v69, v65, s44
    v_perm_b32 v83, v77, v73, s44
    ds_write_b128 v13, v[80:83] offset:8192
    v_perm_b32 v84, v53, v49, s45
    v_perm_b32 v85, v61, v57, s45
    v_perm_b32 v86, v69, v65, s45
    v_perm_b32 v87, v77, v73, s45
    ds_write_b128 v13, v[84:87] offset:9216
    v_perm_b32 v80, v54, v50, s44
    v_perm_b32 v81, v62, v58, s44
    v_perm_b32 v82, v70, v66, s44
    v_perm_b32 v83, v78, v74, s44
    ds_write_b128 v13, v[80:83] offset:16384
    v_perm_b32 v84, v54, v50, s45
    v_perm_b32 v85, v62, v58, s45
    v_perm_b32 v86, v70, v66, s45
    v_perm_b32 v87, v78, v74, s45
    ds_write_b128 v13, v[84:87] offset:17408
    v_perm_b32 v80, v55, v51, s44
    v_perm_b32 v81, v63, v59, s44
    v_perm_b32 v82, v71, v67, s44
    v_perm_b32 v83, v79, v75, s44
    ds_write_b128 v13, v[80:83] offset:24576
    v_perm_b32 v84, v55, v51, s45
    v_perm_b32 v85, v63, v59, s45
    v_perm_b32 v86, v71, v67, s45
    v_perm_b32 v87, v79, v75, s45
    ds_write_b128 v13, v[84:87] offset:25600
    s_cmp_lt_u32 s21, 2
    s_cselect_b32 s26, s49, s49
    s_cselect_b32 s27, 4, 6
    s_cselect_b64 s[88:89], s[80:81], s[80:81]
    s_add_u32 s26, s26, s27
    s_lshl_b32 s27, s26, 18
    s_add_u32 s27, s27, s46
    buffer_load_dwordx4 v[48:51], v12, s[88:91], s27 offen
    s_add_u32 s27, s27, 8192
    buffer_load_dwordx4 v[52:55], v12, s[88:91], s27 offen
    s_add_u32 s27, s27, 8192
    buffer_load_dwordx4 v[56:59], v12, s[88:91], s27 offen
    s_add_u32 s27, s27, 8192
    buffer_load_dwordx4 v[60:63], v12, s[88:91], s27 offen
    s_add_u32 s27, s27, 8192
    buffer_load_dwordx4 v[64:67], v12, s[88:91], s27 offen
    s_add_u32 s27, s27, 8192
    buffer_load_dwordx4 v[68:71], v12, s[88:91], s27 offen
    s_add_u32 s27, s27, 8192
    buffer_load_dwordx4 v[72:75], v12, s[88:91], s27 offen
    s_add_u32 s27, s27, 8192
    buffer_load_dwordx4 v[76:79], v12, s[88:91], s27 offen
    s_waitcnt lgkmcnt(0)
    s_barrier
    ds_read_b128 a[128:131], v4 offset:0
    ds_read_b128 a[120:123], v4 offset:1024
    ds_read_b128 a[132:135], v4 offset:2048
    ds_read_b128 a[124:127], v4 offset:3072
    ds_read_b128 a[96:99], v4 offset:4096
    ds_read_b128 a[88:91], v4 offset:5120
    ds_read_b128 a[100:103], v4 offset:6144
    ds_read_b128 a[92:95], v4 offset:7168
    s_lshl_b32 s27, s21, 11
    s_add_u32 s27, s27, 24576
    v_add_u32 v13, s27, v0
    s_waitcnt vmcnt(14)
    v_perm_b32 v80, v20, v16, s44
    s_waitcnt vmcnt(12)
    v_perm_b32 v81, v28, v24, s44
    s_waitcnt vmcnt(10)
    v_perm_b32 v82, v36, v32, s44
    s_waitcnt vmcnt(8)
    v_perm_b32 v83, v44, v40, s44
    ds_write_b128 v13, v[80:83] offset:0
    v_perm_b32 v84, v20, v16, s45
    v_perm_b32 v85, v28, v24, s45
    v_perm_b32 v86, v36, v32, s45
    v_perm_b32 v87, v44, v40, s45
    ds_write_b128 v13, v[84:87] offset:1024
    v_perm_b32 v80, v21, v17, s44
    v_perm_b32 v81, v29, v25, s44
    v_perm_b32 v82, v37, v33, s44
    v_perm_b32 v83, v45, v41, s44
    ds_write_b128 v13, v[80:83] offset:8192
    v_perm_b32 v84, v21, v17, s45
    v_perm_b32 v85, v29, v25, s45
    v_perm_b32 v86, v37, v33, s45
    v_perm_b32 v87, v45, v41, s45
    ds_write_b128 v13, v[84:87] offset:9216
    v_perm_b32 v80, v22, v18, s44
    v_perm_b32 v81, v30, v26, s44
    v_perm_b32 v82, v38, v34, s44
    v_perm_b32 v83, v46, v42, s44
    ds_write_b128 v13, v[80:83] offset:16384
    v_perm_b32 v84, v22, v18, s45
    v_perm_b32 v85, v30, v26, s45
    v_perm_b32 v86, v38, v34, s45
    v_perm_b32 v87, v46, v42, s45
    ds_write_b128 v13, v[84:87] offset:17408
    v_perm_b32 v80, v23, v19, s44
    v_perm_b32 v81, v31, v27, s44
    v_perm_b32 v82, v39, v35, s44
    v_perm_b32 v83, v47, v43, s44
    ds_write_b128 v13, v[80:83] offset:24576
    v_perm_b32 v84, v23, v19, s45
    v_perm_b32 v85, v31, v27, s45
    v_perm_b32 v86, v39, v35, s45
    v_perm_b32 v87, v47, v43, s45
    ds_write_b128 v13, v[84:87] offset:25600
    s_cmp_lt_u32 s21, 2
    s_cselect_b32 s26, s49, s48
    s_cselect_b32 s27, 8, 4
    s_cselect_b64 s[88:89], s[80:81], s[80:81]
    s_add_u32 s26, s26, s27
    s_lshl_b32 s27, s26, 18
    s_add_u32 s27, s27, s46
    buffer_load_dwordx4 v[16:19], v12, s[88:91], s27 offen
    s_add_u32 s27, s27, 8192
    buffer_load_dwordx4 v[20:23], v12, s[88:91], s27 offen
    s_add_u32 s27, s27, 8192
    buffer_load_dwordx4 v[24:27], v12, s[88:91], s27 offen
    s_add_u32 s27, s27, 8192
    buffer_load_dwordx4 v[28:31], v12, s[88:91], s27 offen
    s_add_u32 s27, s27, 8192
    buffer_load_dwordx4 v[32:35], v12, s[88:91], s27 offen
    s_add_u32 s27, s27, 8192
    buffer_load_dwordx4 v[36:39], v12, s[88:91], s27 offen
    s_add_u32 s27, s27, 8192
    buffer_load_dwordx4 v[40:43], v12, s[88:91], s27 offen
    s_add_u32 s27, s27, 8192
    buffer_load_dwordx4 v[44:47], v12, s[88:91], s27 offen
    s_waitcnt lgkmcnt(0)
    s_barrier
    ds_read_b128 a[64:67], v5 offset:0
    ds_read_b128 a[56:59], v5 offset:1024
    ds_read_b128 a[68:71], v5 offset:2048
    ds_read_b128 a[60:63], v5 offset:3072
    ds_read_b128 a[32:35], v5 offset:4096
    ds_read_b128 a[24:27], v5 offset:5120
    ds_read_b128 a[36:39], v5 offset:6144
    ds_read_b128 a[28:31], v5 offset:7168
    s_lshl_b32 s27, s21, 11
    s_add_u32 s27, s27, 106496
    v_add_u32 v13, s27, v0
    s_waitcnt vmcnt(14)
    v_perm_b32 v80, v52, v48, s44
    s_waitcnt vmcnt(12)
    v_perm_b32 v81, v60, v56, s44
    s_waitcnt vmcnt(10)
    v_perm_b32 v82, v68, v64, s44
    s_waitcnt vmcnt(8)
    v_perm_b32 v83, v76, v72, s44
    ds_write_b128 v13, v[80:83] offset:0
    v_perm_b32 v84, v52, v48, s45
    v_perm_b32 v85, v60, v56, s45
    v_perm_b32 v86, v68, v64, s45
    v_perm_b32 v87, v76, v72, s45
    ds_write_b128 v13, v[84:87] offset:1024
    v_perm_b32 v80, v53, v49, s44
    v_perm_b32 v81, v61, v57, s44
    v_perm_b32 v82, v69, v65, s44
    v_perm_b32 v83, v77, v73, s44
    ds_write_b128 v13, v[80:83] offset:8192
    v_perm_b32 v84, v53, v49, s45
    v_perm_b32 v85, v61, v57, s45
    v_perm_b32 v86, v69, v65, s45
    v_perm_b32 v87, v77, v73, s45
    ds_write_b128 v13, v[84:87] offset:9216
    v_perm_b32 v80, v54, v50, s44
    v_perm_b32 v81, v62, v58, s44
    v_perm_b32 v82, v70, v66, s44
    v_perm_b32 v83, v78, v74, s44
    ds_write_b128 v13, v[80:83] offset:16384
    v_perm_b32 v84, v54, v50, s45
    v_perm_b32 v85, v62, v58, s45
    v_perm_b32 v86, v70, v66, s45
    v_perm_b32 v87, v78, v74, s45
    ds_write_b128 v13, v[84:87] offset:17408
    v_perm_b32 v80, v55, v51, s44
    v_perm_b32 v81, v63, v59, s44
    v_perm_b32 v82, v71, v67, s44
    v_perm_b32 v83, v79, v75, s44
    ds_write_b128 v13, v[80:83] offset:24576
    v_perm_b32 v84, v55, v51, s45
    v_perm_b32 v85, v63, v59, s45
    v_perm_b32 v86, v71, v67, s45
    v_perm_b32 v87, v79, v75, s45
    ds_write_b128 v13, v[84:87] offset:25600
    s_cmp_lt_u32 s21, 2
    s_cselect_b32 s26, s48, s48
    s_cselect_b32 s27, 6, 8
    s_cselect_b64 s[88:89], s[80:81], s[80:81]
    s_add_u32 s26, s26, s27
    s_lshl_b32 s27, s26, 18
    s_add_u32 s27, s27, s46
    buffer_load_dwordx4 v[48:51], v12, s[88:91], s27 offen
    s_add_u32 s27, s27, 8192
    buffer_load_dwordx4 v[52:55], v12, s[88:91], s27 offen
    s_add_u32 s27, s27, 8192
    buffer_load_dwordx4 v[56:59], v12, s[88:91], s27 offen
    s_add_u32 s27, s27, 8192
    buffer_load_dwordx4 v[60:63], v12, s[88:91], s27 offen
    s_add_u32 s27, s27, 8192
    buffer_load_dwordx4 v[64:67], v12, s[88:91], s27 offen
    s_add_u32 s27, s27, 8192
    buffer_load_dwordx4 v[68:71], v12, s[88:91], s27 offen
    s_add_u32 s27, s27, 8192
    buffer_load_dwordx4 v[72:75], v12, s[88:91], s27 offen
    s_add_u32 s27, s27, 8192
    buffer_load_dwordx4 v[76:79], v12, s[88:91], s27 offen
    s_waitcnt lgkmcnt(0)
    s_barrier
    ds_read_b128 a[0:3], v4 offset:0
    ds_read_b128 v[248:251], v4 offset:1024
    ds_read_b128 a[4:7], v4 offset:2048
    ds_read_b128 v[252:255], v4 offset:3072
    ds_read_b128 v[240:243], v4 offset:4096
    ds_read_b128 v[232:235], v4 offset:5120
    ds_read_b128 v[244:247], v4 offset:6144
    ds_read_b128 v[236:239], v4 offset:7168
    s_lshl_b32 s27, s21, 11
    s_add_u32 s27, s27, 24576
    v_add_u32 v13, s27, v0
    s_waitcnt vmcnt(14)
    v_perm_b32 v80, v20, v16, s44
    s_waitcnt vmcnt(12)
    v_perm_b32 v81, v28, v24, s44
    s_waitcnt vmcnt(10)
    v_perm_b32 v82, v36, v32, s44
    s_waitcnt vmcnt(8)
    v_perm_b32 v83, v44, v40, s44
    ds_write_b128 v13, v[80:83] offset:0
    v_perm_b32 v84, v20, v16, s45
    v_perm_b32 v85, v28, v24, s45
    v_perm_b32 v86, v36, v32, s45
    v_perm_b32 v87, v44, v40, s45
    ds_write_b128 v13, v[84:87] offset:1024
    v_perm_b32 v80, v21, v17, s44
    v_perm_b32 v81, v29, v25, s44
    v_perm_b32 v82, v37, v33, s44
    v_perm_b32 v83, v45, v41, s44
    ds_write_b128 v13, v[80:83] offset:8192
    v_perm_b32 v84, v21, v17, s45
    v_perm_b32 v85, v29, v25, s45
    v_perm_b32 v86, v37, v33, s45
    v_perm_b32 v87, v45, v41, s45
    ds_write_b128 v13, v[84:87] offset:9216
    v_perm_b32 v80, v22, v18, s44
    v_perm_b32 v81, v30, v26, s44
    v_perm_b32 v82, v38, v34, s44
    v_perm_b32 v83, v46, v42, s44
    ds_write_b128 v13, v[80:83] offset:16384
    v_perm_b32 v84, v22, v18, s45
    v_perm_b32 v85, v30, v26, s45
    v_perm_b32 v86, v38, v34, s45
    v_perm_b32 v87, v46, v42, s45
    ds_write_b128 v13, v[84:87] offset:17408
    v_perm_b32 v80, v23, v19, s44
    v_perm_b32 v81, v31, v27, s44
    v_perm_b32 v82, v39, v35, s44
    v_perm_b32 v83, v47, v43, s44
    ds_write_b128 v13, v[80:83] offset:24576
    v_perm_b32 v84, v23, v19, s45
    v_perm_b32 v85, v31, v27, s45
    v_perm_b32 v86, v39, v35, s45
    v_perm_b32 v87, v47, v43, s45
    ds_write_b128 v13, v[84:87] offset:25600
    s_cmp_lt_u32 s21, 2
    s_cselect_b32 s26, s48, s48
    s_cselect_b32 s27, 0, 0
    s_cselect_b64 s[88:89], s[72:73], s[80:81]
    s_add_u32 s26, s26, s27
    s_lshl_b32 s27, s26, 18
    s_add_u32 s27, s27, s46
    buffer_load_dwordx4 v[16:19], v12, s[88:91], s27 offen
    s_add_u32 s27, s27, 8192
    buffer_load_dwordx4 v[20:23], v12, s[88:91], s27 offen
    s_add_u32 s27, s27, 8192
    buffer_load_dwordx4 v[24:27], v12, s[88:91], s27 offen
    s_add_u32 s27, s27, 8192
    buffer_load_dwordx4 v[28:31], v12, s[88:91], s27 offen
    s_add_u32 s27, s27, 8192
    buffer_load_dwordx4 v[32:35], v12, s[88:91], s27 offen
    s_add_u32 s27, s27, 8192
    buffer_load_dwordx4 v[36:39], v12, s[88:91], s27 offen
    s_add_u32 s27, s27, 8192
    buffer_load_dwordx4 v[40:43], v12, s[88:91], s27 offen
    s_add_u32 s27, s27, 8192
    buffer_load_dwordx4 v[44:47], v12, s[88:91], s27 offen
    s_waitcnt lgkmcnt(0)
    s_barrier
    ds_read_b128 v[224:227], v5 offset:0
    ds_read_b128 v[216:219], v5 offset:1024
    ds_read_b128 v[228:231], v5 offset:2048
    ds_read_b128 v[220:223], v5 offset:3072
    ds_read_b128 v[208:211], v5 offset:4096
    ds_read_b128 v[200:203], v5 offset:5120
    ds_read_b128 v[212:215], v5 offset:6144
    ds_read_b128 v[204:207], v5 offset:7168
    s_lshl_b32 s27, s21, 11
    s_add_u32 s27, s27, 106496
    v_add_u32 v13, s27, v0
    s_waitcnt vmcnt(14)
    v_perm_b32 v80, v52, v48, s44
    s_waitcnt vmcnt(12)
    v_perm_b32 v81, v60, v56, s44
    s_waitcnt vmcnt(10)
    v_perm_b32 v82, v68, v64, s44
    s_waitcnt vmcnt(8)
    v_perm_b32 v83, v76, v72, s44
    ds_write_b128 v13, v[80:83] offset:0
    v_perm_b32 v84, v52, v48, s45
    v_perm_b32 v85, v60, v56, s45
    v_perm_b32 v86, v68, v64, s45
    v_perm_b32 v87, v76, v72, s45
    ds_write_b128 v13, v[84:87] offset:1024
    v_perm_b32 v80, v53, v49, s44
    v_perm_b32 v81, v61, v57, s44
    v_perm_b32 v82, v69, v65, s44
    v_perm_b32 v83, v77, v73, s44
    ds_write_b128 v13, v[80:83] offset:8192
    v_perm_b32 v84, v53, v49, s45
    v_perm_b32 v85, v61, v57, s45
    v_perm_b32 v86, v69, v65, s45
    v_perm_b32 v87, v77, v73, s45
    ds_write_b128 v13, v[84:87] offset:9216
    v_perm_b32 v80, v54, v50, s44
    v_perm_b32 v81, v62, v58, s44
    v_perm_b32 v82, v70, v66, s44
    v_perm_b32 v83, v78, v74, s44
    ds_write_b128 v13, v[80:83] offset:16384
    v_perm_b32 v84, v54, v50, s45
    v_perm_b32 v85, v62, v58, s45
    v_perm_b32 v86, v70, v66, s45
    v_perm_b32 v87, v78, v74, s45
    ds_write_b128 v13, v[84:87] offset:17408
    v_perm_b32 v80, v55, v51, s44
    v_perm_b32 v81, v63, v59, s44
    v_perm_b32 v82, v71, v67, s44
    v_perm_b32 v83, v79, v75, s44
    ds_write_b128 v13, v[80:83] offset:24576
    v_perm_b32 v84, v55, v51, s45
    v_perm_b32 v85, v63, v59, s45
    v_perm_b32 v86, v71, v67, s45
    v_perm_b32 v87, v79, v75, s45
    ds_write_b128 v13, v[84:87] offset:25600
    s_cmp_lt_u32 s21, 2
    s_cselect_b32 s26, s48, s48
    s_cselect_b32 s27, 2, 2
    s_cselect_b64 s[88:89], s[76:77], s[80:81]
    s_add_u32 s26, s26, s27
    s_lshl_b32 s27, s26, 18
    s_add_u32 s27, s27, s46
    buffer_load_dwordx4 v[48:51], v12, s[88:91], s27 offen
    s_add_u32 s27, s27, 8192
    buffer_load_dwordx4 v[52:55], v12, s[88:91], s27 offen
    s_add_u32 s27, s27, 8192
    buffer_load_dwordx4 v[56:59], v12, s[88:91], s27 offen
    s_add_u32 s27, s27, 8192
    buffer_load_dwordx4 v[60:63], v12, s[88:91], s27 offen
    s_add_u32 s27, s27, 8192
    buffer_load_dwordx4 v[64:67], v12, s[88:91], s27 offen
    s_add_u32 s27, s27, 8192
    buffer_load_dwordx4 v[68:71], v12, s[88:91], s27 offen
    s_add_u32 s27, s27, 8192
    buffer_load_dwordx4 v[72:75], v12, s[88:91], s27 offen
    s_add_u32 s27, s27, 8192
    buffer_load_dwordx4 v[76:79], v12, s[88:91], s27 offen
    s_waitcnt lgkmcnt(0)
    s_barrier
    ds_read_b128 v[192:195], v4 offset:0
    ds_read_b128 v[184:187], v4 offset:1024
    ds_read_b128 v[196:199], v4 offset:2048
    ds_read_b128 v[188:191], v4 offset:3072
    ds_read_b128 v[176:179], v4 offset:4096
    ds_read_b128 v[168:171], v4 offset:5120
    ds_read_b128 v[180:183], v4 offset:6144
    ds_read_b128 v[172:175], v4 offset:7168
    s_waitcnt lgkmcnt(0)
    s_barrier
    s_and_b32 s28, s21, 1
    s_lshl_b32 s28, s28, 10
    s_mov_b32 s29, 2048
    s_mov_b32 s30, 4096
    s_cmp_lt_u32 s21, 2
    s_cselect_b32 s29, 24576, s29
    s_cselect_b32 s30, 34816, s30
    s_add_u32 s29, s29, s28
    v_add_u32 v13, s29, v0
    s_add_u32 s29, s29, s30
    s_waitcnt vmcnt(14)
    v_perm_b32 v80, v20, v16, s44
    s_waitcnt vmcnt(12)
    v_perm_b32 v81, v28, v24, s44
    s_waitcnt vmcnt(10)
    v_perm_b32 v82, v36, v32, s44
    s_waitcnt vmcnt(8)
    v_perm_b32 v83, v44, v40, s44
    ds_write_b128 v13, v[80:83]
    v_add_u32 v14, s29, v0
    s_add_u32 s29, s29, s30
    v_perm_b32 v84, v21, v17, s44
    v_perm_b32 v85, v29, v25, s44
    v_perm_b32 v86, v37, v33, s44
    v_perm_b32 v87, v45, v41, s44
    ds_write_b128 v14, v[84:87]
    v_add_u32 v13, s29, v0
    s_add_u32 s29, s29, s30
    v_perm_b32 v80, v22, v18, s44
    v_perm_b32 v81, v30, v26, s44
    v_perm_b32 v82, v38, v34, s44
    v_perm_b32 v83, v46, v42, s44
    ds_write_b128 v13, v[80:83]
    v_add_u32 v14, s29, v0
    s_add_u32 s29, s29, s30
    v_perm_b32 v84, v23, v19, s44
    v_perm_b32 v85, v31, v27, s44
    v_perm_b32 v86, v39, v35, s44
    v_perm_b32 v87, v47, v43, s44
    ds_write_b128 v14, v[84:87]
    s_mov_b32 s29, 28672
    s_mov_b32 s30, 34816
    s_cmp_lt_u32 s21, 2
    s_cselect_b32 s29, 26624, s29
    s_cselect_b32 s30, 34816, s30
    s_add_u32 s29, s29, s28
    v_add_u32 v13, s29, v0
    s_add_u32 s29, s29, s30
    v_perm_b32 v80, v20, v16, s45
    v_perm_b32 v81, v28, v24, s45
    v_perm_b32 v82, v36, v32, s45
    v_perm_b32 v83, v44, v40, s45
    ds_write_b128 v13, v[80:83]
    v_add_u32 v14, s29, v0
    s_add_u32 s29, s29, s30
    v_perm_b32 v84, v21, v17, s45
    v_perm_b32 v85, v29, v25, s45
    v_perm_b32 v86, v37, v33, s45
    v_perm_b32 v87, v45, v41, s45
    ds_write_b128 v14, v[84:87]
    v_add_u32 v13, s29, v0
    s_add_u32 s29, s29, s30
    v_perm_b32 v80, v22, v18, s45
    v_perm_b32 v81, v30, v26, s45
    v_perm_b32 v82, v38, v34, s45
    v_perm_b32 v83, v46, v42, s45
    ds_write_b128 v13, v[80:83]
    v_add_u32 v14, s29, v0
    s_add_u32 s29, s29, s30
    v_perm_b32 v84, v23, v19, s45
    v_perm_b32 v85, v31, v27, s45
    v_perm_b32 v86, v39, v35, s45
    v_perm_b32 v87, v47, v43, s45
    ds_write_b128 v14, v[84:87]
    s_cmp_lt_u32 s21, 2
    s_cselect_b32 s26, s48, s48
    s_cselect_b32 s27, 4, 6
    s_cselect_b64 s[88:89], s[76:77], s[72:73]
    s_add_u32 s26, s26, s27
    s_lshl_b32 s27, s26, 18
    s_add_u32 s27, s27, s46
    buffer_load_dwordx4 v[16:19], v12, s[88:91], s27 offen
    s_add_u32 s27, s27, 8192
    buffer_load_dwordx4 v[20:23], v12, s[88:91], s27 offen
    s_add_u32 s27, s27, 8192
    buffer_load_dwordx4 v[24:27], v12, s[88:91], s27 offen
    s_add_u32 s27, s27, 8192
    buffer_load_dwordx4 v[28:31], v12, s[88:91], s27 offen
    s_add_u32 s27, s27, 8192
    buffer_load_dwordx4 v[32:35], v12, s[88:91], s27 offen
    s_add_u32 s27, s27, 8192
    buffer_load_dwordx4 v[36:39], v12, s[88:91], s27 offen
    s_add_u32 s27, s27, 8192
    buffer_load_dwordx4 v[40:43], v12, s[88:91], s27 offen
    s_add_u32 s27, s27, 8192
    buffer_load_dwordx4 v[44:47], v12, s[88:91], s27 offen
    s_waitcnt lgkmcnt(0)
    s_barrier
    ds_read_b128 a[232:235], v6 offset:2048
    ds_read_b128 a[236:239], v6 offset:3072
    s_waitcnt lgkmcnt(0)
    s_barrier
    s_and_b32 s28, s21, 1
    s_lshl_b32 s28, s28, 10
    s_mov_b32 s29, 2048
    s_mov_b32 s30, 4096
    s_cmp_lt_u32 s21, 2
    s_cselect_b32 s29, 30720, s29
    s_cselect_b32 s30, 34816, s30
    s_add_u32 s29, s29, s28
    v_add_u32 v13, s29, v0
    s_add_u32 s29, s29, s30
    s_waitcnt vmcnt(14)
    v_perm_b32 v80, v52, v48, s44
    s_waitcnt vmcnt(12)
    v_perm_b32 v81, v60, v56, s44
    s_waitcnt vmcnt(10)
    v_perm_b32 v82, v68, v64, s44
    s_waitcnt vmcnt(8)
    v_perm_b32 v83, v76, v72, s44
    ds_write_b128 v13, v[80:83]
    v_add_u32 v14, s29, v0
    s_add_u32 s29, s29, s30
    v_perm_b32 v84, v53, v49, s44
    v_perm_b32 v85, v61, v57, s44
    v_perm_b32 v86, v69, v65, s44
    v_perm_b32 v87, v77, v73, s44
    ds_write_b128 v14, v[84:87]
    v_add_u32 v13, s29, v0
    s_add_u32 s29, s29, s30
    v_perm_b32 v80, v54, v50, s44
    v_perm_b32 v81, v62, v58, s44
    v_perm_b32 v82, v70, v66, s44
    v_perm_b32 v83, v78, v74, s44
    ds_write_b128 v13, v[80:83]
    v_add_u32 v14, s29, v0
    s_add_u32 s29, s29, s30
    v_perm_b32 v84, v55, v51, s44
    v_perm_b32 v85, v63, v59, s44
    v_perm_b32 v86, v71, v67, s44
    v_perm_b32 v87, v79, v75, s44
    ds_write_b128 v14, v[84:87]
    s_mov_b32 s29, 32768
    s_mov_b32 s30, 34816
    s_cmp_lt_u32 s21, 2
    s_cselect_b32 s29, 0, s29
    s_cselect_b32 s30, 4096, s30
    s_add_u32 s29, s29, s28
    v_add_u32 v13, s29, v0
    s_add_u32 s29, s29, s30
    v_perm_b32 v80, v52, v48, s45
    v_perm_b32 v81, v60, v56, s45
    v_perm_b32 v82, v68, v64, s45
    v_perm_b32 v83, v76, v72, s45
    ds_write_b128 v13, v[80:83]
    v_add_u32 v14, s29, v0
    s_add_u32 s29, s29, s30
    v_perm_b32 v84, v53, v49, s45
    v_perm_b32 v85, v61, v57, s45
    v_perm_b32 v86, v69, v65, s45
    v_perm_b32 v87, v77, v73, s45
    ds_write_b128 v14, v[84:87]
    v_add_u32 v13, s29, v0
    s_add_u32 s29, s29, s30
    v_perm_b32 v80, v54, v50, s45
    v_perm_b32 v81, v62, v58, s45
    v_perm_b32 v82, v70, v66, s45
    v_perm_b32 v83, v78, v74, s45
    ds_write_b128 v13, v[80:83]
    v_add_u32 v14, s29, v0
    s_add_u32 s29, s29, s30
    v_perm_b32 v84, v55, v51, s45
    v_perm_b32 v85, v63, v59, s45
    v_perm_b32 v86, v71, v67, s45
    v_perm_b32 v87, v79, v75, s45
    ds_write_b128 v14, v[84:87]
    s_cmp_lt_u32 s21, 2
    s_cselect_b32 s26, s48, s48
    s_cselect_b32 s27, 8, 8
    s_cselect_b64 s[88:89], s[72:73], s[76:77]
    s_add_u32 s26, s26, s27
    s_lshl_b32 s27, s26, 18
    s_add_u32 s27, s27, s46
    buffer_load_dwordx4 v[48:51], v12, s[88:91], s27 offen
    s_add_u32 s27, s27, 8192
    buffer_load_dwordx4 v[52:55], v12, s[88:91], s27 offen
    s_add_u32 s27, s27, 8192
    buffer_load_dwordx4 v[56:59], v12, s[88:91], s27 offen
    s_add_u32 s27, s27, 8192
    buffer_load_dwordx4 v[60:63], v12, s[88:91], s27 offen
    s_add_u32 s27, s27, 8192
    buffer_load_dwordx4 v[64:67], v12, s[88:91], s27 offen
    s_add_u32 s27, s27, 8192
    buffer_load_dwordx4 v[68:71], v12, s[88:91], s27 offen
    s_add_u32 s27, s27, 8192
    buffer_load_dwordx4 v[72:75], v12, s[88:91], s27 offen
    s_add_u32 s27, s27, 8192
    buffer_load_dwordx4 v[76:79], v12, s[88:91], s27 offen
    s_waitcnt lgkmcnt(0)
    s_barrier
    ds_read_b128 a[208:211], v6 offset:0
    ds_read_b128 a[212:215], v6 offset:1024
    ds_read_b128 a[200:203], v6 offset:2048
    ds_read_b128 a[204:207], v6 offset:3072
    s_waitcnt lgkmcnt(0)
    s_barrier
    s_and_b32 s28, s21, 1
    s_lshl_b32 s28, s28, 10
    s_mov_b32 s29, 2048
    s_mov_b32 s30, 4096
    s_cmp_lt_u32 s21, 2
    s_cselect_b32 s29, 34816, s29
    s_cselect_b32 s30, 34816, s30
    s_add_u32 s29, s29, s28
    v_add_u32 v13, s29, v0
    s_add_u32 s29, s29, s30
    s_waitcnt vmcnt(14)
    v_perm_b32 v80, v20, v16, s44
    s_waitcnt vmcnt(12)
    v_perm_b32 v81, v28, v24, s44
    s_waitcnt vmcnt(10)
    v_perm_b32 v82, v36, v32, s44
    s_waitcnt vmcnt(8)
    v_perm_b32 v83, v44, v40, s44
    ds_write_b128 v13, v[80:83]
    v_add_u32 v14, s29, v0
    s_add_u32 s29, s29, s30
    v_perm_b32 v84, v21, v17, s44
    v_perm_b32 v85, v29, v25, s44
    v_perm_b32 v86, v37, v33, s44
    v_perm_b32 v87, v45, v41, s44
    ds_write_b128 v14, v[84:87]
    v_add_u32 v13, s29, v0
    s_add_u32 s29, s29, s30
    v_perm_b32 v80, v22, v18, s44
    v_perm_b32 v81, v30, v26, s44
    v_perm_b32 v82, v38, v34, s44
    v_perm_b32 v83, v46, v42, s44
    ds_write_b128 v13, v[80:83]
    v_add_u32 v14, s29, v0
    s_add_u32 s29, s29, s30
    v_perm_b32 v84, v23, v19, s44
    v_perm_b32 v85, v31, v27, s44
    v_perm_b32 v86, v39, v35, s44
    v_perm_b32 v87, v47, v43, s44
    ds_write_b128 v14, v[84:87]
    s_mov_b32 s29, 36864
    s_mov_b32 s30, 34816
    s_cmp_lt_u32 s21, 2
    s_cselect_b32 s29, 0, s29
    s_cselect_b32 s30, 4096, s30
    s_add_u32 s29, s29, s28
    v_add_u32 v13, s29, v0
    s_add_u32 s29, s29, s30
    v_perm_b32 v80, v20, v16, s45
    v_perm_b32 v81, v28, v24, s45
    v_perm_b32 v82, v36, v32, s45
    v_perm_b32 v83, v44, v40, s45
    ds_write_b128 v13, v[80:83]
    v_add_u32 v14, s29, v0
    s_add_u32 s29, s29, s30
    v_perm_b32 v84, v21, v17, s45
    v_perm_b32 v85, v29, v25, s45
    v_perm_b32 v86, v37, v33, s45
    v_perm_b32 v87, v45, v41, s45
    ds_write_b128 v14, v[84:87]
    v_add_u32 v13, s29, v0
    s_add_u32 s29, s29, s30
    v_perm_b32 v80, v22, v18, s45
    v_perm_b32 v81, v30, v26, s45
    v_perm_b32 v82, v38, v34, s45
    v_perm_b32 v83, v46, v42, s45
    ds_write_b128 v13, v[80:83]
    v_add_u32 v14, s29, v0
    s_add_u32 s29, s29, s30
    v_perm_b32 v84, v23, v19, s45
    v_perm_b32 v85, v31, v27, s45
    v_perm_b32 v86, v39, v35, s45
    v_perm_b32 v87, v47, v43, s45
    ds_write_b128 v14, v[84:87]
    s_cmp_lt_u32 s21, 2
    s_cselect_b32 s26, s49, s49
    s_cselect_b32 s27, 2, 4
    s_cselect_b64 s[88:89], s[72:73], s[72:73]
    s_add_u32 s26, s26, s27
    s_lshl_b32 s27, s26, 18
    s_add_u32 s27, s27, s46
    buffer_load_dwordx4 v[16:19], v12, s[88:91], s27 offen
    s_add_u32 s27, s27, 8192
    buffer_load_dwordx4 v[20:23], v12, s[88:91], s27 offen
    s_add_u32 s27, s27, 8192
    buffer_load_dwordx4 v[24:27], v12, s[88:91], s27 offen
    s_add_u32 s27, s27, 8192
    buffer_load_dwordx4 v[28:31], v12, s[88:91], s27 offen
    s_add_u32 s27, s27, 8192
    buffer_load_dwordx4 v[32:35], v12, s[88:91], s27 offen
    s_add_u32 s27, s27, 8192
    buffer_load_dwordx4 v[36:39], v12, s[88:91], s27 offen
    s_add_u32 s27, s27, 8192
    buffer_load_dwordx4 v[40:43], v12, s[88:91], s27 offen
    s_add_u32 s27, s27, 8192
    buffer_load_dwordx4 v[44:47], v12, s[88:91], s27 offen
    s_waitcnt lgkmcnt(0)
    s_barrier
    ds_read_b128 a[176:179], v6 offset:0
    ds_read_b128 a[180:183], v6 offset:1024
    ds_read_b128 a[168:171], v6 offset:2048
    ds_read_b128 a[172:175], v6 offset:3072
    s_waitcnt lgkmcnt(0)
    s_barrier
    s_and_b32 s28, s21, 1
    s_lshl_b32 s28, s28, 10
    s_mov_b32 s29, 2048
    s_mov_b32 s30, 4096
    s_cmp_lt_u32 s21, 2
    s_cselect_b32 s29, 38912, s29
    s_cselect_b32 s30, 34816, s30
    s_add_u32 s29, s29, s28
    v_add_u32 v13, s29, v0
    s_add_u32 s29, s29, s30
    s_waitcnt vmcnt(14)
    v_perm_b32 v80, v52, v48, s44
    s_waitcnt vmcnt(12)
    v_perm_b32 v81, v60, v56, s44
    s_waitcnt vmcnt(10)
    v_perm_b32 v82, v68, v64, s44
    s_waitcnt vmcnt(8)
    v_perm_b32 v83, v76, v72, s44
    ds_write_b128 v13, v[80:83]
    v_add_u32 v14, s29, v0
    s_add_u32 s29, s29, s30
    v_perm_b32 v84, v53, v49, s44
    v_perm_b32 v85, v61, v57, s44
    v_perm_b32 v86, v69, v65, s44
    v_perm_b32 v87, v77, v73, s44
    ds_write_b128 v14, v[84:87]
    v_add_u32 v13, s29, v0
    s_add_u32 s29, s29, s30
    v_perm_b32 v80, v54, v50, s44
    v_perm_b32 v81, v62, v58, s44
    v_perm_b32 v82, v70, v66, s44
    v_perm_b32 v83, v78, v74, s44
    ds_write_b128 v13, v[80:83]
    v_add_u32 v14, s29, v0
    s_add_u32 s29, s29, s30
    v_perm_b32 v84, v55, v51, s44
    v_perm_b32 v85, v63, v59, s44
    v_perm_b32 v86, v71, v67, s44
    v_perm_b32 v87, v79, v75, s44
    ds_write_b128 v14, v[84:87]
    s_mov_b32 s29, 40960
    s_mov_b32 s30, 34816
    s_cmp_lt_u32 s21, 2
    s_cselect_b32 s29, 0, s29
    s_cselect_b32 s30, 4096, s30
    s_add_u32 s29, s29, s28
    v_add_u32 v13, s29, v0
    s_add_u32 s29, s29, s30
    v_perm_b32 v80, v52, v48, s45
    v_perm_b32 v81, v60, v56, s45
    v_perm_b32 v82, v68, v64, s45
    v_perm_b32 v83, v76, v72, s45
    ds_write_b128 v13, v[80:83]
    v_add_u32 v14, s29, v0
    s_add_u32 s29, s29, s30
    v_perm_b32 v84, v53, v49, s45
    v_perm_b32 v85, v61, v57, s45
    v_perm_b32 v86, v69, v65, s45
    v_perm_b32 v87, v77, v73, s45
    ds_write_b128 v14, v[84:87]
    v_add_u32 v13, s29, v0
    s_add_u32 s29, s29, s30
    v_perm_b32 v80, v54, v50, s45
    v_perm_b32 v81, v62, v58, s45
    v_perm_b32 v82, v70, v66, s45
    v_perm_b32 v83, v78, v74, s45
    ds_write_b128 v13, v[80:83]
    v_add_u32 v14, s29, v0
    s_add_u32 s29, s29, s30
    v_perm_b32 v84, v55, v51, s45
    v_perm_b32 v85, v63, v59, s45
    v_perm_b32 v86, v71, v67, s45
    v_perm_b32 v87, v79, v75, s45
    ds_write_b128 v14, v[84:87]
    s_cmp_lt_u32 s21, 2
    s_cselect_b32 s26, s49, s49
    s_cselect_b32 s27, 8, 0
    s_cselect_b64 s[88:89], s[72:73], s[76:77]
    s_add_u32 s26, s26, s27
    s_lshl_b32 s27, s26, 18
    s_add_u32 s27, s27, s46
    buffer_load_dwordx4 v[48:51], v12, s[88:91], s27 offen
    s_add_u32 s27, s27, 8192
    buffer_load_dwordx4 v[52:55], v12, s[88:91], s27 offen
    s_add_u32 s27, s27, 8192
    buffer_load_dwordx4 v[56:59], v12, s[88:91], s27 offen
    s_add_u32 s27, s27, 8192
    buffer_load_dwordx4 v[60:63], v12, s[88:91], s27 offen
    s_add_u32 s27, s27, 8192
    buffer_load_dwordx4 v[64:67], v12, s[88:91], s27 offen
    s_add_u32 s27, s27, 8192
    buffer_load_dwordx4 v[68:71], v12, s[88:91], s27 offen
    s_add_u32 s27, s27, 8192
    buffer_load_dwordx4 v[72:75], v12, s[88:91], s27 offen
    s_add_u32 s27, s27, 8192
    buffer_load_dwordx4 v[76:79], v12, s[88:91], s27 offen
    s_waitcnt lgkmcnt(0)
    s_barrier
    ds_read_b128 a[144:147], v6 offset:0
    ds_read_b128 a[148:151], v6 offset:1024
    ds_read_b128 a[136:139], v6 offset:2048
    ds_read_b128 a[140:143], v6 offset:3072
    s_waitcnt lgkmcnt(0)
    s_barrier
    s_and_b32 s28, s21, 1
    s_lshl_b32 s28, s28, 10
    s_mov_b32 s29, 2048
    s_mov_b32 s30, 4096
    s_cmp_lt_u32 s21, 2
    s_cselect_b32 s29, 43008, s29
    s_cselect_b32 s30, 34816, s30
    s_add_u32 s29, s29, s28
    v_add_u32 v13, s29, v0
    s_add_u32 s29, s29, s30
    s_waitcnt vmcnt(14)
    v_perm_b32 v80, v20, v16, s44
    s_waitcnt vmcnt(12)
    v_perm_b32 v81, v28, v24, s44
    s_waitcnt vmcnt(10)
    v_perm_b32 v82, v36, v32, s44
    s_waitcnt vmcnt(8)
    v_perm_b32 v83, v44, v40, s44
    ds_write_b128 v13, v[80:83]
    v_add_u32 v14, s29, v0
    s_add_u32 s29, s29, s30
    v_perm_b32 v84, v21, v17, s44
    v_perm_b32 v85, v29, v25, s44
    v_perm_b32 v86, v37, v33, s44
    v_perm_b32 v87, v45, v41, s44
    ds_write_b128 v14, v[84:87]
    v_add_u32 v13, s29, v0
    s_add_u32 s29, s29, s30
    v_perm_b32 v80, v22, v18, s44
    v_perm_b32 v81, v30, v26, s44
    v_perm_b32 v82, v38, v34, s44
    v_perm_b32 v83, v46, v42, s44
    ds_write_b128 v13, v[80:83]
    v_add_u32 v14, s29, v0
    s_add_u32 s29, s29, s30
    v_perm_b32 v84, v23, v19, s44
    v_perm_b32 v85, v31, v27, s44
    v_perm_b32 v86, v39, v35, s44
    v_perm_b32 v87, v47, v43, s44
    ds_write_b128 v14, v[84:87]
    s_mov_b32 s29, 45056
    s_mov_b32 s30, 34816
    s_cmp_lt_u32 s21, 2
    s_cselect_b32 s29, 0, s29
    s_cselect_b32 s30, 4096, s30
    s_add_u32 s29, s29, s28
    v_add_u32 v13, s29, v0
    s_add_u32 s29, s29, s30
    v_perm_b32 v80, v20, v16, s45
    v_perm_b32 v81, v28, v24, s45
    v_perm_b32 v82, v36, v32, s45
    v_perm_b32 v83, v44, v40, s45
    ds_write_b128 v13, v[80:83]
    v_add_u32 v14, s29, v0
    s_add_u32 s29, s29, s30
    v_perm_b32 v84, v21, v17, s45
    v_perm_b32 v85, v29, v25, s45
    v_perm_b32 v86, v37, v33, s45
    v_perm_b32 v87, v45, v41, s45
    ds_write_b128 v14, v[84:87]
    v_add_u32 v13, s29, v0
    s_add_u32 s29, s29, s30
    v_perm_b32 v80, v22, v18, s45
    v_perm_b32 v81, v30, v26, s45
    v_perm_b32 v82, v38, v34, s45
    v_perm_b32 v83, v46, v42, s45
    ds_write_b128 v13, v[80:83]
    v_add_u32 v14, s29, v0
    s_add_u32 s29, s29, s30
    v_perm_b32 v84, v23, v19, s45
    v_perm_b32 v85, v31, v27, s45
    v_perm_b32 v86, v39, v35, s45
    v_perm_b32 v87, v47, v43, s45
    ds_write_b128 v14, v[84:87]
    s_cmp_lt_u32 s21, 2
    s_cselect_b32 s26, s49, s49
    s_cselect_b32 s27, 4, 6
    s_cselect_b64 s[88:89], s[76:77], s[76:77]
    s_add_u32 s26, s26, s27
    s_lshl_b32 s27, s26, 18
    s_add_u32 s27, s27, s46
    buffer_load_dwordx4 v[16:19], v12, s[88:91], s27 offen
    s_add_u32 s27, s27, 8192
    buffer_load_dwordx4 v[20:23], v12, s[88:91], s27 offen
    s_add_u32 s27, s27, 8192
    buffer_load_dwordx4 v[24:27], v12, s[88:91], s27 offen
    s_add_u32 s27, s27, 8192
    buffer_load_dwordx4 v[28:31], v12, s[88:91], s27 offen
    s_add_u32 s27, s27, 8192
    buffer_load_dwordx4 v[32:35], v12, s[88:91], s27 offen
    s_add_u32 s27, s27, 8192
    buffer_load_dwordx4 v[36:39], v12, s[88:91], s27 offen
    s_add_u32 s27, s27, 8192
    buffer_load_dwordx4 v[40:43], v12, s[88:91], s27 offen
    s_add_u32 s27, s27, 8192
    buffer_load_dwordx4 v[44:47], v12, s[88:91], s27 offen
    s_waitcnt lgkmcnt(0)
    s_barrier
    ds_read_b128 a[112:115], v6 offset:0
    ds_read_b128 a[116:119], v6 offset:1024
    ds_read_b128 a[104:107], v6 offset:2048
    ds_read_b128 a[108:111], v6 offset:3072
    s_waitcnt lgkmcnt(0)
    s_barrier
    s_and_b32 s28, s21, 1
    s_lshl_b32 s28, s28, 10
    s_mov_b32 s29, 2048
    s_mov_b32 s30, 4096
    s_cmp_lt_u32 s21, 2
    s_cselect_b32 s29, 47104, s29
    s_cselect_b32 s30, 34816, s30
    s_add_u32 s29, s29, s28
    v_add_u32 v13, s29, v0
    s_add_u32 s29, s29, s30
    s_waitcnt vmcnt(14)
    v_perm_b32 v80, v52, v48, s44
    s_waitcnt vmcnt(12)
    v_perm_b32 v81, v60, v56, s44
    s_waitcnt vmcnt(10)
    v_perm_b32 v82, v68, v64, s44
    s_waitcnt vmcnt(8)
    v_perm_b32 v83, v76, v72, s44
    ds_write_b128 v13, v[80:83]
    v_add_u32 v14, s29, v0
    s_add_u32 s29, s29, s30
    v_perm_b32 v84, v53, v49, s44
    v_perm_b32 v85, v61, v57, s44
    v_perm_b32 v86, v69, v65, s44
    v_perm_b32 v87, v77, v73, s44
    ds_write_b128 v14, v[84:87]
    v_add_u32 v13, s29, v0
    s_add_u32 s29, s29, s30
    v_perm_b32 v80, v54, v50, s44
    v_perm_b32 v81, v62, v58, s44
    v_perm_b32 v82, v70, v66, s44
    v_perm_b32 v83, v78, v74, s44
    ds_write_b128 v13, v[80:83]
    v_add_u32 v14, s29, v0
    s_add_u32 s29, s29, s30
    v_perm_b32 v84, v55, v51, s44
    v_perm_b32 v85, v63, v59, s44
    v_perm_b32 v86, v71, v67, s44
    v_perm_b32 v87, v79, v75, s44
    ds_write_b128 v14, v[84:87]
    s_mov_b32 s29, 49152
    s_mov_b32 s30, 34816
    s_cmp_lt_u32 s21, 2
    s_cselect_b32 s29, 0, s29
    s_cselect_b32 s30, 4096, s30
    s_add_u32 s29, s29, s28
    v_add_u32 v13, s29, v0
    s_add_u32 s29, s29, s30
    v_perm_b32 v80, v52, v48, s45
    v_perm_b32 v81, v60, v56, s45
    v_perm_b32 v82, v68, v64, s45
    v_perm_b32 v83, v76, v72, s45
    ds_write_b128 v13, v[80:83]
    v_add_u32 v14, s29, v0
    s_add_u32 s29, s29, s30
    v_perm_b32 v84, v53, v49, s45
    v_perm_b32 v85, v61, v57, s45
    v_perm_b32 v86, v69, v65, s45
    v_perm_b32 v87, v77, v73, s45
    ds_write_b128 v14, v[84:87]
    v_add_u32 v13, s29, v0
    s_add_u32 s29, s29, s30
    v_perm_b32 v80, v54, v50, s45
    v_perm_b32 v81, v62, v58, s45
    v_perm_b32 v82, v70, v66, s45
    v_perm_b32 v83, v78, v74, s45
    ds_write_b128 v13, v[80:83]
    v_add_u32 v14, s29, v0
    s_add_u32 s29, s29, s30
    v_perm_b32 v84, v55, v51, s45
    v_perm_b32 v85, v63, v59, s45
    v_perm_b32 v86, v71, v67, s45
    v_perm_b32 v87, v79, v75, s45
    ds_write_b128 v14, v[84:87]
    s_cmp_lt_u32 s21, 2
    s_cselect_b32 s26, s49, s49
    s_cselect_b32 s27, 0, 2
    s_cselect_b64 s[88:89], s[80:81], s[80:81]
    s_add_u32 s26, s26, s27
    s_lshl_b32 s27, s26, 18
    s_add_u32 s27, s27, s46
    buffer_load_dwordx4 v[48:51], v12, s[88:91], s27 offen
    s_add_u32 s27, s27, 8192
    buffer_load_dwordx4 v[52:55], v12, s[88:91], s27 offen
    s_add_u32 s27, s27, 8192
    buffer_load_dwordx4 v[56:59], v12, s[88:91], s27 offen
    s_add_u32 s27, s27, 8192
    buffer_load_dwordx4 v[60:63], v12, s[88:91], s27 offen
    s_add_u32 s27, s27, 8192
    buffer_load_dwordx4 v[64:67], v12, s[88:91], s27 offen
    s_add_u32 s27, s27, 8192
    buffer_load_dwordx4 v[68:71], v12, s[88:91], s27 offen
    s_add_u32 s27, s27, 8192
    buffer_load_dwordx4 v[72:75], v12, s[88:91], s27 offen
    s_add_u32 s27, s27, 8192
    buffer_load_dwordx4 v[76:79], v12, s[88:91], s27 offen
    s_waitcnt lgkmcnt(0)
    s_barrier
    ds_read_b128 a[80:83], v6 offset:0
    ds_read_b128 a[84:87], v6 offset:1024
    ds_read_b128 a[72:75], v6 offset:2048
    ds_read_b128 a[76:79], v6 offset:3072
    s_waitcnt lgkmcnt(0)
    s_barrier
    s_and_b32 s28, s21, 1
    s_lshl_b32 s28, s28, 10
    s_mov_b32 s29, 2048
    s_mov_b32 s30, 4096
    s_cmp_lt_u32 s21, 2
    s_cselect_b32 s29, 51200, s29
    s_cselect_b32 s30, 34816, s30
    s_add_u32 s29, s29, s28
    v_add_u32 v13, s29, v0
    s_add_u32 s29, s29, s30
    s_waitcnt vmcnt(14)
    v_perm_b32 v80, v20, v16, s44
    s_waitcnt vmcnt(12)
    v_perm_b32 v81, v28, v24, s44
    s_waitcnt vmcnt(10)
    v_perm_b32 v82, v36, v32, s44
    s_waitcnt vmcnt(8)
    v_perm_b32 v83, v44, v40, s44
    ds_write_b128 v13, v[80:83]
    v_add_u32 v14, s29, v0
    s_add_u32 s29, s29, s30
    v_perm_b32 v84, v21, v17, s44
    v_perm_b32 v85, v29, v25, s44
    v_perm_b32 v86, v37, v33, s44
    v_perm_b32 v87, v45, v41, s44
    ds_write_b128 v14, v[84:87]
    v_add_u32 v13, s29, v0
    s_add_u32 s29, s29, s30
    v_perm_b32 v80, v22, v18, s44
    v_perm_b32 v81, v30, v26, s44
    v_perm_b32 v82, v38, v34, s44
    v_perm_b32 v83, v46, v42, s44
    ds_write_b128 v13, v[80:83]
    v_add_u32 v14, s29, v0
    s_add_u32 s29, s29, s30
    v_perm_b32 v84, v23, v19, s44
    v_perm_b32 v85, v31, v27, s44
    v_perm_b32 v86, v39, v35, s44
    v_perm_b32 v87, v47, v43, s44
    ds_write_b128 v14, v[84:87]
    s_mov_b32 s29, 53248
    s_mov_b32 s30, 34816
    s_cmp_lt_u32 s21, 2
    s_cselect_b32 s29, 0, s29
    s_cselect_b32 s30, 4096, s30
    s_add_u32 s29, s29, s28
    v_add_u32 v13, s29, v0
    s_add_u32 s29, s29, s30
    v_perm_b32 v80, v20, v16, s45
    v_perm_b32 v81, v28, v24, s45
    v_perm_b32 v82, v36, v32, s45
    v_perm_b32 v83, v44, v40, s45
    ds_write_b128 v13, v[80:83]
    v_add_u32 v14, s29, v0
    s_add_u32 s29, s29, s30
    v_perm_b32 v84, v21, v17, s45
    v_perm_b32 v85, v29, v25, s45
    v_perm_b32 v86, v37, v33, s45
    v_perm_b32 v87, v45, v41, s45
    ds_write_b128 v14, v[84:87]
    v_add_u32 v13, s29, v0
    s_add_u32 s29, s29, s30
    v_perm_b32 v80, v22, v18, s45
    v_perm_b32 v81, v30, v26, s45
    v_perm_b32 v82, v38, v34, s45
    v_perm_b32 v83, v46, v42, s45
    ds_write_b128 v13, v[80:83]
    v_add_u32 v14, s29, v0
    s_add_u32 s29, s29, s30
    v_perm_b32 v84, v23, v19, s45
    v_perm_b32 v85, v31, v27, s45
    v_perm_b32 v86, v39, v35, s45
    v_perm_b32 v87, v47, v43, s45
    ds_write_b128 v14, v[84:87]
    s_waitcnt lgkmcnt(0)
    s_barrier
    ds_read_b128 a[48:51], v6 offset:0
    ds_read_b128 a[52:55], v6 offset:1024
    ds_read_b128 a[40:43], v6 offset:2048
    ds_read_b128 a[44:47], v6 offset:3072
    s_waitcnt lgkmcnt(0)
    s_barrier
    s_and_b32 s28, s21, 1
    s_lshl_b32 s28, s28, 10
    s_mov_b32 s29, 2048
    s_mov_b32 s30, 4096
    s_cmp_lt_u32 s21, 2
    s_cselect_b32 s29, 55296, s29
    s_cselect_b32 s30, 34816, s30
    s_add_u32 s29, s29, s28
    v_add_u32 v13, s29, v0
    s_add_u32 s29, s29, s30
    s_waitcnt vmcnt(6)
    v_perm_b32 v80, v52, v48, s44
    s_waitcnt vmcnt(4)
    v_perm_b32 v81, v60, v56, s44
    s_waitcnt vmcnt(2)
    v_perm_b32 v82, v68, v64, s44
    s_waitcnt vmcnt(0)
    v_perm_b32 v83, v76, v72, s44
    ds_write_b128 v13, v[80:83]
    v_add_u32 v14, s29, v0
    s_add_u32 s29, s29, s30
    v_perm_b32 v84, v53, v49, s44
    v_perm_b32 v85, v61, v57, s44
    v_perm_b32 v86, v69, v65, s44
    v_perm_b32 v87, v77, v73, s44
    ds_write_b128 v14, v[84:87]
    v_add_u32 v13, s29, v0
    s_add_u32 s29, s29, s30
    v_perm_b32 v80, v54, v50, s44
    v_perm_b32 v81, v62, v58, s44
    v_perm_b32 v82, v70, v66, s44
    v_perm_b32 v83, v78, v74, s44
    ds_write_b128 v13, v[80:83]
    v_add_u32 v14, s29, v0
    s_add_u32 s29, s29, s30
    v_perm_b32 v84, v55, v51, s44
    v_perm_b32 v85, v63, v59, s44
    v_perm_b32 v86, v71, v67, s44
    v_perm_b32 v87, v79, v75, s44
    ds_write_b128 v14, v[84:87]
    s_mov_b32 s29, 57344
    s_mov_b32 s30, 34816
    s_cmp_lt_u32 s21, 2
    s_cselect_b32 s29, 0, s29
    s_cselect_b32 s30, 4096, s30
    s_add_u32 s29, s29, s28
    v_add_u32 v13, s29, v0
    s_add_u32 s29, s29, s30
    v_perm_b32 v80, v52, v48, s45
    v_perm_b32 v81, v60, v56, s45
    v_perm_b32 v82, v68, v64, s45
    v_perm_b32 v83, v76, v72, s45
    ds_write_b128 v13, v[80:83]
    v_add_u32 v14, s29, v0
    s_add_u32 s29, s29, s30
    v_perm_b32 v84, v53, v49, s45
    v_perm_b32 v85, v61, v57, s45
    v_perm_b32 v86, v69, v65, s45
    v_perm_b32 v87, v77, v73, s45
    ds_write_b128 v14, v[84:87]
    v_add_u32 v13, s29, v0
    s_add_u32 s29, s29, s30
    v_perm_b32 v80, v54, v50, s45
    v_perm_b32 v81, v62, v58, s45
    v_perm_b32 v82, v70, v66, s45
    v_perm_b32 v83, v78, v74, s45
    ds_write_b128 v13, v[80:83]
    v_add_u32 v14, s29, v0
    s_add_u32 s29, s29, s30
    v_perm_b32 v84, v55, v51, s45
    v_perm_b32 v85, v63, v59, s45
    v_perm_b32 v86, v71, v67, s45
    v_perm_b32 v87, v79, v75, s45
    ds_write_b128 v14, v[84:87]
    s_waitcnt lgkmcnt(0)
    s_barrier
    ds_read_b128 a[16:19], v6 offset:0
    ds_read_b128 a[20:23], v6 offset:1024
    ds_read_b128 a[8:11], v6 offset:2048
    ds_read_b128 a[12:15], v6 offset:3072
    s_waitcnt lgkmcnt(0)
M_lw_done:
    s_cmp_lg_u32 s32, 0
    s_cbranch_scc1 M_role_ok
    s_mov_b32 s32, 1
    s_mov_b32 s30, 0
    v_bfe_u32 v12, v0, 4, 4
    v_lshlrev_b32 v12, 2, v12
M_modepoll:
    buffer_load_dword v13, v12, s[12:15], 0 offen sc1
    s_waitcnt vmcnt(0)
    v_readlane_b32 s31, v13, 8
    s_cmp_eq_u32 s31, 256
    s_cbranch_scc1 M_modegot
    s_sleep 2
    s_add_u32 s30, s30, 1
    s_cmp_lt_u32 s30, 60000
    s_cbranch_scc1 M_modepoll
    s_branch M_fail
M_modegot:
    buffer_load_dword v13, v12, s[12:15], 0 offen sc1
    buffer_load_dword v14, v12, s[12:15], 0 offen offset:128 sc1
    s_waitcnt vmcnt(0)
    v_readlane_b32 s26, v14, 0
    s_mov_b32 s33, 0
    v_readlane_b32 s27, v14, 1
    s_nop 0
    s_cmp_gt_u32 s27, s26
    s_cselect_b32 s33, 8192, s33
    s_max_u32 s26, s26, s27
    v_readlane_b32 s27, v14, 2
    s_nop 0
    s_cmp_gt_u32 s27, s26
    s_cselect_b32 s33, 16384, s33
    s_max_u32 s26, s26, s27
    v_readlane_b32 s27, v14, 3
    s_nop 0
    s_cmp_gt_u32 s27, s26
    s_cselect_b32 s33, 24576, s33
    s_max_u32 s26, s26, s27
    s_xor_b32 s33, s33, 16384
    v_cmp_ne_u32 vcc, 32, v13
    s_and_b32 s31, vcc_lo, 0xff
    s_cmp_lg_u32 s31, 0
    s_cbranch_scc1 M_slowm
    s_cmp_ge_u32 s20, 3
    s_cbranch_scc1 M_loadw
    s_branch M_role_ok
M_slowm:
    s_mov_b32 s23, 1
    s_mov_b32 s31, s25
    v_readlane_b32 s30, v13, 0
    s_cmp_gt_u32 s24, 0
    s_cselect_b32 s30, s30, 0
    s_add_u32 s31, s31, s30
    v_readlane_b32 s30, v13, 1
    s_cmp_gt_u32 s24, 1
    s_cselect_b32 s30, s30, 0
    s_add_u32 s31, s31, s30
    v_readlane_b32 s30, v13, 2
    s_cmp_gt_u32 s24, 2
    s_cselect_b32 s30, s30, 0
    s_add_u32 s31, s31, s30
    v_readlane_b32 s30, v13, 3
    s_cmp_gt_u32 s24, 3
    s_cselect_b32 s30, s30, 0
    s_add_u32 s31, s31, s30
    v_readlane_b32 s30, v13, 4
    s_cmp_gt_u32 s24, 4
    s_cselect_b32 s30, s30, 0
    s_add_u32 s31, s31, s30
    v_readlane_b32 s30, v13, 5
    s_cmp_gt_u32 s24, 5
    s_cselect_b32 s30, s30, 0
    s_add_u32 s31, s31, s30
    v_readlane_b32 s30, v13, 6
    s_cmp_gt_u32 s24, 6
    s_cselect_b32 s30, s30, 0
    s_add_u32 s31, s31, s30
    s_lshr_b32 s20, s31, 5
    s_and_b32 s22, s31, 31
    s_and_b32 s20, s20, 7
    s_and_b32 s22, s22, 31
    s_branch M_loadw
M_role_ok:
    s_mov_b32 s25, s33
    s_cmp_ge_u32 s20, 2
    s_cbranch_scc1 M_bulk
    v_lshrrev_b32 v36, 8, v0
    v_bfe_u32 v37, v0, 4, 4
    v_bfe_u32 v38, v0, 4, 3
    v_bfe_u32 v39, v0, 7, 1
    s_mov_b32 s36, 0x00ff00ff
    s_mov_b32 s37, 0x00ff00ff
    s_not_b64 s[18:19], s[36:37]
    v_mov_b32 v1, 0x4444
    v_mov_b32 v40, 0xeeee
    v_cndmask_b32_e64 v1, v1, v40, s[18:19]
    v_and_b32 v40, 1, v36
    v_lshlrev_b32 v40, 2, v40
    v_lshrrev_b32 v41, 1, v36
    v_add_u32 v40, v40, v41
    v_mul_u32_u24 v40, 288, v40
    v_lshl_add_u32 v40, v37, 2, v40
    s_lshl_b32 s27, s21, 6
    v_add_u32 v2, s27, v40
    v_mul_u32_u24 v40, 288, v38
    v_lshl_add_u32 v3, v36, 4, v40
    s_lshr_b32 s27, s21, 1
    s_lshl_b32 s27, s27, 10
    s_and_b32 s28, s21, 1
    s_lshl_b32 s28, s28, 3
    s_add_u32 s27, s27, s28
    s_add_u32 s27, s27, 13312
    v_and_b32 v40, 0x37f, v0
    v_add_u32 v4, s27, v40
    s_mul_i32 s27, s21, 34816
    s_add_u32 s27, s27, 24576
    v_add_u32 v5, s27, v0
    v_and_b32 v6, 0x200, v0
    v_bfe_u32 v40, v0, 6, 1
    v_lshl_or_b32 v6, v40, 8, v6
    v_bfe_u32 v40, v0, 4, 1
    v_lshl_or_b32 v6, v40, 7, v6
    v_bfe_u32 v40, v0, 5, 1
    v_lshl_or_b32 v6, v40, 6, v6
    v_bfe_u32 v40, v0, 8, 1
    v_lshl_or_b32 v6, v40, 5, v6
    v_bfe_u32 v40, v0, 7, 1
    v_lshl_or_b32 v6, v40, 4, v6
    s_lshl_b32 s27, s21, 13
    s_lshl_b32 s28, s22, 5
    s_add_u32 s27, s27, s28
    s_add_u32 s27, s27, 135168
    v_lshrrev_b32 v40, 7, v0
    v_lshlrev_b32 v40, 10, v40
    v_lshl_add_u32 v40, v38, 2, v40
    v_add_u32 v7, s27, v40
    v_lshrrev_b32 v40, 7, v0
    v_mul_u32_u24 v40, 4224, v40
    v_lshl_add_u32 v8, v38, 4, v40
    v_lshlrev_b32 v9, 3, v0
    s_mul_i32 s34, s20, 671744
    s_add_u32 s34, s34, 172228608
    s_lshl_b32 s35, s21, 10
    s_mul_i32 s27, s22, 4224
    s_add_u32 s35, s35, s27
    s_and_b32 s27, s22, 1
    s_bfe_u32 s28, s22, 0x10001
    s_bfe_u32 s29, s22, 0x10002
    s_lshl_b32 s30, s27, 2
    s_lshl_b32 s31, s28, 1
    s_or_b32 s30, s30, s31
    s_or_b32 s30, s30, s29
    s_and_b32 s31, s22, 0x18
    s_or_b32 s30, s30, s31
    s_lshl_b32 s33, s30, 7
    s_lshl_b32 s32, s22, 7
    s_cmp_eq_u32 s21, 0
    s_cbranch_scc1 M_c_r0
    s_lshl_b32 s32, s22, 10
    s_add_u32 s32, s32, 135168
    s_lshl_b32 s33, s27, 4
    s_lshl_b32 s28, s28, 8
    s_or_b32 s33, s33, s28
    s_lshl_b32 s29, s29, 7
    s_or_b32 s33, s33, s29
    s_bfe_u32 s28, s22, 0x10003
    s_lshl_b32 s28, s28, 5
    s_or_b32 s33, s33, s28
    s_bfe_u32 s28, s22, 0x10004
    s_lshl_b32 s28, s28, 9
    s_or_b32 s33, s33, s28
    s_add_u32 s33, s33, 4096
M_c_r0:
    s_mul_i32 s41, s20, 20480
    s_add_u32 s41, s41, 173605504
    s_lshl_b32 s46, s20, 17
    s_add_u32 s46, s46, 171966464
    s_add_u32 s46, s46, s25
    s_xor_b32 s47, s46, 0x20000
    s_mov_b32 s38, 0x00ff00ff
    s_mov_b32 s39, 0
    s_mov_b32 s62, 0x00030003
    s_mov_b32 s63, 0x00030003
    s_mov_b32 s40, 0x3e0293ee
    s_movk_i32 s45, 0x3f80
    s_mov_b32 s68, 0x33800000
    s_mov_b32 s69, 0x18000000
    s_lshl_b32 s51, s22, 7
    s_add_u32 s52, s51, 167862272
    s_lshl_b32 s51, s22, 8
    s_add_u32 s51, s51, 167854080
    s_mov_b32 s24, 0x3f803f80
    s_mov_b32 s25, 0x3f803f80
    s_mov_b32 s16, 0x3f003f00
    s_mov_b32 s17, 0x3f003f00
    s_lshl_b32 s53, s22, 13
    s_add_u32 s53, s53, 218103808
    s_lshl_b32 s27, s20, 12
    s_add_u32 s53, s53, s27
    s_lshl_b32 s27, s20, 2
    s_add_u32 s52, s52, s27
    s_cmp_eq_u32 s20, 0
    s_cselect_b64 s[42:43], -1, 0
    s_cselect_b64 s[66:67], -1, 0
    s_mov_b32 s44, 0
    s_mov_b32 s54, 0
    s_mov_b32 s71, 0
    s_mov_b32 s4, 0x10000000
    s_mov_b32 s60, 0x10000000
    s_mov_b32 s64, 0x10000000
    s_mov_b32 s65, 0x10000000
    s_mul_i32 s27, s21, 167936
    s_add_u32 s27, s27, s34
    s_mul_i32 s28, s22, 4224
    s_add_u32 s28, s28, s27
    s_mov_b32 exec_hi, 0
    buffer_load_dword v10, v9, s[8:11], s28 offen sc1
    s_lshl_b32 s28, s22, 10
    s_add_u32 s28, s28, s27
    s_add_u32 s28, s28, 135168
    s_mov_b64 exec, 0xff
    buffer_load_dword v10, v9, s[8:11], s28 offen sc1
    s_mul_i32 s27, s21, 5120
    s_add_u32 s27, s27, s41
    s_mul_i32 s28, s22, 160
    s_add_u32 s28, s28, s27
    s_mov_b64 exec, 3
    buffer_load_dword v10, v9, s[8:11], s28 offen sc1
    s_mov_b64 exec, -1
    s_waitcnt vmcnt(0) lgkmcnt(0)
    s_barrier
    s_cmp_lg_u32 s23, 0
    s_cbranch_scc1 M_c_slow
    s_cmp_eq_u32 s21, 1
    s_cbranch_scc1 M_c0_1_layer
    s_cmp_eq_u32 s21, 2
    s_cbranch_scc1 M_c0_2_layer
    s_cmp_eq_u32 s21, 3
    s_cbranch_scc1 M_c0_3_layer
M_c0_0_layer:
    s_lshr_b32 s27, s44, 6
    s_mul_i32 s50, s27, 33554432
    s_lshl_b32 s27, s22, 13
    s_add_u32 s50, s50, s27
    s_add_u32 s50, s50, 37748736
    s_barrier
    s_mov_b32 s26, 0x10010000
    s_mov_b32 s3, s26
    s_mul_i32 s27, s20, 5120
    s_add_u32 s48, s27, 167772160
    s_sub_u32 s49, 167777280, s27
    s_and_b32 s55, s44, 3
    s_mul_i32 s55, s55, 167936
    s_add_u32 s55, s55, s34
    s_add_u32 s58, s55, s35
    s_and_b32 s57, s44, 63
    s_add_u32 s43, s55, s32
    s_add_u32 s61, s43, 33792
    s_add_u32 s100, s43, 67584
    s_add_u32 s101, s43, 101376
    ds_read_b128 v[56:59], v5 offset:0
    ds_read_b128 v[60:63], v5 offset:1024
    ds_read_b128 v[64:67], v5 offset:2048
    ds_read_b128 v[68:71], v5 offset:3072
    v_mov_b64 v[12:13], 0
    v_mov_b64 v[14:15], 0
    v_mov_b64 v[16:17], 0
    v_mov_b64 v[18:19], 0
    v_mov_b64 v[20:21], 0
    v_mov_b64 v[22:23], 0
    v_mov_b64 v[24:25], 0
    v_mov_b64 v[26:27], 0
    v_mov_b64 v[28:29], 0
    v_mov_b64 v[30:31], 0
    v_mov_b64 v[32:33], 0
    v_mov_b64 v[34:35], 0
    s_mov_b32 s70, 0
    s_waitcnt lgkmcnt(0)
M_c0_0_top:
    s_nop 0
    s_barrier
    ds_read_b128 v[36:39], v6 offset:13312
    ds_read_b128 v[40:43], v6 offset:14336
    s_mov_b32 m0, 8192
    s_nop 0
    buffer_load_dwordx4 v0, s[8:11], s49 offen offset:0 sc1 lds
    buffer_load_dwordx4 v0, s[8:11], s49 offen offset:1024 sc1 lds
M_c0_0_lr_r:
    s_waitcnt lgkmcnt(1)
    v_smfmac_f32_16x16x64_bf16 v[20:23], v[36:39], v[56:63], v1
    ds_read_b128 v[56:59], v5 offset:4096
    v_smfmac_f32_16x16x64_bf16 v[24:27], v[36:39], v[64:71], v1
    ds_read_b128 v[60:63], v5 offset:5120
    v_smfmac_f32_16x16x64_bf16 v[28:31], v[36:39], a[248:255], v1
    ds_read_b128 v[64:67], v5 offset:6144
    v_smfmac_f32_16x16x64_bf16 v[32:35], v[36:39], a[240:247], v1
    ds_read_b128 v[68:71], v5 offset:7168
    v_smfmac_f32_16x16x64_bf16 v[12:15], v[36:39], a[232:239], v1
    ds_read_b128 v[44:47], v6 offset:15360
    s_waitcnt lgkmcnt(3)
    v_smfmac_f32_16x16x64_bf16 v[16:19], v[36:39], v[56:63], v1
    ds_read_b128 v[56:59], v5 offset:8192
    v_smfmac_f32_16x16x64_bf16 v[20:23], v[40:43], a[224:231], v1
    ds_read_b128 v[60:63], v5 offset:9216
    v_smfmac_f32_16x16x64_bf16 v[24:27], v[40:43], a[216:223], v1
    ds_read_b128 v[48:51], v6 offset:16384
    s_waitcnt lgkmcnt(4)
    v_smfmac_f32_16x16x64_bf16 v[28:31], v[40:43], v[64:71], v1
    ds_read_b128 v[64:67], v5 offset:10240
    v_smfmac_f32_16x16x64_bf16 v[32:35], v[40:43], a[208:215], v1
    ds_read_b128 v[68:71], v5 offset:11264
    v_smfmac_f32_16x16x64_bf16 v[12:15], v[40:43], a[200:207], v1
    ds_read_b128 v[52:55], v6 offset:17408
    s_waitcnt lgkmcnt(6)
    s_waitcnt lgkmcnt(4)
    v_max3_u32 v10, v36, v40, v44
    v_smfmac_f32_16x16x64_bf16 v[16:19], v[40:43], v[56:63], v1
    ds_read_b128 v[56:59], v5 offset:12288
    s_waitcnt lgkmcnt(1)
    v_max3_u32 v10, v10, v48, v52
    v_smfmac_f32_16x16x64_bf16 v[20:23], v[44:47], a[192:199], v1
    ds_read_b128 v[60:63], v5 offset:13312
    v_cmp_eq_u32 vcc, -1, v10
    v_smfmac_f32_16x16x64_bf16 v[24:27], v[44:47], a[184:191], v1
    s_cbranch_vccnz M_c0_0_lr
    v_smfmac_f32_16x16x64_bf16 v[28:31], v[44:47], v[64:71], v1
    ds_read_b128 v[64:67], v5 offset:14336
    v_smfmac_f32_16x16x64_bf16 v[32:35], v[44:47], a[176:183], v1
    ds_read_b128 v[68:71], v5 offset:15360
    v_smfmac_f32_16x16x64_bf16 v[20:23], v[48:51], a[168:175], v1
    s_waitcnt lgkmcnt(2)
    v_smfmac_f32_16x16x64_bf16 v[24:27], v[48:51], v[56:63], v1
    ds_read_b128 v[56:59], v5 offset:16384
    v_smfmac_f32_16x16x64_bf16 v[28:31], v[48:51], a[160:167], v1
    ds_read_b128 v[60:63], v5 offset:17408
    v_smfmac_f32_16x16x64_bf16 v[32:35], v[48:51], a[152:159], v1
    s_waitcnt vmcnt(0)
    s_barrier
    ds_read_b128 v[36:39], v6 offset:8192
    ds_read_b128 v[40:43], v6 offset:9216
    s_waitcnt lgkmcnt(4)
    v_smfmac_f32_16x16x64_bf16 v[20:23], v[52:55], v[64:71], v1
    ds_read_b128 v[44:47], v6 offset:10240
    ds_read_b128 v[48:51], v6 offset:11264
    v_smfmac_f32_16x16x64_bf16 v[24:27], v[52:55], a[144:151], v1
    ds_read_b32 v11, v6 offset:12288
    ds_read_b128 v[64:67], v5 offset:18432
    v_smfmac_f32_16x16x64_bf16 v[28:31], v[52:55], a[136:143], v1
    ds_read_b128 v[68:71], v5 offset:19456
    s_waitcnt lgkmcnt(4)
    v_max3_u32 v10, v36, v40, v44
    v_smfmac_f32_16x16x64_bf16 v[32:35], v[52:55], v[56:63], v1
    s_waitcnt lgkmcnt(2)
    v_max3_u32 v10, v10, v48, v11
    v_cmp_eq_u32 vcc, -1, v10
    s_cbranch_vccnz M_c0_0_rr
M_c0_0_rr_r:
    ds_read_b128 v[52:55], v6 offset:12288
    buffer_store_dwordx4 v[76:79], v0, s[8:11], s4 offen offset:0 sc1
    s_mov_b32 s4, 0x10000000
    s_mov_b64 exec, 0x3ff
    buffer_store_dwordx4 v[72:75], v0, s[8:11], s60 offen sc1
    s_mov_b64 exec, -1
    s_mov_b32 s60, 0x10000000
    v_smfmac_f32_16x16x64_bf16 v[20:23], v[36:39], a[128:135], v1
    ds_read_b128 v[56:59], v5 offset:20480
    v_smfmac_f32_16x16x64_bf16 v[24:27], v[36:39], a[120:127], v1
    ds_read_b128 v[60:63], v5 offset:21504
    s_waitcnt lgkmcnt(3)
    v_smfmac_f32_16x16x64_bf16 v[20:23], v[40:43], v[64:71], v1
    ds_read_b128 v[64:67], v5 offset:22528
    v_smfmac_f32_16x16x64_bf16 v[24:27], v[40:43], a[112:119], v1
    ds_read_b128 v[68:71], v5 offset:23552
    v_smfmac_f32_16x16x64_bf16 v[20:23], v[44:47], a[104:111], v1
    s_waitcnt lgkmcnt(2)
    v_smfmac_f32_16x16x64_bf16 v[24:27], v[44:47], v[56:63], v1
    ds_read_b128 v[56:59], v5 offset:24576
    v_smfmac_f32_16x16x64_bf16 v[20:23], v[48:51], a[96:103], v1
    ds_read_b128 v[60:63], v5 offset:25600
    v_smfmac_f32_16x16x64_bf16 v[24:27], v[48:51], a[88:95], v1
    s_waitcnt lgkmcnt(2)
    v_smfmac_f32_16x16x64_bf16 v[20:23], v[52:55], v[64:71], v1
    ds_read_b128 v[64:67], v5 offset:26624
    v_smfmac_f32_16x16x64_bf16 v[24:27], v[52:55], a[80:87], v1
    ds_read_b128 v[68:71], v5 offset:27648
    v_smfmac_f32_16x16x64_bf16 v[28:31], v[36:39], a[72:79], v1
    s_waitcnt lgkmcnt(2)
    v_smfmac_f32_16x16x64_bf16 v[32:35], v[36:39], v[56:63], v1
    ds_read_b128 v[56:59], v5 offset:28672
    s_nop 0
    v_permlane32_swap_b32 v20, v21
    v_smfmac_f32_16x16x64_bf16 v[28:31], v[40:43], a[64:71], v1
    ds_read_b128 v[60:63], v5 offset:29696
    v_permlane32_swap_b32 v22, v23
    v_smfmac_f32_16x16x64_bf16 v[32:35], v[40:43], a[56:63], v1
    s_waitcnt lgkmcnt(2)
    v_permlane32_swap_b32 v24, v25
    v_smfmac_f32_16x16x64_bf16 v[28:31], v[44:47], v[64:71], v1
    ds_read_b128 v[64:67], v5 offset:30720
    v_permlane32_swap_b32 v26, v27
    v_smfmac_f32_16x16x64_bf16 v[32:35], v[44:47], a[48:55], v1
    ds_read_b128 v[68:71], v5 offset:31744
    v_add_f32 v20, v20, v21
    v_add_f32 v22, v22, v23
    v_smfmac_f32_16x16x64_bf16 v[28:31], v[48:51], a[40:47], v1
    s_waitcnt lgkmcnt(2)
    v_add_f32 v24, v24, v25
    v_add_f32 v26, v26, v27
    v_smfmac_f32_16x16x64_bf16 v[32:35], v[48:51], v[56:63], v1
    ds_read_b128 v[56:59], v5 offset:32768
    v_mul_f32 v20, s40, v20
    v_mul_f32 v24, s40, v24
    v_smfmac_f32_16x16x64_bf16 v[28:31], v[52:55], a[32:39], v1
    ds_read_b128 v[60:63], v5 offset:33792
    v_mul_f32 v22, s40, v22
    v_mul_f32 v26, s40, v26
    v_smfmac_f32_16x16x64_bf16 v[32:35], v[52:55], a[24:31], v1
    s_waitcnt lgkmcnt(2)
    v_cvt_pk_bf16_f32 v20, v20, v24
    v_cvt_pk_bf16_f32 v21, v22, v26
    v_smfmac_f32_16x16x64_bf16 v[12:15], v[36:39], v[64:71], v1
    s_cmp_eq_u32 s57, 0
    s_cbranch_scc1 M_c0_0_first
M_c0_0_first_r:
    ds_write_b32 v2, v20 offset:18432
    v_smfmac_f32_16x16x64_bf16 v[16:19], v[36:39], a[16:23], v1
    ds_write_b32 v2, v21 offset:19008
    v_permlane32_swap_b32 v28, v29
    v_smfmac_f32_16x16x64_bf16 v[12:15], v[40:43], a[8:15], v1
    ds_read_b128 v[36:39], v6 offset:15360
    s_waitcnt lgkmcnt(3)
    v_permlane32_swap_b32 v30, v31
    v_smfmac_f32_16x16x64_bf16 v[16:19], v[40:43], v[56:63], v1
    ds_read_b128 v[64:67], v0 offset:2048
    v_permlane32_swap_b32 v32, v33
    v_smfmac_f32_16x16x64_bf16 v[12:15], v[44:47], a[0:7], v1
    ds_read_b128 v[68:71], v0 offset:3072
    v_permlane32_swap_b32 v34, v35
    v_smfmac_f32_16x16x64_bf16 v[16:19], v[44:47], v[248:255], v1
    s_waitcnt lgkmcnt(3)
    s_barrier
    ds_read_b128 v[40:43], v6 offset:16384
    v_add_f32 v28, v28, v29
    v_add_f32 v30, v30, v31
    v_smfmac_f32_16x16x64_bf16 v[12:15], v[48:51], v[240:247], v1
    ds_read_b128 v[56:59], v0 offset:0
    v_add_f32 v32, v32, v33
    v_add_f32 v34, v34, v35
    v_smfmac_f32_16x16x64_bf16 v[16:19], v[48:51], v[232:239], v1
    ds_read_b128 v[60:63], v0 offset:1024
    v_cvt_pk_bf16_f32 v28, v28, v32
    v_cvt_pk_bf16_f32 v29, v30, v34
    v_smfmac_f32_16x16x64_bf16 v[12:15], v[52:55], v[224:231], v1
    ds_write_b32 v2, v28 offset:20736
    ds_read_b128 v[20:23], v3 offset:18432
    v_smfmac_f32_16x16x64_bf16 v[16:19], v[52:55], v[216:223], v1
    ds_write_b32 v2, v29 offset:21312
    ds_read_b128 v[24:27], v3 offset:18496
    s_waitcnt lgkmcnt(9)
    v_smfmac_f32_16x16x64_bf16 v[12:15], v[36:39], v[208:215], v1
    ds_read_b128 v[72:75], v3 offset:18560
    ds_read_b128 v[44:47], v3 offset:18624
    v_smfmac_f32_16x16x64_bf16 v[16:19], v[36:39], v[200:207], v1
    ds_read_b128 v[48:51], v6 offset:17408
    s_waitcnt lgkmcnt(9)
    v_smfmac_f32_16x16x64_bf16 v[12:15], v[40:43], v[192:199], v1
    v_smfmac_f32_16x16x64_bf16 v[16:19], v[40:43], v[184:191], v1
    s_waitcnt lgkmcnt(5)
    v_mfma_f32_16x16x32_bf16 v[28:31], v[56:59], v[20:23], 0
    ds_read_b128 v[56:59], v0 offset:4096
    s_waitcnt lgkmcnt(4)
    v_mov_b64 v[52:53], s[24:25]
    v_mfma_f32_16x16x32_bf16 v[28:31], v[60:63], v[24:27], v[28:31]
    ds_read_b128 v[60:63], v0 offset:5120
    s_barrier
    s_waitcnt lgkmcnt(4)
    v_mfma_f32_16x16x32_bf16 v[28:31], v[64:67], v[72:75], v[28:31]
    ds_read_b128 v[64:67], v0 offset:6144
    s_waitcnt lgkmcnt(4)
    v_mov_b64 v[54:55], s[24:25]
    v_mfma_f32_16x16x32_bf16 v[28:31], v[68:71], v[44:47], v[28:31]
    ds_read_b128 v[68:71], v0 offset:7168
    s_waitcnt lgkmcnt(4)
    v_mov_b64 v[10:11], s[16:17]
    v_smfmac_f32_16x16x64_bf16 v[12:15], v[48:51], v[176:183], v1
    ds_read_b128 v[36:39], v3 offset:20736
    v_smfmac_f32_16x16x64_bf16 v[16:19], v[48:51], v[168:175], v1
    ds_read_b128 v[40:43], v3 offset:20800
    s_waitcnt lgkmcnt(4)
    v_mfma_f32_16x16x32_bf16 v[32:35], v[56:59], v[20:23], 0
    v_exp_f32 v28, v28
    v_mfma_f32_16x16x32_bf16 v[32:35], v[60:63], v[24:27], v[32:35]
    s_waitcnt lgkmcnt(2)
    v_exp_f32 v29, v29
    ds_read_b128 v[56:59], v3 offset:20864
    v_mfma_f32_16x16x32_bf16 v[32:35], v[64:67], v[72:75], v[32:35]
    v_exp_f32 v30, v30
    ds_read_b128 v[60:63], v3 offset:20928
    v_mfma_f32_16x16x32_bf16 v[32:35], v[68:71], v[44:47], v[32:35]
    s_waitcnt lgkmcnt(3)
    v_exp_f32 v31, v31
    v_mfma_f32_16x16x32_bf16 v[48:51], v[36:39], v[20:23], 0
    s_waitcnt lgkmcnt(2)
    v_cvt_pk_bf16_f32 v28, v28, v29
    v_cvt_pk_bf16_f32 v29, v30, v31
    v_mfma_f32_16x16x32_bf16 v[48:51], v[40:43], v[24:27], v[48:51]
    s_waitcnt lgkmcnt(1)
    v_cvt_pk_bf16_f32 v12, v12, v13
    v_cvt_pk_bf16_f32 v13, v14, v15
    v_mfma_f32_16x16x32_bf16 v[48:51], v[56:59], v[72:75], v[48:51]
    s_waitcnt lgkmcnt(0)
    v_exp_f32 v32, v32
    v_mfma_f32_16x16x32_bf16 v[48:51], v[60:63], v[44:47], v[48:51]
    v_exp_f32 v33, v33
    v_exp_f32 v34, v34
    v_exp_f32 v35, v35
    v_cvt_pk_bf16_f32 v30, v32, v33
    v_cvt_pk_bf16_f32 v31, v34, v35
    v_cvt_pk_bf16_f32 v14, v16, v17
    v_cvt_pk_bf16_f32 v15, v18, v19
    v_mfma_f32_16x16x32_bf16 v[72:75], v[52:55], v[28:31], 0
    v_exp_f32 v48, v48
    v_mfma_f32_16x16x32_bf16 v[20:23], v[80:83], v[28:31], 0
    v_exp_f32 v49, v49
    v_mfma_f32_16x16x32_bf16 v[24:27], v[84:87], v[28:31], 0
    v_exp_f32 v50, v50
    v_exp_f32 v51, v51
    v_cvt_pk_bf16_f32 v48, v48, v49
    v_cvt_pk_bf16_f32 v49, v50, v51
    v_cndmask_b32_e64 v76, v12, v36, s[66:67]
    v_cndmask_b32_e64 v77, v13, v37, s[66:67]
M_c0_0_fin:
    v_mfma_f32_16x16x16_bf16 v[72:75], v[10:11], v[48:49], v[72:75]
    v_cndmask_b32_e64 v78, v14, v38, s[66:67]
    v_cndmask_b32_e64 v79, v15, v39, s[66:67]
    v_mfma_f32_16x16x16_bf16 v[20:23], v[12:13], v[48:49], v[20:23]
    s_cmp_eq_u32 s57, 63
    v_mov_b64 v[44:45], 0
    v_mov_b64 v[46:47], 0
    v_mfma_f32_16x16x16_bf16 v[24:27], v[14:15], v[48:49], v[24:27]
    s_cbranch_scc1 M_c0_0_last
    v_mov_b64 v[68:69], 0
    v_rcp_f32 v74, v72
    v_subrev_u32 v73, s68, v72
    v_cmp_lt_u32 vcc, s69, v73
    v_mov_b64 v[70:71], 0
    v_mov_b32 v5, v5
    v_mov_b32 v5, v5
    v_cndmask_b32_e64 v20, v20, v24, s[18:19]
    v_cndmask_b32_e64 v21, v21, v25, s[18:19]
    v_cndmask_b32_e64 v22, v22, v26, s[18:19]
    v_cndmask_b32_e64 v23, v23, v27, s[18:19]
    v_pk_mul_f32 v[20:21], v[20:21], v[74:75] op_sel_hi:[1,0]
    v_pk_mul_f32 v[22:23], v[22:23], v[74:75] op_sel_hi:[1,0]
    v_cvt_pk_bf16_f32 v20, v20, v21
    v_cvt_pk_bf16_f32 v21, v22, v23
    ds_write_b64 v0, v[20:21] offset:13312
    s_cbranch_vccnz M_c0_0_zbad
M_c0_0_zok:
    s_cmp_eq_u32 s57, 0
    s_cbranch_scc1 M_c0_0_first2
M_c0_0_first2_r:
    buffer_load_dwordx4 v[80:83], v0, s[8:11], s3 offen offset:0 sc1
    buffer_load_dwordx4 v[84:87], v0, s[8:11], s3 offen offset:1024 sc1
    s_waitcnt lgkmcnt(0)
    s_barrier
    ds_read_b128 v[32:35], v0 offset:13312
    ds_read_b128 v[40:43], v0 offset:14336
    s_mov_b32 m0, 0
    s_nop 0
    buffer_load_dwordx4 v0, s[8:11], s26 offen offset:0 sc1 lds
    buffer_load_dwordx4 v0, s[8:11], s26 offen offset:1024 sc1 lds
    v_mov_b64 v[64:65], 0
    v_mov_b64 v[66:67], 0
    v_mov_b64 v[60:61], 0
    v_mov_b64 v[62:63], 0
    v_mov_b64 v[56:57], 0
    v_mov_b64 v[58:59], 0
    s_waitcnt lgkmcnt(1)
    s_nop 0
    v_smfmac_f32_16x16x64_bf16 v[56:59], v[32:35], v[160:167], v1
    v_smfmac_f32_16x16x64_bf16 v[60:63], v[32:35], v[144:151], v1
    s_waitcnt lgkmcnt(0)
    v_smfmac_f32_16x16x64_bf16 v[56:59], v[40:43], v[152:159], v1
    v_smfmac_f32_16x16x64_bf16 v[60:63], v[40:43], v[136:143], v1
    v_smfmac_f32_16x16x64_bf16 v[64:67], v[32:35], v[128:135], v1
    v_smfmac_f32_16x16x64_bf16 v[68:71], v[32:35], v[112:119], v1
    v_permlane32_swap_b32 v56, v57
    v_smfmac_f32_16x16x64_bf16 v[64:67], v[40:43], v[120:127], v1
    v_permlane32_swap_b32 v58, v59
    v_smfmac_f32_16x16x64_bf16 v[68:71], v[40:43], v[104:111], v1
    v_add_f32 v56, v56, v57
    v_add_f32 v58, v58, v59
    v_smfmac_f32_16x16x64_bf16 v[44:47], v[32:35], v[96:103], v1
    v_permlane32_swap_b32 v60, v61
    v_smfmac_f32_16x16x64_bf16 v[44:47], v[40:43], v[88:95], v1
    v_permlane32_swap_b32 v62, v63
    v_add_f32 v60, v60, v61
    v_add_f32 v62, v62, v63
    v_cvt_pk_bf16_f32 v36, v56, v60
    v_cvt_pk_bf16_f32 v38, v58, v62
    v_permlane32_swap_b32 v64, v65
    v_permlane32_swap_b32 v66, v67
    v_add_f32 v64, v64, v65
    v_add_f32 v66, v66, v67
    v_permlane32_swap_b32 v68, v69
    v_permlane32_swap_b32 v70, v71
    v_add_f32 v68, v68, v69
    v_add_f32 v70, v70, v71
    v_cvt_pk_bf16_f32 v37, v64, v68
    v_cvt_pk_bf16_f32 v39, v66, v70
    buffer_store_dwordx4 v[36:39], v0, s[8:11], s58 offen
    v_permlane32_swap_b32 v44, v45
    v_permlane32_swap_b32 v46, v47
    v_add_f32 v44, v44, v45
    v_add_f32 v46, v46, v47
    v_cvt_pk_bf16_f32 v44, v44, v46
    buffer_store_dword v44, v7, s[8:11], s55 offen
    v_and_b32 v32, 16, v0
    v_bfe_u32 v33, v0, 5, 2
    v_lshlrev_b32_e64 v32, v32, s45
    v_cmp_eq_u32_e64 s[64:65], 0, v33
    v_cmp_eq_u32_e64 vcc, 1, v33
    s_add_u32 s27, s44, 1
    s_and_b32 s27, s27, 3
    v_cndmask_b32_e64 v72, 0, v32, s[64:65]
    v_cndmask_b32_e64 v73, 0, v32, vcc
    v_cmp_eq_u32_e64 s[64:65], 2, v33
    v_cmp_eq_u32_e64 vcc, 3, v33
    s_mul_i32 s48, s27, 5120
    s_add_u32 s48, s48, s41
    v_cndmask_b32_e64 v74, 0, v32, s[64:65]
    v_cndmask_b32_e64 v75, 0, v32, vcc
    s_lshl_b32 s27, s27, 15
    s_add_u32 s49, s27, s47
    v_bfe_u32 v11, v0, 4, 3
    v_lshlrev_b32 v11, 3, v11
    v_lshrrev_b32 v32, 8, v0
    v_lshl_add_u32 v11, v32, 6, v11
    s_add_u32 s56, s27, s46
    s_add_u32 s56, s56, s33
    s_add_u32 s58, s48, s33
    v_mov_b32 v5, v5
    s_nop 1
    v_mov_b32 v5, v5
    s_nop 1
    v_mov_b32 v5, v5
    s_nop 1
    v_mov_b32 v5, v5
    s_nop 1
    v_mov_b32 v5, v5
    s_nop 1
    v_mov_b32 v5, v5
    s_nop 1
    v_mov_b32 v5, v5
    s_nop 1
    v_mov_b32 v5, v5
    s_nop 1
    buffer_load_dwordx4 v[12:15], v8, s[8:11], s43 offen sc1
    buffer_load_dwordx4 v[16:19], v8, s[8:11], s61 offen sc1
    buffer_load_dwordx4 v[20:23], v8, s[8:11], s100 offen sc1
    buffer_load_dwordx4 v[24:27], v8, s[8:11], s101 offen sc1
    v_mov_b32 v5, v5
    s_nop 1
    v_mov_b32 v5, v5
    s_nop 1
    v_mov_b32 v5, v5
    s_nop 1
    v_mov_b32 v5, v5
    s_nop 1
    v_mov_b32 v5, v5
    s_nop 1
    v_mov_b32 v5, v5
    s_nop 1
    v_mov_b32 v5, v5
    s_nop 1
    v_mov_b32 v5, v5
    s_nop 1
    buffer_load_dwordx4 v[40:43], v8, s[8:11], s43 offen sc1
    buffer_load_dwordx4 v[44:47], v8, s[8:11], s61 offen sc1
    buffer_load_dwordx4 v[48:51], v8, s[8:11], s100 offen sc1
    buffer_load_dwordx4 v[52:55], v8, s[8:11], s101 offen sc1
    v_mov_b32 v5, v5
    s_nop 1
    v_mov_b32 v5, v5
    s_nop 1
    v_mov_b32 v5, v5
    v_mov_b32 v5, v5
    s_waitcnt vmcnt(7)
    v_mfma_f32_16x16x32_bf16 v[28:31], v[72:75], v[12:15], 0
    s_waitcnt vmcnt(6)
    v_mfma_f32_16x16x32_bf16 v[28:31], v[72:75], v[16:19], v[28:31]
    s_waitcnt vmcnt(5)
    v_mfma_f32_16x16x32_bf16 v[28:31], v[72:75], v[20:23], v[28:31]
    s_waitcnt vmcnt(4)
    v_mfma_f32_16x16x32_bf16 v[28:31], v[72:75], v[24:27], v[28:31]
    v_max3_u32 v32, v12, v16, v20
    v_max_u32 v32, v32, v24
    v_cmp_eq_u32 vcc, -1, v32
    s_cbranch_vccnz M_c0_0_wq1
    v_mov_b32 v5, v5
    v_mov_b32 v5, v5
    v_mov_b32 v5, v5
    v_mov_b32 v5, v5
    v_add_f32_dpp v28, v28, v28 row_ror:8 row_mask:0xf bank_mask:0xf
    v_add_f32_dpp v29, v29, v29 row_ror:8 row_mask:0xf bank_mask:0xf
    v_add_f32_dpp v30, v30, v30 row_ror:8 row_mask:0xf bank_mask:0xf
    v_add_f32_dpp v31, v31, v31 row_ror:8 row_mask:0xf bank_mask:0xf
    v_cmp_u_f32 vcc, v28, v28
    v_cvt_pk_bf16_f32 v28, v28, v29
    v_cvt_pk_bf16_f32 v29, v30, v31
    s_cbranch_vccnz M_c0_0_wrb_e0
    s_mov_b64 exec, s[38:39]
    buffer_store_dwordx2 v[28:29], v11, s[8:11], s58 offen
M_c0_0_wrb_d:
    s_barrier
    buffer_store_dwordx2 v[28:29], v11, s[8:11], s56 offen sc1
M_c0_0_wrb_g:
    s_mov_b64 exec, -1
    s_waitcnt vmcnt(2)
    ds_read_b128 v[56:59], v5 offset:0
    ds_read_b128 v[60:63], v5 offset:1024
    ds_read_b128 v[64:67], v5 offset:2048
    ds_read_b128 v[68:71], v5 offset:3072
    v_mov_b64 v[12:13], 0
    v_mov_b64 v[14:15], 0
    v_mov_b64 v[16:17], 0
    v_mov_b64 v[18:19], 0
    v_mov_b64 v[20:21], 0
    v_mov_b64 v[22:23], 0
    v_mov_b64 v[24:25], 0
    v_mov_b64 v[26:27], 0
    v_mov_b64 v[28:29], 0
    v_mov_b64 v[30:31], 0
    v_mov_b64 v[32:33], 0
    v_mov_b64 v[34:35], 0
    s_and_b32 s26, s44, 63
    s_add_u32 s26, s26, 2
    s_min_u32 s26, s26, 63
    s_lshl_b32 s26, s26, 18
    s_add_u32 s26, s26, s50
    s_add_u32 s3, s26, 16777216
    s_lshl_b32 s4, s44, 18
    s_add_u32 s4, s4, s53
    v_mov_b64 v[72:73], -1
    v_mov_b64 v[74:75], -1
    s_add_u32 s28, s44, 3
    s_and_b32 s29, s28, 3
    s_mul_i32 s31, s22, 160
    s_mul_i32 s28, s29, 167936
    s_add_u32 s28, s28, s34
    s_add_u32 s64, s28, s35
    s_mul_i32 s65, s29, 5120
    s_add_u32 s65, s65, s41
    s_add_u32 s65, s65, s31
    s_lshl_b32 s60, s29, 15
    s_add_u32 s60, s60, s47
    s_add_u32 s60, s60, s31
    s_add_u32 s44, s44, 1
    s_and_b32 s55, s44, 3
    s_mul_i32 s55, s55, 167936
    s_add_u32 s55, s55, s34
    s_add_u32 s58, s55, s35
    s_and_b32 s57, s44, 63
    s_add_u32 s43, s55, s32
    s_add_u32 s61, s43, 33792
    s_add_u32 s100, s43, 67584
    s_add_u32 s101, s43, 101376
    s_nop 15
    s_nop 15
    s_nop 12
    buffer_store_dwordx4 v[72:75], v0, s[8:11], s64 offen offset:0
    buffer_store_dwordx4 v[72:75], v0, s[8:11], s64 offen offset:1024
    s_mov_b64 exec, 0x3ff
    buffer_store_dwordx4 v[72:75], v0, s[8:11], s65 offen
    s_mov_b64 exec, -1
    s_mov_b32 s65, 0x10000000
    s_mov_b32 s64, 0x10000000
    s_mov_b32 s70, 0
    s_waitcnt lgkmcnt(0)
    s_branch M_c0_0_top
M_c0_0_restart:
    s_waitcnt vmcnt(0) lgkmcnt(0)
    s_nop 7
    s_barrier
    ds_read_b128 v[56:59], v5 offset:0
    ds_read_b128 v[60:63], v5 offset:1024
    ds_read_b128 v[64:67], v5 offset:2048
    ds_read_b128 v[68:71], v5 offset:3072
    v_mov_b64 v[12:13], 0
    v_mov_b64 v[14:15], 0
    v_mov_b64 v[16:17], 0
    v_mov_b64 v[18:19], 0
    v_mov_b64 v[20:21], 0
    v_mov_b64 v[22:23], 0
    v_mov_b64 v[24:25], 0
    v_mov_b64 v[26:27], 0
    v_mov_b64 v[28:29], 0
    v_mov_b64 v[30:31], 0
    v_mov_b64 v[32:33], 0
    v_mov_b64 v[34:35], 0
    s_waitcnt vmcnt(0) lgkmcnt(0)
    s_branch M_c0_0_top
M_c0_0_zbad:
    s_cmp_eq_u32 s70, 2
    s_cbranch_scc1 M_c0_0_zok
    v_cmp_u_f32 vcc, v72, v72
    s_cbranch_vccz M_c0_0_exact
    s_cmp_eq_u32 s70, 1
    s_cbranch_scc1 M_c0_0_exact
M_c0_0_vfy0:
    s_mov_b32 s70, 1
    s_mov_b32 s30, 0
    s_waitcnt vmcnt(0) lgkmcnt(0)
    s_nop 7
M_c0_0_vfy:
    v_mov_b32 v10, 0
    s_add_u32 s59, s48, 4096
    buffer_load_dwordx4 v[36:39], v0, s[8:11], s48 offen offset:0 sc1
    buffer_load_dwordx4 v[40:43], v0, s[8:11], s48 offen offset:1024 sc1
    buffer_load_dwordx4 v[44:47], v0, s[8:11], s48 offen offset:2048 sc1
    buffer_load_dwordx4 v[48:51], v0, s[8:11], s48 offen offset:3072 sc1
    buffer_load_dwordx4 v[52:55], v0, s[8:11], s59 offen offset:0 sc1
    s_waitcnt vmcnt(4)
    v_max3_u32 v10, v10, v36, v37
    v_max3_u32 v10, v10, v38, v39
    s_waitcnt vmcnt(3)
    v_max3_u32 v10, v10, v40, v41
    v_max3_u32 v10, v10, v42, v43
    s_waitcnt vmcnt(2)
    v_max3_u32 v10, v10, v44, v45
    v_max3_u32 v10, v10, v46, v47
    s_waitcnt vmcnt(1)
    v_max3_u32 v10, v10, v48, v49
    v_max3_u32 v10, v10, v50, v51
    s_waitcnt vmcnt(0)
    v_max3_u32 v10, v10, v52, v53
    v_max3_u32 v10, v10, v54, v55
    s_add_u32 s59, s49, 4096
    buffer_load_dwordx4 v[36:39], v0, s[8:11], s49 offen offset:0 sc1
    buffer_load_dwordx4 v[40:43], v0, s[8:11], s49 offen offset:1024 sc1
    buffer_load_dwordx4 v[44:47], v0, s[8:11], s49 offen offset:2048 sc1
    buffer_load_dwordx4 v[48:51], v0, s[8:11], s49 offen offset:3072 sc1
    buffer_load_dwordx4 v[52:55], v0, s[8:11], s59 offen offset:0 sc1
    s_waitcnt vmcnt(4)
    v_max3_u32 v10, v10, v36, v37
    v_max3_u32 v10, v10, v38, v39
    s_waitcnt vmcnt(3)
    v_max3_u32 v10, v10, v40, v41
    v_max3_u32 v10, v10, v42, v43
    s_waitcnt vmcnt(2)
    v_max3_u32 v10, v10, v44, v45
    v_max3_u32 v10, v10, v46, v47
    s_waitcnt vmcnt(1)
    v_max3_u32 v10, v10, v48, v49
    v_max3_u32 v10, v10, v50, v51
    s_waitcnt vmcnt(0)
    v_max3_u32 v10, v10, v52, v53
    v_max3_u32 v10, v10, v54, v55
    v_cmp_eq_u32 vcc, -1, v10
    s_cbranch_vccz M_c0_0_restart
    s_add_u32 s30, s30, 1
    s_cmp_ge_u32 s30, 60000
    s_cbranch_scc1 M_fail
    s_branch M_c0_0_vfy
M_c0_0_exact:
    s_nop 7
    s_mov_b32 s70, 2
    s_waitcnt lgkmcnt(0)
    ds_read_b128 v[20:23], v3 offset:18432
    ds_read_b128 v[24:27], v3 offset:18496
    ds_read_b128 v[72:75], v3 offset:18560
    ds_read_b128 v[44:47], v3 offset:18624
    ds_read_b128 v[56:59], v0 offset:0
    s_waitcnt lgkmcnt(0)
    v_mfma_f32_16x16x32_bf16 v[28:31], v[56:59], v[20:23], 0
    s_nop 3
    ds_read_b128 v[60:63], v0 offset:1024
    s_waitcnt lgkmcnt(0)
    v_mfma_f32_16x16x32_bf16 v[28:31], v[60:63], v[24:27], v[28:31]
    s_nop 3
    ds_read_b128 v[56:59], v0 offset:2048
    s_waitcnt lgkmcnt(0)
    v_mfma_f32_16x16x32_bf16 v[28:31], v[56:59], v[72:75], v[28:31]
    s_nop 3
    ds_read_b128 v[60:63], v0 offset:3072
    s_waitcnt lgkmcnt(0)
    v_mfma_f32_16x16x32_bf16 v[28:31], v[60:63], v[44:47], v[28:31]
    s_nop 3
    ds_read_b128 v[56:59], v0 offset:4096
    s_waitcnt lgkmcnt(0)
    v_mfma_f32_16x16x32_bf16 v[32:35], v[56:59], v[20:23], 0
    s_nop 3
    ds_read_b128 v[60:63], v0 offset:5120
    s_waitcnt lgkmcnt(0)
    v_mfma_f32_16x16x32_bf16 v[32:35], v[60:63], v[24:27], v[32:35]
    s_nop 3
    ds_read_b128 v[56:59], v0 offset:6144
    s_waitcnt lgkmcnt(0)
    v_mfma_f32_16x16x32_bf16 v[32:35], v[56:59], v[72:75], v[32:35]
    s_nop 3
    ds_read_b128 v[60:63], v0 offset:7168
    s_waitcnt lgkmcnt(0)
    v_mfma_f32_16x16x32_bf16 v[32:35], v[60:63], v[44:47], v[32:35]
    s_nop 3
    ds_read_b128 v[56:59], v3 offset:20736
    s_waitcnt lgkmcnt(0)
    v_mfma_f32_16x16x32_bf16 v[48:51], v[56:59], v[20:23], 0
    s_nop 3
    ds_read_b128 v[60:63], v3 offset:20800
    s_waitcnt lgkmcnt(0)
    v_mfma_f32_16x16x32_bf16 v[48:51], v[60:63], v[24:27], v[48:51]
    s_nop 3
    ds_read_b128 v[56:59], v3 offset:20864
    s_waitcnt lgkmcnt(0)
    v_mfma_f32_16x16x32_bf16 v[48:51], v[56:59], v[72:75], v[48:51]
    s_nop 3
    ds_read_b128 v[60:63], v3 offset:20928
    s_waitcnt lgkmcnt(0)
    v_mfma_f32_16x16x32_bf16 v[48:51], v[60:63], v[44:47], v[48:51]
    s_nop 3
    v_max3_f32 v64, v28, v29, v30
    v_max3_f32 v64, v64, v31, v32
    v_max3_f32 v64, v64, v33, v34
    s_nop 0
    v_max3_f32 v64, v64, v35, v48
    v_max3_f32 v64, v64, v49, v50
    v_max_f32 v64, v64, v51
    v_mov_b32 v65, v64
    s_nop 1
    v_permlane16_swap_b32 v64, v65
    v_max_f32 v64, v64, v65
    v_mov_b32 v65, v64
    s_nop 1
    v_permlane32_swap_b32 v64, v65
    v_max_f32 v64, v64, v65
    v_sub_f32 v28, v28, v64
    v_exp_f32 v28, v28
    v_sub_f32 v29, v29, v64
    v_exp_f32 v29, v29
    v_sub_f32 v30, v30, v64
    v_exp_f32 v30, v30
    v_sub_f32 v31, v31, v64
    v_exp_f32 v31, v31
    v_sub_f32 v32, v32, v64
    v_exp_f32 v32, v32
    v_sub_f32 v33, v33, v64
    v_exp_f32 v33, v33
    v_sub_f32 v34, v34, v64
    v_exp_f32 v34, v34
    v_sub_f32 v35, v35, v64
    v_exp_f32 v35, v35
    v_sub_f32 v48, v48, v64
    v_exp_f32 v48, v48
    v_sub_f32 v49, v49, v64
    v_exp_f32 v49, v49
    v_sub_f32 v50, v50, v64
    v_exp_f32 v50, v50
    v_sub_f32 v51, v51, v64
    v_exp_f32 v51, v51
    v_cvt_pk_bf16_f32 v28, v28, v29
    v_cvt_pk_bf16_f32 v29, v30, v31
    v_cvt_pk_bf16_f32 v30, v32, v33
    v_cvt_pk_bf16_f32 v31, v34, v35
    v_cvt_pk_bf16_f32 v48, v48, v49
    v_cvt_pk_bf16_f32 v49, v50, v51
    v_mfma_f32_16x16x32_bf16 v[20:23], v[80:83], v[28:31], 0
    v_mfma_f32_16x16x32_bf16 v[24:27], v[84:87], v[28:31], 0
    v_mfma_f32_16x16x32_bf16 v[72:75], v[52:55], v[28:31], 0
    ds_read_b128 v[36:39], v3 offset:20736
    s_waitcnt lgkmcnt(0)
    s_nop 7
    s_branch M_c0_0_fin
M_c0_0_last:
    s_cmp_lg_u32 s70, 0
    s_cbranch_scc1 M_c0_0_last2
    v_cmp_u_f32 vcc, v32, v32
    s_cbranch_vccnz M_c0_0_vfy0
M_c0_0_last2:
    s_lshl_b32 s4, s44, 18
    s_add_u32 s4, s4, s53
    buffer_store_dwordx4 v[76:79], v0, s[8:11], s4 offen offset:0 sc1
    s_mov_b32 s4, 0x10000000
    s_waitcnt vmcnt(0) lgkmcnt(0)
    s_barrier
    s_nop 7
    v_mov_b64 v[72:73], -1
    v_mov_b64 v[74:75], -1
    s_add_u32 s28, s44, 3
    s_and_b32 s29, s28, 3
    s_mul_i32 s31, s22, 160
    s_mul_i32 s28, s29, 167936
    s_add_u32 s28, s28, s34
    s_add_u32 s64, s28, s35
    s_mul_i32 s65, s29, 5120
    s_add_u32 s65, s65, s41
    s_add_u32 s65, s65, s31
    s_lshl_b32 s60, s29, 15
    s_add_u32 s60, s60, s47
    s_add_u32 s60, s60, s31
    buffer_store_dwordx4 v[72:75], v0, s[8:11], s64 offen offset:0
    buffer_store_dwordx4 v[72:75], v0, s[8:11], s64 offen offset:1024
    s_mov_b64 exec, 0x3ff
    buffer_store_dwordx4 v[72:75], v0, s[8:11], s65 offen
    s_mov_b64 exec, -1
    s_mov_b32 s65, 0x10000000
    s_mov_b32 s64, 0x10000000
    s_mov_b64 exec, 0x3ff
    buffer_store_dwordx4 v[72:75], v0, s[8:11], s60 offen sc1
    s_mov_b64 exec, -1
    s_mov_b32 s60, 0x10000000
    s_waitcnt vmcnt(0)
    s_add_u32 s44, s44, 1
    s_cmp_eq_u32 s44, 128
    s_cbranch_scc1 M_end
    s_branch M_c0_0_layer
M_c0_0_lr:
    s_mov_b32 s30, 0
M_c0_0_lr_l:
    s_waitcnt lgkmcnt(0)
    ds_read_b128 v[36:39], v6 offset:13312
    ds_read_b128 v[40:43], v6 offset:14336
    ds_read_b128 v[44:47], v6 offset:15360
    ds_read_b128 v[48:51], v6 offset:16384
    ds_read_b128 v[52:55], v6 offset:17408
    s_waitcnt lgkmcnt(2)
    v_max3_u32 v10, v36, v40, v44
    s_waitcnt lgkmcnt(0)
    v_max3_u32 v10, v10, v48, v52
    v_cmp_eq_u32 vcc, -1, v10
    s_cbranch_vccz M_c0_0_lr_d
    s_add_u32 s30, s30, 1
    s_cmp_ge_u32 s30, 480000
    s_cbranch_scc1 M_fail
    s_branch M_c0_0_lr_l
M_c0_0_lr_d:
    ds_read_b128 v[56:59], v5 offset:0
    ds_read_b128 v[60:63], v5 offset:1024
    ds_read_b128 v[64:67], v5 offset:2048
    ds_read_b128 v[68:71], v5 offset:3072
    v_mov_b64 v[12:13], 0
    v_mov_b64 v[14:15], 0
    v_mov_b64 v[16:17], 0
    v_mov_b64 v[18:19], 0
    v_mov_b64 v[20:21], 0
    v_mov_b64 v[22:23], 0
    v_mov_b64 v[24:25], 0
    v_mov_b64 v[26:27], 0
    v_mov_b64 v[28:29], 0
    v_mov_b64 v[30:31], 0
    v_mov_b64 v[32:33], 0
    v_mov_b64 v[34:35], 0
    s_waitcnt lgkmcnt(0)
    s_branch M_c0_0_lr_r
M_c0_0_rr:
    s_mov_b32 s30, 0
M_c0_0_rr_l:
    s_waitcnt lgkmcnt(0)
    s_and_b32 s27, s30, 1
    s_cbranch_scc1 M_c0_0_rr_n
    s_waitcnt vmcnt(2)
    s_mov_b32 m0, 8192
    s_nop 0
    buffer_load_dwordx4 v0, s[8:11], s49 offen offset:0 sc1 lds
    buffer_load_dwordx4 v0, s[8:11], s49 offen offset:1024 sc1 lds
M_c0_0_rr_n:
    ds_read_b128 v[36:39], v6 offset:8192
    ds_read_b128 v[40:43], v6 offset:9216
    ds_read_b128 v[44:47], v6 offset:10240
    ds_read_b128 v[48:51], v6 offset:11264
    ds_read_b32 v11, v6 offset:12288
    s_waitcnt lgkmcnt(2)
    v_max3_u32 v10, v36, v40, v44
    s_waitcnt lgkmcnt(0)
    v_max3_u32 v10, v10, v48, v11
    v_cmp_eq_u32 vcc, -1, v10
    s_cbranch_vccz M_c0_0_rr_d
    s_add_u32 s30, s30, 1
    s_cmp_ge_u32 s30, 480000
    s_cbranch_scc1 M_fail
    s_branch M_c0_0_rr_l
M_c0_0_rr_d:
    s_branch M_c0_0_rr_r
M_c0_0_first:
    s_barrier
    s_and_b32 s26, s44, 63
    s_lshl_b32 s26, s26, 18
    s_add_u32 s26, s26, s50
    s_add_u32 s3, s26, 16777216
    s_mov_b32 m0, 0
    s_nop 0
    buffer_load_dwordx4 v0, s[8:11], s26 offen offset:0 sc1 lds
    buffer_load_dwordx4 v0, s[8:11], s26 offen offset:1024 sc1 lds
    buffer_load_dwordx4 v[80:83], v0, s[8:11], s3 offen offset:0 sc1
    buffer_load_dwordx4 v[84:87], v0, s[8:11], s3 offen offset:1024 sc1
    s_and_b32 s26, s44, 63
    s_add_u32 s26, s26, 1
    s_min_u32 s26, s26, 63
    s_lshl_b32 s26, s26, 18
    s_add_u32 s26, s26, s50
    s_add_u32 s3, s26, 16777216
    s_waitcnt vmcnt(0) lgkmcnt(0)
    s_barrier
    s_branch M_c0_0_first_r
M_c0_0_first2:
    s_barrier
    s_branch M_c0_0_first2_r
M_c0_0_wq1:
    buffer_load_dwordx4 v[12:15], v8, s[8:11], s43 offen sc1
    buffer_load_dwordx4 v[16:19], v8, s[8:11], s61 offen sc1
    buffer_load_dwordx4 v[20:23], v8, s[8:11], s100 offen sc1
    buffer_load_dwordx4 v[24:27], v8, s[8:11], s101 offen sc1
    s_waitcnt vmcnt(7)
    v_mfma_f32_16x16x32_bf16 v[28:31], v[72:75], v[40:43], 0
    s_waitcnt vmcnt(6)
    v_mfma_f32_16x16x32_bf16 v[28:31], v[72:75], v[44:47], v[28:31]
    s_waitcnt vmcnt(5)
    v_mfma_f32_16x16x32_bf16 v[28:31], v[72:75], v[48:51], v[28:31]
    s_waitcnt vmcnt(4)
    v_mfma_f32_16x16x32_bf16 v[28:31], v[72:75], v[52:55], v[28:31]
    v_max3_u32 v32, v40, v44, v48
    v_max_u32 v32, v32, v52
    v_cmp_eq_u32 vcc, -1, v32
    s_cbranch_vccnz M_c0_0_wqx
    v_mov_b32 v5, v5
    v_mov_b32 v5, v5
    v_mov_b32 v5, v5
    v_mov_b32 v5, v5
    v_add_f32_dpp v28, v28, v28 row_ror:8 row_mask:0xf bank_mask:0xf
    v_add_f32_dpp v29, v29, v29 row_ror:8 row_mask:0xf bank_mask:0xf
    v_add_f32_dpp v30, v30, v30 row_ror:8 row_mask:0xf bank_mask:0xf
    v_add_f32_dpp v31, v31, v31 row_ror:8 row_mask:0xf bank_mask:0xf
    v_cmp_u_f32 vcc, v28, v28
    v_cvt_pk_bf16_f32 v28, v28, v29
    v_cvt_pk_bf16_f32 v29, v30, v31
    s_cbranch_vccnz M_c0_0_wqe1
    s_mov_b64 exec, s[38:39]
    buffer_store_dwordx2 v[28:29], v11, s[8:11], s58 offen
    s_barrier
    buffer_store_dwordx2 v[28:29], v11, s[8:11], s56 offen sc1
    s_branch M_c0_0_wrb_g
M_c0_0_wqx:
    s_branch M_c0_0_wrb_i1
M_c0_0_wqe1:
    s_waitcnt vmcnt(0)
    buffer_load_dwordx4 v[12:15], v8, s[8:11], s43 offen sc1
    buffer_load_dwordx4 v[16:19], v8, s[8:11], s61 offen sc1
    buffer_load_dwordx4 v[20:23], v8, s[8:11], s100 offen sc1
    buffer_load_dwordx4 v[24:27], v8, s[8:11], s101 offen sc1
    s_branch M_c0_0_wrb_e1
M_c0_0_wrb_l:
    s_waitcnt vmcnt(4)
    v_mfma_f32_16x16x32_bf16 v[28:31], v[72:75], v[12:15], 0
    v_mfma_f32_16x16x32_bf16 v[28:31], v[72:75], v[16:19], v[28:31]
    v_mfma_f32_16x16x32_bf16 v[28:31], v[72:75], v[20:23], v[28:31]
    v_mfma_f32_16x16x32_bf16 v[28:31], v[72:75], v[24:27], v[28:31]
    v_max3_u32 v32, v12, v16, v20
    v_max_u32 v32, v32, v24
    v_cmp_eq_u32 vcc, -1, v32
    s_cbranch_vccz M_c0_0_wrb_x0
M_c0_0_wrb_i0:
    buffer_load_dwordx4 v[12:15], v8, s[8:11], s43 offen sc1
    buffer_load_dwordx4 v[16:19], v8, s[8:11], s61 offen sc1
    buffer_load_dwordx4 v[20:23], v8, s[8:11], s100 offen sc1
    buffer_load_dwordx4 v[24:27], v8, s[8:11], s101 offen sc1
    s_waitcnt vmcnt(4)
    v_mfma_f32_16x16x32_bf16 v[28:31], v[72:75], v[40:43], 0
    v_mfma_f32_16x16x32_bf16 v[28:31], v[72:75], v[44:47], v[28:31]
    v_mfma_f32_16x16x32_bf16 v[28:31], v[72:75], v[48:51], v[28:31]
    v_mfma_f32_16x16x32_bf16 v[28:31], v[72:75], v[52:55], v[28:31]
    v_max3_u32 v32, v40, v44, v48
    v_max_u32 v32, v32, v52
    v_cmp_eq_u32 vcc, -1, v32
    s_cbranch_vccz M_c0_0_wrb_x1
M_c0_0_wrb_i1:
    buffer_load_dwordx4 v[40:43], v8, s[8:11], s43 offen sc1
    buffer_load_dwordx4 v[44:47], v8, s[8:11], s61 offen sc1
    buffer_load_dwordx4 v[48:51], v8, s[8:11], s100 offen sc1
    buffer_load_dwordx4 v[52:55], v8, s[8:11], s101 offen sc1
    s_add_u32 s71, s71, 1
    s_cmp_lt_u32 s71, 240000
    s_cbranch_scc1 M_c0_0_wrb_l
    s_branch M_fail
M_c0_0_wrb_x0:
    s_nop 3
    v_add_f32_dpp v28, v28, v28 row_ror:8 row_mask:0xf bank_mask:0xf
    v_add_f32_dpp v29, v29, v29 row_ror:8 row_mask:0xf bank_mask:0xf
    v_add_f32_dpp v30, v30, v30 row_ror:8 row_mask:0xf bank_mask:0xf
    v_add_f32_dpp v31, v31, v31 row_ror:8 row_mask:0xf bank_mask:0xf
    v_cmp_u_f32 vcc, v28, v28
    v_cvt_pk_bf16_f32 v28, v28, v29
    v_cvt_pk_bf16_f32 v29, v30, v31
    s_cbranch_vccz M_c0_0_wrb_n
M_c0_0_wrb_e0:
    v_max3_u32 v32, v12, v13, v14
    v_max3_u32 v32, v32, v15, v16
    v_max3_u32 v32, v32, v17, v18
    v_max3_u32 v32, v32, v19, v20
    v_max3_u32 v32, v32, v21, v22
    v_max3_u32 v32, v32, v23, v24
    v_max3_u32 v32, v32, v25, v26
    v_max_u32 v32, v32, v27
    v_cmp_eq_u32 vcc, -1, v32
    s_cbranch_vccnz M_c0_0_wrb_i0
    v_min_u32 v28, -2, v28
    v_min_u32 v29, -2, v29
    s_branch M_c0_0_wrb_n
M_c0_0_wrb_x1:
    s_nop 3
    v_add_f32_dpp v28, v28, v28 row_ror:8 row_mask:0xf bank_mask:0xf
    v_add_f32_dpp v29, v29, v29 row_ror:8 row_mask:0xf bank_mask:0xf
    v_add_f32_dpp v30, v30, v30 row_ror:8 row_mask:0xf bank_mask:0xf
    v_add_f32_dpp v31, v31, v31 row_ror:8 row_mask:0xf bank_mask:0xf
    v_cmp_u_f32 vcc, v28, v28
    v_cvt_pk_bf16_f32 v28, v28, v29
    v_cvt_pk_bf16_f32 v29, v30, v31
    s_cbranch_vccz M_c0_0_wrb_n
M_c0_0_wrb_e1:
    v_max3_u32 v32, v40, v41, v42
    v_max3_u32 v32, v32, v43, v44
    v_max3_u32 v32, v32, v45, v46
    v_max3_u32 v32, v32, v47, v48
    v_max3_u32 v32, v32, v49, v50
    v_max3_u32 v32, v32, v51, v52
    v_max3_u32 v32, v32, v53, v54
    v_max_u32 v32, v32, v55
    v_cmp_eq_u32 vcc, -1, v32
    s_cbranch_vccnz M_c0_0_wrb_i1
    v_min_u32 v28, -2, v28
    v_min_u32 v29, -2, v29
M_c0_0_wrb_n:
    s_mov_b64 exec, s[38:39]
    buffer_store_dwordx2 v[28:29], v11, s[8:11], s58 offen
    s_branch M_c0_0_wrb_d
M_c0_1_layer:
    s_lshr_b32 s27, s44, 6
    s_mul_i32 s50, s27, 33554432
    s_lshl_b32 s27, s22, 13
    s_add_u32 s50, s50, s27
    s_add_u32 s50, s50, 37748736
    s_barrier
    s_mov_b32 s26, 0x10010000
    s_mov_b32 s3, s26
    s_mul_i32 s27, s20, 5120
    s_add_u32 s48, s27, 167772160
    s_sub_u32 s49, 167777280, s27
    s_and_b32 s55, s44, 3
    s_mul_i32 s55, s55, 167936
    s_add_u32 s55, s55, s34
    s_add_u32 s58, s55, s35
    s_and_b32 s57, s44, 63
    s_add_u32 s43, s55, s32
    s_sub_u32 s27, s57, 1
    s_max_i32 s27, s27, 0
    s_lshl_b64 s[100:101], 1, s27
    s_lshl_b32 s27, s27, 7
    s_sub_u32 s61, s52, s27
    ds_read_b128 v[56:59], v5 offset:0
    ds_read_b128 v[60:63], v5 offset:1024
    ds_read_b128 v[64:67], v5 offset:2048
    ds_read_b128 v[68:71], v5 offset:3072
    v_mov_b64 v[12:13], 0
    v_mov_b64 v[14:15], 0
    v_mov_b64 v[16:17], 0
    v_mov_b64 v[18:19], 0
    v_mov_b64 v[20:21], 0
    v_mov_b64 v[22:23], 0
    v_mov_b64 v[24:25], 0
    v_mov_b64 v[26:27], 0
    v_mov_b64 v[28:29], 0
    v_mov_b64 v[30:31], 0
    v_mov_b64 v[32:33], 0
    v_mov_b64 v[34:35], 0
    s_mov_b32 s70, 0
    s_waitcnt lgkmcnt(0)
M_c0_1_top:
    s_nop 0
    s_barrier
    ds_read_b128 v[36:39], v6 offset:13312
    ds_read_b128 v[40:43], v6 offset:14336
    s_mov_b32 m0, 8192
    s_nop 0
    buffer_load_dwordx4 v0, s[8:11], s49 offen offset:2048 sc1 lds
M_c0_1_lr_r:
    s_waitcnt lgkmcnt(1)
    v_smfmac_f32_16x16x64_bf16 v[20:23], v[36:39], v[56:63], v1
    ds_read_b128 v[56:59], v5 offset:4096
    v_smfmac_f32_16x16x64_bf16 v[24:27], v[36:39], v[64:71], v1
    ds_read_b128 v[60:63], v5 offset:5120
    v_smfmac_f32_16x16x64_bf16 v[28:31], v[36:39], a[248:255], v1
    ds_read_b128 v[64:67], v5 offset:6144
    v_smfmac_f32_16x16x64_bf16 v[32:35], v[36:39], a[240:247], v1
    ds_read_b128 v[68:71], v5 offset:7168
    v_smfmac_f32_16x16x64_bf16 v[12:15], v[36:39], a[232:239], v1
    ds_read_b128 v[44:47], v6 offset:15360
    s_waitcnt lgkmcnt(3)
    v_smfmac_f32_16x16x64_bf16 v[16:19], v[36:39], v[56:63], v1
    ds_read_b128 v[56:59], v5 offset:8192
    v_smfmac_f32_16x16x64_bf16 v[20:23], v[40:43], a[224:231], v1
    ds_read_b128 v[60:63], v5 offset:9216
    v_smfmac_f32_16x16x64_bf16 v[24:27], v[40:43], a[216:223], v1
    ds_read_b128 v[48:51], v6 offset:16384
    s_waitcnt lgkmcnt(4)
    v_smfmac_f32_16x16x64_bf16 v[28:31], v[40:43], v[64:71], v1
    ds_read_b128 v[64:67], v5 offset:10240
    v_smfmac_f32_16x16x64_bf16 v[32:35], v[40:43], a[208:215], v1
    ds_read_b128 v[68:71], v5 offset:11264
    v_smfmac_f32_16x16x64_bf16 v[12:15], v[40:43], a[200:207], v1
    ds_read_b128 v[52:55], v6 offset:17408
    s_waitcnt lgkmcnt(6)
    s_waitcnt lgkmcnt(4)
    v_max3_u32 v10, v36, v40, v44
    v_smfmac_f32_16x16x64_bf16 v[16:19], v[40:43], v[56:63], v1
    ds_read_b128 v[56:59], v5 offset:12288
    s_waitcnt lgkmcnt(1)
    v_max3_u32 v10, v10, v48, v52
    v_smfmac_f32_16x16x64_bf16 v[20:23], v[44:47], a[192:199], v1
    ds_read_b128 v[60:63], v5 offset:13312
    v_cmp_eq_u32 vcc, -1, v10
    v_smfmac_f32_16x16x64_bf16 v[24:27], v[44:47], a[184:191], v1
    s_cbranch_vccnz M_c0_1_lr
    v_smfmac_f32_16x16x64_bf16 v[28:31], v[44:47], v[64:71], v1
    ds_read_b128 v[64:67], v5 offset:14336
    v_smfmac_f32_16x16x64_bf16 v[32:35], v[44:47], a[176:183], v1
    ds_read_b128 v[68:71], v5 offset:15360
    v_smfmac_f32_16x16x64_bf16 v[20:23], v[48:51], a[168:175], v1
    s_waitcnt lgkmcnt(2)
    v_smfmac_f32_16x16x64_bf16 v[24:27], v[48:51], v[56:63], v1
    ds_read_b128 v[56:59], v5 offset:16384
    v_smfmac_f32_16x16x64_bf16 v[28:31], v[48:51], a[160:167], v1
    ds_read_b128 v[60:63], v5 offset:17408
    v_smfmac_f32_16x16x64_bf16 v[32:35], v[48:51], a[152:159], v1
    s_waitcnt vmcnt(0)
    s_barrier
    ds_read_b128 v[36:39], v6 offset:8192
    ds_read_b128 v[40:43], v6 offset:9216
    s_waitcnt lgkmcnt(4)
    v_smfmac_f32_16x16x64_bf16 v[20:23], v[52:55], v[64:71], v1
    ds_read_b128 v[44:47], v6 offset:10240
    ds_read_b128 v[48:51], v6 offset:11264
    v_smfmac_f32_16x16x64_bf16 v[24:27], v[52:55], a[144:151], v1
    ds_read_b32 v11, v6 offset:12288
    ds_read_b128 v[64:67], v5 offset:18432
    v_smfmac_f32_16x16x64_bf16 v[28:31], v[52:55], a[136:143], v1
    ds_read_b128 v[68:71], v5 offset:19456
    s_waitcnt lgkmcnt(4)
    v_max3_u32 v10, v36, v40, v44
    v_smfmac_f32_16x16x64_bf16 v[32:35], v[52:55], v[56:63], v1
    s_waitcnt lgkmcnt(2)
    v_max3_u32 v10, v10, v48, v11
    v_cmp_eq_u32 vcc, -1, v10
    s_cbranch_vccnz M_c0_1_rr
M_c0_1_rr_r:
    s_mov_b32 m0, 23296
    ds_read_b128 v[52:55], v6 offset:12288
    buffer_store_dwordx4 v[76:79], v0, s[8:11], s4 offen offset:1024 sc1
    s_mov_b32 s4, 0x10000000
    s_mov_b64 exec, 3
    buffer_load_dword v9, s[8:11], s51 offen sc1 lds
    s_mov_b64 exec, s[100:101]
    buffer_store_dword v9, v9, s[8:11], s61 offen sc1
    s_mov_b64 exec, -1
    v_smfmac_f32_16x16x64_bf16 v[20:23], v[36:39], a[128:135], v1
    ds_read_b128 v[56:59], v5 offset:20480
    v_smfmac_f32_16x16x64_bf16 v[24:27], v[36:39], a[120:127], v1
    ds_read_b128 v[60:63], v5 offset:21504
    s_waitcnt lgkmcnt(3)
    v_smfmac_f32_16x16x64_bf16 v[20:23], v[40:43], v[64:71], v1
    ds_read_b128 v[64:67], v5 offset:22528
    v_smfmac_f32_16x16x64_bf16 v[24:27], v[40:43], a[112:119], v1
    ds_read_b128 v[68:71], v5 offset:23552
    v_smfmac_f32_16x16x64_bf16 v[20:23], v[44:47], a[104:111], v1
    s_waitcnt lgkmcnt(2)
    v_smfmac_f32_16x16x64_bf16 v[24:27], v[44:47], v[56:63], v1
    ds_read_b128 v[56:59], v5 offset:24576
    v_smfmac_f32_16x16x64_bf16 v[20:23], v[48:51], a[96:103], v1
    ds_read_b128 v[60:63], v5 offset:25600
    v_smfmac_f32_16x16x64_bf16 v[24:27], v[48:51], a[88:95], v1
    s_waitcnt lgkmcnt(2)
    v_smfmac_f32_16x16x64_bf16 v[20:23], v[52:55], v[64:71], v1
    ds_read_b128 v[64:67], v5 offset:26624
    v_smfmac_f32_16x16x64_bf16 v[24:27], v[52:55], a[80:87], v1
    ds_read_b128 v[68:71], v5 offset:27648
    v_smfmac_f32_16x16x64_bf16 v[28:31], v[36:39], a[72:79], v1
    s_waitcnt lgkmcnt(2)
    v_smfmac_f32_16x16x64_bf16 v[32:35], v[36:39], v[56:63], v1
    ds_read_b128 v[56:59], v5 offset:28672
    s_nop 0
    v_permlane32_swap_b32 v20, v21
    v_smfmac_f32_16x16x64_bf16 v[28:31], v[40:43], a[64:71], v1
    ds_read_b128 v[60:63], v5 offset:29696
    v_permlane32_swap_b32 v22, v23
    v_smfmac_f32_16x16x64_bf16 v[32:35], v[40:43], a[56:63], v1
    s_waitcnt lgkmcnt(2)
    v_permlane32_swap_b32 v24, v25
    v_smfmac_f32_16x16x64_bf16 v[28:31], v[44:47], v[64:71], v1
    ds_read_b128 v[64:67], v5 offset:30720
    v_permlane32_swap_b32 v26, v27
    v_smfmac_f32_16x16x64_bf16 v[32:35], v[44:47], a[48:55], v1
    ds_read_b128 v[68:71], v5 offset:31744
    v_add_f32 v20, v20, v21
    v_add_f32 v22, v22, v23
    v_smfmac_f32_16x16x64_bf16 v[28:31], v[48:51], a[40:47], v1
    s_waitcnt lgkmcnt(2)
    v_add_f32 v24, v24, v25
    v_add_f32 v26, v26, v27
    v_smfmac_f32_16x16x64_bf16 v[32:35], v[48:51], v[56:63], v1
    ds_read_b128 v[56:59], v5 offset:32768
    v_mul_f32 v20, s40, v20
    v_mul_f32 v24, s40, v24
    v_smfmac_f32_16x16x64_bf16 v[28:31], v[52:55], a[32:39], v1
    ds_read_b128 v[60:63], v5 offset:33792
    v_mul_f32 v22, s40, v22
    v_mul_f32 v26, s40, v26
    v_smfmac_f32_16x16x64_bf16 v[32:35], v[52:55], a[24:31], v1
    s_waitcnt lgkmcnt(2)
    v_cvt_pk_bf16_f32 v20, v20, v24
    v_cvt_pk_bf16_f32 v21, v22, v26
    v_smfmac_f32_16x16x64_bf16 v[12:15], v[36:39], v[64:71], v1
    s_cmp_eq_u32 s57, 0
    s_cbranch_scc1 M_c0_1_first
M_c0_1_first_r:
    ds_write_b32 v2, v20 offset:18432
    v_smfmac_f32_16x16x64_bf16 v[16:19], v[36:39], a[16:23], v1
    ds_write_b32 v2, v21 offset:19008
    v_permlane32_swap_b32 v28, v29
    v_smfmac_f32_16x16x64_bf16 v[12:15], v[40:43], a[8:15], v1
    ds_read_b128 v[36:39], v6 offset:15360
    s_waitcnt lgkmcnt(3)
    v_permlane32_swap_b32 v30, v31
    v_smfmac_f32_16x16x64_bf16 v[16:19], v[40:43], v[56:63], v1
    ds_read_b128 v[64:67], v0 offset:2048
    v_permlane32_swap_b32 v32, v33
    v_smfmac_f32_16x16x64_bf16 v[12:15], v[44:47], a[0:7], v1
    ds_read_b128 v[68:71], v0 offset:3072
    v_permlane32_swap_b32 v34, v35
    v_smfmac_f32_16x16x64_bf16 v[16:19], v[44:47], v[248:255], v1
    s_waitcnt lgkmcnt(3)
    s_barrier
    ds_read_b128 v[40:43], v6 offset:16384
    v_add_f32 v28, v28, v29
    v_add_f32 v30, v30, v31
    v_smfmac_f32_16x16x64_bf16 v[12:15], v[48:51], v[240:247], v1
    ds_read_b128 v[56:59], v0 offset:0
    v_add_f32 v32, v32, v33
    v_add_f32 v34, v34, v35
    v_smfmac_f32_16x16x64_bf16 v[16:19], v[48:51], v[232:239], v1
    ds_read_b128 v[60:63], v0 offset:1024
    v_cvt_pk_bf16_f32 v28, v28, v32
    v_cvt_pk_bf16_f32 v29, v30, v34
    v_smfmac_f32_16x16x64_bf16 v[12:15], v[52:55], v[224:231], v1
    ds_write_b32 v2, v28 offset:20736
    ds_read_b128 v[20:23], v3 offset:18432
    v_smfmac_f32_16x16x64_bf16 v[16:19], v[52:55], v[216:223], v1
    ds_write_b32 v2, v29 offset:21312
    ds_read_b128 v[24:27], v3 offset:18496
    s_waitcnt lgkmcnt(9)
    v_smfmac_f32_16x16x64_bf16 v[12:15], v[36:39], v[208:215], v1
    ds_read_b128 v[72:75], v3 offset:18560
    ds_read_b128 v[44:47], v3 offset:18624
    v_smfmac_f32_16x16x64_bf16 v[16:19], v[36:39], v[200:207], v1
    ds_read_b128 v[48:51], v6 offset:17408
    s_waitcnt lgkmcnt(9)
    v_smfmac_f32_16x16x64_bf16 v[12:15], v[40:43], v[192:199], v1
    v_smfmac_f32_16x16x64_bf16 v[16:19], v[40:43], v[184:191], v1
    s_waitcnt lgkmcnt(5)
    v_mfma_f32_16x16x32_bf16 v[28:31], v[56:59], v[20:23], 0
    ds_read_b128 v[56:59], v0 offset:4096
    s_waitcnt lgkmcnt(4)
    v_mov_b64 v[52:53], s[24:25]
    v_mfma_f32_16x16x32_bf16 v[28:31], v[60:63], v[24:27], v[28:31]
    ds_read_b128 v[60:63], v0 offset:5120
    s_barrier
    s_waitcnt lgkmcnt(4)
    v_mfma_f32_16x16x32_bf16 v[28:31], v[64:67], v[72:75], v[28:31]
    ds_read_b128 v[64:67], v0 offset:6144
    s_waitcnt lgkmcnt(4)
    v_mov_b64 v[54:55], s[24:25]
    v_mfma_f32_16x16x32_bf16 v[28:31], v[68:71], v[44:47], v[28:31]
    ds_read_b128 v[68:71], v0 offset:7168
    s_waitcnt lgkmcnt(4)
    v_mov_b64 v[10:11], s[16:17]
    v_smfmac_f32_16x16x64_bf16 v[12:15], v[48:51], v[176:183], v1
    ds_read_b128 v[36:39], v3 offset:20736
    v_smfmac_f32_16x16x64_bf16 v[16:19], v[48:51], v[168:175], v1
    ds_read_b128 v[40:43], v3 offset:20800
    s_waitcnt lgkmcnt(4)
    v_mfma_f32_16x16x32_bf16 v[32:35], v[56:59], v[20:23], 0
    v_exp_f32 v28, v28
    v_mfma_f32_16x16x32_bf16 v[32:35], v[60:63], v[24:27], v[32:35]
    s_waitcnt lgkmcnt(2)
    v_exp_f32 v29, v29
    ds_read_b128 v[56:59], v3 offset:20864
    v_mfma_f32_16x16x32_bf16 v[32:35], v[64:67], v[72:75], v[32:35]
    v_exp_f32 v30, v30
    ds_read_b128 v[60:63], v3 offset:20928
    v_mfma_f32_16x16x32_bf16 v[32:35], v[68:71], v[44:47], v[32:35]
    s_waitcnt lgkmcnt(3)
    v_exp_f32 v31, v31
    v_mfma_f32_16x16x32_bf16 v[48:51], v[36:39], v[20:23], 0
    s_waitcnt lgkmcnt(2)
    v_cvt_pk_bf16_f32 v28, v28, v29
    v_cvt_pk_bf16_f32 v29, v30, v31
    v_mfma_f32_16x16x32_bf16 v[48:51], v[40:43], v[24:27], v[48:51]
    s_waitcnt lgkmcnt(1)
    v_cvt_pk_bf16_f32 v12, v12, v13
    v_cvt_pk_bf16_f32 v13, v14, v15
    v_mfma_f32_16x16x32_bf16 v[48:51], v[56:59], v[72:75], v[48:51]
    s_waitcnt lgkmcnt(0)
    v_exp_f32 v32, v32
    v_mfma_f32_16x16x32_bf16 v[48:51], v[60:63], v[44:47], v[48:51]
    v_exp_f32 v33, v33
    v_exp_f32 v34, v34
    v_exp_f32 v35, v35
    v_cvt_pk_bf16_f32 v30, v32, v33
    v_cvt_pk_bf16_f32 v31, v34, v35
    v_cvt_pk_bf16_f32 v14, v16, v17
    v_cvt_pk_bf16_f32 v15, v18, v19
    v_mfma_f32_16x16x32_bf16 v[72:75], v[52:55], v[28:31], 0
    v_exp_f32 v48, v48
    v_mfma_f32_16x16x32_bf16 v[20:23], v[80:83], v[28:31], 0
    v_exp_f32 v49, v49
    v_mfma_f32_16x16x32_bf16 v[24:27], v[84:87], v[28:31], 0
    v_exp_f32 v50, v50
    v_exp_f32 v51, v51
    v_cvt_pk_bf16_f32 v48, v48, v49
    v_cvt_pk_bf16_f32 v49, v50, v51
    v_cndmask_b32_e64 v76, v12, v40, s[66:67]
    v_cndmask_b32_e64 v77, v13, v41, s[66:67]
M_c0_1_fin:
    v_mfma_f32_16x16x16_bf16 v[72:75], v[10:11], v[48:49], v[72:75]
    v_cndmask_b32_e64 v78, v14, v42, s[66:67]
    v_cndmask_b32_e64 v79, v15, v43, s[66:67]
    v_mfma_f32_16x16x16_bf16 v[20:23], v[12:13], v[48:49], v[20:23]
    s_cmp_eq_u32 s57, 63
    v_mov_b64 v[44:45], 0
    v_mov_b64 v[46:47], 0
    v_mfma_f32_16x16x16_bf16 v[24:27], v[14:15], v[48:49], v[24:27]
    s_cbranch_scc1 M_c0_1_last
    v_mov_b64 v[68:69], 0
    v_rcp_f32 v74, v72
    v_subrev_u32 v73, s68, v72
    v_cmp_lt_u32 vcc, s69, v73
    v_mov_b64 v[70:71], 0
    v_mov_b32 v5, v5
    v_mov_b32 v5, v5
    v_cndmask_b32_e64 v20, v20, v24, s[18:19]
    v_cndmask_b32_e64 v21, v21, v25, s[18:19]
    v_cndmask_b32_e64 v22, v22, v26, s[18:19]
    v_cndmask_b32_e64 v23, v23, v27, s[18:19]
    v_pk_mul_f32 v[20:21], v[20:21], v[74:75] op_sel_hi:[1,0]
    v_pk_mul_f32 v[22:23], v[22:23], v[74:75] op_sel_hi:[1,0]
    v_cvt_pk_bf16_f32 v20, v20, v21
    v_cvt_pk_bf16_f32 v21, v22, v23
    ds_write_b64 v0, v[20:21] offset:13320
    s_cbranch_vccnz M_c0_1_zbad
M_c0_1_zok:
    s_cmp_eq_u32 s57, 0
    s_cbranch_scc1 M_c0_1_first2
M_c0_1_first2_r:
    buffer_load_dwordx4 v[80:83], v0, s[8:11], s3 offen offset:0 sc1
    buffer_load_dwordx4 v[84:87], v0, s[8:11], s3 offen offset:1024 sc1
    s_waitcnt lgkmcnt(0)
    s_barrier
    ds_read_b128 v[32:35], v0 offset:13312
    ds_read_b128 v[40:43], v0 offset:14336
    s_mov_b32 m0, 2048
    s_nop 0
    buffer_load_dwordx4 v0, s[8:11], s26 offen offset:0 sc1 lds
    buffer_load_dwordx4 v0, s[8:11], s26 offen offset:1024 sc1 lds
    v_mov_b64 v[64:65], 0
    v_mov_b64 v[66:67], 0
    v_mov_b64 v[60:61], 0
    v_mov_b64 v[62:63], 0
    v_mov_b64 v[56:57], 0
    v_mov_b64 v[58:59], 0
    s_waitcnt lgkmcnt(1)
    s_nop 0
    v_smfmac_f32_16x16x64_bf16 v[56:59], v[32:35], v[160:167], v1
    v_smfmac_f32_16x16x64_bf16 v[60:63], v[32:35], v[144:151], v1
    s_waitcnt lgkmcnt(0)
    v_smfmac_f32_16x16x64_bf16 v[56:59], v[40:43], v[152:159], v1
    v_smfmac_f32_16x16x64_bf16 v[60:63], v[40:43], v[136:143], v1
    v_smfmac_f32_16x16x64_bf16 v[64:67], v[32:35], v[128:135], v1
    v_smfmac_f32_16x16x64_bf16 v[68:71], v[32:35], v[112:119], v1
    v_permlane32_swap_b32 v56, v57
    v_smfmac_f32_16x16x64_bf16 v[64:67], v[40:43], v[120:127], v1
    v_permlane32_swap_b32 v58, v59
    v_smfmac_f32_16x16x64_bf16 v[68:71], v[40:43], v[104:111], v1
    v_add_f32 v56, v56, v57
    v_add_f32 v58, v58, v59
    v_smfmac_f32_16x16x64_bf16 v[44:47], v[32:35], v[96:103], v1
    v_permlane32_swap_b32 v60, v61
    v_smfmac_f32_16x16x64_bf16 v[44:47], v[40:43], v[88:95], v1
    v_permlane32_swap_b32 v62, v63
    v_add_f32 v60, v60, v61
    v_add_f32 v62, v62, v63
    v_cvt_pk_bf16_f32 v36, v56, v60
    v_cvt_pk_bf16_f32 v38, v58, v62
    v_permlane32_swap_b32 v64, v65
    v_permlane32_swap_b32 v66, v67
    v_add_f32 v64, v64, v65
    v_add_f32 v66, v66, v67
    v_permlane32_swap_b32 v68, v69
    v_permlane32_swap_b32 v70, v71
    v_add_f32 v68, v68, v69
    v_add_f32 v70, v70, v71
    v_cvt_pk_bf16_f32 v37, v64, v68
    v_cvt_pk_bf16_f32 v39, v66, v70
    buffer_store_dwordx4 v[36:39], v0, s[8:11], s58 offen
    v_permlane32_swap_b32 v44, v45
    v_permlane32_swap_b32 v46, v47
    v_add_f32 v44, v44, v45
    v_add_f32 v46, v46, v47
    v_cvt_pk_bf16_f32 v44, v44, v46
    buffer_store_dword v44, v7, s[8:11], s55 offen
    v_bfe_u32 v34, v0, 4, 1
    v_bfe_u32 v33, v0, 7, 1
    v_lshl_add_u32 v33, v33, 1, v34
    v_bfe_u32 v32, v0, 6, 1
    v_lshlrev_b32 v32, 4, v32
    v_lshlrev_b32_e64 v32, v32, s45
    v_cmp_eq_u32_e64 s[64:65], 0, v33
    v_cmp_eq_u32_e64 vcc, 1, v33
    s_add_u32 s27, s44, 1
    s_and_b32 s27, s27, 3
    v_cndmask_b32_e64 v72, 0, v32, s[64:65]
    v_cndmask_b32_e64 v73, 0, v32, vcc
    v_cmp_eq_u32_e64 s[64:65], 2, v33
    v_cmp_eq_u32_e64 vcc, 3, v33
    s_mul_i32 s48, s27, 5120
    s_add_u32 s48, s48, s41
    v_cndmask_b32_e64 v74, 0, v32, s[64:65]
    v_cndmask_b32_e64 v75, 0, v32, vcc
    s_lshl_b32 s27, s27, 15
    s_add_u32 s49, s27, s47
    v_bfe_u32 v32, v0, 8, 1
    v_lshlrev_b32 v11, 6, v32
    v_lshl_add_u32 v11, v34, 3, v11
    v_lshrrev_b32 v33, 9, v0
    v_lshl_add_u32 v11, v33, 2, v11
    s_add_u32 s56, s27, s46
    s_add_u32 s56, s56, s33
    s_add_u32 s58, s48, s33
    v_mov_b32 v5, v5
    s_nop 1
    v_mov_b32 v5, v5
    s_nop 1
    v_mov_b32 v5, v5
    s_nop 1
    v_mov_b32 v5, v5
    s_nop 1
    v_mov_b32 v5, v5
    s_nop 1
    v_mov_b32 v5, v5
    s_nop 1
    v_mov_b32 v5, v5
    s_nop 1
    v_mov_b32 v5, v5
    s_nop 1
    buffer_load_dwordx4 v[12:15], v0, s[8:11], s43 offen sc1
    v_mov_b32 v5, v5
    s_nop 1
    v_mov_b32 v5, v5
    s_nop 1
    v_mov_b32 v5, v5
    s_nop 1
    v_mov_b32 v5, v5
    s_nop 1
    v_mov_b32 v5, v5
    s_nop 1
    v_mov_b32 v5, v5
    s_nop 1
    v_mov_b32 v5, v5
    s_nop 1
    v_mov_b32 v5, v5
    s_nop 1
    v_mov_b32 v5, v5
    s_nop 1
    v_mov_b32 v5, v5
    s_nop 1
    v_mov_b32 v5, v5
    s_nop 1
    v_mov_b32 v5, v5
    s_nop 1
    v_mov_b32 v5, v5
    v_mov_b32 v5, v5
    buffer_load_dwordx4 v[16:19], v0, s[8:11], s43 offen sc1
    v_mov_b32 v5, v5
    s_nop 1
    v_mov_b32 v5, v5
    s_nop 1
    v_mov_b32 v5, v5
    v_mov_b32 v5, v5
    s_waitcnt vmcnt(1)
    v_mfma_f32_16x16x32_bf16 v[28:31], v[72:75], v[12:15], 0
    v_cmp_eq_u32 vcc, -1, v12
    s_cbranch_vccnz M_c0_1_wq1
    v_mov_b32 v5, v5
    v_mov_b32 v5, v5
    v_mov_b32 v5, v5
    v_mov_b32 v5, v5
    v_mov_b32 v5, v5
    v_mov_b32 v5, v5
    v_add_f32_dpp v28, v28, v28 row_ror:8 row_mask:0xf bank_mask:0xf
    v_add_f32_dpp v29, v29, v29 row_ror:8 row_mask:0xf bank_mask:0xf
    s_nop 0
    v_add_f32_dpp v28, v28, v28 row_ror:4 row_mask:0xf bank_mask:0xf
    v_add_f32_dpp v29, v29, v29 row_ror:4 row_mask:0xf bank_mask:0xf
    s_nop 0
    v_add_f32_dpp v28, v28, v28 row_ror:2 row_mask:0xf bank_mask:0xf
    v_add_f32_dpp v29, v29, v29 row_ror:2 row_mask:0xf bank_mask:0xf
    v_cmp_u_f32 vcc, v28, v28
    v_cvt_pk_bf16_f32 v28, v28, v29
    s_cbranch_vccnz M_c0_1_wrb_e0
    s_mov_b64 exec, s[62:63]
    buffer_store_dword v28, v11, s[8:11], s58 offen
M_c0_1_wrb_d:
    s_barrier
    buffer_store_dword v28, v11, s[8:11], s56 offen sc1
M_c0_1_wrb_g:
    s_mov_b64 exec, -1
    s_waitcnt vmcnt(2)
    ds_read_b128 v[56:59], v5 offset:0
    ds_read_b128 v[60:63], v5 offset:1024
    ds_read_b128 v[64:67], v5 offset:2048
    ds_read_b128 v[68:71], v5 offset:3072
    v_mov_b64 v[12:13], 0
    v_mov_b64 v[14:15], 0
    v_mov_b64 v[16:17], 0
    v_mov_b64 v[18:19], 0
    v_mov_b64 v[20:21], 0
    v_mov_b64 v[22:23], 0
    v_mov_b64 v[24:25], 0
    v_mov_b64 v[26:27], 0
    v_mov_b64 v[28:29], 0
    v_mov_b64 v[30:31], 0
    v_mov_b64 v[32:33], 0
    v_mov_b64 v[34:35], 0
    s_and_b32 s26, s44, 63
    s_add_u32 s26, s26, 2
    s_min_u32 s26, s26, 63
    s_lshl_b32 s26, s26, 18
    s_add_u32 s26, s26, s50
    s_add_u32 s26, s26, 2048
    s_add_u32 s3, s26, 16777216
    s_lshl_b32 s4, s44, 18
    s_add_u32 s4, s4, s53
    v_mov_b64 v[72:73], -1
    v_mov_b64 v[74:75], -1
    s_add_u32 s28, s44, 3
    s_and_b32 s29, s28, 3
    s_mul_i32 s31, s22, 160
    s_mul_i32 s28, s29, 167936
    s_add_u32 s28, s28, s34
    s_add_u32 s64, s28, s35
    s_lshl_b32 s65, s22, 10
    s_add_u32 s65, s65, s28
    s_add_u32 s65, s65, 135168
    ds_read_b64 v[36:37], v0 offset:23296
    s_waitcnt lgkmcnt(0)
    v_min_u32 v36, v36, v37
    s_nop 0
    v_readfirstlane_b32 s28, v36
    s_nop 0
    s_max_u32 s54, s54, s28
    s_add_u32 s27, s44, 3
    s_or_b32 s28, s44, 63
    s_add_u32 s28, s28, 1
    s_min_u32 s27, s27, s28
    s_cmp_lt_u32 s54, s27
    s_cbranch_scc1 M_c0_1_wkw
M_c0_1_wkw_r:
    s_add_u32 s44, s44, 1
    s_and_b32 s55, s44, 3
    s_mul_i32 s55, s55, 167936
    s_add_u32 s55, s55, s34
    s_add_u32 s58, s55, s35
    s_and_b32 s57, s44, 63
    s_add_u32 s43, s55, s32
    s_sub_u32 s27, s57, 1
    s_max_i32 s27, s27, 0
    s_lshl_b64 s[100:101], 1, s27
    s_lshl_b32 s27, s27, 7
    s_sub_u32 s61, s52, s27
    s_nop 15
    s_nop 15
    buffer_store_dwordx4 v[72:75], v0, s[8:11], s64 offen offset:1024
    buffer_store_dwordx4 v[72:75], v0, s[8:11], s64 offen offset:2048
    buffer_store_dwordx4 v[72:75], v0, s[8:11], s65 offen
    s_mov_b32 s65, 0x10000000
    s_mov_b32 s64, 0x10000000
    s_mov_b32 s70, 0
    s_branch M_c0_1_top
M_c0_1_restart:
    s_waitcnt vmcnt(0) lgkmcnt(0)
    s_nop 7
    s_barrier
    ds_read_b128 v[56:59], v5 offset:0
    ds_read_b128 v[60:63], v5 offset:1024
    ds_read_b128 v[64:67], v5 offset:2048
    ds_read_b128 v[68:71], v5 offset:3072
    v_mov_b64 v[12:13], 0
    v_mov_b64 v[14:15], 0
    v_mov_b64 v[16:17], 0
    v_mov_b64 v[18:19], 0
    v_mov_b64 v[20:21], 0
    v_mov_b64 v[22:23], 0
    v_mov_b64 v[24:25], 0
    v_mov_b64 v[26:27], 0
    v_mov_b64 v[28:29], 0
    v_mov_b64 v[30:31], 0
    v_mov_b64 v[32:33], 0
    v_mov_b64 v[34:35], 0
    s_waitcnt vmcnt(0) lgkmcnt(0)
    s_branch M_c0_1_top
M_c0_1_zbad:
    s_cmp_eq_u32 s70, 2
    s_cbranch_scc1 M_c0_1_zok
    v_cmp_u_f32 vcc, v72, v72
    s_cbranch_vccz M_c0_1_exact
    s_cmp_eq_u32 s70, 1
    s_cbranch_scc1 M_c0_1_exact
M_c0_1_vfy0:
    s_mov_b32 s70, 1
    s_mov_b32 s30, 0
    s_waitcnt vmcnt(0) lgkmcnt(0)
    s_nop 7
M_c0_1_vfy:
    v_mov_b32 v10, 0
    s_add_u32 s59, s48, 4096
    buffer_load_dwordx4 v[36:39], v0, s[8:11], s48 offen offset:0 sc1
    buffer_load_dwordx4 v[40:43], v0, s[8:11], s48 offen offset:1024 sc1
    buffer_load_dwordx4 v[44:47], v0, s[8:11], s48 offen offset:2048 sc1
    buffer_load_dwordx4 v[48:51], v0, s[8:11], s48 offen offset:3072 sc1
    buffer_load_dwordx4 v[52:55], v0, s[8:11], s59 offen offset:0 sc1
    s_waitcnt vmcnt(4)
    v_max3_u32 v10, v10, v36, v37
    v_max3_u32 v10, v10, v38, v39
    s_waitcnt vmcnt(3)
    v_max3_u32 v10, v10, v40, v41
    v_max3_u32 v10, v10, v42, v43
    s_waitcnt vmcnt(2)
    v_max3_u32 v10, v10, v44, v45
    v_max3_u32 v10, v10, v46, v47
    s_waitcnt vmcnt(1)
    v_max3_u32 v10, v10, v48, v49
    v_max3_u32 v10, v10, v50, v51
    s_waitcnt vmcnt(0)
    v_max3_u32 v10, v10, v52, v53
    v_max3_u32 v10, v10, v54, v55
    s_add_u32 s59, s49, 4096
    buffer_load_dwordx4 v[36:39], v0, s[8:11], s49 offen offset:0 sc1
    buffer_load_dwordx4 v[40:43], v0, s[8:11], s49 offen offset:1024 sc1
    buffer_load_dwordx4 v[44:47], v0, s[8:11], s49 offen offset:2048 sc1
    buffer_load_dwordx4 v[48:51], v0, s[8:11], s49 offen offset:3072 sc1
    buffer_load_dwordx4 v[52:55], v0, s[8:11], s59 offen offset:0 sc1
    s_waitcnt vmcnt(4)
    v_max3_u32 v10, v10, v36, v37
    v_max3_u32 v10, v10, v38, v39
    s_waitcnt vmcnt(3)
    v_max3_u32 v10, v10, v40, v41
    v_max3_u32 v10, v10, v42, v43
    s_waitcnt vmcnt(2)
    v_max3_u32 v10, v10, v44, v45
    v_max3_u32 v10, v10, v46, v47
    s_waitcnt vmcnt(1)
    v_max3_u32 v10, v10, v48, v49
    v_max3_u32 v10, v10, v50, v51
    s_waitcnt vmcnt(0)
    v_max3_u32 v10, v10, v52, v53
    v_max3_u32 v10, v10, v54, v55
    v_cmp_eq_u32 vcc, -1, v10
    s_cbranch_vccz M_c0_1_restart
    s_add_u32 s30, s30, 1
    s_cmp_ge_u32 s30, 60000
    s_cbranch_scc1 M_fail
    s_branch M_c0_1_vfy
M_c0_1_exact:
    s_nop 7
    s_mov_b32 s70, 2
    s_waitcnt lgkmcnt(0)
    ds_read_b128 v[20:23], v3 offset:18432
    ds_read_b128 v[24:27], v3 offset:18496
    ds_read_b128 v[72:75], v3 offset:18560
    ds_read_b128 v[44:47], v3 offset:18624
    ds_read_b128 v[56:59], v0 offset:0
    s_waitcnt lgkmcnt(0)
    v_mfma_f32_16x16x32_bf16 v[28:31], v[56:59], v[20:23], 0
    s_nop 3
    ds_read_b128 v[60:63], v0 offset:1024
    s_waitcnt lgkmcnt(0)
    v_mfma_f32_16x16x32_bf16 v[28:31], v[60:63], v[24:27], v[28:31]
    s_nop 3
    ds_read_b128 v[56:59], v0 offset:2048
    s_waitcnt lgkmcnt(0)
    v_mfma_f32_16x16x32_bf16 v[28:31], v[56:59], v[72:75], v[28:31]
    s_nop 3
    ds_read_b128 v[60:63], v0 offset:3072
    s_waitcnt lgkmcnt(0)
    v_mfma_f32_16x16x32_bf16 v[28:31], v[60:63], v[44:47], v[28:31]
    s_nop 3
    ds_read_b128 v[56:59], v0 offset:4096
    s_waitcnt lgkmcnt(0)
    v_mfma_f32_16x16x32_bf16 v[32:35], v[56:59], v[20:23], 0
    s_nop 3
    ds_read_b128 v[60:63], v0 offset:5120
    s_waitcnt lgkmcnt(0)
    v_mfma_f32_16x16x32_bf16 v[32:35], v[60:63], v[24:27], v[32:35]
    s_nop 3
    ds_read_b128 v[56:59], v0 offset:6144
    s_waitcnt lgkmcnt(0)
    v_mfma_f32_16x16x32_bf16 v[32:35], v[56:59], v[72:75], v[32:35]
    s_nop 3
    ds_read_b128 v[60:63], v0 offset:7168
    s_waitcnt lgkmcnt(0)
    v_mfma_f32_16x16x32_bf16 v[32:35], v[60:63], v[44:47], v[32:35]
    s_nop 3
    ds_read_b128 v[56:59], v3 offset:20736
    s_waitcnt lgkmcnt(0)
    v_mfma_f32_16x16x32_bf16 v[48:51], v[56:59], v[20:23], 0
    s_nop 3
    ds_read_b128 v[60:63], v3 offset:20800
    s_waitcnt lgkmcnt(0)
    v_mfma_f32_16x16x32_bf16 v[48:51], v[60:63], v[24:27], v[48:51]
    s_nop 3
    ds_read_b128 v[56:59], v3 offset:20864
    s_waitcnt lgkmcnt(0)
    v_mfma_f32_16x16x32_bf16 v[48:51], v[56:59], v[72:75], v[48:51]
    s_nop 3
    ds_read_b128 v[60:63], v3 offset:20928
    s_waitcnt lgkmcnt(0)
    v_mfma_f32_16x16x32_bf16 v[48:51], v[60:63], v[44:47], v[48:51]
    s_nop 3
    v_max3_f32 v64, v28, v29, v30
    v_max3_f32 v64, v64, v31, v32
    v_max3_f32 v64, v64, v33, v34
    s_nop 0
    v_max3_f32 v64, v64, v35, v48
    v_max3_f32 v64, v64, v49, v50
    v_max_f32 v64, v64, v51
    v_mov_b32 v65, v64
    s_nop 1
    v_permlane16_swap_b32 v64, v65
    v_max_f32 v64, v64, v65
    v_mov_b32 v65, v64
    s_nop 1
    v_permlane32_swap_b32 v64, v65
    v_max_f32 v64, v64, v65
    v_sub_f32 v28, v28, v64
    v_exp_f32 v28, v28
    v_sub_f32 v29, v29, v64
    v_exp_f32 v29, v29
    v_sub_f32 v30, v30, v64
    v_exp_f32 v30, v30
    v_sub_f32 v31, v31, v64
    v_exp_f32 v31, v31
    v_sub_f32 v32, v32, v64
    v_exp_f32 v32, v32
    v_sub_f32 v33, v33, v64
    v_exp_f32 v33, v33
    v_sub_f32 v34, v34, v64
    v_exp_f32 v34, v34
    v_sub_f32 v35, v35, v64
    v_exp_f32 v35, v35
    v_sub_f32 v48, v48, v64
    v_exp_f32 v48, v48
    v_sub_f32 v49, v49, v64
    v_exp_f32 v49, v49
    v_sub_f32 v50, v50, v64
    v_exp_f32 v50, v50
    v_sub_f32 v51, v51, v64
    v_exp_f32 v51, v51
    v_cvt_pk_bf16_f32 v28, v28, v29
    v_cvt_pk_bf16_f32 v29, v30, v31
    v_cvt_pk_bf16_f32 v30, v32, v33
    v_cvt_pk_bf16_f32 v31, v34, v35
    v_cvt_pk_bf16_f32 v48, v48, v49
    v_cvt_pk_bf16_f32 v49, v50, v51
    v_mfma_f32_16x16x32_bf16 v[20:23], v[80:83], v[28:31], 0
    v_mfma_f32_16x16x32_bf16 v[24:27], v[84:87], v[28:31], 0
    v_mfma_f32_16x16x32_bf16 v[72:75], v[52:55], v[28:31], 0
    ds_read_b128 v[40:43], v3 offset:20800
    s_waitcnt lgkmcnt(0)
    s_nop 7
    s_branch M_c0_1_fin
M_c0_1_last:
    s_cmp_lg_u32 s70, 0
    s_cbranch_scc1 M_c0_1_last2
    v_cmp_u_f32 vcc, v32, v32
    s_cbranch_vccnz M_c0_1_vfy0
M_c0_1_last2:
    s_lshl_b32 s4, s44, 18
    s_add_u32 s4, s4, s53
    buffer_store_dwordx4 v[76:79], v0, s[8:11], s4 offen offset:1024 sc1
    s_mov_b32 s4, 0x10000000
    s_waitcnt vmcnt(0) lgkmcnt(0)
    s_barrier
    v_mov_b32 v11, 8192
    s_mov_b64 exec, 1
    buffer_store_dword v11, v0, s[8:11], s52 offen sc1
    s_mov_b64 exec, -1
    s_add_u32 s52, s52, 4096
    s_nop 7
    v_mov_b64 v[72:73], -1
    v_mov_b64 v[74:75], -1
    s_add_u32 s28, s44, 3
    s_and_b32 s29, s28, 3
    s_mul_i32 s31, s22, 160
    s_mul_i32 s28, s29, 167936
    s_add_u32 s28, s28, s34
    s_add_u32 s64, s28, s35
    s_lshl_b32 s65, s22, 10
    s_add_u32 s65, s65, s28
    s_add_u32 s65, s65, 135168
    buffer_store_dwordx4 v[72:75], v0, s[8:11], s64 offen offset:1024
    buffer_store_dwordx4 v[72:75], v0, s[8:11], s64 offen offset:2048
    buffer_store_dwordx4 v[72:75], v0, s[8:11], s65 offen
    s_mov_b32 s65, 0x10000000
    s_mov_b32 s64, 0x10000000
    s_waitcnt vmcnt(0)
    s_add_u32 s44, s44, 1
    s_cmp_eq_u32 s44, 128
    s_cbranch_scc1 M_end
    s_branch M_c0_1_layer
M_c0_1_lr:
    s_mov_b32 s30, 0
M_c0_1_lr_l:
    s_waitcnt lgkmcnt(0)
    ds_read_b128 v[36:39], v6 offset:13312
    ds_read_b128 v[40:43], v6 offset:14336
    ds_read_b128 v[44:47], v6 offset:15360
    ds_read_b128 v[48:51], v6 offset:16384
    ds_read_b128 v[52:55], v6 offset:17408
    s_waitcnt lgkmcnt(2)
    v_max3_u32 v10, v36, v40, v44
    s_waitcnt lgkmcnt(0)
    v_max3_u32 v10, v10, v48, v52
    v_cmp_eq_u32 vcc, -1, v10
    s_cbranch_vccz M_c0_1_lr_d
    s_add_u32 s30, s30, 1
    s_cmp_ge_u32 s30, 480000
    s_cbranch_scc1 M_fail
    s_branch M_c0_1_lr_l
M_c0_1_lr_d:
    ds_read_b128 v[56:59], v5 offset:0
    ds_read_b128 v[60:63], v5 offset:1024
    ds_read_b128 v[64:67], v5 offset:2048
    ds_read_b128 v[68:71], v5 offset:3072
    v_mov_b64 v[12:13], 0
    v_mov_b64 v[14:15], 0
    v_mov_b64 v[16:17], 0
    v_mov_b64 v[18:19], 0
    v_mov_b64 v[20:21], 0
    v_mov_b64 v[22:23], 0
    v_mov_b64 v[24:25], 0
    v_mov_b64 v[26:27], 0
    v_mov_b64 v[28:29], 0
    v_mov_b64 v[30:31], 0
    v_mov_b64 v[32:33], 0
    v_mov_b64 v[34:35], 0
    s_waitcnt lgkmcnt(0)
    s_branch M_c0_1_lr_r
M_c0_1_rr:
    s_mov_b32 s30, 0
M_c0_1_rr_l:
    s_waitcnt lgkmcnt(0)
    s_and_b32 s27, s30, 1
    s_cbranch_scc1 M_c0_1_rr_n
    s_waitcnt vmcnt(1)
    s_mov_b32 m0, 8192
    s_nop 0
    buffer_load_dwordx4 v0, s[8:11], s49 offen offset:2048 sc1 lds
M_c0_1_rr_n:
    ds_read_b128 v[36:39], v6 offset:8192
    ds_read_b128 v[40:43], v6 offset:9216
    ds_read_b128 v[44:47], v6 offset:10240
    ds_read_b128 v[48:51], v6 offset:11264
    ds_read_b32 v11, v6 offset:12288
    s_waitcnt lgkmcnt(2)
    v_max3_u32 v10, v36, v40, v44
    s_waitcnt lgkmcnt(0)
    v_max3_u32 v10, v10, v48, v11
    v_cmp_eq_u32 vcc, -1, v10
    s_cbranch_vccz M_c0_1_rr_d
    s_add_u32 s30, s30, 1
    s_cmp_ge_u32 s30, 480000
    s_cbranch_scc1 M_fail
    s_branch M_c0_1_rr_l
M_c0_1_rr_d:
    s_branch M_c0_1_rr_r
M_c0_1_first:
    s_add_u32 s27, s44, 1
    s_or_b32 s28, s44, 63
    s_add_u32 s28, s28, 1
    s_min_u32 s27, s27, s28
    s_cmp_lt_u32 s54, s27
    s_cbranch_scc1 M_c0_1_p1
M_c0_1_p1_r:
    s_barrier
    s_and_b32 s26, s44, 63
    s_lshl_b32 s26, s26, 18
    s_add_u32 s26, s26, s50
    s_add_u32 s26, s26, 2048
    s_add_u32 s3, s26, 16777216
    s_mov_b32 m0, 2048
    s_nop 0
    buffer_load_dwordx4 v0, s[8:11], s26 offen offset:0 sc1 lds
    buffer_load_dwordx4 v0, s[8:11], s26 offen offset:1024 sc1 lds
    buffer_load_dwordx4 v[80:83], v0, s[8:11], s3 offen offset:0 sc1
    buffer_load_dwordx4 v[84:87], v0, s[8:11], s3 offen offset:1024 sc1
    s_and_b32 s26, s44, 63
    s_add_u32 s26, s26, 1
    s_min_u32 s26, s26, 63
    s_lshl_b32 s26, s26, 18
    s_add_u32 s26, s26, s50
    s_add_u32 s26, s26, 2048
    s_add_u32 s3, s26, 16777216
    s_waitcnt vmcnt(0) lgkmcnt(0)
    s_barrier
    s_branch M_c0_1_first_r
M_c0_1_first2:
    s_add_u32 s27, s44, 2
    s_or_b32 s28, s44, 63
    s_add_u32 s28, s28, 1
    s_min_u32 s27, s27, s28
    s_cmp_lt_u32 s54, s27
    s_cbranch_scc1 M_c0_1_p2
M_c0_1_p2_r:
    s_barrier
    s_branch M_c0_1_first2_r
M_c0_1_wq1:
    buffer_load_dwordx4 v[12:15], v0, s[8:11], s43 offen sc1
    s_waitcnt vmcnt(1)
    v_mfma_f32_16x16x32_bf16 v[28:31], v[72:75], v[16:19], 0
    v_cmp_eq_u32 vcc, -1, v16
    s_cbranch_vccnz M_c0_1_wqx
    v_mov_b32 v5, v5
    v_mov_b32 v5, v5
    v_mov_b32 v5, v5
    v_mov_b32 v5, v5
    v_mov_b32 v5, v5
    v_mov_b32 v5, v5
    v_add_f32_dpp v28, v28, v28 row_ror:8 row_mask:0xf bank_mask:0xf
    v_add_f32_dpp v29, v29, v29 row_ror:8 row_mask:0xf bank_mask:0xf
    s_nop 0
    v_add_f32_dpp v28, v28, v28 row_ror:4 row_mask:0xf bank_mask:0xf
    v_add_f32_dpp v29, v29, v29 row_ror:4 row_mask:0xf bank_mask:0xf
    s_nop 0
    v_add_f32_dpp v28, v28, v28 row_ror:2 row_mask:0xf bank_mask:0xf
    v_add_f32_dpp v29, v29, v29 row_ror:2 row_mask:0xf bank_mask:0xf
    v_cmp_u_f32 vcc, v28, v28
    v_cvt_pk_bf16_f32 v28, v28, v29
    s_cbranch_vccnz M_c0_1_wqe1
    s_mov_b64 exec, s[62:63]
    buffer_store_dword v28, v11, s[8:11], s58 offen
    s_barrier
    buffer_store_dword v28, v11, s[8:11], s56 offen sc1
    s_branch M_c0_1_wrb_g
M_c0_1_wqx:
    s_branch M_c0_1_wrb_i1
M_c0_1_wqe1:
    s_waitcnt vmcnt(0)
    buffer_load_dwordx4 v[12:15], v0, s[8:11], s43 offen sc1
    s_branch M_c0_1_wrb_e1
M_c0_1_wrb_l:
    s_waitcnt vmcnt(1)
    v_mfma_f32_16x16x32_bf16 v[28:31], v[72:75], v[12:15], 0
    v_cmp_eq_u32 vcc, -1, v12
    s_cbranch_vccz M_c0_1_wrb_x0
M_c0_1_wrb_i0:
    buffer_load_dwordx4 v[12:15], v0, s[8:11], s43 offen sc1
    s_waitcnt vmcnt(1)
    v_mfma_f32_16x16x32_bf16 v[28:31], v[72:75], v[16:19], 0
    v_cmp_eq_u32 vcc, -1, v16
    s_cbranch_vccz M_c0_1_wrb_x1
M_c0_1_wrb_i1:
    buffer_load_dwordx4 v[16:19], v0, s[8:11], s43 offen sc1
    s_add_u32 s71, s71, 1
    s_cmp_lt_u32 s71, 240000
    s_cbranch_scc1 M_c0_1_wrb_l
    s_branch M_fail
M_c0_1_wrb_x0:
    s_nop 5
    v_add_f32_dpp v28, v28, v28 row_ror:8 row_mask:0xf bank_mask:0xf
    v_add_f32_dpp v29, v29, v29 row_ror:8 row_mask:0xf bank_mask:0xf
    s_nop 0
    v_add_f32_dpp v28, v28, v28 row_ror:4 row_mask:0xf bank_mask:0xf
    v_add_f32_dpp v29, v29, v29 row_ror:4 row_mask:0xf bank_mask:0xf
    s_nop 0
    v_add_f32_dpp v28, v28, v28 row_ror:2 row_mask:0xf bank_mask:0xf
    v_add_f32_dpp v29, v29, v29 row_ror:2 row_mask:0xf bank_mask:0xf
    v_cmp_u_f32 vcc, v28, v28
    v_cvt_pk_bf16_f32 v28, v28, v29
    s_cbranch_vccz M_c0_1_wrb_n
M_c0_1_wrb_e0:
    v_max3_u32 v32, v12, v13, v14
    v_max_u32 v32, v32, v15
    v_cmp_eq_u32 vcc, -1, v32
    s_cbranch_vccnz M_c0_1_wrb_i0
    v_min_u32 v28, -2, v28
    v_min_u32 v29, -2, v29
    s_branch M_c0_1_wrb_n
M_c0_1_wrb_x1:
    s_nop 5
    v_add_f32_dpp v28, v28, v28 row_ror:8 row_mask:0xf bank_mask:0xf
    v_add_f32_dpp v29, v29, v29 row_ror:8 row_mask:0xf bank_mask:0xf
    s_nop 0
    v_add_f32_dpp v28, v28, v28 row_ror:4 row_mask:0xf bank_mask:0xf
    v_add_f32_dpp v29, v29, v29 row_ror:4 row_mask:0xf bank_mask:0xf
    s_nop 0
    v_add_f32_dpp v28, v28, v28 row_ror:2 row_mask:0xf bank_mask:0xf
    v_add_f32_dpp v29, v29, v29 row_ror:2 row_mask:0xf bank_mask:0xf
    v_cmp_u_f32 vcc, v28, v28
    v_cvt_pk_bf16_f32 v28, v28, v29
    s_cbranch_vccz M_c0_1_wrb_n
M_c0_1_wrb_e1:
    v_max3_u32 v32, v16, v17, v18
    v_max_u32 v32, v32, v19
    v_cmp_eq_u32 vcc, -1, v32
    s_cbranch_vccnz M_c0_1_wrb_i1
    v_min_u32 v28, -2, v28
    v_min_u32 v29, -2, v29
M_c0_1_wrb_n:
    s_mov_b64 exec, s[62:63]
    buffer_store_dword v28, v11, s[8:11], s58 offen
    s_branch M_c0_1_wrb_d
M_c0_1_wkw:
    s_mov_b32 s30, 0
M_c0_1_wkw_l:
    s_waitcnt lgkmcnt(0)
    s_mov_b64 exec, 3
    buffer_load_dword v11, v9, s[8:11], s51 offen sc1
    s_waitcnt vmcnt(0)
    s_mov_b64 exec, -1
    v_readlane_b32 s54, v11, 0
    v_readlane_b32 s28, v11, 1
    s_nop 3
    s_min_u32 s54, s54, s28
    s_cmp_ge_u32 s54, s27
    s_cbranch_scc1 M_c0_1_wkw_r
    s_sleep 1
    s_add_u32 s30, s30, 1
    s_cmp_ge_u32 s30, 60000
    s_cbranch_scc1 M_fail
    s_branch M_c0_1_wkw_l
M_c0_1_p1:
    s_mov_b32 s30, 0
M_c0_1_p1_l:
    s_waitcnt lgkmcnt(0)
    s_mov_b64 exec, 3
    buffer_load_dword v11, v9, s[8:11], s51 offen sc1
    s_waitcnt vmcnt(0)
    s_mov_b64 exec, -1
    v_readlane_b32 s54, v11, 0
    v_readlane_b32 s28, v11, 1
    s_nop 3
    s_min_u32 s54, s54, s28
    s_cmp_ge_u32 s54, s27
    s_cbranch_scc1 M_c0_1_p1_r
    s_sleep 1
    s_add_u32 s30, s30, 1
    s_cmp_ge_u32 s30, 60000
    s_cbranch_scc1 M_fail
    s_branch M_c0_1_p1_l
M_c0_1_p2:
    s_mov_b32 s30, 0
M_c0_1_p2_l:
    s_waitcnt lgkmcnt(0)
    s_mov_b64 exec, 3
    buffer_load_dword v11, v9, s[8:11], s51 offen sc1
    s_waitcnt vmcnt(0)
    s_mov_b64 exec, -1
    v_readlane_b32 s54, v11, 0
    v_readlane_b32 s28, v11, 1
    s_nop 3
    s_min_u32 s54, s54, s28
    s_cmp_ge_u32 s54, s27
    s_cbranch_scc1 M_c0_1_p2_r
    s_sleep 1
    s_add_u32 s30, s30, 1
    s_cmp_ge_u32 s30, 60000
    s_cbranch_scc1 M_fail
    s_branch M_c0_1_p2_l
M_c0_2_layer:
    s_lshr_b32 s27, s44, 6
    s_mul_i32 s50, s27, 33554432
    s_lshl_b32 s27, s22, 13
    s_add_u32 s50, s50, s27
    s_add_u32 s50, s50, 37748736
    s_barrier
    s_mov_b32 s26, 0x10010000
    s_mov_b32 s3, s26
    s_mul_i32 s27, s20, 5120
    s_add_u32 s48, s27, 167772160
    s_sub_u32 s49, 167777280, s27
    s_mov_b32 m0, 13312
    s_nop 0
    buffer_load_dwordx4 v0, s[8:11], s48 offen offset:0 sc1 lds
    buffer_load_dwordx4 v0, s[8:11], s48 offen offset:1024 sc1 lds
    buffer_load_dwordx4 v0, s[8:11], s48 offen offset:2048 sc1 lds
    s_and_b32 s55, s44, 3
    s_mul_i32 s55, s55, 167936
    s_add_u32 s55, s55, s34
    s_add_u32 s58, s55, s35
    s_and_b32 s57, s44, 63
    s_sub_u32 s61, s3, 4096
    ds_read_b128 v[56:59], v5 offset:0
    ds_read_b128 v[60:63], v5 offset:1024
    ds_read_b128 v[64:67], v5 offset:2048
    ds_read_b128 v[68:71], v5 offset:3072
    v_mov_b64 v[12:13], 0
    v_mov_b64 v[14:15], 0
    v_mov_b64 v[16:17], 0
    v_mov_b64 v[18:19], 0
    v_mov_b64 v[20:21], 0
    v_mov_b64 v[22:23], 0
    v_mov_b64 v[24:25], 0
    v_mov_b64 v[26:27], 0
    v_mov_b64 v[28:29], 0
    v_mov_b64 v[30:31], 0
    v_mov_b64 v[32:33], 0
    v_mov_b64 v[34:35], 0
    s_mov_b32 s70, 0
    s_waitcnt vmcnt(0) lgkmcnt(0)
M_c0_2_top:
    s_waitcnt vmcnt(6)
    s_barrier
    ds_read_b128 v[36:39], v6 offset:13312
    ds_read_b128 v[40:43], v6 offset:14336
    s_mov_b32 m0, 8192
    s_nop 0
    buffer_load_dwordx4 v0, s[8:11], s49 offen offset:3072 sc1 lds
M_c0_2_lr_r:
    s_waitcnt lgkmcnt(1)
    v_smfmac_f32_16x16x64_bf16 v[20:23], v[36:39], v[56:63], v1
    ds_read_b128 v[56:59], v5 offset:4096
    v_smfmac_f32_16x16x64_bf16 v[24:27], v[36:39], v[64:71], v1
    ds_read_b128 v[60:63], v5 offset:5120
    v_smfmac_f32_16x16x64_bf16 v[28:31], v[36:39], a[248:255], v1
    ds_read_b128 v[64:67], v5 offset:6144
    v_smfmac_f32_16x16x64_bf16 v[32:35], v[36:39], a[240:247], v1
    ds_read_b128 v[68:71], v5 offset:7168
    v_smfmac_f32_16x16x64_bf16 v[12:15], v[36:39], a[232:239], v1
    ds_read_b128 v[44:47], v6 offset:15360
    s_waitcnt lgkmcnt(3)
    v_smfmac_f32_16x16x64_bf16 v[16:19], v[36:39], v[56:63], v1
    ds_read_b128 v[56:59], v5 offset:8192
    v_smfmac_f32_16x16x64_bf16 v[20:23], v[40:43], a[224:231], v1
    ds_read_b128 v[60:63], v5 offset:9216
    v_smfmac_f32_16x16x64_bf16 v[24:27], v[40:43], a[216:223], v1
    ds_read_b128 v[48:51], v6 offset:16384
    s_waitcnt lgkmcnt(4)
    v_smfmac_f32_16x16x64_bf16 v[28:31], v[40:43], v[64:71], v1
    ds_read_b128 v[64:67], v5 offset:10240
    v_smfmac_f32_16x16x64_bf16 v[32:35], v[40:43], a[208:215], v1
    ds_read_b128 v[68:71], v5 offset:11264
    v_smfmac_f32_16x16x64_bf16 v[12:15], v[40:43], a[200:207], v1
    ds_read_b128 v[52:55], v6 offset:17408
    s_waitcnt lgkmcnt(6)
    s_waitcnt lgkmcnt(4)
    v_max3_u32 v10, v36, v40, v44
    v_smfmac_f32_16x16x64_bf16 v[16:19], v[40:43], v[56:63], v1
    ds_read_b128 v[56:59], v5 offset:12288
    s_waitcnt lgkmcnt(1)
    v_max3_u32 v10, v10, v48, v52
    v_smfmac_f32_16x16x64_bf16 v[20:23], v[44:47], a[192:199], v1
    ds_read_b128 v[60:63], v5 offset:13312
    v_cmp_eq_u32 vcc, -1, v10
    v_smfmac_f32_16x16x64_bf16 v[24:27], v[44:47], a[184:191], v1
    s_cbranch_vccnz M_c0_2_lr
    v_smfmac_f32_16x16x64_bf16 v[28:31], v[44:47], v[64:71], v1
    ds_read_b128 v[64:67], v5 offset:14336
    v_smfmac_f32_16x16x64_bf16 v[32:35], v[44:47], a[176:183], v1
    ds_read_b128 v[68:71], v5 offset:15360
    v_smfmac_f32_16x16x64_bf16 v[20:23], v[48:51], a[168:175], v1
    s_waitcnt lgkmcnt(2)
    v_smfmac_f32_16x16x64_bf16 v[24:27], v[48:51], v[56:63], v1
    ds_read_b128 v[56:59], v5 offset:16384
    v_smfmac_f32_16x16x64_bf16 v[28:31], v[48:51], a[160:167], v1
    ds_read_b128 v[60:63], v5 offset:17408
    v_smfmac_f32_16x16x64_bf16 v[32:35], v[48:51], a[152:159], v1
    s_waitcnt vmcnt(0)
    s_barrier
    ds_read_b128 v[36:39], v6 offset:8192
    ds_read_b128 v[40:43], v6 offset:9216
    s_waitcnt lgkmcnt(4)
    v_smfmac_f32_16x16x64_bf16 v[20:23], v[52:55], v[64:71], v1
    ds_read_b128 v[44:47], v6 offset:10240
    ds_read_b128 v[48:51], v6 offset:11264
    v_smfmac_f32_16x16x64_bf16 v[24:27], v[52:55], a[144:151], v1
    ds_read_b32 v11, v6 offset:12288
    ds_read_b128 v[64:67], v5 offset:18432
    v_smfmac_f32_16x16x64_bf16 v[28:31], v[52:55], a[136:143], v1
    ds_read_b128 v[68:71], v5 offset:19456
    s_waitcnt lgkmcnt(4)
    v_max3_u32 v10, v36, v40, v44
    v_smfmac_f32_16x16x64_bf16 v[32:35], v[52:55], v[56:63], v1
    s_waitcnt lgkmcnt(2)
    v_max3_u32 v10, v10, v48, v11
    v_cmp_eq_u32 vcc, -1, v10
    s_cbranch_vccnz M_c0_2_rr
M_c0_2_rr_r:
    s_mov_b32 m0, 23040
    ds_read_b128 v[52:55], v6 offset:12288
    buffer_store_dwordx4 v[76:79], v0, s[8:11], s4 offen offset:2048 sc1
    s_mov_b32 s4, 0x10000000
    buffer_load_dword v9, s[8:11], s61 offen sc1 lds
    v_smfmac_f32_16x16x64_bf16 v[20:23], v[36:39], a[128:135], v1
    ds_read_b128 v[56:59], v5 offset:20480
    v_smfmac_f32_16x16x64_bf16 v[24:27], v[36:39], a[120:127], v1
    ds_read_b128 v[60:63], v5 offset:21504
    s_waitcnt lgkmcnt(3)
    v_smfmac_f32_16x16x64_bf16 v[20:23], v[40:43], v[64:71], v1
    ds_read_b128 v[64:67], v5 offset:22528
    v_smfmac_f32_16x16x64_bf16 v[24:27], v[40:43], a[112:119], v1
    ds_read_b128 v[68:71], v5 offset:23552
    v_smfmac_f32_16x16x64_bf16 v[20:23], v[44:47], a[104:111], v1
    s_waitcnt lgkmcnt(2)
    v_smfmac_f32_16x16x64_bf16 v[24:27], v[44:47], v[56:63], v1
    ds_read_b128 v[56:59], v5 offset:24576
    v_smfmac_f32_16x16x64_bf16 v[20:23], v[48:51], a[96:103], v1
    ds_read_b128 v[60:63], v5 offset:25600
    v_smfmac_f32_16x16x64_bf16 v[24:27], v[48:51], a[88:95], v1
    s_waitcnt lgkmcnt(2)
    v_smfmac_f32_16x16x64_bf16 v[20:23], v[52:55], v[64:71], v1
    ds_read_b128 v[64:67], v5 offset:26624
    v_smfmac_f32_16x16x64_bf16 v[24:27], v[52:55], a[80:87], v1
    ds_read_b128 v[68:71], v5 offset:27648
    v_smfmac_f32_16x16x64_bf16 v[28:31], v[36:39], a[72:79], v1
    s_waitcnt lgkmcnt(2)
    v_smfmac_f32_16x16x64_bf16 v[32:35], v[36:39], v[56:63], v1
    ds_read_b128 v[56:59], v5 offset:28672
    s_nop 0
    v_permlane32_swap_b32 v20, v21
    v_smfmac_f32_16x16x64_bf16 v[28:31], v[40:43], a[64:71], v1
    ds_read_b128 v[60:63], v5 offset:29696
    v_permlane32_swap_b32 v22, v23
    v_smfmac_f32_16x16x64_bf16 v[32:35], v[40:43], a[56:63], v1
    s_waitcnt lgkmcnt(2)
    v_permlane32_swap_b32 v24, v25
    v_smfmac_f32_16x16x64_bf16 v[28:31], v[44:47], v[64:71], v1
    ds_read_b128 v[64:67], v5 offset:30720
    v_permlane32_swap_b32 v26, v27
    v_smfmac_f32_16x16x64_bf16 v[32:35], v[44:47], a[48:55], v1
    ds_read_b128 v[68:71], v5 offset:31744
    v_add_f32 v20, v20, v21
    v_add_f32 v22, v22, v23
    v_smfmac_f32_16x16x64_bf16 v[28:31], v[48:51], a[40:47], v1
    s_waitcnt lgkmcnt(2)
    v_add_f32 v24, v24, v25
    v_add_f32 v26, v26, v27
    v_smfmac_f32_16x16x64_bf16 v[32:35], v[48:51], v[56:63], v1
    ds_read_b128 v[56:59], v5 offset:32768
    v_mul_f32 v20, s40, v20
    v_mul_f32 v24, s40, v24
    v_smfmac_f32_16x16x64_bf16 v[28:31], v[52:55], a[32:39], v1
    ds_read_b128 v[60:63], v5 offset:33792
    v_mul_f32 v22, s40, v22
    v_mul_f32 v26, s40, v26
    v_smfmac_f32_16x16x64_bf16 v[32:35], v[52:55], a[24:31], v1
    s_waitcnt lgkmcnt(2)
    v_cvt_pk_bf16_f32 v20, v20, v24
    v_cvt_pk_bf16_f32 v21, v22, v26
    v_smfmac_f32_16x16x64_bf16 v[12:15], v[36:39], v[64:71], v1
    s_cmp_eq_u32 s57, 0
    s_cbranch_scc1 M_c0_2_first
M_c0_2_first_r:
    ds_write_b32 v2, v20 offset:18432
    v_smfmac_f32_16x16x64_bf16 v[16:19], v[36:39], a[16:23], v1
    ds_write_b32 v2, v21 offset:19008
    v_permlane32_swap_b32 v28, v29
    v_smfmac_f32_16x16x64_bf16 v[12:15], v[40:43], a[8:15], v1
    ds_read_b128 v[36:39], v6 offset:15360
    s_waitcnt lgkmcnt(3)
    v_permlane32_swap_b32 v30, v31
    v_smfmac_f32_16x16x64_bf16 v[16:19], v[40:43], v[56:63], v1
    ds_read_b128 v[64:67], v0 offset:2048
    v_permlane32_swap_b32 v32, v33
    v_smfmac_f32_16x16x64_bf16 v[12:15], v[44:47], a[0:7], v1
    ds_read_b128 v[68:71], v0 offset:3072
    v_permlane32_swap_b32 v34, v35
    v_smfmac_f32_16x16x64_bf16 v[16:19], v[44:47], v[248:255], v1
    s_waitcnt lgkmcnt(3)
    s_barrier
    ds_read_b128 v[40:43], v6 offset:16384
    v_add_f32 v28, v28, v29
    v_add_f32 v30, v30, v31
    v_smfmac_f32_16x16x64_bf16 v[12:15], v[48:51], v[240:247], v1
    ds_read_b128 v[56:59], v0 offset:0
    v_add_f32 v32, v32, v33
    v_add_f32 v34, v34, v35
    v_smfmac_f32_16x16x64_bf16 v[16:19], v[48:51], v[232:239], v1
    ds_read_b128 v[60:63], v0 offset:1024
    v_cvt_pk_bf16_f32 v28, v28, v32
    v_cvt_pk_bf16_f32 v29, v30, v34
    v_smfmac_f32_16x16x64_bf16 v[12:15], v[52:55], v[224:231], v1
    ds_write_b32 v2, v28 offset:20736
    ds_read_b128 v[20:23], v3 offset:18432
    v_smfmac_f32_16x16x64_bf16 v[16:19], v[52:55], v[216:223], v1
    ds_write_b32 v2, v29 offset:21312
    ds_read_b128 v[24:27], v3 offset:18496
    s_waitcnt lgkmcnt(9)
    v_smfmac_f32_16x16x64_bf16 v[12:15], v[36:39], v[208:215], v1
    ds_read_b128 v[72:75], v3 offset:18560
    ds_read_b128 v[44:47], v3 offset:18624
    v_smfmac_f32_16x16x64_bf16 v[16:19], v[36:39], v[200:207], v1
    ds_read_b128 v[48:51], v6 offset:17408
    s_waitcnt lgkmcnt(9)
    v_smfmac_f32_16x16x64_bf16 v[12:15], v[40:43], v[192:199], v1
    v_smfmac_f32_16x16x64_bf16 v[16:19], v[40:43], v[184:191], v1
    s_waitcnt lgkmcnt(5)
    v_mfma_f32_16x16x32_bf16 v[28:31], v[56:59], v[20:23], 0
    ds_read_b128 v[56:59], v0 offset:4096
    s_waitcnt lgkmcnt(4)
    v_mov_b64 v[52:53], s[24:25]
    v_mfma_f32_16x16x32_bf16 v[28:31], v[60:63], v[24:27], v[28:31]
    ds_read_b128 v[60:63], v0 offset:5120
    s_barrier
    s_waitcnt lgkmcnt(4)
    v_mfma_f32_16x16x32_bf16 v[28:31], v[64:67], v[72:75], v[28:31]
    ds_read_b128 v[64:67], v0 offset:6144
    s_waitcnt lgkmcnt(4)
    v_mov_b64 v[54:55], s[24:25]
    v_mfma_f32_16x16x32_bf16 v[28:31], v[68:71], v[44:47], v[28:31]
    ds_read_b128 v[68:71], v0 offset:7168
    s_waitcnt lgkmcnt(4)
    v_mov_b64 v[10:11], s[16:17]
    v_smfmac_f32_16x16x64_bf16 v[12:15], v[48:51], v[176:183], v1
    ds_read_b128 v[36:39], v3 offset:20736
    v_smfmac_f32_16x16x64_bf16 v[16:19], v[48:51], v[168:175], v1
    ds_read_b128 v[40:43], v3 offset:20800
    s_waitcnt lgkmcnt(4)
    v_mfma_f32_16x16x32_bf16 v[32:35], v[56:59], v[20:23], 0
    v_exp_f32 v28, v28
    v_mfma_f32_16x16x32_bf16 v[32:35], v[60:63], v[24:27], v[32:35]
    s_waitcnt lgkmcnt(2)
    v_exp_f32 v29, v29
    ds_read_b128 v[56:59], v3 offset:20864
    v_mfma_f32_16x16x32_bf16 v[32:35], v[64:67], v[72:75], v[32:35]
    v_exp_f32 v30, v30
    ds_read_b128 v[60:63], v3 offset:20928
    v_mfma_f32_16x16x32_bf16 v[32:35], v[68:71], v[44:47], v[32:35]
    s_waitcnt lgkmcnt(3)
    v_exp_f32 v31, v31
    v_mfma_f32_16x16x32_bf16 v[48:51], v[36:39], v[20:23], 0
    s_waitcnt lgkmcnt(2)
    v_cvt_pk_bf16_f32 v28, v28, v29
    v_cvt_pk_bf16_f32 v29, v30, v31
    v_mfma_f32_16x16x32_bf16 v[48:51], v[40:43], v[24:27], v[48:51]
    s_waitcnt lgkmcnt(1)
    v_cvt_pk_bf16_f32 v12, v12, v13
    v_cvt_pk_bf16_f32 v13, v14, v15
    v_mfma_f32_16x16x32_bf16 v[48:51], v[56:59], v[72:75], v[48:51]
    s_waitcnt lgkmcnt(0)
    v_exp_f32 v32, v32
    v_mfma_f32_16x16x32_bf16 v[48:51], v[60:63], v[44:47], v[48:51]
    v_exp_f32 v33, v33
    v_exp_f32 v34, v34
    v_exp_f32 v35, v35
    v_cvt_pk_bf16_f32 v30, v32, v33
    v_cvt_pk_bf16_f32 v31, v34, v35
    v_cvt_pk_bf16_f32 v14, v16, v17
    v_cvt_pk_bf16_f32 v15, v18, v19
    v_mfma_f32_16x16x32_bf16 v[72:75], v[52:55], v[28:31], 0
    v_exp_f32 v48, v48
    v_mfma_f32_16x16x32_bf16 v[20:23], v[80:83], v[28:31], 0
    v_exp_f32 v49, v49
    v_mfma_f32_16x16x32_bf16 v[24:27], v[84:87], v[28:31], 0
    v_exp_f32 v50, v50
    v_exp_f32 v51, v51
    v_cvt_pk_bf16_f32 v48, v48, v49
    v_cvt_pk_bf16_f32 v49, v50, v51
    v_cndmask_b32_e64 v76, v12, v56, s[66:67]
    v_cndmask_b32_e64 v77, v13, v57, s[66:67]
M_c0_2_fin:
    v_mfma_f32_16x16x16_bf16 v[72:75], v[10:11], v[48:49], v[72:75]
    v_cndmask_b32_e64 v78, v14, v58, s[66:67]
    v_cndmask_b32_e64 v79, v15, v59, s[66:67]
    v_mfma_f32_16x16x16_bf16 v[20:23], v[12:13], v[48:49], v[20:23]
    s_cmp_eq_u32 s57, 63
    v_mov_b64 v[44:45], 0
    v_mov_b64 v[46:47], 0
    v_mfma_f32_16x16x16_bf16 v[24:27], v[14:15], v[48:49], v[24:27]
    s_cbranch_scc1 M_c0_2_last
    v_mov_b64 v[68:69], 0
    v_rcp_f32 v74, v72
    v_subrev_u32 v73, s68, v72
    v_cmp_lt_u32 vcc, s69, v73
    v_mov_b64 v[70:71], 0
    v_mov_b32 v5, v5
    v_mov_b32 v5, v5
    v_cndmask_b32_e64 v20, v20, v24, s[18:19]
    v_cndmask_b32_e64 v21, v21, v25, s[18:19]
    v_cndmask_b32_e64 v22, v22, v26, s[18:19]
    v_cndmask_b32_e64 v23, v23, v27, s[18:19]
    v_pk_mul_f32 v[20:21], v[20:21], v[74:75] op_sel_hi:[1,0]
    v_pk_mul_f32 v[22:23], v[22:23], v[74:75] op_sel_hi:[1,0]
    v_cvt_pk_bf16_f32 v20, v20, v21
    v_cvt_pk_bf16_f32 v21, v22, v23
    ds_write_b64 v0, v[20:21] offset:14336
    s_cbranch_vccnz M_c0_2_zbad
M_c0_2_zok:
    s_cmp_eq_u32 s57, 0
    s_cbranch_scc1 M_c0_2_first2
M_c0_2_first2_r:
    buffer_load_dwordx4 v[80:83], v0, s[8:11], s3 offen offset:0 sc1
    buffer_load_dwordx4 v[84:87], v0, s[8:11], s3 offen offset:1024 sc1
    s_waitcnt lgkmcnt(0)
    s_barrier
    ds_read_b128 v[32:35], v0 offset:13312
    ds_read_b128 v[40:43], v0 offset:14336
    s_mov_b32 m0, 4096
    s_nop 0
    buffer_load_dwordx4 v0, s[8:11], s26 offen offset:0 sc1 lds
    buffer_load_dwordx4 v0, s[8:11], s26 offen offset:1024 sc1 lds
    v_mov_b64 v[64:65], 0
    v_mov_b64 v[66:67], 0
    v_mov_b64 v[60:61], 0
    v_mov_b64 v[62:63], 0
    v_mov_b64 v[56:57], 0
    v_mov_b64 v[58:59], 0
    s_waitcnt lgkmcnt(1)
    s_nop 0
    v_smfmac_f32_16x16x64_bf16 v[56:59], v[32:35], v[160:167], v1
    v_smfmac_f32_16x16x64_bf16 v[60:63], v[32:35], v[144:151], v1
    s_waitcnt lgkmcnt(0)
    v_smfmac_f32_16x16x64_bf16 v[56:59], v[40:43], v[152:159], v1
    v_smfmac_f32_16x16x64_bf16 v[60:63], v[40:43], v[136:143], v1
    v_smfmac_f32_16x16x64_bf16 v[64:67], v[32:35], v[128:135], v1
    v_smfmac_f32_16x16x64_bf16 v[68:71], v[32:35], v[112:119], v1
    v_permlane32_swap_b32 v56, v57
    v_smfmac_f32_16x16x64_bf16 v[64:67], v[40:43], v[120:127], v1
    v_permlane32_swap_b32 v58, v59
    v_smfmac_f32_16x16x64_bf16 v[68:71], v[40:43], v[104:111], v1
    v_add_f32 v56, v56, v57
    v_add_f32 v58, v58, v59
    v_smfmac_f32_16x16x64_bf16 v[44:47], v[32:35], v[96:103], v1
    v_permlane32_swap_b32 v60, v61
    v_smfmac_f32_16x16x64_bf16 v[44:47], v[40:43], v[88:95], v1
    v_permlane32_swap_b32 v62, v63
    v_add_f32 v60, v60, v61
    v_add_f32 v62, v62, v63
    v_cvt_pk_bf16_f32 v36, v56, v60
    v_cvt_pk_bf16_f32 v38, v58, v62
    v_permlane32_swap_b32 v64, v65
    v_permlane32_swap_b32 v66, v67
    v_add_f32 v64, v64, v65
    v_add_f32 v66, v66, v67
    v_permlane32_swap_b32 v68, v69
    v_permlane32_swap_b32 v70, v71
    v_add_f32 v68, v68, v69
    v_add_f32 v70, v70, v71
    v_cvt_pk_bf16_f32 v37, v64, v68
    v_cvt_pk_bf16_f32 v39, v66, v70
    buffer_store_dwordx4 v[36:39], v0, s[8:11], s58 offen
    v_permlane32_swap_b32 v44, v45
    v_permlane32_swap_b32 v46, v47
    v_add_f32 v44, v44, v45
    v_add_f32 v46, v46, v47
    v_cvt_pk_bf16_f32 v44, v44, v46
    buffer_store_dword v44, v7, s[8:11], s55 offen
    s_add_u32 s27, s44, 1
    s_and_b32 s27, s27, 3
    s_mul_i32 s48, s27, 5120
    s_add_u32 s48, s48, s41
    s_lshl_b32 s27, s27, 15
    s_add_u32 s49, s27, s47
    ds_read_b128 v[56:59], v5 offset:0
    ds_read_b128 v[60:63], v5 offset:1024
    ds_read_b128 v[64:67], v5 offset:2048
    ds_read_b128 v[68:71], v5 offset:3072
    v_mov_b64 v[12:13], 0
    v_mov_b64 v[14:15], 0
    v_mov_b64 v[16:17], 0
    v_mov_b64 v[18:19], 0
    v_mov_b64 v[20:21], 0
    v_mov_b64 v[22:23], 0
    v_mov_b64 v[24:25], 0
    v_mov_b64 v[26:27], 0
    v_mov_b64 v[28:29], 0
    v_mov_b64 v[30:31], 0
    v_mov_b64 v[32:33], 0
    v_mov_b64 v[34:35], 0
    s_barrier
    s_and_b32 s26, s44, 63
    s_add_u32 s26, s26, 2
    s_min_u32 s26, s26, 63
    s_lshl_b32 s26, s26, 18
    s_add_u32 s26, s26, s50
    s_add_u32 s26, s26, 4096
    s_add_u32 s3, s26, 16777216
    s_lshl_b32 s4, s44, 18
    s_add_u32 s4, s4, s53
    s_add_u32 s44, s44, 1
    s_and_b32 s55, s44, 3
    s_mul_i32 s55, s55, 167936
    s_add_u32 s55, s55, s34
    s_add_u32 s58, s55, s35
    s_and_b32 s57, s44, 63
    s_sub_u32 s61, s3, 4096
    s_nop 15
    s_nop 15
    s_nop 7
    s_mov_b32 m0, 13312
    s_nop 0
    buffer_load_dwordx4 v0, s[8:11], s48 offen offset:0 sc1 lds
    buffer_load_dwordx4 v0, s[8:11], s48 offen offset:1024 sc1 lds
    buffer_load_dwordx4 v0, s[8:11], s48 offen offset:2048 sc1 lds
    s_nop 11
    s_mov_b32 m0, 13312
    s_nop 0
    buffer_load_dwordx4 v0, s[8:11], s48 offen offset:0 sc1 lds
    buffer_load_dwordx4 v0, s[8:11], s48 offen offset:1024 sc1 lds
    buffer_load_dwordx4 v0, s[8:11], s48 offen offset:2048 sc1 lds
    s_nop 11
    s_mov_b32 m0, 13312
    s_nop 0
    buffer_load_dwordx4 v0, s[8:11], s48 offen offset:0 sc1 lds
    buffer_load_dwordx4 v0, s[8:11], s48 offen offset:1024 sc1 lds
    buffer_load_dwordx4 v0, s[8:11], s48 offen offset:2048 sc1 lds
    s_mov_b32 s70, 0
    s_waitcnt lgkmcnt(0)
    s_branch M_c0_2_top
M_c0_2_restart:
    s_waitcnt vmcnt(0) lgkmcnt(0)
    s_nop 7
    s_barrier
    s_mov_b32 m0, 13312
    s_nop 0
    buffer_load_dwordx4 v0, s[8:11], s48 offen offset:0 sc1 lds
    buffer_load_dwordx4 v0, s[8:11], s48 offen offset:1024 sc1 lds
    buffer_load_dwordx4 v0, s[8:11], s48 offen offset:2048 sc1 lds
    ds_read_b128 v[56:59], v5 offset:0
    ds_read_b128 v[60:63], v5 offset:1024
    ds_read_b128 v[64:67], v5 offset:2048
    ds_read_b128 v[68:71], v5 offset:3072
    v_mov_b64 v[12:13], 0
    v_mov_b64 v[14:15], 0
    v_mov_b64 v[16:17], 0
    v_mov_b64 v[18:19], 0
    v_mov_b64 v[20:21], 0
    v_mov_b64 v[22:23], 0
    v_mov_b64 v[24:25], 0
    v_mov_b64 v[26:27], 0
    v_mov_b64 v[28:29], 0
    v_mov_b64 v[30:31], 0
    v_mov_b64 v[32:33], 0
    v_mov_b64 v[34:35], 0
    s_waitcnt vmcnt(0) lgkmcnt(0)
    s_branch M_c0_2_top
M_c0_2_zbad:
    s_cmp_eq_u32 s70, 2
    s_cbranch_scc1 M_c0_2_zok
    v_cmp_u_f32 vcc, v72, v72
    s_cbranch_vccz M_c0_2_exact
    s_cmp_eq_u32 s70, 1
    s_cbranch_scc1 M_c0_2_exact
M_c0_2_vfy0:
    s_mov_b32 s70, 1
    s_mov_b32 s30, 0
    s_waitcnt vmcnt(0) lgkmcnt(0)
    s_nop 7
M_c0_2_vfy:
    v_mov_b32 v10, 0
    s_add_u32 s59, s48, 4096
    buffer_load_dwordx4 v[36:39], v0, s[8:11], s48 offen offset:0 sc1
    buffer_load_dwordx4 v[40:43], v0, s[8:11], s48 offen offset:1024 sc1
    buffer_load_dwordx4 v[44:47], v0, s[8:11], s48 offen offset:2048 sc1
    buffer_load_dwordx4 v[48:51], v0, s[8:11], s48 offen offset:3072 sc1
    buffer_load_dwordx4 v[52:55], v0, s[8:11], s59 offen offset:0 sc1
    s_waitcnt vmcnt(4)
    v_max3_u32 v10, v10, v36, v37
    v_max3_u32 v10, v10, v38, v39
    s_waitcnt vmcnt(3)
    v_max3_u32 v10, v10, v40, v41
    v_max3_u32 v10, v10, v42, v43
    s_waitcnt vmcnt(2)
    v_max3_u32 v10, v10, v44, v45
    v_max3_u32 v10, v10, v46, v47
    s_waitcnt vmcnt(1)
    v_max3_u32 v10, v10, v48, v49
    v_max3_u32 v10, v10, v50, v51
    s_waitcnt vmcnt(0)
    v_max3_u32 v10, v10, v52, v53
    v_max3_u32 v10, v10, v54, v55
    s_add_u32 s59, s49, 4096
    buffer_load_dwordx4 v[36:39], v0, s[8:11], s49 offen offset:0 sc1
    buffer_load_dwordx4 v[40:43], v0, s[8:11], s49 offen offset:1024 sc1
    buffer_load_dwordx4 v[44:47], v0, s[8:11], s49 offen offset:2048 sc1
    buffer_load_dwordx4 v[48:51], v0, s[8:11], s49 offen offset:3072 sc1
    buffer_load_dwordx4 v[52:55], v0, s[8:11], s59 offen offset:0 sc1
    s_waitcnt vmcnt(4)
    v_max3_u32 v10, v10, v36, v37
    v_max3_u32 v10, v10, v38, v39
    s_waitcnt vmcnt(3)
    v_max3_u32 v10, v10, v40, v41
    v_max3_u32 v10, v10, v42, v43
    s_waitcnt vmcnt(2)
    v_max3_u32 v10, v10, v44, v45
    v_max3_u32 v10, v10, v46, v47
    s_waitcnt vmcnt(1)
    v_max3_u32 v10, v10, v48, v49
    v_max3_u32 v10, v10, v50, v51
    s_waitcnt vmcnt(0)
    v_max3_u32 v10, v10, v52, v53
    v_max3_u32 v10, v10, v54, v55
    v_cmp_eq_u32 vcc, -1, v10
    s_cbranch_vccz M_c0_2_restart
    s_add_u32 s30, s30, 1
    s_cmp_ge_u32 s30, 60000
    s_cbranch_scc1 M_fail
    s_branch M_c0_2_vfy
M_c0_2_exact:
    s_nop 7
    s_mov_b32 s70, 2
    s_waitcnt lgkmcnt(0)
    ds_read_b128 v[20:23], v3 offset:18432
    ds_read_b128 v[24:27], v3 offset:18496
    ds_read_b128 v[72:75], v3 offset:18560
    ds_read_b128 v[44:47], v3 offset:18624
    ds_read_b128 v[56:59], v0 offset:0
    s_waitcnt lgkmcnt(0)
    v_mfma_f32_16x16x32_bf16 v[28:31], v[56:59], v[20:23], 0
    s_nop 3
    ds_read_b128 v[60:63], v0 offset:1024
    s_waitcnt lgkmcnt(0)
    v_mfma_f32_16x16x32_bf16 v[28:31], v[60:63], v[24:27], v[28:31]
    s_nop 3
    ds_read_b128 v[56:59], v0 offset:2048
    s_waitcnt lgkmcnt(0)
    v_mfma_f32_16x16x32_bf16 v[28:31], v[56:59], v[72:75], v[28:31]
    s_nop 3
    ds_read_b128 v[60:63], v0 offset:3072
    s_waitcnt lgkmcnt(0)
    v_mfma_f32_16x16x32_bf16 v[28:31], v[60:63], v[44:47], v[28:31]
    s_nop 3
    ds_read_b128 v[56:59], v0 offset:4096
    s_waitcnt lgkmcnt(0)
    v_mfma_f32_16x16x32_bf16 v[32:35], v[56:59], v[20:23], 0
    s_nop 3
    ds_read_b128 v[60:63], v0 offset:5120
    s_waitcnt lgkmcnt(0)
    v_mfma_f32_16x16x32_bf16 v[32:35], v[60:63], v[24:27], v[32:35]
    s_nop 3
    ds_read_b128 v[56:59], v0 offset:6144
    s_waitcnt lgkmcnt(0)
    v_mfma_f32_16x16x32_bf16 v[32:35], v[56:59], v[72:75], v[32:35]
    s_nop 3
    ds_read_b128 v[60:63], v0 offset:7168
    s_waitcnt lgkmcnt(0)
    v_mfma_f32_16x16x32_bf16 v[32:35], v[60:63], v[44:47], v[32:35]
    s_nop 3
    ds_read_b128 v[56:59], v3 offset:20736
    s_waitcnt lgkmcnt(0)
    v_mfma_f32_16x16x32_bf16 v[48:51], v[56:59], v[20:23], 0
    s_nop 3
    ds_read_b128 v[60:63], v3 offset:20800
    s_waitcnt lgkmcnt(0)
    v_mfma_f32_16x16x32_bf16 v[48:51], v[60:63], v[24:27], v[48:51]
    s_nop 3
    ds_read_b128 v[56:59], v3 offset:20864
    s_waitcnt lgkmcnt(0)
    v_mfma_f32_16x16x32_bf16 v[48:51], v[56:59], v[72:75], v[48:51]
    s_nop 3
    ds_read_b128 v[60:63], v3 offset:20928
    s_waitcnt lgkmcnt(0)
    v_mfma_f32_16x16x32_bf16 v[48:51], v[60:63], v[44:47], v[48:51]
    s_nop 3
    v_max3_f32 v64, v28, v29, v30
    v_max3_f32 v64, v64, v31, v32
    v_max3_f32 v64, v64, v33, v34
    s_nop 0
    v_max3_f32 v64, v64, v35, v48
    v_max3_f32 v64, v64, v49, v50
    v_max_f32 v64, v64, v51
    v_mov_b32 v65, v64
    s_nop 1
    v_permlane16_swap_b32 v64, v65
    v_max_f32 v64, v64, v65
    v_mov_b32 v65, v64
    s_nop 1
    v_permlane32_swap_b32 v64, v65
    v_max_f32 v64, v64, v65
    v_sub_f32 v28, v28, v64
    v_exp_f32 v28, v28
    v_sub_f32 v29, v29, v64
    v_exp_f32 v29, v29
    v_sub_f32 v30, v30, v64
    v_exp_f32 v30, v30
    v_sub_f32 v31, v31, v64
    v_exp_f32 v31, v31
    v_sub_f32 v32, v32, v64
    v_exp_f32 v32, v32
    v_sub_f32 v33, v33, v64
    v_exp_f32 v33, v33
    v_sub_f32 v34, v34, v64
    v_exp_f32 v34, v34
    v_sub_f32 v35, v35, v64
    v_exp_f32 v35, v35
    v_sub_f32 v48, v48, v64
    v_exp_f32 v48, v48
    v_sub_f32 v49, v49, v64
    v_exp_f32 v49, v49
    v_sub_f32 v50, v50, v64
    v_exp_f32 v50, v50
    v_sub_f32 v51, v51, v64
    v_exp_f32 v51, v51
    v_cvt_pk_bf16_f32 v28, v28, v29
    v_cvt_pk_bf16_f32 v29, v30, v31
    v_cvt_pk_bf16_f32 v30, v32, v33
    v_cvt_pk_bf16_f32 v31, v34, v35
    v_cvt_pk_bf16_f32 v48, v48, v49
    v_cvt_pk_bf16_f32 v49, v50, v51
    v_mfma_f32_16x16x32_bf16 v[20:23], v[80:83], v[28:31], 0
    v_mfma_f32_16x16x32_bf16 v[24:27], v[84:87], v[28:31], 0
    v_mfma_f32_16x16x32_bf16 v[72:75], v[52:55], v[28:31], 0
    ds_read_b128 v[56:59], v3 offset:20864
    s_waitcnt lgkmcnt(0)
    s_nop 7
    s_branch M_c0_2_fin
M_c0_2_last:
    s_cmp_lg_u32 s70, 0
    s_cbranch_scc1 M_c0_2_last2
    v_cmp_u_f32 vcc, v32, v32
    s_cbranch_vccnz M_c0_2_vfy0
M_c0_2_last2:
    s_lshl_b32 s4, s44, 18
    s_add_u32 s4, s4, s53
    buffer_store_dwordx4 v[76:79], v0, s[8:11], s4 offen offset:2048 sc1
    s_mov_b32 s4, 0x10000000
    s_waitcnt vmcnt(0) lgkmcnt(0)
    s_barrier
    s_nop 7
    v_mov_b64 v[72:73], -1
    v_mov_b64 v[74:75], -1
    s_add_u32 s28, s44, 3
    s_and_b32 s29, s28, 3
    s_mul_i32 s31, s22, 160
    s_waitcnt vmcnt(0)
    s_add_u32 s44, s44, 1
    s_cmp_eq_u32 s44, 128
    s_cbranch_scc1 M_end
    s_branch M_c0_2_layer
M_c0_2_lr:
    s_mov_b32 s30, 0
M_c0_2_lr_l:
    s_waitcnt lgkmcnt(0)
    s_and_b32 s27, s30, 1
    s_cbranch_scc0 M_c0_2_lr_n
    s_waitcnt vmcnt(3)
    s_mov_b32 m0, 13312
    s_nop 0
    buffer_load_dwordx4 v0, s[8:11], s48 offen offset:0 sc1 lds
    buffer_load_dwordx4 v0, s[8:11], s48 offen offset:1024 sc1 lds
    buffer_load_dwordx4 v0, s[8:11], s48 offen offset:2048 sc1 lds
M_c0_2_lr_n:
    ds_read_b128 v[36:39], v6 offset:13312
    ds_read_b128 v[40:43], v6 offset:14336
    ds_read_b128 v[44:47], v6 offset:15360
    ds_read_b128 v[48:51], v6 offset:16384
    ds_read_b128 v[52:55], v6 offset:17408
    s_waitcnt lgkmcnt(2)
    v_max3_u32 v10, v36, v40, v44
    s_waitcnt lgkmcnt(0)
    v_max3_u32 v10, v10, v48, v52
    v_cmp_eq_u32 vcc, -1, v10
    s_cbranch_vccz M_c0_2_lr_d
    s_add_u32 s30, s30, 1
    s_cmp_ge_u32 s30, 480000
    s_cbranch_scc1 M_fail
    s_branch M_c0_2_lr_l
M_c0_2_lr_d:
    ds_read_b128 v[56:59], v5 offset:0
    ds_read_b128 v[60:63], v5 offset:1024
    ds_read_b128 v[64:67], v5 offset:2048
    ds_read_b128 v[68:71], v5 offset:3072
    v_mov_b64 v[12:13], 0
    v_mov_b64 v[14:15], 0
    v_mov_b64 v[16:17], 0
    v_mov_b64 v[18:19], 0
    v_mov_b64 v[20:21], 0
    v_mov_b64 v[22:23], 0
    v_mov_b64 v[24:25], 0
    v_mov_b64 v[26:27], 0
    v_mov_b64 v[28:29], 0
    v_mov_b64 v[30:31], 0
    v_mov_b64 v[32:33], 0
    v_mov_b64 v[34:35], 0
    s_waitcnt lgkmcnt(0)
    s_branch M_c0_2_lr_r
M_c0_2_rr:
    s_mov_b32 s30, 0
M_c0_2_rr_l:
    s_waitcnt lgkmcnt(0)
    s_and_b32 s27, s30, 1
    s_cbranch_scc1 M_c0_2_rr_n
    s_waitcnt vmcnt(1)
    s_mov_b32 m0, 8192
    s_nop 0
    buffer_load_dwordx4 v0, s[8:11], s49 offen offset:3072 sc1 lds
M_c0_2_rr_n:
    ds_read_b128 v[36:39], v6 offset:8192
    ds_read_b128 v[40:43], v6 offset:9216
    ds_read_b128 v[44:47], v6 offset:10240
    ds_read_b128 v[48:51], v6 offset:11264
    ds_read_b32 v11, v6 offset:12288
    s_waitcnt lgkmcnt(2)
    v_max3_u32 v10, v36, v40, v44
    s_waitcnt lgkmcnt(0)
    v_max3_u32 v10, v10, v48, v11
    v_cmp_eq_u32 vcc, -1, v10
    s_cbranch_vccz M_c0_2_rr_d
    s_add_u32 s30, s30, 1
    s_cmp_ge_u32 s30, 480000
    s_cbranch_scc1 M_fail
    s_branch M_c0_2_rr_l
M_c0_2_rr_d:
    s_branch M_c0_2_rr_r
M_c0_2_first:
    s_barrier
    s_and_b32 s26, s44, 63
    s_lshl_b32 s26, s26, 18
    s_add_u32 s26, s26, s50
    s_add_u32 s26, s26, 4096
    s_add_u32 s3, s26, 16777216
    s_mov_b32 m0, 4096
    s_nop 0
    buffer_load_dwordx4 v0, s[8:11], s26 offen offset:0 sc1 lds
    buffer_load_dwordx4 v0, s[8:11], s26 offen offset:1024 sc1 lds
    buffer_load_dwordx4 v[80:83], v0, s[8:11], s3 offen offset:0 sc1
    buffer_load_dwordx4 v[84:87], v0, s[8:11], s3 offen offset:1024 sc1
    s_and_b32 s26, s44, 63
    s_add_u32 s26, s26, 1
    s_min_u32 s26, s26, 63
    s_lshl_b32 s26, s26, 18
    s_add_u32 s26, s26, s50
    s_add_u32 s26, s26, 4096
    s_add_u32 s3, s26, 16777216
    s_waitcnt vmcnt(0) lgkmcnt(0)
    s_barrier
    s_branch M_c0_2_first_r
M_c0_2_first2:
    s_barrier
    s_branch M_c0_2_first2_r
M_c0_3_layer:
    s_lshr_b32 s27, s44, 6
    s_mul_i32 s50, s27, 33554432
    s_lshl_b32 s27, s22, 13
    s_add_u32 s50, s50, s27
    s_add_u32 s50, s50, 37748736
    s_barrier
    s_mov_b32 s26, 0x10010000
    s_mov_b32 s3, s26
    s_mul_i32 s27, s20, 5120
    s_add_u32 s48, s27, 167772160
    s_sub_u32 s49, 167777280, s27
    s_mov_b32 m0, 13312
    s_nop 0
    buffer_load_dwordx4 v0, s[8:11], s48 offen offset:3072 sc1 lds
    s_mov_b32 m0, 17408
    s_add_u32 s59, s48, 4096
    buffer_load_dwordx4 v0, s[8:11], s59 offen offset:0 sc1 lds
    s_and_b32 s55, s44, 3
    s_mul_i32 s55, s55, 167936
    s_add_u32 s55, s55, s34
    s_add_u32 s58, s55, s35
    s_and_b32 s57, s44, 63
    s_sub_u32 s61, s26, 6144
    ds_read_b128 v[56:59], v5 offset:0
    ds_read_b128 v[60:63], v5 offset:1024
    ds_read_b128 v[64:67], v5 offset:2048
    ds_read_b128 v[68:71], v5 offset:3072
    v_mov_b64 v[12:13], 0
    v_mov_b64 v[14:15], 0
    v_mov_b64 v[16:17], 0
    v_mov_b64 v[18:19], 0
    v_mov_b64 v[20:21], 0
    v_mov_b64 v[22:23], 0
    v_mov_b64 v[24:25], 0
    v_mov_b64 v[26:27], 0
    v_mov_b64 v[28:29], 0
    v_mov_b64 v[30:31], 0
    v_mov_b64 v[32:33], 0
    v_mov_b64 v[34:35], 0
    s_mov_b32 s70, 0
    s_waitcnt vmcnt(0) lgkmcnt(0)
M_c0_3_top:
    s_waitcnt vmcnt(4)
    s_barrier
    ds_read_b128 v[36:39], v6 offset:13312
    ds_read_b128 v[40:43], v6 offset:14336
    s_mov_b32 m0, 12288
    s_add_u32 s59, s49, 4096
    buffer_load_dwordx4 v0, s[8:11], s59 offen offset:0 sc1 lds
M_c0_3_lr_r:
    s_waitcnt lgkmcnt(1)
    v_smfmac_f32_16x16x64_bf16 v[20:23], v[36:39], v[56:63], v1
    ds_read_b128 v[56:59], v5 offset:4096
    v_smfmac_f32_16x16x64_bf16 v[24:27], v[36:39], v[64:71], v1
    ds_read_b128 v[60:63], v5 offset:5120
    v_smfmac_f32_16x16x64_bf16 v[28:31], v[36:39], a[248:255], v1
    ds_read_b128 v[64:67], v5 offset:6144
    v_smfmac_f32_16x16x64_bf16 v[32:35], v[36:39], a[240:247], v1
    ds_read_b128 v[68:71], v5 offset:7168
    v_smfmac_f32_16x16x64_bf16 v[12:15], v[36:39], a[232:239], v1
    ds_read_b128 v[44:47], v6 offset:15360
    s_waitcnt lgkmcnt(3)
    v_smfmac_f32_16x16x64_bf16 v[16:19], v[36:39], v[56:63], v1
    ds_read_b128 v[56:59], v5 offset:8192
    v_smfmac_f32_16x16x64_bf16 v[20:23], v[40:43], a[224:231], v1
    ds_read_b128 v[60:63], v5 offset:9216
    v_smfmac_f32_16x16x64_bf16 v[24:27], v[40:43], a[216:223], v1
    ds_read_b128 v[48:51], v6 offset:16384
    s_waitcnt lgkmcnt(4)
    v_smfmac_f32_16x16x64_bf16 v[28:31], v[40:43], v[64:71], v1
    ds_read_b128 v[64:67], v5 offset:10240
    v_smfmac_f32_16x16x64_bf16 v[32:35], v[40:43], a[208:215], v1
    ds_read_b128 v[68:71], v5 offset:11264
    v_smfmac_f32_16x16x64_bf16 v[12:15], v[40:43], a[200:207], v1
    ds_read_b128 v[52:55], v6 offset:17408
    s_waitcnt lgkmcnt(6)
    s_waitcnt lgkmcnt(4)
    v_max3_u32 v10, v36, v40, v44
    v_smfmac_f32_16x16x64_bf16 v[16:19], v[40:43], v[56:63], v1
    ds_read_b128 v[56:59], v5 offset:12288
    s_waitcnt lgkmcnt(1)
    v_max3_u32 v10, v10, v48, v52
    v_smfmac_f32_16x16x64_bf16 v[20:23], v[44:47], a[192:199], v1
    ds_read_b128 v[60:63], v5 offset:13312
    v_cmp_eq_u32 vcc, -1, v10
    v_smfmac_f32_16x16x64_bf16 v[24:27], v[44:47], a[184:191], v1
    s_cbranch_vccnz M_c0_3_lr
    v_smfmac_f32_16x16x64_bf16 v[28:31], v[44:47], v[64:71], v1
    ds_read_b128 v[64:67], v5 offset:14336
    v_smfmac_f32_16x16x64_bf16 v[32:35], v[44:47], a[176:183], v1
    ds_read_b128 v[68:71], v5 offset:15360
    v_smfmac_f32_16x16x64_bf16 v[20:23], v[48:51], a[168:175], v1
    s_waitcnt lgkmcnt(2)
    v_smfmac_f32_16x16x64_bf16 v[24:27], v[48:51], v[56:63], v1
    ds_read_b128 v[56:59], v5 offset:16384
    v_smfmac_f32_16x16x64_bf16 v[28:31], v[48:51], a[160:167], v1
    ds_read_b128 v[60:63], v5 offset:17408
    v_smfmac_f32_16x16x64_bf16 v[32:35], v[48:51], a[152:159], v1
    s_waitcnt vmcnt(0)
    s_barrier
    ds_read_b128 v[36:39], v6 offset:8192
    ds_read_b128 v[40:43], v6 offset:9216
    s_waitcnt lgkmcnt(4)
    v_smfmac_f32_16x16x64_bf16 v[20:23], v[52:55], v[64:71], v1
    ds_read_b128 v[44:47], v6 offset:10240
    ds_read_b128 v[48:51], v6 offset:11264
    v_smfmac_f32_16x16x64_bf16 v[24:27], v[52:55], a[144:151], v1
    ds_read_b32 v11, v6 offset:12288
    ds_read_b128 v[64:67], v5 offset:18432
    v_smfmac_f32_16x16x64_bf16 v[28:31], v[52:55], a[136:143], v1
    ds_read_b128 v[68:71], v5 offset:19456
    s_waitcnt lgkmcnt(4)
    v_max3_u32 v10, v36, v40, v44
    v_smfmac_f32_16x16x64_bf16 v[32:35], v[52:55], v[56:63], v1
    s_waitcnt lgkmcnt(2)
    v_max3_u32 v10, v10, v48, v11
    v_cmp_eq_u32 vcc, -1, v10
    s_cbranch_vccnz M_c0_3_rr
M_c0_3_rr_r:
    s_mov_b32 m0, 23040
    ds_read_b128 v[52:55], v6 offset:12288
    buffer_store_dwordx4 v[76:79], v0, s[8:11], s4 offen offset:3072 sc1
    s_mov_b32 s4, 0x10000000
    buffer_load_dword v9, s[8:11], s61 offen sc1 lds
    v_smfmac_f32_16x16x64_bf16 v[20:23], v[36:39], a[128:135], v1
    ds_read_b128 v[56:59], v5 offset:20480
    v_smfmac_f32_16x16x64_bf16 v[24:27], v[36:39], a[120:127], v1
    ds_read_b128 v[60:63], v5 offset:21504
    s_waitcnt lgkmcnt(3)
    v_smfmac_f32_16x16x64_bf16 v[20:23], v[40:43], v[64:71], v1
    ds_read_b128 v[64:67], v5 offset:22528
    v_smfmac_f32_16x16x64_bf16 v[24:27], v[40:43], a[112:119], v1
    ds_read_b128 v[68:71], v5 offset:23552
    v_smfmac_f32_16x16x64_bf16 v[20:23], v[44:47], a[104:111], v1
    s_waitcnt lgkmcnt(2)
    v_smfmac_f32_16x16x64_bf16 v[24:27], v[44:47], v[56:63], v1
    ds_read_b128 v[56:59], v5 offset:24576
    v_smfmac_f32_16x16x64_bf16 v[20:23], v[48:51], a[96:103], v1
    ds_read_b128 v[60:63], v5 offset:25600
    v_smfmac_f32_16x16x64_bf16 v[24:27], v[48:51], a[88:95], v1
    s_waitcnt lgkmcnt(2)
    v_smfmac_f32_16x16x64_bf16 v[20:23], v[52:55], v[64:71], v1
    ds_read_b128 v[64:67], v5 offset:26624
    v_smfmac_f32_16x16x64_bf16 v[24:27], v[52:55], a[80:87], v1
    ds_read_b128 v[68:71], v5 offset:27648
    v_smfmac_f32_16x16x64_bf16 v[28:31], v[36:39], a[72:79], v1
    s_waitcnt lgkmcnt(2)
    v_smfmac_f32_16x16x64_bf16 v[32:35], v[36:39], v[56:63], v1
    ds_read_b128 v[56:59], v5 offset:28672
    s_nop 0
    v_permlane32_swap_b32 v20, v21
    v_smfmac_f32_16x16x64_bf16 v[28:31], v[40:43], a[64:71], v1
    ds_read_b128 v[60:63], v5 offset:29696
    v_permlane32_swap_b32 v22, v23
    v_smfmac_f32_16x16x64_bf16 v[32:35], v[40:43], a[56:63], v1
    s_waitcnt lgkmcnt(2)
    v_permlane32_swap_b32 v24, v25
    v_smfmac_f32_16x16x64_bf16 v[28:31], v[44:47], v[64:71], v1
    ds_read_b128 v[64:67], v5 offset:30720
    v_permlane32_swap_b32 v26, v27
    v_smfmac_f32_16x16x64_bf16 v[32:35], v[44:47], a[48:55], v1
    ds_read_b128 v[68:71], v5 offset:31744
    v_add_f32 v20, v20, v21
    v_add_f32 v22, v22, v23
    v_smfmac_f32_16x16x64_bf16 v[28:31], v[48:51], a[40:47], v1
    s_waitcnt lgkmcnt(2)
    v_add_f32 v24, v24, v25
    v_add_f32 v26, v26, v27
    v_smfmac_f32_16x16x64_bf16 v[32:35], v[48:51], v[56:63], v1
    ds_read_b128 v[56:59], v5 offset:32768
    v_mul_f32 v20, s40, v20
    v_mul_f32 v24, s40, v24
    v_smfmac_f32_16x16x64_bf16 v[28:31], v[52:55], a[32:39], v1
    ds_read_b128 v[60:63], v5 offset:33792
    v_mul_f32 v22, s40, v22
    v_mul_f32 v26, s40, v26
    v_smfmac_f32_16x16x64_bf16 v[32:35], v[52:55], a[24:31], v1
    s_waitcnt lgkmcnt(2)
    v_cvt_pk_bf16_f32 v20, v20, v24
    v_cvt_pk_bf16_f32 v21, v22, v26
    v_smfmac_f32_16x16x64_bf16 v[12:15], v[36:39], v[64:71], v1
    s_cmp_eq_u32 s57, 0
    s_cbranch_scc1 M_c0_3_first
M_c0_3_first_r:
    ds_write_b32 v2, v20 offset:18432
    v_smfmac_f32_16x16x64_bf16 v[16:19], v[36:39], a[16:23], v1
    ds_write_b32 v2, v21 offset:19008
    v_permlane32_swap_b32 v28, v29
    v_smfmac_f32_16x16x64_bf16 v[12:15], v[40:43], a[8:15], v1
    ds_read_b128 v[36:39], v6 offset:15360
    s_waitcnt lgkmcnt(3)
    v_permlane32_swap_b32 v30, v31
    v_smfmac_f32_16x16x64_bf16 v[16:19], v[40:43], v[56:63], v1
    ds_read_b128 v[64:67], v0 offset:2048
    v_permlane32_swap_b32 v32, v33
    v_smfmac_f32_16x16x64_bf16 v[12:15], v[44:47], a[0:7], v1
    ds_read_b128 v[68:71], v0 offset:3072
    v_permlane32_swap_b32 v34, v35
    v_smfmac_f32_16x16x64_bf16 v[16:19], v[44:47], v[248:255], v1
    s_waitcnt lgkmcnt(3)
    s_barrier
    ds_read_b128 v[40:43], v6 offset:16384
    v_add_f32 v28, v28, v29
    v_add_f32 v30, v30, v31
    v_smfmac_f32_16x16x64_bf16 v[12:15], v[48:51], v[240:247], v1
    ds_read_b128 v[56:59], v0 offset:0
    v_add_f32 v32, v32, v33
    v_add_f32 v34, v34, v35
    v_smfmac_f32_16x16x64_bf16 v[16:19], v[48:51], v[232:239], v1
    ds_read_b128 v[60:63], v0 offset:1024
    v_cvt_pk_bf16_f32 v28, v28, v32
    v_cvt_pk_bf16_f32 v29, v30, v34
    v_smfmac_f32_16x16x64_bf16 v[12:15], v[52:55], v[224:231], v1
    ds_write_b32 v2, v28 offset:20736
    ds_read_b128 v[20:23], v3 offset:18432
    v_smfmac_f32_16x16x64_bf16 v[16:19], v[52:55], v[216:223], v1
    ds_write_b32 v2, v29 offset:21312
    ds_read_b128 v[24:27], v3 offset:18496
    s_waitcnt lgkmcnt(9)
    v_smfmac_f32_16x16x64_bf16 v[12:15], v[36:39], v[208:215], v1
    ds_read_b128 v[72:75], v3 offset:18560
    ds_read_b128 v[44:47], v3 offset:18624
    v_smfmac_f32_16x16x64_bf16 v[16:19], v[36:39], v[200:207], v1
    ds_read_b128 v[48:51], v6 offset:17408
    s_waitcnt lgkmcnt(9)
    v_smfmac_f32_16x16x64_bf16 v[12:15], v[40:43], v[192:199], v1
    v_smfmac_f32_16x16x64_bf16 v[16:19], v[40:43], v[184:191], v1
    s_waitcnt lgkmcnt(5)
    v_mfma_f32_16x16x32_bf16 v[28:31], v[56:59], v[20:23], 0
    ds_read_b128 v[56:59], v0 offset:4096
    s_waitcnt lgkmcnt(4)
    v_mov_b64 v[52:53], s[24:25]
    v_mfma_f32_16x16x32_bf16 v[28:31], v[60:63], v[24:27], v[28:31]
    ds_read_b128 v[60:63], v0 offset:5120
    s_barrier
    s_waitcnt lgkmcnt(4)
    v_mfma_f32_16x16x32_bf16 v[28:31], v[64:67], v[72:75], v[28:31]
    ds_read_b128 v[64:67], v0 offset:6144
    s_waitcnt lgkmcnt(4)
    v_mov_b64 v[54:55], s[24:25]
    v_mfma_f32_16x16x32_bf16 v[28:31], v[68:71], v[44:47], v[28:31]
    ds_read_b128 v[68:71], v0 offset:7168
    s_waitcnt lgkmcnt(4)
    v_mov_b64 v[10:11], s[16:17]
    v_smfmac_f32_16x16x64_bf16 v[12:15], v[48:51], v[176:183], v1
    ds_read_b128 v[36:39], v3 offset:20736
    v_smfmac_f32_16x16x64_bf16 v[16:19], v[48:51], v[168:175], v1
    ds_read_b128 v[40:43], v3 offset:20800
    s_waitcnt lgkmcnt(4)
    v_mfma_f32_16x16x32_bf16 v[32:35], v[56:59], v[20:23], 0
    v_exp_f32 v28, v28
    v_mfma_f32_16x16x32_bf16 v[32:35], v[60:63], v[24:27], v[32:35]
    s_waitcnt lgkmcnt(2)
    v_exp_f32 v29, v29
    ds_read_b128 v[56:59], v3 offset:20864
    v_mfma_f32_16x16x32_bf16 v[32:35], v[64:67], v[72:75], v[32:35]
    v_exp_f32 v30, v30
    ds_read_b128 v[60:63], v3 offset:20928
    v_mfma_f32_16x16x32_bf16 v[32:35], v[68:71], v[44:47], v[32:35]
    s_waitcnt lgkmcnt(3)
    v_exp_f32 v31, v31
    v_mfma_f32_16x16x32_bf16 v[48:51], v[36:39], v[20:23], 0
    s_waitcnt lgkmcnt(2)
    v_cvt_pk_bf16_f32 v28, v28, v29
    v_cvt_pk_bf16_f32 v29, v30, v31
    v_mfma_f32_16x16x32_bf16 v[48:51], v[40:43], v[24:27], v[48:51]
    s_waitcnt lgkmcnt(1)
    v_cvt_pk_bf16_f32 v12, v12, v13
    v_cvt_pk_bf16_f32 v13, v14, v15
    v_mfma_f32_16x16x32_bf16 v[48:51], v[56:59], v[72:75], v[48:51]
    s_waitcnt lgkmcnt(0)
    v_exp_f32 v32, v32
    v_mfma_f32_16x16x32_bf16 v[48:51], v[60:63], v[44:47], v[48:51]
    v_exp_f32 v33, v33
    v_exp_f32 v34, v34
    v_exp_f32 v35, v35
    v_cvt_pk_bf16_f32 v30, v32, v33
    v_cvt_pk_bf16_f32 v31, v34, v35
    v_cvt_pk_bf16_f32 v14, v16, v17
    v_cvt_pk_bf16_f32 v15, v18, v19
    v_mfma_f32_16x16x32_bf16 v[72:75], v[52:55], v[28:31], 0
    v_exp_f32 v48, v48
    v_mfma_f32_16x16x32_bf16 v[20:23], v[80:83], v[28:31], 0
    v_exp_f32 v49, v49
    v_mfma_f32_16x16x32_bf16 v[24:27], v[84:87], v[28:31], 0
    v_exp_f32 v50, v50
    v_exp_f32 v51, v51
    v_cvt_pk_bf16_f32 v48, v48, v49
    v_cvt_pk_bf16_f32 v49, v50, v51
    v_cndmask_b32_e64 v76, v12, v60, s[66:67]
    v_cndmask_b32_e64 v77, v13, v61, s[66:67]
M_c0_3_fin:
    v_mfma_f32_16x16x16_bf16 v[72:75], v[10:11], v[48:49], v[72:75]
    v_cndmask_b32_e64 v78, v14, v62, s[66:67]
    v_cndmask_b32_e64 v79, v15, v63, s[66:67]
    v_mfma_f32_16x16x16_bf16 v[20:23], v[12:13], v[48:49], v[20:23]
    s_cmp_eq_u32 s57, 63
    v_mov_b64 v[44:45], 0
    v_mov_b64 v[46:47], 0
    v_mfma_f32_16x16x16_bf16 v[24:27], v[14:15], v[48:49], v[24:27]
    s_cbranch_scc1 M_c0_3_last
    v_mov_b64 v[68:69], 0
    v_rcp_f32 v74, v72
    v_subrev_u32 v73, s68, v72
    v_cmp_lt_u32 vcc, s69, v73
    v_mov_b64 v[70:71], 0
    v_mov_b32 v5, v5
    v_mov_b32 v5, v5
    v_cndmask_b32_e64 v20, v20, v24, s[18:19]
    v_cndmask_b32_e64 v21, v21, v25, s[18:19]
    v_cndmask_b32_e64 v22, v22, v26, s[18:19]
    v_cndmask_b32_e64 v23, v23, v27, s[18:19]
    v_pk_mul_f32 v[20:21], v[20:21], v[74:75] op_sel_hi:[1,0]
    v_pk_mul_f32 v[22:23], v[22:23], v[74:75] op_sel_hi:[1,0]
    v_cvt_pk_bf16_f32 v20, v20, v21
    v_cvt_pk_bf16_f32 v21, v22, v23
    ds_write_b64 v0, v[20:21] offset:14344
    s_cbranch_vccnz M_c0_3_zbad
M_c0_3_zok:
    s_cmp_eq_u32 s57, 0
    s_cbranch_scc1 M_c0_3_first2
M_c0_3_first2_r:
    buffer_load_dwordx4 v[80:83], v0, s[8:11], s3 offen offset:0 sc1
    buffer_load_dwordx4 v[84:87], v0, s[8:11], s3 offen offset:1024 sc1
    s_waitcnt lgkmcnt(0)
    s_barrier
    ds_read_b128 v[32:35], v0 offset:13312
    ds_read_b128 v[40:43], v0 offset:14336
    s_mov_b32 m0, 6144
    s_nop 0
    buffer_load_dwordx4 v0, s[8:11], s26 offen offset:0 sc1 lds
    buffer_load_dwordx4 v0, s[8:11], s26 offen offset:1024 sc1 lds
    v_mov_b64 v[64:65], 0
    v_mov_b64 v[66:67], 0
    v_mov_b64 v[60:61], 0
    v_mov_b64 v[62:63], 0
    v_mov_b64 v[56:57], 0
    v_mov_b64 v[58:59], 0
    s_waitcnt lgkmcnt(1)
    s_nop 0
    v_smfmac_f32_16x16x64_bf16 v[56:59], v[32:35], v[160:167], v1
    v_smfmac_f32_16x16x64_bf16 v[60:63], v[32:35], v[144:151], v1
    s_waitcnt lgkmcnt(0)
    v_smfmac_f32_16x16x64_bf16 v[56:59], v[40:43], v[152:159], v1
    v_smfmac_f32_16x16x64_bf16 v[60:63], v[40:43], v[136:143], v1
    v_smfmac_f32_16x16x64_bf16 v[64:67], v[32:35], v[128:135], v1
    v_smfmac_f32_16x16x64_bf16 v[68:71], v[32:35], v[112:119], v1
    v_permlane32_swap_b32 v56, v57
    v_smfmac_f32_16x16x64_bf16 v[64:67], v[40:43], v[120:127], v1
    v_permlane32_swap_b32 v58, v59
    v_smfmac_f32_16x16x64_bf16 v[68:71], v[40:43], v[104:111], v1
    v_add_f32 v56, v56, v57
    v_add_f32 v58, v58, v59
    v_smfmac_f32_16x16x64_bf16 v[44:47], v[32:35], v[96:103], v1
    v_permlane32_swap_b32 v60, v61
    v_smfmac_f32_16x16x64_bf16 v[44:47], v[40:43], v[88:95], v1
    v_permlane32_swap_b32 v62, v63
    v_add_f32 v60, v60, v61
    v_add_f32 v62, v62, v63
    v_cvt_pk_bf16_f32 v36, v56, v60
    v_cvt_pk_bf16_f32 v38, v58, v62
    v_permlane32_swap_b32 v64, v65
    v_permlane32_swap_b32 v66, v67
    v_add_f32 v64, v64, v65
    v_add_f32 v66, v66, v67
    v_permlane32_swap_b32 v68, v69
    v_permlane32_swap_b32 v70, v71
    v_add_f32 v68, v68, v69
    v_add_f32 v70, v70, v71
    v_cvt_pk_bf16_f32 v37, v64, v68
    v_cvt_pk_bf16_f32 v39, v66, v70
    buffer_store_dwordx4 v[36:39], v0, s[8:11], s58 offen
    v_permlane32_swap_b32 v44, v45
    v_permlane32_swap_b32 v46, v47
    v_add_f32 v44, v44, v45
    v_add_f32 v46, v46, v47
    v_cvt_pk_bf16_f32 v44, v44, v46
    buffer_store_dword v44, v7, s[8:11], s55 offen
    s_add_u32 s27, s44, 1
    s_and_b32 s27, s27, 3
    s_mul_i32 s48, s27, 5120
    s_add_u32 s48, s48, s41
    s_lshl_b32 s27, s27, 15
    s_add_u32 s49, s27, s47
    ds_read_b128 v[56:59], v5 offset:0
    ds_read_b128 v[60:63], v5 offset:1024
    ds_read_b128 v[64:67], v5 offset:2048
    ds_read_b128 v[68:71], v5 offset:3072
    v_mov_b64 v[12:13], 0
    v_mov_b64 v[14:15], 0
    v_mov_b64 v[16:17], 0
    v_mov_b64 v[18:19], 0
    v_mov_b64 v[20:21], 0
    v_mov_b64 v[22:23], 0
    v_mov_b64 v[24:25], 0
    v_mov_b64 v[26:27], 0
    v_mov_b64 v[28:29], 0
    v_mov_b64 v[30:31], 0
    v_mov_b64 v[32:33], 0
    v_mov_b64 v[34:35], 0
    s_barrier
    s_and_b32 s26, s44, 63
    s_add_u32 s26, s26, 2
    s_min_u32 s26, s26, 63
    s_lshl_b32 s26, s26, 18
    s_add_u32 s26, s26, s50
    s_add_u32 s26, s26, 6144
    s_add_u32 s3, s26, 16777216
    s_lshl_b32 s4, s44, 18
    s_add_u32 s4, s4, s53
    s_add_u32 s44, s44, 1
    s_and_b32 s55, s44, 3
    s_mul_i32 s55, s55, 167936
    s_add_u32 s55, s55, s34
    s_add_u32 s58, s55, s35
    s_and_b32 s57, s44, 63
    s_sub_u32 s61, s26, 6144
    s_nop 15
    s_nop 15
    s_nop 7
    s_mov_b32 m0, 13312
    s_nop 0
    buffer_load_dwordx4 v0, s[8:11], s48 offen offset:3072 sc1 lds
    s_mov_b32 m0, 17408
    s_add_u32 s59, s48, 4096
    buffer_load_dwordx4 v0, s[8:11], s59 offen offset:0 sc1 lds
    s_nop 11
    s_mov_b32 m0, 13312
    s_nop 0
    buffer_load_dwordx4 v0, s[8:11], s48 offen offset:3072 sc1 lds
    s_mov_b32 m0, 17408
    s_add_u32 s59, s48, 4096
    buffer_load_dwordx4 v0, s[8:11], s59 offen offset:0 sc1 lds
    s_nop 11
    s_mov_b32 m0, 13312
    s_nop 0
    buffer_load_dwordx4 v0, s[8:11], s48 offen offset:3072 sc1 lds
    s_mov_b32 m0, 17408
    s_add_u32 s59, s48, 4096
    buffer_load_dwordx4 v0, s[8:11], s59 offen offset:0 sc1 lds
    s_mov_b32 s70, 0
    s_waitcnt lgkmcnt(0)
    s_branch M_c0_3_top
M_c0_3_restart:
    s_waitcnt vmcnt(0) lgkmcnt(0)
    s_nop 7
    s_barrier
    s_mov_b32 m0, 13312
    s_nop 0
    buffer_load_dwordx4 v0, s[8:11], s48 offen offset:3072 sc1 lds
    s_mov_b32 m0, 17408
    s_add_u32 s59, s48, 4096
    buffer_load_dwordx4 v0, s[8:11], s59 offen offset:0 sc1 lds
    ds_read_b128 v[56:59], v5 offset:0
    ds_read_b128 v[60:63], v5 offset:1024
    ds_read_b128 v[64:67], v5 offset:2048
    ds_read_b128 v[68:71], v5 offset:3072
    v_mov_b64 v[12:13], 0
    v_mov_b64 v[14:15], 0
    v_mov_b64 v[16:17], 0
    v_mov_b64 v[18:19], 0
    v_mov_b64 v[20:21], 0
    v_mov_b64 v[22:23], 0
    v_mov_b64 v[24:25], 0
    v_mov_b64 v[26:27], 0
    v_mov_b64 v[28:29], 0
    v_mov_b64 v[30:31], 0
    v_mov_b64 v[32:33], 0
    v_mov_b64 v[34:35], 0
    s_waitcnt vmcnt(0) lgkmcnt(0)
    s_branch M_c0_3_top
M_c0_3_zbad:
    s_cmp_eq_u32 s70, 2
    s_cbranch_scc1 M_c0_3_zok
    v_cmp_u_f32 vcc, v72, v72
    s_cbranch_vccz M_c0_3_exact
    s_cmp_eq_u32 s70, 1
    s_cbranch_scc1 M_c0_3_exact
M_c0_3_vfy0:
    s_mov_b32 s70, 1
    s_mov_b32 s30, 0
    s_waitcnt vmcnt(0) lgkmcnt(0)
    s_nop 7
M_c0_3_vfy:
    v_mov_b32 v10, 0
    s_add_u32 s59, s48, 4096
    buffer_load_dwordx4 v[36:39], v0, s[8:11], s48 offen offset:0 sc1
    buffer_load_dwordx4 v[40:43], v0, s[8:11], s48 offen offset:1024 sc1
    buffer_load_dwordx4 v[44:47], v0, s[8:11], s48 offen offset:2048 sc1
    buffer_load_dwordx4 v[48:51], v0, s[8:11], s48 offen offset:3072 sc1
    buffer_load_dwordx4 v[52:55], v0, s[8:11], s59 offen offset:0 sc1
    s_waitcnt vmcnt(4)
    v_max3_u32 v10, v10, v36, v37
    v_max3_u32 v10, v10, v38, v39
    s_waitcnt vmcnt(3)
    v_max3_u32 v10, v10, v40, v41
    v_max3_u32 v10, v10, v42, v43
    s_waitcnt vmcnt(2)
    v_max3_u32 v10, v10, v44, v45
    v_max3_u32 v10, v10, v46, v47
    s_waitcnt vmcnt(1)
    v_max3_u32 v10, v10, v48, v49
    v_max3_u32 v10, v10, v50, v51
    s_waitcnt vmcnt(0)
    v_max3_u32 v10, v10, v52, v53
    v_max3_u32 v10, v10, v54, v55
    s_add_u32 s59, s49, 4096
    buffer_load_dwordx4 v[36:39], v0, s[8:11], s49 offen offset:0 sc1
    buffer_load_dwordx4 v[40:43], v0, s[8:11], s49 offen offset:1024 sc1
    buffer_load_dwordx4 v[44:47], v0, s[8:11], s49 offen offset:2048 sc1
    buffer_load_dwordx4 v[48:51], v0, s[8:11], s49 offen offset:3072 sc1
    buffer_load_dwordx4 v[52:55], v0, s[8:11], s59 offen offset:0 sc1
    s_waitcnt vmcnt(4)
    v_max3_u32 v10, v10, v36, v37
    v_max3_u32 v10, v10, v38, v39
    s_waitcnt vmcnt(3)
    v_max3_u32 v10, v10, v40, v41
    v_max3_u32 v10, v10, v42, v43
    s_waitcnt vmcnt(2)
    v_max3_u32 v10, v10, v44, v45
    v_max3_u32 v10, v10, v46, v47
    s_waitcnt vmcnt(1)
    v_max3_u32 v10, v10, v48, v49
    v_max3_u32 v10, v10, v50, v51
    s_waitcnt vmcnt(0)
    v_max3_u32 v10, v10, v52, v53
    v_max3_u32 v10, v10, v54, v55
    v_cmp_eq_u32 vcc, -1, v10
    s_cbranch_vccz M_c0_3_restart
    s_add_u32 s30, s30, 1
    s_cmp_ge_u32 s30, 60000
    s_cbranch_scc1 M_fail
    s_branch M_c0_3_vfy
M_c0_3_exact:
    s_nop 7
    s_mov_b32 s70, 2
    s_waitcnt lgkmcnt(0)
    ds_read_b128 v[20:23], v3 offset:18432
    ds_read_b128 v[24:27], v3 offset:18496
    ds_read_b128 v[72:75], v3 offset:18560
    ds_read_b128 v[44:47], v3 offset:18624
    ds_read_b128 v[56:59], v0 offset:0
    s_waitcnt lgkmcnt(0)
    v_mfma_f32_16x16x32_bf16 v[28:31], v[56:59], v[20:23], 0
    s_nop 3
    ds_read_b128 v[60:63], v0 offset:1024
    s_waitcnt lgkmcnt(0)
    v_mfma_f32_16x16x32_bf16 v[28:31], v[60:63], v[24:27], v[28:31]
    s_nop 3
    ds_read_b128 v[56:59], v0 offset:2048
    s_waitcnt lgkmcnt(0)
    v_mfma_f32_16x16x32_bf16 v[28:31], v[56:59], v[72:75], v[28:31]
    s_nop 3
    ds_read_b128 v[60:63], v0 offset:3072
    s_waitcnt lgkmcnt(0)
    v_mfma_f32_16x16x32_bf16 v[28:31], v[60:63], v[44:47], v[28:31]
    s_nop 3
    ds_read_b128 v[56:59], v0 offset:4096
    s_waitcnt lgkmcnt(0)
    v_mfma_f32_16x16x32_bf16 v[32:35], v[56:59], v[20:23], 0
    s_nop 3
    ds_read_b128 v[60:63], v0 offset:5120
    s_waitcnt lgkmcnt(0)
    v_mfma_f32_16x16x32_bf16 v[32:35], v[60:63], v[24:27], v[32:35]
    s_nop 3
    ds_read_b128 v[56:59], v0 offset:6144
    s_waitcnt lgkmcnt(0)
    v_mfma_f32_16x16x32_bf16 v[32:35], v[56:59], v[72:75], v[32:35]
    s_nop 3
    ds_read_b128 v[60:63], v0 offset:7168
    s_waitcnt lgkmcnt(0)
    v_mfma_f32_16x16x32_bf16 v[32:35], v[60:63], v[44:47], v[32:35]
    s_nop 3
    ds_read_b128 v[56:59], v3 offset:20736
    s_waitcnt lgkmcnt(0)
    v_mfma_f32_16x16x32_bf16 v[48:51], v[56:59], v[20:23], 0
    s_nop 3
    ds_read_b128 v[60:63], v3 offset:20800
    s_waitcnt lgkmcnt(0)
    v_mfma_f32_16x16x32_bf16 v[48:51], v[60:63], v[24:27], v[48:51]
    s_nop 3
    ds_read_b128 v[56:59], v3 offset:20864
    s_waitcnt lgkmcnt(0)
    v_mfma_f32_16x16x32_bf16 v[48:51], v[56:59], v[72:75], v[48:51]
    s_nop 3
    ds_read_b128 v[60:63], v3 offset:20928
    s_waitcnt lgkmcnt(0)
    v_mfma_f32_16x16x32_bf16 v[48:51], v[60:63], v[44:47], v[48:51]
    s_nop 3
    v_max3_f32 v64, v28, v29, v30
    v_max3_f32 v64, v64, v31, v32
    v_max3_f32 v64, v64, v33, v34
    s_nop 0
    v_max3_f32 v64, v64, v35, v48
    v_max3_f32 v64, v64, v49, v50
    v_max_f32 v64, v64, v51
    v_mov_b32 v65, v64
    s_nop 1
    v_permlane16_swap_b32 v64, v65
    v_max_f32 v64, v64, v65
    v_mov_b32 v65, v64
    s_nop 1
    v_permlane32_swap_b32 v64, v65
    v_max_f32 v64, v64, v65
    v_sub_f32 v28, v28, v64
    v_exp_f32 v28, v28
    v_sub_f32 v29, v29, v64
    v_exp_f32 v29, v29
    v_sub_f32 v30, v30, v64
    v_exp_f32 v30, v30
    v_sub_f32 v31, v31, v64
    v_exp_f32 v31, v31
    v_sub_f32 v32, v32, v64
    v_exp_f32 v32, v32
    v_sub_f32 v33, v33, v64
    v_exp_f32 v33, v33
    v_sub_f32 v34, v34, v64
    v_exp_f32 v34, v34
    v_sub_f32 v35, v35, v64
    v_exp_f32 v35, v35
    v_sub_f32 v48, v48, v64
    v_exp_f32 v48, v48
    v_sub_f32 v49, v49, v64
    v_exp_f32 v49, v49
    v_sub_f32 v50, v50, v64
    v_exp_f32 v50, v50
    v_sub_f32 v51, v51, v64
    v_exp_f32 v51, v51
    v_cvt_pk_bf16_f32 v28, v28, v29
    v_cvt_pk_bf16_f32 v29, v30, v31
    v_cvt_pk_bf16_f32 v30, v32, v33
    v_cvt_pk_bf16_f32 v31, v34, v35
    v_cvt_pk_bf16_f32 v48, v48, v49
    v_cvt_pk_bf16_f32 v49, v50, v51
    v_mfma_f32_16x16x32_bf16 v[20:23], v[80:83], v[28:31], 0
    v_mfma_f32_16x16x32_bf16 v[24:27], v[84:87], v[28:31], 0
    v_mfma_f32_16x16x32_bf16 v[72:75], v[52:55], v[28:31], 0
    ds_read_b128 v[60:63], v3 offset:20928
    s_waitcnt lgkmcnt(0)
    s_nop 7
    s_branch M_c0_3_fin
M_c0_3_last:
    s_cmp_lg_u32 s70, 0
    s_cbranch_scc1 M_c0_3_last2
    v_cmp_u_f32 vcc, v32, v32
    s_cbranch_vccnz M_c0_3_vfy0
M_c0_3_last2:
    s_lshl_b32 s4, s44, 18
    s_add_u32 s4, s4, s53
    buffer_store_dwordx4 v[76:79], v0, s[8:11], s4 offen offset:3072 sc1
    s_mov_b32 s4, 0x10000000
    s_waitcnt vmcnt(0) lgkmcnt(0)
    s_barrier
    s_nop 7
    v_mov_b64 v[72:73], -1
    v_mov_b64 v[74:75], -1
    s_add_u32 s28, s44, 3
    s_and_b32 s29, s28, 3
    s_mul_i32 s31, s22, 160
    s_waitcnt vmcnt(0)
    s_add_u32 s44, s44, 1
    s_cmp_eq_u32 s44, 128
    s_cbranch_scc1 M_end
    s_branch M_c0_3_layer
M_c0_3_lr:
    s_mov_b32 s30, 0
M_c0_3_lr_l:
    s_waitcnt lgkmcnt(0)
    s_and_b32 s27, s30, 1
    s_cbranch_scc0 M_c0_3_lr_n
    s_waitcnt vmcnt(2)
    s_mov_b32 m0, 13312
    s_nop 0
    buffer_load_dwordx4 v0, s[8:11], s48 offen offset:3072 sc1 lds
    s_mov_b32 m0, 17408
    s_add_u32 s59, s48, 4096
    buffer_load_dwordx4 v0, s[8:11], s59 offen offset:0 sc1 lds
M_c0_3_lr_n:
    ds_read_b128 v[36:39], v6 offset:13312
    ds_read_b128 v[40:43], v6 offset:14336
    ds_read_b128 v[44:47], v6 offset:15360
    ds_read_b128 v[48:51], v6 offset:16384
    ds_read_b128 v[52:55], v6 offset:17408
    s_waitcnt lgkmcnt(2)
    v_max3_u32 v10, v36, v40, v44
    s_waitcnt lgkmcnt(0)
    v_max3_u32 v10, v10, v48, v52
    v_cmp_eq_u32 vcc, -1, v10
    s_cbranch_vccz M_c0_3_lr_d
    s_add_u32 s30, s30, 1
    s_cmp_ge_u32 s30, 480000
    s_cbranch_scc1 M_fail
    s_branch M_c0_3_lr_l
M_c0_3_lr_d:
    ds_read_b128 v[56:59], v5 offset:0
    ds_read_b128 v[60:63], v5 offset:1024
    ds_read_b128 v[64:67], v5 offset:2048
    ds_read_b128 v[68:71], v5 offset:3072
    v_mov_b64 v[12:13], 0
    v_mov_b64 v[14:15], 0
    v_mov_b64 v[16:17], 0
    v_mov_b64 v[18:19], 0
    v_mov_b64 v[20:21], 0
    v_mov_b64 v[22:23], 0
    v_mov_b64 v[24:25], 0
    v_mov_b64 v[26:27], 0
    v_mov_b64 v[28:29], 0
    v_mov_b64 v[30:31], 0
    v_mov_b64 v[32:33], 0
    v_mov_b64 v[34:35], 0
    s_waitcnt lgkmcnt(0)
    s_branch M_c0_3_lr_r
M_c0_3_rr:
    s_mov_b32 s30, 0
M_c0_3_rr_l:
    s_waitcnt lgkmcnt(0)
    s_and_b32 s27, s30, 1
    s_cbranch_scc1 M_c0_3_rr_n
    s_waitcnt vmcnt(1)
    s_mov_b32 m0, 12288
    s_add_u32 s59, s49, 4096
    buffer_load_dwordx4 v0, s[8:11], s59 offen offset:0 sc1 lds
M_c0_3_rr_n:
    ds_read_b128 v[36:39], v6 offset:8192
    ds_read_b128 v[40:43], v6 offset:9216
    ds_read_b128 v[44:47], v6 offset:10240
    ds_read_b128 v[48:51], v6 offset:11264
    ds_read_b32 v11, v6 offset:12288
    s_waitcnt lgkmcnt(2)
    v_max3_u32 v10, v36, v40, v44
    s_waitcnt lgkmcnt(0)
    v_max3_u32 v10, v10, v48, v11
    v_cmp_eq_u32 vcc, -1, v10
    s_cbranch_vccz M_c0_3_rr_d
    s_add_u32 s30, s30, 1
    s_cmp_ge_u32 s30, 480000
    s_cbranch_scc1 M_fail
    s_branch M_c0_3_rr_l
M_c0_3_rr_d:
    s_branch M_c0_3_rr_r
M_c0_3_first:
    s_barrier
    s_and_b32 s26, s44, 63
    s_lshl_b32 s26, s26, 18
    s_add_u32 s26, s26, s50
    s_add_u32 s26, s26, 6144
    s_add_u32 s3, s26, 16777216
    s_mov_b32 m0, 6144
    s_nop 0
    buffer_load_dwordx4 v0, s[8:11], s26 offen offset:0 sc1 lds
    buffer_load_dwordx4 v0, s[8:11], s26 offen offset:1024 sc1 lds
    buffer_load_dwordx4 v[80:83], v0, s[8:11], s3 offen offset:0 sc1
    buffer_load_dwordx4 v[84:87], v0, s[8:11], s3 offen offset:1024 sc1
    s_and_b32 s26, s44, 63
    s_add_u32 s26, s26, 1
    s_min_u32 s26, s26, 63
    s_lshl_b32 s26, s26, 18
    s_add_u32 s26, s26, s50
    s_add_u32 s26, s26, 6144
    s_add_u32 s3, s26, 16777216
    s_waitcnt vmcnt(0) lgkmcnt(0)
    s_barrier
    s_branch M_c0_3_first_r
M_c0_3_first2:
    s_barrier
    s_branch M_c0_3_first2_r
M_c_slow:
    s_cmp_eq_u32 s21, 1
    s_cbranch_scc1 M_c1_1_layer
    s_cmp_eq_u32 s21, 2
    s_cbranch_scc1 M_c1_2_layer
    s_cmp_eq_u32 s21, 3
    s_cbranch_scc1 M_c1_3_layer
M_c1_0_layer:
    s_lshr_b32 s27, s44, 6
    s_mul_i32 s50, s27, 33554432
    s_lshl_b32 s27, s22, 13
    s_add_u32 s50, s50, s27
    s_add_u32 s50, s50, 37748736
    s_barrier
    s_mov_b32 s26, 0x10010000
    s_mov_b32 s3, s26
    s_mul_i32 s27, s20, 5120
    s_add_u32 s48, s27, 167772160
    s_sub_u32 s49, 167777280, s27
    s_and_b32 s55, s44, 3
    s_mul_i32 s55, s55, 167936
    s_add_u32 s55, s55, s34
    s_add_u32 s58, s55, s35
    s_and_b32 s57, s44, 63
    s_add_u32 s43, s55, s32
    s_add_u32 s61, s43, 33792
    s_add_u32 s100, s43, 67584
    s_add_u32 s101, s43, 101376
    ds_read_b128 v[56:59], v5 offset:0
    ds_read_b128 v[60:63], v5 offset:1024
    ds_read_b128 v[64:67], v5 offset:2048
    ds_read_b128 v[68:71], v5 offset:3072
    v_mov_b64 v[12:13], 0
    v_mov_b64 v[14:15], 0
    v_mov_b64 v[16:17], 0
    v_mov_b64 v[18:19], 0
    v_mov_b64 v[20:21], 0
    v_mov_b64 v[22:23], 0
    v_mov_b64 v[24:25], 0
    v_mov_b64 v[26:27], 0
    v_mov_b64 v[28:29], 0
    v_mov_b64 v[30:31], 0
    v_mov_b64 v[32:33], 0
    v_mov_b64 v[34:35], 0
    s_mov_b32 s70, 0
    s_waitcnt lgkmcnt(0)
M_c1_0_top:
    s_nop 0
    s_barrier
    ds_read_b128 v[36:39], v6 offset:13312
    ds_read_b128 v[40:43], v6 offset:14336
    s_mov_b32 m0, 8192
    s_nop 0
    buffer_load_dwordx4 v0, s[8:11], s49 offen offset:0 sc1 lds
    buffer_load_dwordx4 v0, s[8:11], s49 offen offset:1024 sc1 lds
M_c1_0_lr_r:
    s_waitcnt lgkmcnt(1)
    v_smfmac_f32_16x16x64_bf16 v[20:23], v[36:39], v[56:63], v1
    ds_read_b128 v[56:59], v5 offset:4096
    v_smfmac_f32_16x16x64_bf16 v[24:27], v[36:39], v[64:71], v1
    ds_read_b128 v[60:63], v5 offset:5120
    v_smfmac_f32_16x16x64_bf16 v[28:31], v[36:39], a[248:255], v1
    ds_read_b128 v[64:67], v5 offset:6144
    v_smfmac_f32_16x16x64_bf16 v[32:35], v[36:39], a[240:247], v1
    ds_read_b128 v[68:71], v5 offset:7168
    v_smfmac_f32_16x16x64_bf16 v[12:15], v[36:39], a[232:239], v1
    ds_read_b128 v[44:47], v6 offset:15360
    s_waitcnt lgkmcnt(3)
    v_smfmac_f32_16x16x64_bf16 v[16:19], v[36:39], v[56:63], v1
    ds_read_b128 v[56:59], v5 offset:8192
    v_smfmac_f32_16x16x64_bf16 v[20:23], v[40:43], a[224:231], v1
    ds_read_b128 v[60:63], v5 offset:9216
    v_smfmac_f32_16x16x64_bf16 v[24:27], v[40:43], a[216:223], v1
    ds_read_b128 v[48:51], v6 offset:16384
    s_waitcnt lgkmcnt(4)
    v_smfmac_f32_16x16x64_bf16 v[28:31], v[40:43], v[64:71], v1
    ds_read_b128 v[64:67], v5 offset:10240
    v_smfmac_f32_16x16x64_bf16 v[32:35], v[40:43], a[208:215], v1
    ds_read_b128 v[68:71], v5 offset:11264
    v_smfmac_f32_16x16x64_bf16 v[12:15], v[40:43], a[200:207], v1
    ds_read_b128 v[52:55], v6 offset:17408
    s_waitcnt lgkmcnt(6)
    s_waitcnt lgkmcnt(4)
    v_max3_u32 v10, v36, v40, v44
    v_smfmac_f32_16x16x64_bf16 v[16:19], v[40:43], v[56:63], v1
    ds_read_b128 v[56:59], v5 offset:12288
    s_waitcnt lgkmcnt(1)
    v_max3_u32 v10, v10, v48, v52
    v_smfmac_f32_16x16x64_bf16 v[20:23], v[44:47], a[192:199], v1
    ds_read_b128 v[60:63], v5 offset:13312
    v_cmp_eq_u32 vcc, -1, v10
    v_smfmac_f32_16x16x64_bf16 v[24:27], v[44:47], a[184:191], v1
    s_cbranch_vccnz M_c1_0_lr
    v_smfmac_f32_16x16x64_bf16 v[28:31], v[44:47], v[64:71], v1
    ds_read_b128 v[64:67], v5 offset:14336
    v_smfmac_f32_16x16x64_bf16 v[32:35], v[44:47], a[176:183], v1
    ds_read_b128 v[68:71], v5 offset:15360
    v_smfmac_f32_16x16x64_bf16 v[20:23], v[48:51], a[168:175], v1
    s_waitcnt lgkmcnt(2)
    v_smfmac_f32_16x16x64_bf16 v[24:27], v[48:51], v[56:63], v1
    ds_read_b128 v[56:59], v5 offset:16384
    v_smfmac_f32_16x16x64_bf16 v[28:31], v[48:51], a[160:167], v1
    ds_read_b128 v[60:63], v5 offset:17408
    v_smfmac_f32_16x16x64_bf16 v[32:35], v[48:51], a[152:159], v1
    s_waitcnt vmcnt(0)
    s_barrier
    ds_read_b128 v[36:39], v6 offset:8192
    ds_read_b128 v[40:43], v6 offset:9216
    s_waitcnt lgkmcnt(4)
    v_smfmac_f32_16x16x64_bf16 v[20:23], v[52:55], v[64:71], v1
    ds_read_b128 v[44:47], v6 offset:10240
    ds_read_b128 v[48:51], v6 offset:11264
    v_smfmac_f32_16x16x64_bf16 v[24:27], v[52:55], a[144:151], v1
    ds_read_b32 v11, v6 offset:12288
    ds_read_b128 v[64:67], v5 offset:18432
    v_smfmac_f32_16x16x64_bf16 v[28:31], v[52:55], a[136:143], v1
    ds_read_b128 v[68:71], v5 offset:19456
    s_waitcnt lgkmcnt(4)
    v_max3_u32 v10, v36, v40, v44
    v_smfmac_f32_16x16x64_bf16 v[32:35], v[52:55], v[56:63], v1
    s_waitcnt lgkmcnt(2)
    v_max3_u32 v10, v10, v48, v11
    v_cmp_eq_u32 vcc, -1, v10
    s_cbranch_vccnz M_c1_0_rr
M_c1_0_rr_r:
    ds_read_b128 v[52:55], v6 offset:12288
    buffer_store_dwordx4 v[76:79], v0, s[8:11], s4 offen offset:0 sc1
    s_mov_b32 s4, 0x10000000
    s_mov_b64 exec, 0x3ff
    buffer_store_dwordx4 v[72:75], v0, s[8:11], s60 offen sc1
    s_mov_b64 exec, -1
    s_mov_b32 s60, 0x10000000
    v_smfmac_f32_16x16x64_bf16 v[20:23], v[36:39], a[128:135], v1
    ds_read_b128 v[56:59], v5 offset:20480
    v_smfmac_f32_16x16x64_bf16 v[24:27], v[36:39], a[120:127], v1
    ds_read_b128 v[60:63], v5 offset:21504
    s_waitcnt lgkmcnt(3)
    v_smfmac_f32_16x16x64_bf16 v[20:23], v[40:43], v[64:71], v1
    ds_read_b128 v[64:67], v5 offset:22528
    v_smfmac_f32_16x16x64_bf16 v[24:27], v[40:43], a[112:119], v1
    ds_read_b128 v[68:71], v5 offset:23552
    v_smfmac_f32_16x16x64_bf16 v[20:23], v[44:47], a[104:111], v1
    s_waitcnt lgkmcnt(2)
    v_smfmac_f32_16x16x64_bf16 v[24:27], v[44:47], v[56:63], v1
    ds_read_b128 v[56:59], v5 offset:24576
    v_smfmac_f32_16x16x64_bf16 v[20:23], v[48:51], a[96:103], v1
    ds_read_b128 v[60:63], v5 offset:25600
    v_smfmac_f32_16x16x64_bf16 v[24:27], v[48:51], a[88:95], v1
    s_waitcnt lgkmcnt(2)
    v_smfmac_f32_16x16x64_bf16 v[20:23], v[52:55], v[64:71], v1
    ds_read_b128 v[64:67], v5 offset:26624
    v_smfmac_f32_16x16x64_bf16 v[24:27], v[52:55], a[80:87], v1
    ds_read_b128 v[68:71], v5 offset:27648
    v_smfmac_f32_16x16x64_bf16 v[28:31], v[36:39], a[72:79], v1
    s_waitcnt lgkmcnt(2)
    v_smfmac_f32_16x16x64_bf16 v[32:35], v[36:39], v[56:63], v1
    ds_read_b128 v[56:59], v5 offset:28672
    s_nop 0
    v_permlane32_swap_b32 v20, v21
    v_smfmac_f32_16x16x64_bf16 v[28:31], v[40:43], a[64:71], v1
    ds_read_b128 v[60:63], v5 offset:29696
    v_permlane32_swap_b32 v22, v23
    v_smfmac_f32_16x16x64_bf16 v[32:35], v[40:43], a[56:63], v1
    s_waitcnt lgkmcnt(2)
    v_permlane32_swap_b32 v24, v25
    v_smfmac_f32_16x16x64_bf16 v[28:31], v[44:47], v[64:71], v1
    ds_read_b128 v[64:67], v5 offset:30720
    v_permlane32_swap_b32 v26, v27
    v_smfmac_f32_16x16x64_bf16 v[32:35], v[44:47], a[48:55], v1
    ds_read_b128 v[68:71], v5 offset:31744
    v_add_f32 v20, v20, v21
    v_add_f32 v22, v22, v23
    v_smfmac_f32_16x16x64_bf16 v[28:31], v[48:51], a[40:47], v1
    s_waitcnt lgkmcnt(2)
    v_add_f32 v24, v24, v25
    v_add_f32 v26, v26, v27
    v_smfmac_f32_16x16x64_bf16 v[32:35], v[48:51], v[56:63], v1
    ds_read_b128 v[56:59], v5 offset:32768
    v_mul_f32 v20, s40, v20
    v_mul_f32 v24, s40, v24
    v_smfmac_f32_16x16x64_bf16 v[28:31], v[52:55], a[32:39], v1
    ds_read_b128 v[60:63], v5 offset:33792
    v_mul_f32 v22, s40, v22
    v_mul_f32 v26, s40, v26
    v_smfmac_f32_16x16x64_bf16 v[32:35], v[52:55], a[24:31], v1
    s_waitcnt lgkmcnt(2)
    v_cvt_pk_bf16_f32 v20, v20, v24
    v_cvt_pk_bf16_f32 v21, v22, v26
    v_smfmac_f32_16x16x64_bf16 v[12:15], v[36:39], v[64:71], v1
    s_cmp_eq_u32 s57, 0
    s_cbranch_scc1 M_c1_0_first
M_c1_0_first_r:
    ds_write_b32 v2, v20 offset:18432
    v_smfmac_f32_16x16x64_bf16 v[16:19], v[36:39], a[16:23], v1
    ds_write_b32 v2, v21 offset:19008
    v_permlane32_swap_b32 v28, v29
    v_smfmac_f32_16x16x64_bf16 v[12:15], v[40:43], a[8:15], v1
    ds_read_b128 v[36:39], v6 offset:15360
    s_waitcnt lgkmcnt(3)
    v_permlane32_swap_b32 v30, v31
    v_smfmac_f32_16x16x64_bf16 v[16:19], v[40:43], v[56:63], v1
    ds_read_b128 v[64:67], v0 offset:2048
    v_permlane32_swap_b32 v32, v33
    v_smfmac_f32_16x16x64_bf16 v[12:15], v[44:47], a[0:7], v1
    ds_read_b128 v[68:71], v0 offset:3072
    v_permlane32_swap_b32 v34, v35
    v_smfmac_f32_16x16x64_bf16 v[16:19], v[44:47], v[248:255], v1
    s_waitcnt lgkmcnt(3)
    s_barrier
    ds_read_b128 v[40:43], v6 offset:16384
    v_add_f32 v28, v28, v29
    v_add_f32 v30, v30, v31
    v_smfmac_f32_16x16x64_bf16 v[12:15], v[48:51], v[240:247], v1
    ds_read_b128 v[56:59], v0 offset:0
    v_add_f32 v32, v32, v33
    v_add_f32 v34, v34, v35
    v_smfmac_f32_16x16x64_bf16 v[16:19], v[48:51], v[232:239], v1
    ds_read_b128 v[60:63], v0 offset:1024
    v_cvt_pk_bf16_f32 v28, v28, v32
    v_cvt_pk_bf16_f32 v29, v30, v34
    v_smfmac_f32_16x16x64_bf16 v[12:15], v[52:55], v[224:231], v1
    ds_write_b32 v2, v28 offset:20736
    ds_read_b128 v[20:23], v3 offset:18432
    v_smfmac_f32_16x16x64_bf16 v[16:19], v[52:55], v[216:223], v1
    ds_write_b32 v2, v29 offset:21312
    ds_read_b128 v[24:27], v3 offset:18496
    s_waitcnt lgkmcnt(9)
    v_smfmac_f32_16x16x64_bf16 v[12:15], v[36:39], v[208:215], v1
    ds_read_b128 v[72:75], v3 offset:18560
    ds_read_b128 v[44:47], v3 offset:18624
    v_smfmac_f32_16x16x64_bf16 v[16:19], v[36:39], v[200:207], v1
    ds_read_b128 v[48:51], v6 offset:17408
    s_waitcnt lgkmcnt(9)
    v_smfmac_f32_16x16x64_bf16 v[12:15], v[40:43], v[192:199], v1
    v_smfmac_f32_16x16x64_bf16 v[16:19], v[40:43], v[184:191], v1
    s_waitcnt lgkmcnt(5)
    v_mfma_f32_16x16x32_bf16 v[28:31], v[56:59], v[20:23], 0
    ds_read_b128 v[56:59], v0 offset:4096
    s_waitcnt lgkmcnt(4)
    v_mov_b64 v[52:53], s[24:25]
    v_mfma_f32_16x16x32_bf16 v[28:31], v[60:63], v[24:27], v[28:31]
    ds_read_b128 v[60:63], v0 offset:5120
    s_barrier
    s_waitcnt lgkmcnt(4)
    v_mfma_f32_16x16x32_bf16 v[28:31], v[64:67], v[72:75], v[28:31]
    ds_read_b128 v[64:67], v0 offset:6144
    s_waitcnt lgkmcnt(4)
    v_mov_b64 v[54:55], s[24:25]
    v_mfma_f32_16x16x32_bf16 v[28:31], v[68:71], v[44:47], v[28:31]
    ds_read_b128 v[68:71], v0 offset:7168
    s_waitcnt lgkmcnt(4)
    v_mov_b64 v[10:11], s[16:17]
    v_smfmac_f32_16x16x64_bf16 v[12:15], v[48:51], v[176:183], v1
    ds_read_b128 v[36:39], v3 offset:20736
    v_smfmac_f32_16x16x64_bf16 v[16:19], v[48:51], v[168:175], v1
    ds_read_b128 v[40:43], v3 offset:20800
    s_waitcnt lgkmcnt(4)
    v_mfma_f32_16x16x32_bf16 v[32:35], v[56:59], v[20:23], 0
    v_exp_f32 v28, v28
    v_mfma_f32_16x16x32_bf16 v[32:35], v[60:63], v[24:27], v[32:35]
    s_waitcnt lgkmcnt(2)
    v_exp_f32 v29, v29
    ds_read_b128 v[56:59], v3 offset:20864
    v_mfma_f32_16x16x32_bf16 v[32:35], v[64:67], v[72:75], v[32:35]
    v_exp_f32 v30, v30
    ds_read_b128 v[60:63], v3 offset:20928
    v_mfma_f32_16x16x32_bf16 v[32:35], v[68:71], v[44:47], v[32:35]
    s_waitcnt lgkmcnt(3)
    v_exp_f32 v31, v31
    v_mfma_f32_16x16x32_bf16 v[48:51], v[36:39], v[20:23], 0
    s_waitcnt lgkmcnt(2)
    v_cvt_pk_bf16_f32 v28, v28, v29
    v_cvt_pk_bf16_f32 v29, v30, v31
    v_mfma_f32_16x16x32_bf16 v[48:51], v[40:43], v[24:27], v[48:51]
    s_waitcnt lgkmcnt(1)
    v_cvt_pk_bf16_f32 v12, v12, v13
    v_cvt_pk_bf16_f32 v13, v14, v15
    v_mfma_f32_16x16x32_bf16 v[48:51], v[56:59], v[72:75], v[48:51]
    s_waitcnt lgkmcnt(0)
    v_exp_f32 v32, v32
    v_mfma_f32_16x16x32_bf16 v[48:51], v[60:63], v[44:47], v[48:51]
    v_exp_f32 v33, v33
    v_exp_f32 v34, v34
    v_exp_f32 v35, v35
    v_cvt_pk_bf16_f32 v30, v32, v33
    v_cvt_pk_bf16_f32 v31, v34, v35
    v_cvt_pk_bf16_f32 v14, v16, v17
    v_cvt_pk_bf16_f32 v15, v18, v19
    v_mfma_f32_16x16x32_bf16 v[72:75], v[52:55], v[28:31], 0
    v_exp_f32 v48, v48
    v_mfma_f32_16x16x32_bf16 v[20:23], v[80:83], v[28:31], 0
    v_exp_f32 v49, v49
    v_mfma_f32_16x16x32_bf16 v[24:27], v[84:87], v[28:31], 0
    v_exp_f32 v50, v50
    v_exp_f32 v51, v51
    v_cvt_pk_bf16_f32 v48, v48, v49
    v_cvt_pk_bf16_f32 v49, v50, v51
    v_cndmask_b32_e64 v76, v12, v36, s[66:67]
    v_cndmask_b32_e64 v77, v13, v37, s[66:67]
M_c1_0_fin:
    v_mfma_f32_16x16x16_bf16 v[72:75], v[10:11], v[48:49], v[72:75]
    v_cndmask_b32_e64 v78, v14, v38, s[66:67]
    v_cndmask_b32_e64 v79, v15, v39, s[66:67]
    v_mfma_f32_16x16x16_bf16 v[20:23], v[12:13], v[48:49], v[20:23]
    s_cmp_eq_u32 s57, 63
    v_mov_b64 v[44:45], 0
    v_mov_b64 v[46:47], 0
    v_mfma_f32_16x16x16_bf16 v[24:27], v[14:15], v[48:49], v[24:27]
    s_cbranch_scc1 M_c1_0_last
    v_mov_b64 v[68:69], 0
    v_rcp_f32 v74, v72
    v_subrev_u32 v73, s68, v72
    v_cmp_lt_u32 vcc, s69, v73
    v_mov_b64 v[70:71], 0
    v_mov_b32 v5, v5
    v_mov_b32 v5, v5
    v_cndmask_b32_e64 v20, v20, v24, s[18:19]
    v_cndmask_b32_e64 v21, v21, v25, s[18:19]
    v_cndmask_b32_e64 v22, v22, v26, s[18:19]
    v_cndmask_b32_e64 v23, v23, v27, s[18:19]
    v_pk_mul_f32 v[20:21], v[20:21], v[74:75] op_sel_hi:[1,0]
    v_pk_mul_f32 v[22:23], v[22:23], v[74:75] op_sel_hi:[1,0]
    v_cvt_pk_bf16_f32 v20, v20, v21
    v_cvt_pk_bf16_f32 v21, v22, v23
    ds_write_b64 v0, v[20:21] offset:13312
    s_cbranch_vccnz M_c1_0_zbad
M_c1_0_zok:
    s_cmp_eq_u32 s57, 0
    s_cbranch_scc1 M_c1_0_first2
M_c1_0_first2_r:
    buffer_load_dwordx4 v[80:83], v0, s[8:11], s3 offen offset:0 sc1
    buffer_load_dwordx4 v[84:87], v0, s[8:11], s3 offen offset:1024 sc1
    s_waitcnt lgkmcnt(0)
    s_barrier
    ds_read_b128 v[32:35], v0 offset:13312
    ds_read_b128 v[40:43], v0 offset:14336
    s_mov_b32 m0, 0
    s_nop 0
    buffer_load_dwordx4 v0, s[8:11], s26 offen offset:0 sc1 lds
    buffer_load_dwordx4 v0, s[8:11], s26 offen offset:1024 sc1 lds
    v_mov_b64 v[64:65], 0
    v_mov_b64 v[66:67], 0
    v_mov_b64 v[60:61], 0
    v_mov_b64 v[62:63], 0
    v_mov_b64 v[56:57], 0
    v_mov_b64 v[58:59], 0
    s_waitcnt lgkmcnt(1)
    s_nop 0
    v_smfmac_f32_16x16x64_bf16 v[56:59], v[32:35], v[160:167], v1
    v_smfmac_f32_16x16x64_bf16 v[60:63], v[32:35], v[144:151], v1
    s_waitcnt lgkmcnt(0)
    v_smfmac_f32_16x16x64_bf16 v[56:59], v[40:43], v[152:159], v1
    v_smfmac_f32_16x16x64_bf16 v[60:63], v[40:43], v[136:143], v1
    v_smfmac_f32_16x16x64_bf16 v[64:67], v[32:35], v[128:135], v1
    v_smfmac_f32_16x16x64_bf16 v[68:71], v[32:35], v[112:119], v1
    v_permlane32_swap_b32 v56, v57
    v_smfmac_f32_16x16x64_bf16 v[64:67], v[40:43], v[120:127], v1
    v_permlane32_swap_b32 v58, v59
    v_smfmac_f32_16x16x64_bf16 v[68:71], v[40:43], v[104:111], v1
    v_add_f32 v56, v56, v57
    v_add_f32 v58, v58, v59
    v_smfmac_f32_16x16x64_bf16 v[44:47], v[32:35], v[96:103], v1
    v_permlane32_swap_b32 v60, v61
    v_smfmac_f32_16x16x64_bf16 v[44:47], v[40:43], v[88:95], v1
    v_permlane32_swap_b32 v62, v63
    v_add_f32 v60, v60, v61
    v_add_f32 v62, v62, v63
    v_cvt_pk_bf16_f32 v36, v56, v60
    v_cvt_pk_bf16_f32 v38, v58, v62
    v_permlane32_swap_b32 v64, v65
    v_permlane32_swap_b32 v66, v67
    v_add_f32 v64, v64, v65
    v_add_f32 v66, v66, v67
    v_permlane32_swap_b32 v68, v69
    v_permlane32_swap_b32 v70, v71
    v_add_f32 v68, v68, v69
    v_add_f32 v70, v70, v71
    v_cvt_pk_bf16_f32 v37, v64, v68
    v_cvt_pk_bf16_f32 v39, v66, v70
    buffer_store_dwordx4 v[36:39], v0, s[8:11], s58 offen sc1
    v_permlane32_swap_b32 v44, v45
    v_permlane32_swap_b32 v46, v47
    v_add_f32 v44, v44, v45
    v_add_f32 v46, v46, v47
    v_cvt_pk_bf16_f32 v44, v44, v46
    buffer_store_dword v44, v7, s[8:11], s55 offen sc1
    v_and_b32 v32, 16, v0
    v_bfe_u32 v33, v0, 5, 2
    v_lshlrev_b32_e64 v32, v32, s45
    v_cmp_eq_u32_e64 s[64:65], 0, v33
    v_cmp_eq_u32_e64 vcc, 1, v33
    s_add_u32 s27, s44, 1
    s_and_b32 s27, s27, 3
    v_cndmask_b32_e64 v72, 0, v32, s[64:65]
    v_cndmask_b32_e64 v73, 0, v32, vcc
    v_cmp_eq_u32_e64 s[64:65], 2, v33
    v_cmp_eq_u32_e64 vcc, 3, v33
    s_mul_i32 s48, s27, 5120
    s_add_u32 s48, s48, s41
    v_cndmask_b32_e64 v74, 0, v32, s[64:65]
    v_cndmask_b32_e64 v75, 0, v32, vcc
    s_lshl_b32 s27, s27, 15
    s_add_u32 s49, s27, s47
    v_bfe_u32 v11, v0, 4, 3
    v_lshlrev_b32 v11, 3, v11
    v_lshrrev_b32 v32, 8, v0
    v_lshl_add_u32 v11, v32, 6, v11
    s_add_u32 s56, s27, s46
    s_add_u32 s56, s56, s33
    s_add_u32 s58, s48, s33
    v_mov_b32 v5, v5
    s_nop 1
    v_mov_b32 v5, v5
    s_nop 1
    v_mov_b32 v5, v5
    s_nop 1
    v_mov_b32 v5, v5
    s_nop 1
    v_mov_b32 v5, v5
    s_nop 1
    v_mov_b32 v5, v5
    s_nop 1
    v_mov_b32 v5, v5
    s_nop 1
    v_mov_b32 v5, v5
    s_nop 1
    buffer_load_dwordx4 v[12:15], v8, s[8:11], s43 offen sc1
    buffer_load_dwordx4 v[16:19], v8, s[8:11], s61 offen sc1
    buffer_load_dwordx4 v[20:23], v8, s[8:11], s100 offen sc1
    buffer_load_dwordx4 v[24:27], v8, s[8:11], s101 offen sc1
    v_mov_b32 v5, v5
    s_nop 1
    v_mov_b32 v5, v5
    s_nop 1
    v_mov_b32 v5, v5
    s_nop 1
    v_mov_b32 v5, v5
    s_nop 1
    v_mov_b32 v5, v5
    s_nop 1
    v_mov_b32 v5, v5
    s_nop 1
    v_mov_b32 v5, v5
    s_nop 1
    v_mov_b32 v5, v5
    s_nop 1
    buffer_load_dwordx4 v[40:43], v8, s[8:11], s43 offen sc1
    buffer_load_dwordx4 v[44:47], v8, s[8:11], s61 offen sc1
    buffer_load_dwordx4 v[48:51], v8, s[8:11], s100 offen sc1
    buffer_load_dwordx4 v[52:55], v8, s[8:11], s101 offen sc1
    v_mov_b32 v5, v5
    s_nop 1
    v_mov_b32 v5, v5
    s_nop 1
    v_mov_b32 v5, v5
    v_mov_b32 v5, v5
    s_waitcnt vmcnt(7)
    v_mfma_f32_16x16x32_bf16 v[28:31], v[72:75], v[12:15], 0
    s_waitcnt vmcnt(6)
    v_mfma_f32_16x16x32_bf16 v[28:31], v[72:75], v[16:19], v[28:31]
    s_waitcnt vmcnt(5)
    v_mfma_f32_16x16x32_bf16 v[28:31], v[72:75], v[20:23], v[28:31]
    s_waitcnt vmcnt(4)
    v_mfma_f32_16x16x32_bf16 v[28:31], v[72:75], v[24:27], v[28:31]
    v_max3_u32 v32, v12, v16, v20
    v_max_u32 v32, v32, v24
    v_cmp_eq_u32 vcc, -1, v32
    s_cbranch_vccnz M_c1_0_wq1
    v_mov_b32 v5, v5
    v_mov_b32 v5, v5
    v_mov_b32 v5, v5
    v_mov_b32 v5, v5
    v_add_f32_dpp v28, v28, v28 row_ror:8 row_mask:0xf bank_mask:0xf
    v_add_f32_dpp v29, v29, v29 row_ror:8 row_mask:0xf bank_mask:0xf
    v_add_f32_dpp v30, v30, v30 row_ror:8 row_mask:0xf bank_mask:0xf
    v_add_f32_dpp v31, v31, v31 row_ror:8 row_mask:0xf bank_mask:0xf
    v_cmp_u_f32 vcc, v28, v28
    v_cvt_pk_bf16_f32 v28, v28, v29
    v_cvt_pk_bf16_f32 v29, v30, v31
    s_cbranch_vccnz M_c1_0_wrb_e0
    s_mov_b64 exec, s[38:39]
    buffer_store_dwordx2 v[28:29], v11, s[8:11], s58 offen sc1
M_c1_0_wrb_d:
    s_barrier
    buffer_store_dwordx2 v[28:29], v11, s[8:11], s56 offen sc1
M_c1_0_wrb_g:
    s_mov_b64 exec, -1
    s_waitcnt vmcnt(2)
    ds_read_b128 v[56:59], v5 offset:0
    ds_read_b128 v[60:63], v5 offset:1024
    ds_read_b128 v[64:67], v5 offset:2048
    ds_read_b128 v[68:71], v5 offset:3072
    v_mov_b64 v[12:13], 0
    v_mov_b64 v[14:15], 0
    v_mov_b64 v[16:17], 0
    v_mov_b64 v[18:19], 0
    v_mov_b64 v[20:21], 0
    v_mov_b64 v[22:23], 0
    v_mov_b64 v[24:25], 0
    v_mov_b64 v[26:27], 0
    v_mov_b64 v[28:29], 0
    v_mov_b64 v[30:31], 0
    v_mov_b64 v[32:33], 0
    v_mov_b64 v[34:35], 0
    s_and_b32 s26, s44, 63
    s_add_u32 s26, s26, 2
    s_min_u32 s26, s26, 63
    s_lshl_b32 s26, s26, 18
    s_add_u32 s26, s26, s50
    s_add_u32 s3, s26, 16777216
    s_lshl_b32 s4, s44, 18
    s_add_u32 s4, s4, s53
    v_mov_b64 v[72:73], -1
    v_mov_b64 v[74:75], -1
    s_add_u32 s28, s44, 3
    s_and_b32 s29, s28, 3
    s_mul_i32 s31, s22, 160
    s_mul_i32 s28, s29, 167936
    s_add_u32 s28, s28, s34
    s_add_u32 s64, s28, s35
    s_mul_i32 s65, s29, 5120
    s_add_u32 s65, s65, s41
    s_add_u32 s65, s65, s31
    s_lshl_b32 s60, s29, 15
    s_add_u32 s60, s60, s47
    s_add_u32 s60, s60, s31
    s_add_u32 s44, s44, 1
    s_and_b32 s55, s44, 3
    s_mul_i32 s55, s55, 167936
    s_add_u32 s55, s55, s34
    s_add_u32 s58, s55, s35
    s_and_b32 s57, s44, 63
    s_add_u32 s43, s55, s32
    s_add_u32 s61, s43, 33792
    s_add_u32 s100, s43, 67584
    s_add_u32 s101, s43, 101376
    s_nop 15
    s_nop 15
    s_nop 12
    buffer_store_dwordx4 v[72:75], v0, s[8:11], s64 offen offset:0 sc1
    buffer_store_dwordx4 v[72:75], v0, s[8:11], s64 offen offset:1024 sc1
    s_mov_b64 exec, 0x3ff
    buffer_store_dwordx4 v[72:75], v0, s[8:11], s65 offen sc1
    s_mov_b64 exec, -1
    s_mov_b32 s65, 0x10000000
    s_mov_b32 s64, 0x10000000
    s_mov_b32 s70, 0
    s_waitcnt lgkmcnt(0)
    s_branch M_c1_0_top
M_c1_0_restart:
    s_waitcnt vmcnt(0) lgkmcnt(0)
    s_nop 7
    s_barrier
    ds_read_b128 v[56:59], v5 offset:0
    ds_read_b128 v[60:63], v5 offset:1024
    ds_read_b128 v[64:67], v5 offset:2048
    ds_read_b128 v[68:71], v5 offset:3072
    v_mov_b64 v[12:13], 0
    v_mov_b64 v[14:15], 0
    v_mov_b64 v[16:17], 0
    v_mov_b64 v[18:19], 0
    v_mov_b64 v[20:21], 0
    v_mov_b64 v[22:23], 0
    v_mov_b64 v[24:25], 0
    v_mov_b64 v[26:27], 0
    v_mov_b64 v[28:29], 0
    v_mov_b64 v[30:31], 0
    v_mov_b64 v[32:33], 0
    v_mov_b64 v[34:35], 0
    s_waitcnt vmcnt(0) lgkmcnt(0)
    s_branch M_c1_0_top
M_c1_0_zbad:
    s_cmp_eq_u32 s70, 2
    s_cbranch_scc1 M_c1_0_zok
    v_cmp_u_f32 vcc, v72, v72
    s_cbranch_vccz M_c1_0_exact
    s_cmp_eq_u32 s70, 1
    s_cbranch_scc1 M_c1_0_exact
M_c1_0_vfy0:
    s_mov_b32 s70, 1
    s_mov_b32 s30, 0
    s_waitcnt vmcnt(0) lgkmcnt(0)
    s_nop 7
M_c1_0_vfy:
    v_mov_b32 v10, 0
    s_add_u32 s59, s48, 4096
    buffer_load_dwordx4 v[36:39], v0, s[8:11], s48 offen offset:0 sc1
    buffer_load_dwordx4 v[40:43], v0, s[8:11], s48 offen offset:1024 sc1
    buffer_load_dwordx4 v[44:47], v0, s[8:11], s48 offen offset:2048 sc1
    buffer_load_dwordx4 v[48:51], v0, s[8:11], s48 offen offset:3072 sc1
    buffer_load_dwordx4 v[52:55], v0, s[8:11], s59 offen offset:0 sc1
    s_waitcnt vmcnt(4)
    v_max3_u32 v10, v10, v36, v37
    v_max3_u32 v10, v10, v38, v39
    s_waitcnt vmcnt(3)
    v_max3_u32 v10, v10, v40, v41
    v_max3_u32 v10, v10, v42, v43
    s_waitcnt vmcnt(2)
    v_max3_u32 v10, v10, v44, v45
    v_max3_u32 v10, v10, v46, v47
    s_waitcnt vmcnt(1)
    v_max3_u32 v10, v10, v48, v49
    v_max3_u32 v10, v10, v50, v51
    s_waitcnt vmcnt(0)
    v_max3_u32 v10, v10, v52, v53
    v_max3_u32 v10, v10, v54, v55
    s_add_u32 s59, s49, 4096
    buffer_load_dwordx4 v[36:39], v0, s[8:11], s49 offen offset:0 sc1
    buffer_load_dwordx4 v[40:43], v0, s[8:11], s49 offen offset:1024 sc1
    buffer_load_dwordx4 v[44:47], v0, s[8:11], s49 offen offset:2048 sc1
    buffer_load_dwordx4 v[48:51], v0, s[8:11], s49 offen offset:3072 sc1
    buffer_load_dwordx4 v[52:55], v0, s[8:11], s59 offen offset:0 sc1
    s_waitcnt vmcnt(4)
    v_max3_u32 v10, v10, v36, v37
    v_max3_u32 v10, v10, v38, v39
    s_waitcnt vmcnt(3)
    v_max3_u32 v10, v10, v40, v41
    v_max3_u32 v10, v10, v42, v43
    s_waitcnt vmcnt(2)
    v_max3_u32 v10, v10, v44, v45
    v_max3_u32 v10, v10, v46, v47
    s_waitcnt vmcnt(1)
    v_max3_u32 v10, v10, v48, v49
    v_max3_u32 v10, v10, v50, v51
    s_waitcnt vmcnt(0)
    v_max3_u32 v10, v10, v52, v53
    v_max3_u32 v10, v10, v54, v55
    v_cmp_eq_u32 vcc, -1, v10
    s_cbranch_vccz M_c1_0_restart
    s_add_u32 s30, s30, 1
    s_cmp_ge_u32 s30, 60000
    s_cbranch_scc1 M_fail
    s_branch M_c1_0_vfy
M_c1_0_exact:
    s_nop 7
    s_mov_b32 s70, 2
    s_waitcnt lgkmcnt(0)
    ds_read_b128 v[20:23], v3 offset:18432
    ds_read_b128 v[24:27], v3 offset:18496
    ds_read_b128 v[72:75], v3 offset:18560
    ds_read_b128 v[44:47], v3 offset:18624
    ds_read_b128 v[56:59], v0 offset:0
    s_waitcnt lgkmcnt(0)
    v_mfma_f32_16x16x32_bf16 v[28:31], v[56:59], v[20:23], 0
    s_nop 3
    ds_read_b128 v[60:63], v0 offset:1024
    s_waitcnt lgkmcnt(0)
    v_mfma_f32_16x16x32_bf16 v[28:31], v[60:63], v[24:27], v[28:31]
    s_nop 3
    ds_read_b128 v[56:59], v0 offset:2048
    s_waitcnt lgkmcnt(0)
    v_mfma_f32_16x16x32_bf16 v[28:31], v[56:59], v[72:75], v[28:31]
    s_nop 3
    ds_read_b128 v[60:63], v0 offset:3072
    s_waitcnt lgkmcnt(0)
    v_mfma_f32_16x16x32_bf16 v[28:31], v[60:63], v[44:47], v[28:31]
    s_nop 3
    ds_read_b128 v[56:59], v0 offset:4096
    s_waitcnt lgkmcnt(0)
    v_mfma_f32_16x16x32_bf16 v[32:35], v[56:59], v[20:23], 0
    s_nop 3
    ds_read_b128 v[60:63], v0 offset:5120
    s_waitcnt lgkmcnt(0)
    v_mfma_f32_16x16x32_bf16 v[32:35], v[60:63], v[24:27], v[32:35]
    s_nop 3
    ds_read_b128 v[56:59], v0 offset:6144
    s_waitcnt lgkmcnt(0)
    v_mfma_f32_16x16x32_bf16 v[32:35], v[56:59], v[72:75], v[32:35]
    s_nop 3
    ds_read_b128 v[60:63], v0 offset:7168
    s_waitcnt lgkmcnt(0)
    v_mfma_f32_16x16x32_bf16 v[32:35], v[60:63], v[44:47], v[32:35]
    s_nop 3
    ds_read_b128 v[56:59], v3 offset:20736
    s_waitcnt lgkmcnt(0)
    v_mfma_f32_16x16x32_bf16 v[48:51], v[56:59], v[20:23], 0
    s_nop 3
    ds_read_b128 v[60:63], v3 offset:20800
    s_waitcnt lgkmcnt(0)
    v_mfma_f32_16x16x32_bf16 v[48:51], v[60:63], v[24:27], v[48:51]
    s_nop 3
    ds_read_b128 v[56:59], v3 offset:20864
    s_waitcnt lgkmcnt(0)
    v_mfma_f32_16x16x32_bf16 v[48:51], v[56:59], v[72:75], v[48:51]
    s_nop 3
    ds_read_b128 v[60:63], v3 offset:20928
    s_waitcnt lgkmcnt(0)
    v_mfma_f32_16x16x32_bf16 v[48:51], v[60:63], v[44:47], v[48:51]
    s_nop 3
    v_max3_f32 v64, v28, v29, v30
    v_max3_f32 v64, v64, v31, v32
    v_max3_f32 v64, v64, v33, v34
    s_nop 0
    v_max3_f32 v64, v64, v35, v48
    v_max3_f32 v64, v64, v49, v50
    v_max_f32 v64, v64, v51
    v_mov_b32 v65, v64
    s_nop 1
    v_permlane16_swap_b32 v64, v65
    v_max_f32 v64, v64, v65
    v_mov_b32 v65, v64
    s_nop 1
    v_permlane32_swap_b32 v64, v65
    v_max_f32 v64, v64, v65
    v_sub_f32 v28, v28, v64
    v_exp_f32 v28, v28
    v_sub_f32 v29, v29, v64
    v_exp_f32 v29, v29
    v_sub_f32 v30, v30, v64
    v_exp_f32 v30, v30
    v_sub_f32 v31, v31, v64
    v_exp_f32 v31, v31
    v_sub_f32 v32, v32, v64
    v_exp_f32 v32, v32
    v_sub_f32 v33, v33, v64
    v_exp_f32 v33, v33
    v_sub_f32 v34, v34, v64
    v_exp_f32 v34, v34
    v_sub_f32 v35, v35, v64
    v_exp_f32 v35, v35
    v_sub_f32 v48, v48, v64
    v_exp_f32 v48, v48
    v_sub_f32 v49, v49, v64
    v_exp_f32 v49, v49
    v_sub_f32 v50, v50, v64
    v_exp_f32 v50, v50
    v_sub_f32 v51, v51, v64
    v_exp_f32 v51, v51
    v_cvt_pk_bf16_f32 v28, v28, v29
    v_cvt_pk_bf16_f32 v29, v30, v31
    v_cvt_pk_bf16_f32 v30, v32, v33
    v_cvt_pk_bf16_f32 v31, v34, v35
    v_cvt_pk_bf16_f32 v48, v48, v49
    v_cvt_pk_bf16_f32 v49, v50, v51
    v_mfma_f32_16x16x32_bf16 v[20:23], v[80:83], v[28:31], 0
    v_mfma_f32_16x16x32_bf16 v[24:27], v[84:87], v[28:31], 0
    v_mfma_f32_16x16x32_bf16 v[72:75], v[52:55], v[28:31], 0
    ds_read_b128 v[36:39], v3 offset:20736
    s_waitcnt lgkmcnt(0)
    s_nop 7
    s_branch M_c1_0_fin
M_c1_0_last:
    s_cmp_lg_u32 s70, 0
    s_cbranch_scc1 M_c1_0_last2
    v_cmp_u_f32 vcc, v32, v32
    s_cbranch_vccnz M_c1_0_vfy0
M_c1_0_last2:
    s_lshl_b32 s4, s44, 18
    s_add_u32 s4, s4, s53
    buffer_store_dwordx4 v[76:79], v0, s[8:11], s4 offen offset:0 sc1
    s_mov_b32 s4, 0x10000000
    s_waitcnt vmcnt(0) lgkmcnt(0)
    s_barrier
    s_nop 7
    v_mov_b64 v[72:73], -1
    v_mov_b64 v[74:75], -1
    s_add_u32 s28, s44, 3
    s_and_b32 s29, s28, 3
    s_mul_i32 s31, s22, 160
    s_mul_i32 s28, s29, 167936
    s_add_u32 s28, s28, s34
    s_add_u32 s64, s28, s35
    s_mul_i32 s65, s29, 5120
    s_add_u32 s65, s65, s41
    s_add_u32 s65, s65, s31
    s_lshl_b32 s60, s29, 15
    s_add_u32 s60, s60, s47
    s_add_u32 s60, s60, s31
    buffer_store_dwordx4 v[72:75], v0, s[8:11], s64 offen offset:0 sc1
    buffer_store_dwordx4 v[72:75], v0, s[8:11], s64 offen offset:1024 sc1
    s_mov_b64 exec, 0x3ff
    buffer_store_dwordx4 v[72:75], v0, s[8:11], s65 offen sc1
    s_mov_b64 exec, -1
    s_mov_b32 s65, 0x10000000
    s_mov_b32 s64, 0x10000000
    s_mov_b64 exec, 0x3ff
    buffer_store_dwordx4 v[72:75], v0, s[8:11], s60 offen sc1
    s_mov_b64 exec, -1
    s_mov_b32 s60, 0x10000000
    s_waitcnt vmcnt(0)
    s_add_u32 s44, s44, 1
    s_cmp_eq_u32 s44, 128
    s_cbranch_scc1 M_end
    s_branch M_c1_0_layer
M_c1_0_lr:
    s_mov_b32 s30, 0
M_c1_0_lr_l:
    s_waitcnt lgkmcnt(0)
    ds_read_b128 v[36:39], v6 offset:13312
    ds_read_b128 v[40:43], v6 offset:14336
    ds_read_b128 v[44:47], v6 offset:15360
    ds_read_b128 v[48:51], v6 offset:16384
    ds_read_b128 v[52:55], v6 offset:17408
    s_waitcnt lgkmcnt(2)
    v_max3_u32 v10, v36, v40, v44
    s_waitcnt lgkmcnt(0)
    v_max3_u32 v10, v10, v48, v52
    v_cmp_eq_u32 vcc, -1, v10
    s_cbranch_vccz M_c1_0_lr_d
    s_add_u32 s30, s30, 1
    s_cmp_ge_u32 s30, 480000
    s_cbranch_scc1 M_fail
    s_branch M_c1_0_lr_l
M_c1_0_lr_d:
    ds_read_b128 v[56:59], v5 offset:0
    ds_read_b128 v[60:63], v5 offset:1024
    ds_read_b128 v[64:67], v5 offset:2048
    ds_read_b128 v[68:71], v5 offset:3072
    v_mov_b64 v[12:13], 0
    v_mov_b64 v[14:15], 0
    v_mov_b64 v[16:17], 0
    v_mov_b64 v[18:19], 0
    v_mov_b64 v[20:21], 0
    v_mov_b64 v[22:23], 0
    v_mov_b64 v[24:25], 0
    v_mov_b64 v[26:27], 0
    v_mov_b64 v[28:29], 0
    v_mov_b64 v[30:31], 0
    v_mov_b64 v[32:33], 0
    v_mov_b64 v[34:35], 0
    s_waitcnt lgkmcnt(0)
    s_branch M_c1_0_lr_r
M_c1_0_rr:
    s_mov_b32 s30, 0
M_c1_0_rr_l:
    s_waitcnt lgkmcnt(0)
    s_and_b32 s27, s30, 1
    s_cbranch_scc1 M_c1_0_rr_n
    s_waitcnt vmcnt(2)
    s_mov_b32 m0, 8192
    s_nop 0
    buffer_load_dwordx4 v0, s[8:11], s49 offen offset:0 sc1 lds
    buffer_load_dwordx4 v0, s[8:11], s49 offen offset:1024 sc1 lds
M_c1_0_rr_n:
    ds_read_b128 v[36:39], v6 offset:8192
    ds_read_b128 v[40:43], v6 offset:9216
    ds_read_b128 v[44:47], v6 offset:10240
    ds_read_b128 v[48:51], v6 offset:11264
    ds_read_b32 v11, v6 offset:12288
    s_waitcnt lgkmcnt(2)
    v_max3_u32 v10, v36, v40, v44
    s_waitcnt lgkmcnt(0)
    v_max3_u32 v10, v10, v48, v11
    v_cmp_eq_u32 vcc, -1, v10
    s_cbranch_vccz M_c1_0_rr_d
    s_add_u32 s30, s30, 1
    s_cmp_ge_u32 s30, 480000
    s_cbranch_scc1 M_fail
    s_branch M_c1_0_rr_l
M_c1_0_rr_d:
    s_branch M_c1_0_rr_r
M_c1_0_first:
    s_barrier
    s_and_b32 s26, s44, 63
    s_lshl_b32 s26, s26, 18
    s_add_u32 s26, s26, s50
    s_add_u32 s3, s26, 16777216
    s_mov_b32 m0, 0
    s_nop 0
    buffer_load_dwordx4 v0, s[8:11], s26 offen offset:0 sc1 lds
    buffer_load_dwordx4 v0, s[8:11], s26 offen offset:1024 sc1 lds
    buffer_load_dwordx4 v[80:83], v0, s[8:11], s3 offen offset:0 sc1
    buffer_load_dwordx4 v[84:87], v0, s[8:11], s3 offen offset:1024 sc1
    s_and_b32 s26, s44, 63
    s_add_u32 s26, s26, 1
    s_min_u32 s26, s26, 63
    s_lshl_b32 s26, s26, 18
    s_add_u32 s26, s26, s50
    s_add_u32 s3, s26, 16777216
    s_waitcnt vmcnt(0) lgkmcnt(0)
    s_barrier
    s_branch M_c1_0_first_r
M_c1_0_first2:
    s_barrier
    s_branch M_c1_0_first2_r
M_c1_0_wq1:
    buffer_load_dwordx4 v[12:15], v8, s[8:11], s43 offen sc1
    buffer_load_dwordx4 v[16:19], v8, s[8:11], s61 offen sc1
    buffer_load_dwordx4 v[20:23], v8, s[8:11], s100 offen sc1
    buffer_load_dwordx4 v[24:27], v8, s[8:11], s101 offen sc1
    s_waitcnt vmcnt(7)
    v_mfma_f32_16x16x32_bf16 v[28:31], v[72:75], v[40:43], 0
    s_waitcnt vmcnt(6)
    v_mfma_f32_16x16x32_bf16 v[28:31], v[72:75], v[44:47], v[28:31]
    s_waitcnt vmcnt(5)
    v_mfma_f32_16x16x32_bf16 v[28:31], v[72:75], v[48:51], v[28:31]
    s_waitcnt vmcnt(4)
    v_mfma_f32_16x16x32_bf16 v[28:31], v[72:75], v[52:55], v[28:31]
    v_max3_u32 v32, v40, v44, v48
    v_max_u32 v32, v32, v52
    v_cmp_eq_u32 vcc, -1, v32
    s_cbranch_vccnz M_c1_0_wqx
    v_mov_b32 v5, v5
    v_mov_b32 v5, v5
    v_mov_b32 v5, v5
    v_mov_b32 v5, v5
    v_add_f32_dpp v28, v28, v28 row_ror:8 row_mask:0xf bank_mask:0xf
    v_add_f32_dpp v29, v29, v29 row_ror:8 row_mask:0xf bank_mask:0xf
    v_add_f32_dpp v30, v30, v30 row_ror:8 row_mask:0xf bank_mask:0xf
    v_add_f32_dpp v31, v31, v31 row_ror:8 row_mask:0xf bank_mask:0xf
    v_cmp_u_f32 vcc, v28, v28
    v_cvt_pk_bf16_f32 v28, v28, v29
    v_cvt_pk_bf16_f32 v29, v30, v31
    s_cbranch_vccnz M_c1_0_wqe1
    s_mov_b64 exec, s[38:39]
    buffer_store_dwordx2 v[28:29], v11, s[8:11], s58 offen sc1
    s_barrier
    buffer_store_dwordx2 v[28:29], v11, s[8:11], s56 offen sc1
    s_branch M_c1_0_wrb_g
M_c1_0_wqx:
    s_branch M_c1_0_wrb_i1
M_c1_0_wqe1:
    s_waitcnt vmcnt(0)
    buffer_load_dwordx4 v[12:15], v8, s[8:11], s43 offen sc1
    buffer_load_dwordx4 v[16:19], v8, s[8:11], s61 offen sc1
    buffer_load_dwordx4 v[20:23], v8, s[8:11], s100 offen sc1
    buffer_load_dwordx4 v[24:27], v8, s[8:11], s101 offen sc1
    s_branch M_c1_0_wrb_e1
M_c1_0_wrb_l:
    s_waitcnt vmcnt(4)
    v_mfma_f32_16x16x32_bf16 v[28:31], v[72:75], v[12:15], 0
    v_mfma_f32_16x16x32_bf16 v[28:31], v[72:75], v[16:19], v[28:31]
    v_mfma_f32_16x16x32_bf16 v[28:31], v[72:75], v[20:23], v[28:31]
    v_mfma_f32_16x16x32_bf16 v[28:31], v[72:75], v[24:27], v[28:31]
    v_max3_u32 v32, v12, v16, v20
    v_max_u32 v32, v32, v24
    v_cmp_eq_u32 vcc, -1, v32
    s_cbranch_vccz M_c1_0_wrb_x0
M_c1_0_wrb_i0:
    buffer_load_dwordx4 v[12:15], v8, s[8:11], s43 offen sc1
    buffer_load_dwordx4 v[16:19], v8, s[8:11], s61 offen sc1
    buffer_load_dwordx4 v[20:23], v8, s[8:11], s100 offen sc1
    buffer_load_dwordx4 v[24:27], v8, s[8:11], s101 offen sc1
    s_waitcnt vmcnt(4)
    v_mfma_f32_16x16x32_bf16 v[28:31], v[72:75], v[40:43], 0
    v_mfma_f32_16x16x32_bf16 v[28:31], v[72:75], v[44:47], v[28:31]
    v_mfma_f32_16x16x32_bf16 v[28:31], v[72:75], v[48:51], v[28:31]
    v_mfma_f32_16x16x32_bf16 v[28:31], v[72:75], v[52:55], v[28:31]
    v_max3_u32 v32, v40, v44, v48
    v_max_u32 v32, v32, v52
    v_cmp_eq_u32 vcc, -1, v32
    s_cbranch_vccz M_c1_0_wrb_x1
M_c1_0_wrb_i1:
    buffer_load_dwordx4 v[40:43], v8, s[8:11], s43 offen sc1
    buffer_load_dwordx4 v[44:47], v8, s[8:11], s61 offen sc1
    buffer_load_dwordx4 v[48:51], v8, s[8:11], s100 offen sc1
    buffer_load_dwordx4 v[52:55], v8, s[8:11], s101 offen sc1
    s_add_u32 s71, s71, 1
    s_cmp_lt_u32 s71, 240000
    s_cbranch_scc1 M_c1_0_wrb_l
    s_branch M_fail
M_c1_0_wrb_x0:
    s_nop 3
    v_add_f32_dpp v28, v28, v28 row_ror:8 row_mask:0xf bank_mask:0xf
    v_add_f32_dpp v29, v29, v29 row_ror:8 row_mask:0xf bank_mask:0xf
    v_add_f32_dpp v30, v30, v30 row_ror:8 row_mask:0xf bank_mask:0xf
    v_add_f32_dpp v31, v31, v31 row_ror:8 row_mask:0xf bank_mask:0xf
    v_cmp_u_f32 vcc, v28, v28
    v_cvt_pk_bf16_f32 v28, v28, v29
    v_cvt_pk_bf16_f32 v29, v30, v31
    s_cbranch_vccz M_c1_0_wrb_n
M_c1_0_wrb_e0:
    v_max3_u32 v32, v12, v13, v14
    v_max3_u32 v32, v32, v15, v16
    v_max3_u32 v32, v32, v17, v18
    v_max3_u32 v32, v32, v19, v20
    v_max3_u32 v32, v32, v21, v22
    v_max3_u32 v32, v32, v23, v24
    v_max3_u32 v32, v32, v25, v26
    v_max_u32 v32, v32, v27
    v_cmp_eq_u32 vcc, -1, v32
    s_cbranch_vccnz M_c1_0_wrb_i0
    v_min_u32 v28, -2, v28
    v_min_u32 v29, -2, v29
    s_branch M_c1_0_wrb_n
M_c1_0_wrb_x1:
    s_nop 3
    v_add_f32_dpp v28, v28, v28 row_ror:8 row_mask:0xf bank_mask:0xf
    v_add_f32_dpp v29, v29, v29 row_ror:8 row_mask:0xf bank_mask:0xf
    v_add_f32_dpp v30, v30, v30 row_ror:8 row_mask:0xf bank_mask:0xf
    v_add_f32_dpp v31, v31, v31 row_ror:8 row_mask:0xf bank_mask:0xf
    v_cmp_u_f32 vcc, v28, v28
    v_cvt_pk_bf16_f32 v28, v28, v29
    v_cvt_pk_bf16_f32 v29, v30, v31
    s_cbranch_vccz M_c1_0_wrb_n
M_c1_0_wrb_e1:
    v_max3_u32 v32, v40, v41, v42
    v_max3_u32 v32, v32, v43, v44
    v_max3_u32 v32, v32, v45, v46
    v_max3_u32 v32, v32, v47, v48
    v_max3_u32 v32, v32, v49, v50
    v_max3_u32 v32, v32, v51, v52
    v_max3_u32 v32, v32, v53, v54
    v_max_u32 v32, v32, v55
    v_cmp_eq_u32 vcc, -1, v32
    s_cbranch_vccnz M_c1_0_wrb_i1
    v_min_u32 v28, -2, v28
    v_min_u32 v29, -2, v29
M_c1_0_wrb_n:
    s_mov_b64 exec, s[38:39]
    buffer_store_dwordx2 v[28:29], v11, s[8:11], s58 offen sc1
    s_branch M_c1_0_wrb_d
M_c1_1_layer:
    s_lshr_b32 s27, s44, 6
    s_mul_i32 s50, s27, 33554432
    s_lshl_b32 s27, s22, 13
    s_add_u32 s50, s50, s27
    s_add_u32 s50, s50, 37748736
    s_barrier
    s_mov_b32 s26, 0x10010000
    s_mov_b32 s3, s26
    s_mul_i32 s27, s20, 5120
    s_add_u32 s48, s27, 167772160
    s_sub_u32 s49, 167777280, s27
    s_and_b32 s55, s44, 3
    s_mul_i32 s55, s55, 167936
    s_add_u32 s55, s55, s34
    s_add_u32 s58, s55, s35
    s_and_b32 s57, s44, 63
    s_add_u32 s43, s55, s32
    s_sub_u32 s27, s57, 1
    s_max_i32 s27, s27, 0
    s_lshl_b64 s[100:101], 1, s27
    s_lshl_b32 s27, s27, 7
    s_sub_u32 s61, s52, s27
    ds_read_b128 v[56:59], v5 offset:0
    ds_read_b128 v[60:63], v5 offset:1024
    ds_read_b128 v[64:67], v5 offset:2048
    ds_read_b128 v[68:71], v5 offset:3072
    v_mov_b64 v[12:13], 0
    v_mov_b64 v[14:15], 0
    v_mov_b64 v[16:17], 0
    v_mov_b64 v[18:19], 0
    v_mov_b64 v[20:21], 0
    v_mov_b64 v[22:23], 0
    v_mov_b64 v[24:25], 0
    v_mov_b64 v[26:27], 0
    v_mov_b64 v[28:29], 0
    v_mov_b64 v[30:31], 0
    v_mov_b64 v[32:33], 0
    v_mov_b64 v[34:35], 0
    s_mov_b32 s70, 0
    s_waitcnt lgkmcnt(0)
M_c1_1_top:
    s_nop 0
    s_barrier
    ds_read_b128 v[36:39], v6 offset:13312
    ds_read_b128 v[40:43], v6 offset:14336
    s_mov_b32 m0, 8192
    s_nop 0
    buffer_load_dwordx4 v0, s[8:11], s49 offen offset:2048 sc1 lds
M_c1_1_lr_r:
    s_waitcnt lgkmcnt(1)
    v_smfmac_f32_16x16x64_bf16 v[20:23], v[36:39], v[56:63], v1
    ds_read_b128 v[56:59], v5 offset:4096
    v_smfmac_f32_16x16x64_bf16 v[24:27], v[36:39], v[64:71], v1
    ds_read_b128 v[60:63], v5 offset:5120
    v_smfmac_f32_16x16x64_bf16 v[28:31], v[36:39], a[248:255], v1
    ds_read_b128 v[64:67], v5 offset:6144
    v_smfmac_f32_16x16x64_bf16 v[32:35], v[36:39], a[240:247], v1
    ds_read_b128 v[68:71], v5 offset:7168
    v_smfmac_f32_16x16x64_bf16 v[12:15], v[36:39], a[232:239], v1
    ds_read_b128 v[44:47], v6 offset:15360
    s_waitcnt lgkmcnt(3)
    v_smfmac_f32_16x16x64_bf16 v[16:19], v[36:39], v[56:63], v1
    ds_read_b128 v[56:59], v5 offset:8192
    v_smfmac_f32_16x16x64_bf16 v[20:23], v[40:43], a[224:231], v1
    ds_read_b128 v[60:63], v5 offset:9216
    v_smfmac_f32_16x16x64_bf16 v[24:27], v[40:43], a[216:223], v1
    ds_read_b128 v[48:51], v6 offset:16384
    s_waitcnt lgkmcnt(4)
    v_smfmac_f32_16x16x64_bf16 v[28:31], v[40:43], v[64:71], v1
    ds_read_b128 v[64:67], v5 offset:10240
    v_smfmac_f32_16x16x64_bf16 v[32:35], v[40:43], a[208:215], v1
    ds_read_b128 v[68:71], v5 offset:11264
    v_smfmac_f32_16x16x64_bf16 v[12:15], v[40:43], a[200:207], v1
    ds_read_b128 v[52:55], v6 offset:17408
    s_waitcnt lgkmcnt(6)
    s_waitcnt lgkmcnt(4)
    v_max3_u32 v10, v36, v40, v44
    v_smfmac_f32_16x16x64_bf16 v[16:19], v[40:43], v[56:63], v1
    ds_read_b128 v[56:59], v5 offset:12288
    s_waitcnt lgkmcnt(1)
    v_max3_u32 v10, v10, v48, v52
    v_smfmac_f32_16x16x64_bf16 v[20:23], v[44:47], a[192:199], v1
    ds_read_b128 v[60:63], v5 offset:13312
    v_cmp_eq_u32 vcc, -1, v10
    v_smfmac_f32_16x16x64_bf16 v[24:27], v[44:47], a[184:191], v1
    s_cbranch_vccnz M_c1_1_lr
    v_smfmac_f32_16x16x64_bf16 v[28:31], v[44:47], v[64:71], v1
    ds_read_b128 v[64:67], v5 offset:14336
    v_smfmac_f32_16x16x64_bf16 v[32:35], v[44:47], a[176:183], v1
    ds_read_b128 v[68:71], v5 offset:15360
    v_smfmac_f32_16x16x64_bf16 v[20:23], v[48:51], a[168:175], v1
    s_waitcnt lgkmcnt(2)
    v_smfmac_f32_16x16x64_bf16 v[24:27], v[48:51], v[56:63], v1
    ds_read_b128 v[56:59], v5 offset:16384
    v_smfmac_f32_16x16x64_bf16 v[28:31], v[48:51], a[160:167], v1
    ds_read_b128 v[60:63], v5 offset:17408
    v_smfmac_f32_16x16x64_bf16 v[32:35], v[48:51], a[152:159], v1
    s_waitcnt vmcnt(0)
    s_barrier
    ds_read_b128 v[36:39], v6 offset:8192
    ds_read_b128 v[40:43], v6 offset:9216
    s_waitcnt lgkmcnt(4)
    v_smfmac_f32_16x16x64_bf16 v[20:23], v[52:55], v[64:71], v1
    ds_read_b128 v[44:47], v6 offset:10240
    ds_read_b128 v[48:51], v6 offset:11264
    v_smfmac_f32_16x16x64_bf16 v[24:27], v[52:55], a[144:151], v1
    ds_read_b32 v11, v6 offset:12288
    ds_read_b128 v[64:67], v5 offset:18432
    v_smfmac_f32_16x16x64_bf16 v[28:31], v[52:55], a[136:143], v1
    ds_read_b128 v[68:71], v5 offset:19456
    s_waitcnt lgkmcnt(4)
    v_max3_u32 v10, v36, v40, v44
    v_smfmac_f32_16x16x64_bf16 v[32:35], v[52:55], v[56:63], v1
    s_waitcnt lgkmcnt(2)
    v_max3_u32 v10, v10, v48, v11
    v_cmp_eq_u32 vcc, -1, v10
    s_cbranch_vccnz M_c1_1_rr
M_c1_1_rr_r:
    s_mov_b32 m0, 23296
    ds_read_b128 v[52:55], v6 offset:12288
    buffer_store_dwordx4 v[76:79], v0, s[8:11], s4 offen offset:1024 sc1
    s_mov_b32 s4, 0x10000000
    s_mov_b64 exec, 3
    buffer_load_dword v9, s[8:11], s51 offen sc1 lds
    s_mov_b64 exec, s[100:101]
    buffer_store_dword v9, v9, s[8:11], s61 offen sc1
    s_mov_b64 exec, -1
    v_smfmac_f32_16x16x64_bf16 v[20:23], v[36:39], a[128:135], v1
    ds_read_b128 v[56:59], v5 offset:20480
    v_smfmac_f32_16x16x64_bf16 v[24:27], v[36:39], a[120:127], v1
    ds_read_b128 v[60:63], v5 offset:21504
    s_waitcnt lgkmcnt(3)
    v_smfmac_f32_16x16x64_bf16 v[20:23], v[40:43], v[64:71], v1
    ds_read_b128 v[64:67], v5 offset:22528
    v_smfmac_f32_16x16x64_bf16 v[24:27], v[40:43], a[112:119], v1
    ds_read_b128 v[68:71], v5 offset:23552
    v_smfmac_f32_16x16x64_bf16 v[20:23], v[44:47], a[104:111], v1
    s_waitcnt lgkmcnt(2)
    v_smfmac_f32_16x16x64_bf16 v[24:27], v[44:47], v[56:63], v1
    ds_read_b128 v[56:59], v5 offset:24576
    v_smfmac_f32_16x16x64_bf16 v[20:23], v[48:51], a[96:103], v1
    ds_read_b128 v[60:63], v5 offset:25600
    v_smfmac_f32_16x16x64_bf16 v[24:27], v[48:51], a[88:95], v1
    s_waitcnt lgkmcnt(2)
    v_smfmac_f32_16x16x64_bf16 v[20:23], v[52:55], v[64:71], v1
    ds_read_b128 v[64:67], v5 offset:26624
    v_smfmac_f32_16x16x64_bf16 v[24:27], v[52:55], a[80:87], v1
    ds_read_b128 v[68:71], v5 offset:27648
    v_smfmac_f32_16x16x64_bf16 v[28:31], v[36:39], a[72:79], v1
    s_waitcnt lgkmcnt(2)
    v_smfmac_f32_16x16x64_bf16 v[32:35], v[36:39], v[56:63], v1
    ds_read_b128 v[56:59], v5 offset:28672
    s_nop 0
    v_permlane32_swap_b32 v20, v21
    v_smfmac_f32_16x16x64_bf16 v[28:31], v[40:43], a[64:71], v1
    ds_read_b128 v[60:63], v5 offset:29696
    v_permlane32_swap_b32 v22, v23
    v_smfmac_f32_16x16x64_bf16 v[32:35], v[40:43], a[56:63], v1
    s_waitcnt lgkmcnt(2)
    v_permlane32_swap_b32 v24, v25
    v_smfmac_f32_16x16x64_bf16 v[28:31], v[44:47], v[64:71], v1
    ds_read_b128 v[64:67], v5 offset:30720
    v_permlane32_swap_b32 v26, v27
    v_smfmac_f32_16x16x64_bf16 v[32:35], v[44:47], a[48:55], v1
    ds_read_b128 v[68:71], v5 offset:31744
    v_add_f32 v20, v20, v21
    v_add_f32 v22, v22, v23
    v_smfmac_f32_16x16x64_bf16 v[28:31], v[48:51], a[40:47], v1
    s_waitcnt lgkmcnt(2)
    v_add_f32 v24, v24, v25
    v_add_f32 v26, v26, v27
    v_smfmac_f32_16x16x64_bf16 v[32:35], v[48:51], v[56:63], v1
    ds_read_b128 v[56:59], v5 offset:32768
    v_mul_f32 v20, s40, v20
    v_mul_f32 v24, s40, v24
    v_smfmac_f32_16x16x64_bf16 v[28:31], v[52:55], a[32:39], v1
    ds_read_b128 v[60:63], v5 offset:33792
    v_mul_f32 v22, s40, v22
    v_mul_f32 v26, s40, v26
    v_smfmac_f32_16x16x64_bf16 v[32:35], v[52:55], a[24:31], v1
    s_waitcnt lgkmcnt(2)
    v_cvt_pk_bf16_f32 v20, v20, v24
    v_cvt_pk_bf16_f32 v21, v22, v26
    v_smfmac_f32_16x16x64_bf16 v[12:15], v[36:39], v[64:71], v1
    s_cmp_eq_u32 s57, 0
    s_cbranch_scc1 M_c1_1_first
M_c1_1_first_r:
    ds_write_b32 v2, v20 offset:18432
    v_smfmac_f32_16x16x64_bf16 v[16:19], v[36:39], a[16:23], v1
    ds_write_b32 v2, v21 offset:19008
    v_permlane32_swap_b32 v28, v29
    v_smfmac_f32_16x16x64_bf16 v[12:15], v[40:43], a[8:15], v1
    ds_read_b128 v[36:39], v6 offset:15360
    s_waitcnt lgkmcnt(3)
    v_permlane32_swap_b32 v30, v31
    v_smfmac_f32_16x16x64_bf16 v[16:19], v[40:43], v[56:63], v1
    ds_read_b128 v[64:67], v0 offset:2048
    v_permlane32_swap_b32 v32, v33
    v_smfmac_f32_16x16x64_bf16 v[12:15], v[44:47], a[0:7], v1
    ds_read_b128 v[68:71], v0 offset:3072
    v_permlane32_swap_b32 v34, v35
    v_smfmac_f32_16x16x64_bf16 v[16:19], v[44:47], v[248:255], v1
    s_waitcnt lgkmcnt(3)
    s_barrier
    ds_read_b128 v[40:43], v6 offset:16384
    v_add_f32 v28, v28, v29
    v_add_f32 v30, v30, v31
    v_smfmac_f32_16x16x64_bf16 v[12:15], v[48:51], v[240:247], v1
    ds_read_b128 v[56:59], v0 offset:0
    v_add_f32 v32, v32, v33
    v_add_f32 v34, v34, v35
    v_smfmac_f32_16x16x64_bf16 v[16:19], v[48:51], v[232:239], v1
    ds_read_b128 v[60:63], v0 offset:1024
    v_cvt_pk_bf16_f32 v28, v28, v32
    v_cvt_pk_bf16_f32 v29, v30, v34
    v_smfmac_f32_16x16x64_bf16 v[12:15], v[52:55], v[224:231], v1
    ds_write_b32 v2, v28 offset:20736
    ds_read_b128 v[20:23], v3 offset:18432
    v_smfmac_f32_16x16x64_bf16 v[16:19], v[52:55], v[216:223], v1
    ds_write_b32 v2, v29 offset:21312
    ds_read_b128 v[24:27], v3 offset:18496
    s_waitcnt lgkmcnt(9)
    v_smfmac_f32_16x16x64_bf16 v[12:15], v[36:39], v[208:215], v1
    ds_read_b128 v[72:75], v3 offset:18560
    ds_read_b128 v[44:47], v3 offset:18624
    v_smfmac_f32_16x16x64_bf16 v[16:19], v[36:39], v[200:207], v1
    ds_read_b128 v[48:51], v6 offset:17408
    s_waitcnt lgkmcnt(9)
    v_smfmac_f32_16x16x64_bf16 v[12:15], v[40:43], v[192:199], v1
    v_smfmac_f32_16x16x64_bf16 v[16:19], v[40:43], v[184:191], v1
    s_waitcnt lgkmcnt(5)
    v_mfma_f32_16x16x32_bf16 v[28:31], v[56:59], v[20:23], 0
    ds_read_b128 v[56:59], v0 offset:4096
    s_waitcnt lgkmcnt(4)
    v_mov_b64 v[52:53], s[24:25]
    v_mfma_f32_16x16x32_bf16 v[28:31], v[60:63], v[24:27], v[28:31]
    ds_read_b128 v[60:63], v0 offset:5120
    s_barrier
    s_waitcnt lgkmcnt(4)
    v_mfma_f32_16x16x32_bf16 v[28:31], v[64:67], v[72:75], v[28:31]
    ds_read_b128 v[64:67], v0 offset:6144
    s_waitcnt lgkmcnt(4)
    v_mov_b64 v[54:55], s[24:25]
    v_mfma_f32_16x16x32_bf16 v[28:31], v[68:71], v[44:47], v[28:31]
    ds_read_b128 v[68:71], v0 offset:7168
    s_waitcnt lgkmcnt(4)
    v_mov_b64 v[10:11], s[16:17]
    v_smfmac_f32_16x16x64_bf16 v[12:15], v[48:51], v[176:183], v1
    ds_read_b128 v[36:39], v3 offset:20736
    v_smfmac_f32_16x16x64_bf16 v[16:19], v[48:51], v[168:175], v1
    ds_read_b128 v[40:43], v3 offset:20800
    s_waitcnt lgkmcnt(4)
    v_mfma_f32_16x16x32_bf16 v[32:35], v[56:59], v[20:23], 0
    v_exp_f32 v28, v28
    v_mfma_f32_16x16x32_bf16 v[32:35], v[60:63], v[24:27], v[32:35]
    s_waitcnt lgkmcnt(2)
    v_exp_f32 v29, v29
    ds_read_b128 v[56:59], v3 offset:20864
    v_mfma_f32_16x16x32_bf16 v[32:35], v[64:67], v[72:75], v[32:35]
    v_exp_f32 v30, v30
    ds_read_b128 v[60:63], v3 offset:20928
    v_mfma_f32_16x16x32_bf16 v[32:35], v[68:71], v[44:47], v[32:35]
    s_waitcnt lgkmcnt(3)
    v_exp_f32 v31, v31
    v_mfma_f32_16x16x32_bf16 v[48:51], v[36:39], v[20:23], 0
    s_waitcnt lgkmcnt(2)
    v_cvt_pk_bf16_f32 v28, v28, v29
    v_cvt_pk_bf16_f32 v29, v30, v31
    v_mfma_f32_16x16x32_bf16 v[48:51], v[40:43], v[24:27], v[48:51]
    s_waitcnt lgkmcnt(1)
    v_cvt_pk_bf16_f32 v12, v12, v13
    v_cvt_pk_bf16_f32 v13, v14, v15
    v_mfma_f32_16x16x32_bf16 v[48:51], v[56:59], v[72:75], v[48:51]
    s_waitcnt lgkmcnt(0)
    v_exp_f32 v32, v32
    v_mfma_f32_16x16x32_bf16 v[48:51], v[60:63], v[44:47], v[48:51]
    v_exp_f32 v33, v33
    v_exp_f32 v34, v34
    v_exp_f32 v35, v35
    v_cvt_pk_bf16_f32 v30, v32, v33
    v_cvt_pk_bf16_f32 v31, v34, v35
    v_cvt_pk_bf16_f32 v14, v16, v17
    v_cvt_pk_bf16_f32 v15, v18, v19
    v_mfma_f32_16x16x32_bf16 v[72:75], v[52:55], v[28:31], 0
    v_exp_f32 v48, v48
    v_mfma_f32_16x16x32_bf16 v[20:23], v[80:83], v[28:31], 0
    v_exp_f32 v49, v49
    v_mfma_f32_16x16x32_bf16 v[24:27], v[84:87], v[28:31], 0
    v_exp_f32 v50, v50
    v_exp_f32 v51, v51
    v_cvt_pk_bf16_f32 v48, v48, v49
    v_cvt_pk_bf16_f32 v49, v50, v51
    v_cndmask_b32_e64 v76, v12, v40, s[66:67]
    v_cndmask_b32_e64 v77, v13, v41, s[66:67]
M_c1_1_fin:
    v_mfma_f32_16x16x16_bf16 v[72:75], v[10:11], v[48:49], v[72:75]
    v_cndmask_b32_e64 v78, v14, v42, s[66:67]
    v_cndmask_b32_e64 v79, v15, v43, s[66:67]
    v_mfma_f32_16x16x16_bf16 v[20:23], v[12:13], v[48:49], v[20:23]
    s_cmp_eq_u32 s57, 63
    v_mov_b64 v[44:45], 0
    v_mov_b64 v[46:47], 0
    v_mfma_f32_16x16x16_bf16 v[24:27], v[14:15], v[48:49], v[24:27]
    s_cbranch_scc1 M_c1_1_last
    v_mov_b64 v[68:69], 0
    v_rcp_f32 v74, v72
    v_subrev_u32 v73, s68, v72
    v_cmp_lt_u32 vcc, s69, v73
    v_mov_b64 v[70:71], 0
    v_mov_b32 v5, v5
    v_mov_b32 v5, v5
    v_cndmask_b32_e64 v20, v20, v24, s[18:19]
    v_cndmask_b32_e64 v21, v21, v25, s[18:19]
    v_cndmask_b32_e64 v22, v22, v26, s[18:19]
    v_cndmask_b32_e64 v23, v23, v27, s[18:19]
    v_pk_mul_f32 v[20:21], v[20:21], v[74:75] op_sel_hi:[1,0]
    v_pk_mul_f32 v[22:23], v[22:23], v[74:75] op_sel_hi:[1,0]
    v_cvt_pk_bf16_f32 v20, v20, v21
    v_cvt_pk_bf16_f32 v21, v22, v23
    ds_write_b64 v0, v[20:21] offset:13320
    s_cbranch_vccnz M_c1_1_zbad
M_c1_1_zok:
    s_cmp_eq_u32 s57, 0
    s_cbranch_scc1 M_c1_1_first2
M_c1_1_first2_r:
    buffer_load_dwordx4 v[80:83], v0, s[8:11], s3 offen offset:0 sc1
    buffer_load_dwordx4 v[84:87], v0, s[8:11], s3 offen offset:1024 sc1
    s_waitcnt lgkmcnt(0)
    s_barrier
    ds_read_b128 v[32:35], v0 offset:13312
    ds_read_b128 v[40:43], v0 offset:14336
    s_mov_b32 m0, 2048
    s_nop 0
    buffer_load_dwordx4 v0, s[8:11], s26 offen offset:0 sc1 lds
    buffer_load_dwordx4 v0, s[8:11], s26 offen offset:1024 sc1 lds
    v_mov_b64 v[64:65], 0
    v_mov_b64 v[66:67], 0
    v_mov_b64 v[60:61], 0
    v_mov_b64 v[62:63], 0
    v_mov_b64 v[56:57], 0
    v_mov_b64 v[58:59], 0
    s_waitcnt lgkmcnt(1)
    s_nop 0
    v_smfmac_f32_16x16x64_bf16 v[56:59], v[32:35], v[160:167], v1
    v_smfmac_f32_16x16x64_bf16 v[60:63], v[32:35], v[144:151], v1
    s_waitcnt lgkmcnt(0)
    v_smfmac_f32_16x16x64_bf16 v[56:59], v[40:43], v[152:159], v1
    v_smfmac_f32_16x16x64_bf16 v[60:63], v[40:43], v[136:143], v1
    v_smfmac_f32_16x16x64_bf16 v[64:67], v[32:35], v[128:135], v1
    v_smfmac_f32_16x16x64_bf16 v[68:71], v[32:35], v[112:119], v1
    v_permlane32_swap_b32 v56, v57
    v_smfmac_f32_16x16x64_bf16 v[64:67], v[40:43], v[120:127], v1
    v_permlane32_swap_b32 v58, v59
    v_smfmac_f32_16x16x64_bf16 v[68:71], v[40:43], v[104:111], v1
    v_add_f32 v56, v56, v57
    v_add_f32 v58, v58, v59
    v_smfmac_f32_16x16x64_bf16 v[44:47], v[32:35], v[96:103], v1
    v_permlane32_swap_b32 v60, v61
    v_smfmac_f32_16x16x64_bf16 v[44:47], v[40:43], v[88:95], v1
    v_permlane32_swap_b32 v62, v63
    v_add_f32 v60, v60, v61
    v_add_f32 v62, v62, v63
    v_cvt_pk_bf16_f32 v36, v56, v60
    v_cvt_pk_bf16_f32 v38, v58, v62
    v_permlane32_swap_b32 v64, v65
    v_permlane32_swap_b32 v66, v67
    v_add_f32 v64, v64, v65
    v_add_f32 v66, v66, v67
    v_permlane32_swap_b32 v68, v69
    v_permlane32_swap_b32 v70, v71
    v_add_f32 v68, v68, v69
    v_add_f32 v70, v70, v71
    v_cvt_pk_bf16_f32 v37, v64, v68
    v_cvt_pk_bf16_f32 v39, v66, v70
    buffer_store_dwordx4 v[36:39], v0, s[8:11], s58 offen sc1
    v_permlane32_swap_b32 v44, v45
    v_permlane32_swap_b32 v46, v47
    v_add_f32 v44, v44, v45
    v_add_f32 v46, v46, v47
    v_cvt_pk_bf16_f32 v44, v44, v46
    buffer_store_dword v44, v7, s[8:11], s55 offen sc1
    v_bfe_u32 v34, v0, 4, 1
    v_bfe_u32 v33, v0, 7, 1
    v_lshl_add_u32 v33, v33, 1, v34
    v_bfe_u32 v32, v0, 6, 1
    v_lshlrev_b32 v32, 4, v32
    v_lshlrev_b32_e64 v32, v32, s45
    v_cmp_eq_u32_e64 s[64:65], 0, v33
    v_cmp_eq_u32_e64 vcc, 1, v33
    s_add_u32 s27, s44, 1
    s_and_b32 s27, s27, 3
    v_cndmask_b32_e64 v72, 0, v32, s[64:65]
    v_cndmask_b32_e64 v73, 0, v32, vcc
    v_cmp_eq_u32_e64 s[64:65], 2, v33
    v_cmp_eq_u32_e64 vcc, 3, v33
    s_mul_i32 s48, s27, 5120
    s_add_u32 s48, s48, s41
    v_cndmask_b32_e64 v74, 0, v32, s[64:65]
    v_cndmask_b32_e64 v75, 0, v32, vcc
    s_lshl_b32 s27, s27, 15
    s_add_u32 s49, s27, s47
    v_bfe_u32 v32, v0, 8, 1
    v_lshlrev_b32 v11, 6, v32
    v_lshl_add_u32 v11, v34, 3, v11
    v_lshrrev_b32 v33, 9, v0
    v_lshl_add_u32 v11, v33, 2, v11
    s_add_u32 s56, s27, s46
    s_add_u32 s56, s56, s33
    s_add_u32 s58, s48, s33
    v_mov_b32 v5, v5
    s_nop 1
    v_mov_b32 v5, v5
    s_nop 1
    v_mov_b32 v5, v5
    s_nop 1
    v_mov_b32 v5, v5
    s_nop 1
    v_mov_b32 v5, v5
    s_nop 1
    v_mov_b32 v5, v5
    s_nop 1
    v_mov_b32 v5, v5
    s_nop 1
    v_mov_b32 v5, v5
    s_nop 1
    buffer_load_dwordx4 v[12:15], v0, s[8:11], s43 offen sc1
    v_mov_b32 v5, v5
    s_nop 1
    v_mov_b32 v5, v5
    s_nop 1
    v_mov_b32 v5, v5
    s_nop 1
    v_mov_b32 v5, v5
    s_nop 1
    v_mov_b32 v5, v5
    s_nop 1
    v_mov_b32 v5, v5
    s_nop 1
    v_mov_b32 v5, v5
    s_nop 1
    v_mov_b32 v5, v5
    s_nop 1
    v_mov_b32 v5, v5
    s_nop 1
    v_mov_b32 v5, v5
    s_nop 1
    v_mov_b32 v5, v5
    s_nop 1
    v_mov_b32 v5, v5
    s_nop 1
    v_mov_b32 v5, v5
    v_mov_b32 v5, v5
    buffer_load_dwordx4 v[16:19], v0, s[8:11], s43 offen sc1
    v_mov_b32 v5, v5
    s_nop 1
    v_mov_b32 v5, v5
    s_nop 1
    v_mov_b32 v5, v5
    v_mov_b32 v5, v5
    s_waitcnt vmcnt(1)
    v_mfma_f32_16x16x32_bf16 v[28:31], v[72:75], v[12:15], 0
    v_cmp_eq_u32 vcc, -1, v12
    s_cbranch_vccnz M_c1_1_wq1
    v_mov_b32 v5, v5
    v_mov_b32 v5, v5
    v_mov_b32 v5, v5
    v_mov_b32 v5, v5
    v_mov_b32 v5, v5
    v_mov_b32 v5, v5
    v_add_f32_dpp v28, v28, v28 row_ror:8 row_mask:0xf bank_mask:0xf
    v_add_f32_dpp v29, v29, v29 row_ror:8 row_mask:0xf bank_mask:0xf
    s_nop 0
    v_add_f32_dpp v28, v28, v28 row_ror:4 row_mask:0xf bank_mask:0xf
    v_add_f32_dpp v29, v29, v29 row_ror:4 row_mask:0xf bank_mask:0xf
    s_nop 0
    v_add_f32_dpp v28, v28, v28 row_ror:2 row_mask:0xf bank_mask:0xf
    v_add_f32_dpp v29, v29, v29 row_ror:2 row_mask:0xf bank_mask:0xf
    v_cmp_u_f32 vcc, v28, v28
    v_cvt_pk_bf16_f32 v28, v28, v29
    s_cbranch_vccnz M_c1_1_wrb_e0
    s_mov_b64 exec, s[62:63]
    buffer_store_dword v28, v11, s[8:11], s58 offen sc1
M_c1_1_wrb_d:
    s_barrier
    buffer_store_dword v28, v11, s[8:11], s56 offen sc1
M_c1_1_wrb_g:
    s_mov_b64 exec, -1
    s_waitcnt vmcnt(2)
    ds_read_b128 v[56:59], v5 offset:0
    ds_read_b128 v[60:63], v5 offset:1024
    ds_read_b128 v[64:67], v5 offset:2048
    ds_read_b128 v[68:71], v5 offset:3072
    v_mov_b64 v[12:13], 0
    v_mov_b64 v[14:15], 0
    v_mov_b64 v[16:17], 0
    v_mov_b64 v[18:19], 0
    v_mov_b64 v[20:21], 0
    v_mov_b64 v[22:23], 0
    v_mov_b64 v[24:25], 0
    v_mov_b64 v[26:27], 0
    v_mov_b64 v[28:29], 0
    v_mov_b64 v[30:31], 0
    v_mov_b64 v[32:33], 0
    v_mov_b64 v[34:35], 0
    s_and_b32 s26, s44, 63
    s_add_u32 s26, s26, 2
    s_min_u32 s26, s26, 63
    s_lshl_b32 s26, s26, 18
    s_add_u32 s26, s26, s50
    s_add_u32 s26, s26, 2048
    s_add_u32 s3, s26, 16777216
    s_lshl_b32 s4, s44, 18
    s_add_u32 s4, s4, s53
    v_mov_b64 v[72:73], -1
    v_mov_b64 v[74:75], -1
    s_add_u32 s28, s44, 3
    s_and_b32 s29, s28, 3
    s_mul_i32 s31, s22, 160
    s_mul_i32 s28, s29, 167936
    s_add_u32 s28, s28, s34
    s_add_u32 s64, s28, s35
    s_lshl_b32 s65, s22, 10
    s_add_u32 s65, s65, s28
    s_add_u32 s65, s65, 135168
    ds_read_b64 v[36:37], v0 offset:23296
    s_waitcnt lgkmcnt(0)
    v_min_u32 v36, v36, v37
    s_nop 0
    v_readfirstlane_b32 s28, v36
    s_nop 0
    s_max_u32 s54, s54, s28
    s_add_u32 s27, s44, 3
    s_or_b32 s28, s44, 63
    s_add_u32 s28, s28, 1
    s_min_u32 s27, s27, s28
    s_cmp_lt_u32 s54, s27
    s_cbranch_scc1 M_c1_1_wkw
M_c1_1_wkw_r:
    s_add_u32 s44, s44, 1
    s_and_b32 s55, s44, 3
    s_mul_i32 s55, s55, 167936
    s_add_u32 s55, s55, s34
    s_add_u32 s58, s55, s35
    s_and_b32 s57, s44, 63
    s_add_u32 s43, s55, s32
    s_sub_u32 s27, s57, 1
    s_max_i32 s27, s27, 0
    s_lshl_b64 s[100:101], 1, s27
    s_lshl_b32 s27, s27, 7
    s_sub_u32 s61, s52, s27
    s_nop 15
    s_nop 15
    buffer_store_dwordx4 v[72:75], v0, s[8:11], s64 offen offset:1024 sc1
    buffer_store_dwordx4 v[72:75], v0, s[8:11], s64 offen offset:2048 sc1
    buffer_store_dwordx4 v[72:75], v0, s[8:11], s65 offen sc1
    s_mov_b32 s65, 0x10000000
    s_mov_b32 s64, 0x10000000
    s_mov_b32 s70, 0
    s_branch M_c1_1_top
M_c1_1_restart:
    s_waitcnt vmcnt(0) lgkmcnt(0)
    s_nop 7
    s_barrier
    ds_read_b128 v[56:59], v5 offset:0
    ds_read_b128 v[60:63], v5 offset:1024
    ds_read_b128 v[64:67], v5 offset:2048
    ds_read_b128 v[68:71], v5 offset:3072
    v_mov_b64 v[12:13], 0
    v_mov_b64 v[14:15], 0
    v_mov_b64 v[16:17], 0
    v_mov_b64 v[18:19], 0
    v_mov_b64 v[20:21], 0
    v_mov_b64 v[22:23], 0
    v_mov_b64 v[24:25], 0
    v_mov_b64 v[26:27], 0
    v_mov_b64 v[28:29], 0
    v_mov_b64 v[30:31], 0
    v_mov_b64 v[32:33], 0
    v_mov_b64 v[34:35], 0
    s_waitcnt vmcnt(0) lgkmcnt(0)
    s_branch M_c1_1_top
M_c1_1_zbad:
    s_cmp_eq_u32 s70, 2
    s_cbranch_scc1 M_c1_1_zok
    v_cmp_u_f32 vcc, v72, v72
    s_cbranch_vccz M_c1_1_exact
    s_cmp_eq_u32 s70, 1
    s_cbranch_scc1 M_c1_1_exact
M_c1_1_vfy0:
    s_mov_b32 s70, 1
    s_mov_b32 s30, 0
    s_waitcnt vmcnt(0) lgkmcnt(0)
    s_nop 7
M_c1_1_vfy:
    v_mov_b32 v10, 0
    s_add_u32 s59, s48, 4096
    buffer_load_dwordx4 v[36:39], v0, s[8:11], s48 offen offset:0 sc1
    buffer_load_dwordx4 v[40:43], v0, s[8:11], s48 offen offset:1024 sc1
    buffer_load_dwordx4 v[44:47], v0, s[8:11], s48 offen offset:2048 sc1
    buffer_load_dwordx4 v[48:51], v0, s[8:11], s48 offen offset:3072 sc1
    buffer_load_dwordx4 v[52:55], v0, s[8:11], s59 offen offset:0 sc1
    s_waitcnt vmcnt(4)
    v_max3_u32 v10, v10, v36, v37
    v_max3_u32 v10, v10, v38, v39
    s_waitcnt vmcnt(3)
    v_max3_u32 v10, v10, v40, v41
    v_max3_u32 v10, v10, v42, v43
    s_waitcnt vmcnt(2)
    v_max3_u32 v10, v10, v44, v45
    v_max3_u32 v10, v10, v46, v47
    s_waitcnt vmcnt(1)
    v_max3_u32 v10, v10, v48, v49
    v_max3_u32 v10, v10, v50, v51
    s_waitcnt vmcnt(0)
    v_max3_u32 v10, v10, v52, v53
    v_max3_u32 v10, v10, v54, v55
    s_add_u32 s59, s49, 4096
    buffer_load_dwordx4 v[36:39], v0, s[8:11], s49 offen offset:0 sc1
    buffer_load_dwordx4 v[40:43], v0, s[8:11], s49 offen offset:1024 sc1
    buffer_load_dwordx4 v[44:47], v0, s[8:11], s49 offen offset:2048 sc1
    buffer_load_dwordx4 v[48:51], v0, s[8:11], s49 offen offset:3072 sc1
    buffer_load_dwordx4 v[52:55], v0, s[8:11], s59 offen offset:0 sc1
    s_waitcnt vmcnt(4)
    v_max3_u32 v10, v10, v36, v37
    v_max3_u32 v10, v10, v38, v39
    s_waitcnt vmcnt(3)
    v_max3_u32 v10, v10, v40, v41
    v_max3_u32 v10, v10, v42, v43
    s_waitcnt vmcnt(2)
    v_max3_u32 v10, v10, v44, v45
    v_max3_u32 v10, v10, v46, v47
    s_waitcnt vmcnt(1)
    v_max3_u32 v10, v10, v48, v49
    v_max3_u32 v10, v10, v50, v51
    s_waitcnt vmcnt(0)
    v_max3_u32 v10, v10, v52, v53
    v_max3_u32 v10, v10, v54, v55
    v_cmp_eq_u32 vcc, -1, v10
    s_cbranch_vccz M_c1_1_restart
    s_add_u32 s30, s30, 1
    s_cmp_ge_u32 s30, 60000
    s_cbranch_scc1 M_fail
    s_branch M_c1_1_vfy
M_c1_1_exact:
    s_nop 7
    s_mov_b32 s70, 2
    s_waitcnt lgkmcnt(0)
    ds_read_b128 v[20:23], v3 offset:18432
    ds_read_b128 v[24:27], v3 offset:18496
    ds_read_b128 v[72:75], v3 offset:18560
    ds_read_b128 v[44:47], v3 offset:18624
    ds_read_b128 v[56:59], v0 offset:0
    s_waitcnt lgkmcnt(0)
    v_mfma_f32_16x16x32_bf16 v[28:31], v[56:59], v[20:23], 0
    s_nop 3
    ds_read_b128 v[60:63], v0 offset:1024
    s_waitcnt lgkmcnt(0)
    v_mfma_f32_16x16x32_bf16 v[28:31], v[60:63], v[24:27], v[28:31]
    s_nop 3
    ds_read_b128 v[56:59], v0 offset:2048
    s_waitcnt lgkmcnt(0)
    v_mfma_f32_16x16x32_bf16 v[28:31], v[56:59], v[72:75], v[28:31]
    s_nop 3
    ds_read_b128 v[60:63], v0 offset:3072
    s_waitcnt lgkmcnt(0)
    v_mfma_f32_16x16x32_bf16 v[28:31], v[60:63], v[44:47], v[28:31]
    s_nop 3
    ds_read_b128 v[56:59], v0 offset:4096
    s_waitcnt lgkmcnt(0)
    v_mfma_f32_16x16x32_bf16 v[32:35], v[56:59], v[20:23], 0
    s_nop 3
    ds_read_b128 v[60:63], v0 offset:5120
    s_waitcnt lgkmcnt(0)
    v_mfma_f32_16x16x32_bf16 v[32:35], v[60:63], v[24:27], v[32:35]
    s_nop 3
    ds_read_b128 v[56:59], v0 offset:6144
    s_waitcnt lgkmcnt(0)
    v_mfma_f32_16x16x32_bf16 v[32:35], v[56:59], v[72:75], v[32:35]
    s_nop 3
    ds_read_b128 v[60:63], v0 offset:7168
    s_waitcnt lgkmcnt(0)
    v_mfma_f32_16x16x32_bf16 v[32:35], v[60:63], v[44:47], v[32:35]
    s_nop 3
    ds_read_b128 v[56:59], v3 offset:20736
    s_waitcnt lgkmcnt(0)
    v_mfma_f32_16x16x32_bf16 v[48:51], v[56:59], v[20:23], 0
    s_nop 3
    ds_read_b128 v[60:63], v3 offset:20800
    s_waitcnt lgkmcnt(0)
    v_mfma_f32_16x16x32_bf16 v[48:51], v[60:63], v[24:27], v[48:51]
    s_nop 3
    ds_read_b128 v[56:59], v3 offset:20864
    s_waitcnt lgkmcnt(0)
    v_mfma_f32_16x16x32_bf16 v[48:51], v[56:59], v[72:75], v[48:51]
    s_nop 3
    ds_read_b128 v[60:63], v3 offset:20928
    s_waitcnt lgkmcnt(0)
    v_mfma_f32_16x16x32_bf16 v[48:51], v[60:63], v[44:47], v[48:51]
    s_nop 3
    v_max3_f32 v64, v28, v29, v30
    v_max3_f32 v64, v64, v31, v32
    v_max3_f32 v64, v64, v33, v34
    s_nop 0
    v_max3_f32 v64, v64, v35, v48
    v_max3_f32 v64, v64, v49, v50
    v_max_f32 v64, v64, v51
    v_mov_b32 v65, v64
    s_nop 1
    v_permlane16_swap_b32 v64, v65
    v_max_f32 v64, v64, v65
    v_mov_b32 v65, v64
    s_nop 1
    v_permlane32_swap_b32 v64, v65
    v_max_f32 v64, v64, v65
    v_sub_f32 v28, v28, v64
    v_exp_f32 v28, v28
    v_sub_f32 v29, v29, v64
    v_exp_f32 v29, v29
    v_sub_f32 v30, v30, v64
    v_exp_f32 v30, v30
    v_sub_f32 v31, v31, v64
    v_exp_f32 v31, v31
    v_sub_f32 v32, v32, v64
    v_exp_f32 v32, v32
    v_sub_f32 v33, v33, v64
    v_exp_f32 v33, v33
    v_sub_f32 v34, v34, v64
    v_exp_f32 v34, v34
    v_sub_f32 v35, v35, v64
    v_exp_f32 v35, v35
    v_sub_f32 v48, v48, v64
    v_exp_f32 v48, v48
    v_sub_f32 v49, v49, v64
    v_exp_f32 v49, v49
    v_sub_f32 v50, v50, v64
    v_exp_f32 v50, v50
    v_sub_f32 v51, v51, v64
    v_exp_f32 v51, v51
    v_cvt_pk_bf16_f32 v28, v28, v29
    v_cvt_pk_bf16_f32 v29, v30, v31
    v_cvt_pk_bf16_f32 v30, v32, v33
    v_cvt_pk_bf16_f32 v31, v34, v35
    v_cvt_pk_bf16_f32 v48, v48, v49
    v_cvt_pk_bf16_f32 v49, v50, v51
    v_mfma_f32_16x16x32_bf16 v[20:23], v[80:83], v[28:31], 0
    v_mfma_f32_16x16x32_bf16 v[24:27], v[84:87], v[28:31], 0
    v_mfma_f32_16x16x32_bf16 v[72:75], v[52:55], v[28:31], 0
    ds_read_b128 v[40:43], v3 offset:20800
    s_waitcnt lgkmcnt(0)
    s_nop 7
    s_branch M_c1_1_fin
M_c1_1_last:
    s_cmp_lg_u32 s70, 0
    s_cbranch_scc1 M_c1_1_last2
    v_cmp_u_f32 vcc, v32, v32
    s_cbranch_vccnz M_c1_1_vfy0
M_c1_1_last2:
    s_lshl_b32 s4, s44, 18
    s_add_u32 s4, s4, s53
    buffer_store_dwordx4 v[76:79], v0, s[8:11], s4 offen offset:1024 sc1
    s_mov_b32 s4, 0x10000000
    s_waitcnt vmcnt(0) lgkmcnt(0)
    s_barrier
    v_mov_b32 v11, 8192
    s_mov_b64 exec, 1
    buffer_store_dword v11, v0, s[8:11], s52 offen sc1
    s_mov_b64 exec, -1
    s_add_u32 s52, s52, 4096
    s_nop 7
    v_mov_b64 v[72:73], -1
    v_mov_b64 v[74:75], -1
    s_add_u32 s28, s44, 3
    s_and_b32 s29, s28, 3
    s_mul_i32 s31, s22, 160
    s_mul_i32 s28, s29, 167936
    s_add_u32 s28, s28, s34
    s_add_u32 s64, s28, s35
    s_lshl_b32 s65, s22, 10
    s_add_u32 s65, s65, s28
    s_add_u32 s65, s65, 135168
    buffer_store_dwordx4 v[72:75], v0, s[8:11], s64 offen offset:1024 sc1
    buffer_store_dwordx4 v[72:75], v0, s[8:11], s64 offen offset:2048 sc1
    buffer_store_dwordx4 v[72:75], v0, s[8:11], s65 offen sc1
    s_mov_b32 s65, 0x10000000
    s_mov_b32 s64, 0x10000000
    s_waitcnt vmcnt(0)
    s_add_u32 s44, s44, 1
    s_cmp_eq_u32 s44, 128
    s_cbranch_scc1 M_end
    s_branch M_c1_1_layer
M_c1_1_lr:
    s_mov_b32 s30, 0
M_c1_1_lr_l:
    s_waitcnt lgkmcnt(0)
    ds_read_b128 v[36:39], v6 offset:13312
    ds_read_b128 v[40:43], v6 offset:14336
    ds_read_b128 v[44:47], v6 offset:15360
    ds_read_b128 v[48:51], v6 offset:16384
    ds_read_b128 v[52:55], v6 offset:17408
    s_waitcnt lgkmcnt(2)
    v_max3_u32 v10, v36, v40, v44
    s_waitcnt lgkmcnt(0)
    v_max3_u32 v10, v10, v48, v52
    v_cmp_eq_u32 vcc, -1, v10
    s_cbranch_vccz M_c1_1_lr_d
    s_add_u32 s30, s30, 1
    s_cmp_ge_u32 s30, 480000
    s_cbranch_scc1 M_fail
    s_branch M_c1_1_lr_l
M_c1_1_lr_d:
    ds_read_b128 v[56:59], v5 offset:0
    ds_read_b128 v[60:63], v5 offset:1024
    ds_read_b128 v[64:67], v5 offset:2048
    ds_read_b128 v[68:71], v5 offset:3072
    v_mov_b64 v[12:13], 0
    v_mov_b64 v[14:15], 0
    v_mov_b64 v[16:17], 0
    v_mov_b64 v[18:19], 0
    v_mov_b64 v[20:21], 0
    v_mov_b64 v[22:23], 0
    v_mov_b64 v[24:25], 0
    v_mov_b64 v[26:27], 0
    v_mov_b64 v[28:29], 0
    v_mov_b64 v[30:31], 0
    v_mov_b64 v[32:33], 0
    v_mov_b64 v[34:35], 0
    s_waitcnt lgkmcnt(0)
    s_branch M_c1_1_lr_r
M_c1_1_rr:
    s_mov_b32 s30, 0
M_c1_1_rr_l:
    s_waitcnt lgkmcnt(0)
    s_and_b32 s27, s30, 1
    s_cbranch_scc1 M_c1_1_rr_n
    s_waitcnt vmcnt(1)
    s_mov_b32 m0, 8192
    s_nop 0
    buffer_load_dwordx4 v0, s[8:11], s49 offen offset:2048 sc1 lds
M_c1_1_rr_n:
    ds_read_b128 v[36:39], v6 offset:8192
    ds_read_b128 v[40:43], v6 offset:9216
    ds_read_b128 v[44:47], v6 offset:10240
    ds_read_b128 v[48:51], v6 offset:11264
    ds_read_b32 v11, v6 offset:12288
    s_waitcnt lgkmcnt(2)
    v_max3_u32 v10, v36, v40, v44
    s_waitcnt lgkmcnt(0)
    v_max3_u32 v10, v10, v48, v11
    v_cmp_eq_u32 vcc, -1, v10
    s_cbranch_vccz M_c1_1_rr_d
    s_add_u32 s30, s30, 1
    s_cmp_ge_u32 s30, 480000
    s_cbranch_scc1 M_fail
    s_branch M_c1_1_rr_l
M_c1_1_rr_d:
    s_branch M_c1_1_rr_r
M_c1_1_first:
    s_add_u32 s27, s44, 1
    s_or_b32 s28, s44, 63
    s_add_u32 s28, s28, 1
    s_min_u32 s27, s27, s28
    s_cmp_lt_u32 s54, s27
    s_cbranch_scc1 M_c1_1_p1
M_c1_1_p1_r:
    s_barrier
    s_and_b32 s26, s44, 63
    s_lshl_b32 s26, s26, 18
    s_add_u32 s26, s26, s50
    s_add_u32 s26, s26, 2048
    s_add_u32 s3, s26, 16777216
    s_mov_b32 m0, 2048
    s_nop 0
    buffer_load_dwordx4 v0, s[8:11], s26 offen offset:0 sc1 lds
    buffer_load_dwordx4 v0, s[8:11], s26 offen offset:1024 sc1 lds
    buffer_load_dwordx4 v[80:83], v0, s[8:11], s3 offen offset:0 sc1
    buffer_load_dwordx4 v[84:87], v0, s[8:11], s3 offen offset:1024 sc1
    s_and_b32 s26, s44, 63
    s_add_u32 s26, s26, 1
    s_min_u32 s26, s26, 63
    s_lshl_b32 s26, s26, 18
    s_add_u32 s26, s26, s50
    s_add_u32 s26, s26, 2048
    s_add_u32 s3, s26, 16777216
    s_waitcnt vmcnt(0) lgkmcnt(0)
    s_barrier
    s_branch M_c1_1_first_r
M_c1_1_first2:
    s_add_u32 s27, s44, 2
    s_or_b32 s28, s44, 63
    s_add_u32 s28, s28, 1
    s_min_u32 s27, s27, s28
    s_cmp_lt_u32 s54, s27
    s_cbranch_scc1 M_c1_1_p2
M_c1_1_p2_r:
    s_barrier
    s_branch M_c1_1_first2_r
M_c1_1_wq1:
    buffer_load_dwordx4 v[12:15], v0, s[8:11], s43 offen sc1
    s_waitcnt vmcnt(1)
    v_mfma_f32_16x16x32_bf16 v[28:31], v[72:75], v[16:19], 0
    v_cmp_eq_u32 vcc, -1, v16
    s_cbranch_vccnz M_c1_1_wqx
    v_mov_b32 v5, v5
    v_mov_b32 v5, v5
    v_mov_b32 v5, v5
    v_mov_b32 v5, v5
    v_mov_b32 v5, v5
    v_mov_b32 v5, v5
    v_add_f32_dpp v28, v28, v28 row_ror:8 row_mask:0xf bank_mask:0xf
    v_add_f32_dpp v29, v29, v29 row_ror:8 row_mask:0xf bank_mask:0xf
    s_nop 0
    v_add_f32_dpp v28, v28, v28 row_ror:4 row_mask:0xf bank_mask:0xf
    v_add_f32_dpp v29, v29, v29 row_ror:4 row_mask:0xf bank_mask:0xf
    s_nop 0
    v_add_f32_dpp v28, v28, v28 row_ror:2 row_mask:0xf bank_mask:0xf
    v_add_f32_dpp v29, v29, v29 row_ror:2 row_mask:0xf bank_mask:0xf
    v_cmp_u_f32 vcc, v28, v28
    v_cvt_pk_bf16_f32 v28, v28, v29
    s_cbranch_vccnz M_c1_1_wqe1
    s_mov_b64 exec, s[62:63]
    buffer_store_dword v28, v11, s[8:11], s58 offen sc1
    s_barrier
    buffer_store_dword v28, v11, s[8:11], s56 offen sc1
    s_branch M_c1_1_wrb_g
M_c1_1_wqx:
    s_branch M_c1_1_wrb_i1
M_c1_1_wqe1:
    s_waitcnt vmcnt(0)
    buffer_load_dwordx4 v[12:15], v0, s[8:11], s43 offen sc1
    s_branch M_c1_1_wrb_e1
M_c1_1_wrb_l:
    s_waitcnt vmcnt(1)
    v_mfma_f32_16x16x32_bf16 v[28:31], v[72:75], v[12:15], 0
    v_cmp_eq_u32 vcc, -1, v12
    s_cbranch_vccz M_c1_1_wrb_x0
M_c1_1_wrb_i0:
    buffer_load_dwordx4 v[12:15], v0, s[8:11], s43 offen sc1
    s_waitcnt vmcnt(1)
    v_mfma_f32_16x16x32_bf16 v[28:31], v[72:75], v[16:19], 0
    v_cmp_eq_u32 vcc, -1, v16
    s_cbranch_vccz M_c1_1_wrb_x1
M_c1_1_wrb_i1:
    buffer_load_dwordx4 v[16:19], v0, s[8:11], s43 offen sc1
    s_add_u32 s71, s71, 1
    s_cmp_lt_u32 s71, 240000
    s_cbranch_scc1 M_c1_1_wrb_l
    s_branch M_fail
M_c1_1_wrb_x0:
    s_nop 5
    v_add_f32_dpp v28, v28, v28 row_ror:8 row_mask:0xf bank_mask:0xf
    v_add_f32_dpp v29, v29, v29 row_ror:8 row_mask:0xf bank_mask:0xf
    s_nop 0
    v_add_f32_dpp v28, v28, v28 row_ror:4 row_mask:0xf bank_mask:0xf
    v_add_f32_dpp v29, v29, v29 row_ror:4 row_mask:0xf bank_mask:0xf
    s_nop 0
    v_add_f32_dpp v28, v28, v28 row_ror:2 row_mask:0xf bank_mask:0xf
    v_add_f32_dpp v29, v29, v29 row_ror:2 row_mask:0xf bank_mask:0xf
    v_cmp_u_f32 vcc, v28, v28
    v_cvt_pk_bf16_f32 v28, v28, v29
    s_cbranch_vccz M_c1_1_wrb_n
M_c1_1_wrb_e0:
    v_max3_u32 v32, v12, v13, v14
    v_max_u32 v32, v32, v15
    v_cmp_eq_u32 vcc, -1, v32
    s_cbranch_vccnz M_c1_1_wrb_i0
    v_min_u32 v28, -2, v28
    v_min_u32 v29, -2, v29
    s_branch M_c1_1_wrb_n
M_c1_1_wrb_x1:
    s_nop 5
    v_add_f32_dpp v28, v28, v28 row_ror:8 row_mask:0xf bank_mask:0xf
    v_add_f32_dpp v29, v29, v29 row_ror:8 row_mask:0xf bank_mask:0xf
    s_nop 0
    v_add_f32_dpp v28, v28, v28 row_ror:4 row_mask:0xf bank_mask:0xf
    v_add_f32_dpp v29, v29, v29 row_ror:4 row_mask:0xf bank_mask:0xf
    s_nop 0
    v_add_f32_dpp v28, v28, v28 row_ror:2 row_mask:0xf bank_mask:0xf
    v_add_f32_dpp v29, v29, v29 row_ror:2 row_mask:0xf bank_mask:0xf
    v_cmp_u_f32 vcc, v28, v28
    v_cvt_pk_bf16_f32 v28, v28, v29
    s_cbranch_vccz M_c1_1_wrb_n
M_c1_1_wrb_e1:
    v_max3_u32 v32, v16, v17, v18
    v_max_u32 v32, v32, v19
    v_cmp_eq_u32 vcc, -1, v32
    s_cbranch_vccnz M_c1_1_wrb_i1
    v_min_u32 v28, -2, v28
    v_min_u32 v29, -2, v29
M_c1_1_wrb_n:
    s_mov_b64 exec, s[62:63]
    buffer_store_dword v28, v11, s[8:11], s58 offen sc1
    s_branch M_c1_1_wrb_d
M_c1_1_wkw:
    s_mov_b32 s30, 0
M_c1_1_wkw_l:
    s_waitcnt lgkmcnt(0)
    s_mov_b64 exec, 3
    buffer_load_dword v11, v9, s[8:11], s51 offen sc1
    s_waitcnt vmcnt(0)
    s_mov_b64 exec, -1
    v_readlane_b32 s54, v11, 0
    v_readlane_b32 s28, v11, 1
    s_nop 3
    s_min_u32 s54, s54, s28
    s_cmp_ge_u32 s54, s27
    s_cbranch_scc1 M_c1_1_wkw_r
    s_sleep 1
    s_add_u32 s30, s30, 1
    s_cmp_ge_u32 s30, 60000
    s_cbranch_scc1 M_fail
    s_branch M_c1_1_wkw_l
M_c1_1_p1:
    s_mov_b32 s30, 0
M_c1_1_p1_l:
    s_waitcnt lgkmcnt(0)
    s_mov_b64 exec, 3
    buffer_load_dword v11, v9, s[8:11], s51 offen sc1
    s_waitcnt vmcnt(0)
    s_mov_b64 exec, -1
    v_readlane_b32 s54, v11, 0
    v_readlane_b32 s28, v11, 1
    s_nop 3
    s_min_u32 s54, s54, s28
    s_cmp_ge_u32 s54, s27
    s_cbranch_scc1 M_c1_1_p1_r
    s_sleep 1
    s_add_u32 s30, s30, 1
    s_cmp_ge_u32 s30, 60000
    s_cbranch_scc1 M_fail
    s_branch M_c1_1_p1_l
M_c1_1_p2:
    s_mov_b32 s30, 0
M_c1_1_p2_l:
    s_waitcnt lgkmcnt(0)
    s_mov_b64 exec, 3
    buffer_load_dword v11, v9, s[8:11], s51 offen sc1
    s_waitcnt vmcnt(0)
    s_mov_b64 exec, -1
    v_readlane_b32 s54, v11, 0
    v_readlane_b32 s28, v11, 1
    s_nop 3
    s_min_u32 s54, s54, s28
    s_cmp_ge_u32 s54, s27
    s_cbranch_scc1 M_c1_1_p2_r
    s_sleep 1
    s_add_u32 s30, s30, 1
    s_cmp_ge_u32 s30, 60000
    s_cbranch_scc1 M_fail
    s_branch M_c1_1_p2_l
M_c1_2_layer:
    s_lshr_b32 s27, s44, 6
    s_mul_i32 s50, s27, 33554432
    s_lshl_b32 s27, s22, 13
    s_add_u32 s50, s50, s27
    s_add_u32 s50, s50, 37748736
    s_barrier
    s_mov_b32 s26, 0x10010000
    s_mov_b32 s3, s26
    s_mul_i32 s27, s20, 5120
    s_add_u32 s48, s27, 167772160
    s_sub_u32 s49, 167777280, s27
    s_mov_b32 m0, 13312
    s_nop 0
    buffer_load_dwordx4 v0, s[8:11], s48 offen offset:0 sc1 lds
    buffer_load_dwordx4 v0, s[8:11], s48 offen offset:1024 sc1 lds
    buffer_load_dwordx4 v0, s[8:11], s48 offen offset:2048 sc1 lds
    s_and_b32 s55, s44, 3
    s_mul_i32 s55, s55, 167936
    s_add_u32 s55, s55, s34
    s_add_u32 s58, s55, s35
    s_and_b32 s57, s44, 63
    s_sub_u32 s61, s3, 4096
    ds_read_b128 v[56:59], v5 offset:0
    ds_read_b128 v[60:63], v5 offset:1024
    ds_read_b128 v[64:67], v5 offset:2048
    ds_read_b128 v[68:71], v5 offset:3072
    v_mov_b64 v[12:13], 0
    v_mov_b64 v[14:15], 0
    v_mov_b64 v[16:17], 0
    v_mov_b64 v[18:19], 0
    v_mov_b64 v[20:21], 0
    v_mov_b64 v[22:23], 0
    v_mov_b64 v[24:25], 0
    v_mov_b64 v[26:27], 0
    v_mov_b64 v[28:29], 0
    v_mov_b64 v[30:31], 0
    v_mov_b64 v[32:33], 0
    v_mov_b64 v[34:35], 0
    s_mov_b32 s70, 0
    s_waitcnt vmcnt(0) lgkmcnt(0)
M_c1_2_top:
    s_waitcnt vmcnt(6)
    s_barrier
    ds_read_b128 v[36:39], v6 offset:13312
    ds_read_b128 v[40:43], v6 offset:14336
    s_mov_b32 m0, 8192
    s_nop 0
    buffer_load_dwordx4 v0, s[8:11], s49 offen offset:3072 sc1 lds
M_c1_2_lr_r:
    s_waitcnt lgkmcnt(1)
    v_smfmac_f32_16x16x64_bf16 v[20:23], v[36:39], v[56:63], v1
    ds_read_b128 v[56:59], v5 offset:4096
    v_smfmac_f32_16x16x64_bf16 v[24:27], v[36:39], v[64:71], v1
    ds_read_b128 v[60:63], v5 offset:5120
    v_smfmac_f32_16x16x64_bf16 v[28:31], v[36:39], a[248:255], v1
    ds_read_b128 v[64:67], v5 offset:6144
    v_smfmac_f32_16x16x64_bf16 v[32:35], v[36:39], a[240:247], v1
    ds_read_b128 v[68:71], v5 offset:7168
    v_smfmac_f32_16x16x64_bf16 v[12:15], v[36:39], a[232:239], v1
    ds_read_b128 v[44:47], v6 offset:15360
    s_waitcnt lgkmcnt(3)
    v_smfmac_f32_16x16x64_bf16 v[16:19], v[36:39], v[56:63], v1
    ds_read_b128 v[56:59], v5 offset:8192
    v_smfmac_f32_16x16x64_bf16 v[20:23], v[40:43], a[224:231], v1
    ds_read_b128 v[60:63], v5 offset:9216
    v_smfmac_f32_16x16x64_bf16 v[24:27], v[40:43], a[216:223], v1
    ds_read_b128 v[48:51], v6 offset:16384
    s_waitcnt lgkmcnt(4)
    v_smfmac_f32_16x16x64_bf16 v[28:31], v[40:43], v[64:71], v1
    ds_read_b128 v[64:67], v5 offset:10240
    v_smfmac_f32_16x16x64_bf16 v[32:35], v[40:43], a[208:215], v1
    ds_read_b128 v[68:71], v5 offset:11264
    v_smfmac_f32_16x16x64_bf16 v[12:15], v[40:43], a[200:207], v1
    ds_read_b128 v[52:55], v6 offset:17408
    s_waitcnt lgkmcnt(6)
    s_waitcnt lgkmcnt(4)
    v_max3_u32 v10, v36, v40, v44
    v_smfmac_f32_16x16x64_bf16 v[16:19], v[40:43], v[56:63], v1
    ds_read_b128 v[56:59], v5 offset:12288
    s_waitcnt lgkmcnt(1)
    v_max3_u32 v10, v10, v48, v52
    v_smfmac_f32_16x16x64_bf16 v[20:23], v[44:47], a[192:199], v1
    ds_read_b128 v[60:63], v5 offset:13312
    v_cmp_eq_u32 vcc, -1, v10
    v_smfmac_f32_16x16x64_bf16 v[24:27], v[44:47], a[184:191], v1
    s_cbranch_vccnz M_c1_2_lr
    v_smfmac_f32_16x16x64_bf16 v[28:31], v[44:47], v[64:71], v1
    ds_read_b128 v[64:67], v5 offset:14336
    v_smfmac_f32_16x16x64_bf16 v[32:35], v[44:47], a[176:183], v1
    ds_read_b128 v[68:71], v5 offset:15360
    v_smfmac_f32_16x16x64_bf16 v[20:23], v[48:51], a[168:175], v1
    s_waitcnt lgkmcnt(2)
    v_smfmac_f32_16x16x64_bf16 v[24:27], v[48:51], v[56:63], v1
    ds_read_b128 v[56:59], v5 offset:16384
    v_smfmac_f32_16x16x64_bf16 v[28:31], v[48:51], a[160:167], v1
    ds_read_b128 v[60:63], v5 offset:17408
    v_smfmac_f32_16x16x64_bf16 v[32:35], v[48:51], a[152:159], v1
    s_waitcnt vmcnt(0)
    s_barrier
    ds_read_b128 v[36:39], v6 offset:8192
    ds_read_b128 v[40:43], v6 offset:9216
    s_waitcnt lgkmcnt(4)
    v_smfmac_f32_16x16x64_bf16 v[20:23], v[52:55], v[64:71], v1
    ds_read_b128 v[44:47], v6 offset:10240
    ds_read_b128 v[48:51], v6 offset:11264
    v_smfmac_f32_16x16x64_bf16 v[24:27], v[52:55], a[144:151], v1
    ds_read_b32 v11, v6 offset:12288
    ds_read_b128 v[64:67], v5 offset:18432
    v_smfmac_f32_16x16x64_bf16 v[28:31], v[52:55], a[136:143], v1
    ds_read_b128 v[68:71], v5 offset:19456
    s_waitcnt lgkmcnt(4)
    v_max3_u32 v10, v36, v40, v44
    v_smfmac_f32_16x16x64_bf16 v[32:35], v[52:55], v[56:63], v1
    s_waitcnt lgkmcnt(2)
    v_max3_u32 v10, v10, v48, v11
    v_cmp_eq_u32 vcc, -1, v10
    s_cbranch_vccnz M_c1_2_rr
M_c1_2_rr_r:
    s_mov_b32 m0, 23040
    ds_read_b128 v[52:55], v6 offset:12288
    buffer_store_dwordx4 v[76:79], v0, s[8:11], s4 offen offset:2048 sc1
    s_mov_b32 s4, 0x10000000
    buffer_load_dword v9, s[8:11], s61 offen sc1 lds
    v_smfmac_f32_16x16x64_bf16 v[20:23], v[36:39], a[128:135], v1
    ds_read_b128 v[56:59], v5 offset:20480
    v_smfmac_f32_16x16x64_bf16 v[24:27], v[36:39], a[120:127], v1
    ds_read_b128 v[60:63], v5 offset:21504
    s_waitcnt lgkmcnt(3)
    v_smfmac_f32_16x16x64_bf16 v[20:23], v[40:43], v[64:71], v1
    ds_read_b128 v[64:67], v5 offset:22528
    v_smfmac_f32_16x16x64_bf16 v[24:27], v[40:43], a[112:119], v1
    ds_read_b128 v[68:71], v5 offset:23552
    v_smfmac_f32_16x16x64_bf16 v[20:23], v[44:47], a[104:111], v1
    s_waitcnt lgkmcnt(2)
    v_smfmac_f32_16x16x64_bf16 v[24:27], v[44:47], v[56:63], v1
    ds_read_b128 v[56:59], v5 offset:24576
    v_smfmac_f32_16x16x64_bf16 v[20:23], v[48:51], a[96:103], v1
    ds_read_b128 v[60:63], v5 offset:25600
    v_smfmac_f32_16x16x64_bf16 v[24:27], v[48:51], a[88:95], v1
    s_waitcnt lgkmcnt(2)
    v_smfmac_f32_16x16x64_bf16 v[20:23], v[52:55], v[64:71], v1
    ds_read_b128 v[64:67], v5 offset:26624
    v_smfmac_f32_16x16x64_bf16 v[24:27], v[52:55], a[80:87], v1
    ds_read_b128 v[68:71], v5 offset:27648
    v_smfmac_f32_16x16x64_bf16 v[28:31], v[36:39], a[72:79], v1
    s_waitcnt lgkmcnt(2)
    v_smfmac_f32_16x16x64_bf16 v[32:35], v[36:39], v[56:63], v1
    ds_read_b128 v[56:59], v5 offset:28672
    s_nop 0
    v_permlane32_swap_b32 v20, v21
    v_smfmac_f32_16x16x64_bf16 v[28:31], v[40:43], a[64:71], v1
    ds_read_b128 v[60:63], v5 offset:29696
    v_permlane32_swap_b32 v22, v23
    v_smfmac_f32_16x16x64_bf16 v[32:35], v[40:43], a[56:63], v1
    s_waitcnt lgkmcnt(2)
    v_permlane32_swap_b32 v24, v25
    v_smfmac_f32_16x16x64_bf16 v[28:31], v[44:47], v[64:71], v1
    ds_read_b128 v[64:67], v5 offset:30720
    v_permlane32_swap_b32 v26, v27
    v_smfmac_f32_16x16x64_bf16 v[32:35], v[44:47], a[48:55], v1
    ds_read_b128 v[68:71], v5 offset:31744
    v_add_f32 v20, v20, v21
    v_add_f32 v22, v22, v23
    v_smfmac_f32_16x16x64_bf16 v[28:31], v[48:51], a[40:47], v1
    s_waitcnt lgkmcnt(2)
    v_add_f32 v24, v24, v25
    v_add_f32 v26, v26, v27
    v_smfmac_f32_16x16x64_bf16 v[32:35], v[48:51], v[56:63], v1
    ds_read_b128 v[56:59], v5 offset:32768
    v_mul_f32 v20, s40, v20
    v_mul_f32 v24, s40, v24
    v_smfmac_f32_16x16x64_bf16 v[28:31], v[52:55], a[32:39], v1
    ds_read_b128 v[60:63], v5 offset:33792
    v_mul_f32 v22, s40, v22
    v_mul_f32 v26, s40, v26
    v_smfmac_f32_16x16x64_bf16 v[32:35], v[52:55], a[24:31], v1
    s_waitcnt lgkmcnt(2)
    v_cvt_pk_bf16_f32 v20, v20, v24
    v_cvt_pk_bf16_f32 v21, v22, v26
    v_smfmac_f32_16x16x64_bf16 v[12:15], v[36:39], v[64:71], v1
    s_cmp_eq_u32 s57, 0
    s_cbranch_scc1 M_c1_2_first
M_c1_2_first_r:
    ds_write_b32 v2, v20 offset:18432
    v_smfmac_f32_16x16x64_bf16 v[16:19], v[36:39], a[16:23], v1
    ds_write_b32 v2, v21 offset:19008
    v_permlane32_swap_b32 v28, v29
    v_smfmac_f32_16x16x64_bf16 v[12:15], v[40:43], a[8:15], v1
    ds_read_b128 v[36:39], v6 offset:15360
    s_waitcnt lgkmcnt(3)
    v_permlane32_swap_b32 v30, v31
    v_smfmac_f32_16x16x64_bf16 v[16:19], v[40:43], v[56:63], v1
    ds_read_b128 v[64:67], v0 offset:2048
    v_permlane32_swap_b32 v32, v33
    v_smfmac_f32_16x16x64_bf16 v[12:15], v[44:47], a[0:7], v1
    ds_read_b128 v[68:71], v0 offset:3072
    v_permlane32_swap_b32 v34, v35
    v_smfmac_f32_16x16x64_bf16 v[16:19], v[44:47], v[248:255], v1
    s_waitcnt lgkmcnt(3)
    s_barrier
    ds_read_b128 v[40:43], v6 offset:16384
    v_add_f32 v28, v28, v29
    v_add_f32 v30, v30, v31
    v_smfmac_f32_16x16x64_bf16 v[12:15], v[48:51], v[240:247], v1
    ds_read_b128 v[56:59], v0 offset:0
    v_add_f32 v32, v32, v33
    v_add_f32 v34, v34, v35
    v_smfmac_f32_16x16x64_bf16 v[16:19], v[48:51], v[232:239], v1
    ds_read_b128 v[60:63], v0 offset:1024
    v_cvt_pk_bf16_f32 v28, v28, v32
    v_cvt_pk_bf16_f32 v29, v30, v34
    v_smfmac_f32_16x16x64_bf16 v[12:15], v[52:55], v[224:231], v1
    ds_write_b32 v2, v28 offset:20736
    ds_read_b128 v[20:23], v3 offset:18432
    v_smfmac_f32_16x16x64_bf16 v[16:19], v[52:55], v[216:223], v1
    ds_write_b32 v2, v29 offset:21312
    ds_read_b128 v[24:27], v3 offset:18496
    s_waitcnt lgkmcnt(9)
    v_smfmac_f32_16x16x64_bf16 v[12:15], v[36:39], v[208:215], v1
    ds_read_b128 v[72:75], v3 offset:18560
    ds_read_b128 v[44:47], v3 offset:18624
    v_smfmac_f32_16x16x64_bf16 v[16:19], v[36:39], v[200:207], v1
    ds_read_b128 v[48:51], v6 offset:17408
    s_waitcnt lgkmcnt(9)
    v_smfmac_f32_16x16x64_bf16 v[12:15], v[40:43], v[192:199], v1
    v_smfmac_f32_16x16x64_bf16 v[16:19], v[40:43], v[184:191], v1
    s_waitcnt lgkmcnt(5)
    v_mfma_f32_16x16x32_bf16 v[28:31], v[56:59], v[20:23], 0
    ds_read_b128 v[56:59], v0 offset:4096
    s_waitcnt lgkmcnt(4)
    v_mov_b64 v[52:53], s[24:25]
    v_mfma_f32_16x16x32_bf16 v[28:31], v[60:63], v[24:27], v[28:31]
    ds_read_b128 v[60:63], v0 offset:5120
    s_barrier
    s_waitcnt lgkmcnt(4)
    v_mfma_f32_16x16x32_bf16 v[28:31], v[64:67], v[72:75], v[28:31]
    ds_read_b128 v[64:67], v0 offset:6144
    s_waitcnt lgkmcnt(4)
    v_mov_b64 v[54:55], s[24:25]
    v_mfma_f32_16x16x32_bf16 v[28:31], v[68:71], v[44:47], v[28:31]
    ds_read_b128 v[68:71], v0 offset:7168
    s_waitcnt lgkmcnt(4)
    v_mov_b64 v[10:11], s[16:17]
    v_smfmac_f32_16x16x64_bf16 v[12:15], v[48:51], v[176:183], v1
    ds_read_b128 v[36:39], v3 offset:20736
    v_smfmac_f32_16x16x64_bf16 v[16:19], v[48:51], v[168:175], v1
    ds_read_b128 v[40:43], v3 offset:20800
    s_waitcnt lgkmcnt(4)
    v_mfma_f32_16x16x32_bf16 v[32:35], v[56:59], v[20:23], 0
    v_exp_f32 v28, v28
    v_mfma_f32_16x16x32_bf16 v[32:35], v[60:63], v[24:27], v[32:35]
    s_waitcnt lgkmcnt(2)
    v_exp_f32 v29, v29
    ds_read_b128 v[56:59], v3 offset:20864
    v_mfma_f32_16x16x32_bf16 v[32:35], v[64:67], v[72:75], v[32:35]
    v_exp_f32 v30, v30
    ds_read_b128 v[60:63], v3 offset:20928
    v_mfma_f32_16x16x32_bf16 v[32:35], v[68:71], v[44:47], v[32:35]
    s_waitcnt lgkmcnt(3)
    v_exp_f32 v31, v31
    v_mfma_f32_16x16x32_bf16 v[48:51], v[36:39], v[20:23], 0
    s_waitcnt lgkmcnt(2)
    v_cvt_pk_bf16_f32 v28, v28, v29
    v_cvt_pk_bf16_f32 v29, v30, v31
    v_mfma_f32_16x16x32_bf16 v[48:51], v[40:43], v[24:27], v[48:51]
    s_waitcnt lgkmcnt(1)
    v_cvt_pk_bf16_f32 v12, v12, v13
    v_cvt_pk_bf16_f32 v13, v14, v15
    v_mfma_f32_16x16x32_bf16 v[48:51], v[56:59], v[72:75], v[48:51]
    s_waitcnt lgkmcnt(0)
    v_exp_f32 v32, v32
    v_mfma_f32_16x16x32_bf16 v[48:51], v[60:63], v[44:47], v[48:51]
    v_exp_f32 v33, v33
    v_exp_f32 v34, v34
    v_exp_f32 v35, v35
    v_cvt_pk_bf16_f32 v30, v32, v33
    v_cvt_pk_bf16_f32 v31, v34, v35
    v_cvt_pk_bf16_f32 v14, v16, v17
    v_cvt_pk_bf16_f32 v15, v18, v19
    v_mfma_f32_16x16x32_bf16 v[72:75], v[52:55], v[28:31], 0
    v_exp_f32 v48, v48
    v_mfma_f32_16x16x32_bf16 v[20:23], v[80:83], v[28:31], 0
    v_exp_f32 v49, v49
    v_mfma_f32_16x16x32_bf16 v[24:27], v[84:87], v[28:31], 0
    v_exp_f32 v50, v50
    v_exp_f32 v51, v51
    v_cvt_pk_bf16_f32 v48, v48, v49
    v_cvt_pk_bf16_f32 v49, v50, v51
    v_cndmask_b32_e64 v76, v12, v56, s[66:67]
    v_cndmask_b32_e64 v77, v13, v57, s[66:67]
M_c1_2_fin:
    v_mfma_f32_16x16x16_bf16 v[72:75], v[10:11], v[48:49], v[72:75]
    v_cndmask_b32_e64 v78, v14, v58, s[66:67]
    v_cndmask_b32_e64 v79, v15, v59, s[66:67]
    v_mfma_f32_16x16x16_bf16 v[20:23], v[12:13], v[48:49], v[20:23]
    s_cmp_eq_u32 s57, 63
    v_mov_b64 v[44:45], 0
    v_mov_b64 v[46:47], 0
    v_mfma_f32_16x16x16_bf16 v[24:27], v[14:15], v[48:49], v[24:27]
    s_cbranch_scc1 M_c1_2_last
    v_mov_b64 v[68:69], 0
    v_rcp_f32 v74, v72
    v_subrev_u32 v73, s68, v72
    v_cmp_lt_u32 vcc, s69, v73
    v_mov_b64 v[70:71], 0
    v_mov_b32 v5, v5
    v_mov_b32 v5, v5
    v_cndmask_b32_e64 v20, v20, v24, s[18:19]
    v_cndmask_b32_e64 v21, v21, v25, s[18:19]
    v_cndmask_b32_e64 v22, v22, v26, s[18:19]
    v_cndmask_b32_e64 v23, v23, v27, s[18:19]
    v_pk_mul_f32 v[20:21], v[20:21], v[74:75] op_sel_hi:[1,0]
    v_pk_mul_f32 v[22:23], v[22:23], v[74:75] op_sel_hi:[1,0]
    v_cvt_pk_bf16_f32 v20, v20, v21
    v_cvt_pk_bf16_f32 v21, v22, v23
    ds_write_b64 v0, v[20:21] offset:14336
    s_cbranch_vccnz M_c1_2_zbad
M_c1_2_zok:
    s_cmp_eq_u32 s57, 0
    s_cbranch_scc1 M_c1_2_first2
M_c1_2_first2_r:
    buffer_load_dwordx4 v[80:83], v0, s[8:11], s3 offen offset:0 sc1
    buffer_load_dwordx4 v[84:87], v0, s[8:11], s3 offen offset:1024 sc1
    s_waitcnt lgkmcnt(0)
    s_barrier
    ds_read_b128 v[32:35], v0 offset:13312
    ds_read_b128 v[40:43], v0 offset:14336
    s_mov_b32 m0, 4096
    s_nop 0
    buffer_load_dwordx4 v0, s[8:11], s26 offen offset:0 sc1 lds
    buffer_load_dwordx4 v0, s[8:11], s26 offen offset:1024 sc1 lds
    v_mov_b64 v[64:65], 0
    v_mov_b64 v[66:67], 0
    v_mov_b64 v[60:61], 0
    v_mov_b64 v[62:63], 0
    v_mov_b64 v[56:57], 0
    v_mov_b64 v[58:59], 0
    s_waitcnt lgkmcnt(1)
    s_nop 0
    v_smfmac_f32_16x16x64_bf16 v[56:59], v[32:35], v[160:167], v1
    v_smfmac_f32_16x16x64_bf16 v[60:63], v[32:35], v[144:151], v1
    s_waitcnt lgkmcnt(0)
    v_smfmac_f32_16x16x64_bf16 v[56:59], v[40:43], v[152:159], v1
    v_smfmac_f32_16x16x64_bf16 v[60:63], v[40:43], v[136:143], v1
    v_smfmac_f32_16x16x64_bf16 v[64:67], v[32:35], v[128:135], v1
    v_smfmac_f32_16x16x64_bf16 v[68:71], v[32:35], v[112:119], v1
    v_permlane32_swap_b32 v56, v57
    v_smfmac_f32_16x16x64_bf16 v[64:67], v[40:43], v[120:127], v1
    v_permlane32_swap_b32 v58, v59
    v_smfmac_f32_16x16x64_bf16 v[68:71], v[40:43], v[104:111], v1
    v_add_f32 v56, v56, v57
    v_add_f32 v58, v58, v59
    v_smfmac_f32_16x16x64_bf16 v[44:47], v[32:35], v[96:103], v1
    v_permlane32_swap_b32 v60, v61
    v_smfmac_f32_16x16x64_bf16 v[44:47], v[40:43], v[88:95], v1
    v_permlane32_swap_b32 v62, v63
    v_add_f32 v60, v60, v61
    v_add_f32 v62, v62, v63
    v_cvt_pk_bf16_f32 v36, v56, v60
    v_cvt_pk_bf16_f32 v38, v58, v62
    v_permlane32_swap_b32 v64, v65
    v_permlane32_swap_b32 v66, v67
    v_add_f32 v64, v64, v65
    v_add_f32 v66, v66, v67
    v_permlane32_swap_b32 v68, v69
    v_permlane32_swap_b32 v70, v71
    v_add_f32 v68, v68, v69
    v_add_f32 v70, v70, v71
    v_cvt_pk_bf16_f32 v37, v64, v68
    v_cvt_pk_bf16_f32 v39, v66, v70
    buffer_store_dwordx4 v[36:39], v0, s[8:11], s58 offen sc1
    v_permlane32_swap_b32 v44, v45
    v_permlane32_swap_b32 v46, v47
    v_add_f32 v44, v44, v45
    v_add_f32 v46, v46, v47
    v_cvt_pk_bf16_f32 v44, v44, v46
    buffer_store_dword v44, v7, s[8:11], s55 offen sc1
    s_add_u32 s27, s44, 1
    s_and_b32 s27, s27, 3
    s_mul_i32 s48, s27, 5120
    s_add_u32 s48, s48, s41
    s_lshl_b32 s27, s27, 15
    s_add_u32 s49, s27, s47
    ds_read_b128 v[56:59], v5 offset:0
    ds_read_b128 v[60:63], v5 offset:1024
    ds_read_b128 v[64:67], v5 offset:2048
    ds_read_b128 v[68:71], v5 offset:3072
    v_mov_b64 v[12:13], 0
    v_mov_b64 v[14:15], 0
    v_mov_b64 v[16:17], 0
    v_mov_b64 v[18:19], 0
    v_mov_b64 v[20:21], 0
    v_mov_b64 v[22:23], 0
    v_mov_b64 v[24:25], 0
    v_mov_b64 v[26:27], 0
    v_mov_b64 v[28:29], 0
    v_mov_b64 v[30:31], 0
    v_mov_b64 v[32:33], 0
    v_mov_b64 v[34:35], 0
    s_barrier
    s_and_b32 s26, s44, 63
    s_add_u32 s26, s26, 2
    s_min_u32 s26, s26, 63
    s_lshl_b32 s26, s26, 18
    s_add_u32 s26, s26, s50
    s_add_u32 s26, s26, 4096
    s_add_u32 s3, s26, 16777216
    s_lshl_b32 s4, s44, 18
    s_add_u32 s4, s4, s53
    s_add_u32 s44, s44, 1
    s_and_b32 s55, s44, 3
    s_mul_i32 s55, s55, 167936
    s_add_u32 s55, s55, s34
    s_add_u32 s58, s55, s35
    s_and_b32 s57, s44, 63
    s_sub_u32 s61, s3, 4096
    s_nop 15
    s_nop 15
    s_nop 7
    s_mov_b32 m0, 13312
    s_nop 0
    buffer_load_dwordx4 v0, s[8:11], s48 offen offset:0 sc1 lds
    buffer_load_dwordx4 v0, s[8:11], s48 offen offset:1024 sc1 lds
    buffer_load_dwordx4 v0, s[8:11], s48 offen offset:2048 sc1 lds
    s_nop 11
    s_mov_b32 m0, 13312
    s_nop 0
    buffer_load_dwordx4 v0, s[8:11], s48 offen offset:0 sc1 lds
    buffer_load_dwordx4 v0, s[8:11], s48 offen offset:1024 sc1 lds
    buffer_load_dwordx4 v0, s[8:11], s48 offen offset:2048 sc1 lds
    s_nop 11
    s_mov_b32 m0, 13312
    s_nop 0
    buffer_load_dwordx4 v0, s[8:11], s48 offen offset:0 sc1 lds
    buffer_load_dwordx4 v0, s[8:11], s48 offen offset:1024 sc1 lds
    buffer_load_dwordx4 v0, s[8:11], s48 offen offset:2048 sc1 lds
    s_mov_b32 s70, 0
    s_waitcnt lgkmcnt(0)
    s_branch M_c1_2_top
M_c1_2_restart:
    s_waitcnt vmcnt(0) lgkmcnt(0)
    s_nop 7
    s_barrier
    s_mov_b32 m0, 13312
    s_nop 0
    buffer_load_dwordx4 v0, s[8:11], s48 offen offset:0 sc1 lds
    buffer_load_dwordx4 v0, s[8:11], s48 offen offset:1024 sc1 lds
    buffer_load_dwordx4 v0, s[8:11], s48 offen offset:2048 sc1 lds
    ds_read_b128 v[56:59], v5 offset:0
    ds_read_b128 v[60:63], v5 offset:1024
    ds_read_b128 v[64:67], v5 offset:2048
    ds_read_b128 v[68:71], v5 offset:3072
    v_mov_b64 v[12:13], 0
    v_mov_b64 v[14:15], 0
    v_mov_b64 v[16:17], 0
    v_mov_b64 v[18:19], 0
    v_mov_b64 v[20:21], 0
    v_mov_b64 v[22:23], 0
    v_mov_b64 v[24:25], 0
    v_mov_b64 v[26:27], 0
    v_mov_b64 v[28:29], 0
    v_mov_b64 v[30:31], 0
    v_mov_b64 v[32:33], 0
    v_mov_b64 v[34:35], 0
    s_waitcnt vmcnt(0) lgkmcnt(0)
    s_branch M_c1_2_top
M_c1_2_zbad:
    s_cmp_eq_u32 s70, 2
    s_cbranch_scc1 M_c1_2_zok
    v_cmp_u_f32 vcc, v72, v72
    s_cbranch_vccz M_c1_2_exact
    s_cmp_eq_u32 s70, 1
    s_cbranch_scc1 M_c1_2_exact
M_c1_2_vfy0:
    s_mov_b32 s70, 1
    s_mov_b32 s30, 0
    s_waitcnt vmcnt(0) lgkmcnt(0)
    s_nop 7
M_c1_2_vfy:
    v_mov_b32 v10, 0
    s_add_u32 s59, s48, 4096
    buffer_load_dwordx4 v[36:39], v0, s[8:11], s48 offen offset:0 sc1
    buffer_load_dwordx4 v[40:43], v0, s[8:11], s48 offen offset:1024 sc1
    buffer_load_dwordx4 v[44:47], v0, s[8:11], s48 offen offset:2048 sc1
    buffer_load_dwordx4 v[48:51], v0, s[8:11], s48 offen offset:3072 sc1
    buffer_load_dwordx4 v[52:55], v0, s[8:11], s59 offen offset:0 sc1
    s_waitcnt vmcnt(4)
    v_max3_u32 v10, v10, v36, v37
    v_max3_u32 v10, v10, v38, v39
    s_waitcnt vmcnt(3)
    v_max3_u32 v10, v10, v40, v41
    v_max3_u32 v10, v10, v42, v43
    s_waitcnt vmcnt(2)
    v_max3_u32 v10, v10, v44, v45
    v_max3_u32 v10, v10, v46, v47
    s_waitcnt vmcnt(1)
    v_max3_u32 v10, v10, v48, v49
    v_max3_u32 v10, v10, v50, v51
    s_waitcnt vmcnt(0)
    v_max3_u32 v10, v10, v52, v53
    v_max3_u32 v10, v10, v54, v55
    s_add_u32 s59, s49, 4096
    buffer_load_dwordx4 v[36:39], v0, s[8:11], s49 offen offset:0 sc1
    buffer_load_dwordx4 v[40:43], v0, s[8:11], s49 offen offset:1024 sc1
    buffer_load_dwordx4 v[44:47], v0, s[8:11], s49 offen offset:2048 sc1
    buffer_load_dwordx4 v[48:51], v0, s[8:11], s49 offen offset:3072 sc1
    buffer_load_dwordx4 v[52:55], v0, s[8:11], s59 offen offset:0 sc1
    s_waitcnt vmcnt(4)
    v_max3_u32 v10, v10, v36, v37
    v_max3_u32 v10, v10, v38, v39
    s_waitcnt vmcnt(3)
    v_max3_u32 v10, v10, v40, v41
    v_max3_u32 v10, v10, v42, v43
    s_waitcnt vmcnt(2)
    v_max3_u32 v10, v10, v44, v45
    v_max3_u32 v10, v10, v46, v47
    s_waitcnt vmcnt(1)
    v_max3_u32 v10, v10, v48, v49
    v_max3_u32 v10, v10, v50, v51
    s_waitcnt vmcnt(0)
    v_max3_u32 v10, v10, v52, v53
    v_max3_u32 v10, v10, v54, v55
    v_cmp_eq_u32 vcc, -1, v10
    s_cbranch_vccz M_c1_2_restart
    s_add_u32 s30, s30, 1
    s_cmp_ge_u32 s30, 60000
    s_cbranch_scc1 M_fail
    s_branch M_c1_2_vfy
M_c1_2_exact:
    s_nop 7
    s_mov_b32 s70, 2
    s_waitcnt lgkmcnt(0)
    ds_read_b128 v[20:23], v3 offset:18432
    ds_read_b128 v[24:27], v3 offset:18496
    ds_read_b128 v[72:75], v3 offset:18560
    ds_read_b128 v[44:47], v3 offset:18624
    ds_read_b128 v[56:59], v0 offset:0
    s_waitcnt lgkmcnt(0)
    v_mfma_f32_16x16x32_bf16 v[28:31], v[56:59], v[20:23], 0
    s_nop 3
    ds_read_b128 v[60:63], v0 offset:1024
    s_waitcnt lgkmcnt(0)
    v_mfma_f32_16x16x32_bf16 v[28:31], v[60:63], v[24:27], v[28:31]
    s_nop 3
    ds_read_b128 v[56:59], v0 offset:2048
    s_waitcnt lgkmcnt(0)
    v_mfma_f32_16x16x32_bf16 v[28:31], v[56:59], v[72:75], v[28:31]
    s_nop 3
    ds_read_b128 v[60:63], v0 offset:3072
    s_waitcnt lgkmcnt(0)
    v_mfma_f32_16x16x32_bf16 v[28:31], v[60:63], v[44:47], v[28:31]
    s_nop 3
    ds_read_b128 v[56:59], v0 offset:4096
    s_waitcnt lgkmcnt(0)
    v_mfma_f32_16x16x32_bf16 v[32:35], v[56:59], v[20:23], 0
    s_nop 3
    ds_read_b128 v[60:63], v0 offset:5120
    s_waitcnt lgkmcnt(0)
    v_mfma_f32_16x16x32_bf16 v[32:35], v[60:63], v[24:27], v[32:35]
    s_nop 3
    ds_read_b128 v[56:59], v0 offset:6144
    s_waitcnt lgkmcnt(0)
    v_mfma_f32_16x16x32_bf16 v[32:35], v[56:59], v[72:75], v[32:35]
    s_nop 3
    ds_read_b128 v[60:63], v0 offset:7168
    s_waitcnt lgkmcnt(0)
    v_mfma_f32_16x16x32_bf16 v[32:35], v[60:63], v[44:47], v[32:35]
    s_nop 3
    ds_read_b128 v[56:59], v3 offset:20736
    s_waitcnt lgkmcnt(0)
    v_mfma_f32_16x16x32_bf16 v[48:51], v[56:59], v[20:23], 0
    s_nop 3
    ds_read_b128 v[60:63], v3 offset:20800
    s_waitcnt lgkmcnt(0)
    v_mfma_f32_16x16x32_bf16 v[48:51], v[60:63], v[24:27], v[48:51]
    s_nop 3
    ds_read_b128 v[56:59], v3 offset:20864
    s_waitcnt lgkmcnt(0)
    v_mfma_f32_16x16x32_bf16 v[48:51], v[56:59], v[72:75], v[48:51]
    s_nop 3
    ds_read_b128 v[60:63], v3 offset:20928
    s_waitcnt lgkmcnt(0)
    v_mfma_f32_16x16x32_bf16 v[48:51], v[60:63], v[44:47], v[48:51]
    s_nop 3
    v_max3_f32 v64, v28, v29, v30
    v_max3_f32 v64, v64, v31, v32
    v_max3_f32 v64, v64, v33, v34
    s_nop 0
    v_max3_f32 v64, v64, v35, v48
    v_max3_f32 v64, v64, v49, v50
    v_max_f32 v64, v64, v51
    v_mov_b32 v65, v64
    s_nop 1
    v_permlane16_swap_b32 v64, v65
    v_max_f32 v64, v64, v65
    v_mov_b32 v65, v64
    s_nop 1
    v_permlane32_swap_b32 v64, v65
    v_max_f32 v64, v64, v65
    v_sub_f32 v28, v28, v64
    v_exp_f32 v28, v28
    v_sub_f32 v29, v29, v64
    v_exp_f32 v29, v29
    v_sub_f32 v30, v30, v64
    v_exp_f32 v30, v30
    v_sub_f32 v31, v31, v64
    v_exp_f32 v31, v31
    v_sub_f32 v32, v32, v64
    v_exp_f32 v32, v32
    v_sub_f32 v33, v33, v64
    v_exp_f32 v33, v33
    v_sub_f32 v34, v34, v64
    v_exp_f32 v34, v34
    v_sub_f32 v35, v35, v64
    v_exp_f32 v35, v35
    v_sub_f32 v48, v48, v64
    v_exp_f32 v48, v48
    v_sub_f32 v49, v49, v64
    v_exp_f32 v49, v49
    v_sub_f32 v50, v50, v64
    v_exp_f32 v50, v50
    v_sub_f32 v51, v51, v64
    v_exp_f32 v51, v51
    v_cvt_pk_bf16_f32 v28, v28, v29
    v_cvt_pk_bf16_f32 v29, v30, v31
    v_cvt_pk_bf16_f32 v30, v32, v33
    v_cvt_pk_bf16_f32 v31, v34, v35
    v_cvt_pk_bf16_f32 v48, v48, v49
    v_cvt_pk_bf16_f32 v49, v50, v51
    v_mfma_f32_16x16x32_bf16 v[20:23], v[80:83], v[28:31], 0
    v_mfma_f32_16x16x32_bf16 v[24:27], v[84:87], v[28:31], 0
    v_mfma_f32_16x16x32_bf16 v[72:75], v[52:55], v[28:31], 0
    ds_read_b128 v[56:59], v3 offset:20864
    s_waitcnt lgkmcnt(0)
    s_nop 7
    s_branch M_c1_2_fin
M_c1_2_last:
    s_cmp_lg_u32 s70, 0
    s_cbranch_scc1 M_c1_2_last2
    v_cmp_u_f32 vcc, v32, v32
    s_cbranch_vccnz M_c1_2_vfy0
M_c1_2_last2:
    s_lshl_b32 s4, s44, 18
    s_add_u32 s4, s4, s53
    buffer_store_dwordx4 v[76:79], v0, s[8:11], s4 offen offset:2048 sc1
    s_mov_b32 s4, 0x10000000
    s_waitcnt vmcnt(0) lgkmcnt(0)
    s_barrier
    s_nop 7
    v_mov_b64 v[72:73], -1
    v_mov_b64 v[74:75], -1
    s_add_u32 s28, s44, 3
    s_and_b32 s29, s28, 3
    s_mul_i32 s31, s22, 160
    s_waitcnt vmcnt(0)
    s_add_u32 s44, s44, 1
    s_cmp_eq_u32 s44, 128
    s_cbranch_scc1 M_end
    s_branch M_c1_2_layer
M_c1_2_lr:
    s_mov_b32 s30, 0
M_c1_2_lr_l:
    s_waitcnt lgkmcnt(0)
    s_and_b32 s27, s30, 1
    s_cbranch_scc0 M_c1_2_lr_n
    s_waitcnt vmcnt(3)
    s_mov_b32 m0, 13312
    s_nop 0
    buffer_load_dwordx4 v0, s[8:11], s48 offen offset:0 sc1 lds
    buffer_load_dwordx4 v0, s[8:11], s48 offen offset:1024 sc1 lds
    buffer_load_dwordx4 v0, s[8:11], s48 offen offset:2048 sc1 lds
M_c1_2_lr_n:
    ds_read_b128 v[36:39], v6 offset:13312
    ds_read_b128 v[40:43], v6 offset:14336
    ds_read_b128 v[44:47], v6 offset:15360
    ds_read_b128 v[48:51], v6 offset:16384
    ds_read_b128 v[52:55], v6 offset:17408
    s_waitcnt lgkmcnt(2)
    v_max3_u32 v10, v36, v40, v44
    s_waitcnt lgkmcnt(0)
    v_max3_u32 v10, v10, v48, v52
    v_cmp_eq_u32 vcc, -1, v10
    s_cbranch_vccz M_c1_2_lr_d
    s_add_u32 s30, s30, 1
    s_cmp_ge_u32 s30, 480000
    s_cbranch_scc1 M_fail
    s_branch M_c1_2_lr_l
M_c1_2_lr_d:
    ds_read_b128 v[56:59], v5 offset:0
    ds_read_b128 v[60:63], v5 offset:1024
    ds_read_b128 v[64:67], v5 offset:2048
    ds_read_b128 v[68:71], v5 offset:3072
    v_mov_b64 v[12:13], 0
    v_mov_b64 v[14:15], 0
    v_mov_b64 v[16:17], 0
    v_mov_b64 v[18:19], 0
    v_mov_b64 v[20:21], 0
    v_mov_b64 v[22:23], 0
    v_mov_b64 v[24:25], 0
    v_mov_b64 v[26:27], 0
    v_mov_b64 v[28:29], 0
    v_mov_b64 v[30:31], 0
    v_mov_b64 v[32:33], 0
    v_mov_b64 v[34:35], 0
    s_waitcnt lgkmcnt(0)
    s_branch M_c1_2_lr_r
M_c1_2_rr:
    s_mov_b32 s30, 0
M_c1_2_rr_l:
    s_waitcnt lgkmcnt(0)
    s_and_b32 s27, s30, 1
    s_cbranch_scc1 M_c1_2_rr_n
    s_waitcnt vmcnt(1)
    s_mov_b32 m0, 8192
    s_nop 0
    buffer_load_dwordx4 v0, s[8:11], s49 offen offset:3072 sc1 lds
M_c1_2_rr_n:
    ds_read_b128 v[36:39], v6 offset:8192
    ds_read_b128 v[40:43], v6 offset:9216
    ds_read_b128 v[44:47], v6 offset:10240
    ds_read_b128 v[48:51], v6 offset:11264
    ds_read_b32 v11, v6 offset:12288
    s_waitcnt lgkmcnt(2)
    v_max3_u32 v10, v36, v40, v44
    s_waitcnt lgkmcnt(0)
    v_max3_u32 v10, v10, v48, v11
    v_cmp_eq_u32 vcc, -1, v10
    s_cbranch_vccz M_c1_2_rr_d
    s_add_u32 s30, s30, 1
    s_cmp_ge_u32 s30, 480000
    s_cbranch_scc1 M_fail
    s_branch M_c1_2_rr_l
M_c1_2_rr_d:
    s_branch M_c1_2_rr_r
M_c1_2_first:
    s_barrier
    s_and_b32 s26, s44, 63
    s_lshl_b32 s26, s26, 18
    s_add_u32 s26, s26, s50
    s_add_u32 s26, s26, 4096
    s_add_u32 s3, s26, 16777216
    s_mov_b32 m0, 4096
    s_nop 0
    buffer_load_dwordx4 v0, s[8:11], s26 offen offset:0 sc1 lds
    buffer_load_dwordx4 v0, s[8:11], s26 offen offset:1024 sc1 lds
    buffer_load_dwordx4 v[80:83], v0, s[8:11], s3 offen offset:0 sc1
    buffer_load_dwordx4 v[84:87], v0, s[8:11], s3 offen offset:1024 sc1
    s_and_b32 s26, s44, 63
    s_add_u32 s26, s26, 1
    s_min_u32 s26, s26, 63
    s_lshl_b32 s26, s26, 18
    s_add_u32 s26, s26, s50
    s_add_u32 s26, s26, 4096
    s_add_u32 s3, s26, 16777216
    s_waitcnt vmcnt(0) lgkmcnt(0)
    s_barrier
    s_branch M_c1_2_first_r
M_c1_2_first2:
    s_barrier
    s_branch M_c1_2_first2_r
M_c1_3_layer:
    s_lshr_b32 s27, s44, 6
    s_mul_i32 s50, s27, 33554432
    s_lshl_b32 s27, s22, 13
    s_add_u32 s50, s50, s27
    s_add_u32 s50, s50, 37748736
    s_barrier
    s_mov_b32 s26, 0x10010000
    s_mov_b32 s3, s26
    s_mul_i32 s27, s20, 5120
    s_add_u32 s48, s27, 167772160
    s_sub_u32 s49, 167777280, s27
    s_mov_b32 m0, 13312
    s_nop 0
    buffer_load_dwordx4 v0, s[8:11], s48 offen offset:3072 sc1 lds
    s_mov_b32 m0, 17408
    s_add_u32 s59, s48, 4096
    buffer_load_dwordx4 v0, s[8:11], s59 offen offset:0 sc1 lds
    s_and_b32 s55, s44, 3
    s_mul_i32 s55, s55, 167936
    s_add_u32 s55, s55, s34
    s_add_u32 s58, s55, s35
    s_and_b32 s57, s44, 63
    s_sub_u32 s61, s26, 6144
    ds_read_b128 v[56:59], v5 offset:0
    ds_read_b128 v[60:63], v5 offset:1024
    ds_read_b128 v[64:67], v5 offset:2048
    ds_read_b128 v[68:71], v5 offset:3072
    v_mov_b64 v[12:13], 0
    v_mov_b64 v[14:15], 0
    v_mov_b64 v[16:17], 0
    v_mov_b64 v[18:19], 0
    v_mov_b64 v[20:21], 0
    v_mov_b64 v[22:23], 0
    v_mov_b64 v[24:25], 0
    v_mov_b64 v[26:27], 0
    v_mov_b64 v[28:29], 0
    v_mov_b64 v[30:31], 0
    v_mov_b64 v[32:33], 0
    v_mov_b64 v[34:35], 0
    s_mov_b32 s70, 0
    s_waitcnt vmcnt(0) lgkmcnt(0)
M_c1_3_top:
    s_waitcnt vmcnt(4)
    s_barrier
    ds_read_b128 v[36:39], v6 offset:13312
    ds_read_b128 v[40:43], v6 offset:14336
    s_mov_b32 m0, 12288
    s_add_u32 s59, s49, 4096
    buffer_load_dwordx4 v0, s[8:11], s59 offen offset:0 sc1 lds
M_c1_3_lr_r:
    s_waitcnt lgkmcnt(1)
    v_smfmac_f32_16x16x64_bf16 v[20:23], v[36:39], v[56:63], v1
    ds_read_b128 v[56:59], v5 offset:4096
    v_smfmac_f32_16x16x64_bf16 v[24:27], v[36:39], v[64:71], v1
    ds_read_b128 v[60:63], v5 offset:5120
    v_smfmac_f32_16x16x64_bf16 v[28:31], v[36:39], a[248:255], v1
    ds_read_b128 v[64:67], v5 offset:6144
    v_smfmac_f32_16x16x64_bf16 v[32:35], v[36:39], a[240:247], v1
    ds_read_b128 v[68:71], v5 offset:7168
    v_smfmac_f32_16x16x64_bf16 v[12:15], v[36:39], a[232:239], v1
    ds_read_b128 v[44:47], v6 offset:15360
    s_waitcnt lgkmcnt(3)
    v_smfmac_f32_16x16x64_bf16 v[16:19], v[36:39], v[56:63], v1
    ds_read_b128 v[56:59], v5 offset:8192
    v_smfmac_f32_16x16x64_bf16 v[20:23], v[40:43], a[224:231], v1
    ds_read_b128 v[60:63], v5 offset:9216
    v_smfmac_f32_16x16x64_bf16 v[24:27], v[40:43], a[216:223], v1
    ds_read_b128 v[48:51], v6 offset:16384
    s_waitcnt lgkmcnt(4)
    v_smfmac_f32_16x16x64_bf16 v[28:31], v[40:43], v[64:71], v1
    ds_read_b128 v[64:67], v5 offset:10240
    v_smfmac_f32_16x16x64_bf16 v[32:35], v[40:43], a[208:215], v1
    ds_read_b128 v[68:71], v5 offset:11264
    v_smfmac_f32_16x16x64_bf16 v[12:15], v[40:43], a[200:207], v1
    ds_read_b128 v[52:55], v6 offset:17408
    s_waitcnt lgkmcnt(6)
    s_waitcnt lgkmcnt(4)
    v_max3_u32 v10, v36, v40, v44
    v_smfmac_f32_16x16x64_bf16 v[16:19], v[40:43], v[56:63], v1
    ds_read_b128 v[56:59], v5 offset:12288
    s_waitcnt lgkmcnt(1)
    v_max3_u32 v10, v10, v48, v52
    v_smfmac_f32_16x16x64_bf16 v[20:23], v[44:47], a[192:199], v1
    ds_read_b128 v[60:63], v5 offset:13312
    v_cmp_eq_u32 vcc, -1, v10
    v_smfmac_f32_16x16x64_bf16 v[24:27], v[44:47], a[184:191], v1
    s_cbranch_vccnz M_c1_3_lr
    v_smfmac_f32_16x16x64_bf16 v[28:31], v[44:47], v[64:71], v1
    ds_read_b128 v[64:67], v5 offset:14336
    v_smfmac_f32_16x16x64_bf16 v[32:35], v[44:47], a[176:183], v1
    ds_read_b128 v[68:71], v5 offset:15360
    v_smfmac_f32_16x16x64_bf16 v[20:23], v[48:51], a[168:175], v1
    s_waitcnt lgkmcnt(2)
    v_smfmac_f32_16x16x64_bf16 v[24:27], v[48:51], v[56:63], v1
    ds_read_b128 v[56:59], v5 offset:16384
    v_smfmac_f32_16x16x64_bf16 v[28:31], v[48:51], a[160:167], v1
    ds_read_b128 v[60:63], v5 offset:17408
    v_smfmac_f32_16x16x64_bf16 v[32:35], v[48:51], a[152:159], v1
    s_waitcnt vmcnt(0)
    s_barrier
    ds_read_b128 v[36:39], v6 offset:8192
    ds_read_b128 v[40:43], v6 offset:9216
    s_waitcnt lgkmcnt(4)
    v_smfmac_f32_16x16x64_bf16 v[20:23], v[52:55], v[64:71], v1
    ds_read_b128 v[44:47], v6 offset:10240
    ds_read_b128 v[48:51], v6 offset:11264
    v_smfmac_f32_16x16x64_bf16 v[24:27], v[52:55], a[144:151], v1
    ds_read_b32 v11, v6 offset:12288
    ds_read_b128 v[64:67], v5 offset:18432
    v_smfmac_f32_16x16x64_bf16 v[28:31], v[52:55], a[136:143], v1
    ds_read_b128 v[68:71], v5 offset:19456
    s_waitcnt lgkmcnt(4)
    v_max3_u32 v10, v36, v40, v44
    v_smfmac_f32_16x16x64_bf16 v[32:35], v[52:55], v[56:63], v1
    s_waitcnt lgkmcnt(2)
    v_max3_u32 v10, v10, v48, v11
    v_cmp_eq_u32 vcc, -1, v10
    s_cbranch_vccnz M_c1_3_rr
M_c1_3_rr_r:
    s_mov_b32 m0, 23040
    ds_read_b128 v[52:55], v6 offset:12288
    buffer_store_dwordx4 v[76:79], v0, s[8:11], s4 offen offset:3072 sc1
    s_mov_b32 s4, 0x10000000
    buffer_load_dword v9, s[8:11], s61 offen sc1 lds
    v_smfmac_f32_16x16x64_bf16 v[20:23], v[36:39], a[128:135], v1
    ds_read_b128 v[56:59], v5 offset:20480
    v_smfmac_f32_16x16x64_bf16 v[24:27], v[36:39], a[120:127], v1
    ds_read_b128 v[60:63], v5 offset:21504
    s_waitcnt lgkmcnt(3)
    v_smfmac_f32_16x16x64_bf16 v[20:23], v[40:43], v[64:71], v1
    ds_read_b128 v[64:67], v5 offset:22528
    v_smfmac_f32_16x16x64_bf16 v[24:27], v[40:43], a[112:119], v1
    ds_read_b128 v[68:71], v5 offset:23552
    v_smfmac_f32_16x16x64_bf16 v[20:23], v[44:47], a[104:111], v1
    s_waitcnt lgkmcnt(2)
    v_smfmac_f32_16x16x64_bf16 v[24:27], v[44:47], v[56:63], v1
    ds_read_b128 v[56:59], v5 offset:24576
    v_smfmac_f32_16x16x64_bf16 v[20:23], v[48:51], a[96:103], v1
    ds_read_b128 v[60:63], v5 offset:25600
    v_smfmac_f32_16x16x64_bf16 v[24:27], v[48:51], a[88:95], v1
    s_waitcnt lgkmcnt(2)
    v_smfmac_f32_16x16x64_bf16 v[20:23], v[52:55], v[64:71], v1
    ds_read_b128 v[64:67], v5 offset:26624
    v_smfmac_f32_16x16x64_bf16 v[24:27], v[52:55], a[80:87], v1
    ds_read_b128 v[68:71], v5 offset:27648
    v_smfmac_f32_16x16x64_bf16 v[28:31], v[36:39], a[72:79], v1
    s_waitcnt lgkmcnt(2)
    v_smfmac_f32_16x16x64_bf16 v[32:35], v[36:39], v[56:63], v1
    ds_read_b128 v[56:59], v5 offset:28672
    s_nop 0
    v_permlane32_swap_b32 v20, v21
    v_smfmac_f32_16x16x64_bf16 v[28:31], v[40:43], a[64:71], v1
    ds_read_b128 v[60:63], v5 offset:29696
    v_permlane32_swap_b32 v22, v23
    v_smfmac_f32_16x16x64_bf16 v[32:35], v[40:43], a[56:63], v1
    s_waitcnt lgkmcnt(2)
    v_permlane32_swap_b32 v24, v25
    v_smfmac_f32_16x16x64_bf16 v[28:31], v[44:47], v[64:71], v1
    ds_read_b128 v[64:67], v5 offset:30720
    v_permlane32_swap_b32 v26, v27
    v_smfmac_f32_16x16x64_bf16 v[32:35], v[44:47], a[48:55], v1
    ds_read_b128 v[68:71], v5 offset:31744
    v_add_f32 v20, v20, v21
    v_add_f32 v22, v22, v23
    v_smfmac_f32_16x16x64_bf16 v[28:31], v[48:51], a[40:47], v1
    s_waitcnt lgkmcnt(2)
    v_add_f32 v24, v24, v25
    v_add_f32 v26, v26, v27
    v_smfmac_f32_16x16x64_bf16 v[32:35], v[48:51], v[56:63], v1
    ds_read_b128 v[56:59], v5 offset:32768
    v_mul_f32 v20, s40, v20
    v_mul_f32 v24, s40, v24
    v_smfmac_f32_16x16x64_bf16 v[28:31], v[52:55], a[32:39], v1
    ds_read_b128 v[60:63], v5 offset:33792
    v_mul_f32 v22, s40, v22
    v_mul_f32 v26, s40, v26
    v_smfmac_f32_16x16x64_bf16 v[32:35], v[52:55], a[24:31], v1
    s_waitcnt lgkmcnt(2)
    v_cvt_pk_bf16_f32 v20, v20, v24
    v_cvt_pk_bf16_f32 v21, v22, v26
    v_smfmac_f32_16x16x64_bf16 v[12:15], v[36:39], v[64:71], v1
    s_cmp_eq_u32 s57, 0
    s_cbranch_scc1 M_c1_3_first
M_c1_3_first_r:
    ds_write_b32 v2, v20 offset:18432
    v_smfmac_f32_16x16x64_bf16 v[16:19], v[36:39], a[16:23], v1
    ds_write_b32 v2, v21 offset:19008
    v_permlane32_swap_b32 v28, v29
    v_smfmac_f32_16x16x64_bf16 v[12:15], v[40:43], a[8:15], v1
    ds_read_b128 v[36:39], v6 offset:15360
    s_waitcnt lgkmcnt(3)
    v_permlane32_swap_b32 v30, v31
    v_smfmac_f32_16x16x64_bf16 v[16:19], v[40:43], v[56:63], v1
    ds_read_b128 v[64:67], v0 offset:2048
    v_permlane32_swap_b32 v32, v33
    v_smfmac_f32_16x16x64_bf16 v[12:15], v[44:47], a[0:7], v1
    ds_read_b128 v[68:71], v0 offset:3072
    v_permlane32_swap_b32 v34, v35
    v_smfmac_f32_16x16x64_bf16 v[16:19], v[44:47], v[248:255], v1
    s_waitcnt lgkmcnt(3)
    s_barrier
    ds_read_b128 v[40:43], v6 offset:16384
    v_add_f32 v28, v28, v29
    v_add_f32 v30, v30, v31
    v_smfmac_f32_16x16x64_bf16 v[12:15], v[48:51], v[240:247], v1
    ds_read_b128 v[56:59], v0 offset:0
    v_add_f32 v32, v32, v33
    v_add_f32 v34, v34, v35
    v_smfmac_f32_16x16x64_bf16 v[16:19], v[48:51], v[232:239], v1
    ds_read_b128 v[60:63], v0 offset:1024
    v_cvt_pk_bf16_f32 v28, v28, v32
    v_cvt_pk_bf16_f32 v29, v30, v34
    v_smfmac_f32_16x16x64_bf16 v[12:15], v[52:55], v[224:231], v1
    ds_write_b32 v2, v28 offset:20736
    ds_read_b128 v[20:23], v3 offset:18432
    v_smfmac_f32_16x16x64_bf16 v[16:19], v[52:55], v[216:223], v1
    ds_write_b32 v2, v29 offset:21312
    ds_read_b128 v[24:27], v3 offset:18496
    s_waitcnt lgkmcnt(9)
    v_smfmac_f32_16x16x64_bf16 v[12:15], v[36:39], v[208:215], v1
    ds_read_b128 v[72:75], v3 offset:18560
    ds_read_b128 v[44:47], v3 offset:18624
    v_smfmac_f32_16x16x64_bf16 v[16:19], v[36:39], v[200:207], v1
    ds_read_b128 v[48:51], v6 offset:17408
    s_waitcnt lgkmcnt(9)
    v_smfmac_f32_16x16x64_bf16 v[12:15], v[40:43], v[192:199], v1
    v_smfmac_f32_16x16x64_bf16 v[16:19], v[40:43], v[184:191], v1
    s_waitcnt lgkmcnt(5)
    v_mfma_f32_16x16x32_bf16 v[28:31], v[56:59], v[20:23], 0
    ds_read_b128 v[56:59], v0 offset:4096
    s_waitcnt lgkmcnt(4)
    v_mov_b64 v[52:53], s[24:25]
    v_mfma_f32_16x16x32_bf16 v[28:31], v[60:63], v[24:27], v[28:31]
    ds_read_b128 v[60:63], v0 offset:5120
    s_barrier
    s_waitcnt lgkmcnt(4)
    v_mfma_f32_16x16x32_bf16 v[28:31], v[64:67], v[72:75], v[28:31]
    ds_read_b128 v[64:67], v0 offset:6144
    s_waitcnt lgkmcnt(4)
    v_mov_b64 v[54:55], s[24:25]
    v_mfma_f32_16x16x32_bf16 v[28:31], v[68:71], v[44:47], v[28:31]
    ds_read_b128 v[68:71], v0 offset:7168
    s_waitcnt lgkmcnt(4)
    v_mov_b64 v[10:11], s[16:17]
    v_smfmac_f32_16x16x64_bf16 v[12:15], v[48:51], v[176:183], v1
    ds_read_b128 v[36:39], v3 offset:20736
    v_smfmac_f32_16x16x64_bf16 v[16:19], v[48:51], v[168:175], v1
    ds_read_b128 v[40:43], v3 offset:20800
    s_waitcnt lgkmcnt(4)
    v_mfma_f32_16x16x32_bf16 v[32:35], v[56:59], v[20:23], 0
    v_exp_f32 v28, v28
    v_mfma_f32_16x16x32_bf16 v[32:35], v[60:63], v[24:27], v[32:35]
    s_waitcnt lgkmcnt(2)
    v_exp_f32 v29, v29
    ds_read_b128 v[56:59], v3 offset:20864
    v_mfma_f32_16x16x32_bf16 v[32:35], v[64:67], v[72:75], v[32:35]
    v_exp_f32 v30, v30
    ds_read_b128 v[60:63], v3 offset:20928
    v_mfma_f32_16x16x32_bf16 v[32:35], v[68:71], v[44:47], v[32:35]
    s_waitcnt lgkmcnt(3)
    v_exp_f32 v31, v31
    v_mfma_f32_16x16x32_bf16 v[48:51], v[36:39], v[20:23], 0
    s_waitcnt lgkmcnt(2)
    v_cvt_pk_bf16_f32 v28, v28, v29
    v_cvt_pk_bf16_f32 v29, v30, v31
    v_mfma_f32_16x16x32_bf16 v[48:51], v[40:43], v[24:27], v[48:51]
    s_waitcnt lgkmcnt(1)
    v_cvt_pk_bf16_f32 v12, v12, v13
    v_cvt_pk_bf16_f32 v13, v14, v15
    v_mfma_f32_16x16x32_bf16 v[48:51], v[56:59], v[72:75], v[48:51]
    s_waitcnt lgkmcnt(0)
    v_exp_f32 v32, v32
    v_mfma_f32_16x16x32_bf16 v[48:51], v[60:63], v[44:47], v[48:51]
    v_exp_f32 v33, v33
    v_exp_f32 v34, v34
    v_exp_f32 v35, v35
    v_cvt_pk_bf16_f32 v30, v32, v33
    v_cvt_pk_bf16_f32 v31, v34, v35
    v_cvt_pk_bf16_f32 v14, v16, v17
    v_cvt_pk_bf16_f32 v15, v18, v19
    v_mfma_f32_16x16x32_bf16 v[72:75], v[52:55], v[28:31], 0
    v_exp_f32 v48, v48
    v_mfma_f32_16x16x32_bf16 v[20:23], v[80:83], v[28:31], 0
    v_exp_f32 v49, v49
    v_mfma_f32_16x16x32_bf16 v[24:27], v[84:87], v[28:31], 0
    v_exp_f32 v50, v50
    v_exp_f32 v51, v51
    v_cvt_pk_bf16_f32 v48, v48, v49
    v_cvt_pk_bf16_f32 v49, v50, v51
    v_cndmask_b32_e64 v76, v12, v60, s[66:67]
    v_cndmask_b32_e64 v77, v13, v61, s[66:67]
M_c1_3_fin:
    v_mfma_f32_16x16x16_bf16 v[72:75], v[10:11], v[48:49], v[72:75]
    v_cndmask_b32_e64 v78, v14, v62, s[66:67]
    v_cndmask_b32_e64 v79, v15, v63, s[66:67]
    v_mfma_f32_16x16x16_bf16 v[20:23], v[12:13], v[48:49], v[20:23]
    s_cmp_eq_u32 s57, 63
    v_mov_b64 v[44:45], 0
    v_mov_b64 v[46:47], 0
    v_mfma_f32_16x16x16_bf16 v[24:27], v[14:15], v[48:49], v[24:27]
    s_cbranch_scc1 M_c1_3_last
    v_mov_b64 v[68:69], 0
    v_rcp_f32 v74, v72
    v_subrev_u32 v73, s68, v72
    v_cmp_lt_u32 vcc, s69, v73
    v_mov_b64 v[70:71], 0
    v_mov_b32 v5, v5
    v_mov_b32 v5, v5
    v_cndmask_b32_e64 v20, v20, v24, s[18:19]
    v_cndmask_b32_e64 v21, v21, v25, s[18:19]
    v_cndmask_b32_e64 v22, v22, v26, s[18:19]
    v_cndmask_b32_e64 v23, v23, v27, s[18:19]
    v_pk_mul_f32 v[20:21], v[20:21], v[74:75] op_sel_hi:[1,0]
    v_pk_mul_f32 v[22:23], v[22:23], v[74:75] op_sel_hi:[1,0]
    v_cvt_pk_bf16_f32 v20, v20, v21
    v_cvt_pk_bf16_f32 v21, v22, v23
    ds_write_b64 v0, v[20:21] offset:14344
    s_cbranch_vccnz M_c1_3_zbad
M_c1_3_zok:
    s_cmp_eq_u32 s57, 0
    s_cbranch_scc1 M_c1_3_first2
M_c1_3_first2_r:
    buffer_load_dwordx4 v[80:83], v0, s[8:11], s3 offen offset:0 sc1
    buffer_load_dwordx4 v[84:87], v0, s[8:11], s3 offen offset:1024 sc1
    s_waitcnt lgkmcnt(0)
    s_barrier
    ds_read_b128 v[32:35], v0 offset:13312
    ds_read_b128 v[40:43], v0 offset:14336
    s_mov_b32 m0, 6144
    s_nop 0
    buffer_load_dwordx4 v0, s[8:11], s26 offen offset:0 sc1 lds
    buffer_load_dwordx4 v0, s[8:11], s26 offen offset:1024 sc1 lds
    v_mov_b64 v[64:65], 0
    v_mov_b64 v[66:67], 0
    v_mov_b64 v[60:61], 0
    v_mov_b64 v[62:63], 0
    v_mov_b64 v[56:57], 0
    v_mov_b64 v[58:59], 0
    s_waitcnt lgkmcnt(1)
    s_nop 0
    v_smfmac_f32_16x16x64_bf16 v[56:59], v[32:35], v[160:167], v1
    v_smfmac_f32_16x16x64_bf16 v[60:63], v[32:35], v[144:151], v1
    s_waitcnt lgkmcnt(0)
    v_smfmac_f32_16x16x64_bf16 v[56:59], v[40:43], v[152:159], v1
    v_smfmac_f32_16x16x64_bf16 v[60:63], v[40:43], v[136:143], v1
    v_smfmac_f32_16x16x64_bf16 v[64:67], v[32:35], v[128:135], v1
    v_smfmac_f32_16x16x64_bf16 v[68:71], v[32:35], v[112:119], v1
    v_permlane32_swap_b32 v56, v57
    v_smfmac_f32_16x16x64_bf16 v[64:67], v[40:43], v[120:127], v1
    v_permlane32_swap_b32 v58, v59
    v_smfmac_f32_16x16x64_bf16 v[68:71], v[40:43], v[104:111], v1
    v_add_f32 v56, v56, v57
    v_add_f32 v58, v58, v59
    v_smfmac_f32_16x16x64_bf16 v[44:47], v[32:35], v[96:103], v1
    v_permlane32_swap_b32 v60, v61
    v_smfmac_f32_16x16x64_bf16 v[44:47], v[40:43], v[88:95], v1
    v_permlane32_swap_b32 v62, v63
    v_add_f32 v60, v60, v61
    v_add_f32 v62, v62, v63
    v_cvt_pk_bf16_f32 v36, v56, v60
    v_cvt_pk_bf16_f32 v38, v58, v62
    v_permlane32_swap_b32 v64, v65
    v_permlane32_swap_b32 v66, v67
    v_add_f32 v64, v64, v65
    v_add_f32 v66, v66, v67
    v_permlane32_swap_b32 v68, v69
    v_permlane32_swap_b32 v70, v71
    v_add_f32 v68, v68, v69
    v_add_f32 v70, v70, v71
    v_cvt_pk_bf16_f32 v37, v64, v68
    v_cvt_pk_bf16_f32 v39, v66, v70
    buffer_store_dwordx4 v[36:39], v0, s[8:11], s58 offen sc1
    v_permlane32_swap_b32 v44, v45
    v_permlane32_swap_b32 v46, v47
    v_add_f32 v44, v44, v45
    v_add_f32 v46, v46, v47
    v_cvt_pk_bf16_f32 v44, v44, v46
    buffer_store_dword v44, v7, s[8:11], s55 offen sc1
    s_add_u32 s27, s44, 1
    s_and_b32 s27, s27, 3
    s_mul_i32 s48, s27, 5120
    s_add_u32 s48, s48, s41
    s_lshl_b32 s27, s27, 15
    s_add_u32 s49, s27, s47
    ds_read_b128 v[56:59], v5 offset:0
    ds_read_b128 v[60:63], v5 offset:1024
    ds_read_b128 v[64:67], v5 offset:2048
    ds_read_b128 v[68:71], v5 offset:3072
    v_mov_b64 v[12:13], 0
    v_mov_b64 v[14:15], 0
    v_mov_b64 v[16:17], 0
    v_mov_b64 v[18:19], 0
    v_mov_b64 v[20:21], 0
    v_mov_b64 v[22:23], 0
    v_mov_b64 v[24:25], 0
    v_mov_b64 v[26:27], 0
    v_mov_b64 v[28:29], 0
    v_mov_b64 v[30:31], 0
    v_mov_b64 v[32:33], 0
    v_mov_b64 v[34:35], 0
    s_barrier
    s_and_b32 s26, s44, 63
    s_add_u32 s26, s26, 2
    s_min_u32 s26, s26, 63
    s_lshl_b32 s26, s26, 18
    s_add_u32 s26, s26, s50
    s_add_u32 s26, s26, 6144
    s_add_u32 s3, s26, 16777216
    s_lshl_b32 s4, s44, 18
    s_add_u32 s4, s4, s53
    s_add_u32 s44, s44, 1
    s_and_b32 s55, s44, 3
    s_mul_i32 s55, s55, 167936
    s_add_u32 s55, s55, s34
    s_add_u32 s58, s55, s35
    s_and_b32 s57, s44, 63
    s_sub_u32 s61, s26, 6144
    s_nop 15
    s_nop 15
    s_nop 7
    s_mov_b32 m0, 13312
    s_nop 0
    buffer_load_dwordx4 v0, s[8:11], s48 offen offset:3072 sc1 lds
    s_mov_b32 m0, 17408
    s_add_u32 s59, s48, 4096
    buffer_load_dwordx4 v0, s[8:11], s59 offen offset:0 sc1 lds
    s_nop 11
    s_mov_b32 m0, 13312
    s_nop 0
    buffer_load_dwordx4 v0, s[8:11], s48 offen offset:3072 sc1 lds
    s_mov_b32 m0, 17408
    s_add_u32 s59, s48, 4096
    buffer_load_dwordx4 v0, s[8:11], s59 offen offset:0 sc1 lds
    s_nop 11
    s_mov_b32 m0, 13312
    s_nop 0
    buffer_load_dwordx4 v0, s[8:11], s48 offen offset:3072 sc1 lds
    s_mov_b32 m0, 17408
    s_add_u32 s59, s48, 4096
    buffer_load_dwordx4 v0, s[8:11], s59 offen offset:0 sc1 lds
    s_mov_b32 s70, 0
    s_waitcnt lgkmcnt(0)
    s_branch M_c1_3_top
M_c1_3_restart:
    s_waitcnt vmcnt(0) lgkmcnt(0)
    s_nop 7
    s_barrier
    s_mov_b32 m0, 13312
    s_nop 0
    buffer_load_dwordx4 v0, s[8:11], s48 offen offset:3072 sc1 lds
    s_mov_b32 m0, 17408
    s_add_u32 s59, s48, 4096
    buffer_load_dwordx4 v0, s[8:11], s59 offen offset:0 sc1 lds
    ds_read_b128 v[56:59], v5 offset:0
    ds_read_b128 v[60:63], v5 offset:1024
    ds_read_b128 v[64:67], v5 offset:2048
    ds_read_b128 v[68:71], v5 offset:3072
    v_mov_b64 v[12:13], 0
    v_mov_b64 v[14:15], 0
    v_mov_b64 v[16:17], 0
    v_mov_b64 v[18:19], 0
    v_mov_b64 v[20:21], 0
    v_mov_b64 v[22:23], 0
    v_mov_b64 v[24:25], 0
    v_mov_b64 v[26:27], 0
    v_mov_b64 v[28:29], 0
    v_mov_b64 v[30:31], 0
    v_mov_b64 v[32:33], 0
    v_mov_b64 v[34:35], 0
    s_waitcnt vmcnt(0) lgkmcnt(0)
    s_branch M_c1_3_top
M_c1_3_zbad:
    s_cmp_eq_u32 s70, 2
    s_cbranch_scc1 M_c1_3_zok
    v_cmp_u_f32 vcc, v72, v72
    s_cbranch_vccz M_c1_3_exact
    s_cmp_eq_u32 s70, 1
    s_cbranch_scc1 M_c1_3_exact
M_c1_3_vfy0:
    s_mov_b32 s70, 1
    s_mov_b32 s30, 0
    s_waitcnt vmcnt(0) lgkmcnt(0)
    s_nop 7
M_c1_3_vfy:
    v_mov_b32 v10, 0
    s_add_u32 s59, s48, 4096
    buffer_load_dwordx4 v[36:39], v0, s[8:11], s48 offen offset:0 sc1
    buffer_load_dwordx4 v[40:43], v0, s[8:11], s48 offen offset:1024 sc1
    buffer_load_dwordx4 v[44:47], v0, s[8:11], s48 offen offset:2048 sc1
    buffer_load_dwordx4 v[48:51], v0, s[8:11], s48 offen offset:3072 sc1
    buffer_load_dwordx4 v[52:55], v0, s[8:11], s59 offen offset:0 sc1
    s_waitcnt vmcnt(4)
    v_max3_u32 v10, v10, v36, v37
    v_max3_u32 v10, v10, v38, v39
    s_waitcnt vmcnt(3)
    v_max3_u32 v10, v10, v40, v41
    v_max3_u32 v10, v10, v42, v43
    s_waitcnt vmcnt(2)
    v_max3_u32 v10, v10, v44, v45
    v_max3_u32 v10, v10, v46, v47
    s_waitcnt vmcnt(1)
    v_max3_u32 v10, v10, v48, v49
    v_max3_u32 v10, v10, v50, v51
    s_waitcnt vmcnt(0)
    v_max3_u32 v10, v10, v52, v53
    v_max3_u32 v10, v10, v54, v55
    s_add_u32 s59, s49, 4096
    buffer_load_dwordx4 v[36:39], v0, s[8:11], s49 offen offset:0 sc1
    buffer_load_dwordx4 v[40:43], v0, s[8:11], s49 offen offset:1024 sc1
    buffer_load_dwordx4 v[44:47], v0, s[8:11], s49 offen offset:2048 sc1
    buffer_load_dwordx4 v[48:51], v0, s[8:11], s49 offen offset:3072 sc1
    buffer_load_dwordx4 v[52:55], v0, s[8:11], s59 offen offset:0 sc1
    s_waitcnt vmcnt(4)
    v_max3_u32 v10, v10, v36, v37
    v_max3_u32 v10, v10, v38, v39
    s_waitcnt vmcnt(3)
    v_max3_u32 v10, v10, v40, v41
    v_max3_u32 v10, v10, v42, v43
    s_waitcnt vmcnt(2)
    v_max3_u32 v10, v10, v44, v45
    v_max3_u32 v10, v10, v46, v47
    s_waitcnt vmcnt(1)
    v_max3_u32 v10, v10, v48, v49
    v_max3_u32 v10, v10, v50, v51
    s_waitcnt vmcnt(0)
    v_max3_u32 v10, v10, v52, v53
    v_max3_u32 v10, v10, v54, v55
    v_cmp_eq_u32 vcc, -1, v10
    s_cbranch_vccz M_c1_3_restart
    s_add_u32 s30, s30, 1
    s_cmp_ge_u32 s30, 60000
    s_cbranch_scc1 M_fail
    s_branch M_c1_3_vfy
M_c1_3_exact:
    s_nop 7
    s_mov_b32 s70, 2
    s_waitcnt lgkmcnt(0)
    ds_read_b128 v[20:23], v3 offset:18432
    ds_read_b128 v[24:27], v3 offset:18496
    ds_read_b128 v[72:75], v3 offset:18560
    ds_read_b128 v[44:47], v3 offset:18624
    ds_read_b128 v[56:59], v0 offset:0
    s_waitcnt lgkmcnt(0)
    v_mfma_f32_16x16x32_bf16 v[28:31], v[56:59], v[20:23], 0
    s_nop 3
    ds_read_b128 v[60:63], v0 offset:1024
    s_waitcnt lgkmcnt(0)
    v_mfma_f32_16x16x32_bf16 v[28:31], v[60:63], v[24:27], v[28:31]
    s_nop 3
    ds_read_b128 v[56:59], v0 offset:2048
    s_waitcnt lgkmcnt(0)
    v_mfma_f32_16x16x32_bf16 v[28:31], v[56:59], v[72:75], v[28:31]
    s_nop 3
    ds_read_b128 v[60:63], v0 offset:3072
    s_waitcnt lgkmcnt(0)
    v_mfma_f32_16x16x32_bf16 v[28:31], v[60:63], v[44:47], v[28:31]
    s_nop 3
    ds_read_b128 v[56:59], v0 offset:4096
    s_waitcnt lgkmcnt(0)
    v_mfma_f32_16x16x32_bf16 v[32:35], v[56:59], v[20:23], 0
    s_nop 3
    ds_read_b128 v[60:63], v0 offset:5120
    s_waitcnt lgkmcnt(0)
    v_mfma_f32_16x16x32_bf16 v[32:35], v[60:63], v[24:27], v[32:35]
    s_nop 3
    ds_read_b128 v[56:59], v0 offset:6144
    s_waitcnt lgkmcnt(0)
    v_mfma_f32_16x16x32_bf16 v[32:35], v[56:59], v[72:75], v[32:35]
    s_nop 3
    ds_read_b128 v[60:63], v0 offset:7168
    s_waitcnt lgkmcnt(0)
    v_mfma_f32_16x16x32_bf16 v[32:35], v[60:63], v[44:47], v[32:35]
    s_nop 3
    ds_read_b128 v[56:59], v3 offset:20736
    s_waitcnt lgkmcnt(0)
    v_mfma_f32_16x16x32_bf16 v[48:51], v[56:59], v[20:23], 0
    s_nop 3
    ds_read_b128 v[60:63], v3 offset:20800
    s_waitcnt lgkmcnt(0)
    v_mfma_f32_16x16x32_bf16 v[48:51], v[60:63], v[24:27], v[48:51]
    s_nop 3
    ds_read_b128 v[56:59], v3 offset:20864
    s_waitcnt lgkmcnt(0)
    v_mfma_f32_16x16x32_bf16 v[48:51], v[56:59], v[72:75], v[48:51]
    s_nop 3
    ds_read_b128 v[60:63], v3 offset:20928
    s_waitcnt lgkmcnt(0)
    v_mfma_f32_16x16x32_bf16 v[48:51], v[60:63], v[44:47], v[48:51]
    s_nop 3
    v_max3_f32 v64, v28, v29, v30
    v_max3_f32 v64, v64, v31, v32
    v_max3_f32 v64, v64, v33, v34
    s_nop 0
    v_max3_f32 v64, v64, v35, v48
    v_max3_f32 v64, v64, v49, v50
    v_max_f32 v64, v64, v51
    v_mov_b32 v65, v64
    s_nop 1
    v_permlane16_swap_b32 v64, v65
    v_max_f32 v64, v64, v65
    v_mov_b32 v65, v64
    s_nop 1
    v_permlane32_swap_b32 v64, v65
    v_max_f32 v64, v64, v65
    v_sub_f32 v28, v28, v64
    v_exp_f32 v28, v28
    v_sub_f32 v29, v29, v64
    v_exp_f32 v29, v29
    v_sub_f32 v30, v30, v64
    v_exp_f32 v30, v30
    v_sub_f32 v31, v31, v64
    v_exp_f32 v31, v31
    v_sub_f32 v32, v32, v64
    v_exp_f32 v32, v32
    v_sub_f32 v33, v33, v64
    v_exp_f32 v33, v33
    v_sub_f32 v34, v34, v64
    v_exp_f32 v34, v34
    v_sub_f32 v35, v35, v64
    v_exp_f32 v35, v35
    v_sub_f32 v48, v48, v64
    v_exp_f32 v48, v48
    v_sub_f32 v49, v49, v64
    v_exp_f32 v49, v49
    v_sub_f32 v50, v50, v64
    v_exp_f32 v50, v50
    v_sub_f32 v51, v51, v64
    v_exp_f32 v51, v51
    v_cvt_pk_bf16_f32 v28, v28, v29
    v_cvt_pk_bf16_f32 v29, v30, v31
    v_cvt_pk_bf16_f32 v30, v32, v33
    v_cvt_pk_bf16_f32 v31, v34, v35
    v_cvt_pk_bf16_f32 v48, v48, v49
    v_cvt_pk_bf16_f32 v49, v50, v51
    v_mfma_f32_16x16x32_bf16 v[20:23], v[80:83], v[28:31], 0
    v_mfma_f32_16x16x32_bf16 v[24:27], v[84:87], v[28:31], 0
    v_mfma_f32_16x16x32_bf16 v[72:75], v[52:55], v[28:31], 0
    ds_read_b128 v[60:63], v3 offset:20928
    s_waitcnt lgkmcnt(0)
    s_nop 7
    s_branch M_c1_3_fin
M_c1_3_last:
    s_cmp_lg_u32 s70, 0
    s_cbranch_scc1 M_c1_3_last2
    v_cmp_u_f32 vcc, v32, v32
    s_cbranch_vccnz M_c1_3_vfy0
M_c1_3_last2:
    s_lshl_b32 s4, s44, 18
    s_add_u32 s4, s4, s53
    buffer_store_dwordx4 v[76:79], v0, s[8:11], s4 offen offset:3072 sc1
    s_mov_b32 s4, 0x10000000
    s_waitcnt vmcnt(0) lgkmcnt(0)
    s_barrier
    s_nop 7
    v_mov_b64 v[72:73], -1
    v_mov_b64 v[74:75], -1
    s_add_u32 s28, s44, 3
    s_and_b32 s29, s28, 3
    s_mul_i32 s31, s22, 160
    s_waitcnt vmcnt(0)
    s_add_u32 s44, s44, 1
    s_cmp_eq_u32 s44, 128
    s_cbranch_scc1 M_end
    s_branch M_c1_3_layer
M_c1_3_lr:
    s_mov_b32 s30, 0
M_c1_3_lr_l:
    s_waitcnt lgkmcnt(0)
    s_and_b32 s27, s30, 1
    s_cbranch_scc0 M_c1_3_lr_n
    s_waitcnt vmcnt(2)
    s_mov_b32 m0, 13312
    s_nop 0
    buffer_load_dwordx4 v0, s[8:11], s48 offen offset:3072 sc1 lds
    s_mov_b32 m0, 17408
    s_add_u32 s59, s48, 4096
    buffer_load_dwordx4 v0, s[8:11], s59 offen offset:0 sc1 lds
M_c1_3_lr_n:
    ds_read_b128 v[36:39], v6 offset:13312
    ds_read_b128 v[40:43], v6 offset:14336
    ds_read_b128 v[44:47], v6 offset:15360
    ds_read_b128 v[48:51], v6 offset:16384
    ds_read_b128 v[52:55], v6 offset:17408
    s_waitcnt lgkmcnt(2)
    v_max3_u32 v10, v36, v40, v44
    s_waitcnt lgkmcnt(0)
    v_max3_u32 v10, v10, v48, v52
    v_cmp_eq_u32 vcc, -1, v10
    s_cbranch_vccz M_c1_3_lr_d
    s_add_u32 s30, s30, 1
    s_cmp_ge_u32 s30, 480000
    s_cbranch_scc1 M_fail
    s_branch M_c1_3_lr_l
M_c1_3_lr_d:
    ds_read_b128 v[56:59], v5 offset:0
    ds_read_b128 v[60:63], v5 offset:1024
    ds_read_b128 v[64:67], v5 offset:2048
    ds_read_b128 v[68:71], v5 offset:3072
    v_mov_b64 v[12:13], 0
    v_mov_b64 v[14:15], 0
    v_mov_b64 v[16:17], 0
    v_mov_b64 v[18:19], 0
    v_mov_b64 v[20:21], 0
    v_mov_b64 v[22:23], 0
    v_mov_b64 v[24:25], 0
    v_mov_b64 v[26:27], 0
    v_mov_b64 v[28:29], 0
    v_mov_b64 v[30:31], 0
    v_mov_b64 v[32:33], 0
    v_mov_b64 v[34:35], 0
    s_waitcnt lgkmcnt(0)
    s_branch M_c1_3_lr_r
M_c1_3_rr:
    s_mov_b32 s30, 0
M_c1_3_rr_l:
    s_waitcnt lgkmcnt(0)
    s_and_b32 s27, s30, 1
    s_cbranch_scc1 M_c1_3_rr_n
    s_waitcnt vmcnt(1)
    s_mov_b32 m0, 12288
    s_add_u32 s59, s49, 4096
    buffer_load_dwordx4 v0, s[8:11], s59 offen offset:0 sc1 lds
M_c1_3_rr_n:
    ds_read_b128 v[36:39], v6 offset:8192
    ds_read_b128 v[40:43], v6 offset:9216
    ds_read_b128 v[44:47], v6 offset:10240
    ds_read_b128 v[48:51], v6 offset:11264
    ds_read_b32 v11, v6 offset:12288
    s_waitcnt lgkmcnt(2)
    v_max3_u32 v10, v36, v40, v44
    s_waitcnt lgkmcnt(0)
    v_max3_u32 v10, v10, v48, v11
    v_cmp_eq_u32 vcc, -1, v10
    s_cbranch_vccz M_c1_3_rr_d
    s_add_u32 s30, s30, 1
    s_cmp_ge_u32 s30, 480000
    s_cbranch_scc1 M_fail
    s_branch M_c1_3_rr_l
M_c1_3_rr_d:
    s_branch M_c1_3_rr_r
M_c1_3_first:
    s_barrier
    s_and_b32 s26, s44, 63
    s_lshl_b32 s26, s26, 18
    s_add_u32 s26, s26, s50
    s_add_u32 s26, s26, 6144
    s_add_u32 s3, s26, 16777216
    s_mov_b32 m0, 6144
    s_nop 0
    buffer_load_dwordx4 v0, s[8:11], s26 offen offset:0 sc1 lds
    buffer_load_dwordx4 v0, s[8:11], s26 offen offset:1024 sc1 lds
    buffer_load_dwordx4 v[80:83], v0, s[8:11], s3 offen offset:0 sc1
    buffer_load_dwordx4 v[84:87], v0, s[8:11], s3 offen offset:1024 sc1
    s_and_b32 s26, s44, 63
    s_add_u32 s26, s26, 1
    s_min_u32 s26, s26, 63
    s_lshl_b32 s26, s26, 18
    s_add_u32 s26, s26, s50
    s_add_u32 s26, s26, 6144
    s_add_u32 s3, s26, 16777216
    s_waitcnt vmcnt(0) lgkmcnt(0)
    s_barrier
    s_branch M_c1_3_first_r
M_c1_3_first2:
    s_barrier
    s_branch M_c1_3_first2_r
M_bulk:
    s_waitcnt vmcnt(0)
    s_barrier
    s_mul_i32 s42, s21, 10240
    s_mul_i32 s47, s101, 3145728
    s_add_u32 s47, s47, s42
    s_add_u32 s47, s47, 29360128
    s_mul_i32 s50, s101, 33554432
    s_lshl_b32 s27, s22, 13
    s_add_u32 s50, s50, s27
    s_add_u32 s50, s50, 37748736
    s_lshl_b32 s43, s101, 6
    s_mul_i32 s27, s22, 26
    s_lshr_b32 s27, s27, 8
    s_mul_i32 s28, s27, 10
    s_sub_u32 s88, s22, s28
    s_mul_i32 s28, s20, 3
    s_sub_u32 s28, s28, 9
    s_cmp_lt_u32 s20, 3
    s_cselect_b32 s28, 15, s28
    s_cselect_b32 s29, 1, 3
    s_add_u32 s28, s28, s27
    s_lshl_b32 s89, s28, 2
    s_add_u32 s89, s89, s21
    s_cmp_lt_u32 s27, s29
    s_cselect_b32 s89, s89, 64
    s_cmp_ge_u32 s20, 3
    s_cbranch_scc1 M_qao
    s_lshl_b32 s28, s21, 11
    s_add_u32 s52, s50, s28
    s_add_u32 s52, s52, 16777216
    s_lshl_b32 s28, s21, 10
    s_add_u32 s50, s50, s28
    s_lshl_b32 s51, s22, 8
    s_add_u32 s51, s51, 167854080
    v_lshlrev_b32 v3, 3, v0
    s_mov_b32 s44, 0
    s_mov_b32 s45, 0
    s_cmp_lg_u32 s21, 0
    s_cbranch_scc1 M_kx_1
    v_lshlrev_b32 v190, 3, v0
    s_mov_b64 exec, 7
    s_mov_b32 s30, 0
    s_lshl_b32 s27, s101, 13
    s_add_u32 s27, s27, 167911424
M_kx_2:
    buffer_load_dwordx4 v[176:179], v190, s[8:11], s27 offen sc1
    buffer_load_dwordx4 v[180:183], v190, s[8:11], s27 offen offset:16 sc1
    buffer_load_dwordx2 v[184:185], v190, s[8:11], s27 offen offset:32 sc1
    s_add_u32 s30, s30, 1
    s_cmp_ge_u32 s30, 60000
    s_cbranch_scc1 M_fail
    s_waitcnt vmcnt(0)
    v_min3_u32 v176, v176, v177, v178
    v_min3_u32 v176, v176, v179, v180
    v_min3_u32 v176, v176, v181, v182
    v_min3_u32 v176, v176, v183, v184
    v_min_u32 v176, v176, v185
    v_cmp_eq_u32 vcc, 0, v176
    s_cbranch_vccnz M_kx_2
    s_mov_b64 exec, -1
M_kx_1:
    s_barrier
M_kx_3:
    s_min_u32 s27, s44, 63
    s_mul_i32 s27, s27, 40960
    s_add_u32 s27, s27, s47
    s_add_u32 s28, s45, s42
    s_mov_b32 m0, s28
    s_nop 0
    buffer_load_dwordx4 v0, s[8:11], s27 offen offset:0 sc1 lds
    buffer_load_dwordx4 v0, s[8:11], s27 offen offset:1024 sc1 lds
    buffer_load_dwordx4 v0, s[8:11], s27 offen offset:2048 sc1 lds
    buffer_load_dwordx4 v0, s[8:11], s27 offen offset:3072 sc1 lds
    s_add_u32 s27, s27, 4096
    s_add_u32 s28, s28, 4096
    s_mov_b32 m0, s28
    s_nop 0
    buffer_load_dwordx4 v0, s[8:11], s27 offen offset:0 sc1 lds
    buffer_load_dwordx4 v0, s[8:11], s27 offen offset:1024 sc1 lds
    buffer_load_dwordx4 v0, s[8:11], s27 offen offset:2048 sc1 lds
    buffer_load_dwordx4 v0, s[8:11], s27 offen offset:3072 sc1 lds
    s_add_u32 s27, s27, 4096
    s_add_u32 s28, s28, 4096
    s_mov_b32 m0, s28
    s_nop 0
    buffer_load_dwordx4 v0, s[8:11], s27 offen offset:0 sc1 lds
    buffer_load_dwordx4 v0, s[8:11], s27 offen offset:1024 sc1 lds
    s_waitcnt vmcnt(0)
    s_barrier
    v_mov_b32 v1, v0
    ds_read_b128 v[56:59], v1 offset:0
    ds_read_b128 v[60:63], v1 offset:1024
    ds_read_b128 v[64:67], v1 offset:2048
    ds_read_b128 v[68:71], v1 offset:3072
M_kv_top:
    s_add_u32 s27, s44, s43
    v_mov_b32 v2, s27
    s_sub_u32 s45, 40960, s45
    s_add_u32 s44, s44, 1
    v_add_u32 v4, s45, v0
    s_min_u32 s27, s44, 63
    s_mul_i32 s27, s27, 40960
    s_add_u32 s27, s27, s47
    s_add_u32 s28, s45, s42
    s_mov_b32 m0, s28
    s_nop 0
    buffer_load_dwordx4 v0, s[8:11], s27 offen offset:0 sc1 lds
    buffer_load_dwordx4 v0, s[8:11], s27 offen offset:1024 sc1 lds
    buffer_load_dwordx4 v0, s[8:11], s27 offen offset:2048 sc1 lds
    buffer_load_dwordx4 v0, s[8:11], s27 offen offset:3072 sc1 lds
    ds_read_b128 v[72:75], v1 offset:4096
    s_waitcnt lgkmcnt(4)
    v_mfma_f32_16x16x32_bf16 v[8:11], a[0:3], v[56:59], 0
    v_mfma_f32_16x16x32_bf16 v[24:27], v[56:59], a[160:163], 0
    v_mfma_f32_16x16x32_bf16 v[12:15], a[80:83], v[56:59], 0
    v_mfma_f32_16x16x32_bf16 v[28:31], v[56:59], a[240:243], 0
    ds_read_b128 v[56:59], v1 offset:5120
    s_waitcnt lgkmcnt(4)
    v_mfma_f32_16x16x32_bf16 v[8:11], a[4:7], v[60:63], v[8:11]
    v_mfma_f32_16x16x32_bf16 v[24:27], v[60:63], a[164:167], v[24:27]
    v_mfma_f32_16x16x32_bf16 v[12:15], a[84:87], v[60:63], v[12:15]
    v_mfma_f32_16x16x32_bf16 v[28:31], v[60:63], a[244:247], v[28:31]
    s_add_u32 s27, s27, 4096
    s_add_u32 s28, s28, 4096
    s_mov_b32 m0, s28
    s_nop 0
    buffer_load_dwordx4 v0, s[8:11], s27 offen offset:0 sc1 lds
    buffer_load_dwordx4 v0, s[8:11], s27 offen offset:1024 sc1 lds
    buffer_load_dwordx4 v0, s[8:11], s27 offen offset:2048 sc1 lds
    buffer_load_dwordx4 v0, s[8:11], s27 offen offset:3072 sc1 lds
    ds_read_b128 v[60:63], v1 offset:6144
    s_waitcnt lgkmcnt(4)
    v_mfma_f32_16x16x32_bf16 v[8:11], a[8:11], v[64:67], v[8:11]
    v_mfma_f32_16x16x32_bf16 v[24:27], v[64:67], a[168:171], v[24:27]
    v_mfma_f32_16x16x32_bf16 v[12:15], a[88:91], v[64:67], v[12:15]
    v_mfma_f32_16x16x32_bf16 v[28:31], v[64:67], a[248:251], v[28:31]
    ds_read_b128 v[64:67], v1 offset:7168
    s_waitcnt lgkmcnt(4)
    v_mfma_f32_16x16x32_bf16 v[8:11], a[12:15], v[68:71], v[8:11]
    v_mfma_f32_16x16x32_bf16 v[24:27], v[68:71], a[172:175], v[24:27]
    v_mfma_f32_16x16x32_bf16 v[12:15], a[92:95], v[68:71], v[12:15]
    v_mfma_f32_16x16x32_bf16 v[28:31], v[68:71], a[252:255], v[28:31]
    s_add_u32 s27, s27, 4096
    s_add_u32 s28, s28, 4096
    s_mov_b32 m0, s28
    s_nop 0
    buffer_load_dwordx4 v0, s[8:11], s27 offen offset:0 sc1 lds
    buffer_load_dwordx4 v0, s[8:11], s27 offen offset:1024 sc1 lds
    ds_read_b128 v[68:71], v1 offset:8192
    s_waitcnt lgkmcnt(4)
    v_mfma_f32_16x16x32_bf16 v[8:11], a[16:19], v[72:75], v[8:11]
    v_mfma_f32_16x16x32_bf16 v[24:27], v[72:75], a[176:179], v[24:27]
    v_mfma_f32_16x16x32_bf16 v[12:15], a[96:99], v[72:75], v[12:15]
    v_mfma_f32_16x16x32_bf16 v[28:31], v[72:75], v[192:195], v[28:31]
    ds_read_b128 v[72:75], v1 offset:9216
    s_waitcnt lgkmcnt(4)
    v_mfma_f32_16x16x32_bf16 v[8:11], a[20:23], v[56:59], v[8:11]
    v_mfma_f32_16x16x32_bf16 v[24:27], v[56:59], a[180:183], v[24:27]
    v_mfma_f32_16x16x32_bf16 v[12:15], a[100:103], v[56:59], v[12:15]
    v_mfma_f32_16x16x32_bf16 v[28:31], v[56:59], v[196:199], v[28:31]
    ds_read_b128 v[56:59], v1 offset:10240
    s_waitcnt lgkmcnt(4)
    v_mfma_f32_16x16x32_bf16 v[8:11], a[24:27], v[60:63], v[8:11]
    v_mfma_f32_16x16x32_bf16 v[24:27], v[60:63], a[184:187], v[24:27]
    v_mfma_f32_16x16x32_bf16 v[12:15], a[104:107], v[60:63], v[12:15]
    v_mfma_f32_16x16x32_bf16 v[28:31], v[60:63], v[200:203], v[28:31]
    ds_read_b128 v[60:63], v1 offset:11264
    s_waitcnt lgkmcnt(4)
    v_mfma_f32_16x16x32_bf16 v[8:11], a[28:31], v[64:67], v[8:11]
    v_mfma_f32_16x16x32_bf16 v[24:27], v[64:67], a[188:191], v[24:27]
    v_mfma_f32_16x16x32_bf16 v[12:15], a[108:111], v[64:67], v[12:15]
    v_mfma_f32_16x16x32_bf16 v[28:31], v[64:67], v[204:207], v[28:31]
    ds_read_b128 v[64:67], v1 offset:12288
    s_waitcnt lgkmcnt(4)
    v_mfma_f32_16x16x32_bf16 v[8:11], a[32:35], v[68:71], v[8:11]
    v_mfma_f32_16x16x32_bf16 v[24:27], v[68:71], a[192:195], v[24:27]
    v_mfma_f32_16x16x32_bf16 v[12:15], a[112:115], v[68:71], v[12:15]
    v_mfma_f32_16x16x32_bf16 v[28:31], v[68:71], v[208:211], v[28:31]
    ds_read_b128 v[68:71], v1 offset:13312
    s_waitcnt lgkmcnt(4)
    v_mfma_f32_16x16x32_bf16 v[8:11], a[36:39], v[72:75], v[8:11]
    v_mfma_f32_16x16x32_bf16 v[24:27], v[72:75], a[196:199], v[24:27]
    v_mfma_f32_16x16x32_bf16 v[12:15], a[116:119], v[72:75], v[12:15]
    v_mfma_f32_16x16x32_bf16 v[28:31], v[72:75], v[212:215], v[28:31]
    ds_read_b128 v[72:75], v1 offset:14336
    s_waitcnt lgkmcnt(4)
    v_mfma_f32_16x16x32_bf16 v[8:11], a[40:43], v[56:59], v[8:11]
    v_mfma_f32_16x16x32_bf16 v[24:27], v[56:59], a[200:203], v[24:27]
    v_mfma_f32_16x16x32_bf16 v[12:15], a[120:123], v[56:59], v[12:15]
    v_mfma_f32_16x16x32_bf16 v[28:31], v[56:59], v[216:219], v[28:31]
    ds_read_b128 v[56:59], v1 offset:15360
    s_waitcnt lgkmcnt(4)
    v_mfma_f32_16x16x32_bf16 v[8:11], a[44:47], v[60:63], v[8:11]
    v_mfma_f32_16x16x32_bf16 v[24:27], v[60:63], a[204:207], v[24:27]
    v_mfma_f32_16x16x32_bf16 v[12:15], a[124:127], v[60:63], v[12:15]
    v_mfma_f32_16x16x32_bf16 v[28:31], v[60:63], v[220:223], v[28:31]
    s_waitcnt vmcnt(10)
    s_barrier
    s_cmp_lg_u32 s21, 0
    s_cbranch_scc1 M_kv_f0
    s_mov_b64 exec, 3
    buffer_store_dword v2, v3, s[8:11], s51 offen sc1
    s_mov_b64 exec, -1
M_kv_f0:
    ds_read_b128 v[60:63], v1 offset:16384
    s_waitcnt lgkmcnt(4)
    v_mfma_f32_16x16x32_bf16 v[8:11], a[48:51], v[64:67], v[8:11]
    v_mfma_f32_16x16x32_bf16 v[24:27], v[64:67], a[208:211], v[24:27]
    v_mfma_f32_16x16x32_bf16 v[12:15], a[128:131], v[64:67], v[12:15]
    v_mfma_f32_16x16x32_bf16 v[28:31], v[64:67], v[224:227], v[28:31]
    ds_read_b128 v[64:67], v1 offset:17408
    s_waitcnt lgkmcnt(4)
    v_mfma_f32_16x16x32_bf16 v[8:11], a[52:55], v[68:71], v[8:11]
    v_mfma_f32_16x16x32_bf16 v[24:27], v[68:71], a[212:215], v[24:27]
    v_mfma_f32_16x16x32_bf16 v[12:15], a[132:135], v[68:71], v[12:15]
    v_mfma_f32_16x16x32_bf16 v[28:31], v[68:71], v[228:231], v[28:31]
    ds_read_b128 v[68:71], v1 offset:18432
    s_waitcnt lgkmcnt(4)
    v_mfma_f32_16x16x32_bf16 v[8:11], a[56:59], v[72:75], v[8:11]
    v_mfma_f32_16x16x32_bf16 v[24:27], v[72:75], a[216:219], v[24:27]
    v_mfma_f32_16x16x32_bf16 v[12:15], a[136:139], v[72:75], v[12:15]
    v_mfma_f32_16x16x32_bf16 v[28:31], v[72:75], v[232:235], v[28:31]
    ds_read_b128 v[72:75], v1 offset:19456
    s_waitcnt lgkmcnt(4)
    v_mfma_f32_16x16x32_bf16 v[8:11], a[60:63], v[56:59], v[8:11]
    v_mfma_f32_16x16x32_bf16 v[24:27], v[56:59], a[220:223], v[24:27]
    v_mfma_f32_16x16x32_bf16 v[12:15], a[140:143], v[56:59], v[12:15]
    v_mfma_f32_16x16x32_bf16 v[28:31], v[56:59], v[236:239], v[28:31]
    ds_read_b128 v[56:59], v1 offset:20480
    s_waitcnt lgkmcnt(4)
    v_mfma_f32_16x16x32_bf16 v[8:11], a[64:67], v[60:63], v[8:11]
    v_mfma_f32_16x16x32_bf16 v[24:27], v[60:63], a[224:227], v[24:27]
    v_mfma_f32_16x16x32_bf16 v[12:15], a[144:147], v[60:63], v[12:15]
    v_mfma_f32_16x16x32_bf16 v[28:31], v[60:63], v[240:243], v[28:31]
    ds_read_b128 v[60:63], v1 offset:21504
    s_waitcnt lgkmcnt(4)
    v_mfma_f32_16x16x32_bf16 v[8:11], a[68:71], v[64:67], v[8:11]
    v_mfma_f32_16x16x32_bf16 v[24:27], v[64:67], a[228:231], v[24:27]
    v_mfma_f32_16x16x32_bf16 v[12:15], a[148:151], v[64:67], v[12:15]
    v_mfma_f32_16x16x32_bf16 v[28:31], v[64:67], v[244:247], v[28:31]
    ds_read_b128 v[64:67], v1 offset:22528
    s_waitcnt lgkmcnt(4)
    v_mfma_f32_16x16x32_bf16 v[8:11], a[72:75], v[68:71], v[8:11]
    v_mfma_f32_16x16x32_bf16 v[24:27], v[68:71], a[232:235], v[24:27]
    v_mfma_f32_16x16x32_bf16 v[12:15], a[152:155], v[68:71], v[12:15]
    v_mfma_f32_16x16x32_bf16 v[28:31], v[68:71], v[248:251], v[28:31]
    ds_read_b128 v[68:71], v1 offset:23552
    s_waitcnt lgkmcnt(4)
    v_mfma_f32_16x16x32_bf16 v[8:11], a[76:79], v[72:75], v[8:11]
    v_mfma_f32_16x16x32_bf16 v[24:27], v[72:75], a[236:239], v[24:27]
    v_mfma_f32_16x16x32_bf16 v[12:15], a[156:159], v[72:75], v[12:15]
    v_mfma_f32_16x16x32_bf16 v[28:31], v[72:75], v[252:255], v[28:31]
    ds_read_b128 v[72:75], v1 offset:24576
    s_waitcnt lgkmcnt(4)
    v_mfma_f32_16x16x32_bf16 v[16:19], a[0:3], v[56:59], 0
    v_mfma_f32_16x16x32_bf16 v[32:35], v[56:59], a[160:163], 0
    v_mfma_f32_16x16x32_bf16 v[20:23], a[80:83], v[56:59], 0
    v_mfma_f32_16x16x32_bf16 v[36:39], v[56:59], a[240:243], 0
    ds_read_b128 v[56:59], v1 offset:25600
    s_waitcnt lgkmcnt(4)
    v_mfma_f32_16x16x32_bf16 v[16:19], a[4:7], v[60:63], v[16:19]
    v_mfma_f32_16x16x32_bf16 v[32:35], v[60:63], a[164:167], v[32:35]
    v_mfma_f32_16x16x32_bf16 v[20:23], a[84:87], v[60:63], v[20:23]
    v_mfma_f32_16x16x32_bf16 v[36:39], v[60:63], a[244:247], v[36:39]
    ds_read_b128 v[60:63], v1 offset:26624
    s_waitcnt lgkmcnt(4)
    v_mfma_f32_16x16x32_bf16 v[16:19], a[8:11], v[64:67], v[16:19]
    v_cvt_pk_bf16_f32 v40, v8, v12
    v_mfma_f32_16x16x32_bf16 v[32:35], v[64:67], a[168:171], v[32:35]
    v_mfma_f32_16x16x32_bf16 v[20:23], a[88:91], v[64:67], v[20:23]
    v_cvt_pk_bf16_f32 v41, v9, v13
    v_mfma_f32_16x16x32_bf16 v[36:39], v[64:67], a[248:251], v[36:39]
    ds_read_b128 v[64:67], v1 offset:27648
    s_waitcnt lgkmcnt(4)
    v_mfma_f32_16x16x32_bf16 v[16:19], a[12:15], v[68:71], v[16:19]
    v_cvt_pk_bf16_f32 v42, v10, v14
    v_mfma_f32_16x16x32_bf16 v[32:35], v[68:71], a[172:175], v[32:35]
    v_mfma_f32_16x16x32_bf16 v[20:23], a[92:95], v[68:71], v[20:23]
    v_cvt_pk_bf16_f32 v43, v11, v15
    v_mfma_f32_16x16x32_bf16 v[36:39], v[68:71], a[252:255], v[36:39]
    ds_read_b128 v[68:71], v1 offset:28672
    s_waitcnt lgkmcnt(4)
    v_mfma_f32_16x16x32_bf16 v[16:19], a[16:19], v[72:75], v[16:19]
    v_cvt_pk_bf16_f32 v48, v24, v25
    v_mfma_f32_16x16x32_bf16 v[32:35], v[72:75], a[176:179], v[32:35]
    v_mfma_f32_16x16x32_bf16 v[20:23], a[96:99], v[72:75], v[20:23]
    v_cvt_pk_bf16_f32 v49, v26, v27
    v_mfma_f32_16x16x32_bf16 v[36:39], v[72:75], v[192:195], v[36:39]
    ds_read_b128 v[72:75], v1 offset:29696
    s_waitcnt lgkmcnt(4)
    v_mfma_f32_16x16x32_bf16 v[16:19], a[20:23], v[56:59], v[16:19]
    v_cvt_pk_bf16_f32 v52, v28, v29
    v_mfma_f32_16x16x32_bf16 v[32:35], v[56:59], a[180:183], v[32:35]
    v_mfma_f32_16x16x32_bf16 v[20:23], a[100:103], v[56:59], v[20:23]
    v_cvt_pk_bf16_f32 v53, v30, v31
    v_mfma_f32_16x16x32_bf16 v[36:39], v[56:59], v[196:199], v[36:39]
    ds_read_b128 v[56:59], v1 offset:30720
    s_waitcnt lgkmcnt(4)
    v_mfma_f32_16x16x32_bf16 v[16:19], a[24:27], v[60:63], v[16:19]
    v_mfma_f32_16x16x32_bf16 v[32:35], v[60:63], a[184:187], v[32:35]
    v_mfma_f32_16x16x32_bf16 v[20:23], a[104:107], v[60:63], v[20:23]
    v_mfma_f32_16x16x32_bf16 v[36:39], v[60:63], v[200:203], v[36:39]
    ds_read_b128 v[60:63], v1 offset:31744
    s_waitcnt lgkmcnt(4)
    v_mfma_f32_16x16x32_bf16 v[16:19], a[28:31], v[64:67], v[16:19]
    v_mfma_f32_16x16x32_bf16 v[32:35], v[64:67], a[188:191], v[32:35]
    v_mfma_f32_16x16x32_bf16 v[20:23], a[108:111], v[64:67], v[20:23]
    v_mfma_f32_16x16x32_bf16 v[36:39], v[64:67], v[204:207], v[36:39]
    ds_read_b128 v[64:67], v1 offset:32768
    s_waitcnt lgkmcnt(4)
    v_mfma_f32_16x16x32_bf16 v[16:19], a[32:35], v[68:71], v[16:19]
    v_mfma_f32_16x16x32_bf16 v[32:35], v[68:71], a[192:195], v[32:35]
    v_mfma_f32_16x16x32_bf16 v[20:23], a[112:115], v[68:71], v[20:23]
    v_mfma_f32_16x16x32_bf16 v[36:39], v[68:71], v[208:211], v[36:39]
    ds_read_b128 v[68:71], v1 offset:33792
    s_waitcnt lgkmcnt(4)
    v_mfma_f32_16x16x32_bf16 v[16:19], a[36:39], v[72:75], v[16:19]
    v_mfma_f32_16x16x32_bf16 v[32:35], v[72:75], a[196:199], v[32:35]
    v_mfma_f32_16x16x32_bf16 v[20:23], a[116:119], v[72:75], v[20:23]
    v_mfma_f32_16x16x32_bf16 v[36:39], v[72:75], v[212:215], v[36:39]
    ds_read_b128 v[72:75], v1 offset:34816
    s_waitcnt lgkmcnt(4)
    v_mfma_f32_16x16x32_bf16 v[16:19], a[40:43], v[56:59], v[16:19]
    v_mfma_f32_16x16x32_bf16 v[32:35], v[56:59], a[200:203], v[32:35]
    v_mfma_f32_16x16x32_bf16 v[20:23], a[120:123], v[56:59], v[20:23]
    v_mfma_f32_16x16x32_bf16 v[36:39], v[56:59], v[216:219], v[36:39]
    ds_read_b128 v[56:59], v1 offset:35840
    s_waitcnt lgkmcnt(4)
    v_mfma_f32_16x16x32_bf16 v[16:19], a[44:47], v[60:63], v[16:19]
    v_mfma_f32_16x16x32_bf16 v[32:35], v[60:63], a[204:207], v[32:35]
    v_mfma_f32_16x16x32_bf16 v[20:23], a[124:127], v[60:63], v[20:23]
    v_mfma_f32_16x16x32_bf16 v[36:39], v[60:63], v[220:223], v[36:39]
    ds_read_b128 v[60:63], v1 offset:36864
    s_waitcnt lgkmcnt(4)
    v_mfma_f32_16x16x32_bf16 v[16:19], a[48:51], v[64:67], v[16:19]
    v_mfma_f32_16x16x32_bf16 v[32:35], v[64:67], a[208:211], v[32:35]
    v_mfma_f32_16x16x32_bf16 v[20:23], a[128:131], v[64:67], v[20:23]
    v_mfma_f32_16x16x32_bf16 v[36:39], v[64:67], v[224:227], v[36:39]
    ds_read_b128 v[64:67], v1 offset:37888
    s_waitcnt lgkmcnt(4)
    v_mfma_f32_16x16x32_bf16 v[16:19], a[52:55], v[68:71], v[16:19]
    v_mfma_f32_16x16x32_bf16 v[32:35], v[68:71], a[212:215], v[32:35]
    v_mfma_f32_16x16x32_bf16 v[20:23], a[132:135], v[68:71], v[20:23]
    v_mfma_f32_16x16x32_bf16 v[36:39], v[68:71], v[228:231], v[36:39]
    ds_read_b128 v[68:71], v1 offset:38912
    s_waitcnt lgkmcnt(4)
    v_mfma_f32_16x16x32_bf16 v[16:19], a[56:59], v[72:75], v[16:19]
    v_mfma_f32_16x16x32_bf16 v[32:35], v[72:75], a[216:219], v[32:35]
    v_mfma_f32_16x16x32_bf16 v[20:23], a[136:139], v[72:75], v[20:23]
    v_mfma_f32_16x16x32_bf16 v[36:39], v[72:75], v[232:235], v[36:39]
    ds_read_b128 v[72:75], v1 offset:39936
    s_waitcnt lgkmcnt(4)
    v_mfma_f32_16x16x32_bf16 v[16:19], a[60:63], v[56:59], v[16:19]
    v_mfma_f32_16x16x32_bf16 v[32:35], v[56:59], a[220:223], v[32:35]
    v_mfma_f32_16x16x32_bf16 v[20:23], a[140:143], v[56:59], v[20:23]
    v_mfma_f32_16x16x32_bf16 v[36:39], v[56:59], v[236:239], v[36:39]
    s_waitcnt vmcnt(0)
    s_barrier
    ds_read_b128 v[56:59], v4 offset:0
    s_waitcnt lgkmcnt(4)
    v_mfma_f32_16x16x32_bf16 v[16:19], a[64:67], v[60:63], v[16:19]
    v_mfma_f32_16x16x32_bf16 v[32:35], v[60:63], a[224:227], v[32:35]
    v_mfma_f32_16x16x32_bf16 v[20:23], a[144:147], v[60:63], v[20:23]
    v_mfma_f32_16x16x32_bf16 v[36:39], v[60:63], v[240:243], v[36:39]
    ds_read_b128 v[60:63], v4 offset:1024
    s_waitcnt lgkmcnt(4)
    v_mfma_f32_16x16x32_bf16 v[16:19], a[68:71], v[64:67], v[16:19]
    v_mfma_f32_16x16x32_bf16 v[32:35], v[64:67], a[228:231], v[32:35]
    v_mfma_f32_16x16x32_bf16 v[20:23], a[148:151], v[64:67], v[20:23]
    v_mfma_f32_16x16x32_bf16 v[36:39], v[64:67], v[244:247], v[36:39]
    ds_read_b128 v[64:67], v4 offset:2048
    s_waitcnt lgkmcnt(4)
    v_mfma_f32_16x16x32_bf16 v[16:19], a[72:75], v[68:71], v[16:19]
    v_mfma_f32_16x16x32_bf16 v[32:35], v[68:71], a[232:235], v[32:35]
    v_mfma_f32_16x16x32_bf16 v[20:23], a[152:155], v[68:71], v[20:23]
    v_mfma_f32_16x16x32_bf16 v[36:39], v[68:71], v[248:251], v[36:39]
    ds_read_b128 v[68:71], v4 offset:3072
    s_waitcnt lgkmcnt(4)
    v_mfma_f32_16x16x32_bf16 v[16:19], a[76:79], v[72:75], v[16:19]
    v_mfma_f32_16x16x32_bf16 v[32:35], v[72:75], a[236:239], v[32:35]
    v_mfma_f32_16x16x32_bf16 v[20:23], a[156:159], v[72:75], v[20:23]
    v_mfma_f32_16x16x32_bf16 v[36:39], v[72:75], v[252:255], v[36:39]
    s_add_u32 s27, s50, 4096
    v_mov_b32 v1, v4
    buffer_store_dwordx4 v[40:43], v0, s[8:11], s50 offen sc1
    s_nop 3
    v_cvt_pk_bf16_f32 v44, v16, v20
    v_cvt_pk_bf16_f32 v45, v17, v21
    v_cvt_pk_bf16_f32 v46, v18, v22
    v_cvt_pk_bf16_f32 v47, v19, v23
    v_cvt_pk_bf16_f32 v50, v32, v33
    v_cvt_pk_bf16_f32 v51, v34, v35
    v_cvt_pk_bf16_f32 v54, v36, v37
    v_cvt_pk_bf16_f32 v55, v38, v39
    buffer_store_dwordx4 v[44:47], v0, s[8:11], s27 offen sc1
    buffer_store_dwordx4 v[48:51], v0, s[8:11], s52 offen offset:0 sc1
    buffer_store_dwordx4 v[52:55], v0, s[8:11], s52 offen offset:1024 sc1
    s_add_u32 s50, s50, 262144
    s_add_u32 s52, s52, 262144
    s_barrier
    s_cmp_lg_u32 s44, 2
    s_cbranch_scc1 M_kv_np
    s_cmp_lg_u32 s21, 0
    s_cbranch_scc1 M_kx_4
    v_lshlrev_b32 v190, 3, v0
    s_mov_b64 exec, -1
    s_mov_b32 s30, 0
    s_lshl_b32 s27, s101, 13
    s_add_u32 s27, s27, 167911424
M_kx_5:
    buffer_load_dwordx4 v[176:179], v190, s[8:11], s27 offen sc1
    buffer_load_dwordx4 v[180:183], v190, s[8:11], s27 offen offset:16 sc1
    buffer_load_dwordx2 v[184:185], v190, s[8:11], s27 offen offset:32 sc1
    s_add_u32 s30, s30, 1
    s_cmp_ge_u32 s30, 60000
    s_cbranch_scc1 M_fail
    s_waitcnt vmcnt(0)
    v_min3_u32 v176, v176, v177, v178
    v_min3_u32 v176, v176, v179, v180
    v_min3_u32 v176, v176, v181, v182
    v_min3_u32 v176, v176, v183, v184
    v_min_u32 v176, v176, v185
    v_cmp_eq_u32 vcc, 0, v176
    s_cbranch_vccnz M_kx_5
    s_mov_b64 exec, -1
M_kx_4:
    s_barrier
M_kx_6:
M_kv_np:
    s_cmp_lt_u32 s44, 64
    s_cbranch_scc1 M_kv_top
    s_add_u32 s27, s44, s43
    v_mov_b32 v2, s27
    s_waitcnt vmcnt(0) lgkmcnt(0)
    s_barrier
    s_cmp_lg_u32 s21, 0
    s_cbranch_scc1 M_kv_f2
    s_mov_b64 exec, 3
    buffer_store_dword v2, v3, s[8:11], s51 offen sc1
    s_mov_b64 exec, -1
M_kv_f2:
    s_branch M_bphase
M_qao:
    s_cmp_lg_u32 s101, 0
    s_cbranch_scc1 M_q_ft
    v_lshrrev_b32 v1, 4, v0
    v_lshrrev_b32 v3, 8, v0
    v_and_b32 v4, 15, v1
    v_mov_b32 v5, v0
    s_min_u32 s36, s22, 19
    s_mul_i32 s36, s36, 40
    s_mul_i32 s27, s21, 10
    s_add_u32 s36, s36, s27
    s_add_u32 s35, s36, 10
    s_add_u32 s27, s42, 122880
    v_add_u32 v2, s27, v0
M_q_ftl:
    s_mul_hi_u32 s37, s36, 0xccccccd
    s_mul_i32 s38, s37, 20
    s_sub_u32 s38, s36, s38
    s_lshl_b32 s37, s37, 4
    s_lshl_b32 s38, s38, 5
    v_lshlrev_b32 v7, 3, v3
    v_add_u32 v7, s38, v7
    s_mov_b32 s39, 0x666667
    s_movk_i32 s40, 640
    v_add_u32 v6, s37, v4
    v_cmp_lt_u32 vcc, 320, v6
    v_subrev_u32 v8, 320, v6
    s_nop 1
    v_cndmask_b32 v8, v6, v8, vcc
    v_mov_b32 v9, 0
    v_mov_b32 v10, 0x3e800000
    v_cndmask_b32 v9, v9, v10, vcc
    v_add_u32 v11, 0, v7
    v_mul_u32_u24 v11, v11, v8
    v_mul_hi_u32 v12, v11, s39
    v_mul_lo_u32 v12, v12, s40
    v_sub_u32 v11, v11, v12
    v_cvt_f32_u32 v11, v11
    v_mov_b32 v12, v9
    v_fmac_f32 v12, 0x3acccccd, v11
    v_cos_f32 v16, v12
    v_add_u32 v11, 1, v7
    v_mul_u32_u24 v11, v11, v8
    v_mul_hi_u32 v12, v11, s39
    v_mul_lo_u32 v12, v12, s40
    v_sub_u32 v11, v11, v12
    v_cvt_f32_u32 v11, v11
    v_mov_b32 v12, v9
    v_fmac_f32 v12, 0x3acccccd, v11
    v_cos_f32 v17, v12
    v_add_u32 v11, 2, v7
    v_mul_u32_u24 v11, v11, v8
    v_mul_hi_u32 v12, v11, s39
    v_mul_lo_u32 v12, v12, s40
    v_sub_u32 v11, v11, v12
    v_cvt_f32_u32 v11, v11
    v_mov_b32 v12, v9
    v_fmac_f32 v12, 0x3acccccd, v11
    v_cos_f32 v18, v12
    v_add_u32 v11, 3, v7
    v_mul_u32_u24 v11, v11, v8
    v_mul_hi_u32 v12, v11, s39
    v_mul_lo_u32 v12, v12, s40
    v_sub_u32 v11, v11, v12
    v_cvt_f32_u32 v11, v11
    v_mov_b32 v12, v9
    v_fmac_f32 v12, 0x3acccccd, v11
    v_cos_f32 v19, v12
    v_add_u32 v11, 4, v7
    v_mul_u32_u24 v11, v11, v8
    v_mul_hi_u32 v12, v11, s39
    v_mul_lo_u32 v12, v12, s40
    v_sub_u32 v11, v11, v12
    v_cvt_f32_u32 v11, v11
    v_mov_b32 v12, v9
    v_fmac_f32 v12, 0x3acccccd, v11
    v_cos_f32 v20, v12
    v_add_u32 v11, 5, v7
    v_mul_u32_u24 v11, v11, v8
    v_mul_hi_u32 v12, v11, s39
    v_mul_lo_u32 v12, v12, s40
    v_sub_u32 v11, v11, v12
    v_cvt_f32_u32 v11, v11
    v_mov_b32 v12, v9
    v_fmac_f32 v12, 0x3acccccd, v11
    v_cos_f32 v21, v12
    v_add_u32 v11, 6, v7
    v_mul_u32_u24 v11, v11, v8
    v_mul_hi_u32 v12, v11, s39
    v_mul_lo_u32 v12, v12, s40
    v_sub_u32 v11, v11, v12
    v_cvt_f32_u32 v11, v11
    v_mov_b32 v12, v9
    v_fmac_f32 v12, 0x3acccccd, v11
    v_cos_f32 v22, v12
    v_add_u32 v11, 7, v7
    v_mul_u32_u24 v11, v11, v8
    v_mul_hi_u32 v12, v11, s39
    v_mul_lo_u32 v12, v12, s40
    v_sub_u32 v11, v11, v12
    v_cvt_f32_u32 v11, v11
    v_mov_b32 v12, v9
    v_fmac_f32 v12, 0x3acccccd, v11
    v_cos_f32 v23, v12
    s_nop 0
    v_cvt_pk_f16_f32 v24, v16, v17
    v_cvt_pk_f16_f32 v25, v18, v19
    v_cvt_pk_f16_f32 v26, v20, v21
    v_cvt_pk_f16_f32 v27, v22, v23
    ds_write_b128 v2, v[24:27]
    v_add_u32 v2, 1024, v2
    s_add_u32 s36, s36, 1
    s_cmp_lt_u32 s36, s35
    s_cbranch_scc1 M_q_ftl
    s_waitcnt lgkmcnt(0)
M_q_ft:
    v_lshrrev_b32 v1, 8, v0
    v_bfe_u32 v2, v0, 4, 4
    v_add_u32 v3, 81920, v0
    v_add_u32 v14, 122880, v0
    s_mul_i32 s28, s21, 320
    v_mul_u32_u24 v10, 40960, v2
    v_lshl_add_u32 v10, v1, 4, v10
    s_mul_i32 s27, s22, 1280
    s_add_u32 s29, s27, s28
    v_add_u32 v4, s29, v10
    v_mul_u32_u24 v10, 1280, v1
    s_mul_i32 s27, s22, 40960
    s_add_u32 s27, s27, s28
    v_add_u32 v10, s27, v10
    v_lshl_add_u32 v5, v2, 4, v10
    v_lshrrev_b32 v11, 2, v2
    v_mul_u32_u24 v15, 5120, v11
    v_add_u32 v10, v10, v15
    v_and_b32 v15, 0x30, v0
    v_add_u32 v6, v10, v15
    v_and_b32 v10, 1, v1
    v_lshlrev_b32 v10, 3, v10
    v_add_u32 v8, s29, v10
    v_lshl_add_u32 v7, v2, 4, v8
    v_add_u32 v8, v8, v15
    v_lshl_add_u32 v10, v11, 10, v10
    v_lshl_add_u32 v10, v15, 4, v10
    s_mul_i32 s27, s21, 5120
    s_and_b32 s28, s22, 15
    s_lshl_b32 s28, s28, 4
    s_add_u32 s27, s27, s28
    s_lshr_b32 s28, s22, 4
    s_mul_i32 s28, s28, 20480
    s_add_u32 s27, s27, s28
    v_add_u32 v12, s27, v10
    v_lshlrev_b32 v10, 13, v2
    v_lshl_add_u32 v10, v1, 4, v10
    s_lshl_b32 s27, s22, 18
    s_lshl_b32 s28, s21, 6
    s_add_u32 s27, s27, s28
    v_add_u32 v13, s27, v10
    s_and_b32 s58, s21, 1
    s_lshr_b32 s59, s21, 1
    v_lshlrev_b32 v10, 2, v1
    v_sub_u32 v10, v2, v10
    s_lshl_b32 s27, s58, 4
    v_add_u32 v9, s27, v10
    v_and_b32 v10, 16, v0
    s_movk_i32 s27, 0x3f80
    v_lshlrev_b32_e64 v10, v10, s27
    v_bfe_u32 v11, v0, 5, 2
    v_cmp_eq_u32 vcc, 0, v11
    s_nop 1
    v_cndmask_b32 v16, 0, v10, vcc
    v_cmp_eq_u32 vcc, 1, v11
    s_nop 1
    v_cndmask_b32 v17, 0, v10, vcc
    v_cmp_eq_u32 vcc, 2, v11
    s_nop 1
    v_cndmask_b32 v18, 0, v10, vcc
    v_cmp_eq_u32 vcc, 3, v11
    s_nop 1
    v_cndmask_b32 v19, 0, v10, vcc
    s_mov_b32 s40, 0x3e0293ee
    s_mov_b32 s41, s40
    s_sub_u32 s44, s20, 4
    s_min_u32 s44, s44, 4
    s_mov_b32 s45, 0
    s_load_dwordx2 s[72:73], s[0:1], 64
    s_load_dwordx2 s[76:77], s[0:1], 72
    s_mul_i32 s94, s44, 12
    s_add_u32 s94, s94, s22
    s_sub_u32 s94, s94, 20
    s_lshl_b32 s95, s94, 7
    s_add_u32 s95, s95, 167948288
    s_lshl_b32 s94, s94, 2
    s_add_u32 s94, s94, s21
    s_cmp_lg_u32 s101, 0
    s_cselect_b32 s94, 5000, s94
    s_waitcnt lgkmcnt(0)
    s_and_b32 s73, s73, 0xffff
    s_mov_b32 s74, 1314816
    s_mov_b32 s75, 0x00020000
    s_and_b32 s77, s77, 0xffff
    s_mov_b32 s78, 1314816
    s_mov_b32 s79, 0x00020000
    s_mul_i32 s48, s44, 2621440
    s_add_u32 s48, s48, 117440512
    s_mov_b32 s49, 1310720
    s_lshl_b32 s51, s44, 12
    s_lshl_b32 s27, s101, 11
    s_add_u32 s51, s51, s27
    s_add_u32 s51, s51, 167870464
    s_lshl_b32 s52, s22, 7
    s_lshl_b32 s27, s101, 12
    s_add_u32 s52, s52, s27
    s_add_u32 s52, s52, 167862272
    s_lshl_b32 s53, s22, 13
    s_add_u32 s53, s53, 218103808
    s_mul_i32 s54, s101, 8388608
    s_add_u32 s54, s54, 134217728
    s_lshl_b32 s60, s22, 8
    s_add_u32 s60, s60, 167854080
    s_mul_i32 s63, s44, 65536
    s_add_u32 s63, s63, 104857600
    s_add_u32 s64, s63, 4096
    s_cmp_lg_u32 s21, 0
    s_cbranch_scc1 M_qx_7
    v_lshlrev_b32 v190, 3, v0
    s_mov_b64 exec, -1
    s_mov_b32 s30, 0
    s_lshl_b32 s27, s101, 13
    s_add_u32 s27, s27, 167911424
M_qx_8:
    buffer_load_dwordx4 v[176:179], v190, s[8:11], s27 offen sc1
    buffer_load_dwordx4 v[180:183], v190, s[8:11], s27 offen offset:16 sc1
    buffer_load_dwordx2 v[184:185], v190, s[8:11], s27 offen offset:32 sc1
    s_add_u32 s30, s30, 1
    s_cmp_ge_u32 s30, 60000
    s_cbranch_scc1 M_fail
    s_waitcnt vmcnt(0)
    v_min3_u32 v176, v176, v177, v178
    v_min3_u32 v176, v176, v179, v180
    v_min3_u32 v176, v176, v181, v182
    v_min3_u32 v176, v176, v183, v184
    v_min_u32 v176, v176, v185
    v_cmp_eq_u32 vcc, 0, v176
    s_cbranch_vccnz M_qx_8
    s_mov_b64 exec, -1
M_qx_7:
    s_barrier
M_qx_9:
    s_min_u32 s27, s44, 63
    s_mul_i32 s27, s27, 40960
    s_add_u32 s27, s27, s47
    s_add_u32 s28, 0, s42
    s_mov_b32 m0, s28
    s_nop 0
    buffer_load_dwordx4 v0, s[8:11], s27 offen offset:0 sc1 lds
    buffer_load_dwordx4 v0, s[8:11], s27 offen offset:1024 sc1 lds
    buffer_load_dwordx4 v0, s[8:11], s27 offen offset:2048 sc1 lds
    buffer_load_dwordx4 v0, s[8:11], s27 offen offset:3072 sc1 lds
    s_add_u32 s27, s27, 4096
    s_add_u32 s28, s28, 4096
    s_mov_b32 m0, s28
    s_nop 0
    buffer_load_dwordx4 v0, s[8:11], s27 offen offset:0 sc1 lds
    buffer_load_dwordx4 v0, s[8:11], s27 offen offset:1024 sc1 lds
    buffer_load_dwordx4 v0, s[8:11], s27 offen offset:2048 sc1 lds
    buffer_load_dwordx4 v0, s[8:11], s27 offen offset:3072 sc1 lds
    s_add_u32 s27, s27, 4096
    s_add_u32 s28, s28, 4096
    s_mov_b32 m0, s28
    s_nop 0
    buffer_load_dwordx4 v0, s[8:11], s27 offen offset:0 sc1 lds
    buffer_load_dwordx4 v0, s[8:11], s27 offen offset:1024 sc1 lds
    s_add_u32 s46, s44, 5
    s_min_u32 s27, s46, 63
    s_mul_i32 s27, s27, 40960
    s_add_u32 s27, s27, s47
    s_add_u32 s28, 40960, s42
    s_mov_b32 m0, s28
    s_nop 0
    buffer_load_dwordx4 v0, s[8:11], s27 offen offset:0 sc1 lds
    buffer_load_dwordx4 v0, s[8:11], s27 offen offset:1024 sc1 lds
    buffer_load_dwordx4 v0, s[8:11], s27 offen offset:2048 sc1 lds
    buffer_load_dwordx4 v0, s[8:11], s27 offen offset:3072 sc1 lds
    s_add_u32 s27, s27, 4096
    s_add_u32 s28, s28, 4096
    s_mov_b32 m0, s28
    s_nop 0
    buffer_load_dwordx4 v0, s[8:11], s27 offen offset:0 sc1 lds
    buffer_load_dwordx4 v0, s[8:11], s27 offen offset:1024 sc1 lds
    buffer_load_dwordx4 v0, s[8:11], s27 offen offset:2048 sc1 lds
    buffer_load_dwordx4 v0, s[8:11], s27 offen offset:3072 sc1 lds
    s_add_u32 s27, s27, 4096
    s_add_u32 s28, s28, 4096
    s_mov_b32 m0, s28
    s_nop 0
    buffer_load_dwordx4 v0, s[8:11], s27 offen offset:0 sc1 lds
    buffer_load_dwordx4 v0, s[8:11], s27 offen offset:1024 sc1 lds
    s_waitcnt vmcnt(0)
    s_barrier
    s_mov_b32 s65, 0
    s_mov_b32 s66, s44
    s_mov_b32 s62, 0x10000000
    s_mov_b32 s67, 0x10000000
    s_mov_b32 s68, 0x10000000
M_q_front:
    s_add_u32 s56, s66, s43
    s_mov_b32 s30, 0
M_q_kf:
    s_cmp_gt_u32 s65, s56
    s_cbranch_scc1 M_q_kg
    v_lshlrev_b32 v10, 3, v0
    s_mov_b64 exec, 3
    buffer_load_dword v15, v10, s[8:11], s60 offen sc1
    s_mov_b64 exec, -1
    s_waitcnt vmcnt(0)
    v_readlane_b32 s65, v15, 0
    v_readlane_b32 s27, v15, 1
    s_nop 3
    s_min_u32 s65, s65, s27
    s_sleep 1
    s_add_u32 s30, s30, 1
    s_cmp_lt_u32 s30, 60000
    s_cbranch_scc1 M_q_kf
    s_branch M_fail
M_q_kg:
    s_nop 1
    s_lshl_b32 s27, s66, 18
    s_add_u32 s27, s27, s50
    s_add_u32 s28, s27, 4096
    buffer_load_dwordx4 v[72:75], v0, s[8:11], s27 offen offset:0 sc1
    buffer_load_dwordx4 v[76:79], v0, s[8:11], s27 offen offset:1024 sc1
    buffer_load_dwordx4 v[80:83], v0, s[8:11], s27 offen offset:2048 sc1
    buffer_load_dwordx4 v[84:87], v0, s[8:11], s27 offen offset:3072 sc1
    buffer_load_dwordx4 v[88:91], v0, s[8:11], s28 offen offset:0 sc1
    buffer_load_dwordx4 v[92:95], v0, s[8:11], s28 offen offset:1024 sc1
    buffer_load_dwordx4 v[96:99], v0, s[8:11], s28 offen offset:2048 sc1
    buffer_load_dwordx4 v[100:103], v0, s[8:11], s28 offen offset:3072 sc1
    s_lshl_b32 s28, s59, 12
    s_add_u32 s27, s27, s28
    s_add_u32 s27, s27, 16777216
    buffer_load_dwordx4 v[104:107], v0, s[8:11], s27 offen offset:0 sc1
    buffer_load_dwordx4 v[108:111], v0, s[8:11], s27 offen offset:1024 sc1
    buffer_load_dwordx4 v[112:115], v0, s[8:11], s27 offen offset:2048 sc1
    buffer_load_dwordx4 v[116:119], v0, s[8:11], s27 offen offset:3072 sc1
    s_mul_i32 s27, s66, 40960
    buffer_load_dwordx2 v[184:185], v7, s[16:19], s27 offen sc1
    buffer_load_dwordx2 v[186:187], v8, s[16:19], s27 offen offset:256 sc1
    v_lshlrev_b32 v10, 3, v0
    s_mov_b64 exec, 3
    buffer_load_dword v15, v10, s[8:11], s60 offen sc1
    s_mov_b64 exec, -1
    v_add_u32 v11, s45, v0
    s_sub_u32 s45, 40960, s45
    ds_read_b128 v[40:43], v11 offset:0
    ds_read_b128 v[44:47], v11 offset:1024
    ds_read_b128 v[48:51], v11 offset:2048
    ds_read_b128 v[52:55], v11 offset:3072
    ds_read_b128 v[56:59], v11 offset:4096
    ds_read_b128 v[60:63], v11 offset:5120
    s_waitcnt lgkmcnt(5)
    v_mfma_f32_16x16x32_bf16 v[24:27], a[0:3], v[40:43], 0
    v_mfma_f32_16x16x32_bf16 v[28:31], a[80:83], v[40:43], 0
    ds_read_b128 v[40:43], v11 offset:6144
    s_waitcnt lgkmcnt(5)
    v_mfma_f32_16x16x32_bf16 v[24:27], a[4:7], v[44:47], v[24:27]
    v_mfma_f32_16x16x32_bf16 v[28:31], a[84:87], v[44:47], v[28:31]
    ds_read_b128 v[44:47], v11 offset:7168
    s_waitcnt lgkmcnt(5)
    v_mfma_f32_16x16x32_bf16 v[24:27], a[8:11], v[48:51], v[24:27]
    v_mfma_f32_16x16x32_bf16 v[28:31], a[88:91], v[48:51], v[28:31]
    ds_read_b128 v[48:51], v11 offset:8192
    s_waitcnt lgkmcnt(5)
    v_mfma_f32_16x16x32_bf16 v[24:27], a[12:15], v[52:55], v[24:27]
    v_mfma_f32_16x16x32_bf16 v[28:31], a[92:95], v[52:55], v[28:31]
    ds_read_b128 v[52:55], v11 offset:9216
    s_waitcnt lgkmcnt(5)
    v_mfma_f32_16x16x32_bf16 v[24:27], a[16:19], v[56:59], v[24:27]
    v_mfma_f32_16x16x32_bf16 v[28:31], a[96:99], v[56:59], v[28:31]
    ds_read_b128 v[56:59], v11 offset:10240
    s_waitcnt lgkmcnt(5)
    v_mfma_f32_16x16x32_bf16 v[24:27], a[20:23], v[60:63], v[24:27]
    v_mfma_f32_16x16x32_bf16 v[28:31], a[100:103], v[60:63], v[28:31]
    ds_read_b128 v[60:63], v11 offset:11264
    s_waitcnt lgkmcnt(5)
    v_mfma_f32_16x16x32_bf16 v[24:27], a[24:27], v[40:43], v[24:27]
    v_mfma_f32_16x16x32_bf16 v[28:31], a[104:107], v[40:43], v[28:31]
    ds_read_b128 v[40:43], v11 offset:12288
    s_waitcnt lgkmcnt(5)
    v_mfma_f32_16x16x32_bf16 v[24:27], a[28:31], v[44:47], v[24:27]
    v_mfma_f32_16x16x32_bf16 v[28:31], a[108:111], v[44:47], v[28:31]
    ds_read_b128 v[44:47], v11 offset:13312
    s_waitcnt lgkmcnt(5)
    v_mfma_f32_16x16x32_bf16 v[24:27], a[32:35], v[48:51], v[24:27]
    v_mfma_f32_16x16x32_bf16 v[28:31], a[112:115], v[48:51], v[28:31]
    ds_read_b128 v[48:51], v11 offset:14336
    s_waitcnt lgkmcnt(5)
    v_mfma_f32_16x16x32_bf16 v[24:27], a[36:39], v[52:55], v[24:27]
    v_mfma_f32_16x16x32_bf16 v[28:31], a[116:119], v[52:55], v[28:31]
    ds_read_b128 v[52:55], v11 offset:15360
    s_waitcnt lgkmcnt(5)
    v_mfma_f32_16x16x32_bf16 v[24:27], a[40:43], v[56:59], v[24:27]
    v_mfma_f32_16x16x32_bf16 v[28:31], a[120:123], v[56:59], v[28:31]
    ds_read_b128 v[56:59], v11 offset:16384
    s_waitcnt lgkmcnt(5)
    v_mfma_f32_16x16x32_bf16 v[24:27], a[44:47], v[60:63], v[24:27]
    v_mfma_f32_16x16x32_bf16 v[28:31], a[124:127], v[60:63], v[28:31]
    ds_read_b128 v[60:63], v11 offset:17408
    s_waitcnt lgkmcnt(5)
    v_mfma_f32_16x16x32_bf16 v[24:27], a[48:51], v[40:43], v[24:27]
    v_mfma_f32_16x16x32_bf16 v[28:31], a[128:131], v[40:43], v[28:31]
    ds_read_b128 v[40:43], v11 offset:18432
    s_waitcnt lgkmcnt(5)
    v_mfma_f32_16x16x32_bf16 v[24:27], a[52:55], v[44:47], v[24:27]
    v_mfma_f32_16x16x32_bf16 v[28:31], a[132:135], v[44:47], v[28:31]
    ds_read_b128 v[44:47], v11 offset:19456
    s_waitcnt lgkmcnt(5)
    v_mfma_f32_16x16x32_bf16 v[24:27], a[56:59], v[48:51], v[24:27]
    v_mfma_f32_16x16x32_bf16 v[28:31], a[136:139], v[48:51], v[28:31]
    ds_read_b128 v[48:51], v11 offset:20480
    s_waitcnt lgkmcnt(5)
    v_mfma_f32_16x16x32_bf16 v[24:27], a[60:63], v[52:55], v[24:27]
    v_mfma_f32_16x16x32_bf16 v[28:31], a[140:143], v[52:55], v[28:31]
    ds_read_b128 v[52:55], v11 offset:21504
    s_waitcnt lgkmcnt(5)
    v_mfma_f32_16x16x32_bf16 v[24:27], a[64:67], v[56:59], v[24:27]
    v_mfma_f32_16x16x32_bf16 v[28:31], a[144:147], v[56:59], v[28:31]
    ds_read_b128 v[56:59], v11 offset:22528
    s_waitcnt lgkmcnt(5)
    v_mfma_f32_16x16x32_bf16 v[24:27], a[68:71], v[60:63], v[24:27]
    v_mfma_f32_16x16x32_bf16 v[28:31], a[148:151], v[60:63], v[28:31]
    ds_read_b128 v[60:63], v11 offset:23552
    s_waitcnt lgkmcnt(5)
    v_mfma_f32_16x16x32_bf16 v[24:27], a[72:75], v[40:43], v[24:27]
    v_mfma_f32_16x16x32_bf16 v[28:31], a[152:155], v[40:43], v[28:31]
    ds_read_b128 v[40:43], v11 offset:24576
    s_waitcnt lgkmcnt(5)
    v_mfma_f32_16x16x32_bf16 v[24:27], a[76:79], v[44:47], v[24:27]
    v_mfma_f32_16x16x32_bf16 v[28:31], a[156:159], v[44:47], v[28:31]
    ds_read_b128 v[44:47], v11 offset:25600
    s_waitcnt lgkmcnt(5)
    v_mfma_f32_16x16x32_bf16 v[32:35], a[0:3], v[48:51], 0
    v_mfma_f32_16x16x32_bf16 v[36:39], a[80:83], v[48:51], 0
    ds_read_b128 v[48:51], v11 offset:26624
    s_waitcnt lgkmcnt(5)
    v_mfma_f32_16x16x32_bf16 v[32:35], a[4:7], v[52:55], v[32:35]
    v_mfma_f32_16x16x32_bf16 v[36:39], a[84:87], v[52:55], v[36:39]
    ds_read_b128 v[52:55], v11 offset:27648
    s_waitcnt lgkmcnt(5)
    v_mfma_f32_16x16x32_bf16 v[32:35], a[8:11], v[56:59], v[32:35]
    v_mfma_f32_16x16x32_bf16 v[36:39], a[88:91], v[56:59], v[36:39]
    ds_read_b128 v[56:59], v11 offset:28672
    s_waitcnt lgkmcnt(5)
    v_mfma_f32_16x16x32_bf16 v[32:35], a[12:15], v[60:63], v[32:35]
    v_mfma_f32_16x16x32_bf16 v[36:39], a[92:95], v[60:63], v[36:39]
    ds_read_b128 v[60:63], v11 offset:29696
    s_waitcnt lgkmcnt(5)
    v_mfma_f32_16x16x32_bf16 v[32:35], a[16:19], v[40:43], v[32:35]
    v_mfma_f32_16x16x32_bf16 v[36:39], a[96:99], v[40:43], v[36:39]
    ds_read_b128 v[40:43], v11 offset:30720
    s_waitcnt lgkmcnt(5)
    v_mfma_f32_16x16x32_bf16 v[32:35], a[20:23], v[44:47], v[32:35]
    v_mfma_f32_16x16x32_bf16 v[36:39], a[100:103], v[44:47], v[36:39]
    ds_read_b128 v[44:47], v11 offset:31744
    s_waitcnt lgkmcnt(5)
    v_mfma_f32_16x16x32_bf16 v[32:35], a[24:27], v[48:51], v[32:35]
    v_mfma_f32_16x16x32_bf16 v[36:39], a[104:107], v[48:51], v[36:39]
    ds_read_b128 v[48:51], v11 offset:32768
    s_waitcnt lgkmcnt(5)
    v_mfma_f32_16x16x32_bf16 v[32:35], a[28:31], v[52:55], v[32:35]
    v_mfma_f32_16x16x32_bf16 v[36:39], a[108:111], v[52:55], v[36:39]
    ds_read_b128 v[52:55], v11 offset:33792
    s_waitcnt lgkmcnt(5)
    v_mfma_f32_16x16x32_bf16 v[32:35], a[32:35], v[56:59], v[32:35]
    v_mfma_f32_16x16x32_bf16 v[36:39], a[112:115], v[56:59], v[36:39]
    ds_read_b128 v[56:59], v11 offset:34816
    s_waitcnt lgkmcnt(5)
    v_mfma_f32_16x16x32_bf16 v[32:35], a[36:39], v[60:63], v[32:35]
    v_mfma_f32_16x16x32_bf16 v[36:39], a[116:119], v[60:63], v[36:39]
    ds_read_b128 v[60:63], v11 offset:35840
    s_waitcnt lgkmcnt(5)
    v_mfma_f32_16x16x32_bf16 v[32:35], a[40:43], v[40:43], v[32:35]
    v_mfma_f32_16x16x32_bf16 v[36:39], a[120:123], v[40:43], v[36:39]
    ds_read_b128 v[40:43], v11 offset:36864
    s_waitcnt lgkmcnt(5)
    v_mfma_f32_16x16x32_bf16 v[32:35], a[44:47], v[44:47], v[32:35]
    v_mfma_f32_16x16x32_bf16 v[36:39], a[124:127], v[44:47], v[36:39]
    ds_read_b128 v[44:47], v11 offset:37888
    s_waitcnt lgkmcnt(5)
    v_mfma_f32_16x16x32_bf16 v[32:35], a[48:51], v[48:51], v[32:35]
    v_mfma_f32_16x16x32_bf16 v[36:39], a[128:131], v[48:51], v[36:39]
    ds_read_b128 v[48:51], v11 offset:38912
    s_waitcnt lgkmcnt(5)
    v_mfma_f32_16x16x32_bf16 v[32:35], a[52:55], v[52:55], v[32:35]
    v_mfma_f32_16x16x32_bf16 v[36:39], a[132:135], v[52:55], v[36:39]
    ds_read_b128 v[52:55], v11 offset:39936
    s_waitcnt lgkmcnt(5)
    v_mfma_f32_16x16x32_bf16 v[32:35], a[56:59], v[56:59], v[32:35]
    v_mfma_f32_16x16x32_bf16 v[36:39], a[136:139], v[56:59], v[36:39]
    s_waitcnt lgkmcnt(4)
    v_mfma_f32_16x16x32_bf16 v[32:35], a[60:63], v[60:63], v[32:35]
    v_mfma_f32_16x16x32_bf16 v[36:39], a[140:143], v[60:63], v[36:39]
    s_waitcnt lgkmcnt(3)
    v_mfma_f32_16x16x32_bf16 v[32:35], a[64:67], v[40:43], v[32:35]
    v_mfma_f32_16x16x32_bf16 v[36:39], a[144:147], v[40:43], v[36:39]
    s_waitcnt lgkmcnt(2)
    v_mfma_f32_16x16x32_bf16 v[32:35], a[68:71], v[44:47], v[32:35]
    v_mfma_f32_16x16x32_bf16 v[36:39], a[148:151], v[44:47], v[36:39]
    s_waitcnt lgkmcnt(1)
    v_mfma_f32_16x16x32_bf16 v[32:35], a[72:75], v[48:51], v[32:35]
    v_mfma_f32_16x16x32_bf16 v[36:39], a[152:155], v[48:51], v[36:39]
    s_waitcnt lgkmcnt(0)
    v_mfma_f32_16x16x32_bf16 v[32:35], a[76:79], v[52:55], v[32:35]
    v_mfma_f32_16x16x32_bf16 v[36:39], a[156:159], v[52:55], v[36:39]
    v_pk_mul_f32 v[24:25], v[24:25], s[40:41]
    v_pk_mul_f32 v[26:27], v[26:27], s[40:41]
    v_pk_mul_f32 v[28:29], v[28:29], s[40:41]
    v_pk_mul_f32 v[30:31], v[30:31], s[40:41]
    s_nop 2
    v_pk_mul_f32 v[32:33], v[32:33], s[40:41]
    v_pk_mul_f32 v[34:35], v[34:35], s[40:41]
    v_pk_mul_f32 v[36:37], v[36:37], s[40:41]
    v_pk_mul_f32 v[38:39], v[38:39], s[40:41]
    s_lshl_b32 s27, s21, 10
    v_add_u32 v10, s27, v3
    v_cvt_pk_bf16_f32 v40, v24, v28
    v_cvt_pk_bf16_f32 v41, v25, v29
    v_cvt_pk_bf16_f32 v42, v26, v30
    v_cvt_pk_bf16_f32 v43, v27, v31
    ds_write_b128 v10, v[40:43] offset:0
    v_cvt_pk_bf16_f32 v44, v32, v36
    v_cvt_pk_bf16_f32 v45, v33, v37
    v_cvt_pk_bf16_f32 v46, v34, v38
    v_cvt_pk_bf16_f32 v47, v35, v39
    ds_write_b128 v10, v[44:47] offset:4096
    s_lshl_b32 s27, s58, 12
    v_add_u32 v10, s27, v3
    s_waitcnt vmcnt(15) lgkmcnt(0)
    s_barrier
    ds_read_b128 v[160:163], v10 offset:0
    ds_read_b128 v[164:167], v10 offset:1024
    ds_read_b128 v[168:171], v10 offset:2048
    ds_read_b128 v[172:175], v10 offset:3072
    s_waitcnt vmcnt(0)
    s_cmp_lg_u32 s21, 0
    s_cbranch_scc1 M_q_fa
    s_mov_b64 exec, 1
    v_mov_b32 v10, s22
    v_mov_b32 v11, 1
    s_cmp_lg_u32 s23, 0
    s_cbranch_scc1 M_ls_10
    buffer_store_byte v11, v10, s[8:11], s62 offen
M_ls_10_r:
    s_mov_b64 exec, -1
M_q_fa:
    v_mov_b32 v11, 0xf149f2ca
    v_cmp_gt_i32 vcc, 0, v9
    s_nop 1
    v_cndmask_b32 v120, 0, v11, vcc
    v_cmp_gt_i32 vcc, 1, v9
    s_nop 1
    v_cndmask_b32 v121, 0, v11, vcc
    v_cmp_gt_i32 vcc, 2, v9
    s_nop 1
    v_cndmask_b32 v122, 0, v11, vcc
    v_cmp_gt_i32 vcc, 3, v9
    s_nop 1
    v_cndmask_b32 v123, 0, v11, vcc
    v_cmp_gt_i32 vcc, 16, v9
    s_nop 1
    v_cndmask_b32 v124, 0, v11, vcc
    v_cmp_gt_i32 vcc, 17, v9
    s_nop 1
    v_cndmask_b32 v125, 0, v11, vcc
    v_cmp_gt_i32 vcc, 18, v9
    s_nop 1
    v_cndmask_b32 v126, 0, v11, vcc
    v_cmp_gt_i32 vcc, 19, v9
    s_nop 1
    v_cndmask_b32 v127, 0, v11, vcc
    s_waitcnt lgkmcnt(3)
    v_mfma_f32_16x16x32_bf16 v[120:123], v[72:75], v[160:163], v[120:123]
    v_mfma_f32_16x16x32_bf16 v[124:127], v[88:91], v[160:163], v[124:127]
    s_waitcnt lgkmcnt(2)
    v_mfma_f32_16x16x32_bf16 v[120:123], v[76:79], v[164:167], v[120:123]
    v_mfma_f32_16x16x32_bf16 v[124:127], v[92:95], v[164:167], v[124:127]
    s_waitcnt lgkmcnt(1)
    v_mfma_f32_16x16x32_bf16 v[120:123], v[80:83], v[168:171], v[120:123]
    v_mfma_f32_16x16x32_bf16 v[124:127], v[96:99], v[168:171], v[124:127]
    s_waitcnt lgkmcnt(0)
    v_mfma_f32_16x16x32_bf16 v[120:123], v[84:87], v[172:175], v[120:123]
    v_mfma_f32_16x16x32_bf16 v[124:127], v[100:103], v[172:175], v[124:127]
    v_readlane_b32 s65, v15, 0
    v_readlane_b32 s27, v15, 1
    s_nop 3
    s_min_u32 s65, s65, s27
    v_max3_f32 v176, v120, v121, v122
    v_max3_f32 v176, v176, v123, v124
    v_max3_f32 v176, v176, v125, v126
    v_max_f32 v176, v176, v127
    v_mov_b32 v178, v176
    s_nop 1
    v_permlane16_swap_b32 v176, v178
    v_max_f32 v176, v176, v178
    v_mov_b32 v178, v176
    s_nop 1
    v_permlane32_swap_b32 v176, v178
    v_max_f32 v176, v176, v178
    v_sub_f32 v120, v120, v176
    v_sub_f32 v121, v121, v176
    v_sub_f32 v122, v122, v176
    v_sub_f32 v123, v123, v176
    v_sub_f32 v124, v124, v176
    v_sub_f32 v125, v125, v176
    v_sub_f32 v126, v126, v176
    v_sub_f32 v127, v127, v176
    v_exp_f32 v120, v120
    v_exp_f32 v121, v121
    v_exp_f32 v122, v122
    v_exp_f32 v123, v123
    v_exp_f32 v124, v124
    v_exp_f32 v125, v125
    v_exp_f32 v126, v126
    v_exp_f32 v127, v127
    v_cvt_pk_bf16_f32 v128, v120, v121
    v_cvt_pk_bf16_f32 v129, v122, v123
    v_cvt_pk_bf16_f32 v130, v124, v125
    v_cvt_pk_bf16_f32 v131, v126, v127
    v_add_f32 v177, v120, v121
    v_add_f32 v177, v177, v122
    v_add_f32 v177, v177, v123
    v_add_f32 v177, v177, v124
    v_add_f32 v177, v177, v125
    v_add_f32 v177, v177, v126
    v_add_f32 v177, v177, v127
    v_mfma_f32_16x16x32_bf16 v[144:147], v[104:107], v[128:131], 0
    v_mfma_f32_16x16x32_bf16 v[148:151], v[108:111], v[128:131], 0
    v_mfma_f32_16x16x32_bf16 v[152:155], v[112:115], v[128:131], 0
    v_mfma_f32_16x16x32_bf16 v[156:159], v[116:119], v[128:131], 0
    v_mov_b32 v178, v177
    s_nop 1
    v_permlane16_swap_b32 v177, v178
    v_add_f32 v177, v177, v178
    v_mov_b32 v178, v177
    s_nop 1
    v_permlane32_swap_b32 v177, v178
    v_add_f32 v177, v177, v178
    s_cmp_lg_u32 s66, s44
    s_cbranch_scc1 M_q_back2
M_q_top:
    s_add_u32 s56, s44, s43
    s_lshl_b32 s57, s44, 7
    s_mul_i32 s55, s44, 40960
    s_lshl_b32 s26, s56, 18
    s_add_u32 s26, s26, s53
    s_lshl_b32 s28, s59, 11
    s_add_u32 s29, s26, s28
    s_add_u32 s29, s29, 4096
    s_lshl_b32 s27, s58, 12
    s_add_u32 s27, s27, s28
    v_add_u32 v10, s27, v3
    s_cmp_lg_u32 s21, 0
    s_cbranch_scc1 M_cf_11
    s_mov_b64 exec, 0x3
    s_mov_b32 s30, 0
    v_lshrrev_b32 v190, 2, v0
M_cf_12:
    buffer_load_dword v191, v190, s[8:11], s52 offen sc1
    s_add_u32 s30, s30, 1
    s_cmp_ge_u32 s30, 60000
    s_cbranch_scc1 M_fail
    s_waitcnt vmcnt(0)
    v_cmp_ge_u32 vcc, s57, v191
    s_cbranch_vccz M_cf_12d
    s_sleep 1
    s_branch M_cf_12
M_cf_12d:
    s_mov_b64 exec, -1
M_cf_11:
    s_barrier
    buffer_load_dwordx4 v[24:27], v0, s[8:11], s26 offen offset:0 sc1
    buffer_load_dwordx4 v[28:31], v0, s[8:11], s26 offen offset:1024 sc1
    buffer_load_dwordx4 v[32:35], v0, s[8:11], s26 offen offset:2048 sc1
    buffer_load_dwordx4 v[36:39], v0, s[8:11], s26 offen offset:3072 sc1
    buffer_load_dwordx4 v[40:43], v0, s[8:11], s29 offen offset:0 sc1
    buffer_load_dwordx4 v[44:47], v0, s[8:11], s29 offen offset:1024 sc1
    s_waitcnt vmcnt(5)
    v_mfma_f32_16x16x32_bf16 v[48:51], v[24:27], v[160:163], 0
    s_waitcnt vmcnt(4)
    v_mfma_f32_16x16x32_bf16 v[48:51], v[28:31], v[164:167], v[48:51]
    s_waitcnt vmcnt(3)
    v_mfma_f32_16x16x32_bf16 v[48:51], v[32:35], v[168:171], v[48:51]
    s_waitcnt vmcnt(2)
    v_mfma_f32_16x16x32_bf16 v[48:51], v[36:39], v[172:175], v[48:51]
    s_nop 7
    v_max3_f32 v179, v176, v48, v49
    v_max3_f32 v179, v179, v50, v51
    v_mov_b32 v178, v179
    s_nop 1
    v_permlane16_swap_b32 v179, v178
    v_max_f32 v179, v179, v178
    v_sub_f32 v180, v176, v179
    v_sub_f32 v48, v48, v179
    v_sub_f32 v49, v49, v179
    v_sub_f32 v50, v50, v179
    v_sub_f32 v51, v51, v179
    v_exp_f32 v180, v180
    v_exp_f32 v48, v48
    v_exp_f32 v49, v49
    v_exp_f32 v50, v50
    v_exp_f32 v51, v51
    v_add_f32 v179, v48, v49
    v_add_f32 v176, v50, v51
    v_add_f32 v179, v179, v176
    v_mov_b32 v178, v179
    s_nop 1
    v_permlane16_swap_b32 v179, v178
    v_add_f32 v179, v179, v178
    v_fmac_f32 v179, v180, v177
    v_rcp_f32 v179, v179
    s_nop 0
    v_mul_f32 v180, v180, v179
    v_mul_f32 v48, v48, v179
    v_mul_f32 v49, v49, v179
    v_mul_f32 v50, v50, v179
    v_mul_f32 v51, v51, v179
    v_cvt_pk_bf16_f32 v48, v48, v49
    v_cvt_pk_bf16_f32 v49, v50, v51
    v_pk_mul_f32 v[144:145], v[144:145], v[180:181] op_sel_hi:[1,0]
    v_pk_mul_f32 v[146:147], v[146:147], v[180:181] op_sel_hi:[1,0]
    v_pk_mul_f32 v[148:149], v[148:149], v[180:181] op_sel_hi:[1,0]
    v_pk_mul_f32 v[150:151], v[150:151], v[180:181] op_sel_hi:[1,0]
    v_pk_mul_f32 v[152:153], v[152:153], v[180:181] op_sel_hi:[1,0]
    v_pk_mul_f32 v[154:155], v[154:155], v[180:181] op_sel_hi:[1,0]
    v_pk_mul_f32 v[156:157], v[156:157], v[180:181] op_sel_hi:[1,0]
    v_pk_mul_f32 v[158:159], v[158:159], v[180:181] op_sel_hi:[1,0]
    s_waitcnt vmcnt(1)
    v_mfma_f32_16x16x16_bf16 v[144:147], v[40:41], v[48:49], v[144:147]
    v_mfma_f32_16x16x16_bf16 v[148:151], v[42:43], v[48:49], v[148:151]
    s_waitcnt vmcnt(0)
    v_mfma_f32_16x16x16_bf16 v[152:155], v[44:45], v[48:49], v[152:155]
    v_mfma_f32_16x16x16_bf16 v[156:159], v[46:47], v[48:49], v[156:159]
    s_nop 4
    v_cvt_pk_bf16_f32 v56, v144, v148
    v_cvt_pk_bf16_f32 v57, v145, v149
    v_cvt_pk_bf16_f32 v58, v146, v150
    v_cvt_pk_bf16_f32 v59, v147, v151
    ds_write_b128 v10, v[56:59] offset:8192
    v_cvt_pk_bf16_f32 v60, v152, v156
    v_cvt_pk_bf16_f32 v61, v153, v157
    v_cvt_pk_bf16_f32 v62, v154, v158
    v_cvt_pk_bf16_f32 v63, v155, v159
    ds_write_b128 v10, v[60:63] offset:9216
    s_waitcnt lgkmcnt(0)
    s_barrier
    ds_read_b128 v[24:27], v3 offset:8192
    ds_read_b128 v[40:43], v3 offset:12288
    ds_read_b128 v[28:31], v3 offset:9216
    ds_read_b128 v[44:47], v3 offset:13312
    ds_read_b128 v[32:35], v3 offset:10240
    ds_read_b128 v[48:51], v3 offset:14336
    ds_read_b128 v[36:39], v3 offset:11264
    ds_read_b128 v[52:55], v3 offset:15360
    s_add_u32 s28, s68, 131072
    buffer_store_dwordx4 v[104:107], v13, s[8:11], s68 offen sc1
    buffer_store_dwordx4 v[108:111], v13, s[8:11], s28 offen sc1
    s_mov_b32 exec_hi, 0
    buffer_store_dwordx2 v[20:21], v7, s[8:11], s67 offen sc1
    s_mov_b32 exec_lo, 0x000f000f
    buffer_store_dwordx2 v[22:23], v7, s[8:11], s67 offen offset:256 sc1
    s_mov_b64 exec, -1
    v_mov_b64 v[20:21], v[184:185]
    v_mov_b64 v[22:23], v[186:187]
    s_add_u32 s46, s44, 10
    s_cmp_ge_u32 s46, 64
    s_cbranch_scc1 M_q_tb
    s_sub_u32 s29, 40960, s45
    s_min_u32 s27, s46, 63
    s_mul_i32 s27, s27, 40960
    s_add_u32 s27, s27, s47
    s_add_u32 s28, s29, s42
    s_mov_b32 m0, s28
    s_nop 0
    buffer_load_dwordx4 v0, s[8:11], s27 offen offset:0 sc1 lds
    buffer_load_dwordx4 v0, s[8:11], s27 offen offset:1024 sc1 lds
    buffer_load_dwordx4 v0, s[8:11], s27 offen offset:2048 sc1 lds
    buffer_load_dwordx4 v0, s[8:11], s27 offen offset:3072 sc1 lds
    s_add_u32 s27, s27, 4096
    s_add_u32 s28, s28, 4096
    s_mov_b32 m0, s28
    s_nop 0
    buffer_load_dwordx4 v0, s[8:11], s27 offen offset:0 sc1 lds
    buffer_load_dwordx4 v0, s[8:11], s27 offen offset:1024 sc1 lds
    buffer_load_dwordx4 v0, s[8:11], s27 offen offset:2048 sc1 lds
    buffer_load_dwordx4 v0, s[8:11], s27 offen offset:3072 sc1 lds
    s_add_u32 s27, s27, 4096
    s_add_u32 s28, s28, 4096
    s_mov_b32 m0, s28
    s_nop 0
    buffer_load_dwordx4 v0, s[8:11], s27 offen offset:0 sc1 lds
    buffer_load_dwordx4 v0, s[8:11], s27 offen offset:1024 sc1 lds
M_q_nx:
    s_mov_b32 s62, s51
    s_add_u32 s27, s48, 655360
    s_waitcnt lgkmcnt(7)
    v_mfma_f32_16x16x32_bf16 v[64:67], a[160:163], v[24:27], 0
    v_mfma_f32_16x16x32_bf16 v[68:71], a[176:179], v[24:27], 0
    s_waitcnt lgkmcnt(6)
    v_mfma_f32_16x16x32_bf16 v[72:75], a[160:163], v[40:43], 0
    v_mfma_f32_16x16x32_bf16 v[76:79], a[176:179], v[40:43], 0
    s_waitcnt lgkmcnt(5)
    v_mfma_f32_16x16x32_bf16 v[64:67], a[164:167], v[28:31], v[64:67]
    v_mfma_f32_16x16x32_bf16 v[68:71], a[180:183], v[28:31], v[68:71]
    s_waitcnt lgkmcnt(4)
    v_mfma_f32_16x16x32_bf16 v[72:75], a[164:167], v[44:47], v[72:75]
    v_mfma_f32_16x16x32_bf16 v[76:79], a[180:183], v[44:47], v[76:79]
    s_waitcnt lgkmcnt(3)
    v_mfma_f32_16x16x32_bf16 v[64:67], a[168:171], v[32:35], v[64:67]
    v_mfma_f32_16x16x32_bf16 v[68:71], a[184:187], v[32:35], v[68:71]
    s_waitcnt lgkmcnt(2)
    v_mfma_f32_16x16x32_bf16 v[72:75], a[168:171], v[48:51], v[72:75]
    v_mfma_f32_16x16x32_bf16 v[76:79], a[184:187], v[48:51], v[76:79]
    s_waitcnt lgkmcnt(1)
    v_mfma_f32_16x16x32_bf16 v[64:67], a[172:175], v[36:39], v[64:67]
    v_mfma_f32_16x16x32_bf16 v[68:71], a[188:191], v[36:39], v[68:71]
    s_waitcnt lgkmcnt(0)
    v_mfma_f32_16x16x32_bf16 v[72:75], a[172:175], v[52:55], v[72:75]
    v_mfma_f32_16x16x32_bf16 v[76:79], a[188:191], v[52:55], v[76:79]
    v_mfma_f32_16x16x32_bf16 v[80:83], a[192:195], v[24:27], 0
    v_mfma_f32_16x16x32_bf16 v[84:87], a[208:211], v[24:27], 0
    v_mfma_f32_16x16x32_bf16 v[88:91], a[192:195], v[40:43], 0
    v_mfma_f32_16x16x32_bf16 v[92:95], a[208:211], v[40:43], 0
    v_mfma_f32_16x16x32_bf16 v[80:83], a[196:199], v[28:31], v[80:83]
    v_cvt_pk_bf16_f32 v64, v64, v65
    v_cvt_pk_bf16_f32 v65, v66, v67
    v_mfma_f32_16x16x32_bf16 v[84:87], a[212:215], v[28:31], v[84:87]
    v_cvt_pk_bf16_f32 v66, v68, v69
    v_cvt_pk_bf16_f32 v67, v70, v71
    v_mfma_f32_16x16x32_bf16 v[88:91], a[196:199], v[44:47], v[88:91]
    v_cvt_pk_bf16_f32 v72, v72, v73
    v_cvt_pk_bf16_f32 v73, v74, v75
    v_mfma_f32_16x16x32_bf16 v[92:95], a[212:215], v[44:47], v[92:95]
    v_cvt_pk_bf16_f32 v74, v76, v77
    v_cvt_pk_bf16_f32 v75, v78, v79
    s_cmp_lg_u32 s23, 0
    s_cbranch_scc1 M_ls_13
    buffer_store_dwordx4 v[64:67], v4, s[8:11], s48 offen offset:0
    buffer_store_dwordx4 v[72:75], v4, s[8:11], s27 offen offset:0
M_ls_13_r:
    v_mfma_f32_16x16x32_bf16 v[80:83], a[200:203], v[32:35], v[80:83]
    v_mfma_f32_16x16x32_bf16 v[84:87], a[216:219], v[32:35], v[84:87]
    v_mfma_f32_16x16x32_bf16 v[88:91], a[200:203], v[48:51], v[88:91]
    v_mfma_f32_16x16x32_bf16 v[92:95], a[216:219], v[48:51], v[92:95]
    v_mfma_f32_16x16x32_bf16 v[80:83], a[204:207], v[36:39], v[80:83]
    v_mfma_f32_16x16x32_bf16 v[84:87], a[220:223], v[36:39], v[84:87]
    v_mfma_f32_16x16x32_bf16 v[88:91], a[204:207], v[52:55], v[88:91]
    v_mfma_f32_16x16x32_bf16 v[92:95], a[220:223], v[52:55], v[92:95]
    v_mfma_f32_16x16x32_bf16 v[96:99], a[224:227], v[24:27], 0
    v_mfma_f32_16x16x32_bf16 v[100:103], a[240:243], v[24:27], 0
    v_mfma_f32_16x16x32_bf16 v[104:107], a[224:227], v[40:43], 0
    v_mfma_f32_16x16x32_bf16 v[108:111], a[240:243], v[40:43], 0
    v_mfma_f32_16x16x32_bf16 v[96:99], a[228:231], v[28:31], v[96:99]
    v_cvt_pk_bf16_f32 v80, v80, v81
    v_cvt_pk_bf16_f32 v81, v82, v83
    v_mfma_f32_16x16x32_bf16 v[100:103], a[244:247], v[28:31], v[100:103]
    v_cvt_pk_bf16_f32 v82, v84, v85
    v_cvt_pk_bf16_f32 v83, v86, v87
    v_mfma_f32_16x16x32_bf16 v[104:107], a[228:231], v[44:47], v[104:107]
    v_cvt_pk_bf16_f32 v88, v88, v89
    v_cvt_pk_bf16_f32 v89, v90, v91
    v_mfma_f32_16x16x32_bf16 v[108:111], a[244:247], v[44:47], v[108:111]
    v_cvt_pk_bf16_f32 v90, v92, v93
    v_cvt_pk_bf16_f32 v91, v94, v95
    s_cmp_lg_u32 s23, 0
    s_cbranch_scc1 M_ls_14
    buffer_store_dwordx4 v[80:83], v4, s[8:11], s48 offen offset:64
    buffer_store_dwordx4 v[88:91], v4, s[8:11], s27 offen offset:64
M_ls_14_r:
    v_mfma_f32_16x16x32_bf16 v[96:99], a[232:235], v[32:35], v[96:99]
    v_mfma_f32_16x16x32_bf16 v[100:103], a[248:251], v[32:35], v[100:103]
    v_mfma_f32_16x16x32_bf16 v[104:107], a[232:235], v[48:51], v[104:107]
    v_mfma_f32_16x16x32_bf16 v[108:111], a[248:251], v[48:51], v[108:111]
    v_mfma_f32_16x16x32_bf16 v[96:99], a[236:239], v[36:39], v[96:99]
    v_mfma_f32_16x16x32_bf16 v[100:103], a[252:255], v[36:39], v[100:103]
    v_mfma_f32_16x16x32_bf16 v[104:107], a[236:239], v[52:55], v[104:107]
    v_mfma_f32_16x16x32_bf16 v[108:111], a[252:255], v[52:55], v[108:111]
    v_mfma_f32_16x16x32_bf16 v[112:115], v[192:195], v[24:27], 0
    v_mfma_f32_16x16x32_bf16 v[116:119], v[208:211], v[24:27], 0
    v_mfma_f32_16x16x32_bf16 v[120:123], v[192:195], v[40:43], 0
    v_mfma_f32_16x16x32_bf16 v[124:127], v[208:211], v[40:43], 0
    v_mfma_f32_16x16x32_bf16 v[112:115], v[196:199], v[28:31], v[112:115]
    v_cvt_pk_bf16_f32 v96, v96, v97
    v_cvt_pk_bf16_f32 v97, v98, v99
    v_mfma_f32_16x16x32_bf16 v[116:119], v[212:215], v[28:31], v[116:119]
    v_cvt_pk_bf16_f32 v98, v100, v101
    v_cvt_pk_bf16_f32 v99, v102, v103
    v_mfma_f32_16x16x32_bf16 v[120:123], v[196:199], v[44:47], v[120:123]
    v_cvt_pk_bf16_f32 v104, v104, v105
    v_cvt_pk_bf16_f32 v105, v106, v107
    v_mfma_f32_16x16x32_bf16 v[124:127], v[212:215], v[44:47], v[124:127]
    v_cvt_pk_bf16_f32 v106, v108, v109
    v_cvt_pk_bf16_f32 v107, v110, v111
    s_cmp_lg_u32 s23, 0
    s_cbranch_scc1 M_ls_15
    buffer_store_dwordx4 v[96:99], v4, s[8:11], s48 offen offset:128
    buffer_store_dwordx4 v[104:107], v4, s[8:11], s27 offen offset:128
M_ls_15_r:
    v_mfma_f32_16x16x32_bf16 v[112:115], v[200:203], v[32:35], v[112:115]
    v_mfma_f32_16x16x32_bf16 v[116:119], v[216:219], v[32:35], v[116:119]
    v_mfma_f32_16x16x32_bf16 v[120:123], v[200:203], v[48:51], v[120:123]
    v_mfma_f32_16x16x32_bf16 v[124:127], v[216:219], v[48:51], v[124:127]
    v_mfma_f32_16x16x32_bf16 v[112:115], v[204:207], v[36:39], v[112:115]
    v_mfma_f32_16x16x32_bf16 v[116:119], v[220:223], v[36:39], v[116:119]
    v_mfma_f32_16x16x32_bf16 v[120:123], v[204:207], v[52:55], v[120:123]
    v_mfma_f32_16x16x32_bf16 v[124:127], v[220:223], v[52:55], v[124:127]
    v_mfma_f32_16x16x32_bf16 v[128:131], v[224:227], v[24:27], 0
    v_mfma_f32_16x16x32_bf16 v[132:135], v[240:243], v[24:27], 0
    v_mfma_f32_16x16x32_bf16 v[136:139], v[224:227], v[40:43], 0
    v_mfma_f32_16x16x32_bf16 v[140:143], v[240:243], v[40:43], 0
    v_mfma_f32_16x16x32_bf16 v[128:131], v[228:231], v[28:31], v[128:131]
    v_cvt_pk_bf16_f32 v112, v112, v113
    v_cvt_pk_bf16_f32 v113, v114, v115
    v_mfma_f32_16x16x32_bf16 v[132:135], v[244:247], v[28:31], v[132:135]
    v_cvt_pk_bf16_f32 v114, v116, v117
    v_cvt_pk_bf16_f32 v115, v118, v119
    v_mfma_f32_16x16x32_bf16 v[136:139], v[228:231], v[44:47], v[136:139]
    v_cvt_pk_bf16_f32 v120, v120, v121
    v_cvt_pk_bf16_f32 v121, v122, v123
    v_mfma_f32_16x16x32_bf16 v[140:143], v[244:247], v[44:47], v[140:143]
    v_cvt_pk_bf16_f32 v122, v124, v125
    v_cvt_pk_bf16_f32 v123, v126, v127
    s_cmp_lg_u32 s23, 0
    s_cbranch_scc1 M_ls_16
    buffer_store_dwordx4 v[112:115], v4, s[8:11], s48 offen offset:192
    buffer_store_dwordx4 v[120:123], v4, s[8:11], s27 offen offset:192
M_ls_16_r:
    v_mfma_f32_16x16x32_bf16 v[128:131], v[232:235], v[32:35], v[128:131]
    v_mfma_f32_16x16x32_bf16 v[132:135], v[248:251], v[32:35], v[132:135]
    v_mfma_f32_16x16x32_bf16 v[136:139], v[232:235], v[48:51], v[136:139]
    v_mfma_f32_16x16x32_bf16 v[140:143], v[248:251], v[48:51], v[140:143]
    v_mfma_f32_16x16x32_bf16 v[128:131], v[236:239], v[36:39], v[128:131]
    v_mfma_f32_16x16x32_bf16 v[132:135], v[252:255], v[36:39], v[132:135]
    v_mfma_f32_16x16x32_bf16 v[136:139], v[236:239], v[52:55], v[136:139]
    v_mfma_f32_16x16x32_bf16 v[140:143], v[252:255], v[52:55], v[140:143]
    s_nop 4
    v_cvt_pk_bf16_f32 v128, v128, v129
    v_cvt_pk_bf16_f32 v129, v130, v131
    v_cvt_pk_bf16_f32 v130, v132, v133
    v_cvt_pk_bf16_f32 v131, v134, v135
    v_cvt_pk_bf16_f32 v136, v136, v137
    v_cvt_pk_bf16_f32 v137, v138, v139
    v_cvt_pk_bf16_f32 v138, v140, v141
    v_cvt_pk_bf16_f32 v139, v142, v143
    s_cmp_lg_u32 s23, 0
    s_cbranch_scc1 M_ls_17
    buffer_store_dwordx4 v[128:131], v4, s[8:11], s48 offen offset:256
    buffer_store_dwordx4 v[136:139], v4, s[8:11], s27 offen offset:256
M_ls_17_r:
    s_add_u32 s66, s44, 5
    s_cmp_lt_u32 s66, 64
    s_cbranch_scc1 M_q_front
    s_waitcnt vmcnt(0)
    s_barrier
    s_cmp_lg_u32 s21, 0
    s_cbranch_scc1 M_q_na
    s_mov_b64 exec, 1
    v_mov_b32 v10, s22
    v_mov_b32 v11, 1
    s_cmp_lg_u32 s23, 0
    s_cbranch_scc1 M_ls_18
    buffer_store_byte v11, v10, s[8:11], s62 offen
M_ls_18_r:
    s_mov_b64 exec, -1
M_q_na:
M_q_back2:
    s_sub_u32 s27, s44, 56
    s_cmp_ge_u32 s27, 5
    s_cbranch_scc1 M_q_nf1
    s_cmp_lg_u32 s21, 3
    s_cbranch_scc1 M_q_nf1
    s_lshl_b32 s27, s20, 12
    s_lshl_b32 s28, s22, 7
    s_add_u32 s27, s27, s28
    s_add_u32 s27, s27, 167915520
    s_lshl_b32 s28, s101, 1
    s_add_u32 s28, s28, 1
    v_mov_b32 v11, s28
    s_mov_b64 exec, 1
    buffer_store_dword v11, v0, s[8:11], s27 offen sc1
    s_mov_b64 exec, -1
M_q_nf1:
    s_cmp_lg_u32 s21, 0
    s_cbranch_scc1 M_ar_19
    s_mov_b64 exec, 0xff
    s_mov_b32 s30, 0
    v_lshrrev_b32 v190, 2, v0
M_ar_20:
    buffer_load_dword v191, v190, s[8:11], s62 offen sc1
    s_add_u32 s30, s30, 1
    s_cmp_ge_u32 s30, 60000
    s_cbranch_scc1 M_fail
    s_waitcnt vmcnt(0)
    v_cmp_ne_u32 vcc, 0x01010101, v191
    s_cbranch_vccz M_ar_20d
    s_branch M_ar_20
M_ar_20d:
    s_mov_b64 exec, -1
M_ar_19:
    s_barrier
    buffer_load_dwordx4 v[24:27], v5, s[8:11], s48 offen sc1
    buffer_load_dwordx4 v[56:59], v6, s[8:11], s48 offen offset:256 sc1
    s_add_u32 s27, s48, 5120
    buffer_load_dwordx4 v[28:31], v5, s[8:11], s27 offen sc1
    s_add_u32 s27, s48, 10240
    buffer_load_dwordx4 v[32:35], v5, s[8:11], s27 offen sc1
    s_add_u32 s27, s48, 15360
    buffer_load_dwordx4 v[36:39], v5, s[8:11], s27 offen sc1
    s_add_u32 s27, s48, 20480
    buffer_load_dwordx4 v[40:43], v5, s[8:11], s27 offen sc1
    buffer_load_dwordx4 v[60:63], v6, s[8:11], s27 offen offset:256 sc1
    s_add_u32 s27, s48, 25600
    buffer_load_dwordx4 v[44:47], v5, s[8:11], s27 offen sc1
    s_add_u32 s27, s48, 30720
    buffer_load_dwordx4 v[48:51], v5, s[8:11], s27 offen sc1
    s_add_u32 s27, s48, 35840
    buffer_load_dwordx4 v[52:55], v5, s[8:11], s27 offen sc1
    v_lshlrev_b32 v72, 16, v20
    v_and_b32 v73, 0xffff0000, v20
    v_lshlrev_b32 v74, 16, v21
    v_and_b32 v75, 0xffff0000, v21
    v_lshlrev_b32 v76, 16, v22
    v_and_b32 v77, 0xffff0000, v22
    v_lshlrev_b32 v78, 16, v23
    v_and_b32 v79, 0xffff0000, v23
    s_add_u32 s67, s55, s54
    s_waitcnt vmcnt(9)
    v_mfma_f32_16x16x32_bf16 v[64:67], v[16:19], v[24:27], 0
    s_waitcnt vmcnt(8)
    v_mfma_f32_16x16x32_bf16 v[68:71], v[16:19], v[56:59], 0
    s_waitcnt vmcnt(7)
    v_mfma_f32_16x16x32_bf16 v[64:67], v[16:19], v[28:31], v[64:67]
    s_waitcnt vmcnt(6)
    v_mfma_f32_16x16x32_bf16 v[64:67], v[16:19], v[32:35], v[64:67]
    s_waitcnt vmcnt(5)
    v_mfma_f32_16x16x32_bf16 v[64:67], v[16:19], v[36:39], v[64:67]
    s_waitcnt vmcnt(4)
    v_mfma_f32_16x16x32_bf16 v[64:67], v[16:19], v[40:43], v[64:67]
    s_waitcnt vmcnt(3)
    v_mfma_f32_16x16x32_bf16 v[68:71], v[16:19], v[60:63], v[68:71]
    s_waitcnt vmcnt(2)
    v_mfma_f32_16x16x32_bf16 v[64:67], v[16:19], v[44:47], v[64:67]
    s_waitcnt vmcnt(1)
    v_mfma_f32_16x16x32_bf16 v[64:67], v[16:19], v[48:51], v[64:67]
    s_waitcnt vmcnt(0)
    v_mfma_f32_16x16x32_bf16 v[64:67], v[16:19], v[52:55], v[64:67]
    s_nop 1
    v_add_f32_dpp v68, v68, v68 row_ror:8 row_mask:0xf bank_mask:0xf
    v_add_f32_dpp v69, v69, v69 row_ror:8 row_mask:0xf bank_mask:0xf
    v_add_f32_dpp v70, v70, v70 row_ror:8 row_mask:0xf bank_mask:0xf
    v_add_f32_dpp v71, v71, v71 row_ror:8 row_mask:0xf bank_mask:0xf
    v_add_f32_dpp v68, v68, v68 row_ror:4 row_mask:0xf bank_mask:0xf
    v_add_f32_dpp v69, v69, v69 row_ror:4 row_mask:0xf bank_mask:0xf
    v_add_f32_dpp v70, v70, v70 row_ror:4 row_mask:0xf bank_mask:0xf
    v_add_f32_dpp v71, v71, v71 row_ror:4 row_mask:0xf bank_mask:0xf
    v_pk_add_f32 v[72:73], v[72:73], v[64:65]
    v_pk_add_f32 v[74:75], v[74:75], v[66:67]
    v_pk_add_f32 v[76:77], v[76:77], v[68:69]
    v_pk_add_f32 v[78:79], v[78:79], v[70:71]
    v_cvt_pk_bf16_f32 v20, v72, v73
    v_cvt_pk_bf16_f32 v21, v74, v75
    v_cvt_pk_bf16_f32 v22, v76, v77
    v_cvt_pk_bf16_f32 v23, v78, v79
    v_lshlrev_b32 v72, 16, v20
    v_and_b32 v73, 0xffff0000, v20
    v_lshlrev_b32 v74, 16, v21
    v_and_b32 v75, 0xffff0000, v21
    v_lshlrev_b32 v76, 16, v22
    v_and_b32 v77, 0xffff0000, v22
    v_lshlrev_b32 v78, 16, v23
    v_and_b32 v79, 0xffff0000, v23
    v_pk_add_f32 v[92:93], v[72:73], v[74:75]
    v_pk_add_f32 v[94:95], v[76:77], v[78:79]
    v_add_f32 v92, v92, v93
    v_add_f32 v94, v94, v95
    v_mul_f32 v94, 0x3e800000, v94
    v_add_f32 v80, v92, v94
    s_nop 1
    v_add_f32_dpp v80, v80, v80 row_ror:8 row_mask:0xf bank_mask:0xf
    s_nop 1
    v_add_f32_dpp v80, v80, v80 row_ror:4 row_mask:0xf bank_mask:0xf
    s_nop 1
    v_add_f32_dpp v80, v80, v80 row_ror:2 row_mask:0xf bank_mask:0xf
    s_nop 1
    v_add_f32_dpp v80, v80, v80 row_ror:1 row_mask:0xf bank_mask:0xf
    v_mov_b32 v178, v80
    s_nop 1
    v_permlane16_swap_b32 v80, v178
    v_add_f32 v80, v80, v178
    v_mul_f32 v80, 0x3bcccccd, v80
    v_pk_add_f32 v[84:85], v[72:73], v[80:81] op_sel_hi:[1,0] neg_lo:[0,1] neg_hi:[0,1]
    v_pk_add_f32 v[86:87], v[74:75], v[80:81] op_sel_hi:[1,0] neg_lo:[0,1] neg_hi:[0,1]
    v_pk_add_f32 v[88:89], v[76:77], v[80:81] op_sel_hi:[1,0] neg_lo:[0,1] neg_hi:[0,1]
    v_pk_add_f32 v[90:91], v[78:79], v[80:81] op_sel_hi:[1,0] neg_lo:[0,1] neg_hi:[0,1]
    v_pk_mul_f32 v[84:85], v[84:85], v[84:85]
    v_pk_mul_f32 v[86:87], v[86:87], v[86:87]
    v_pk_mul_f32 v[88:89], v[88:89], v[88:89]
    v_pk_mul_f32 v[90:91], v[90:91], v[90:91]
    v_pk_add_f32 v[92:93], v[84:85], v[86:87]
    v_pk_add_f32 v[94:95], v[88:89], v[90:91]
    v_add_f32 v92, v92, v93
    v_add_f32 v94, v94, v95
    v_mul_f32 v94, 0x3e800000, v94
    v_add_f32 v81, v92, v94
    s_nop 1
    v_add_f32_dpp v81, v81, v81 row_ror:8 row_mask:0xf bank_mask:0xf
    s_nop 1
    v_add_f32_dpp v81, v81, v81 row_ror:4 row_mask:0xf bank_mask:0xf
    s_nop 1
    v_add_f32_dpp v81, v81, v81 row_ror:2 row_mask:0xf bank_mask:0xf
    s_nop 1
    v_add_f32_dpp v81, v81, v81 row_ror:1 row_mask:0xf bank_mask:0xf
    v_mov_b32 v178, v81
    s_nop 1
    v_permlane16_swap_b32 v81, v178
    v_add_f32 v81, v81, v178
    s_lshl_b32 s27, s21, 3
    s_add_u32 s27, s27, 98304
    v_mov_b32 v10, s27
    v_mov_b32 v11, 98304
    ds_write_b64 v10, v[80:81]
    s_waitcnt lgkmcnt(0)
    s_barrier
    ds_read_b128 v[84:87], v11 offset:0
    ds_read_b128 v[88:91], v11 offset:16
    s_waitcnt lgkmcnt(1)
    v_pk_add_f32 v[80:81], v[84:85], v[86:87]
    s_waitcnt lgkmcnt(0)
    v_pk_add_f32 v[92:93], v[88:89], v[90:91]
    v_pk_add_f32 v[80:81], v[80:81], v[92:93]
    v_mul_f32 v80, 0x3e800000, v80
    v_sub_f32 v84, v84, v80
    v_sub_f32 v86, v86, v80
    v_sub_f32 v88, v88, v80
    v_sub_f32 v90, v90, v80
    v_mul_f32 v85, 0x43200000, v84
    v_mul_f32 v87, 0x43200000, v86
    v_mul_f32 v89, 0x43200000, v88
    v_mul_f32 v91, 0x43200000, v90
    v_fmac_f32 v81, v84, v85
    v_fmac_f32 v81, v86, v87
    v_fmac_f32 v81, v88, v89
    v_fmac_f32 v81, v90, v91
    v_mov_b32 v82, 0x3727c5ac
    v_fmac_f32 v82, 0x3acccccd, v81
    v_rsq_f32 v82, v82
    v_pk_add_f32 v[72:73], v[72:73], v[80:81] op_sel_hi:[1,0] neg_lo:[0,1] neg_hi:[0,1]
    v_pk_add_f32 v[74:75], v[74:75], v[80:81] op_sel_hi:[1,0] neg_lo:[0,1] neg_hi:[0,1]
    v_pk_add_f32 v[76:77], v[76:77], v[80:81] op_sel_hi:[1,0] neg_lo:[0,1] neg_hi:[0,1]
    v_pk_add_f32 v[78:79], v[78:79], v[80:81] op_sel_hi:[1,0] neg_lo:[0,1] neg_hi:[0,1]
    v_pk_mul_f32 v[72:73], v[72:73], v[82:83] op_sel_hi:[1,0]
    v_pk_mul_f32 v[74:75], v[74:75], v[82:83] op_sel_hi:[1,0]
    v_pk_mul_f32 v[76:77], v[76:77], v[82:83] op_sel_hi:[1,0]
    v_pk_mul_f32 v[78:79], v[78:79], v[82:83] op_sel_hi:[1,0]
    v_cvt_pk_f16_f32 v72, v72, v73
    v_cvt_pk_f16_f32 v73, v74, v75
    v_cvt_pk_f16_f32 v74, v76, v77
    v_cvt_pk_f16_f32 v75, v78, v79
    s_cmp_lg_u32 s23, 0
    s_cbranch_scc1 M_ls_21
    s_mov_b32 exec_hi, 0
    buffer_store_dwordx2 v[72:73], v12, s[8:11], s63 offen
    s_mov_b32 exec_lo, 0x000f000f
    buffer_store_dwordx2 v[74:75], v12, s[8:11], s64 offen
    s_mov_b64 exec, -1
M_ls_21_r:
    s_add_u32 s62, s51, 20480
    s_waitcnt vmcnt(0)
    s_barrier
    s_cmp_lg_u32 s21, 0
    s_cbranch_scc1 M_q_nb
    s_mov_b64 exec, 1
    v_mov_b32 v10, s22
    v_mov_b32 v11, 1
    s_cmp_lg_u32 s23, 0
    s_cbranch_scc1 M_ls_22
    buffer_store_byte v11, v10, s[8:11], s62 offen
M_ls_22_r:
    s_mov_b64 exec, -1
M_q_nb:
    s_cmp_ge_u32 s22, 20
    s_cbranch_scc1 M_q_tab
    s_cmp_lg_u32 s21, 0
    s_cbranch_scc1 M_ar_23
    s_mov_b64 exec, 0xff
    s_mov_b32 s30, 0
    v_lshrrev_b32 v190, 2, v0
M_ar_24:
    buffer_load_dword v191, v190, s[8:11], s62 offen sc1
    s_add_u32 s30, s30, 1
    s_cmp_ge_u32 s30, 60000
    s_cbranch_scc1 M_fail
    s_waitcnt vmcnt(0)
    v_cmp_ne_u32 vcc, 0x01010101, v191
    s_cbranch_vccz M_ar_24d
    s_branch M_ar_24
M_ar_24d:
    s_mov_b64 exec, -1
M_ar_23:
    s_barrier
    s_cmp_ge_u32 s21, 2
    s_cbranch_scc1 M_q_nd
    s_mul_i32 s27, s21, 20480
    s_add_u32 s27, s27, s63
    buffer_load_dwordx4 v[24:27], v0, s[8:11], s27 offen offset:0 sc1
    buffer_load_dwordx4 v[28:31], v0, s[8:11], s27 offen offset:1024 sc1
    buffer_load_dwordx4 v[32:35], v0, s[8:11], s27 offen offset:2048 sc1
    buffer_load_dwordx4 v[36:39], v0, s[8:11], s27 offen offset:3072 sc1
    s_add_u32 s27, s27, 4096
    buffer_load_dwordx4 v[40:43], v0, s[8:11], s27 offen offset:0 sc1
    buffer_load_dwordx4 v[44:47], v0, s[8:11], s27 offen offset:1024 sc1
    buffer_load_dwordx4 v[48:51], v0, s[8:11], s27 offen offset:2048 sc1
    buffer_load_dwordx4 v[52:55], v0, s[8:11], s27 offen offset:3072 sc1
    s_add_u32 s27, s27, 4096
    buffer_load_dwordx4 v[56:59], v0, s[8:11], s27 offen offset:0 sc1
    buffer_load_dwordx4 v[60:63], v0, s[8:11], s27 offen offset:1024 sc1
    buffer_load_dwordx4 v[64:67], v0, s[8:11], s27 offen offset:2048 sc1
    buffer_load_dwordx4 v[68:71], v0, s[8:11], s27 offen offset:3072 sc1
    s_add_u32 s27, s27, 4096
    buffer_load_dwordx4 v[72:75], v0, s[8:11], s27 offen offset:0 sc1
    buffer_load_dwordx4 v[76:79], v0, s[8:11], s27 offen offset:1024 sc1
    buffer_load_dwordx4 v[80:83], v0, s[8:11], s27 offen offset:2048 sc1
    buffer_load_dwordx4 v[84:87], v0, s[8:11], s27 offen offset:3072 sc1
    s_add_u32 s27, s27, 4096
    buffer_load_dwordx4 v[88:91], v0, s[8:11], s27 offen offset:0 sc1
    buffer_load_dwordx4 v[92:95], v0, s[8:11], s27 offen offset:1024 sc1
    buffer_load_dwordx4 v[96:99], v0, s[8:11], s27 offen offset:2048 sc1
    buffer_load_dwordx4 v[100:103], v0, s[8:11], s27 offen offset:3072 sc1
    s_add_u32 s27, s27, 4096
    ds_read_b128 v[112:115], v14 offset:0
    ds_read_b128 v[116:119], v14 offset:20480
    ds_read_b128 v[120:123], v14 offset:1024
    ds_read_b128 v[124:127], v14 offset:21504
    ds_read_b128 v[128:131], v14 offset:2048
    ds_read_b128 v[132:135], v14 offset:22528
    ds_read_b128 v[136:139], v14 offset:3072
    s_lshl_b32 s27, s44, 7
    s_mul_i32 s68, s101, 6291456
    s_add_u32 s68, s68, s27
    s_add_u32 s68, s68, 176160768
    s_waitcnt vmcnt(19) lgkmcnt(6)
    v_mfma_f32_16x16x32_f16 v[104:107], v[24:27], v[112:115], 0
    ds_read_b128 v[140:143], v14 offset:23552
    s_waitcnt lgkmcnt(6)
    v_mfma_f32_16x16x32_f16 v[108:111], v[24:27], v[116:119], 0
    ds_read_b128 v[112:115], v14 offset:4096
    s_waitcnt vmcnt(18) lgkmcnt(6)
    v_mfma_f32_16x16x32_f16 v[104:107], v[28:31], v[120:123], v[104:107]
    ds_read_b128 v[116:119], v14 offset:24576
    s_waitcnt lgkmcnt(6)
    v_mfma_f32_16x16x32_f16 v[108:111], v[28:31], v[124:127], v[108:111]
    ds_read_b128 v[120:123], v14 offset:5120
    s_waitcnt vmcnt(17) lgkmcnt(6)
    v_mfma_f32_16x16x32_f16 v[104:107], v[32:35], v[128:131], v[104:107]
    ds_read_b128 v[124:127], v14 offset:25600
    s_waitcnt lgkmcnt(6)
    v_mfma_f32_16x16x32_f16 v[108:111], v[32:35], v[132:135], v[108:111]
    ds_read_b128 v[128:131], v14 offset:6144
    s_waitcnt vmcnt(16) lgkmcnt(6)
    v_mfma_f32_16x16x32_f16 v[104:107], v[36:39], v[136:139], v[104:107]
    ds_read_b128 v[132:135], v14 offset:26624
    s_waitcnt lgkmcnt(6)
    v_mfma_f32_16x16x32_f16 v[108:111], v[36:39], v[140:143], v[108:111]
    ds_read_b128 v[136:139], v14 offset:7168
    s_waitcnt vmcnt(15) lgkmcnt(6)
    v_mfma_f32_16x16x32_f16 v[104:107], v[40:43], v[112:115], v[104:107]
    ds_read_b128 v[140:143], v14 offset:27648
    s_waitcnt lgkmcnt(6)
    v_mfma_f32_16x16x32_f16 v[108:111], v[40:43], v[116:119], v[108:111]
    ds_read_b128 v[112:115], v14 offset:8192
    s_waitcnt vmcnt(14) lgkmcnt(6)
    v_mfma_f32_16x16x32_f16 v[104:107], v[44:47], v[120:123], v[104:107]
    ds_read_b128 v[116:119], v14 offset:28672
    s_waitcnt lgkmcnt(6)
    v_mfma_f32_16x16x32_f16 v[108:111], v[44:47], v[124:127], v[108:111]
    ds_read_b128 v[120:123], v14 offset:9216
    s_waitcnt vmcnt(13) lgkmcnt(6)
    v_mfma_f32_16x16x32_f16 v[104:107], v[48:51], v[128:131], v[104:107]
    ds_read_b128 v[124:127], v14 offset:29696
    s_waitcnt lgkmcnt(6)
    v_mfma_f32_16x16x32_f16 v[108:111], v[48:51], v[132:135], v[108:111]
    ds_read_b128 v[128:131], v14 offset:10240
    s_waitcnt vmcnt(12) lgkmcnt(6)
    v_mfma_f32_16x16x32_f16 v[104:107], v[52:55], v[136:139], v[104:107]
    ds_read_b128 v[132:135], v14 offset:30720
    s_waitcnt lgkmcnt(6)
    v_mfma_f32_16x16x32_f16 v[108:111], v[52:55], v[140:143], v[108:111]
    ds_read_b128 v[136:139], v14 offset:11264
    s_waitcnt vmcnt(11) lgkmcnt(6)
    v_mfma_f32_16x16x32_f16 v[104:107], v[56:59], v[112:115], v[104:107]
    ds_read_b128 v[140:143], v14 offset:31744
    s_waitcnt lgkmcnt(6)
    v_mfma_f32_16x16x32_f16 v[108:111], v[56:59], v[116:119], v[108:111]
    ds_read_b128 v[112:115], v14 offset:12288
    s_waitcnt vmcnt(10) lgkmcnt(6)
    v_mfma_f32_16x16x32_f16 v[104:107], v[60:63], v[120:123], v[104:107]
    ds_read_b128 v[116:119], v14 offset:32768
    s_waitcnt lgkmcnt(6)
    v_mfma_f32_16x16x32_f16 v[108:111], v[60:63], v[124:127], v[108:111]
    ds_read_b128 v[120:123], v14 offset:13312
    s_waitcnt vmcnt(9) lgkmcnt(6)
    v_mfma_f32_16x16x32_f16 v[104:107], v[64:67], v[128:131], v[104:107]
    ds_read_b128 v[124:127], v14 offset:33792
    s_waitcnt lgkmcnt(6)
    v_mfma_f32_16x16x32_f16 v[108:111], v[64:67], v[132:135], v[108:111]
    ds_read_b128 v[128:131], v14 offset:14336
    s_waitcnt vmcnt(8) lgkmcnt(6)
    v_mfma_f32_16x16x32_f16 v[104:107], v[68:71], v[136:139], v[104:107]
    ds_read_b128 v[132:135], v14 offset:34816
    s_waitcnt lgkmcnt(6)
    v_mfma_f32_16x16x32_f16 v[108:111], v[68:71], v[140:143], v[108:111]
    ds_read_b128 v[136:139], v14 offset:15360
    s_waitcnt vmcnt(7) lgkmcnt(6)
    v_mfma_f32_16x16x32_f16 v[104:107], v[72:75], v[112:115], v[104:107]
    ds_read_b128 v[140:143], v14 offset:35840
    s_waitcnt lgkmcnt(6)
    v_mfma_f32_16x16x32_f16 v[108:111], v[72:75], v[116:119], v[108:111]
    ds_read_b128 v[112:115], v14 offset:16384
    s_waitcnt vmcnt(6) lgkmcnt(6)
    v_mfma_f32_16x16x32_f16 v[104:107], v[76:79], v[120:123], v[104:107]
    ds_read_b128 v[116:119], v14 offset:36864
    s_waitcnt lgkmcnt(6)
    v_mfma_f32_16x16x32_f16 v[108:111], v[76:79], v[124:127], v[108:111]
    ds_read_b128 v[120:123], v14 offset:17408
    s_waitcnt vmcnt(5) lgkmcnt(6)
    v_mfma_f32_16x16x32_f16 v[104:107], v[80:83], v[128:131], v[104:107]
    ds_read_b128 v[124:127], v14 offset:37888
    s_waitcnt lgkmcnt(6)
    v_mfma_f32_16x16x32_f16 v[108:111], v[80:83], v[132:135], v[108:111]
    ds_read_b128 v[128:131], v14 offset:18432
    s_waitcnt vmcnt(4) lgkmcnt(6)
    v_mfma_f32_16x16x32_f16 v[104:107], v[84:87], v[136:139], v[104:107]
    ds_read_b128 v[132:135], v14 offset:38912
    s_waitcnt lgkmcnt(6)
    v_mfma_f32_16x16x32_f16 v[108:111], v[84:87], v[140:143], v[108:111]
    ds_read_b128 v[136:139], v14 offset:19456
    s_waitcnt vmcnt(3) lgkmcnt(6)
    v_mfma_f32_16x16x32_f16 v[104:107], v[88:91], v[112:115], v[104:107]
    ds_read_b128 v[140:143], v14 offset:39936
    s_waitcnt lgkmcnt(6)
    v_mfma_f32_16x16x32_f16 v[108:111], v[88:91], v[116:119], v[108:111]
    s_waitcnt vmcnt(2) lgkmcnt(5)
    v_mfma_f32_16x16x32_f16 v[104:107], v[92:95], v[120:123], v[104:107]
    s_waitcnt lgkmcnt(4)
    v_mfma_f32_16x16x32_f16 v[108:111], v[92:95], v[124:127], v[108:111]
    s_waitcnt vmcnt(1) lgkmcnt(3)
    v_mfma_f32_16x16x32_f16 v[104:107], v[96:99], v[128:131], v[104:107]
    s_waitcnt lgkmcnt(2)
    v_mfma_f32_16x16x32_f16 v[108:111], v[96:99], v[132:135], v[108:111]
    s_waitcnt vmcnt(0) lgkmcnt(1)
    v_mfma_f32_16x16x32_f16 v[104:107], v[100:103], v[136:139], v[104:107]
    s_waitcnt lgkmcnt(0)
    v_mfma_f32_16x16x32_f16 v[108:111], v[100:103], v[140:143], v[108:111]
    s_nop 7
M_q_nd:
    s_sub_u32 s27, s44, 54
    s_cmp_ge_u32 s27, 5
    s_cbranch_scc1 M_q_nt
    s_sub_u32 s27, 40960, s45
    s_mul_i32 s29, s21, 10240
    s_add_u32 s29, s29, s27
    s_mul_i32 s28, s88, 81920
    s_add_u32 s28, s28, s29
    s_add_u32 s28, s28, 147849216
    s_mov_b32 m0, s29
    s_nop 0
    buffer_load_dwordx4 v0, s[8:11], s28 offen offset:0 sc1 lds
    buffer_load_dwordx4 v0, s[8:11], s28 offen offset:1024 sc1 lds
    buffer_load_dwordx4 v0, s[8:11], s28 offen offset:2048 sc1 lds
    buffer_load_dwordx4 v0, s[8:11], s28 offen offset:3072 sc1 lds
    s_add_u32 s29, s29, 4096
    s_add_u32 s28, s28, 4096
    s_mov_b32 m0, s29
    s_nop 0
    buffer_load_dwordx4 v0, s[8:11], s28 offen offset:0 sc1 lds
    buffer_load_dwordx4 v0, s[8:11], s28 offen offset:1024 sc1 lds
    buffer_load_dwordx4 v0, s[8:11], s28 offen offset:2048 sc1 lds
    buffer_load_dwordx4 v0, s[8:11], s28 offen offset:3072 sc1 lds
    s_add_u32 s29, s29, 4096
    s_add_u32 s28, s28, 4096
    s_mov_b32 m0, s29
    s_nop 0
    buffer_load_dwordx4 v0, s[8:11], s28 offen offset:0 sc1 lds
    buffer_load_dwordx4 v0, s[8:11], s28 offen offset:1024 sc1 lds
M_q_nt:
    s_add_u32 s48, s48, s49
    s_sub_u32 s49, 0, s49
    s_add_u32 s51, s51, 128
    s_add_u32 s44, s44, 5
    s_cmp_lt_u32 s44, 64
    s_cbranch_scc1 M_q_top
    s_cmp_ge_u32 s21, 2
    s_cbranch_scc1 M_q_e1
    s_add_u32 s28, s68, 131072
    buffer_store_dwordx4 v[104:107], v13, s[8:11], s68 offen sc1
    buffer_store_dwordx4 v[108:111], v13, s[8:11], s28 offen sc1
    s_mov_b32 exec_hi, 0
    buffer_store_dwordx2 v[20:21], v7, s[8:11], s67 offen sc1
    s_mov_b32 exec_lo, 0x000f000f
    buffer_store_dwordx2 v[22:23], v7, s[8:11], s67 offen offset:256 sc1
    s_mov_b64 exec, -1
    s_waitcnt vmcnt(2)
    s_barrier
    s_cmp_lg_u32 s21, 0
    s_cbranch_scc1 M_bphase
    s_lshl_b32 s27, s20, 12
    s_lshl_b32 s28, s22, 7
    s_add_u32 s27, s27, s28
    s_add_u32 s27, s27, 167915520
    s_lshl_b32 s28, s101, 1
    s_add_u32 s28, s28, 2
    v_mov_b32 v11, s28
    s_mov_b64 exec, 1
    buffer_store_dword v11, v0, s[8:11], s27 offen sc1
    s_mov_b64 exec, -1
    s_branch M_bphase
M_q_tb:
    s_cmp_ge_u32 s44, 59
    s_cbranch_scc1 M_q_nx
    s_cmp_lg_u32 s101, 0
    s_cbranch_scc1 M_q_tp2
    v_lshlrev_b32 v190, 3, v0
    s_mov_b32 exec_hi, 0x0fffffff
    s_mov_b32 s28, 167948288
    s_mov_b32 s30, 0
M_q_tpl:
    buffer_load_dword v191, v190, s[8:11], s28 offen sc1
    s_add_u32 s30, s30, 1
    s_cmp_ge_u32 s30, 240000
    s_cbranch_scc1 M_fail
    s_waitcnt vmcnt(0)
    v_cmp_ne_u32 vcc, 0x01010101, v191
    s_cbranch_vccz M_q_tpd
    s_sleep 8
    s_branch M_q_tpl
M_q_tpd:
    s_mov_b64 exec, -1
M_q_tp2:
    s_sub_u32 s27, 40960, s45
    s_mul_i32 s29, s21, 10240
    s_add_u32 s29, s29, s27
    s_mul_i32 s28, s88, 81920
    s_add_u32 s28, s28, s29
    s_add_u32 s28, s28, 147849216
    s_mov_b32 m0, s29
    s_nop 0
    buffer_load_dwordx4 v0, s[8:11], s28 offen offset:0 sc1 lds
    buffer_load_dwordx4 v0, s[8:11], s28 offen offset:1024 sc1 lds
    buffer_load_dwordx4 v0, s[8:11], s28 offen offset:2048 sc1 lds
    buffer_load_dwordx4 v0, s[8:11], s28 offen offset:3072 sc1 lds
    s_add_u32 s29, s29, 4096
    s_add_u32 s28, s28, 4096
    s_mov_b32 m0, s29
    s_nop 0
    buffer_load_dwordx4 v0, s[8:11], s28 offen offset:0 sc1 lds
    buffer_load_dwordx4 v0, s[8:11], s28 offen offset:1024 sc1 lds
    buffer_load_dwordx4 v0, s[8:11], s28 offen offset:2048 sc1 lds
    buffer_load_dwordx4 v0, s[8:11], s28 offen offset:3072 sc1 lds
    s_add_u32 s29, s29, 4096
    s_add_u32 s28, s28, 4096
    s_mov_b32 m0, s29
    s_nop 0
    buffer_load_dwordx4 v0, s[8:11], s28 offen offset:0 sc1 lds
    buffer_load_dwordx4 v0, s[8:11], s28 offen offset:1024 sc1 lds
    s_branch M_q_nx
M_q_tab:
    s_cmp_ge_u32 s94, 2400
    s_cbranch_scc1 M_q_nd
    v_mov_b32 v32, v0
    v_mov_b32 v33, v1
    v_mov_b32 v34, v2
    v_mov_b32 v35, v3
    v_mov_b32 v36, v4
    v_mov_b32 v37, v5
    v_mov_b32 v38, v6
    v_mov_b32 v39, v7
    v_mov_b32 v40, v8
    v_mov_b32 v41, v9
    v_mov_b32 v42, v10
    v_mov_b32 v43, v11
    v_mov_b32 v44, v12
    v_mov_b32 v45, v13
    v_mov_b32 v46, v14
    v_mov_b32 v47, v15
    v_mov_b32 v48, v16
    v_mov_b32 v49, v17
    v_mov_b32 v50, v18
    v_mov_b32 v51, v19
    v_mov_b32 v52, v20
    v_mov_b32 v53, v21
    v_mov_b32 v54, v22
    v_mov_b32 v55, v23
    v_lshrrev_b32 v1, 4, v0
    v_lshrrev_b32 v3, 8, v0
    v_and_b32 v4, 15, v1
    v_mov_b32 v5, v0
    s_cmp_ge_u32 s94, 800
    s_cbranch_scc1 M_q_wt
    s_mov_b32 s36, s94
    s_mul_hi_u32 s37, s36, 0xccccccd
    s_mul_i32 s38, s37, 20
    s_sub_u32 s38, s36, s38
    s_lshl_b32 s37, s37, 4
    s_lshl_b32 s38, s38, 5
    v_lshlrev_b32 v7, 3, v3
    v_add_u32 v7, s38, v7
    s_mov_b32 s39, 0x666667
    s_movk_i32 s40, 640
    s_and_b32 s41, s37, 16
    s_sub_u32 s37, s37, s41
    s_lshr_b32 s41, s41, 2
    s_add_u32 s37, s37, s41
    v_and_b32 v6, 12, v4
    v_add_u32 v6, v6, v4
    v_add_u32 v6, s37, v6
    v_lshrrev_b32 v8, 1, v7
    v_cmp_eq_u32 vcc, 0, v7
    v_add_u32 v11, 0, v8
    v_mov_b32 v13, 0x00000000
    v_mov_b32 v14, 0x35cccccd
    v_mov_b32 v15, 0x354ccccd
    v_cndmask_b32 v14, v14, v15, vcc
    v_mul_u32_u24 v11, v11, v6
    v_mul_hi_u32 v12, v11, s39
    v_mul_lo_u32 v12, v12, s40
    v_sub_u32 v11, v11, v12
    v_cvt_f32_u32 v11, v11
    v_fmac_f32 v13, 0x3acccccd, v11
    v_cos_f32 v13, v13
    s_nop 0
    v_mul_f32 v16, v13, v14
    v_add_u32 v11, 0, v8
    v_mov_b32 v13, 0x3e800000
    v_mov_b32 v14, 0x35cccccd
    v_mov_b32 v15, 0x354ccccd
    v_cndmask_b32 v14, v14, v15, vcc
    v_mov_b32 v15, 320
    v_cndmask_b32 v11, v11, v15, vcc
    v_mov_b32 v15, 0
    v_cndmask_b32 v13, v13, v15, vcc
    v_mul_u32_u24 v11, v11, v6
    v_mul_hi_u32 v12, v11, s39
    v_mul_lo_u32 v12, v12, s40
    v_sub_u32 v11, v11, v12
    v_cvt_f32_u32 v11, v11
    v_fmac_f32 v13, 0x3acccccd, v11
    v_cos_f32 v13, v13
    s_nop 0
    v_mul_f32 v17, v13, v14
    v_add_u32 v11, 1, v8
    v_mov_b32 v13, 0x00000000
    v_mov_b32 v14, 0x35cccccd
    v_mul_u32_u24 v11, v11, v6
    v_mul_hi_u32 v12, v11, s39
    v_mul_lo_u32 v12, v12, s40
    v_sub_u32 v11, v11, v12
    v_cvt_f32_u32 v11, v11
    v_fmac_f32 v13, 0x3acccccd, v11
    v_cos_f32 v13, v13
    s_nop 0
    v_mul_f32 v18, v13, v14
    v_add_u32 v11, 1, v8
    v_mov_b32 v13, 0x3e800000
    v_mov_b32 v14, 0x35cccccd
    v_mul_u32_u24 v11, v11, v6
    v_mul_hi_u32 v12, v11, s39
    v_mul_lo_u32 v12, v12, s40
    v_sub_u32 v11, v11, v12
    v_cvt_f32_u32 v11, v11
    v_fmac_f32 v13, 0x3acccccd, v11
    v_cos_f32 v13, v13
    s_nop 0
    v_mul_f32 v19, v13, v14
    v_add_u32 v11, 2, v8
    v_mov_b32 v13, 0x00000000
    v_mov_b32 v14, 0x35cccccd
    v_mul_u32_u24 v11, v11, v6
    v_mul_hi_u32 v12, v11, s39
    v_mul_lo_u32 v12, v12, s40
    v_sub_u32 v11, v11, v12
    v_cvt_f32_u32 v11, v11
    v_fmac_f32 v13, 0x3acccccd, v11
    v_cos_f32 v13, v13
    s_nop 0
    v_mul_f32 v20, v13, v14
    v_add_u32 v11, 2, v8
    v_mov_b32 v13, 0x3e800000
    v_mov_b32 v14, 0x35cccccd
    v_mul_u32_u24 v11, v11, v6
    v_mul_hi_u32 v12, v11, s39
    v_mul_lo_u32 v12, v12, s40
    v_sub_u32 v11, v11, v12
    v_cvt_f32_u32 v11, v11
    v_fmac_f32 v13, 0x3acccccd, v11
    v_cos_f32 v13, v13
    s_nop 0
    v_mul_f32 v21, v13, v14
    v_add_u32 v11, 3, v8
    v_mov_b32 v13, 0x00000000
    v_mov_b32 v14, 0x35cccccd
    v_mul_u32_u24 v11, v11, v6
    v_mul_hi_u32 v12, v11, s39
    v_mul_lo_u32 v12, v12, s40
    v_sub_u32 v11, v11, v12
    v_cvt_f32_u32 v11, v11
    v_fmac_f32 v13, 0x3acccccd, v11
    v_cos_f32 v13, v13
    s_nop 0
    v_mul_f32 v22, v13, v14
    v_add_u32 v11, 3, v8
    v_mov_b32 v13, 0x3e800000
    v_mov_b32 v14, 0x35cccccd
    v_mul_u32_u24 v11, v11, v6
    v_mul_hi_u32 v12, v11, s39
    v_mul_lo_u32 v12, v12, s40
    v_sub_u32 v11, v11, v12
    v_cvt_f32_u32 v11, v11
    v_fmac_f32 v13, 0x3acccccd, v11
    v_cos_f32 v13, v13
    s_nop 0
    v_mul_f32 v23, v13, v14
    v_cvt_pk_bf16_f32 v24, v16, v17
    v_cvt_pk_bf16_f32 v25, v18, v19
    v_cvt_pk_bf16_f32 v26, v20, v21
    v_cvt_pk_bf16_f32 v27, v22, v23
    s_lshl_b32 s37, s36, 10
    s_add_u32 s37, s37, 147849216
    buffer_store_dwordx4 v[24:27], v5, s[8:11], s37 offen sc1
    s_branch M_q_te
M_q_wt:
    s_sub_u32 s37, s94, 800
    s_lshr_b32 s36, s37, 8
    s_and_b32 s37, s37, 255
    s_lshl_b32 s38, s36, 6
    v_add_u32 v6, s38, v1
    s_lshr_b32 s38, s37, 5
    s_bfe_u32 s39, s37, 0x30002
    s_lshl_b32 s39, s39, 3
    s_add_u32 s38, s38, s39
    s_and_b32 s39, s37, 3
    s_lshl_b32 s39, s39, 7
    s_add_u32 s38, s38, s39
    s_mul_i32 s38, s38, 642
    v_lshlrev_b32 v7, 1, v6
    v_lshrrev_b32 v2, 1, v6
    v_lshlrev_b32 v2, 14, v2
    v_and_b32 v24, 1, v6
    v_lshl_add_u32 v2, v24, 4, v2
    v_cmp_gt_u32 vcc, 321, v6
    s_and_saveexec_b64 s[90:91], vcc
    s_cbranch_execz M_q_ws
    s_add_u32 s39, s38, 0
    buffer_load_ushort v8, v7, s[72:75], s39 offen
    buffer_load_ushort v16, v7, s[76:79], s39 offen
    s_add_u32 s39, s38, 328704
    buffer_load_ushort v9, v7, s[72:75], s39 offen
    buffer_load_ushort v17, v7, s[76:79], s39 offen
    s_add_u32 s39, s38, 657408
    buffer_load_ushort v10, v7, s[72:75], s39 offen
    buffer_load_ushort v18, v7, s[76:79], s39 offen
    s_add_u32 s39, s38, 986112
    buffer_load_ushort v11, v7, s[72:75], s39 offen
    buffer_load_ushort v19, v7, s[76:79], s39 offen
    s_add_u32 s39, s38, 41088
    buffer_load_ushort v12, v7, s[72:75], s39 offen
    buffer_load_ushort v20, v7, s[76:79], s39 offen
    s_add_u32 s39, s38, 369792
    buffer_load_ushort v13, v7, s[72:75], s39 offen
    buffer_load_ushort v21, v7, s[76:79], s39 offen
    s_add_u32 s39, s38, 698496
    buffer_load_ushort v14, v7, s[72:75], s39 offen
    buffer_load_ushort v22, v7, s[76:79], s39 offen
    s_add_u32 s39, s38, 1027200
    buffer_load_ushort v15, v7, s[72:75], s39 offen
    buffer_load_ushort v23, v7, s[76:79], s39 offen
    s_lshl_b32 s39, s37, 6
    s_add_u32 s39, s39, 148897792
    s_waitcnt vmcnt(0)
    v_lshl_or_b32 v8, v16, 16, v8
    v_lshl_or_b32 v9, v17, 16, v9
    v_lshl_or_b32 v10, v18, 16, v10
    v_lshl_or_b32 v11, v19, 16, v11
    v_lshl_or_b32 v12, v20, 16, v12
    v_lshl_or_b32 v13, v21, 16, v13
    v_lshl_or_b32 v14, v22, 16, v14
    v_lshl_or_b32 v15, v23, 16, v15
    buffer_store_dwordx4 v[8:11], v2, s[8:11], s39 offen sc1
    buffer_store_dwordx4 v[12:15], v2, s[8:11], s39 offen offset:32 sc1
M_q_ws:
    s_mov_b64 exec, s[90:91]
M_q_te:
    s_add_u32 s94, s94, 240
    s_mov_b32 s40, 0x3e0293ee
    s_mov_b32 s41, s40
    s_cmp_lt_u32 s94, 2400
    s_cbranch_scc1 M_q_tr
    s_waitcnt vmcnt(0)
    v_mov_b32 v1, s21
    v_mov_b32 v2, 1
    s_mov_b64 exec, 1
    buffer_store_byte v2, v1, s[8:11], s95 offen sc1
    s_mov_b64 exec, -1
M_q_tr:
    s_nop 1
    v_mov_b32 v1, v33
    v_mov_b32 v2, v34
    v_mov_b32 v3, v35
    v_mov_b32 v4, v36
    v_mov_b32 v5, v37
    v_mov_b32 v6, v38
    v_mov_b32 v7, v39
    v_mov_b32 v8, v40
    v_mov_b32 v9, v41
    v_mov_b32 v10, v42
    v_mov_b32 v11, v43
    v_mov_b32 v12, v44
    v_mov_b32 v13, v45
    v_mov_b32 v14, v46
    v_mov_b32 v15, v47
    v_mov_b32 v16, v48
    v_mov_b32 v17, v49
    v_mov_b32 v18, v50
    v_mov_b32 v19, v51
    v_mov_b32 v20, v52
    v_mov_b32 v21, v53
    v_mov_b32 v22, v54
    v_mov_b32 v23, v55
    s_branch M_q_nd
M_q_e1:
    s_barrier
    s_add_u32 s28, s68, 131072
    buffer_store_dwordx4 v[104:107], v13, s[8:11], s68 offen sc1
    buffer_store_dwordx4 v[108:111], v13, s[8:11], s28 offen sc1
    s_mov_b32 exec_hi, 0
    buffer_store_dwordx2 v[20:21], v7, s[8:11], s67 offen sc1
    s_mov_b32 exec_lo, 0x000f000f
    buffer_store_dwordx2 v[22:23], v7, s[8:11], s67 offen offset:256 sc1
    s_mov_b64 exec, -1
M_bphase:
    s_sub_u32 s82, s20, 2
    s_mov_b32 s83, s21
    s_mov_b32 s84, s22
    s_mov_b32 s85, s23
    s_lshl_b32 s87, s82, 5
    s_add_u32 s87, s87, s22
    s_mul_i32 s86, s101, 8192
    s_mul_i32 s80, s101, 8388608
    s_add_u32 s80, s80, 134217728
    s_load_dwordx2 s[16:17], s[0:1], 80
    s_waitcnt lgkmcnt(0)
    s_and_b32 s17, s17, 0xffff
    s_cmp_eq_u32 s101, 1
    s_cbranch_scc1 M_osrd
    s_add_u32 s16, s8, 138412032
    s_addc_u32 s17, s9, 0
M_osrd:
    s_cmp_eq_u32 s87, 160
    s_cselect_b32 s81, 191, s87
    s_cmp_eq_u32 s87, 191
    s_cselect_b32 s81, 160, s81
    s_cmp_ge_u32 s82, 1
    s_cbranch_scc1 M_tabok2
    s_cmp_lg_u32 s101, 0
    s_cbranch_scc1 M_b_tp2
    v_lshlrev_b32 v190, 3, v0
    s_mov_b32 exec_hi, 0x0fffffff
    s_mov_b32 s28, 167948288
    s_mov_b32 s30, 0
M_b_tpl:
    buffer_load_dword v191, v190, s[8:11], s28 offen sc1
    s_add_u32 s30, s30, 1
    s_cmp_ge_u32 s30, 240000
    s_cbranch_scc1 M_fail
    s_waitcnt vmcnt(0)
    v_cmp_ne_u32 vcc, 0x01010101, v191
    s_cbranch_vccz M_b_tpd
    s_sleep 8
    s_branch M_b_tpl
M_b_tpd:
    s_mov_b64 exec, -1
M_b_tp2:
    s_mul_i32 s29, s83, 10240
    s_add_u32 s29, s29, 0
    s_mul_i32 s28, s88, 81920
    s_add_u32 s28, s28, s29
    s_add_u32 s28, s28, 147849216
    s_mov_b32 m0, s29
    s_nop 0
    buffer_load_dwordx4 v0, s[8:11], s28 offen offset:0 sc1 lds
    buffer_load_dwordx4 v0, s[8:11], s28 offen offset:1024 sc1 lds
    buffer_load_dwordx4 v0, s[8:11], s28 offen offset:2048 sc1 lds
    buffer_load_dwordx4 v0, s[8:11], s28 offen offset:3072 sc1 lds
    s_add_u32 s29, s29, 4096
    s_add_u32 s28, s28, 4096
    s_mov_b32 m0, s29
    s_nop 0
    buffer_load_dwordx4 v0, s[8:11], s28 offen offset:0 sc1 lds
    buffer_load_dwordx4 v0, s[8:11], s28 offen offset:1024 sc1 lds
    buffer_load_dwordx4 v0, s[8:11], s28 offen offset:2048 sc1 lds
    buffer_load_dwordx4 v0, s[8:11], s28 offen offset:3072 sc1 lds
    s_add_u32 s29, s29, 4096
    s_add_u32 s28, s28, 4096
    s_mov_b32 m0, s29
    s_nop 0
    buffer_load_dwordx4 v0, s[8:11], s28 offen offset:0 sc1 lds
    buffer_load_dwordx4 v0, s[8:11], s28 offen offset:1024 sc1 lds
    s_mul_i32 s29, s83, 10240
    s_add_u32 s29, s29, 40960
    s_mul_i32 s28, s88, 81920
    s_add_u32 s28, s28, s29
    s_add_u32 s28, s28, 147849216
    s_mov_b32 m0, s29
    s_nop 0
    buffer_load_dwordx4 v0, s[8:11], s28 offen offset:0 sc1 lds
    buffer_load_dwordx4 v0, s[8:11], s28 offen offset:1024 sc1 lds
    buffer_load_dwordx4 v0, s[8:11], s28 offen offset:2048 sc1 lds
    buffer_load_dwordx4 v0, s[8:11], s28 offen offset:3072 sc1 lds
    s_add_u32 s29, s29, 4096
    s_add_u32 s28, s28, 4096
    s_mov_b32 m0, s29
    s_nop 0
    buffer_load_dwordx4 v0, s[8:11], s28 offen offset:0 sc1 lds
    buffer_load_dwordx4 v0, s[8:11], s28 offen offset:1024 sc1 lds
    buffer_load_dwordx4 v0, s[8:11], s28 offen offset:2048 sc1 lds
    buffer_load_dwordx4 v0, s[8:11], s28 offen offset:3072 sc1 lds
    s_add_u32 s29, s29, 4096
    s_add_u32 s28, s28, 4096
    s_mov_b32 m0, s29
    s_nop 0
    buffer_load_dwordx4 v0, s[8:11], s28 offen offset:0 sc1 lds
    buffer_load_dwordx4 v0, s[8:11], s28 offen offset:1024 sc1 lds
M_tabok2:
    v_mbcnt_lo_u32_b32 v0, -1, 0
    v_mbcnt_hi_u32_b32 v0, -1, v0
    s_lshl_b32 s27, s83, 6
    v_add_u32 v0, s27, v0
    s_mov_b32 s2, s81
    v_lshlrev_b32 v1, 2, v0
    v_and_b32 v102, 63, v0
    v_lshlrev_b32 v102, 4, v102
    v_lshlrev_b32 v2, 6, v0
    s_cmp_lt_u32 s2, 161
    s_cbranch_scc1 M_fft_go
    s_min_u32 s28, s89, 63
    s_lshl_b32 s29, s28, 12
    s_add_u32 s29, s29, 173654016
    v_lshlrev_b32 v190, 3, v102
    s_mov_b32 exec_hi, 0
    buffer_load_dword v191, v190, s[8:11], s29 offen sc1
    s_mov_b64 exec, 1
    s_mul_i32 s28, s28, 40960
    s_lshl_b32 s29, s88, 7
    s_add_u32 s29, s29, s28
    buffer_load_dword v191, v190, s[16:19], s29 offen sc1
    s_lshl_b32 s29, s88, 11
    s_add_u32 s29, s29, s28
    s_add_u32 s29, s29, 32505856
    buffer_load_dword v191, v190, s[8:11], s29 offen sc1
    s_mul_i32 s28, s101, 3145728
    s_min_u32 s29, s2, 159
    s_lshl_b32 s29, s29, 14
    s_add_u32 s28, s28, s29
    s_lshl_b32 s29, s83, 9
    s_add_u32 s28, s28, s29
    s_add_u32 s28, s28, 157286400
    s_cmp_lt_u32 s2, 160
    s_cselect_b32 s28, s28, 0x10000000
    buffer_load_dword v191, v190, s[8:11], s28 offen sc1
    s_mov_b64 exec, -1
    s_branch M_fft_end
M_fft_go:
    s_mov_b32 s26, 0x3f3504f3
    s_mov_b32 s27, s26
    s_lshl_b32 s34, s2, 1
    s_add_u32 s35, s34, 1
    s_cmp_eq_u32 s2, 0
    s_cselect_b32 s35, 320, s35
    s_cmp_eq_u32 s2, 160
    s_cselect_b32 s34, 1, s34
    s_cselect_b32 s35, 1, s35
    s_mul_i32 s21, s101, 6291456
    s_add_u32 s21, s21, 176160768
    s_lshl_b32 s20, s34, 13
    s_add_u32 s20, s20, s21
    s_lshl_b32 s36, s35, 13
    s_add_u32 s36, s36, s21
    s_add_u32 s21, s20, 2621440
    s_add_u32 s37, s36, 2621440
    s_cmp_eq_u32 s2, 0
    s_cselect_b32 s21, 0x10000000, s21
    s_cselect_b32 s37, 0x10000000, s37
    s_add_u32 s22, s20, 4096
    s_add_u32 s23, s21, 4096
    s_add_u32 s38, s36, 4096
    s_add_u32 s39, s37, 4096
    s_cmp_lg_u32 s83, 0
    s_cbranch_scc1 M_dp_25
    v_and_b32 v190, 7, v0
    v_lshlrev_b32 v190, 12, v190
    v_bfe_u32 v191, v0, 3, 1
    v_mul_u32_u24 v191, 1280, v191
    v_add_u32 v190, v190, v191
    s_mov_b64 exec, 0x1f1f
    s_lshr_b32 s31, s34, 5
    s_lshl_b32 s31, s31, 7
    s_add_u32 s31, s31, 167927808
    s_lshl_b32 s32, s101, 1
    s_add_u32 s32, s32, 1
    s_mov_b32 s30, 0
M_dp_26:
    buffer_load_dword v191, v190, s[8:11], s31 offen sc1
    s_add_u32 s30, s30, 1
    s_cmp_ge_u32 s30, 240000
    s_cbranch_scc1 M_fail
    s_sleep 4
    s_waitcnt vmcnt(0)
    v_cmp_gt_u32 vcc, s32, v191
    s_cbranch_vccnz M_dp_26
    s_mov_b64 exec, -1
M_dp_25:
    s_barrier
    buffer_load_dword v8, v1, s[8:11], s20 offen offset:0 sc1
    buffer_load_dword v9, v1, s[8:11], s21 offen offset:0 sc1
    buffer_load_dword v10, v1, s[8:11], s20 offen offset:1024 sc1
    buffer_load_dword v11, v1, s[8:11], s21 offen offset:1024 sc1
    buffer_load_dword v12, v1, s[8:11], s20 offen offset:2048 sc1
    buffer_load_dword v13, v1, s[8:11], s21 offen offset:2048 sc1
    buffer_load_dword v14, v1, s[8:11], s20 offen offset:3072 sc1
    buffer_load_dword v15, v1, s[8:11], s21 offen offset:3072 sc1
    buffer_load_dword v16, v1, s[8:11], s22 offen offset:0 sc1
    buffer_load_dword v17, v1, s[8:11], s23 offen offset:0 sc1
    buffer_load_dword v18, v1, s[8:11], s22 offen offset:1024 sc1
    buffer_load_dword v19, v1, s[8:11], s23 offen offset:1024 sc1
    buffer_load_dword v20, v1, s[8:11], s22 offen offset:2048 sc1
    buffer_load_dword v21, v1, s[8:11], s23 offen offset:2048 sc1
    buffer_load_dword v112, v1, s[8:11], s36 offen offset:0 sc1
    buffer_load_dword v113, v1, s[8:11], s37 offen offset:0 sc1
    buffer_load_dword v114, v1, s[8:11], s36 offen offset:1024 sc1
    buffer_load_dword v115, v1, s[8:11], s37 offen offset:1024 sc1
    buffer_load_dword v116, v1, s[8:11], s36 offen offset:2048 sc1
    buffer_load_dword v117, v1, s[8:11], s37 offen offset:2048 sc1
    buffer_load_dword v118, v1, s[8:11], s36 offen offset:3072 sc1
    buffer_load_dword v119, v1, s[8:11], s37 offen offset:3072 sc1
    buffer_load_dword v120, v1, s[8:11], s38 offen offset:0 sc1
    buffer_load_dword v121, v1, s[8:11], s39 offen offset:0 sc1
    buffer_load_dword v122, v1, s[8:11], s38 offen offset:1024 sc1
    buffer_load_dword v123, v1, s[8:11], s39 offen offset:1024 sc1
    buffer_load_dword v124, v1, s[8:11], s38 offen offset:2048 sc1
    buffer_load_dword v125, v1, s[8:11], s39 offen offset:2048 sc1
    s_lshr_b32 s24, s34, 1
    s_lshl_b32 s24, s24, 14
    s_and_b32 s25, s34, 1
    s_lshl_b32 s25, s25, 4
    s_add_u32 s24, s24, s25
    s_add_u32 s24, s24, 148897792
    buffer_load_dwordx4 v[92:95], v2, s[8:11], s24 offen sc1
    buffer_load_dwordx4 v[96:99], v2, s[8:11], s24 offen offset:32 sc1
    s_lshr_b32 s24, s35, 1
    s_lshl_b32 s24, s24, 14
    s_and_b32 s25, s35, 1
    s_lshl_b32 s25, s25, 4
    s_add_u32 s24, s24, s25
    s_add_u32 s24, s24, 148897792
    buffer_load_dwordx4 v[104:107], v2, s[8:11], s24 offen sc1
    buffer_load_dwordx4 v[108:111], v2, s[8:11], s24 offen offset:32 sc1
    s_min_u32 s28, s89, 63
    s_lshl_b32 s29, s28, 12
    s_add_u32 s29, s29, 173654016
    v_lshlrev_b32 v190, 3, v102
    s_mov_b32 exec_hi, 0
    buffer_load_dword v191, v190, s[8:11], s29 offen sc1
    s_mov_b64 exec, 1
    s_mul_i32 s28, s28, 40960
    s_lshl_b32 s29, s88, 7
    s_add_u32 s29, s29, s28
    buffer_load_dword v191, v190, s[16:19], s29 offen sc1
    s_lshl_b32 s29, s88, 11
    s_add_u32 s29, s29, s28
    s_add_u32 s29, s29, 32505856
    buffer_load_dword v191, v190, s[8:11], s29 offen sc1
    s_mul_i32 s28, s101, 3145728
    s_min_u32 s29, s2, 159
    s_lshl_b32 s29, s29, 14
    s_add_u32 s28, s28, s29
    s_lshl_b32 s29, s83, 9
    s_add_u32 s28, s28, s29
    s_add_u32 s28, s28, 157286400
    s_cmp_lt_u32 s2, 160
    s_cselect_b32 s28, s28, 0x10000000
    buffer_load_dword v191, v190, s[8:11], s28 offen sc1
    s_mov_b64 exec, -1
    v_and_b32 v3, 255, v0
    v_cvt_f32_u32 v3, v3
    v_mul_f32 v4, 0xba000000, v3
    v_cos_f32 v48, v4
    v_sin_f32 v49, v4
    v_mul_f32 v4, 0xba800000, v3
    v_cos_f32 v50, v4
    v_sin_f32 v51, v4
    v_mul_f32 v4, 0xbac00000, v3
    v_cos_f32 v52, v4
    v_sin_f32 v53, v4
    v_mul_f32 v4, 0xbb000000, v3
    v_cos_f32 v54, v4
    v_sin_f32 v55, v4
    v_mul_f32 v4, 0xbb200000, v3
    v_cos_f32 v56, v4
    v_sin_f32 v57, v4
    v_mul_f32 v4, 0xbb400000, v3
    v_cos_f32 v58, v4
    v_sin_f32 v59, v4
    v_mul_f32 v4, 0xbb600000, v3
    v_cos_f32 v60, v4
    v_sin_f32 v61, v4
    v_and_b32 v3, 31, v0
    v_cvt_f32_u32 v3, v3
    v_mul_f32 v4, 0xbb800000, v3
    v_cos_f32 v62, v4
    v_sin_f32 v63, v4
    v_mul_f32 v4, 0xbc000000, v3
    v_cos_f32 v64, v4
    v_sin_f32 v65, v4
    v_mul_f32 v4, 0xbc400000, v3
    v_cos_f32 v66, v4
    v_sin_f32 v67, v4
    v_mul_f32 v4, 0xbc800000, v3
    v_cos_f32 v68, v4
    v_sin_f32 v69, v4
    v_mul_f32 v4, 0xbca00000, v3
    v_cos_f32 v70, v4
    v_sin_f32 v71, v4
    v_mul_f32 v4, 0xbcc00000, v3
    v_cos_f32 v72, v4
    v_sin_f32 v73, v4
    v_mul_f32 v4, 0xbce00000, v3
    v_cos_f32 v74, v4
    v_sin_f32 v75, v4
    v_and_b32 v3, 3, v0
    v_cvt_f32_u32 v3, v3
    v_mul_f32 v4, 0xbd000000, v3
    v_cos_f32 v76, v4
    v_sin_f32 v77, v4
    v_mul_f32 v4, 0xbd800000, v3
    v_cos_f32 v78, v4
    v_sin_f32 v79, v4
    v_mul_f32 v4, 0xbdc00000, v3
    v_cos_f32 v80, v4
    v_sin_f32 v81, v4
    v_mul_f32 v4, 0xbe000000, v3
    v_cos_f32 v82, v4
    v_sin_f32 v83, v4
    v_mul_f32 v4, 0xbe200000, v3
    v_cos_f32 v84, v4
    v_sin_f32 v85, v4
    v_mul_f32 v4, 0xbe400000, v3
    v_cos_f32 v86, v4
    v_sin_f32 v87, v4
    v_mul_f32 v4, 0xbe600000, v3
    v_cos_f32 v88, v4
    v_sin_f32 v89, v4
    v_lshlrev_b32 v3, 3, v0
    v_lshrrev_b32 v4, 5, v0
    v_mul_u32_u24 v4, 2304, v4
    v_add_u32 v3, 81920, v3
    v_add_u32 v4, 81920, v4
    v_and_b32 v5, 31, v0
    v_lshl_add_u32 v5, v5, 3, v4
    v_bfe_u32 v6, v0, 2, 3
    v_mul_u32_u24 v6, 288, v6
    v_add_u32 v6, v6, v4
    v_and_b32 v7, 3, v0
    v_lshl_add_u32 v100, v7, 6, v6
    v_lshl_add_u32 v6, v7, 3, v6
    v_and_b32 v101, 0xe0, v0
    v_and_b32 v7, 15, v0
    v_lshl_add_u32 v101, v7, 1, v101
    v_bfe_u32 v7, v0, 4, 1
    v_add_u32 v101, v101, v7
    v_lshlrev_b32 v101, 3, v101
    s_waitcnt vmcnt(0)
    s_cmp_lg_u32 s83, 0
    s_cbranch_scc1 M_dp_27
    v_and_b32 v190, 7, v0
    v_lshlrev_b32 v190, 12, v190
    v_bfe_u32 v191, v0, 3, 1
    v_mul_u32_u24 v191, 1280, v191
    v_add_u32 v190, v190, v191
    s_mov_b64 exec, 0x1f1f
    s_lshr_b32 s31, s34, 5
    s_lshl_b32 s31, s31, 7
    s_add_u32 s31, s31, 167927808
    s_lshl_b32 s32, s101, 1
    s_add_u32 s32, s32, 2
    s_mov_b32 s30, 0
M_dp_28:
    buffer_load_dword v191, v190, s[8:11], s31 offen sc1
    s_add_u32 s30, s30, 1
    s_cmp_ge_u32 s30, 240000
    s_cbranch_scc1 M_fail
    s_waitcnt vmcnt(0)
    v_cmp_gt_u32 vcc, s32, v191
    s_cbranch_vccnz M_dp_28
    s_mov_b64 exec, -1
M_dp_27:
    s_barrier
    buffer_load_dword v22, v1, s[8:11], s22 offen offset:3072 sc1
    buffer_load_dword v23, v1, s[8:11], s23 offen offset:3072 sc1
    buffer_load_dword v126, v1, s[8:11], s38 offen offset:3072 sc1
    buffer_load_dword v127, v1, s[8:11], s39 offen offset:3072 sc1
    v_pk_add_f32 v[24:25], v[8:9], v[16:17]
    v_pk_add_f32 v[26:27], v[8:9], v[16:17] neg_lo:[0,1] neg_hi:[0,1]
    v_pk_add_f32 v[28:29], v[10:11], v[18:19]
    v_pk_add_f32 v[30:31], v[10:11], v[18:19] neg_lo:[0,1] neg_hi:[0,1]
    v_pk_add_f32 v[32:33], v[12:13], v[20:21]
    v_pk_add_f32 v[34:35], v[12:13], v[20:21] neg_lo:[0,1] neg_hi:[0,1]
    s_waitcnt vmcnt(2)
    v_pk_add_f32 v[36:37], v[14:15], v[22:23]
    v_pk_add_f32 v[38:39], v[14:15], v[22:23] neg_lo:[0,1] neg_hi:[0,1]
    v_pk_add_f32 v[40:41], v[24:25], v[32:33]
    v_pk_add_f32 v[42:43], v[24:25], v[32:33] neg_lo:[0,1] neg_hi:[0,1]
    v_pk_add_f32 v[44:45], v[28:29], v[36:37]
    v_pk_add_f32 v[46:47], v[28:29], v[36:37] neg_lo:[0,1] neg_hi:[0,1]
    v_pk_add_f32 v[8:9], v[40:41], v[44:45]
    v_pk_add_f32 v[16:17], v[40:41], v[44:45] neg_lo:[0,1] neg_hi:[0,1]
    v_pk_add_f32 v[10:11], v[42:43], v[46:47] op_sel:[0,1] op_sel_hi:[1,0] neg_lo:[0,0] neg_hi:[0,1]
    v_pk_add_f32 v[18:19], v[42:43], v[46:47] op_sel:[0,1] op_sel_hi:[1,0] neg_lo:[0,1] neg_hi:[0,0]
    v_pk_add_f32 v[12:13], v[30:31], v[30:31] op_sel:[0,1] op_sel_hi:[1,0] neg_lo:[0,0] neg_hi:[0,1]
    v_pk_add_f32 v[20:21], v[38:39], v[38:39] op_sel:[0,1] op_sel_hi:[1,0] neg_lo:[1,0] neg_hi:[1,1]
    v_pk_add_f32 v[14:15], v[26:27], v[34:35] op_sel:[0,1] op_sel_hi:[1,0] neg_lo:[0,0] neg_hi:[0,1]
    v_pk_add_f32 v[22:23], v[26:27], v[34:35] op_sel:[0,1] op_sel_hi:[1,0] neg_lo:[0,1] neg_hi:[0,0]
    v_pk_add_f32 v[24:25], v[12:13], v[20:21]
    v_pk_add_f32 v[28:29], v[12:13], v[20:21] neg_lo:[0,1] neg_hi:[0,1]
    v_pk_fma_f32 v[32:33], v[24:25], s[26:27], v[14:15] neg_lo:[0,0,0] neg_hi:[0,0,0]
    v_pk_fma_f32 v[36:37], v[24:25], s[26:27], v[14:15] neg_lo:[1,0,0] neg_hi:[1,0,0]
    v_pk_fma_f32 v[40:41], v[28:29], s[26:27], v[22:23] op_sel:[1,0,0] op_sel_hi:[0,1,1] neg_lo:[0,0,0] neg_hi:[1,0,0]
    v_pk_fma_f32 v[42:43], v[28:29], s[26:27], v[22:23] op_sel:[1,0,0] op_sel_hi:[0,1,1] neg_lo:[1,0,0] neg_hi:[0,0,0]
    v_pk_mul_f32 v[44:45], v[32:33], v[48:49] op_sel:[0,0] op_sel_hi:[1,0]
    v_pk_mul_f32 v[46:47], v[10:11], v[50:51] op_sel:[0,0] op_sel_hi:[1,0]
    v_pk_mul_f32 v[26:27], v[40:41], v[52:53] op_sel:[0,0] op_sel_hi:[1,0]
    v_pk_mul_f32 v[30:31], v[16:17], v[54:55] op_sel:[0,0] op_sel_hi:[1,0]
    v_pk_mul_f32 v[34:35], v[36:37], v[56:57] op_sel:[0,0] op_sel_hi:[1,0]
    v_pk_mul_f32 v[38:39], v[18:19], v[58:59] op_sel:[0,0] op_sel_hi:[1,0]
    v_pk_mul_f32 v[12:13], v[42:43], v[60:61] op_sel:[0,0] op_sel_hi:[1,0]
    v_pk_fma_f32 v[44:45], v[32:33], v[48:49], v[44:45] op_sel:[1,1,0] op_sel_hi:[0,1,1] neg_lo:[1,0,0] neg_hi:[0,0,0]
    v_pk_fma_f32 v[46:47], v[10:11], v[50:51], v[46:47] op_sel:[1,1,0] op_sel_hi:[0,1,1] neg_lo:[1,0,0] neg_hi:[0,0,0]
    v_pk_fma_f32 v[26:27], v[40:41], v[52:53], v[26:27] op_sel:[1,1,0] op_sel_hi:[0,1,1] neg_lo:[1,0,0] neg_hi:[0,0,0]
    v_pk_fma_f32 v[30:31], v[16:17], v[54:55], v[30:31] op_sel:[1,1,0] op_sel_hi:[0,1,1] neg_lo:[1,0,0] neg_hi:[0,0,0]
    v_pk_fma_f32 v[34:35], v[36:37], v[56:57], v[34:35] op_sel:[1,1,0] op_sel_hi:[0,1,1] neg_lo:[1,0,0] neg_hi:[0,0,0]
    v_pk_fma_f32 v[38:39], v[18:19], v[58:59], v[38:39] op_sel:[1,1,0] op_sel_hi:[0,1,1] neg_lo:[1,0,0] neg_hi:[0,0,0]
    v_pk_fma_f32 v[12:13], v[42:43], v[60:61], v[12:13] op_sel:[1,1,0] op_sel_hi:[0,1,1] neg_lo:[1,0,0] neg_hi:[0,0,0]
    ds_write_b64 v3, v[8:9] offset:0
    v_pk_add_f32 v[128:129], v[112:113], v[120:121]
    v_pk_add_f32 v[130:131], v[112:113], v[120:121] neg_lo:[0,1] neg_hi:[0,1]
    v_pk_add_f32 v[132:133], v[114:115], v[122:123]
    ds_write_b64 v3, v[44:45] offset:2304
    v_pk_add_f32 v[134:135], v[114:115], v[122:123] neg_lo:[0,1] neg_hi:[0,1]
    v_pk_add_f32 v[136:137], v[116:117], v[124:125]
    v_pk_add_f32 v[138:139], v[116:117], v[124:125] neg_lo:[0,1] neg_hi:[0,1]
    ds_write_b64 v3, v[46:47] offset:4608
    s_waitcnt vmcnt(0)
    v_pk_add_f32 v[140:141], v[118:119], v[126:127]
    v_pk_add_f32 v[142:143], v[118:119], v[126:127] neg_lo:[0,1] neg_hi:[0,1]
    v_pk_add_f32 v[144:145], v[128:129], v[136:137]
    ds_write_b64 v3, v[26:27] offset:6912
    v_pk_add_f32 v[146:147], v[128:129], v[136:137] neg_lo:[0,1] neg_hi:[0,1]
    v_pk_add_f32 v[148:149], v[132:133], v[140:141]
    v_pk_add_f32 v[150:151], v[132:133], v[140:141] neg_lo:[0,1] neg_hi:[0,1]
    ds_write_b64 v3, v[30:31] offset:9216
    v_pk_add_f32 v[112:113], v[144:145], v[148:149]
    v_pk_add_f32 v[120:121], v[144:145], v[148:149] neg_lo:[0,1] neg_hi:[0,1]
    v_pk_add_f32 v[114:115], v[146:147], v[150:151] op_sel:[0,1] op_sel_hi:[1,0] neg_lo:[0,0] neg_hi:[0,1]
    ds_write_b64 v3, v[34:35] offset:11520
    v_pk_add_f32 v[122:123], v[146:147], v[150:151] op_sel:[0,1] op_sel_hi:[1,0] neg_lo:[0,1] neg_hi:[0,0]
    v_pk_add_f32 v[116:117], v[134:135], v[134:135] op_sel:[0,1] op_sel_hi:[1,0] neg_lo:[0,0] neg_hi:[0,1]
    v_pk_add_f32 v[124:125], v[142:143], v[142:143] op_sel:[0,1] op_sel_hi:[1,0] neg_lo:[1,0] neg_hi:[1,1]
    ds_write_b64 v3, v[38:39] offset:13824
    v_pk_add_f32 v[118:119], v[130:131], v[138:139] op_sel:[0,1] op_sel_hi:[1,0] neg_lo:[0,0] neg_hi:[0,1]
    v_pk_add_f32 v[126:127], v[130:131], v[138:139] op_sel:[0,1] op_sel_hi:[1,0] neg_lo:[0,1] neg_hi:[0,0]
    v_pk_add_f32 v[128:129], v[116:117], v[124:125]
    ds_write_b64 v3, v[12:13] offset:16128
    v_pk_add_f32 v[132:133], v[116:117], v[124:125] neg_lo:[0,1] neg_hi:[0,1]
    v_pk_fma_f32 v[136:137], v[128:129], s[26:27], v[118:119] neg_lo:[0,0,0] neg_hi:[0,0,0]
    v_pk_fma_f32 v[140:141], v[128:129], s[26:27], v[118:119] neg_lo:[1,0,0] neg_hi:[1,0,0]
    v_pk_fma_f32 v[144:145], v[132:133], s[26:27], v[126:127] op_sel:[1,0,0] op_sel_hi:[0,1,1] neg_lo:[0,0,0] neg_hi:[1,0,0]
    v_pk_fma_f32 v[146:147], v[132:133], s[26:27], v[126:127] op_sel:[1,0,0] op_sel_hi:[0,1,1] neg_lo:[1,0,0] neg_hi:[0,0,0]
    v_pk_mul_f32 v[148:149], v[136:137], v[48:49] op_sel:[0,0] op_sel_hi:[1,0]
    v_pk_mul_f32 v[150:151], v[114:115], v[50:51] op_sel:[0,0] op_sel_hi:[1,0]
    v_pk_mul_f32 v[130:131], v[144:145], v[52:53] op_sel:[0,0] op_sel_hi:[1,0]
    v_pk_mul_f32 v[134:135], v[120:121], v[54:55] op_sel:[0,0] op_sel_hi:[1,0]
    v_pk_mul_f32 v[138:139], v[140:141], v[56:57] op_sel:[0,0] op_sel_hi:[1,0]
    v_pk_mul_f32 v[142:143], v[122:123], v[58:59] op_sel:[0,0] op_sel_hi:[1,0]
    v_pk_mul_f32 v[116:117], v[146:147], v[60:61] op_sel:[0,0] op_sel_hi:[1,0]
    v_pk_fma_f32 v[148:149], v[136:137], v[48:49], v[148:149] op_sel:[1,1,0] op_sel_hi:[0,1,1] neg_lo:[1,0,0] neg_hi:[0,0,0]
    v_pk_fma_f32 v[150:151], v[114:115], v[50:51], v[150:151] op_sel:[1,1,0] op_sel_hi:[0,1,1] neg_lo:[1,0,0] neg_hi:[0,0,0]
    v_pk_fma_f32 v[130:131], v[144:145], v[52:53], v[130:131] op_sel:[1,1,0] op_sel_hi:[0,1,1] neg_lo:[1,0,0] neg_hi:[0,0,0]
    v_pk_fma_f32 v[134:135], v[120:121], v[54:55], v[134:135] op_sel:[1,1,0] op_sel_hi:[0,1,1] neg_lo:[1,0,0] neg_hi:[0,0,0]
    v_pk_fma_f32 v[138:139], v[140:141], v[56:57], v[138:139] op_sel:[1,1,0] op_sel_hi:[0,1,1] neg_lo:[1,0,0] neg_hi:[0,0,0]
    v_pk_fma_f32 v[142:143], v[122:123], v[58:59], v[142:143] op_sel:[1,1,0] op_sel_hi:[0,1,1] neg_lo:[1,0,0] neg_hi:[0,0,0]
    v_pk_fma_f32 v[116:117], v[146:147], v[60:61], v[116:117] op_sel:[1,1,0] op_sel_hi:[0,1,1] neg_lo:[1,0,0] neg_hi:[0,0,0]
    ds_write_b64 v3, v[112:113] offset:18432
    ds_write_b64 v3, v[148:149] offset:20736
    ds_write_b64 v3, v[150:151] offset:23040
    ds_write_b64 v3, v[130:131] offset:25344
    ds_write_b64 v3, v[134:135] offset:27648
    ds_write_b64 v3, v[138:139] offset:29952
    ds_write_b64 v3, v[142:143] offset:32256
    ds_write_b64 v3, v[116:117] offset:34560
    s_waitcnt lgkmcnt(0)
    s_barrier
    ds_read_b64 v[20:21], v5 offset:0
    ds_read_b64 v[14:15], v5 offset:256
    ds_read_b64 v[22:23], v5 offset:512
    ds_read_b64 v[24:25], v5 offset:768
    ds_read_b64 v[28:29], v5 offset:1024
    ds_read_b64 v[32:33], v5 offset:1280
    ds_read_b64 v[10:11], v5 offset:1536
    ds_read_b64 v[40:41], v5 offset:1792
    ds_read_b64 v[124:125], v5 offset:18432
    ds_read_b64 v[118:119], v5 offset:18688
    ds_read_b64 v[126:127], v5 offset:18944
    ds_read_b64 v[128:129], v5 offset:19200
    ds_read_b64 v[132:133], v5 offset:19456
    ds_read_b64 v[136:137], v5 offset:19712
    ds_read_b64 v[114:115], v5 offset:19968
    ds_read_b64 v[144:145], v5 offset:20224
    s_waitcnt lgkmcnt(11)
    v_pk_add_f32 v[16:17], v[20:21], v[28:29]
    v_pk_add_f32 v[36:37], v[20:21], v[28:29] neg_lo:[0,1] neg_hi:[0,1]
    s_waitcnt lgkmcnt(10)
    v_pk_add_f32 v[18:19], v[14:15], v[32:33]
    v_pk_add_f32 v[42:43], v[14:15], v[32:33] neg_lo:[0,1] neg_hi:[0,1]
    s_waitcnt lgkmcnt(9)
    v_pk_add_f32 v[8:9], v[22:23], v[10:11]
    v_pk_add_f32 v[44:45], v[22:23], v[10:11] neg_lo:[0,1] neg_hi:[0,1]
    s_waitcnt lgkmcnt(8)
    v_pk_add_f32 v[46:47], v[24:25], v[40:41]
    v_pk_add_f32 v[26:27], v[24:25], v[40:41] neg_lo:[0,1] neg_hi:[0,1]
    v_pk_add_f32 v[30:31], v[16:17], v[8:9]
    v_pk_add_f32 v[34:35], v[16:17], v[8:9] neg_lo:[0,1] neg_hi:[0,1]
    v_pk_add_f32 v[38:39], v[18:19], v[46:47]
    v_pk_add_f32 v[12:13], v[18:19], v[46:47] neg_lo:[0,1] neg_hi:[0,1]
    v_pk_add_f32 v[20:21], v[30:31], v[38:39]
    v_pk_add_f32 v[28:29], v[30:31], v[38:39] neg_lo:[0,1] neg_hi:[0,1]
    v_pk_add_f32 v[14:15], v[34:35], v[12:13] op_sel:[0,1] op_sel_hi:[1,0] neg_lo:[0,0] neg_hi:[0,1]
    v_pk_add_f32 v[32:33], v[34:35], v[12:13] op_sel:[0,1] op_sel_hi:[1,0] neg_lo:[0,1] neg_hi:[0,0]
    v_pk_add_f32 v[22:23], v[42:43], v[42:43] op_sel:[0,1] op_sel_hi:[1,0] neg_lo:[0,0] neg_hi:[0,1]
    v_pk_add_f32 v[10:11], v[26:27], v[26:27] op_sel:[0,1] op_sel_hi:[1,0] neg_lo:[1,0] neg_hi:[1,1]
    v_pk_add_f32 v[24:25], v[36:37], v[44:45] op_sel:[0,1] op_sel_hi:[1,0] neg_lo:[0,0] neg_hi:[0,1]
    v_pk_add_f32 v[40:41], v[36:37], v[44:45] op_sel:[0,1] op_sel_hi:[1,0] neg_lo:[0,1] neg_hi:[0,0]
    v_pk_add_f32 v[16:17], v[22:23], v[10:11]
    v_pk_add_f32 v[18:19], v[22:23], v[10:11] neg_lo:[0,1] neg_hi:[0,1]
    v_pk_fma_f32 v[8:9], v[16:17], s[26:27], v[24:25] neg_lo:[0,0,0] neg_hi:[0,0,0]
    v_pk_fma_f32 v[46:47], v[16:17], s[26:27], v[24:25] neg_lo:[1,0,0] neg_hi:[1,0,0]
    v_pk_fma_f32 v[30:31], v[18:19], s[26:27], v[40:41] op_sel:[1,0,0] op_sel_hi:[0,1,1] neg_lo:[0,0,0] neg_hi:[1,0,0]
    v_pk_fma_f32 v[34:35], v[18:19], s[26:27], v[40:41] op_sel:[1,0,0] op_sel_hi:[0,1,1] neg_lo:[1,0,0] neg_hi:[0,0,0]
    v_pk_mul_f32 v[38:39], v[8:9], v[62:63] op_sel:[0,0] op_sel_hi:[1,0]
    v_pk_mul_f32 v[12:13], v[14:15], v[64:65] op_sel:[0,0] op_sel_hi:[1,0]
    v_pk_mul_f32 v[36:37], v[30:31], v[66:67] op_sel:[0,0] op_sel_hi:[1,0]
    v_pk_mul_f32 v[42:43], v[28:29], v[68:69] op_sel:[0,0] op_sel_hi:[1,0]
    v_pk_mul_f32 v[44:45], v[46:47], v[70:71] op_sel:[0,0] op_sel_hi:[1,0]
    v_pk_mul_f32 v[26:27], v[32:33], v[72:73] op_sel:[0,0] op_sel_hi:[1,0]
    v_pk_mul_f32 v[22:23], v[34:35], v[74:75] op_sel:[0,0] op_sel_hi:[1,0]
    v_pk_fma_f32 v[38:39], v[8:9], v[62:63], v[38:39] op_sel:[1,1,0] op_sel_hi:[0,1,1] neg_lo:[1,0,0] neg_hi:[0,0,0]
    v_pk_fma_f32 v[12:13], v[14:15], v[64:65], v[12:13] op_sel:[1,1,0] op_sel_hi:[0,1,1] neg_lo:[1,0,0] neg_hi:[0,0,0]
    v_pk_fma_f32 v[36:37], v[30:31], v[66:67], v[36:37] op_sel:[1,1,0] op_sel_hi:[0,1,1] neg_lo:[1,0,0] neg_hi:[0,0,0]
    v_pk_fma_f32 v[42:43], v[28:29], v[68:69], v[42:43] op_sel:[1,1,0] op_sel_hi:[0,1,1] neg_lo:[1,0,0] neg_hi:[0,0,0]
    v_pk_fma_f32 v[44:45], v[46:47], v[70:71], v[44:45] op_sel:[1,1,0] op_sel_hi:[0,1,1] neg_lo:[1,0,0] neg_hi:[0,0,0]
    v_pk_fma_f32 v[26:27], v[32:33], v[72:73], v[26:27] op_sel:[1,1,0] op_sel_hi:[0,1,1] neg_lo:[1,0,0] neg_hi:[0,0,0]
    v_pk_fma_f32 v[22:23], v[34:35], v[74:75], v[22:23] op_sel:[1,1,0] op_sel_hi:[0,1,1] neg_lo:[1,0,0] neg_hi:[0,0,0]
    ds_write_b64 v5, v[20:21] offset:0
    s_waitcnt lgkmcnt(4)
    v_pk_add_f32 v[120:121], v[124:125], v[132:133]
    v_pk_add_f32 v[140:141], v[124:125], v[132:133] neg_lo:[0,1] neg_hi:[0,1]
    s_waitcnt lgkmcnt(3)
    v_pk_add_f32 v[122:123], v[118:119], v[136:137]
    ds_write_b64 v5, v[38:39] offset:288
    v_pk_add_f32 v[146:147], v[118:119], v[136:137] neg_lo:[0,1] neg_hi:[0,1]
    s_waitcnt lgkmcnt(3)
    v_pk_add_f32 v[112:113], v[126:127], v[114:115]
    v_pk_add_f32 v[148:149], v[126:127], v[114:115] neg_lo:[0,1] neg_hi:[0,1]
    ds_write_b64 v5, v[12:13] offset:576
    s_waitcnt lgkmcnt(3)
    v_pk_add_f32 v[150:151], v[128:129], v[144:145]
    v_pk_add_f32 v[130:131], v[128:129], v[144:145] neg_lo:[0,1] neg_hi:[0,1]
    v_pk_add_f32 v[134:135], v[120:121], v[112:113]
    ds_write_b64 v5, v[36:37] offset:864
    v_pk_add_f32 v[138:139], v[120:121], v[112:113] neg_lo:[0,1] neg_hi:[0,1]
    v_pk_add_f32 v[142:143], v[122:123], v[150:151]
    v_pk_add_f32 v[116:117], v[122:123], v[150:151] neg_lo:[0,1] neg_hi:[0,1]
    ds_write_b64 v5, v[42:43] offset:1152
    v_pk_add_f32 v[124:125], v[134:135], v[142:143]
    v_pk_add_f32 v[132:133], v[134:135], v[142:143] neg_lo:[0,1] neg_hi:[0,1]
    v_pk_add_f32 v[118:119], v[138:139], v[116:117] op_sel:[0,1] op_sel_hi:[1,0] neg_lo:[0,0] neg_hi:[0,1]
    ds_write_b64 v5, v[44:45] offset:1440
    v_pk_add_f32 v[136:137], v[138:139], v[116:117] op_sel:[0,1] op_sel_hi:[1,0] neg_lo:[0,1] neg_hi:[0,0]
    v_pk_add_f32 v[126:127], v[146:147], v[146:147] op_sel:[0,1] op_sel_hi:[1,0] neg_lo:[0,0] neg_hi:[0,1]
    v_pk_add_f32 v[114:115], v[130:131], v[130:131] op_sel:[0,1] op_sel_hi:[1,0] neg_lo:[1,0] neg_hi:[1,1]
    ds_write_b64 v5, v[26:27] offset:1728
    v_pk_add_f32 v[128:129], v[140:141], v[148:149] op_sel:[0,1] op_sel_hi:[1,0] neg_lo:[0,0] neg_hi:[0,1]
    v_pk_add_f32 v[144:145], v[140:141], v[148:149] op_sel:[0,1] op_sel_hi:[1,0] neg_lo:[0,1] neg_hi:[0,0]
    v_pk_add_f32 v[120:121], v[126:127], v[114:115]
    ds_write_b64 v5, v[22:23] offset:2016
    v_pk_add_f32 v[122:123], v[126:127], v[114:115] neg_lo:[0,1] neg_hi:[0,1]
    v_pk_fma_f32 v[112:113], v[120:121], s[26:27], v[128:129] neg_lo:[0,0,0] neg_hi:[0,0,0]
    ds_read_b64 v[10:11], v6 offset:0
    v_pk_fma_f32 v[150:151], v[120:121], s[26:27], v[128:129] neg_lo:[1,0,0] neg_hi:[1,0,0]
    v_pk_fma_f32 v[134:135], v[122:123], s[26:27], v[144:145] op_sel:[1,0,0] op_sel_hi:[0,1,1] neg_lo:[0,0,0] neg_hi:[1,0,0]
    ds_read_b64 v[24:25], v6 offset:32
    v_pk_fma_f32 v[138:139], v[122:123], s[26:27], v[144:145] op_sel:[1,0,0] op_sel_hi:[0,1,1] neg_lo:[1,0,0] neg_hi:[0,0,0]
    v_pk_mul_f32 v[142:143], v[112:113], v[62:63] op_sel:[0,0] op_sel_hi:[1,0]
    ds_read_b64 v[40:41], v6 offset:64
    v_pk_mul_f32 v[116:117], v[118:119], v[64:65] op_sel:[0,0] op_sel_hi:[1,0]
    v_pk_mul_f32 v[140:141], v[134:135], v[66:67] op_sel:[0,0] op_sel_hi:[1,0]
    ds_read_b64 v[16:17], v6 offset:96
    v_pk_mul_f32 v[146:147], v[132:133], v[68:69] op_sel:[0,0] op_sel_hi:[1,0]
    v_pk_mul_f32 v[148:149], v[150:151], v[70:71] op_sel:[0,0] op_sel_hi:[1,0]
    ds_read_b64 v[18:19], v6 offset:128
    v_pk_mul_f32 v[130:131], v[136:137], v[72:73] op_sel:[0,0] op_sel_hi:[1,0]
    v_pk_mul_f32 v[126:127], v[138:139], v[74:75] op_sel:[0,0] op_sel_hi:[1,0]
    ds_read_b64 v[8:9], v6 offset:160
    v_pk_fma_f32 v[142:143], v[112:113], v[62:63], v[142:143] op_sel:[1,1,0] op_sel_hi:[0,1,1] neg_lo:[1,0,0] neg_hi:[0,0,0]
    v_pk_fma_f32 v[116:117], v[118:119], v[64:65], v[116:117] op_sel:[1,1,0] op_sel_hi:[0,1,1] neg_lo:[1,0,0] neg_hi:[0,0,0]
    ds_read_b64 v[14:15], v6 offset:192
    v_pk_fma_f32 v[140:141], v[134:135], v[66:67], v[140:141] op_sel:[1,1,0] op_sel_hi:[0,1,1] neg_lo:[1,0,0] neg_hi:[0,0,0]
    v_pk_fma_f32 v[146:147], v[132:133], v[68:69], v[146:147] op_sel:[1,1,0] op_sel_hi:[0,1,1] neg_lo:[1,0,0] neg_hi:[0,0,0]
    ds_read_b64 v[30:31], v6 offset:224
    v_pk_fma_f32 v[148:149], v[150:151], v[70:71], v[148:149] op_sel:[1,1,0] op_sel_hi:[0,1,1] neg_lo:[1,0,0] neg_hi:[0,0,0]
    v_pk_fma_f32 v[130:131], v[136:137], v[72:73], v[130:131] op_sel:[1,1,0] op_sel_hi:[0,1,1] neg_lo:[1,0,0] neg_hi:[0,0,0]
    v_pk_fma_f32 v[126:127], v[138:139], v[74:75], v[126:127] op_sel:[1,1,0] op_sel_hi:[0,1,1] neg_lo:[1,0,0] neg_hi:[0,0,0]
    ds_write_b64 v5, v[124:125] offset:18432
    s_waitcnt lgkmcnt(4)
    v_pk_add_f32 v[28:29], v[10:11], v[18:19]
    v_pk_add_f32 v[46:47], v[10:11], v[18:19] neg_lo:[0,1] neg_hi:[0,1]
    s_waitcnt lgkmcnt(3)
    v_pk_add_f32 v[32:33], v[24:25], v[8:9]
    ds_write_b64 v5, v[142:143] offset:18720
    v_pk_add_f32 v[34:35], v[24:25], v[8:9] neg_lo:[0,1] neg_hi:[0,1]
    s_waitcnt lgkmcnt(3)
    v_pk_add_f32 v[20:21], v[40:41], v[14:15]
    v_pk_add_f32 v[38:39], v[40:41], v[14:15] neg_lo:[0,1] neg_hi:[0,1]
    ds_write_b64 v5, v[116:117] offset:19008
    s_waitcnt lgkmcnt(3)
    v_pk_add_f32 v[12:13], v[16:17], v[30:31]
    v_pk_add_f32 v[36:37], v[16:17], v[30:31] neg_lo:[0,1] neg_hi:[0,1]
    v_pk_add_f32 v[42:43], v[28:29], v[20:21]
    ds_write_b64 v5, v[140:141] offset:19296
    v_pk_add_f32 v[44:45], v[28:29], v[20:21] neg_lo:[0,1] neg_hi:[0,1]
    v_pk_add_f32 v[26:27], v[32:33], v[12:13]
    v_pk_add_f32 v[22:23], v[32:33], v[12:13] neg_lo:[0,1] neg_hi:[0,1]
    ds_write_b64 v5, v[146:147] offset:19584
    v_pk_add_f32 v[10:11], v[42:43], v[26:27]
    v_pk_add_f32 v[18:19], v[42:43], v[26:27] neg_lo:[0,1] neg_hi:[0,1]
    v_pk_add_f32 v[24:25], v[44:45], v[22:23] op_sel:[0,1] op_sel_hi:[1,0] neg_lo:[0,0] neg_hi:[0,1]
    ds_write_b64 v5, v[148:149] offset:19872
    v_pk_add_f32 v[8:9], v[44:45], v[22:23] op_sel:[0,1] op_sel_hi:[1,0] neg_lo:[0,1] neg_hi:[0,0]
    v_pk_add_f32 v[40:41], v[34:35], v[34:35] op_sel:[0,1] op_sel_hi:[1,0] neg_lo:[0,0] neg_hi:[0,1]
    v_pk_add_f32 v[14:15], v[36:37], v[36:37] op_sel:[0,1] op_sel_hi:[1,0] neg_lo:[1,0] neg_hi:[1,1]
    ds_write_b64 v5, v[130:131] offset:20160
    v_pk_add_f32 v[16:17], v[46:47], v[38:39] op_sel:[0,1] op_sel_hi:[1,0] neg_lo:[0,0] neg_hi:[0,1]
    v_pk_add_f32 v[30:31], v[46:47], v[38:39] op_sel:[0,1] op_sel_hi:[1,0] neg_lo:[0,1] neg_hi:[0,0]
    v_pk_add_f32 v[28:29], v[40:41], v[14:15]
    ds_write_b64 v5, v[126:127] offset:20448
    v_pk_add_f32 v[32:33], v[40:41], v[14:15] neg_lo:[0,1] neg_hi:[0,1]
    v_pk_fma_f32 v[20:21], v[28:29], s[26:27], v[16:17] neg_lo:[0,0,0] neg_hi:[0,0,0]
    ds_read_b64 v[114:115], v6 offset:18432
    v_pk_fma_f32 v[12:13], v[28:29], s[26:27], v[16:17] neg_lo:[1,0,0] neg_hi:[1,0,0]
    v_pk_fma_f32 v[42:43], v[32:33], s[26:27], v[30:31] op_sel:[1,0,0] op_sel_hi:[0,1,1] neg_lo:[0,0,0] neg_hi:[1,0,0]
    ds_read_b64 v[128:129], v6 offset:18464
    v_pk_fma_f32 v[44:45], v[32:33], s[26:27], v[30:31] op_sel:[1,0,0] op_sel_hi:[0,1,1] neg_lo:[1,0,0] neg_hi:[0,0,0]
    v_pk_mul_f32 v[26:27], v[20:21], v[76:77] op_sel:[0,0] op_sel_hi:[1,0]
    ds_read_b64 v[144:145], v6 offset:18496
    v_pk_mul_f32 v[22:23], v[24:25], v[78:79] op_sel:[0,0] op_sel_hi:[1,0]
    v_pk_mul_f32 v[46:47], v[42:43], v[80:81] op_sel:[0,0] op_sel_hi:[1,0]
    ds_read_b64 v[120:121], v6 offset:18528
    v_pk_mul_f32 v[34:35], v[18:19], v[82:83] op_sel:[0,0] op_sel_hi:[1,0]
    v_pk_mul_f32 v[38:39], v[12:13], v[84:85] op_sel:[0,0] op_sel_hi:[1,0]
    ds_read_b64 v[122:123], v6 offset:18560
    v_pk_mul_f32 v[36:37], v[8:9], v[86:87] op_sel:[0,0] op_sel_hi:[1,0]
    v_pk_mul_f32 v[40:41], v[44:45], v[88:89] op_sel:[0,0] op_sel_hi:[1,0]
    ds_read_b64 v[112:113], v6 offset:18592
    v_pk_fma_f32 v[26:27], v[20:21], v[76:77], v[26:27] op_sel:[1,1,0] op_sel_hi:[0,1,1] neg_lo:[1,0,0] neg_hi:[0,0,0]
    v_pk_fma_f32 v[22:23], v[24:25], v[78:79], v[22:23] op_sel:[1,1,0] op_sel_hi:[0,1,1] neg_lo:[1,0,0] neg_hi:[0,0,0]
    ds_read_b64 v[118:119], v6 offset:18624
    v_pk_fma_f32 v[46:47], v[42:43], v[80:81], v[46:47] op_sel:[1,1,0] op_sel_hi:[0,1,1] neg_lo:[1,0,0] neg_hi:[0,0,0]
    v_pk_fma_f32 v[34:35], v[18:19], v[82:83], v[34:35] op_sel:[1,1,0] op_sel_hi:[0,1,1] neg_lo:[1,0,0] neg_hi:[0,0,0]
    ds_read_b64 v[134:135], v6 offset:18656
    v_pk_fma_f32 v[38:39], v[12:13], v[84:85], v[38:39] op_sel:[1,1,0] op_sel_hi:[0,1,1] neg_lo:[1,0,0] neg_hi:[0,0,0]
    v_pk_fma_f32 v[36:37], v[8:9], v[86:87], v[36:37] op_sel:[1,1,0] op_sel_hi:[0,1,1] neg_lo:[1,0,0] neg_hi:[0,0,0]
    v_pk_fma_f32 v[40:41], v[44:45], v[88:89], v[40:41] op_sel:[1,1,0] op_sel_hi:[0,1,1] neg_lo:[1,0,0] neg_hi:[0,0,0]
    ds_write_b64 v6, v[10:11] offset:0
    s_waitcnt lgkmcnt(4)
    v_pk_add_f32 v[132:133], v[114:115], v[122:123]
    v_pk_add_f32 v[150:151], v[114:115], v[122:123] neg_lo:[0,1] neg_hi:[0,1]
    s_waitcnt lgkmcnt(3)
    v_pk_add_f32 v[136:137], v[128:129], v[112:113]
    ds_write_b64 v6, v[26:27] offset:32
    v_pk_add_f32 v[138:139], v[128:129], v[112:113] neg_lo:[0,1] neg_hi:[0,1]
    s_waitcnt lgkmcnt(3)
    v_pk_add_f32 v[124:125], v[144:145], v[118:119]
    v_pk_add_f32 v[142:143], v[144:145], v[118:119] neg_lo:[0,1] neg_hi:[0,1]
    ds_write_b64 v6, v[22:23] offset:64
    s_waitcnt lgkmcnt(3)
    v_pk_add_f32 v[116:117], v[120:121], v[134:135]
    v_pk_add_f32 v[140:141], v[120:121], v[134:135] neg_lo:[0,1] neg_hi:[0,1]
    v_pk_add_f32 v[146:147], v[132:133], v[124:125]
    ds_write_b64 v6, v[46:47] offset:96
    v_pk_add_f32 v[148:149], v[132:133], v[124:125] neg_lo:[0,1] neg_hi:[0,1]
    v_pk_add_f32 v[130:131], v[136:137], v[116:117]
    v_pk_add_f32 v[126:127], v[136:137], v[116:117] neg_lo:[0,1] neg_hi:[0,1]
    ds_write_b64 v6, v[34:35] offset:128
    v_pk_add_f32 v[114:115], v[146:147], v[130:131]
    v_pk_add_f32 v[122:123], v[146:147], v[130:131] neg_lo:[0,1] neg_hi:[0,1]
    v_pk_add_f32 v[128:129], v[148:149], v[126:127] op_sel:[0,1] op_sel_hi:[1,0] neg_lo:[0,0] neg_hi:[0,1]
    ds_write_b64 v6, v[38:39] offset:160
    v_pk_add_f32 v[112:113], v[148:149], v[126:127] op_sel:[0,1] op_sel_hi:[1,0] neg_lo:[0,1] neg_hi:[0,0]
    v_pk_add_f32 v[144:145], v[138:139], v[138:139] op_sel:[0,1] op_sel_hi:[1,0] neg_lo:[0,0] neg_hi:[0,1]
    v_pk_add_f32 v[118:119], v[140:141], v[140:141] op_sel:[0,1] op_sel_hi:[1,0] neg_lo:[1,0] neg_hi:[1,1]
    ds_write_b64 v6, v[36:37] offset:192
    v_pk_add_f32 v[120:121], v[150:151], v[142:143] op_sel:[0,1] op_sel_hi:[1,0] neg_lo:[0,0] neg_hi:[0,1]
    v_pk_add_f32 v[134:135], v[150:151], v[142:143] op_sel:[0,1] op_sel_hi:[1,0] neg_lo:[0,1] neg_hi:[0,0]
    v_pk_add_f32 v[132:133], v[144:145], v[118:119]
    ds_write_b64 v6, v[40:41] offset:224
    v_pk_add_f32 v[136:137], v[144:145], v[118:119] neg_lo:[0,1] neg_hi:[0,1]
    v_pk_fma_f32 v[124:125], v[132:133], s[26:27], v[120:121] neg_lo:[0,0,0] neg_hi:[0,0,0]
    ds_read_b64 v[14:15], v100 offset:0
    v_pk_fma_f32 v[116:117], v[132:133], s[26:27], v[120:121] neg_lo:[1,0,0] neg_hi:[1,0,0]
    v_pk_fma_f32 v[146:147], v[136:137], s[26:27], v[134:135] op_sel:[1,0,0] op_sel_hi:[0,1,1] neg_lo:[0,0,0] neg_hi:[1,0,0]
    ds_read_b64 v[16:17], v100 offset:8
    v_pk_fma_f32 v[148:149], v[136:137], s[26:27], v[134:135] op_sel:[1,0,0] op_sel_hi:[0,1,1] neg_lo:[1,0,0] neg_hi:[0,0,0]
    v_pk_mul_f32 v[130:131], v[124:125], v[76:77] op_sel:[0,0] op_sel_hi:[1,0]
    ds_read_b64 v[30:31], v100 offset:16
    v_pk_mul_f32 v[126:127], v[128:129], v[78:79] op_sel:[0,0] op_sel_hi:[1,0]
    v_pk_mul_f32 v[150:151], v[146:147], v[80:81] op_sel:[0,0] op_sel_hi:[1,0]
    ds_read_b64 v[28:29], v100 offset:24
    v_pk_mul_f32 v[138:139], v[122:123], v[82:83] op_sel:[0,0] op_sel_hi:[1,0]
    v_pk_mul_f32 v[142:143], v[116:117], v[84:85] op_sel:[0,0] op_sel_hi:[1,0]
    ds_read_b64 v[32:33], v100 offset:32
    v_pk_mul_f32 v[140:141], v[112:113], v[86:87] op_sel:[0,0] op_sel_hi:[1,0]
    v_pk_mul_f32 v[144:145], v[148:149], v[88:89] op_sel:[0,0] op_sel_hi:[1,0]
    ds_read_b64 v[20:21], v100 offset:40
    v_pk_fma_f32 v[130:131], v[124:125], v[76:77], v[130:131] op_sel:[1,1,0] op_sel_hi:[0,1,1] neg_lo:[1,0,0] neg_hi:[0,0,0]
    v_pk_fma_f32 v[126:127], v[128:129], v[78:79], v[126:127] op_sel:[1,1,0] op_sel_hi:[0,1,1] neg_lo:[1,0,0] neg_hi:[0,0,0]
    ds_read_b64 v[24:25], v100 offset:48
    v_pk_fma_f32 v[150:151], v[146:147], v[80:81], v[150:151] op_sel:[1,1,0] op_sel_hi:[0,1,1] neg_lo:[1,0,0] neg_hi:[0,0,0]
    v_pk_fma_f32 v[138:139], v[122:123], v[82:83], v[138:139] op_sel:[1,1,0] op_sel_hi:[0,1,1] neg_lo:[1,0,0] neg_hi:[0,0,0]
    ds_read_b64 v[42:43], v100 offset:56
    v_pk_fma_f32 v[142:143], v[116:117], v[84:85], v[142:143] op_sel:[1,1,0] op_sel_hi:[0,1,1] neg_lo:[1,0,0] neg_hi:[0,0,0]
    v_pk_fma_f32 v[140:141], v[112:113], v[86:87], v[140:141] op_sel:[1,1,0] op_sel_hi:[0,1,1] neg_lo:[1,0,0] neg_hi:[0,0,0]
    v_pk_fma_f32 v[144:145], v[148:149], v[88:89], v[144:145] op_sel:[1,1,0] op_sel_hi:[0,1,1] neg_lo:[1,0,0] neg_hi:[0,0,0]
    ds_write_b64 v6, v[114:115] offset:18432
    s_waitcnt lgkmcnt(6)
    v_pk_add_f32 v[18:19], v[14:15], v[30:31]
    v_pk_add_f32 v[12:13], v[14:15], v[30:31] neg_lo:[0,1] neg_hi:[0,1]
    s_waitcnt lgkmcnt(5)
    v_pk_add_f32 v[8:9], v[16:17], v[28:29]
    ds_write_b64 v6, v[130:131] offset:18464
    v_pk_add_f32 v[44:45], v[16:17], v[28:29] neg_lo:[0,1] neg_hi:[0,1]
    v_pk_add_f32 v[10:11], v[18:19], v[8:9]
    v_pk_add_f32 v[26:27], v[18:19], v[8:9] neg_lo:[0,1] neg_hi:[0,1]
    ds_write_b64 v6, v[126:127] offset:18496
    v_pk_add_f32 v[22:23], v[12:13], v[44:45] op_sel:[0,1] op_sel_hi:[1,0] neg_lo:[0,0] neg_hi:[0,1]
    v_pk_add_f32 v[46:47], v[12:13], v[44:45] op_sel:[0,1] op_sel_hi:[1,0] neg_lo:[0,1] neg_hi:[0,0]
    s_waitcnt lgkmcnt(4)
    v_pk_add_f32 v[34:35], v[32:33], v[24:25]
    ds_write_b64 v6, v[150:151] offset:18528
    v_pk_add_f32 v[38:39], v[32:33], v[24:25] neg_lo:[0,1] neg_hi:[0,1]
    s_waitcnt lgkmcnt(4)
    v_pk_add_f32 v[36:37], v[20:21], v[42:43]
    v_pk_add_f32 v[40:41], v[20:21], v[42:43] neg_lo:[0,1] neg_hi:[0,1]
    ds_write_b64 v6, v[138:139] offset:18560
    v_pk_add_f32 v[14:15], v[34:35], v[36:37]
    v_pk_add_f32 v[16:17], v[34:35], v[36:37] neg_lo:[0,1] neg_hi:[0,1]
    v_pk_add_f32 v[30:31], v[38:39], v[40:41] op_sel:[0,1] op_sel_hi:[1,0] neg_lo:[0,0] neg_hi:[0,1]
    ds_write_b64 v6, v[142:143] offset:18592
    v_pk_add_f32 v[28:29], v[38:39], v[40:41] op_sel:[0,1] op_sel_hi:[1,0] neg_lo:[0,1] neg_hi:[0,0]
    v_lshlrev_b32 v18, 16, v92
    v_and_b32 v19, 0xffff0000, v92
    ds_write_b64 v6, v[140:141] offset:18624
    v_lshlrev_b32 v12, 16, v93
    v_and_b32 v13, 0xffff0000, v93
    v_lshlrev_b32 v8, 16, v94
    ds_write_b64 v6, v[144:145] offset:18656
    v_and_b32 v9, 0xffff0000, v94
    v_lshlrev_b32 v44, 16, v95
    ds_read_b64 v[118:119], v100 offset:18432
    v_and_b32 v45, 0xffff0000, v95
    v_pk_mul_f32 v[32:33], v[10:11], v[18:19] op_sel:[0,0] op_sel_hi:[1,0]
    ds_read_b64 v[120:121], v100 offset:18440
    v_pk_mul_f32 v[20:21], v[22:23], v[12:13] op_sel:[0,0] op_sel_hi:[1,0]
    v_pk_mul_f32 v[24:25], v[26:27], v[8:9] op_sel:[0,0] op_sel_hi:[1,0]
    ds_read_b64 v[134:135], v100 offset:18448
    v_pk_mul_f32 v[42:43], v[46:47], v[44:45] op_sel:[0,0] op_sel_hi:[1,0]
    v_pk_fma_f32 v[32:33], v[10:11], v[18:19], v[32:33] op_sel:[1,1,0] op_sel_hi:[0,1,1] neg_lo:[1,0,0] neg_hi:[0,0,0]
    ds_read_b64 v[132:133], v100 offset:18456
    v_pk_fma_f32 v[20:21], v[22:23], v[12:13], v[20:21] op_sel:[1,1,0] op_sel_hi:[0,1,1] neg_lo:[1,0,0] neg_hi:[0,0,0]
    v_pk_fma_f32 v[24:25], v[26:27], v[8:9], v[24:25] op_sel:[1,1,0] op_sel_hi:[0,1,1] neg_lo:[1,0,0] neg_hi:[0,0,0]
    ds_read_b64 v[136:137], v100 offset:18464
    v_pk_fma_f32 v[42:43], v[46:47], v[44:45], v[42:43] op_sel:[1,1,0] op_sel_hi:[0,1,1] neg_lo:[1,0,0] neg_hi:[0,0,0]
    v_lshlrev_b32 v34, 16, v96
    ds_read_b64 v[124:125], v100 offset:18472
    v_and_b32 v35, 0xffff0000, v96
    v_lshlrev_b32 v38, 16, v97
    ds_read_b64 v[128:129], v100 offset:18480
    v_and_b32 v39, 0xffff0000, v97
    v_lshlrev_b32 v36, 16, v98
    ds_read_b64 v[146:147], v100 offset:18488
    v_and_b32 v37, 0xffff0000, v98
    v_lshlrev_b32 v40, 16, v99
    v_and_b32 v41, 0xffff0000, v99
    v_pk_mul_f32 v[10:11], v[14:15], v[34:35] op_sel:[0,0] op_sel_hi:[1,0]
    v_pk_mul_f32 v[22:23], v[30:31], v[38:39] op_sel:[0,0] op_sel_hi:[1,0]
    v_pk_mul_f32 v[26:27], v[16:17], v[36:37] op_sel:[0,0] op_sel_hi:[1,0]
    v_pk_mul_f32 v[46:47], v[28:29], v[40:41] op_sel:[0,0] op_sel_hi:[1,0]
    v_pk_fma_f32 v[10:11], v[14:15], v[34:35], v[10:11] op_sel:[1,1,0] op_sel_hi:[0,1,1] neg_lo:[1,0,0] neg_hi:[0,0,0]
    v_pk_fma_f32 v[22:23], v[30:31], v[38:39], v[22:23] op_sel:[1,1,0] op_sel_hi:[0,1,1] neg_lo:[1,0,0] neg_hi:[0,0,0]
    v_pk_fma_f32 v[26:27], v[16:17], v[36:37], v[26:27] op_sel:[1,1,0] op_sel_hi:[0,1,1] neg_lo:[1,0,0] neg_hi:[0,0,0]
    v_pk_fma_f32 v[46:47], v[28:29], v[40:41], v[46:47] op_sel:[1,1,0] op_sel_hi:[0,1,1] neg_lo:[1,0,0] neg_hi:[0,0,0]
    v_pk_add_f32 v[18:19], v[32:33], v[24:25]
    v_pk_add_f32 v[12:13], v[32:33], v[24:25] neg_lo:[0,1] neg_hi:[0,1]
    v_pk_add_f32 v[8:9], v[20:21], v[42:43]
    v_pk_add_f32 v[44:45], v[20:21], v[42:43] neg_lo:[0,1] neg_hi:[0,1]
    v_pk_add_f32 v[14:15], v[18:19], v[8:9]
    v_pk_add_f32 v[30:31], v[18:19], v[8:9] neg_lo:[0,1] neg_hi:[0,1]
    v_pk_add_f32 v[16:17], v[12:13], v[44:45] op_sel:[0,1] op_sel_hi:[1,0] neg_lo:[0,1] neg_hi:[0,0]
    v_pk_add_f32 v[28:29], v[12:13], v[44:45] op_sel:[0,1] op_sel_hi:[1,0] neg_lo:[0,0] neg_hi:[0,1]
    v_pk_add_f32 v[34:35], v[10:11], v[26:27]
    v_pk_add_f32 v[38:39], v[10:11], v[26:27] neg_lo:[0,1] neg_hi:[0,1]
    v_pk_add_f32 v[36:37], v[22:23], v[46:47]
    v_pk_add_f32 v[40:41], v[22:23], v[46:47] neg_lo:[0,1] neg_hi:[0,1]
    v_pk_add_f32 v[32:33], v[34:35], v[36:37]
    v_pk_add_f32 v[20:21], v[34:35], v[36:37] neg_lo:[0,1] neg_hi:[0,1]
    v_pk_add_f32 v[24:25], v[38:39], v[40:41] op_sel:[0,1] op_sel_hi:[1,0] neg_lo:[0,1] neg_hi:[0,0]
    v_pk_add_f32 v[42:43], v[38:39], v[40:41] op_sel:[0,1] op_sel_hi:[1,0] neg_lo:[0,0] neg_hi:[0,1]
    ds_write_b64 v100, v[14:15] offset:0
    s_waitcnt lgkmcnt(6)
    v_pk_add_f32 v[122:123], v[118:119], v[134:135]
    v_pk_add_f32 v[116:117], v[118:119], v[134:135] neg_lo:[0,1] neg_hi:[0,1]
    s_waitcnt lgkmcnt(5)
    v_pk_add_f32 v[112:113], v[120:121], v[132:133]
    ds_write_b64 v100, v[16:17] offset:8
    v_pk_add_f32 v[148:149], v[120:121], v[132:133] neg_lo:[0,1] neg_hi:[0,1]
    v_pk_add_f32 v[114:115], v[122:123], v[112:113]
    v_pk_add_f32 v[130:131], v[122:123], v[112:113] neg_lo:[0,1] neg_hi:[0,1]
    ds_write_b64 v100, v[30:31] offset:16
    v_pk_add_f32 v[126:127], v[116:117], v[148:149] op_sel:[0,1] op_sel_hi:[1,0] neg_lo:[0,0] neg_hi:[0,1]
    v_pk_add_f32 v[150:151], v[116:117], v[148:149] op_sel:[0,1] op_sel_hi:[1,0] neg_lo:[0,1] neg_hi:[0,0]
    s_waitcnt lgkmcnt(4)
    v_pk_add_f32 v[138:139], v[136:137], v[128:129]
    ds_write_b64 v100, v[28:29] offset:24
    v_pk_add_f32 v[142:143], v[136:137], v[128:129] neg_lo:[0,1] neg_hi:[0,1]
    s_waitcnt lgkmcnt(4)
    v_pk_add_f32 v[140:141], v[124:125], v[146:147]
    v_pk_add_f32 v[144:145], v[124:125], v[146:147] neg_lo:[0,1] neg_hi:[0,1]
    ds_write_b64 v100, v[32:33] offset:32
    v_pk_add_f32 v[118:119], v[138:139], v[140:141]
    v_pk_add_f32 v[120:121], v[138:139], v[140:141] neg_lo:[0,1] neg_hi:[0,1]
    v_pk_add_f32 v[134:135], v[142:143], v[144:145] op_sel:[0,1] op_sel_hi:[1,0] neg_lo:[0,0] neg_hi:[0,1]
    ds_write_b64 v100, v[24:25] offset:40
    v_pk_add_f32 v[132:133], v[142:143], v[144:145] op_sel:[0,1] op_sel_hi:[1,0] neg_lo:[0,1] neg_hi:[0,0]
    v_lshlrev_b32 v122, 16, v104
    v_and_b32 v123, 0xffff0000, v104
    ds_write_b64 v100, v[20:21] offset:48
    v_lshlrev_b32 v116, 16, v105
    v_and_b32 v117, 0xffff0000, v105
    v_lshlrev_b32 v112, 16, v106
    ds_write_b64 v100, v[42:43] offset:56
    v_and_b32 v113, 0xffff0000, v106
    v_lshlrev_b32 v148, 16, v107
    ds_read_b64 v[18:19], v6 offset:0
    v_and_b32 v149, 0xffff0000, v107
    v_pk_mul_f32 v[136:137], v[114:115], v[122:123] op_sel:[0,0] op_sel_hi:[1,0]
    ds_read_b64 v[12:13], v6 offset:32
    v_pk_mul_f32 v[124:125], v[126:127], v[116:117] op_sel:[0,0] op_sel_hi:[1,0]
    v_pk_mul_f32 v[128:129], v[130:131], v[112:113] op_sel:[0,0] op_sel_hi:[1,0]
    ds_read_b64 v[8:9], v6 offset:64
    v_pk_mul_f32 v[146:147], v[150:151], v[148:149] op_sel:[0,0] op_sel_hi:[1,0]
    v_pk_fma_f32 v[136:137], v[114:115], v[122:123], v[136:137] op_sel:[1,1,0] op_sel_hi:[0,1,1] neg_lo:[1,0,0] neg_hi:[0,0,0]
    ds_read_b64 v[44:45], v6 offset:96
    v_pk_fma_f32 v[124:125], v[126:127], v[116:117], v[124:125] op_sel:[1,1,0] op_sel_hi:[0,1,1] neg_lo:[1,0,0] neg_hi:[0,0,0]
    v_pk_fma_f32 v[128:129], v[130:131], v[112:113], v[128:129] op_sel:[1,1,0] op_sel_hi:[0,1,1] neg_lo:[1,0,0] neg_hi:[0,0,0]
    ds_read_b64 v[10:11], v6 offset:128
    v_pk_fma_f32 v[146:147], v[150:151], v[148:149], v[146:147] op_sel:[1,1,0] op_sel_hi:[0,1,1] neg_lo:[1,0,0] neg_hi:[0,0,0]
    v_lshlrev_b32 v138, 16, v108
    ds_read_b64 v[22:23], v6 offset:160
    v_and_b32 v139, 0xffff0000, v108
    v_lshlrev_b32 v142, 16, v109
    ds_read_b64 v[26:27], v6 offset:192
    v_and_b32 v143, 0xffff0000, v109
    v_lshlrev_b32 v140, 16, v110
    ds_read_b64 v[46:47], v6 offset:224
    v_and_b32 v141, 0xffff0000, v110
    v_lshlrev_b32 v144, 16, v111
    v_and_b32 v145, 0xffff0000, v111
    v_pk_mul_f32 v[114:115], v[118:119], v[138:139] op_sel:[0,0] op_sel_hi:[1,0]
    v_pk_mul_f32 v[126:127], v[134:135], v[142:143] op_sel:[0,0] op_sel_hi:[1,0]
    v_pk_mul_f32 v[130:131], v[120:121], v[140:141] op_sel:[0,0] op_sel_hi:[1,0]
    v_pk_mul_f32 v[150:151], v[132:133], v[144:145] op_sel:[0,0] op_sel_hi:[1,0]
    v_pk_fma_f32 v[114:115], v[118:119], v[138:139], v[114:115] op_sel:[1,1,0] op_sel_hi:[0,1,1] neg_lo:[1,0,0] neg_hi:[0,0,0]
    v_pk_fma_f32 v[126:127], v[134:135], v[142:143], v[126:127] op_sel:[1,1,0] op_sel_hi:[0,1,1] neg_lo:[1,0,0] neg_hi:[0,0,0]
    v_pk_fma_f32 v[130:131], v[120:121], v[140:141], v[130:131] op_sel:[1,1,0] op_sel_hi:[0,1,1] neg_lo:[1,0,0] neg_hi:[0,0,0]
    v_pk_fma_f32 v[150:151], v[132:133], v[144:145], v[150:151] op_sel:[1,1,0] op_sel_hi:[0,1,1] neg_lo:[1,0,0] neg_hi:[0,0,0]
    v_pk_add_f32 v[122:123], v[136:137], v[128:129]
    v_pk_add_f32 v[116:117], v[136:137], v[128:129] neg_lo:[0,1] neg_hi:[0,1]
    v_pk_add_f32 v[112:113], v[124:125], v[146:147]
    v_pk_add_f32 v[148:149], v[124:125], v[146:147] neg_lo:[0,1] neg_hi:[0,1]
    v_pk_add_f32 v[118:119], v[122:123], v[112:113]
    v_pk_add_f32 v[134:135], v[122:123], v[112:113] neg_lo:[0,1] neg_hi:[0,1]
    v_pk_add_f32 v[120:121], v[116:117], v[148:149] op_sel:[0,1] op_sel_hi:[1,0] neg_lo:[0,1] neg_hi:[0,0]
    v_pk_add_f32 v[132:133], v[116:117], v[148:149] op_sel:[0,1] op_sel_hi:[1,0] neg_lo:[0,0] neg_hi:[0,1]
    v_pk_add_f32 v[138:139], v[114:115], v[130:131]
    v_pk_add_f32 v[142:143], v[114:115], v[130:131] neg_lo:[0,1] neg_hi:[0,1]
    v_pk_add_f32 v[140:141], v[126:127], v[150:151]
    v_pk_add_f32 v[144:145], v[126:127], v[150:151] neg_lo:[0,1] neg_hi:[0,1]
    v_pk_add_f32 v[136:137], v[138:139], v[140:141]
    v_pk_add_f32 v[124:125], v[138:139], v[140:141] neg_lo:[0,1] neg_hi:[0,1]
    v_pk_add_f32 v[128:129], v[142:143], v[144:145] op_sel:[0,1] op_sel_hi:[1,0] neg_lo:[0,1] neg_hi:[0,0]
    v_pk_add_f32 v[146:147], v[142:143], v[144:145] op_sel:[0,1] op_sel_hi:[1,0] neg_lo:[0,0] neg_hi:[0,1]
    ds_write_b64 v100, v[118:119] offset:18432
    s_waitcnt lgkmcnt(7)
    v_pk_mul_f32 v[34:35], v[12:13], v[76:77] op_sel:[0,0] op_sel_hi:[1,0]
    s_waitcnt lgkmcnt(6)
    v_pk_mul_f32 v[38:39], v[8:9], v[78:79] op_sel:[0,0] op_sel_hi:[1,0]
    s_waitcnt lgkmcnt(5)
    v_pk_mul_f32 v[36:37], v[44:45], v[80:81] op_sel:[0,0] op_sel_hi:[1,0]
    ds_write_b64 v100, v[120:121] offset:18440
    s_waitcnt lgkmcnt(5)
    v_pk_mul_f32 v[40:41], v[10:11], v[82:83] op_sel:[0,0] op_sel_hi:[1,0]
    s_waitcnt lgkmcnt(4)
    v_pk_mul_f32 v[14:15], v[22:23], v[84:85] op_sel:[0,0] op_sel_hi:[1,0]
    s_waitcnt lgkmcnt(3)
    v_pk_mul_f32 v[16:17], v[26:27], v[86:87] op_sel:[0,0] op_sel_hi:[1,0]
    ds_write_b64 v100, v[134:135] offset:18448
    s_waitcnt lgkmcnt(3)
    v_pk_mul_f32 v[30:31], v[46:47], v[88:89] op_sel:[0,0] op_sel_hi:[1,0]
    v_pk_fma_f32 v[34:35], v[12:13], v[76:77], v[34:35] op_sel:[1,1,0] op_sel_hi:[0,1,1] neg_lo:[0,0,0] neg_hi:[1,0,0]
    v_pk_fma_f32 v[38:39], v[8:9], v[78:79], v[38:39] op_sel:[1,1,0] op_sel_hi:[0,1,1] neg_lo:[0,0,0] neg_hi:[1,0,0]
    ds_write_b64 v100, v[132:133] offset:18456
    v_pk_fma_f32 v[36:37], v[44:45], v[80:81], v[36:37] op_sel:[1,1,0] op_sel_hi:[0,1,1] neg_lo:[0,0,0] neg_hi:[1,0,0]
    v_pk_fma_f32 v[40:41], v[10:11], v[82:83], v[40:41] op_sel:[1,1,0] op_sel_hi:[0,1,1] neg_lo:[0,0,0] neg_hi:[1,0,0]
    v_pk_fma_f32 v[14:15], v[22:23], v[84:85], v[14:15] op_sel:[1,1,0] op_sel_hi:[0,1,1] neg_lo:[0,0,0] neg_hi:[1,0,0]
    ds_write_b64 v100, v[136:137] offset:18464
    v_pk_fma_f32 v[16:17], v[26:27], v[86:87], v[16:17] op_sel:[1,1,0] op_sel_hi:[0,1,1] neg_lo:[0,0,0] neg_hi:[1,0,0]
    v_pk_fma_f32 v[30:31], v[46:47], v[88:89], v[30:31] op_sel:[1,1,0] op_sel_hi:[0,1,1] neg_lo:[0,0,0] neg_hi:[1,0,0]
    v_pk_add_f32 v[28:29], v[18:19], v[40:41]
    ds_write_b64 v100, v[128:129] offset:18472
    v_pk_add_f32 v[32:33], v[18:19], v[40:41] neg_lo:[0,1] neg_hi:[0,1]
    v_pk_add_f32 v[24:25], v[34:35], v[14:15]
    v_pk_add_f32 v[20:21], v[34:35], v[14:15] neg_lo:[0,1] neg_hi:[0,1]
    ds_write_b64 v100, v[124:125] offset:18480
    v_pk_add_f32 v[42:43], v[38:39], v[16:17]
    v_pk_add_f32 v[12:13], v[38:39], v[16:17] neg_lo:[0,1] neg_hi:[0,1]
    v_pk_add_f32 v[8:9], v[36:37], v[30:31]
    ds_write_b64 v100, v[146:147] offset:18488
    v_pk_add_f32 v[44:45], v[36:37], v[30:31] neg_lo:[0,1] neg_hi:[0,1]
    v_pk_add_f32 v[10:11], v[28:29], v[42:43]
    ds_read_b64 v[122:123], v6 offset:18432
    v_pk_add_f32 v[22:23], v[28:29], v[42:43] neg_lo:[0,1] neg_hi:[0,1]
    v_pk_add_f32 v[26:27], v[24:25], v[8:9]
    ds_read_b64 v[116:117], v6 offset:18464
    v_pk_add_f32 v[46:47], v[24:25], v[8:9] neg_lo:[0,1] neg_hi:[0,1]
    v_pk_add_f32 v[18:19], v[10:11], v[26:27]
    ds_read_b64 v[112:113], v6 offset:18496
    v_pk_add_f32 v[40:41], v[10:11], v[26:27] neg_lo:[0,1] neg_hi:[0,1]
    v_pk_add_f32 v[34:35], v[22:23], v[46:47] op_sel:[0,1] op_sel_hi:[1,0] neg_lo:[0,1] neg_hi:[0,0]
    ds_read_b64 v[148:149], v6 offset:18528
    v_pk_add_f32 v[14:15], v[22:23], v[46:47] op_sel:[0,1] op_sel_hi:[1,0] neg_lo:[0,0] neg_hi:[0,1]
    v_pk_add_f32 v[38:39], v[20:21], v[20:21] op_sel:[0,1] op_sel_hi:[1,0] neg_lo:[0,1] neg_hi:[0,0]
    ds_read_b64 v[114:115], v6 offset:18560
    v_pk_add_f32 v[16:17], v[44:45], v[44:45] op_sel:[0,1] op_sel_hi:[1,0] neg_lo:[1,1] neg_hi:[1,0]
    v_pk_add_f32 v[36:37], v[32:33], v[12:13] op_sel:[0,1] op_sel_hi:[1,0] neg_lo:[0,1] neg_hi:[0,0]
    ds_read_b64 v[126:127], v6 offset:18592
    v_pk_add_f32 v[30:31], v[32:33], v[12:13] op_sel:[0,1] op_sel_hi:[1,0] neg_lo:[0,0] neg_hi:[0,1]
    v_pk_add_f32 v[28:29], v[38:39], v[16:17]
    ds_read_b64 v[130:131], v6 offset:18624
    v_pk_add_f32 v[24:25], v[38:39], v[16:17] neg_lo:[0,1] neg_hi:[0,1]
    v_pk_fma_f32 v[42:43], v[28:29], s[26:27], v[36:37] neg_lo:[0,0,0] neg_hi:[0,0,0]
    ds_read_b64 v[150:151], v6 offset:18656
    v_pk_fma_f32 v[8:9], v[28:29], s[26:27], v[36:37] neg_lo:[1,0,0] neg_hi:[1,0,0]
    v_pk_fma_f32 v[10:11], v[24:25], s[26:27], v[30:31] op_sel:[1,0,0] op_sel_hi:[0,1,1] neg_lo:[1,0,0] neg_hi:[0,0,0]
    v_pk_fma_f32 v[22:23], v[24:25], s[26:27], v[30:31] op_sel:[1,0,0] op_sel_hi:[0,1,1] neg_lo:[0,0,0] neg_hi:[1,0,0]
    ds_write_b64 v6, v[18:19] offset:0
    s_waitcnt lgkmcnt(7)
    v_pk_mul_f32 v[138:139], v[116:117], v[76:77] op_sel:[0,0] op_sel_hi:[1,0]
    s_waitcnt lgkmcnt(6)
    v_pk_mul_f32 v[142:143], v[112:113], v[78:79] op_sel:[0,0] op_sel_hi:[1,0]
    s_waitcnt lgkmcnt(5)
    v_pk_mul_f32 v[140:141], v[148:149], v[80:81] op_sel:[0,0] op_sel_hi:[1,0]
    ds_write_b64 v6, v[42:43] offset:32
    s_waitcnt lgkmcnt(5)
    v_pk_mul_f32 v[144:145], v[114:115], v[82:83] op_sel:[0,0] op_sel_hi:[1,0]
    s_waitcnt lgkmcnt(4)
    v_pk_mul_f32 v[118:119], v[126:127], v[84:85] op_sel:[0,0] op_sel_hi:[1,0]
    s_waitcnt lgkmcnt(3)
    v_pk_mul_f32 v[120:121], v[130:131], v[86:87] op_sel:[0,0] op_sel_hi:[1,0]
    ds_write_b64 v6, v[34:35] offset:64
    s_waitcnt lgkmcnt(3)
    v_pk_mul_f32 v[134:135], v[150:151], v[88:89] op_sel:[0,0] op_sel_hi:[1,0]
    v_pk_fma_f32 v[138:139], v[116:117], v[76:77], v[138:139] op_sel:[1,1,0] op_sel_hi:[0,1,1] neg_lo:[0,0,0] neg_hi:[1,0,0]
    v_pk_fma_f32 v[142:143], v[112:113], v[78:79], v[142:143] op_sel:[1,1,0] op_sel_hi:[0,1,1] neg_lo:[0,0,0] neg_hi:[1,0,0]
    ds_write_b64 v6, v[10:11] offset:96
    v_pk_fma_f32 v[140:141], v[148:149], v[80:81], v[140:141] op_sel:[1,1,0] op_sel_hi:[0,1,1] neg_lo:[0,0,0] neg_hi:[1,0,0]
    v_pk_fma_f32 v[144:145], v[114:115], v[82:83], v[144:145] op_sel:[1,1,0] op_sel_hi:[0,1,1] neg_lo:[0,0,0] neg_hi:[1,0,0]
    v_pk_fma_f32 v[118:119], v[126:127], v[84:85], v[118:119] op_sel:[1,1,0] op_sel_hi:[0,1,1] neg_lo:[0,0,0] neg_hi:[1,0,0]
    ds_write_b64 v6, v[40:41] offset:128
    v_pk_fma_f32 v[120:121], v[130:131], v[86:87], v[120:121] op_sel:[1,1,0] op_sel_hi:[0,1,1] neg_lo:[0,0,0] neg_hi:[1,0,0]
    v_pk_fma_f32 v[134:135], v[150:151], v[88:89], v[134:135] op_sel:[1,1,0] op_sel_hi:[0,1,1] neg_lo:[0,0,0] neg_hi:[1,0,0]
    v_pk_add_f32 v[132:133], v[122:123], v[144:145]
    ds_write_b64 v6, v[8:9] offset:160
    v_pk_add_f32 v[136:137], v[122:123], v[144:145] neg_lo:[0,1] neg_hi:[0,1]
    v_pk_add_f32 v[128:129], v[138:139], v[118:119]
    v_pk_add_f32 v[124:125], v[138:139], v[118:119] neg_lo:[0,1] neg_hi:[0,1]
    ds_write_b64 v6, v[14:15] offset:192
    v_pk_add_f32 v[146:147], v[142:143], v[120:121]
    v_pk_add_f32 v[116:117], v[142:143], v[120:121] neg_lo:[0,1] neg_hi:[0,1]
    v_pk_add_f32 v[112:113], v[140:141], v[134:135]
    ds_write_b64 v6, v[22:23] offset:224
    v_pk_add_f32 v[148:149], v[140:141], v[134:135] neg_lo:[0,1] neg_hi:[0,1]
    v_pk_add_f32 v[114:115], v[132:133], v[146:147]
    ds_read_b64 v[26:27], v5 offset:0
    v_pk_add_f32 v[126:127], v[132:133], v[146:147] neg_lo:[0,1] neg_hi:[0,1]
    v_pk_add_f32 v[130:131], v[128:129], v[112:113]
    ds_read_b64 v[46:47], v5 offset:288
    v_pk_add_f32 v[150:151], v[128:129], v[112:113] neg_lo:[0,1] neg_hi:[0,1]
    v_pk_add_f32 v[122:123], v[114:115], v[130:131]
    ds_read_b64 v[32:33], v5 offset:576
    v_pk_add_f32 v[144:145], v[114:115], v[130:131] neg_lo:[0,1] neg_hi:[0,1]
    v_pk_add_f32 v[138:139], v[126:127], v[150:151] op_sel:[0,1] op_sel_hi:[1,0] neg_lo:[0,1] neg_hi:[0,0]
    ds_read_b64 v[20:21], v5 offset:864
    v_pk_add_f32 v[118:119], v[126:127], v[150:151] op_sel:[0,1] op_sel_hi:[1,0] neg_lo:[0,0] neg_hi:[0,1]
    v_pk_add_f32 v[142:143], v[124:125], v[124:125] op_sel:[0,1] op_sel_hi:[1,0] neg_lo:[0,1] neg_hi:[0,0]
    ds_read_b64 v[12:13], v5 offset:1152
    v_pk_add_f32 v[120:121], v[148:149], v[148:149] op_sel:[0,1] op_sel_hi:[1,0] neg_lo:[1,1] neg_hi:[1,0]
    v_pk_add_f32 v[140:141], v[136:137], v[116:117] op_sel:[0,1] op_sel_hi:[1,0] neg_lo:[0,1] neg_hi:[0,0]
    ds_read_b64 v[44:45], v5 offset:1440
    v_pk_add_f32 v[134:135], v[136:137], v[116:117] op_sel:[0,1] op_sel_hi:[1,0] neg_lo:[0,0] neg_hi:[0,1]
    v_pk_add_f32 v[132:133], v[142:143], v[120:121]
    ds_read_b64 v[38:39], v5 offset:1728
    v_pk_add_f32 v[128:129], v[142:143], v[120:121] neg_lo:[0,1] neg_hi:[0,1]
    v_pk_fma_f32 v[146:147], v[132:133], s[26:27], v[140:141] neg_lo:[0,0,0] neg_hi:[0,0,0]
    ds_read_b64 v[16:17], v5 offset:2016
    v_pk_fma_f32 v[112:113], v[132:133], s[26:27], v[140:141] neg_lo:[1,0,0] neg_hi:[1,0,0]
    v_pk_fma_f32 v[114:115], v[128:129], s[26:27], v[134:135] op_sel:[1,0,0] op_sel_hi:[0,1,1] neg_lo:[1,0,0] neg_hi:[0,0,0]
    v_pk_fma_f32 v[126:127], v[128:129], s[26:27], v[134:135] op_sel:[1,0,0] op_sel_hi:[0,1,1] neg_lo:[0,0,0] neg_hi:[1,0,0]
    ds_write_b64 v6, v[122:123] offset:18432
    s_waitcnt lgkmcnt(7)
    v_pk_mul_f32 v[36:37], v[46:47], v[62:63] op_sel:[0,0] op_sel_hi:[1,0]
    s_waitcnt lgkmcnt(6)
    v_pk_mul_f32 v[30:31], v[32:33], v[64:65] op_sel:[0,0] op_sel_hi:[1,0]
    s_waitcnt lgkmcnt(5)
    v_pk_mul_f32 v[28:29], v[20:21], v[66:67] op_sel:[0,0] op_sel_hi:[1,0]
    ds_write_b64 v6, v[146:147] offset:18464
    s_waitcnt lgkmcnt(5)
    v_pk_mul_f32 v[24:25], v[12:13], v[68:69] op_sel:[0,0] op_sel_hi:[1,0]
    s_waitcnt lgkmcnt(4)
    v_pk_mul_f32 v[18:19], v[44:45], v[70:71] op_sel:[0,0] op_sel_hi:[1,0]
    s_waitcnt lgkmcnt(3)
    v_pk_mul_f32 v[42:43], v[38:39], v[72:73] op_sel:[0,0] op_sel_hi:[1,0]
    ds_write_b64 v6, v[138:139] offset:18496
    s_waitcnt lgkmcnt(3)
    v_pk_mul_f32 v[34:35], v[16:17], v[74:75] op_sel:[0,0] op_sel_hi:[1,0]
    v_pk_fma_f32 v[36:37], v[46:47], v[62:63], v[36:37] op_sel:[1,1,0] op_sel_hi:[0,1,1] neg_lo:[0,0,0] neg_hi:[1,0,0]
    v_pk_fma_f32 v[30:31], v[32:33], v[64:65], v[30:31] op_sel:[1,1,0] op_sel_hi:[0,1,1] neg_lo:[0,0,0] neg_hi:[1,0,0]
    ds_write_b64 v6, v[114:115] offset:18528
    v_pk_fma_f32 v[28:29], v[20:21], v[66:67], v[28:29] op_sel:[1,1,0] op_sel_hi:[0,1,1] neg_lo:[0,0,0] neg_hi:[1,0,0]
    v_pk_fma_f32 v[24:25], v[12:13], v[68:69], v[24:25] op_sel:[1,1,0] op_sel_hi:[0,1,1] neg_lo:[0,0,0] neg_hi:[1,0,0]
    v_pk_fma_f32 v[18:19], v[44:45], v[70:71], v[18:19] op_sel:[1,1,0] op_sel_hi:[0,1,1] neg_lo:[0,0,0] neg_hi:[1,0,0]
    ds_write_b64 v6, v[144:145] offset:18560
    v_pk_fma_f32 v[42:43], v[38:39], v[72:73], v[42:43] op_sel:[1,1,0] op_sel_hi:[0,1,1] neg_lo:[0,0,0] neg_hi:[1,0,0]
    v_pk_fma_f32 v[34:35], v[16:17], v[74:75], v[34:35] op_sel:[1,1,0] op_sel_hi:[0,1,1] neg_lo:[0,0,0] neg_hi:[1,0,0]
    v_pk_add_f32 v[10:11], v[26:27], v[24:25]
    ds_write_b64 v6, v[112:113] offset:18592
    v_pk_add_f32 v[40:41], v[26:27], v[24:25] neg_lo:[0,1] neg_hi:[0,1]
    v_pk_add_f32 v[8:9], v[36:37], v[18:19]
    v_pk_add_f32 v[14:15], v[36:37], v[18:19] neg_lo:[0,1] neg_hi:[0,1]
    ds_write_b64 v6, v[118:119] offset:18624
    v_pk_add_f32 v[22:23], v[30:31], v[42:43]
    v_pk_add_f32 v[46:47], v[30:31], v[42:43] neg_lo:[0,1] neg_hi:[0,1]
    v_pk_add_f32 v[32:33], v[28:29], v[34:35]
    ds_write_b64 v6, v[126:127] offset:18656
    v_pk_add_f32 v[20:21], v[28:29], v[34:35] neg_lo:[0,1] neg_hi:[0,1]
    v_pk_add_f32 v[12:13], v[10:11], v[22:23]
    ds_read_b64 v[130:131], v5 offset:18432
    v_pk_add_f32 v[44:45], v[10:11], v[22:23] neg_lo:[0,1] neg_hi:[0,1]
    v_pk_add_f32 v[38:39], v[8:9], v[32:33]
    ds_read_b64 v[150:151], v5 offset:18720
    v_pk_add_f32 v[16:17], v[8:9], v[32:33] neg_lo:[0,1] neg_hi:[0,1]
    v_pk_add_f32 v[26:27], v[12:13], v[38:39]
    ds_read_b64 v[136:137], v5 offset:19008
    v_pk_add_f32 v[24:25], v[12:13], v[38:39] neg_lo:[0,1] neg_hi:[0,1]
    v_pk_add_f32 v[36:37], v[44:45], v[16:17] op_sel:[0,1] op_sel_hi:[1,0] neg_lo:[0,1] neg_hi:[0,0]
    ds_read_b64 v[124:125], v5 offset:19296
    v_pk_add_f32 v[18:19], v[44:45], v[16:17] op_sel:[0,1] op_sel_hi:[1,0] neg_lo:[0,0] neg_hi:[0,1]
    v_pk_add_f32 v[30:31], v[14:15], v[14:15] op_sel:[0,1] op_sel_hi:[1,0] neg_lo:[0,1] neg_hi:[0,0]
    ds_read_b64 v[116:117], v5 offset:19584
    v_pk_add_f32 v[42:43], v[20:21], v[20:21] op_sel:[0,1] op_sel_hi:[1,0] neg_lo:[1,1] neg_hi:[1,0]
    v_pk_add_f32 v[28:29], v[40:41], v[46:47] op_sel:[0,1] op_sel_hi:[1,0] neg_lo:[0,1] neg_hi:[0,0]
    ds_read_b64 v[148:149], v5 offset:19872
    v_pk_add_f32 v[34:35], v[40:41], v[46:47] op_sel:[0,1] op_sel_hi:[1,0] neg_lo:[0,0] neg_hi:[0,1]
    v_pk_add_f32 v[10:11], v[30:31], v[42:43]
    ds_read_b64 v[142:143], v5 offset:20160
    v_pk_add_f32 v[8:9], v[30:31], v[42:43] neg_lo:[0,1] neg_hi:[0,1]
    v_pk_fma_f32 v[22:23], v[10:11], s[26:27], v[28:29] neg_lo:[0,0,0] neg_hi:[0,0,0]
    ds_read_b64 v[120:121], v5 offset:20448
    v_pk_fma_f32 v[32:33], v[10:11], s[26:27], v[28:29] neg_lo:[1,0,0] neg_hi:[1,0,0]
    v_pk_fma_f32 v[12:13], v[8:9], s[26:27], v[34:35] op_sel:[1,0,0] op_sel_hi:[0,1,1] neg_lo:[1,0,0] neg_hi:[0,0,0]
    v_pk_fma_f32 v[44:45], v[8:9], s[26:27], v[34:35] op_sel:[1,0,0] op_sel_hi:[0,1,1] neg_lo:[0,0,0] neg_hi:[1,0,0]
    ds_write_b64 v5, v[26:27] offset:0
    s_waitcnt lgkmcnt(7)
    v_pk_mul_f32 v[140:141], v[150:151], v[62:63] op_sel:[0,0] op_sel_hi:[1,0]
    s_waitcnt lgkmcnt(6)
    v_pk_mul_f32 v[134:135], v[136:137], v[64:65] op_sel:[0,0] op_sel_hi:[1,0]
    s_waitcnt lgkmcnt(5)
    v_pk_mul_f32 v[132:133], v[124:125], v[66:67] op_sel:[0,0] op_sel_hi:[1,0]
    ds_write_b64 v5, v[22:23] offset:256
    s_waitcnt lgkmcnt(5)
    v_pk_mul_f32 v[128:129], v[116:117], v[68:69] op_sel:[0,0] op_sel_hi:[1,0]
    s_waitcnt lgkmcnt(4)
    v_pk_mul_f32 v[122:123], v[148:149], v[70:71] op_sel:[0,0] op_sel_hi:[1,0]
    s_waitcnt lgkmcnt(3)
    v_pk_mul_f32 v[146:147], v[142:143], v[72:73] op_sel:[0,0] op_sel_hi:[1,0]
    ds_write_b64 v5, v[36:37] offset:512
    s_waitcnt lgkmcnt(3)
    v_pk_mul_f32 v[138:139], v[120:121], v[74:75] op_sel:[0,0] op_sel_hi:[1,0]
    v_pk_fma_f32 v[140:141], v[150:151], v[62:63], v[140:141] op_sel:[1,1,0] op_sel_hi:[0,1,1] neg_lo:[0,0,0] neg_hi:[1,0,0]
    v_pk_fma_f32 v[134:135], v[136:137], v[64:65], v[134:135] op_sel:[1,1,0] op_sel_hi:[0,1,1] neg_lo:[0,0,0] neg_hi:[1,0,0]
    ds_write_b64 v5, v[12:13] offset:768
    v_pk_fma_f32 v[132:133], v[124:125], v[66:67], v[132:133] op_sel:[1,1,0] op_sel_hi:[0,1,1] neg_lo:[0,0,0] neg_hi:[1,0,0]
    v_pk_fma_f32 v[128:129], v[116:117], v[68:69], v[128:129] op_sel:[1,1,0] op_sel_hi:[0,1,1] neg_lo:[0,0,0] neg_hi:[1,0,0]
    v_pk_fma_f32 v[122:123], v[148:149], v[70:71], v[122:123] op_sel:[1,1,0] op_sel_hi:[0,1,1] neg_lo:[0,0,0] neg_hi:[1,0,0]
    ds_write_b64 v5, v[24:25] offset:1024
    v_pk_fma_f32 v[146:147], v[142:143], v[72:73], v[146:147] op_sel:[1,1,0] op_sel_hi:[0,1,1] neg_lo:[0,0,0] neg_hi:[1,0,0]
    v_pk_fma_f32 v[138:139], v[120:121], v[74:75], v[138:139] op_sel:[1,1,0] op_sel_hi:[0,1,1] neg_lo:[0,0,0] neg_hi:[1,0,0]
    v_pk_add_f32 v[114:115], v[130:131], v[128:129]
    ds_write_b64 v5, v[32:33] offset:1280
    v_pk_add_f32 v[144:145], v[130:131], v[128:129] neg_lo:[0,1] neg_hi:[0,1]
    v_pk_add_f32 v[112:113], v[140:141], v[122:123]
    v_pk_add_f32 v[118:119], v[140:141], v[122:123] neg_lo:[0,1] neg_hi:[0,1]
    ds_write_b64 v5, v[18:19] offset:1536
    v_pk_add_f32 v[126:127], v[134:135], v[146:147]
    v_pk_add_f32 v[150:151], v[134:135], v[146:147] neg_lo:[0,1] neg_hi:[0,1]
    v_pk_add_f32 v[136:137], v[132:133], v[138:139]
    ds_write_b64 v5, v[44:45] offset:1792
    v_pk_add_f32 v[124:125], v[132:133], v[138:139] neg_lo:[0,1] neg_hi:[0,1]
    v_pk_add_f32 v[116:117], v[114:115], v[126:127]
    v_pk_add_f32 v[148:149], v[114:115], v[126:127] neg_lo:[0,1] neg_hi:[0,1]
    v_pk_add_f32 v[142:143], v[112:113], v[136:137]
    v_pk_add_f32 v[120:121], v[112:113], v[136:137] neg_lo:[0,1] neg_hi:[0,1]
    v_pk_add_f32 v[130:131], v[116:117], v[142:143]
    v_pk_add_f32 v[128:129], v[116:117], v[142:143] neg_lo:[0,1] neg_hi:[0,1]
    v_pk_add_f32 v[140:141], v[148:149], v[120:121] op_sel:[0,1] op_sel_hi:[1,0] neg_lo:[0,1] neg_hi:[0,0]
    v_pk_add_f32 v[122:123], v[148:149], v[120:121] op_sel:[0,1] op_sel_hi:[1,0] neg_lo:[0,0] neg_hi:[0,1]
    v_pk_add_f32 v[134:135], v[118:119], v[118:119] op_sel:[0,1] op_sel_hi:[1,0] neg_lo:[0,1] neg_hi:[0,0]
    v_pk_add_f32 v[146:147], v[124:125], v[124:125] op_sel:[0,1] op_sel_hi:[1,0] neg_lo:[1,1] neg_hi:[1,0]
    v_pk_add_f32 v[132:133], v[144:145], v[150:151] op_sel:[0,1] op_sel_hi:[1,0] neg_lo:[0,1] neg_hi:[0,0]
    v_pk_add_f32 v[138:139], v[144:145], v[150:151] op_sel:[0,1] op_sel_hi:[1,0] neg_lo:[0,0] neg_hi:[0,1]
    v_pk_add_f32 v[114:115], v[134:135], v[146:147]
    v_pk_add_f32 v[112:113], v[134:135], v[146:147] neg_lo:[0,1] neg_hi:[0,1]
    v_pk_fma_f32 v[126:127], v[114:115], s[26:27], v[132:133] neg_lo:[0,0,0] neg_hi:[0,0,0]
    v_pk_fma_f32 v[136:137], v[114:115], s[26:27], v[132:133] neg_lo:[1,0,0] neg_hi:[1,0,0]
    v_pk_fma_f32 v[116:117], v[112:113], s[26:27], v[138:139] op_sel:[1,0,0] op_sel_hi:[0,1,1] neg_lo:[1,0,0] neg_hi:[0,0,0]
    v_pk_fma_f32 v[148:149], v[112:113], s[26:27], v[138:139] op_sel:[1,0,0] op_sel_hi:[0,1,1] neg_lo:[0,0,0] neg_hi:[1,0,0]
    ds_write_b64 v5, v[130:131] offset:18432
    ds_write_b64 v5, v[126:127] offset:18688
    ds_write_b64 v5, v[140:141] offset:18944
    ds_write_b64 v5, v[116:117] offset:19200
    ds_write_b64 v5, v[128:129] offset:19456
    ds_write_b64 v5, v[136:137] offset:19712
    ds_write_b64 v5, v[122:123] offset:19968
    ds_write_b64 v5, v[148:149] offset:20224
    s_waitcnt lgkmcnt(0)
    s_barrier
    ds_read_b64 v[38:39], v3 offset:0
    ds_read_b64 v[16:17], v3 offset:2304
    ds_read_b64 v[40:41], v3 offset:4608
    ds_read_b64 v[14:15], v3 offset:6912
    ds_read_b64 v[46:47], v3 offset:9216
    ds_read_b64 v[20:21], v3 offset:11520
    ds_read_b64 v[30:31], v3 offset:13824
    ds_read_b64 v[42:43], v3 offset:16128
    ds_read_b64 v[142:143], v3 offset:18432
    ds_read_b64 v[120:121], v3 offset:20736
    ds_read_b64 v[144:145], v3 offset:23040
    ds_read_b64 v[118:119], v3 offset:25344
    ds_read_b64 v[150:151], v3 offset:27648
    ds_read_b64 v[124:125], v3 offset:29952
    ds_read_b64 v[134:135], v3 offset:32256
    ds_read_b64 v[146:147], v3 offset:34560
    s_waitcnt lgkmcnt(14)
    v_pk_mul_f32 v[28:29], v[16:17], v[48:49] op_sel:[0,0] op_sel_hi:[1,0]
    s_waitcnt lgkmcnt(13)
    v_pk_mul_f32 v[34:35], v[40:41], v[50:51] op_sel:[0,0] op_sel_hi:[1,0]
    s_waitcnt lgkmcnt(12)
    v_pk_mul_f32 v[10:11], v[14:15], v[52:53] op_sel:[0,0] op_sel_hi:[1,0]
    s_waitcnt lgkmcnt(11)
    v_pk_mul_f32 v[8:9], v[46:47], v[54:55] op_sel:[0,0] op_sel_hi:[1,0]
    s_waitcnt lgkmcnt(10)
    v_pk_mul_f32 v[26:27], v[20:21], v[56:57] op_sel:[0,0] op_sel_hi:[1,0]
    s_waitcnt lgkmcnt(9)
    v_pk_mul_f32 v[22:23], v[30:31], v[58:59] op_sel:[0,0] op_sel_hi:[1,0]
    s_waitcnt lgkmcnt(8)
    v_pk_mul_f32 v[36:37], v[42:43], v[60:61] op_sel:[0,0] op_sel_hi:[1,0]
    v_pk_fma_f32 v[28:29], v[16:17], v[48:49], v[28:29] op_sel:[1,1,0] op_sel_hi:[0,1,1] neg_lo:[0,0,0] neg_hi:[1,0,0]
    v_pk_fma_f32 v[34:35], v[40:41], v[50:51], v[34:35] op_sel:[1,1,0] op_sel_hi:[0,1,1] neg_lo:[0,0,0] neg_hi:[1,0,0]
    v_pk_fma_f32 v[10:11], v[14:15], v[52:53], v[10:11] op_sel:[1,1,0] op_sel_hi:[0,1,1] neg_lo:[0,0,0] neg_hi:[1,0,0]
    v_pk_fma_f32 v[8:9], v[46:47], v[54:55], v[8:9] op_sel:[1,1,0] op_sel_hi:[0,1,1] neg_lo:[0,0,0] neg_hi:[1,0,0]
    v_pk_fma_f32 v[26:27], v[20:21], v[56:57], v[26:27] op_sel:[1,1,0] op_sel_hi:[0,1,1] neg_lo:[0,0,0] neg_hi:[1,0,0]
    v_pk_fma_f32 v[22:23], v[30:31], v[58:59], v[22:23] op_sel:[1,1,0] op_sel_hi:[0,1,1] neg_lo:[0,0,0] neg_hi:[1,0,0]
    v_pk_fma_f32 v[36:37], v[42:43], v[60:61], v[36:37] op_sel:[1,1,0] op_sel_hi:[0,1,1] neg_lo:[0,0,0] neg_hi:[1,0,0]
    v_pk_add_f32 v[12:13], v[38:39], v[8:9]
    v_pk_add_f32 v[24:25], v[38:39], v[8:9] neg_lo:[0,1] neg_hi:[0,1]
    v_pk_add_f32 v[32:33], v[28:29], v[26:27]
    v_pk_add_f32 v[18:19], v[28:29], v[26:27] neg_lo:[0,1] neg_hi:[0,1]
    v_pk_add_f32 v[44:45], v[34:35], v[22:23]
    v_pk_add_f32 v[16:17], v[34:35], v[22:23] neg_lo:[0,1] neg_hi:[0,1]
    v_pk_add_f32 v[40:41], v[10:11], v[36:37]
    v_pk_add_f32 v[14:15], v[10:11], v[36:37] neg_lo:[0,1] neg_hi:[0,1]
    v_pk_add_f32 v[46:47], v[12:13], v[44:45]
    v_pk_add_f32 v[20:21], v[12:13], v[44:45] neg_lo:[0,1] neg_hi:[0,1]
    v_pk_add_f32 v[30:31], v[32:33], v[40:41]
    v_pk_add_f32 v[42:43], v[32:33], v[40:41] neg_lo:[0,1] neg_hi:[0,1]
    v_pk_add_f32 v[38:39], v[46:47], v[30:31]
    v_pk_add_f32 v[8:9], v[46:47], v[30:31] neg_lo:[0,1] neg_hi:[0,1]
    v_pk_add_f32 v[28:29], v[20:21], v[42:43] op_sel:[0,1] op_sel_hi:[1,0] neg_lo:[0,1] neg_hi:[0,0]
    v_pk_add_f32 v[26:27], v[20:21], v[42:43] op_sel:[0,1] op_sel_hi:[1,0] neg_lo:[0,0] neg_hi:[0,1]
    v_pk_add_f32 v[34:35], v[18:19], v[18:19] op_sel:[0,1] op_sel_hi:[1,0] neg_lo:[0,1] neg_hi:[0,0]
    v_pk_add_f32 v[22:23], v[14:15], v[14:15] op_sel:[0,1] op_sel_hi:[1,0] neg_lo:[1,1] neg_hi:[1,0]
    v_pk_add_f32 v[10:11], v[24:25], v[16:17] op_sel:[0,1] op_sel_hi:[1,0] neg_lo:[0,1] neg_hi:[0,0]
    v_pk_add_f32 v[36:37], v[24:25], v[16:17] op_sel:[0,1] op_sel_hi:[1,0] neg_lo:[0,0] neg_hi:[0,1]
    v_pk_add_f32 v[12:13], v[34:35], v[22:23]
    v_pk_add_f32 v[32:33], v[34:35], v[22:23] neg_lo:[0,1] neg_hi:[0,1]
    v_pk_fma_f32 v[44:45], v[12:13], s[26:27], v[10:11] neg_lo:[0,0,0] neg_hi:[0,0,0]
    v_pk_fma_f32 v[40:41], v[12:13], s[26:27], v[10:11] neg_lo:[1,0,0] neg_hi:[1,0,0]
    v_pk_fma_f32 v[46:47], v[32:33], s[26:27], v[36:37] op_sel:[1,0,0] op_sel_hi:[0,1,1] neg_lo:[1,0,0] neg_hi:[0,0,0]
    v_pk_fma_f32 v[20:21], v[32:33], s[26:27], v[36:37] op_sel:[1,0,0] op_sel_hi:[0,1,1] neg_lo:[0,0,0] neg_hi:[1,0,0]
    s_waitcnt lgkmcnt(6)
    v_pk_mul_f32 v[132:133], v[120:121], v[48:49] op_sel:[0,0] op_sel_hi:[1,0]
    s_waitcnt lgkmcnt(5)
    v_pk_mul_f32 v[138:139], v[144:145], v[50:51] op_sel:[0,0] op_sel_hi:[1,0]
    s_waitcnt lgkmcnt(4)
    v_pk_mul_f32 v[114:115], v[118:119], v[52:53] op_sel:[0,0] op_sel_hi:[1,0]
    s_waitcnt lgkmcnt(3)
    v_pk_mul_f32 v[112:113], v[150:151], v[54:55] op_sel:[0,0] op_sel_hi:[1,0]
    s_waitcnt lgkmcnt(2)
    v_pk_mul_f32 v[130:131], v[124:125], v[56:57] op_sel:[0,0] op_sel_hi:[1,0]
    s_waitcnt lgkmcnt(1)
    v_pk_mul_f32 v[126:127], v[134:135], v[58:59] op_sel:[0,0] op_sel_hi:[1,0]
    s_waitcnt lgkmcnt(0)
    v_pk_mul_f32 v[140:141], v[146:147], v[60:61] op_sel:[0,0] op_sel_hi:[1,0]
    v_pk_fma_f32 v[132:133], v[120:121], v[48:49], v[132:133] op_sel:[1,1,0] op_sel_hi:[0,1,1] neg_lo:[0,0,0] neg_hi:[1,0,0]
    v_pk_fma_f32 v[138:139], v[144:145], v[50:51], v[138:139] op_sel:[1,1,0] op_sel_hi:[0,1,1] neg_lo:[0,0,0] neg_hi:[1,0,0]
    v_pk_fma_f32 v[114:115], v[118:119], v[52:53], v[114:115] op_sel:[1,1,0] op_sel_hi:[0,1,1] neg_lo:[0,0,0] neg_hi:[1,0,0]
    v_pk_fma_f32 v[112:113], v[150:151], v[54:55], v[112:113] op_sel:[1,1,0] op_sel_hi:[0,1,1] neg_lo:[0,0,0] neg_hi:[1,0,0]
    v_pk_fma_f32 v[130:131], v[124:125], v[56:57], v[130:131] op_sel:[1,1,0] op_sel_hi:[0,1,1] neg_lo:[0,0,0] neg_hi:[1,0,0]
    v_pk_fma_f32 v[126:127], v[134:135], v[58:59], v[126:127] op_sel:[1,1,0] op_sel_hi:[0,1,1] neg_lo:[0,0,0] neg_hi:[1,0,0]
    v_pk_fma_f32 v[140:141], v[146:147], v[60:61], v[140:141] op_sel:[1,1,0] op_sel_hi:[0,1,1] neg_lo:[0,0,0] neg_hi:[1,0,0]
    v_pk_add_f32 v[116:117], v[142:143], v[112:113]
    v_pk_add_f32 v[128:129], v[142:143], v[112:113] neg_lo:[0,1] neg_hi:[0,1]
    v_pk_add_f32 v[136:137], v[132:133], v[130:131]
    v_pk_add_f32 v[122:123], v[132:133], v[130:131] neg_lo:[0,1] neg_hi:[0,1]
    v_pk_add_f32 v[148:149], v[138:139], v[126:127]
    v_pk_add_f32 v[120:121], v[138:139], v[126:127] neg_lo:[0,1] neg_hi:[0,1]
    v_pk_add_f32 v[144:145], v[114:115], v[140:141]
    v_pk_add_f32 v[118:119], v[114:115], v[140:141] neg_lo:[0,1] neg_hi:[0,1]
    v_pk_add_f32 v[150:151], v[116:117], v[148:149]
    v_pk_add_f32 v[124:125], v[116:117], v[148:149] neg_lo:[0,1] neg_hi:[0,1]
    v_pk_add_f32 v[134:135], v[136:137], v[144:145]
    v_pk_add_f32 v[146:147], v[136:137], v[144:145] neg_lo:[0,1] neg_hi:[0,1]
    v_pk_add_f32 v[142:143], v[150:151], v[134:135]
    v_pk_add_f32 v[112:113], v[150:151], v[134:135] neg_lo:[0,1] neg_hi:[0,1]
    v_pk_add_f32 v[132:133], v[124:125], v[146:147] op_sel:[0,1] op_sel_hi:[1,0] neg_lo:[0,1] neg_hi:[0,0]
    v_pk_add_f32 v[130:131], v[124:125], v[146:147] op_sel:[0,1] op_sel_hi:[1,0] neg_lo:[0,0] neg_hi:[0,1]
    v_pk_add_f32 v[138:139], v[122:123], v[122:123] op_sel:[0,1] op_sel_hi:[1,0] neg_lo:[0,1] neg_hi:[0,0]
    v_pk_add_f32 v[126:127], v[118:119], v[118:119] op_sel:[0,1] op_sel_hi:[1,0] neg_lo:[1,1] neg_hi:[1,0]
    v_pk_add_f32 v[114:115], v[128:129], v[120:121] op_sel:[0,1] op_sel_hi:[1,0] neg_lo:[0,1] neg_hi:[0,0]
    v_pk_add_f32 v[140:141], v[128:129], v[120:121] op_sel:[0,1] op_sel_hi:[1,0] neg_lo:[0,0] neg_hi:[0,1]
    v_pk_add_f32 v[116:117], v[138:139], v[126:127]
    v_pk_add_f32 v[136:137], v[138:139], v[126:127] neg_lo:[0,1] neg_hi:[0,1]
    v_pk_fma_f32 v[148:149], v[116:117], s[26:27], v[114:115] neg_lo:[0,0,0] neg_hi:[0,0,0]
    v_pk_fma_f32 v[144:145], v[116:117], s[26:27], v[114:115] neg_lo:[1,0,0] neg_hi:[1,0,0]
    v_pk_fma_f32 v[150:151], v[136:137], s[26:27], v[140:141] op_sel:[1,0,0] op_sel_hi:[0,1,1] neg_lo:[1,0,0] neg_hi:[0,0,0]
    v_pk_fma_f32 v[124:125], v[136:137], s[26:27], v[140:141] op_sel:[1,0,0] op_sel_hi:[0,1,1] neg_lo:[0,0,0] neg_hi:[1,0,0]
    s_mul_i32 s22, s101, 3145728
    s_add_u32 s22, s22, 157286400
    s_lshl_b32 s21, s2, 14
    s_add_u32 s21, s21, s22
    s_cmp_eq_u32 s2, 0
    s_cbranch_scc1 M_fft_c0
    v_cvt_pk_bf16_f32 v38, v38, v39
    v_cvt_pk_bf16_f32 v39, v142, v143
    v_cvt_pk_bf16_f32 v44, v44, v45
    v_cvt_pk_bf16_f32 v45, v148, v149
    v_cvt_pk_bf16_f32 v28, v28, v29
    v_cvt_pk_bf16_f32 v29, v132, v133
    v_cvt_pk_bf16_f32 v46, v46, v47
    v_cvt_pk_bf16_f32 v47, v150, v151
    v_cvt_pk_bf16_f32 v8, v8, v9
    v_cvt_pk_bf16_f32 v9, v112, v113
    v_cvt_pk_bf16_f32 v40, v40, v41
    v_cvt_pk_bf16_f32 v41, v144, v145
    v_cvt_pk_bf16_f32 v26, v26, v27
    v_cvt_pk_bf16_f32 v27, v130, v131
    v_cvt_pk_bf16_f32 v20, v20, v21
    v_cvt_pk_bf16_f32 v21, v124, v125
    s_cmp_eq_u32 s2, 160
    s_cbranch_scc1 M_fft_c1
    buffer_store_dwordx2 v[38:39], v101, s[8:11], s21 offen offset:0 sc1
    buffer_store_dwordx2 v[44:45], v101, s[8:11], s21 offen offset:2048 sc1
    s_add_u32 s21, s21, 4096
    buffer_store_dwordx2 v[28:29], v101, s[8:11], s21 offen offset:0 sc1
    buffer_store_dwordx2 v[46:47], v101, s[8:11], s21 offen offset:2048 sc1
    s_add_u32 s21, s21, 4096
    buffer_store_dwordx2 v[8:9], v101, s[8:11], s21 offen offset:0 sc1
    buffer_store_dwordx2 v[40:41], v101, s[8:11], s21 offen offset:2048 sc1
    s_add_u32 s21, s21, 4096
    buffer_store_dwordx2 v[26:27], v101, s[8:11], s21 offen offset:0 sc1
    buffer_store_dwordx2 v[20:21], v101, s[8:11], s21 offen offset:2048 sc1
    s_add_u32 s21, s21, 4096
    s_branch M_fft_end
M_fft_c0:
    v_cvt_pk_bf16_f32 v38, v38, v142
    v_cvt_pk_bf16_f32 v44, v44, v148
    v_cvt_pk_bf16_f32 v28, v28, v132
    v_cvt_pk_bf16_f32 v46, v46, v150
    v_cvt_pk_bf16_f32 v8, v8, v112
    v_cvt_pk_bf16_f32 v40, v40, v144
    v_cvt_pk_bf16_f32 v26, v26, v130
    v_cvt_pk_bf16_f32 v20, v20, v124
    s_sub_u32 s22, s22, 4
M_fft_c1:
    buffer_store_dword v38, v101, s[8:11], s22 offen offset:4 sc1
    buffer_store_dword v44, v101, s[8:11], s22 offen offset:2052 sc1
    s_add_u32 s22, s22, 4096
    buffer_store_dword v28, v101, s[8:11], s22 offen offset:4 sc1
    buffer_store_dword v46, v101, s[8:11], s22 offen offset:2052 sc1
    s_add_u32 s22, s22, 4096
    buffer_store_dword v8, v101, s[8:11], s22 offen offset:4 sc1
    buffer_store_dword v40, v101, s[8:11], s22 offen offset:2052 sc1
    s_add_u32 s22, s22, 4096
    buffer_store_dword v26, v101, s[8:11], s22 offen offset:4 sc1
    buffer_store_dword v20, v101, s[8:11], s22 offen offset:2052 sc1
    s_add_u32 s22, s22, 4096
M_fft_end:
    s_waitcnt vmcnt(0) lgkmcnt(0)
    s_barrier
    s_cmp_lg_u32 s83, 0
    s_cbranch_scc1 M_gb_31
    s_mov_b32 s23, s85
    s_add_u32 s28, s86, 167841792
    s_lshl_b32 s27, s82, 7
    s_mov_b64 exec, 1
    s_add_u32 s31, s27, s84
    v_mov_b32 v190, s31
    v_mov_b32 v191, 1
    s_cmp_lg_u32 s23, 0
    s_cbranch_scc1 M_ls_32
    buffer_store_byte v191, v190, s[8:11], s28 offen
M_ls_32_r:
    s_cmp_lg_u32 s84, 31
    s_cbranch_scc1 M_gb_29
    s_mov_b64 exec, -1
    v_mbcnt_lo_u32_b32 v189, -1, 0
    s_mov_b64 exec, 0xff
    v_lshl_add_u32 v190, v189, 2, s27
    s_mov_b32 s30, 0
M_gs_33:
    buffer_load_dword v191, v190, s[8:11], s28 offen sc1
    s_add_u32 s30, s30, 1
    s_cmp_ge_u32 s30, 240000
    s_cbranch_scc1 M_fail
    s_waitcnt vmcnt(0)
    v_cmp_ne_u32 vcc, 0x1010101, v191
    s_cbranch_vccnz M_gs_33
    s_mov_b64 exec, 1
    v_mov_b32 v190, s27
    v_mov_b32 v191, 1
    buffer_store_dword v191, v190, s[8:11], s28 offen offset:1024 sc1
M_gb_29:
    s_mov_b64 exec, -1
M_gb_31:
    s_cmp_lg_u32 s83, 0
    s_cbranch_scc1 M_gb_30
    s_add_u32 s28, s86, 167841792
    v_mbcnt_lo_u32_b32 v189, -1, 0
    s_mov_b64 exec, 0x3f
    v_lshlrev_b32 v190, 7, v189
    v_add_u32 v190, 1024, v190
    s_mov_b32 s30, 0
M_gs_34:
    buffer_load_dword v191, v190, s[8:11], s28 offen sc1
    s_add_u32 s30, s30, 1
    s_cmp_ge_u32 s30, 240000
    s_cbranch_scc1 M_fail
    s_waitcnt vmcnt(0)
    v_cmp_ne_u32 vcc, 0x1, v191
    s_cbranch_vccnz M_gs_34
    s_mov_b64 exec, -1
M_gb_30:
    s_barrier
    s_cmp_ge_u32 s89, 64
    s_cbranch_scc1 M_noid
    v_mbcnt_lo_u32_b32 v0, -1, 0
    v_mbcnt_hi_u32_b32 v0, -1, v0
    s_mov_b32 s23, s85
    v_lshlrev_b32 v1, 4, v0
    v_lshrrev_b32 v3, 4, v0
    v_and_b32 v4, 15, v0
    v_lshlrev_b32 v2, 15, v3
    v_lshl_add_u32 v2, v4, 4, v2
    s_mul_i32 s24, s101, 3145728
    s_lshl_b32 s25, s89, 8
    s_add_u32 s24, s24, s25
    s_add_u32 s24, s24, 157286400
    s_add_u32 s25, s24, 0
    buffer_load_dwordx4 v[64:67], v2, s[8:11], s25 offen sc1
    s_add_u32 s25, s24, 16384
    buffer_load_dwordx4 v[68:71], v2, s[8:11], s25 offen sc1
    s_add_u32 s25, s24, 131072
    buffer_load_dwordx4 v[72:75], v2, s[8:11], s25 offen sc1
    s_add_u32 s25, s24, 147456
    buffer_load_dwordx4 v[76:79], v2, s[8:11], s25 offen sc1
    s_add_u32 s25, s24, 262144
    buffer_load_dwordx4 v[80:83], v2, s[8:11], s25 offen sc1
    s_add_u32 s25, s24, 278528
    buffer_load_dwordx4 v[84:87], v2, s[8:11], s25 offen sc1
    s_add_u32 s25, s24, 393216
    buffer_load_dwordx4 v[88:91], v2, s[8:11], s25 offen sc1
    s_add_u32 s25, s24, 409600
    buffer_load_dwordx4 v[92:95], v2, s[8:11], s25 offen sc1
    s_add_u32 s25, s24, 524288
    buffer_load_dwordx4 v[96:99], v2, s[8:11], s25 offen sc1
    s_add_u32 s25, s24, 540672
    buffer_load_dwordx4 v[100:103], v2, s[8:11], s25 offen sc1
    s_add_u32 s25, s24, 655360
    buffer_load_dwordx4 v[104:107], v2, s[8:11], s25 offen sc1
    s_add_u32 s25, s24, 671744
    buffer_load_dwordx4 v[108:111], v2, s[8:11], s25 offen sc1
    s_add_u32 s25, s24, 786432
    buffer_load_dwordx4 v[112:115], v2, s[8:11], s25 offen sc1
    s_add_u32 s25, s24, 802816
    buffer_load_dwordx4 v[116:119], v2, s[8:11], s25 offen sc1
    s_add_u32 s25, s24, 917504
    buffer_load_dwordx4 v[120:123], v2, s[8:11], s25 offen sc1
    s_add_u32 s25, s24, 933888
    buffer_load_dwordx4 v[124:127], v2, s[8:11], s25 offen sc1
    s_mul_i32 s29, s89, 40960
    v_mul_u32_u24 v5, 1280, v4
    v_lshl_add_u32 v5, v3, 4, v5
    v_add_u32 v6, 40960, v1
    s_lshl_b32 s31, s88, 7
    s_add_u32 s30, s29, s31
    s_add_u32 s31, s30, s80
    s_add_u32 s32, s31, 20480
    s_add_u32 s33, s30, 20480
    ds_read_b128 v[44:47], v1 offset:0
    ds_read_b128 v[48:51], v1 offset:20480
    ds_read_b128 v[52:55], v6 offset:0
    ds_read_b128 v[56:59], v6 offset:20480
    s_waitcnt vmcnt(14)
    v_swap_b32 v66, v68
    v_swap_b32 v67, v69
    s_waitcnt lgkmcnt(3)
    s_nop 0
    v_mfma_f32_16x16x32_bf16 v[12:15], v[44:47], v[64:67], 0
    ds_read_b128 v[60:63], v1 offset:1024
    v_mfma_f32_16x16x32_bf16 v[28:31], v[44:47], v[68:71], 0
    s_waitcnt lgkmcnt(3)
    v_mfma_f32_16x16x32_bf16 v[16:19], v[48:51], v[64:67], 0
    ds_read_b128 v[44:47], v1 offset:21504
    v_mfma_f32_16x16x32_bf16 v[32:35], v[48:51], v[68:71], 0
    s_waitcnt lgkmcnt(3)
    v_mfma_f32_16x16x32_bf16 v[20:23], v[52:55], v[64:67], 0
    ds_read_b128 v[48:51], v6 offset:1024
    v_mfma_f32_16x16x32_bf16 v[36:39], v[52:55], v[68:71], 0
    s_waitcnt vmcnt(12)
    v_swap_b32 v74, v76
    v_swap_b32 v75, v77
    s_waitcnt lgkmcnt(3)
    v_mfma_f32_16x16x32_bf16 v[24:27], v[56:59], v[64:67], 0
    ds_read_b128 v[52:55], v6 offset:21504
    v_mfma_f32_16x16x32_bf16 v[40:43], v[56:59], v[68:71], 0
    s_add_u32 s25, s24, 1048576
    buffer_load_dwordx4 v[128:131], v2, s[8:11], s25 offen sc1
    s_add_u32 s25, s24, 1064960
    buffer_load_dwordx4 v[132:135], v2, s[8:11], s25 offen sc1
    s_add_u32 s25, s24, 1179648
    buffer_load_dwordx4 v[136:139], v2, s[8:11], s25 offen sc1
    s_add_u32 s25, s24, 1196032
    buffer_load_dwordx4 v[140:143], v2, s[8:11], s25 offen sc1
    s_add_u32 s25, s24, 1310720
    buffer_load_dwordx4 v[144:147], v2, s[8:11], s25 offen sc1
    s_add_u32 s25, s24, 1327104
    buffer_load_dwordx4 v[148:151], v2, s[8:11], s25 offen sc1
    s_add_u32 s25, s24, 1441792
    buffer_load_dwordx4 v[152:155], v2, s[8:11], s25 offen sc1
    s_add_u32 s25, s24, 1458176
    buffer_load_dwordx4 v[156:159], v2, s[8:11], s25 offen sc1
    s_waitcnt lgkmcnt(3)
    v_mfma_f32_16x16x32_bf16 v[12:15], v[60:63], v[72:75], v[12:15]
    ds_read_b128 v[56:59], v1 offset:2048
    v_mfma_f32_16x16x32_bf16 v[28:31], v[60:63], v[76:79], v[28:31]
    s_waitcnt lgkmcnt(3)
    v_mfma_f32_16x16x32_bf16 v[16:19], v[44:47], v[72:75], v[16:19]
    ds_read_b128 v[60:63], v1 offset:22528
    v_mfma_f32_16x16x32_bf16 v[32:35], v[44:47], v[76:79], v[32:35]
    s_waitcnt lgkmcnt(3)
    v_mfma_f32_16x16x32_bf16 v[20:23], v[48:51], v[72:75], v[20:23]
    ds_read_b128 v[44:47], v6 offset:2048
    v_mfma_f32_16x16x32_bf16 v[36:39], v[48:51], v[76:79], v[36:39]
    s_waitcnt vmcnt(18)
    v_swap_b32 v82, v84
    v_swap_b32 v83, v85
    s_waitcnt lgkmcnt(3)
    v_mfma_f32_16x16x32_bf16 v[24:27], v[52:55], v[72:75], v[24:27]
    ds_read_b128 v[48:51], v6 offset:22528
    v_mfma_f32_16x16x32_bf16 v[40:43], v[52:55], v[76:79], v[40:43]
    s_waitcnt lgkmcnt(3)
    v_mfma_f32_16x16x32_bf16 v[12:15], v[56:59], v[80:83], v[12:15]
    ds_read_b128 v[52:55], v1 offset:3072
    v_mfma_f32_16x16x32_bf16 v[28:31], v[56:59], v[84:87], v[28:31]
    s_waitcnt lgkmcnt(3)
    v_mfma_f32_16x16x32_bf16 v[16:19], v[60:63], v[80:83], v[16:19]
    ds_read_b128 v[56:59], v1 offset:23552
    v_mfma_f32_16x16x32_bf16 v[32:35], v[60:63], v[84:87], v[32:35]
    s_waitcnt lgkmcnt(3)
    v_mfma_f32_16x16x32_bf16 v[20:23], v[44:47], v[80:83], v[20:23]
    ds_read_b128 v[60:63], v6 offset:3072
    v_mfma_f32_16x16x32_bf16 v[36:39], v[44:47], v[84:87], v[36:39]
    s_waitcnt vmcnt(16)
    v_swap_b32 v90, v92
    v_swap_b32 v91, v93
    s_waitcnt lgkmcnt(3)
    v_mfma_f32_16x16x32_bf16 v[24:27], v[48:51], v[80:83], v[24:27]
    ds_read_b128 v[44:47], v6 offset:23552
    v_mfma_f32_16x16x32_bf16 v[40:43], v[48:51], v[84:87], v[40:43]
    s_add_u32 s25, s24, 1572864
    buffer_load_dwordx4 v[160:163], v2, s[8:11], s25 offen sc1
    s_add_u32 s25, s24, 1589248
    buffer_load_dwordx4 v[164:167], v2, s[8:11], s25 offen sc1
    s_add_u32 s25, s24, 1703936
    buffer_load_dwordx4 v[168:171], v2, s[8:11], s25 offen sc1
    s_add_u32 s25, s24, 1720320
    buffer_load_dwordx4 v[172:175], v2, s[8:11], s25 offen sc1
    s_add_u32 s25, s24, 1835008
    buffer_load_dwordx4 v[176:179], v2, s[8:11], s25 offen sc1
    s_add_u32 s25, s24, 1851392
    buffer_load_dwordx4 v[180:183], v2, s[8:11], s25 offen sc1
    s_add_u32 s25, s24, 1966080
    buffer_load_dwordx4 v[64:67], v2, s[8:11], s25 offen sc1
    s_add_u32 s25, s24, 1982464
    buffer_load_dwordx4 v[68:71], v2, s[8:11], s25 offen sc1
    s_waitcnt lgkmcnt(3)
    v_mfma_f32_16x16x32_bf16 v[12:15], v[52:55], v[88:91], v[12:15]
    ds_read_b128 v[48:51], v1 offset:4096
    v_mfma_f32_16x16x32_bf16 v[28:31], v[52:55], v[92:95], v[28:31]
    s_waitcnt lgkmcnt(3)
    v_mfma_f32_16x16x32_bf16 v[16:19], v[56:59], v[88:91], v[16:19]
    ds_read_b128 v[52:55], v1 offset:24576
    v_mfma_f32_16x16x32_bf16 v[32:35], v[56:59], v[92:95], v[32:35]
    s_waitcnt lgkmcnt(3)
    v_mfma_f32_16x16x32_bf16 v[20:23], v[60:63], v[88:91], v[20:23]
    ds_read_b128 v[56:59], v6 offset:4096
    v_mfma_f32_16x16x32_bf16 v[36:39], v[60:63], v[92:95], v[36:39]
    s_waitcnt vmcnt(22)
    v_swap_b32 v98, v100
    v_swap_b32 v99, v101
    s_waitcnt lgkmcnt(3)
    v_mfma_f32_16x16x32_bf16 v[24:27], v[44:47], v[88:91], v[24:27]
    ds_read_b128 v[60:63], v6 offset:24576
    v_mfma_f32_16x16x32_bf16 v[40:43], v[44:47], v[92:95], v[40:43]
    s_waitcnt lgkmcnt(3)
    v_mfma_f32_16x16x32_bf16 v[12:15], v[48:51], v[96:99], v[12:15]
    ds_read_b128 v[44:47], v1 offset:5120
    v_mfma_f32_16x16x32_bf16 v[28:31], v[48:51], v[100:103], v[28:31]
    s_waitcnt lgkmcnt(3)
    v_mfma_f32_16x16x32_bf16 v[16:19], v[52:55], v[96:99], v[16:19]
    ds_read_b128 v[48:51], v1 offset:25600
    v_mfma_f32_16x16x32_bf16 v[32:35], v[52:55], v[100:103], v[32:35]
    s_waitcnt lgkmcnt(3)
    v_mfma_f32_16x16x32_bf16 v[20:23], v[56:59], v[96:99], v[20:23]
    ds_read_b128 v[52:55], v6 offset:5120
    v_mfma_f32_16x16x32_bf16 v[36:39], v[56:59], v[100:103], v[36:39]
    s_waitcnt vmcnt(20)
    v_swap_b32 v106, v108
    v_swap_b32 v107, v109
    s_waitcnt lgkmcnt(3)
    v_mfma_f32_16x16x32_bf16 v[24:27], v[60:63], v[96:99], v[24:27]
    ds_read_b128 v[56:59], v6 offset:25600
    v_mfma_f32_16x16x32_bf16 v[40:43], v[60:63], v[100:103], v[40:43]
    s_add_u32 s25, s24, 2097152
    buffer_load_dwordx4 v[72:75], v2, s[8:11], s25 offen sc1
    s_add_u32 s25, s24, 2113536
    buffer_load_dwordx4 v[76:79], v2, s[8:11], s25 offen sc1
    s_add_u32 s25, s24, 2228224
    buffer_load_dwordx4 v[80:83], v2, s[8:11], s25 offen sc1
    s_add_u32 s25, s24, 2244608
    buffer_load_dwordx4 v[84:87], v2, s[8:11], s25 offen sc1
    s_add_u32 s25, s24, 2359296
    buffer_load_dwordx4 v[88:91], v2, s[8:11], s25 offen sc1
    s_add_u32 s25, s24, 2375680
    buffer_load_dwordx4 v[92:95], v2, s[8:11], s25 offen sc1
    s_add_u32 s25, s24, 2490368
    buffer_load_dwordx4 v[96:99], v2, s[8:11], s25 offen sc1
    s_add_u32 s25, s24, 2506752
    buffer_load_dwordx4 v[100:103], v2, s[8:11], s25 offen sc1
    s_waitcnt lgkmcnt(3)
    v_mfma_f32_16x16x32_bf16 v[12:15], v[44:47], v[104:107], v[12:15]
    ds_read_b128 v[60:63], v1 offset:6144
    v_mfma_f32_16x16x32_bf16 v[28:31], v[44:47], v[108:111], v[28:31]
    s_waitcnt lgkmcnt(3)
    v_mfma_f32_16x16x32_bf16 v[16:19], v[48:51], v[104:107], v[16:19]
    ds_read_b128 v[44:47], v1 offset:26624
    v_mfma_f32_16x16x32_bf16 v[32:35], v[48:51], v[108:111], v[32:35]
    s_waitcnt lgkmcnt(3)
    v_mfma_f32_16x16x32_bf16 v[20:23], v[52:55], v[104:107], v[20:23]
    ds_read_b128 v[48:51], v6 offset:6144
    v_mfma_f32_16x16x32_bf16 v[36:39], v[52:55], v[108:111], v[36:39]
    s_waitcnt vmcnt(26)
    v_swap_b32 v114, v116
    v_swap_b32 v115, v117
    s_waitcnt lgkmcnt(3)
    v_mfma_f32_16x16x32_bf16 v[24:27], v[56:59], v[104:107], v[24:27]
    ds_read_b128 v[52:55], v6 offset:26624
    v_mfma_f32_16x16x32_bf16 v[40:43], v[56:59], v[108:111], v[40:43]
    s_waitcnt lgkmcnt(3)
    v_mfma_f32_16x16x32_bf16 v[12:15], v[60:63], v[112:115], v[12:15]
    ds_read_b128 v[56:59], v1 offset:7168
    v_mfma_f32_16x16x32_bf16 v[28:31], v[60:63], v[116:119], v[28:31]
    s_waitcnt lgkmcnt(3)
    v_mfma_f32_16x16x32_bf16 v[16:19], v[44:47], v[112:115], v[16:19]
    ds_read_b128 v[60:63], v1 offset:27648
    v_mfma_f32_16x16x32_bf16 v[32:35], v[44:47], v[116:119], v[32:35]
    s_waitcnt lgkmcnt(3)
    v_mfma_f32_16x16x32_bf16 v[20:23], v[48:51], v[112:115], v[20:23]
    ds_read_b128 v[44:47], v6 offset:7168
    v_mfma_f32_16x16x32_bf16 v[36:39], v[48:51], v[116:119], v[36:39]
    s_waitcnt vmcnt(24)
    v_swap_b32 v122, v124
    v_swap_b32 v123, v125
    s_waitcnt lgkmcnt(3)
    v_mfma_f32_16x16x32_bf16 v[24:27], v[52:55], v[112:115], v[24:27]
    ds_read_b128 v[48:51], v6 offset:27648
    v_mfma_f32_16x16x32_bf16 v[40:43], v[52:55], v[116:119], v[40:43]
    s_waitcnt lgkmcnt(3)
    v_mfma_f32_16x16x32_bf16 v[12:15], v[56:59], v[120:123], v[12:15]
    ds_read_b128 v[52:55], v1 offset:8192
    v_mfma_f32_16x16x32_bf16 v[28:31], v[56:59], v[124:127], v[28:31]
    s_waitcnt lgkmcnt(3)
    v_mfma_f32_16x16x32_bf16 v[16:19], v[60:63], v[120:123], v[16:19]
    ds_read_b128 v[56:59], v1 offset:28672
    v_mfma_f32_16x16x32_bf16 v[32:35], v[60:63], v[124:127], v[32:35]
    s_waitcnt lgkmcnt(3)
    v_mfma_f32_16x16x32_bf16 v[20:23], v[44:47], v[120:123], v[20:23]
    ds_read_b128 v[60:63], v6 offset:8192
    v_mfma_f32_16x16x32_bf16 v[36:39], v[44:47], v[124:127], v[36:39]
    s_waitcnt vmcnt(22)
    v_swap_b32 v130, v132
    v_swap_b32 v131, v133
    s_waitcnt lgkmcnt(3)
    v_mfma_f32_16x16x32_bf16 v[24:27], v[48:51], v[120:123], v[24:27]
    ds_read_b128 v[44:47], v6 offset:28672
    v_mfma_f32_16x16x32_bf16 v[40:43], v[48:51], v[124:127], v[40:43]
    s_waitcnt lgkmcnt(3)
    v_mfma_f32_16x16x32_bf16 v[12:15], v[52:55], v[128:131], v[12:15]
    ds_read_b128 v[48:51], v1 offset:9216
    v_mfma_f32_16x16x32_bf16 v[28:31], v[52:55], v[132:135], v[28:31]
    s_waitcnt lgkmcnt(3)
    v_mfma_f32_16x16x32_bf16 v[16:19], v[56:59], v[128:131], v[16:19]
    ds_read_b128 v[52:55], v1 offset:29696
    v_mfma_f32_16x16x32_bf16 v[32:35], v[56:59], v[132:135], v[32:35]
    s_waitcnt lgkmcnt(3)
    v_mfma_f32_16x16x32_bf16 v[20:23], v[60:63], v[128:131], v[20:23]
    ds_read_b128 v[56:59], v6 offset:9216
    v_mfma_f32_16x16x32_bf16 v[36:39], v[60:63], v[132:135], v[36:39]
    s_waitcnt vmcnt(20)
    v_swap_b32 v138, v140
    v_swap_b32 v139, v141
    s_waitcnt lgkmcnt(3)
    v_mfma_f32_16x16x32_bf16 v[24:27], v[44:47], v[128:131], v[24:27]
    ds_read_b128 v[60:63], v6 offset:29696
    v_mfma_f32_16x16x32_bf16 v[40:43], v[44:47], v[132:135], v[40:43]
    s_waitcnt lgkmcnt(3)
    v_mfma_f32_16x16x32_bf16 v[12:15], v[48:51], v[136:139], v[12:15]
    ds_read_b128 v[44:47], v1 offset:10240
    v_mfma_f32_16x16x32_bf16 v[28:31], v[48:51], v[140:143], v[28:31]
    s_waitcnt lgkmcnt(3)
    v_mfma_f32_16x16x32_bf16 v[16:19], v[52:55], v[136:139], v[16:19]
    ds_read_b128 v[48:51], v1 offset:30720
    v_mfma_f32_16x16x32_bf16 v[32:35], v[52:55], v[140:143], v[32:35]
    s_waitcnt lgkmcnt(3)
    v_mfma_f32_16x16x32_bf16 v[20:23], v[56:59], v[136:139], v[20:23]
    ds_read_b128 v[52:55], v6 offset:10240
    v_mfma_f32_16x16x32_bf16 v[36:39], v[56:59], v[140:143], v[36:39]
    s_waitcnt vmcnt(18)
    v_swap_b32 v146, v148
    v_swap_b32 v147, v149
    s_waitcnt lgkmcnt(3)
    v_mfma_f32_16x16x32_bf16 v[24:27], v[60:63], v[136:139], v[24:27]
    ds_read_b128 v[56:59], v6 offset:30720
    v_mfma_f32_16x16x32_bf16 v[40:43], v[60:63], v[140:143], v[40:43]
    buffer_load_dwordx4 v[104:107], v5, s[8:11], s31 offen offset:0 sc1
    buffer_load_dwordx4 v[108:111], v5, s[8:11], s31 offen offset:64 sc1
    buffer_load_dwordx4 v[112:115], v5, s[8:11], s32 offen offset:0 sc1
    buffer_load_dwordx4 v[116:119], v5, s[8:11], s32 offen offset:64 sc1
    s_waitcnt lgkmcnt(3)
    v_mfma_f32_16x16x32_bf16 v[12:15], v[44:47], v[144:147], v[12:15]
    ds_read_b128 v[60:63], v1 offset:11264
    v_mfma_f32_16x16x32_bf16 v[28:31], v[44:47], v[148:151], v[28:31]
    s_waitcnt lgkmcnt(3)
    v_mfma_f32_16x16x32_bf16 v[16:19], v[48:51], v[144:147], v[16:19]
    ds_read_b128 v[44:47], v1 offset:31744
    v_mfma_f32_16x16x32_bf16 v[32:35], v[48:51], v[148:151], v[32:35]
    s_waitcnt lgkmcnt(3)
    v_mfma_f32_16x16x32_bf16 v[20:23], v[52:55], v[144:147], v[20:23]
    ds_read_b128 v[48:51], v6 offset:11264
    v_mfma_f32_16x16x32_bf16 v[36:39], v[52:55], v[148:151], v[36:39]
    s_waitcnt vmcnt(20)
    v_swap_b32 v154, v156
    v_swap_b32 v155, v157
    s_waitcnt lgkmcnt(3)
    v_mfma_f32_16x16x32_bf16 v[24:27], v[56:59], v[144:147], v[24:27]
    ds_read_b128 v[52:55], v6 offset:31744
    v_mfma_f32_16x16x32_bf16 v[40:43], v[56:59], v[148:151], v[40:43]
    s_waitcnt lgkmcnt(3)
    v_mfma_f32_16x16x32_bf16 v[12:15], v[60:63], v[152:155], v[12:15]
    ds_read_b128 v[56:59], v1 offset:12288
    v_mfma_f32_16x16x32_bf16 v[28:31], v[60:63], v[156:159], v[28:31]
    s_waitcnt lgkmcnt(3)
    v_mfma_f32_16x16x32_bf16 v[16:19], v[44:47], v[152:155], v[16:19]
    ds_read_b128 v[60:63], v1 offset:32768
    v_mfma_f32_16x16x32_bf16 v[32:35], v[44:47], v[156:159], v[32:35]
    s_waitcnt lgkmcnt(3)
    v_mfma_f32_16x16x32_bf16 v[20:23], v[48:51], v[152:155], v[20:23]
    ds_read_b128 v[44:47], v6 offset:12288
    v_mfma_f32_16x16x32_bf16 v[36:39], v[48:51], v[156:159], v[36:39]
    s_waitcnt vmcnt(18)
    v_swap_b32 v162, v164
    v_swap_b32 v163, v165
    s_waitcnt lgkmcnt(3)
    v_mfma_f32_16x16x32_bf16 v[24:27], v[52:55], v[152:155], v[24:27]
    ds_read_b128 v[48:51], v6 offset:32768
    v_mfma_f32_16x16x32_bf16 v[40:43], v[52:55], v[156:159], v[40:43]
    s_waitcnt lgkmcnt(3)
    v_mfma_f32_16x16x32_bf16 v[12:15], v[56:59], v[160:163], v[12:15]
    ds_read_b128 v[52:55], v1 offset:13312
    v_mfma_f32_16x16x32_bf16 v[28:31], v[56:59], v[164:167], v[28:31]
    s_waitcnt lgkmcnt(3)
    v_mfma_f32_16x16x32_bf16 v[16:19], v[60:63], v[160:163], v[16:19]
    ds_read_b128 v[56:59], v1 offset:33792
    v_mfma_f32_16x16x32_bf16 v[32:35], v[60:63], v[164:167], v[32:35]
    s_waitcnt lgkmcnt(3)
    v_mfma_f32_16x16x32_bf16 v[20:23], v[44:47], v[160:163], v[20:23]
    ds_read_b128 v[60:63], v6 offset:13312
    v_mfma_f32_16x16x32_bf16 v[36:39], v[44:47], v[164:167], v[36:39]
    s_waitcnt vmcnt(16)
    v_swap_b32 v170, v172
    v_swap_b32 v171, v173
    s_waitcnt lgkmcnt(3)
    v_mfma_f32_16x16x32_bf16 v[24:27], v[48:51], v[160:163], v[24:27]
    ds_read_b128 v[44:47], v6 offset:33792
    v_mfma_f32_16x16x32_bf16 v[40:43], v[48:51], v[164:167], v[40:43]
    s_waitcnt lgkmcnt(3)
    v_mfma_f32_16x16x32_bf16 v[12:15], v[52:55], v[168:171], v[12:15]
    ds_read_b128 v[48:51], v1 offset:14336
    v_mfma_f32_16x16x32_bf16 v[28:31], v[52:55], v[172:175], v[28:31]
    s_waitcnt lgkmcnt(3)
    v_mfma_f32_16x16x32_bf16 v[16:19], v[56:59], v[168:171], v[16:19]
    ds_read_b128 v[52:55], v1 offset:34816
    v_mfma_f32_16x16x32_bf16 v[32:35], v[56:59], v[172:175], v[32:35]
    s_waitcnt lgkmcnt(3)
    v_mfma_f32_16x16x32_bf16 v[20:23], v[60:63], v[168:171], v[20:23]
    ds_read_b128 v[56:59], v6 offset:14336
    v_mfma_f32_16x16x32_bf16 v[36:39], v[60:63], v[172:175], v[36:39]
    s_waitcnt vmcnt(14)
    v_swap_b32 v178, v180
    v_swap_b32 v179, v181
    s_waitcnt lgkmcnt(3)
    v_mfma_f32_16x16x32_bf16 v[24:27], v[44:47], v[168:171], v[24:27]
    ds_read_b128 v[60:63], v6 offset:34816
    v_mfma_f32_16x16x32_bf16 v[40:43], v[44:47], v[172:175], v[40:43]
    s_waitcnt lgkmcnt(3)
    v_mfma_f32_16x16x32_bf16 v[12:15], v[48:51], v[176:179], v[12:15]
    ds_read_b128 v[44:47], v1 offset:15360
    v_mfma_f32_16x16x32_bf16 v[28:31], v[48:51], v[180:183], v[28:31]
    s_waitcnt lgkmcnt(3)
    v_mfma_f32_16x16x32_bf16 v[16:19], v[52:55], v[176:179], v[16:19]
    ds_read_b128 v[48:51], v1 offset:35840
    v_mfma_f32_16x16x32_bf16 v[32:35], v[52:55], v[180:183], v[32:35]
    s_waitcnt lgkmcnt(3)
    v_mfma_f32_16x16x32_bf16 v[20:23], v[56:59], v[176:179], v[20:23]
    ds_read_b128 v[52:55], v6 offset:15360
    v_mfma_f32_16x16x32_bf16 v[36:39], v[56:59], v[180:183], v[36:39]
    s_waitcnt vmcnt(12)
    v_swap_b32 v66, v68
    v_swap_b32 v67, v69
    s_waitcnt lgkmcnt(3)
    v_mfma_f32_16x16x32_bf16 v[24:27], v[60:63], v[176:179], v[24:27]
    ds_read_b128 v[56:59], v6 offset:35840
    v_mfma_f32_16x16x32_bf16 v[40:43], v[60:63], v[180:183], v[40:43]
    s_waitcnt lgkmcnt(3)
    v_mfma_f32_16x16x32_bf16 v[12:15], v[44:47], v[64:67], v[12:15]
    ds_read_b128 v[60:63], v1 offset:16384
    v_mfma_f32_16x16x32_bf16 v[28:31], v[44:47], v[68:71], v[28:31]
    s_waitcnt lgkmcnt(3)
    v_mfma_f32_16x16x32_bf16 v[16:19], v[48:51], v[64:67], v[16:19]
    ds_read_b128 v[44:47], v1 offset:36864
    v_mfma_f32_16x16x32_bf16 v[32:35], v[48:51], v[68:71], v[32:35]
    s_waitcnt lgkmcnt(3)
    v_mfma_f32_16x16x32_bf16 v[20:23], v[52:55], v[64:67], v[20:23]
    ds_read_b128 v[48:51], v6 offset:16384
    v_mfma_f32_16x16x32_bf16 v[36:39], v[52:55], v[68:71], v[36:39]
    s_waitcnt vmcnt(10)
    v_swap_b32 v74, v76
    v_swap_b32 v75, v77
    s_waitcnt lgkmcnt(3)
    v_mfma_f32_16x16x32_bf16 v[24:27], v[56:59], v[64:67], v[24:27]
    ds_read_b128 v[52:55], v6 offset:36864
    v_mfma_f32_16x16x32_bf16 v[40:43], v[56:59], v[68:71], v[40:43]
    s_waitcnt lgkmcnt(3)
    v_mfma_f32_16x16x32_bf16 v[12:15], v[60:63], v[72:75], v[12:15]
    ds_read_b128 v[56:59], v1 offset:17408
    v_mfma_f32_16x16x32_bf16 v[28:31], v[60:63], v[76:79], v[28:31]
    s_waitcnt lgkmcnt(3)
    v_mfma_f32_16x16x32_bf16 v[16:19], v[44:47], v[72:75], v[16:19]
    ds_read_b128 v[60:63], v1 offset:37888
    v_mfma_f32_16x16x32_bf16 v[32:35], v[44:47], v[76:79], v[32:35]
    s_waitcnt lgkmcnt(3)
    v_mfma_f32_16x16x32_bf16 v[20:23], v[48:51], v[72:75], v[20:23]
    ds_read_b128 v[44:47], v6 offset:17408
    v_mfma_f32_16x16x32_bf16 v[36:39], v[48:51], v[76:79], v[36:39]
    s_waitcnt vmcnt(8)
    v_swap_b32 v82, v84
    v_swap_b32 v83, v85
    s_waitcnt lgkmcnt(3)
    v_mfma_f32_16x16x32_bf16 v[24:27], v[52:55], v[72:75], v[24:27]
    ds_read_b128 v[48:51], v6 offset:37888
    v_mfma_f32_16x16x32_bf16 v[40:43], v[52:55], v[76:79], v[40:43]
    s_waitcnt lgkmcnt(3)
    v_mfma_f32_16x16x32_bf16 v[12:15], v[56:59], v[80:83], v[12:15]
    ds_read_b128 v[52:55], v1 offset:18432
    v_mfma_f32_16x16x32_bf16 v[28:31], v[56:59], v[84:87], v[28:31]
    s_waitcnt lgkmcnt(3)
    v_mfma_f32_16x16x32_bf16 v[16:19], v[60:63], v[80:83], v[16:19]
    ds_read_b128 v[56:59], v1 offset:38912
    v_mfma_f32_16x16x32_bf16 v[32:35], v[60:63], v[84:87], v[32:35]
    s_waitcnt lgkmcnt(3)
    v_mfma_f32_16x16x32_bf16 v[20:23], v[44:47], v[80:83], v[20:23]
    ds_read_b128 v[60:63], v6 offset:18432
    v_mfma_f32_16x16x32_bf16 v[36:39], v[44:47], v[84:87], v[36:39]
    s_waitcnt vmcnt(6)
    v_swap_b32 v90, v92
    v_swap_b32 v91, v93
    s_waitcnt lgkmcnt(3)
    v_mfma_f32_16x16x32_bf16 v[24:27], v[48:51], v[80:83], v[24:27]
    ds_read_b128 v[44:47], v6 offset:38912
    v_mfma_f32_16x16x32_bf16 v[40:43], v[48:51], v[84:87], v[40:43]
    s_waitcnt lgkmcnt(3)
    v_mfma_f32_16x16x32_bf16 v[12:15], v[52:55], v[88:91], v[12:15]
    ds_read_b128 v[48:51], v1 offset:19456
    v_mfma_f32_16x16x32_bf16 v[28:31], v[52:55], v[92:95], v[28:31]
    s_waitcnt lgkmcnt(3)
    v_mfma_f32_16x16x32_bf16 v[16:19], v[56:59], v[88:91], v[16:19]
    ds_read_b128 v[52:55], v1 offset:39936
    v_mfma_f32_16x16x32_bf16 v[32:35], v[56:59], v[92:95], v[32:35]
    s_waitcnt lgkmcnt(3)
    v_mfma_f32_16x16x32_bf16 v[20:23], v[60:63], v[88:91], v[20:23]
    ds_read_b128 v[56:59], v6 offset:19456
    v_mfma_f32_16x16x32_bf16 v[36:39], v[60:63], v[92:95], v[36:39]
    s_waitcnt vmcnt(4)
    v_swap_b32 v98, v100
    v_swap_b32 v99, v101
    s_waitcnt lgkmcnt(3)
    v_mfma_f32_16x16x32_bf16 v[24:27], v[44:47], v[88:91], v[24:27]
    ds_read_b128 v[60:63], v6 offset:39936
    v_mfma_f32_16x16x32_bf16 v[40:43], v[44:47], v[92:95], v[40:43]
    s_waitcnt lgkmcnt(3)
    v_mfma_f32_16x16x32_bf16 v[12:15], v[48:51], v[96:99], v[12:15]
    v_mfma_f32_16x16x32_bf16 v[28:31], v[48:51], v[100:103], v[28:31]
    s_waitcnt lgkmcnt(2)
    v_mfma_f32_16x16x32_bf16 v[16:19], v[52:55], v[96:99], v[16:19]
    v_mfma_f32_16x16x32_bf16 v[32:35], v[52:55], v[100:103], v[32:35]
    s_waitcnt lgkmcnt(1)
    v_mfma_f32_16x16x32_bf16 v[20:23], v[56:59], v[96:99], v[20:23]
    v_mfma_f32_16x16x32_bf16 v[36:39], v[56:59], v[100:103], v[36:39]
    s_waitcnt lgkmcnt(0)
    v_mfma_f32_16x16x32_bf16 v[24:27], v[60:63], v[96:99], v[24:27]
    v_mfma_f32_16x16x32_bf16 v[40:43], v[60:63], v[100:103], v[40:43]
    s_waitcnt vmcnt(3)
    v_lshlrev_b32 v8, 16, v104
    v_and_b32 v9, 0xffff0000, v104
    v_pk_add_f32 v[12:13], v[12:13], v[8:9]
    v_cvt_pk_bf16_f32 v104, v12, v13
    v_lshlrev_b32 v8, 16, v105
    v_and_b32 v9, 0xffff0000, v105
    v_pk_add_f32 v[14:15], v[14:15], v[8:9]
    v_cvt_pk_bf16_f32 v105, v14, v15
    v_lshlrev_b32 v8, 16, v106
    v_and_b32 v9, 0xffff0000, v106
    v_pk_add_f32 v[16:17], v[16:17], v[8:9]
    v_cvt_pk_bf16_f32 v106, v16, v17
    v_lshlrev_b32 v8, 16, v107
    v_and_b32 v9, 0xffff0000, v107
    v_pk_add_f32 v[18:19], v[18:19], v[8:9]
    v_cvt_pk_bf16_f32 v107, v18, v19
    s_waitcnt vmcnt(2)
    v_lshlrev_b32 v8, 16, v108
    v_and_b32 v9, 0xffff0000, v108
    v_pk_add_f32 v[20:21], v[20:21], v[8:9]
    v_cvt_pk_bf16_f32 v108, v20, v21
    v_lshlrev_b32 v8, 16, v109
    v_and_b32 v9, 0xffff0000, v109
    v_pk_add_f32 v[22:23], v[22:23], v[8:9]
    v_cvt_pk_bf16_f32 v109, v22, v23
    v_lshlrev_b32 v8, 16, v110
    v_and_b32 v9, 0xffff0000, v110
    v_pk_add_f32 v[24:25], v[24:25], v[8:9]
    v_cvt_pk_bf16_f32 v110, v24, v25
    v_lshlrev_b32 v8, 16, v111
    v_and_b32 v9, 0xffff0000, v111
    v_pk_add_f32 v[26:27], v[26:27], v[8:9]
    v_cvt_pk_bf16_f32 v111, v26, v27
    s_waitcnt vmcnt(1)
    v_lshlrev_b32 v8, 16, v112
    v_and_b32 v9, 0xffff0000, v112
    v_pk_add_f32 v[28:29], v[28:29], v[8:9]
    v_cvt_pk_bf16_f32 v112, v28, v29
    v_lshlrev_b32 v8, 16, v113
    v_and_b32 v9, 0xffff0000, v113
    v_pk_add_f32 v[30:31], v[30:31], v[8:9]
    v_cvt_pk_bf16_f32 v113, v30, v31
    v_lshlrev_b32 v8, 16, v114
    v_and_b32 v9, 0xffff0000, v114
    v_pk_add_f32 v[32:33], v[32:33], v[8:9]
    v_cvt_pk_bf16_f32 v114, v32, v33
    v_lshlrev_b32 v8, 16, v115
    v_and_b32 v9, 0xffff0000, v115
    v_pk_add_f32 v[34:35], v[34:35], v[8:9]
    v_cvt_pk_bf16_f32 v115, v34, v35
    s_waitcnt vmcnt(0)
    v_lshlrev_b32 v8, 16, v116
    v_and_b32 v9, 0xffff0000, v116
    v_pk_add_f32 v[36:37], v[36:37], v[8:9]
    v_cvt_pk_bf16_f32 v116, v36, v37
    v_lshlrev_b32 v8, 16, v117
    v_and_b32 v9, 0xffff0000, v117
    v_pk_add_f32 v[38:39], v[38:39], v[8:9]
    v_cvt_pk_bf16_f32 v117, v38, v39
    v_lshlrev_b32 v8, 16, v118
    v_and_b32 v9, 0xffff0000, v118
    v_pk_add_f32 v[40:41], v[40:41], v[8:9]
    v_cvt_pk_bf16_f32 v118, v40, v41
    v_lshlrev_b32 v8, 16, v119
    v_and_b32 v9, 0xffff0000, v119
    v_pk_add_f32 v[42:43], v[42:43], v[8:9]
    v_cvt_pk_bf16_f32 v119, v42, v43
    s_cmp_eq_u32 s101, 1
    s_cbranch_scc1 M_id_out
    v_lshlrev_b32 v12, 16, v104
    v_and_b32 v13, 0xffff0000, v104
    v_lshlrev_b32 v14, 16, v105
    v_and_b32 v15, 0xffff0000, v105
    v_lshlrev_b32 v16, 16, v106
    v_and_b32 v17, 0xffff0000, v106
    v_lshlrev_b32 v18, 16, v107
    v_and_b32 v19, 0xffff0000, v107
    v_lshlrev_b32 v20, 16, v108
    v_and_b32 v21, 0xffff0000, v108
    v_lshlrev_b32 v22, 16, v109
    v_and_b32 v23, 0xffff0000, v109
    v_lshlrev_b32 v24, 16, v110
    v_and_b32 v25, 0xffff0000, v110
    v_lshlrev_b32 v26, 16, v111
    v_and_b32 v27, 0xffff0000, v111
    v_lshlrev_b32 v28, 16, v112
    v_and_b32 v29, 0xffff0000, v112
    v_lshlrev_b32 v30, 16, v113
    v_and_b32 v31, 0xffff0000, v113
    v_lshlrev_b32 v32, 16, v114
    v_and_b32 v33, 0xffff0000, v114
    v_lshlrev_b32 v34, 16, v115
    v_and_b32 v35, 0xffff0000, v115
    v_lshlrev_b32 v36, 16, v116
    v_and_b32 v37, 0xffff0000, v116
    v_lshlrev_b32 v38, 16, v117
    v_and_b32 v39, 0xffff0000, v117
    v_lshlrev_b32 v40, 16, v118
    v_and_b32 v41, 0xffff0000, v118
    v_lshlrev_b32 v42, 16, v119
    v_and_b32 v43, 0xffff0000, v119
    v_pk_add_f32 v[124:125], v[12:13], v[14:15]
    v_pk_add_f32 v[128:129], v[28:29], v[30:31]
    v_pk_add_f32 v[124:125], v[124:125], v[16:17]
    v_pk_add_f32 v[128:129], v[128:129], v[32:33]
    v_pk_add_f32 v[124:125], v[124:125], v[18:19]
    v_pk_add_f32 v[128:129], v[128:129], v[34:35]
    v_pk_add_f32 v[124:125], v[124:125], v[20:21]
    v_pk_add_f32 v[128:129], v[128:129], v[36:37]
    v_pk_add_f32 v[124:125], v[124:125], v[22:23]
    v_pk_add_f32 v[128:129], v[128:129], v[38:39]
    v_pk_add_f32 v[124:125], v[124:125], v[24:25]
    v_pk_add_f32 v[128:129], v[128:129], v[40:41]
    v_pk_add_f32 v[124:125], v[124:125], v[26:27]
    v_pk_add_f32 v[128:129], v[128:129], v[42:43]
    v_add_f32 v124, v124, v125
    v_add_f32 v128, v128, v129
    v_mov_b32 v132, v124
    v_mov_b32 v133, v128
    s_nop 0
    v_permlane16_swap_b32 v124, v132
    v_permlane16_swap_b32 v128, v133
    v_add_f32 v124, v124, v132
    v_add_f32 v128, v128, v133
    v_mov_b32 v132, v124
    v_mov_b32 v133, v128
    s_nop 0
    v_permlane32_swap_b32 v124, v132
    v_permlane32_swap_b32 v128, v133
    v_add_f32 v124, v124, v132
    v_add_f32 v128, v128, v133
    v_mul_f32 v124, 0x3c800000, v124
    v_mov_b64 v[126:127], 0
    v_mul_f32 v128, 0x3c800000, v128
    v_mov_b64 v[130:131], 0
    v_pk_add_f32 v[8:9], v[12:13], v[124:125] op_sel_hi:[1,0] neg_lo:[0,1] neg_hi:[0,1]
    v_pk_add_f32 v[10:11], v[28:29], v[128:129] op_sel_hi:[1,0] neg_lo:[0,1] neg_hi:[0,1]
    v_pk_fma_f32 v[126:127], v[8:9], v[8:9], v[126:127]
    v_pk_fma_f32 v[130:131], v[10:11], v[10:11], v[130:131]
    v_pk_add_f32 v[8:9], v[14:15], v[124:125] op_sel_hi:[1,0] neg_lo:[0,1] neg_hi:[0,1]
    v_pk_add_f32 v[10:11], v[30:31], v[128:129] op_sel_hi:[1,0] neg_lo:[0,1] neg_hi:[0,1]
    v_pk_fma_f32 v[126:127], v[8:9], v[8:9], v[126:127]
    v_pk_fma_f32 v[130:131], v[10:11], v[10:11], v[130:131]
    v_pk_add_f32 v[8:9], v[16:17], v[124:125] op_sel_hi:[1,0] neg_lo:[0,1] neg_hi:[0,1]
    v_pk_add_f32 v[10:11], v[32:33], v[128:129] op_sel_hi:[1,0] neg_lo:[0,1] neg_hi:[0,1]
    v_pk_fma_f32 v[126:127], v[8:9], v[8:9], v[126:127]
    v_pk_fma_f32 v[130:131], v[10:11], v[10:11], v[130:131]
    v_pk_add_f32 v[8:9], v[18:19], v[124:125] op_sel_hi:[1,0] neg_lo:[0,1] neg_hi:[0,1]
    v_pk_add_f32 v[10:11], v[34:35], v[128:129] op_sel_hi:[1,0] neg_lo:[0,1] neg_hi:[0,1]
    v_pk_fma_f32 v[126:127], v[8:9], v[8:9], v[126:127]
    v_pk_fma_f32 v[130:131], v[10:11], v[10:11], v[130:131]
    v_pk_add_f32 v[8:9], v[20:21], v[124:125] op_sel_hi:[1,0] neg_lo:[0,1] neg_hi:[0,1]
    v_pk_add_f32 v[10:11], v[36:37], v[128:129] op_sel_hi:[1,0] neg_lo:[0,1] neg_hi:[0,1]
    v_pk_fma_f32 v[126:127], v[8:9], v[8:9], v[126:127]
    v_pk_fma_f32 v[130:131], v[10:11], v[10:11], v[130:131]
    v_pk_add_f32 v[8:9], v[22:23], v[124:125] op_sel_hi:[1,0] neg_lo:[0,1] neg_hi:[0,1]
    v_pk_add_f32 v[10:11], v[38:39], v[128:129] op_sel_hi:[1,0] neg_lo:[0,1] neg_hi:[0,1]
    v_pk_fma_f32 v[126:127], v[8:9], v[8:9], v[126:127]
    v_pk_fma_f32 v[130:131], v[10:11], v[10:11], v[130:131]
    v_pk_add_f32 v[8:9], v[24:25], v[124:125] op_sel_hi:[1,0] neg_lo:[0,1] neg_hi:[0,1]
    v_pk_add_f32 v[10:11], v[40:41], v[128:129] op_sel_hi:[1,0] neg_lo:[0,1] neg_hi:[0,1]
    v_pk_fma_f32 v[126:127], v[8:9], v[8:9], v[126:127]
    v_pk_fma_f32 v[130:131], v[10:11], v[10:11], v[130:131]
    v_pk_add_f32 v[8:9], v[26:27], v[124:125] op_sel_hi:[1,0] neg_lo:[0,1] neg_hi:[0,1]
    v_pk_add_f32 v[10:11], v[42:43], v[128:129] op_sel_hi:[1,0] neg_lo:[0,1] neg_hi:[0,1]
    v_pk_fma_f32 v[126:127], v[8:9], v[8:9], v[126:127]
    v_pk_fma_f32 v[130:131], v[10:11], v[10:11], v[130:131]
    v_add_f32 v125, v126, v127
    v_add_f32 v129, v130, v131
    v_mov_b32 v132, v125
    v_mov_b32 v133, v129
    s_nop 0
    v_permlane16_swap_b32 v125, v132
    v_permlane16_swap_b32 v129, v133
    v_add_f32 v125, v125, v132
    v_add_f32 v129, v129, v133
    v_mov_b32 v132, v125
    v_mov_b32 v133, v129
    s_nop 0
    v_permlane32_swap_b32 v125, v132
    v_permlane32_swap_b32 v129, v133
    v_add_f32 v125, v125, v132
    v_add_f32 v129, v129, v133
    v_min_u32 v124, -2, v124
    v_min_u32 v125, -2, v125
    v_min_u32 v128, -2, v128
    v_min_u32 v129, -2, v129
    s_lshl_b32 s24, s89, 12
    s_add_u32 s24, s24, 173654016
    s_lshl_b32 s25, s88, 3
    s_add_u32 s25, s25, s24
    v_lshlrev_b32 v7, 7, v4
    v_lshl_add_u32 v2, v3, 5, v7
    s_mov_b64 exec, 0xffff
    s_cmp_lg_u32 s23, 0
    s_cbranch_scc1 M_ls_35
    buffer_store_dwordx2 v[124:125], v7, s[8:11], s25 offen offset:0
    buffer_store_dwordx2 v[128:129], v7, s[8:11], s25 offen offset:2048
M_ls_35_r:
    s_mov_b64 exec, -1
    v_cmp_gt_u32_e64 s[36:37], 3, v3
    v_cmp_gt_u32_e64 s[38:39], 2, v3
    s_mov_b32 s34, 0
M_id_poll:
    buffer_load_dwordx4 v[136:139], v2, s[8:11], s24 offen offset:0 sc1
    buffer_load_dwordx4 v[140:143], v2, s[8:11], s24 offen offset:16 sc1
    buffer_load_dwordx4 v[144:147], v2, s[8:11], s24 offen offset:2048 sc1
    buffer_load_dwordx4 v[148:151], v2, s[8:11], s24 offen offset:2064 sc1
    s_add_u32 s34, s34, 1
    s_cmp_ge_u32 s34, 60000
    s_cbranch_scc1 M_fail
    s_waitcnt vmcnt(3)
    v_cndmask_b32_e64 v136, 0, v136, s[36:37]
    v_cndmask_b32_e64 v137, 0, v137, s[36:37]
    v_cndmask_b32_e64 v138, 0, v138, s[36:37]
    v_cndmask_b32_e64 v139, 0, v139, s[36:37]
    s_waitcnt vmcnt(2)
    v_cndmask_b32_e64 v140, 0, v140, s[38:39]
    v_cndmask_b32_e64 v141, 0, v141, s[38:39]
    v_cndmask_b32_e64 v142, 0, v142, s[38:39]
    v_cndmask_b32_e64 v143, 0, v143, s[38:39]
    s_waitcnt vmcnt(1)
    v_cndmask_b32_e64 v144, 0, v144, s[36:37]
    v_cndmask_b32_e64 v145, 0, v145, s[36:37]
    v_cndmask_b32_e64 v146, 0, v146, s[36:37]
    v_cndmask_b32_e64 v147, 0, v147, s[36:37]
    s_waitcnt vmcnt(0)
    v_cndmask_b32_e64 v148, 0, v148, s[38:39]
    v_cndmask_b32_e64 v149, 0, v149, s[38:39]
    v_cndmask_b32_e64 v150, 0, v150, s[38:39]
    v_cndmask_b32_e64 v151, 0, v151, s[38:39]
    v_max3_u32 v8, v136, v137, v138
    v_max3_u32 v8, v8, v139, v140
    v_max3_u32 v8, v8, v141, v142
    v_max3_u32 v8, v8, v143, v144
    v_max3_u32 v8, v8, v145, v146
    v_max3_u32 v8, v8, v147, v148
    v_max3_u32 v8, v8, v149, v150
    v_max_u32 v8, v8, v151
    v_cmp_eq_u32 vcc, -1, v8
    s_cbranch_vccnz M_id_poll
    v_add_f32 v124, v136, v138
    v_add_f32 v125, v140, v142
    v_add_f32 v124, v124, v125
    v_add_f32 v128, v144, v146
    v_add_f32 v129, v148, v150
    v_add_f32 v128, v128, v129
    v_mov_b32 v132, v124
    v_mov_b32 v133, v128
    s_nop 0
    v_permlane16_swap_b32 v124, v132
    v_permlane16_swap_b32 v128, v133
    v_add_f32 v124, v124, v132
    v_add_f32 v128, v128, v133
    v_mov_b32 v132, v124
    v_mov_b32 v133, v128
    s_nop 0
    v_permlane32_swap_b32 v124, v132
    v_permlane32_swap_b32 v128, v133
    v_add_f32 v124, v124, v132
    v_add_f32 v128, v128, v133
    v_mul_f32 v124, 0x3dcccccd, v124
    v_add_f32 v125, v137, v139
    v_add_f32 v126, v141, v143
    v_add_f32 v125, v125, v126
    v_sub_f32 v8, v136, v124
    v_cndmask_b32_e64 v8, 0, v8, s[36:37]
    v_mul_f32 v9, 0x42800000, v8
    v_fmac_f32 v125, v8, v9
    v_sub_f32 v8, v138, v124
    v_cndmask_b32_e64 v8, 0, v8, s[36:37]
    v_mul_f32 v9, 0x42800000, v8
    v_fmac_f32 v125, v8, v9
    v_sub_f32 v8, v140, v124
    v_cndmask_b32_e64 v8, 0, v8, s[38:39]
    v_mul_f32 v9, 0x42800000, v8
    v_fmac_f32 v125, v8, v9
    v_sub_f32 v8, v142, v124
    v_cndmask_b32_e64 v8, 0, v8, s[38:39]
    v_mul_f32 v9, 0x42800000, v8
    v_fmac_f32 v125, v8, v9
    v_mul_f32 v128, 0x3dcccccd, v128
    v_add_f32 v129, v145, v147
    v_add_f32 v130, v149, v151
    v_add_f32 v129, v129, v130
    v_sub_f32 v8, v144, v128
    v_cndmask_b32_e64 v8, 0, v8, s[36:37]
    v_mul_f32 v9, 0x42800000, v8
    v_fmac_f32 v129, v8, v9
    v_sub_f32 v8, v146, v128
    v_cndmask_b32_e64 v8, 0, v8, s[36:37]
    v_mul_f32 v9, 0x42800000, v8
    v_fmac_f32 v129, v8, v9
    v_sub_f32 v8, v148, v128
    v_cndmask_b32_e64 v8, 0, v8, s[38:39]
    v_mul_f32 v9, 0x42800000, v8
    v_fmac_f32 v129, v8, v9
    v_sub_f32 v8, v150, v128
    v_cndmask_b32_e64 v8, 0, v8, s[38:39]
    v_mul_f32 v9, 0x42800000, v8
    v_fmac_f32 v129, v8, v9
    v_mov_b32 v132, v125
    v_mov_b32 v133, v129
    s_nop 0
    v_permlane16_swap_b32 v125, v132
    v_permlane16_swap_b32 v129, v133
    v_add_f32 v125, v125, v132
    v_add_f32 v129, v129, v133
    v_mov_b32 v132, v125
    v_mov_b32 v133, v129
    s_nop 0
    v_permlane32_swap_b32 v125, v132
    v_permlane32_swap_b32 v129, v133
    v_add_f32 v125, v125, v132
    v_add_f32 v129, v129, v133
    v_mov_b32 v126, 0x3727c5ac
    v_fmac_f32 v126, 0x3acccccd, v125
    v_rsq_f32 v126, v126
    v_mov_b32 v130, 0x3727c5ac
    v_fmac_f32 v130, 0x3acccccd, v129
    v_rsq_f32 v130, v130
    s_lshl_b32 s25, s88, 11
    s_add_u32 s25, s25, s29
    s_add_u32 s25, s25, 32505856
    s_add_u32 s24, s25, 20480
    v_pk_add_f32 v[12:13], v[12:13], v[124:125] op_sel_hi:[1,0] neg_lo:[0,1] neg_hi:[0,1]
    v_pk_add_f32 v[14:15], v[14:15], v[124:125] op_sel_hi:[1,0] neg_lo:[0,1] neg_hi:[0,1]
    v_pk_add_f32 v[16:17], v[16:17], v[124:125] op_sel_hi:[1,0] neg_lo:[0,1] neg_hi:[0,1]
    v_pk_add_f32 v[18:19], v[18:19], v[124:125] op_sel_hi:[1,0] neg_lo:[0,1] neg_hi:[0,1]
    v_pk_add_f32 v[20:21], v[20:21], v[124:125] op_sel_hi:[1,0] neg_lo:[0,1] neg_hi:[0,1]
    v_pk_add_f32 v[22:23], v[22:23], v[124:125] op_sel_hi:[1,0] neg_lo:[0,1] neg_hi:[0,1]
    v_pk_add_f32 v[24:25], v[24:25], v[124:125] op_sel_hi:[1,0] neg_lo:[0,1] neg_hi:[0,1]
    v_pk_add_f32 v[26:27], v[26:27], v[124:125] op_sel_hi:[1,0] neg_lo:[0,1] neg_hi:[0,1]
    v_pk_mul_f32 v[12:13], v[12:13], v[126:127] op_sel_hi:[1,0]
    v_pk_mul_f32 v[14:15], v[14:15], v[126:127] op_sel_hi:[1,0]
    v_pk_mul_f32 v[16:17], v[16:17], v[126:127] op_sel_hi:[1,0]
    v_pk_mul_f32 v[18:19], v[18:19], v[126:127] op_sel_hi:[1,0]
    v_pk_mul_f32 v[20:21], v[20:21], v[126:127] op_sel_hi:[1,0]
    v_pk_mul_f32 v[22:23], v[22:23], v[126:127] op_sel_hi:[1,0]
    v_pk_mul_f32 v[24:25], v[24:25], v[126:127] op_sel_hi:[1,0]
    v_pk_mul_f32 v[26:27], v[26:27], v[126:127] op_sel_hi:[1,0]
    v_cvt_pk_bf16_f32 v12, v12, v13
    v_cvt_pk_bf16_f32 v13, v14, v15
    v_cvt_pk_bf16_f32 v14, v16, v17
    v_cvt_pk_bf16_f32 v15, v18, v19
    v_cvt_pk_bf16_f32 v16, v20, v21
    v_cvt_pk_bf16_f32 v17, v22, v23
    v_cvt_pk_bf16_f32 v18, v24, v25
    v_cvt_pk_bf16_f32 v19, v26, v27
    buffer_store_dwordx4 v[12:15], v1, s[8:11], s25 offen offset:0 sc1
    buffer_store_dwordx4 v[16:19], v1, s[8:11], s25 offen offset:1024 sc1
    v_pk_add_f32 v[28:29], v[28:29], v[128:129] op_sel_hi:[1,0] neg_lo:[0,1] neg_hi:[0,1]
    v_pk_add_f32 v[30:31], v[30:31], v[128:129] op_sel_hi:[1,0] neg_lo:[0,1] neg_hi:[0,1]
    v_pk_add_f32 v[32:33], v[32:33], v[128:129] op_sel_hi:[1,0] neg_lo:[0,1] neg_hi:[0,1]
    v_pk_add_f32 v[34:35], v[34:35], v[128:129] op_sel_hi:[1,0] neg_lo:[0,1] neg_hi:[0,1]
    v_pk_add_f32 v[36:37], v[36:37], v[128:129] op_sel_hi:[1,0] neg_lo:[0,1] neg_hi:[0,1]
    v_pk_add_f32 v[38:39], v[38:39], v[128:129] op_sel_hi:[1,0] neg_lo:[0,1] neg_hi:[0,1]
    v_pk_add_f32 v[40:41], v[40:41], v[128:129] op_sel_hi:[1,0] neg_lo:[0,1] neg_hi:[0,1]
    v_pk_add_f32 v[42:43], v[42:43], v[128:129] op_sel_hi:[1,0] neg_lo:[0,1] neg_hi:[0,1]
    v_pk_mul_f32 v[28:29], v[28:29], v[130:131] op_sel_hi:[1,0]
    v_pk_mul_f32 v[30:31], v[30:31], v[130:131] op_sel_hi:[1,0]
    v_pk_mul_f32 v[32:33], v[32:33], v[130:131] op_sel_hi:[1,0]
    v_pk_mul_f32 v[34:35], v[34:35], v[130:131] op_sel_hi:[1,0]
    v_pk_mul_f32 v[36:37], v[36:37], v[130:131] op_sel_hi:[1,0]
    v_pk_mul_f32 v[38:39], v[38:39], v[130:131] op_sel_hi:[1,0]
    v_pk_mul_f32 v[40:41], v[40:41], v[130:131] op_sel_hi:[1,0]
    v_pk_mul_f32 v[42:43], v[42:43], v[130:131] op_sel_hi:[1,0]
    v_cvt_pk_bf16_f32 v28, v28, v29
    v_cvt_pk_bf16_f32 v29, v30, v31
    v_cvt_pk_bf16_f32 v30, v32, v33
    v_cvt_pk_bf16_f32 v31, v34, v35
    v_cvt_pk_bf16_f32 v32, v36, v37
    v_cvt_pk_bf16_f32 v33, v38, v39
    v_cvt_pk_bf16_f32 v34, v40, v41
    v_cvt_pk_bf16_f32 v35, v42, v43
    buffer_store_dwordx4 v[28:31], v1, s[8:11], s24 offen offset:0 sc1
    buffer_store_dwordx4 v[32:35], v1, s[8:11], s24 offen offset:1024 sc1
M_id_out:
    buffer_store_dwordx4 v[104:107], v5, s[16:19], s30 offen offset:0 sc1
    buffer_store_dwordx4 v[108:111], v5, s[16:19], s30 offen offset:64 sc1
    buffer_store_dwordx4 v[112:115], v5, s[16:19], s33 offen offset:0 sc1
    buffer_store_dwordx4 v[116:119], v5, s[16:19], s33 offen offset:64 sc1
    s_cmp_eq_u32 s101, 1
    s_cbranch_scc1 M_end
    s_lshl_b32 s24, s89, 7
    s_lshl_b32 s25, s88, 2
    s_add_u32 s24, s24, s25
    s_add_u32 s24, s24, 167919616
    v_mov_b32 v8, 1
    s_waitcnt vmcnt(0)
    s_mov_b64 exec, 1
    buffer_store_dword v8, v1, s[8:11], s24 offen sc1
    s_mov_b64 exec, -1
M_noid:
    s_add_u32 s20, s82, 2
    s_mov_b32 s21, s83
    s_mov_b32 s22, s84
    s_mov_b32 s23, s85
    s_cmp_eq_u32 s101, 1
    s_cbranch_scc1 M_end
    s_mov_b32 s101, 1
    v_mbcnt_lo_u32_b32 v0, -1, 0
    v_mbcnt_hi_u32_b32 v0, -1, v0
    v_lshlrev_b32 v0, 4, v0
    s_waitcnt lgkmcnt(0)
    s_barrier
    s_branch M_bulk
M_ls_10:
    s_nop 7
    buffer_store_byte v11, v10, s[8:11], s62 offen sc1
    s_branch M_ls_10_r
M_ls_13:
    s_nop 7
    buffer_store_dwordx4 v[64:67], v4, s[8:11], s48 offen offset:0 sc1
    buffer_store_dwordx4 v[72:75], v4, s[8:11], s27 offen offset:0 sc1
    s_branch M_ls_13_r
M_ls_14:
    s_nop 7
    buffer_store_dwordx4 v[80:83], v4, s[8:11], s48 offen offset:64 sc1
    buffer_store_dwordx4 v[88:91], v4, s[8:11], s27 offen offset:64 sc1
    s_branch M_ls_14_r
M_ls_15:
    s_nop 7
    buffer_store_dwordx4 v[96:99], v4, s[8:11], s48 offen offset:128 sc1
    buffer_store_dwordx4 v[104:107], v4, s[8:11], s27 offen offset:128 sc1
    s_branch M_ls_15_r
M_ls_16:
    s_nop 7
    buffer_store_dwordx4 v[112:115], v4, s[8:11], s48 offen offset:192 sc1
    buffer_store_dwordx4 v[120:123], v4, s[8:11], s27 offen offset:192 sc1
    s_branch M_ls_16_r
M_ls_17:
    s_nop 7
    buffer_store_dwordx4 v[128:131], v4, s[8:11], s48 offen offset:256 sc1
    buffer_store_dwordx4 v[136:139], v4, s[8:11], s27 offen offset:256 sc1
    s_branch M_ls_17_r
M_ls_18:
    s_nop 7
    buffer_store_byte v11, v10, s[8:11], s62 offen sc1
    s_branch M_ls_18_r
M_ls_21:
    s_nop 7
    s_mov_b32 exec_hi, 0
    buffer_store_dwordx2 v[72:73], v12, s[8:11], s63 offen sc1
    s_mov_b32 exec_lo, 0x000f000f
    buffer_store_dwordx2 v[74:75], v12, s[8:11], s64 offen sc1
    s_mov_b64 exec, -1
    s_branch M_ls_21_r
M_ls_22:
    s_nop 7
    buffer_store_byte v11, v10, s[8:11], s62 offen sc1
    s_branch M_ls_22_r
M_ls_32:
    s_nop 7
    buffer_store_byte v191, v190, s[8:11], s28 offen sc1
    s_branch M_ls_32_r
M_ls_35:
    s_nop 7
    buffer_store_dwordx2 v[124:125], v7, s[8:11], s25 offen offset:0 sc1
    buffer_store_dwordx2 v[128:129], v7, s[8:11], s25 offen offset:2048 sc1
    s_branch M_ls_35_r
M_fail:
    s_mov_b64 exec, 1
    v_mov_b32 v12, 1
    v_mov_b32 v13, 48
    buffer_atomic_add v12, v13, s[12:15], 0 offen
M_end:
    s_endpgm

.section .rodata,"a"
.p2align 6
.amdhsa_kernel interleave_layers__memory_aug_recurrent_mem_tr__spectral_gfnet__prompt_kernel
  .amdhsa_next_free_vgpr 512
  .amdhsa_next_free_sgpr 102
  .amdhsa_accum_offset 256
  .amdhsa_group_segment_fixed_size 0
  .amdhsa_kernarg_size 104
  .amdhsa_user_sgpr_count 2
  .amdhsa_user_sgpr_kernarg_segment_ptr 1
  .amdhsa_system_sgpr_workgroup_id_x 1
  .amdhsa_float_denorm_mode_32 3
  .amdhsa_float_denorm_mode_16_64 3
.end_amdhsa_kernel
```

```asm
; @launch kernel=interleave_layers__memory_aug_recurrent_mem_tr__spectral_gfnet__prompt_kernel grid=(256,1,1) block=(256,1,1) lds=163840
.amdgcn_target "amdgcn-amd-amdhsa--gfx950"
.text
.globl interleave_layers__memory_aug_recurrent_mem_tr__spectral_gfnet__prompt_kernel
.p2align 8
.type interleave_layers__memory_aug_recurrent_mem_tr__spectral_gfnet__prompt_kernel,@function
interleave_layers__memory_aug_recurrent_mem_tr__spectral_gfnet__prompt_kernel:
    s_cmp_ge_u32 s2, 256
    s_cbranch_scc1 M_end
    s_load_dwordx2 s[16:17], s[0:1], 0
    s_load_dwordx2 s[8:9], s[0:1], 96
    s_load_dwordx2 s[12:13], s[0:1], 88
    s_load_dwordx2 s[72:73], s[0:1], 16
    s_load_dwordx2 s[76:77], s[0:1], 24
    s_load_dwordx2 s[80:81], s[0:1], 32
    s_load_dwordx2 s[84:85], s[0:1], 40
    s_load_dwordx2 s[68:69], s[0:1], 8
    s_getreg_b32 s24, hwreg(HW_REG_XCC_ID)
    s_and_b32 s24, s24, 7
    s_getpc_b64 s[26:27]
M_cpf:
    s_lshr_b32 s28, s2, 3
    s_lshl_b32 s28, s28, 8
    v_add_u32 v13, s28, v0
    v_lshlrev_b32 v13, 6, v13
    v_cmp_gt_u32 vcc, M_end - M_cpf, v13
    s_and_saveexec_b64 s[28:29], vcc
    s_cbranch_execz M_cpfd
    global_load_dword v14, v13, s[26:27]
M_cpfd:
    s_mov_b64 exec, s[28:29]
    v_lshrrev_b32 v12, 6, v0
    v_and_b32 v0, 63, v0
    v_readfirstlane_b32 s21, v12
    v_lshlrev_b32 v0, 4, v0
    s_waitcnt lgkmcnt(0)
    s_and_b32 s9, s9, 0xffff
    s_mov_b32 s10, 268435456
    s_mov_b32 s11, 0x00020000
    s_and_b32 s13, s13, 0xffff
    s_mov_b32 s14, 256
    s_mov_b32 s15, 0x00020000
    s_and_b32 s17, s17, 0xffff
    s_mov_b32 s18, 2621440
    s_mov_b32 s19, 0x00020000
    s_and_b32 s73, s73, 0xffff
    s_mov_b32 s74, 5242880
    s_mov_b32 s75, 0x00020000
    s_and_b32 s77, s77, 0xffff
    s_mov_b32 s78, 5242880
    s_mov_b32 s79, 0x00020000
    s_and_b32 s81, s81, 0xffff
    s_mov_b32 s82, 5242880
    s_mov_b32 s83, 0x00020000
    s_and_b32 s85, s85, 0xffff
    s_mov_b32 s86, 5242880
    s_mov_b32 s87, 0x00020000
    s_and_b32 s69, s69, 0xffff
    s_mov_b32 s70, 10240
    s_mov_b32 s71, 0x00020000
    s_mov_b32 s5, 0
    s_mov_b32 s101, 0
    s_cmp_eq_u32 s21, 0
    s_cbranch_scc1 M_tick
    s_cmp_eq_u32 s21, 3
    s_cbranch_scc1 M_zero
    v_mov_b32 v28, -1
    v_mov_b32 v29, -1
    v_mov_b32 v30, -1
    v_mov_b32 v31, -1
    s_lshl_b32 s26, s2, 1
    s_add_u32 s26, s26, s21
    s_lshl_b32 s26, s26, 12
    s_add_u32 s26, s26, 171962368
    buffer_store_dwordx4 v[28:31], v0, s[8:11], s26 offen offset:0 sc1
    buffer_store_dwordx4 v[28:31], v0, s[8:11], s26 offen offset:1024 sc1
    buffer_store_dwordx4 v[28:31], v0, s[8:11], s26 offen offset:2048 sc1
    buffer_store_dwordx4 v[28:31], v0, s[8:11], s26 offen offset:3072 sc1
    s_branch M_notick
M_zero:
    v_mov_b32 v28, 0
    v_mov_b32 v29, 0
    v_mov_b32 v30, 0
    v_mov_b32 v31, 0
    s_lshl_b32 s26, s2, 9
    s_add_u32 s26, s26, 167837696
    s_mov_b32 exec_hi, 0
    buffer_store_dwordx4 v[28:31], v0, s[8:11], s26 offen sc1
    s_mov_b64 exec, -1
    s_cmp_ge_u32 s2, 10
    s_cbranch_scc1 M_notick
    v_bfe_u32 v6, v0, 4, 3
    v_mul_u32_u24 v6, 1280, v6
    v_lshrrev_b32 v7, 8, v0
    v_lshl_add_u32 v6, v7, 5, v6
    v_bfe_u32 v7, v0, 7, 1
    v_lshl_add_u32 v6, v7, 2, v6
    s_lshl_b32 s26, s2, 7
    buffer_load_dword v32, v6, s[68:71], s26 offen offset:0
    buffer_load_dword v33, v6, s[68:71], s26 offen offset:8
    buffer_load_dword v34, v6, s[68:71], s26 offen offset:16
    buffer_load_dword v35, v6, s[68:71], s26 offen offset:24
    v_and_b32 v7, 0x200, v0
    v_bfe_u32 v12, v0, 6, 1
    v_lshl_or_b32 v7, v12, 8, v7
    v_bfe_u32 v12, v0, 4, 1
    v_lshl_or_b32 v7, v12, 7, v7
    v_bfe_u32 v12, v0, 5, 1
    v_lshl_or_b32 v7, v12, 6, v7
    v_bfe_u32 v12, v0, 8, 1
    v_lshl_or_b32 v7, v12, 5, v7
    v_bfe_u32 v12, v0, 7, 1
    v_lshl_or_b32 v7, v12, 4, v7
    s_lshl_b32 s26, s2, 10
    s_add_u32 s26, s26, 167772160
    s_waitcnt vmcnt(0)
    v_min_u32 v32, -2, v32
    v_min_u32 v33, -2, v33
    v_min_u32 v34, -2, v34
    v_min_u32 v35, -2, v35
    buffer_store_dwordx4 v[32:35], v7, s[8:11], s26 offen sc1
    s_branch M_notick
M_tick:
    s_and_b32 s25, s24, 5
    s_cmp_lg_u32 s25, 1
    s_cbranch_scc1 M_nocal
    s_bfe_u32 s25, s2, 0x20003
    s_lshl_b32 s26, s25, 13
    s_lshr_b32 s27, s2, 5
    s_lshl_b32 s27, s27, 15
    s_add_u32 s26, s26, s27
    s_lshl_b32 s27, s24, 8
    s_add_u32 s26, s26, s27
    s_add_u32 s26, s26, 171966464
    v_mov_b32 v28, -1
    v_mov_b32 v29, -1
    v_mov_b32 v30, -1
    v_mov_b32 v31, -1
    s_mov_b64 exec, 0xff
    s_mov_b32 s27, -1
    s_waitcnt vmcnt(0)
    s_memtime s[28:29]
    buffer_store_dwordx4 v[28:31], v0, s[8:11], s26 offen sc1
    s_waitcnt vmcnt(0)
    s_memtime s[30:31]
    s_waitcnt lgkmcnt(0)
    s_sub_u32 s28, s30, s28
    s_min_u32 s27, s27, s28
    s_memtime s[28:29]
    buffer_store_dwordx4 v[28:31], v0, s[8:11], s26 offen sc1
    s_waitcnt vmcnt(0)
    s_memtime s[30:31]
    s_waitcnt lgkmcnt(0)
    s_sub_u32 s28, s30, s28
    s_min_u32 s27, s27, s28
    s_memtime s[28:29]
    buffer_store_dwordx4 v[28:31], v0, s[8:11], s26 offen sc1
    s_waitcnt vmcnt(0)
    s_memtime s[30:31]
    s_waitcnt lgkmcnt(0)
    s_sub_u32 s28, s30, s28
    s_min_u32 s27, s27, s28
    s_memtime s[28:29]
    buffer_store_dwordx4 v[28:31], v0, s[8:11], s26 offen sc1
    s_waitcnt vmcnt(0)
    s_memtime s[30:31]
    s_waitcnt lgkmcnt(0)
    s_sub_u32 s28, s30, s28
    s_min_u32 s27, s27, s28
    s_mov_b64 exec, 1
    s_min_u32 s27, s27, 0xffff
    s_sub_u32 s27, 0x10000, s27
    s_lshl_b32 s27, s27, 2
    s_or_b32 s27, s27, s25
    v_mov_b32 v28, s27
    v_mov_b32 v29, 60
    buffer_atomic_umax v28, v29, s[12:15], 0 offen
M_nocal:
    s_mov_b64 exec, 1
    v_mov_b32 v28, 1
    s_lshl_b32 s25, s24, 2
    v_mov_b32 v29, s25
    buffer_atomic_add v28, v29, s[12:15], 0 offen sc0
    s_mov_b64 exec, -1
M_notick:
    s_lshl_b32 s20, s24, 2
    s_lshr_b32 s20, 0x76524130, s20
    s_and_b32 s20, s20, 7
    s_lshr_b32 s26, s2, 3
    v_lshrrev_b32 v6, 4, v0
    s_cmp_eq_u32 s20, 2
    s_cbranch_scc1 M_pf_kv
    s_mul_i32 s26, s26, 163840
    s_mul_i32 s27, s20, 640
    s_add_u32 s26, s26, s27
    s_and_b32 s27, s21, 1
    s_mul_i32 s27, s27, 81920
    s_add_u32 s26, s26, s27
    s_lshr_b32 s27, s21, 1
    s_mul_i32 s27, s27, 384
    s_add_u32 s26, s26, s27
    s_cmp_lt_u32 s20, 2
    s_cselect_b32 s26, s26, 0x10000000
    v_mul_u32_u24 v6, 1280, v6
    buffer_load_dword v3, v6, s[84:87], s26 offen offset:0 sc1
    buffer_load_dword v3, v6, s[84:87], s26 offen offset:128 sc1
    buffer_load_dword v3, v6, s[84:87], s26 offen offset:256 sc1
    s_branch M_pf_d
M_pf_kv:
    s_lshl_b32 s26, s26, 8
    s_lshl_b32 s27, s21, 18
    s_add_u32 s26, s26, s27
    v_lshrrev_b32 v7, 1, v6
    v_lshlrev_b32 v7, 13, v7
    v_and_b32 v6, 1, v6
    v_lshl_add_u32 v6, v6, 7, v7
    buffer_load_dword v3, v6, s[76:79], s26 offen sc1
    s_add_u32 s26, s26, 1048576
    buffer_load_dword v3, v6, s[76:79], s26 offen sc1
    s_add_u32 s26, s26, 1048576
    buffer_load_dword v3, v6, s[76:79], s26 offen sc1
    s_add_u32 s26, s26, 1048576
M_pf_d:
    s_waitcnt vmcnt(3)
    s_cmp_lg_u32 s21, 0
    s_cbranch_scc1 M_notick2
    s_mov_b64 exec, 1
    v_mov_b32 v29, 23296
    ds_write_b32 v29, v28
    s_waitcnt lgkmcnt(0)
    s_mov_b64 exec, -1
M_notick2:
    s_barrier
    s_cmp_lg_u32 s21, 0
    s_cbranch_scc1 M_noarr
    s_mov_b64 exec, 1
    v_mov_b32 v30, 1
    v_mov_b32 v29, 32
    buffer_atomic_add v30, v29, s[12:15], 0 offen
    s_mov_b64 exec, -1
M_noarr:
    v_mov_b32 v29, 23296
    ds_read_b32 v28, v29
    s_waitcnt lgkmcnt(0)
    v_readfirstlane_b32 s25, v28
    s_and_b32 s22, s25, 31
    s_mov_b32 s23, 0
    s_mov_b32 s32, 0
    s_cmp_ge_u32 s20, 3
    s_cbranch_scc1 M_lw_done
M_loadw:
    s_barrier
    s_cmp_lt_u32 s20, 2
    s_cbranch_scc1 M_lw_chain
    s_cmp_lt_u32 s20, 4
    s_cbranch_scc1 M_lw_bulk
    s_lshl_b32 s34, s22, 2
    s_add_u32 s34, s34, s20
    s_sub_u32 s34, s34, 4
    s_mov_b32 s92, s33
    s_mov_b32 s33, s21
    v_lshrrev_b32 v1, 4, v0
    v_lshrrev_b32 v3, 8, v0
    v_and_b32 v4, 15, v1
    v_mov_b32 v5, v0
    v_mul_u32_u24 v6, 1280, v4
    v_lshl_add_u32 v6, v3, 4, v6
    s_mul_i32 s36, s34, 20480
    s_mul_i32 s35, s33, 320
    s_add_u32 s36, s36, s35
    buffer_load_dwordx4 v[8:11], v6, s[16:19], s36 offen offset:0
    buffer_load_dwordx4 v[12:15], v6, s[16:19], s36 offen offset:64
    buffer_load_dwordx4 v[16:19], v6, s[16:19], s36 offen offset:128
    buffer_load_dwordx4 v[20:23], v6, s[16:19], s36 offen offset:192
    buffer_load_dwordx4 v[24:27], v6, s[16:19], s36 offen offset:256
    s_waitcnt vmcnt(4)
    v_lshlrev_b32 v32, 16, v8
    v_and_b32 v33, 0xffff0000, v8
    v_lshlrev_b32 v34, 16, v9
    v_and_b32 v35, 0xffff0000, v9
    v_lshlrev_b32 v36, 16, v10
    v_and_b32 v37, 0xffff0000, v10
    v_lshlrev_b32 v38, 16, v11
    v_and_b32 v39, 0xffff0000, v11
    s_waitcnt vmcnt(3)
    v_lshlrev_b32 v40, 16, v12
    v_and_b32 v41, 0xffff0000, v12
    v_lshlrev_b32 v42, 16, v13
    v_and_b32 v43, 0xffff0000, v13
    v_lshlrev_b32 v44, 16, v14
    v_and_b32 v45, 0xffff0000, v14
    v_lshlrev_b32 v46, 16, v15
    v_and_b32 v47, 0xffff0000, v15
    s_waitcnt vmcnt(2)
    v_lshlrev_b32 v48, 16, v16
    v_and_b32 v49, 0xffff0000, v16
    v_lshlrev_b32 v50, 16, v17
    v_and_b32 v51, 0xffff0000, v17
    v_lshlrev_b32 v52, 16, v18
    v_and_b32 v53, 0xffff0000, v18
    v_lshlrev_b32 v54, 16, v19
    v_and_b32 v55, 0xffff0000, v19
    s_waitcnt vmcnt(1)
    v_lshlrev_b32 v56, 16, v20
    v_and_b32 v57, 0xffff0000, v20
    v_lshlrev_b32 v58, 16, v21
    v_and_b32 v59, 0xffff0000, v21
    v_lshlrev_b32 v60, 16, v22
    v_and_b32 v61, 0xffff0000, v22
    v_lshlrev_b32 v62, 16, v23
    v_and_b32 v63, 0xffff0000, v23
    s_waitcnt vmcnt(0)
    v_lshlrev_b32 v64, 16, v24
    v_and_b32 v65, 0xffff0000, v24
    v_lshlrev_b32 v66, 16, v25
    v_and_b32 v67, 0xffff0000, v25
    v_lshlrev_b32 v68, 16, v26
    v_and_b32 v69, 0xffff0000, v26
    v_lshlrev_b32 v70, 16, v27
    v_and_b32 v71, 0xffff0000, v27
    v_add_f32 v72, v32, v33
    v_add_f32 v72, v72, v34
    v_add_f32 v72, v72, v35
    v_add_f32 v72, v72, v36
    v_add_f32 v72, v72, v37
    v_add_f32 v72, v72, v38
    v_add_f32 v72, v72, v39
    v_add_f32 v72, v72, v40
    v_add_f32 v72, v72, v41
    v_add_f32 v72, v72, v42
    v_add_f32 v72, v72, v43
    v_add_f32 v72, v72, v44
    v_add_f32 v72, v72, v45
    v_add_f32 v72, v72, v46
    v_add_f32 v72, v72, v47
    v_add_f32 v72, v72, v48
    v_add_f32 v72, v72, v49
    v_add_f32 v72, v72, v50
    v_add_f32 v72, v72, v51
    v_add_f32 v72, v72, v52
    v_add_f32 v72, v72, v53
    v_add_f32 v72, v72, v54
    v_add_f32 v72, v72, v55
    v_add_f32 v72, v72, v56
    v_add_f32 v72, v72, v57
    v_add_f32 v72, v72, v58
    v_add_f32 v72, v72, v59
    v_add_f32 v72, v72, v60
    v_add_f32 v72, v72, v61
    v_add_f32 v72, v72, v62
    v_add_f32 v72, v72, v63
    v_add_f32 v72, v72, v64
    v_add_f32 v72, v72, v65
    v_add_f32 v72, v72, v66
    v_add_f32 v72, v72, v67
    v_add_f32 v72, v72, v68
    v_add_f32 v72, v72, v69
    v_add_f32 v72, v72, v70
    v_add_f32 v72, v72, v71
    v_lshlrev_b32 v77, 4, v4
    s_lshl_b32 s35, s33, 2
    v_add_u32 v76, s35, v77
    v_mov_b32 v73, v72
    s_nop 1
    v_permlane16_swap_b32 v72, v73
    v_add_f32 v72, v72, v73
    v_mov_b32 v73, v72
    s_nop 1
    v_permlane32_swap_b32 v72, v73
    v_add_f32 v72, v72, v73
    ds_write_b32 v76, v72 offset:0
    s_waitcnt lgkmcnt(0)
    s_barrier
    ds_read_b128 v[80:83], v77 offset:0
    s_waitcnt lgkmcnt(0)
    v_add_f32 v80, v80, v81
    v_add_f32 v82, v82, v83
    v_add_f32 v72, v80, v82
    v_mul_f32 v72, 0x3acccccd, v72
    v_sub_f32 v32, v32, v72
    v_sub_f32 v33, v33, v72
    v_sub_f32 v34, v34, v72
    v_sub_f32 v35, v35, v72
    v_sub_f32 v36, v36, v72
    v_sub_f32 v37, v37, v72
    v_sub_f32 v38, v38, v72
    v_sub_f32 v39, v39, v72
    v_sub_f32 v40, v40, v72
    v_sub_f32 v41, v41, v72
    v_sub_f32 v42, v42, v72
    v_sub_f32 v43, v43, v72
    v_sub_f32 v44, v44, v72
    v_sub_f32 v45, v45, v72
    v_sub_f32 v46, v46, v72
    v_sub_f32 v47, v47, v72
    v_sub_f32 v48, v48, v72
    v_sub_f32 v49, v49, v72
    v_sub_f32 v50, v50, v72
    v_sub_f32 v51, v51, v72
    v_sub_f32 v52, v52, v72
    v_sub_f32 v53, v53, v72
    v_sub_f32 v54, v54, v72
    v_sub_f32 v55, v55, v72
    v_sub_f32 v56, v56, v72
    v_sub_f32 v57, v57, v72
    v_sub_f32 v58, v58, v72
    v_sub_f32 v59, v59, v72
    v_sub_f32 v60, v60, v72
    v_sub_f32 v61, v61, v72
    v_sub_f32 v62, v62, v72
    v_sub_f32 v63, v63, v72
    v_sub_f32 v64, v64, v72
    v_sub_f32 v65, v65, v72
    v_sub_f32 v66, v66, v72
    v_sub_f32 v67, v67, v72
    v_sub_f32 v68, v68, v72
    v_sub_f32 v69, v69, v72
    v_sub_f32 v70, v70, v72
    v_sub_f32 v71, v71, v72
    v_mul_f32 v74, v32, v32
    v_fmac_f32 v74, v33, v33
    v_fmac_f32 v74, v34, v34
    v_fmac_f32 v74, v35, v35
    v_fmac_f32 v74, v36, v36
    v_fmac_f32 v74, v37, v37
    v_fmac_f32 v74, v38, v38
    v_fmac_f32 v74, v39, v39
    v_fmac_f32 v74, v40, v40
    v_fmac_f32 v74, v41, v41
    v_fmac_f32 v74, v42, v42
    v_fmac_f32 v74, v43, v43
    v_fmac_f32 v74, v44, v44
    v_fmac_f32 v74, v45, v45
    v_fmac_f32 v74, v46, v46
    v_fmac_f32 v74, v47, v47
    v_fmac_f32 v74, v48, v48
    v_fmac_f32 v74, v49, v49
    v_fmac_f32 v74, v50, v50
    v_fmac_f32 v74, v51, v51
    v_fmac_f32 v74, v52, v52
    v_fmac_f32 v74, v53, v53
    v_fmac_f32 v74, v54, v54
    v_fmac_f32 v74, v55, v55
    v_fmac_f32 v74, v56, v56
    v_fmac_f32 v74, v57, v57
    v_fmac_f32 v74, v58, v58
    v_fmac_f32 v74, v59, v59
    v_fmac_f32 v74, v60, v60
    v_fmac_f32 v74, v61, v61
    v_fmac_f32 v74, v62, v62
    v_fmac_f32 v74, v63, v63
    v_fmac_f32 v74, v64, v64
    v_fmac_f32 v74, v65, v65
    v_fmac_f32 v74, v66, v66
    v_fmac_f32 v74, v67, v67
    v_fmac_f32 v74, v68, v68
    v_fmac_f32 v74, v69, v69
    v_fmac_f32 v74, v70, v70
    v_fmac_f32 v74, v71, v71
    v_mov_b32 v73, v74
    s_nop 1
    v_permlane16_swap_b32 v74, v73
    v_add_f32 v74, v74, v73
    v_mov_b32 v73, v74
    s_nop 1
    v_permlane32_swap_b32 v74, v73
    v_add_f32 v74, v74, v73
    ds_write_b32 v76, v74 offset:512
    s_waitcnt lgkmcnt(0)
    s_barrier
    ds_read_b128 v[80:83], v77 offset:512
    s_waitcnt lgkmcnt(0)
    v_add_f32 v80, v80, v81
    v_add_f32 v82, v82, v83
    v_add_f32 v74, v80, v82
    v_mov_b32 v75, 0x3727c5ac
    v_fmac_f32 v75, 0x3acccccd, v74
    v_rsq_f32 v75, v75
    s_nop 0
    v_mul_f32 v32, v32, v75
    v_mul_f32 v33, v33, v75
    v_mul_f32 v34, v34, v75
    v_mul_f32 v35, v35, v75
    v_mul_f32 v36, v36, v75
    v_mul_f32 v37, v37, v75
    v_mul_f32 v38, v38, v75
    v_mul_f32 v39, v39, v75
    v_mul_f32 v40, v40, v75
    v_mul_f32 v41, v41, v75
    v_mul_f32 v42, v42, v75
    v_mul_f32 v43, v43, v75
    v_mul_f32 v44, v44, v75
    v_mul_f32 v45, v45, v75
    v_mul_f32 v46, v46, v75
    v_mul_f32 v47, v47, v75
    v_mul_f32 v48, v48, v75
    v_mul_f32 v49, v49, v75
    v_mul_f32 v50, v50, v75
    v_mul_f32 v51, v51, v75
    v_mul_f32 v52, v52, v75
    v_mul_f32 v53, v53, v75
    v_mul_f32 v54, v54, v75
    v_mul_f32 v55, v55, v75
    v_mul_f32 v56, v56, v75
    v_mul_f32 v57, v57, v75
    v_mul_f32 v58, v58, v75
    v_mul_f32 v59, v59, v75
    v_mul_f32 v60, v60, v75
    v_mul_f32 v61, v61, v75
    v_mul_f32 v62, v62, v75
    v_mul_f32 v63, v63, v75
    v_mul_f32 v64, v64, v75
    v_mul_f32 v65, v65, v75
    v_mul_f32 v66, v66, v75
    v_mul_f32 v67, v67, v75
    v_mul_f32 v68, v68, v75
    v_mul_f32 v69, v69, v75
    v_mul_f32 v70, v70, v75
    v_mul_f32 v71, v71, v75
    v_cvt_pk_bf16_f32 v8, v32, v33
    v_cvt_pk_bf16_f32 v9, v34, v35
    v_cvt_pk_bf16_f32 v10, v36, v37
    v_cvt_pk_bf16_f32 v11, v38, v39
    v_cvt_pk_bf16_f32 v12, v40, v41
    v_cvt_pk_bf16_f32 v13, v42, v43
    v_cvt_pk_bf16_f32 v14, v44, v45
    v_cvt_pk_bf16_f32 v15, v46, v47
    v_cvt_pk_bf16_f32 v16, v48, v49
    v_cvt_pk_bf16_f32 v17, v50, v51
    v_cvt_pk_bf16_f32 v18, v52, v53
    v_cvt_pk_bf16_f32 v19, v54, v55
    v_cvt_pk_bf16_f32 v20, v56, v57
    v_cvt_pk_bf16_f32 v21, v58, v59
    v_cvt_pk_bf16_f32 v22, v60, v61
    v_cvt_pk_bf16_f32 v23, v62, v63
    v_cvt_pk_bf16_f32 v24, v64, v65
    v_cvt_pk_bf16_f32 v25, v66, v67
    v_cvt_pk_bf16_f32 v26, v68, v69
    v_cvt_pk_bf16_f32 v27, v70, v71
    s_mul_i32 s36, s34, 20480
    s_mul_i32 s35, s33, 5120
    s_add_u32 s36, s36, s35
    s_add_u32 s36, s36, 29360128
    s_add_u32 s35, s36, 4096
    buffer_store_dwordx4 v[8:11], v5, s[8:11], s36 offen offset:0 sc1
    buffer_store_dwordx4 v[12:15], v5, s[8:11], s36 offen offset:1024 sc1
    buffer_store_dwordx4 v[16:19], v5, s[8:11], s36 offen offset:2048 sc1
    buffer_store_dwordx4 v[20:23], v5, s[8:11], s36 offen offset:3072 sc1
    buffer_store_dwordx4 v[24:27], v5, s[8:11], s35 offen offset:0 sc1
    s_mov_b32 s33, s92
    s_waitcnt vmcnt(0)
    s_barrier
    s_cmp_lg_u32 s21, 0
    s_cbranch_scc1 M_lw_bulk
    s_lshr_b32 s27, s34, 1
    s_lshl_b32 s27, s27, 7
    s_and_b32 s28, s34, 1
    s_mul_i32 s28, s28, 20
    s_add_u32 s27, s27, s28
    s_add_u32 s27, s27, 167911424
    v_lshrrev_b32 v12, 2, v0
    v_mov_b32 v13, 1
    s_mov_b64 exec, 31
    buffer_store_dword v13, v12, s[8:11], s27 offen sc1
    s_mov_b64 exec, -1
M_lw_bulk:
    v_lshrrev_b32 v12, 8, v0
    v_lshlrev_b32 v12, 16, v12
    v_and_b32 v14, 0xf0, v0
    v_add_u32 v12, v12, v14
    s_lshl_b32 s46, s22, 8
    s_lshl_b32 s27, s21, 13
    v_add_u32 v4, s27, v0
    v_add_u32 v5, 32768, v4
    s_cmp_eq_u32 s20, 2
    s_cbranch_scc1 M_bl_kv
    s_mul_i32 s27, s21, 40960
    v_add_u32 v7, s27, v0
    v_lshrrev_b32 v8, 8, v0
    v_mul_u32_u24 v8, 40960, v8
    s_lshl_b32 s47, s22, 6
    s_add_u32 s47, s47, s21
    s_mul_i32 s47, s47, 2560
    v_and_b32 v14, 0xf0, v0
    v_add_u32 v8, v8, v14
    s_mov_b32 s44, 0x05040100
    s_mov_b32 s45, 0x07060302
    s_add_u32 s27, s47, 0
    buffer_load_dwordx4 v[16:19], v8, s[84:87], s27 offen
    s_add_u32 s27, s47, 1280
    buffer_load_dwordx4 v[20:23], v8, s[84:87], s27 offen
    s_add_u32 s27, s47, 10240
    buffer_load_dwordx4 v[24:27], v8, s[84:87], s27 offen
    s_add_u32 s27, s47, 11520
    buffer_load_dwordx4 v[28:31], v8, s[84:87], s27 offen
    s_add_u32 s27, s47, 20480
    buffer_load_dwordx4 v[32:35], v8, s[84:87], s27 offen
    s_add_u32 s27, s47, 21760
    buffer_load_dwordx4 v[36:39], v8, s[84:87], s27 offen
    s_add_u32 s27, s47, 30720
    buffer_load_dwordx4 v[40:43], v8, s[84:87], s27 offen
    s_add_u32 s27, s47, 32000
    buffer_load_dwordx4 v[44:47], v8, s[84:87], s27 offen
    s_add_u32 s27, s47, 256
    buffer_load_dwordx4 v[48:51], v8, s[84:87], s27 offen
    s_add_u32 s27, s47, 1536
    buffer_load_dwordx4 v[52:55], v8, s[84:87], s27 offen
    s_add_u32 s27, s47, 10496
    buffer_load_dwordx4 v[56:59], v8, s[84:87], s27 offen
    s_add_u32 s27, s47, 11776
    buffer_load_dwordx4 v[60:63], v8, s[84:87], s27 offen
    s_add_u32 s27, s47, 20736
    buffer_load_dwordx4 v[64:67], v8, s[84:87], s27 offen
    s_add_u32 s27, s47, 22016
    buffer_load_dwordx4 v[68:71], v8, s[84:87], s27 offen
    s_add_u32 s27, s47, 30976
    buffer_load_dwordx4 v[72:75], v8, s[84:87], s27 offen
    s_add_u32 s27, s47, 32256
    buffer_load_dwordx4 v[76:79], v8, s[84:87], s27 offen
    v_and_b32 v13, 0x300, v0
    s_lshl_b32 s27, s21, 10
    s_add_u32 s27, s27, 0
    v_add_u32 v13, s27, v13
    v_bfe_u32 v14, v0, 6, 2
    v_lshl_add_u32 v13, v14, 13, v13
    v_bfe_u32 v14, v0, 4, 2
    v_lshl_add_u32 v13, v14, 6, v13
    s_waitcnt vmcnt(14)
    v_perm_b32 v80, v20, v16, s44
    s_waitcnt vmcnt(12)
    v_perm_b32 v81, v28, v24, s44
    s_waitcnt vmcnt(10)
    v_perm_b32 v82, v36, v32, s44
    s_waitcnt vmcnt(8)
    v_perm_b32 v83, v44, v40, s44
    ds_write_b128 v13, v[80:83] offset:0
    v_perm_b32 v84, v20, v16, s45
    v_perm_b32 v85, v28, v24, s45
    v_perm_b32 v86, v36, v32, s45
    v_perm_b32 v87, v44, v40, s45
    ds_write_b128 v13, v[84:87] offset:16
    v_perm_b32 v80, v21, v17, s44
    v_perm_b32 v81, v29, v25, s44
    v_perm_b32 v82, v37, v33, s44
    v_perm_b32 v83, v45, v41, s44
    ds_write_b128 v13, v[80:83] offset:32
    v_perm_b32 v84, v21, v17, s45
    v_perm_b32 v85, v29, v25, s45
    v_perm_b32 v86, v37, v33, s45
    v_perm_b32 v87, v45, v41, s45
    ds_write_b128 v13, v[84:87] offset:48
    v_perm_b32 v80, v22, v18, s44
    v_perm_b32 v81, v30, v26, s44
    v_perm_b32 v82, v38, v34, s44
    v_perm_b32 v83, v46, v42, s44
    ds_write_b128 v13, v[80:83] offset:4096
    v_perm_b32 v84, v22, v18, s45
    v_perm_b32 v85, v30, v26, s45
    v_perm_b32 v86, v38, v34, s45
    v_perm_b32 v87, v46, v42, s45
    ds_write_b128 v13, v[84:87] offset:4112
    v_perm_b32 v80, v23, v19, s44
    v_perm_b32 v81, v31, v27, s44
    v_perm_b32 v82, v39, v35, s44
    v_perm_b32 v83, v47, v43, s44
    ds_write_b128 v13, v[80:83] offset:4128
    v_perm_b32 v84, v23, v19, s45
    v_perm_b32 v85, v31, v27, s45
    v_perm_b32 v86, v39, v35, s45
    v_perm_b32 v87, v47, v43, s45
    ds_write_b128 v13, v[84:87] offset:4144
    s_add_u32 s27, s47, 512
    buffer_load_dwordx4 v[16:19], v8, s[84:87], s27 offen
    s_add_u32 s27, s47, 1792
    buffer_load_dwordx4 v[20:23], v8, s[84:87], s27 offen
    s_add_u32 s27, s47, 10752
    buffer_load_dwordx4 v[24:27], v8, s[84:87], s27 offen
    s_add_u32 s27, s47, 12032
    buffer_load_dwordx4 v[28:31], v8, s[84:87], s27 offen
    s_add_u32 s27, s47, 20992
    buffer_load_dwordx4 v[32:35], v8, s[84:87], s27 offen
    s_add_u32 s27, s47, 22272
    buffer_load_dwordx4 v[36:39], v8, s[84:87], s27 offen
    s_add_u32 s27, s47, 31232
    buffer_load_dwordx4 v[40:43], v8, s[84:87], s27 offen
    s_add_u32 s27, s47, 32512
    buffer_load_dwordx4 v[44:47], v8, s[84:87], s27 offen
    v_and_b32 v13, 0x300, v0
    s_lshl_b32 s27, s21, 10
    s_add_u32 s27, s27, 32768
    v_add_u32 v13, s27, v13
    v_bfe_u32 v14, v0, 6, 2
    v_lshl_add_u32 v13, v14, 13, v13
    v_bfe_u32 v14, v0, 4, 2
    v_lshl_add_u32 v13, v14, 6, v13
    s_waitcnt vmcnt(14)
    v_perm_b32 v80, v52, v48, s44
    s_waitcnt vmcnt(12)
    v_perm_b32 v81, v60, v56, s44
    s_waitcnt vmcnt(10)
    v_perm_b32 v82, v68, v64, s44
    s_waitcnt vmcnt(8)
    v_perm_b32 v83, v76, v72, s44
    ds_write_b128 v13, v[80:83] offset:0
    v_perm_b32 v84, v52, v48, s45
    v_perm_b32 v85, v60, v56, s45
    v_perm_b32 v86, v68, v64, s45
    v_perm_b32 v87, v76, v72, s45
    ds_write_b128 v13, v[84:87] offset:16
    v_perm_b32 v80, v53, v49, s44
    v_perm_b32 v81, v61, v57, s44
    v_perm_b32 v82, v69, v65, s44
    v_perm_b32 v83, v77, v73, s44
    ds_write_b128 v13, v[80:83] offset:32
    v_perm_b32 v84, v53, v49, s45
    v_perm_b32 v85, v61, v57, s45
    v_perm_b32 v86, v69, v65, s45
    v_perm_b32 v87, v77, v73, s45
    ds_write_b128 v13, v[84:87] offset:48
    v_perm_b32 v80, v54, v50, s44
    v_perm_b32 v81, v62, v58, s44
    v_perm_b32 v82, v70, v66, s44
    v_perm_b32 v83, v78, v74, s44
    ds_write_b128 v13, v[80:83] offset:4096
    v_perm_b32 v84, v54, v50, s45
    v_perm_b32 v85, v62, v58, s45
    v_perm_b32 v86, v70, v66, s45
    v_perm_b32 v87, v78, v74, s45
    ds_write_b128 v13, v[84:87] offset:4112
    v_perm_b32 v80, v55, v51, s44
    v_perm_b32 v81, v63, v59, s44
    v_perm_b32 v82, v71, v67, s44
    v_perm_b32 v83, v79, v75, s44
    ds_write_b128 v13, v[80:83] offset:4128
    v_perm_b32 v84, v55, v51, s45
    v_perm_b32 v85, v63, v59, s45
    v_perm_b32 v86, v71, v67, s45
    v_perm_b32 v87, v79, v75, s45
    ds_write_b128 v13, v[84:87] offset:4144
    s_add_u32 s27, s47, 768
    buffer_load_dwordx4 v[48:51], v8, s[84:87], s27 offen
    s_add_u32 s27, s47, 2048
    buffer_load_dwordx4 v[52:55], v8, s[84:87], s27 offen
    s_add_u32 s27, s47, 11008
    buffer_load_dwordx4 v[56:59], v8, s[84:87], s27 offen
    s_add_u32 s27, s47, 12288
    buffer_load_dwordx4 v[60:63], v8, s[84:87], s27 offen
    s_add_u32 s27, s47, 21248
    buffer_load_dwordx4 v[64:67], v8, s[84:87], s27 offen
    s_add_u32 s27, s47, 22528
    buffer_load_dwordx4 v[68:71], v8, s[84:87], s27 offen
    s_add_u32 s27, s47, 31488
    buffer_load_dwordx4 v[72:75], v8, s[84:87], s27 offen
    s_add_u32 s27, s47, 32768
    buffer_load_dwordx4 v[76:79], v8, s[84:87], s27 offen
    v_and_b32 v13, 0x300, v0
    s_lshl_b32 s27, s21, 10
    s_add_u32 s27, s27, 65536
    v_add_u32 v13, s27, v13
    v_bfe_u32 v14, v0, 6, 2
    v_lshl_add_u32 v13, v14, 13, v13
    v_bfe_u32 v14, v0, 4, 2
    v_lshl_add_u32 v13, v14, 6, v13
    s_waitcnt vmcnt(14)
    v_perm_b32 v80, v20, v16, s44
    s_waitcnt vmcnt(12)
    v_perm_b32 v81, v28, v24, s44
    s_waitcnt vmcnt(10)
    v_perm_b32 v82, v36, v32, s44
    s_waitcnt vmcnt(8)
    v_perm_b32 v83, v44, v40, s44
    ds_write_b128 v13, v[80:83] offset:0
    v_perm_b32 v84, v20, v16, s45
    v_perm_b32 v85, v28, v24, s45
    v_perm_b32 v86, v36, v32, s45
    v_perm_b32 v87, v44, v40, s45
    ds_write_b128 v13, v[84:87] offset:16
    v_perm_b32 v80, v21, v17, s44
    v_perm_b32 v81, v29, v25, s44
    v_perm_b32 v82, v37, v33, s44
    v_perm_b32 v83, v45, v41, s44
    ds_write_b128 v13, v[80:83] offset:32
    v_perm_b32 v84, v21, v17, s45
    v_perm_b32 v85, v29, v25, s45
    v_perm_b32 v86, v37, v33, s45
    v_perm_b32 v87, v45, v41, s45
    ds_write_b128 v13, v[84:87] offset:48
    v_perm_b32 v80, v22, v18, s44
    v_perm_b32 v81, v30, v26, s44
    v_perm_b32 v82, v38, v34, s44
    v_perm_b32 v83, v46, v42, s44
    ds_write_b128 v13, v[80:83] offset:4096
    v_perm_b32 v84, v22, v18, s45
    v_perm_b32 v85, v30, v26, s45
    v_perm_b32 v86, v38, v34, s45
    v_perm_b32 v87, v46, v42, s45
    ds_write_b128 v13, v[84:87] offset:4112
    v_perm_b32 v80, v23, v19, s44
    v_perm_b32 v81, v31, v27, s44
    v_perm_b32 v82, v39, v35, s44
    v_perm_b32 v83, v47, v43, s44
    ds_write_b128 v13, v[80:83] offset:4128
    v_perm_b32 v84, v23, v19, s45
    v_perm_b32 v85, v31, v27, s45
    v_perm_b32 v86, v39, v35, s45
    v_perm_b32 v87, v47, v43, s45
    ds_write_b128 v13, v[84:87] offset:4144
    s_add_u32 s27, s47, 1024
    buffer_load_dwordx4 v[16:19], v8, s[84:87], s27 offen
    s_add_u32 s27, s47, 2304
    buffer_load_dwordx4 v[20:23], v8, s[84:87], s27 offen
    s_add_u32 s27, s47, 11264
    buffer_load_dwordx4 v[24:27], v8, s[84:87], s27 offen
    s_add_u32 s27, s47, 12544
    buffer_load_dwordx4 v[28:31], v8, s[84:87], s27 offen
    s_add_u32 s27, s47, 21504
    buffer_load_dwordx4 v[32:35], v8, s[84:87], s27 offen
    s_add_u32 s27, s47, 22784
    buffer_load_dwordx4 v[36:39], v8, s[84:87], s27 offen
    s_add_u32 s27, s47, 31744
    buffer_load_dwordx4 v[40:43], v8, s[84:87], s27 offen
    s_add_u32 s27, s47, 33024
    buffer_load_dwordx4 v[44:47], v8, s[84:87], s27 offen
    v_and_b32 v13, 0x300, v0
    s_lshl_b32 s27, s21, 10
    s_add_u32 s27, s27, 98304
    v_add_u32 v13, s27, v13
    v_bfe_u32 v14, v0, 6, 2
    v_lshl_add_u32 v13, v14, 13, v13
    v_bfe_u32 v14, v0, 4, 2
    v_lshl_add_u32 v13, v14, 6, v13
    s_waitcnt vmcnt(14)
    v_perm_b32 v80, v52, v48, s44
    s_waitcnt vmcnt(12)
    v_perm_b32 v81, v60, v56, s44
    s_waitcnt vmcnt(10)
    v_perm_b32 v82, v68, v64, s44
    s_waitcnt vmcnt(8)
    v_perm_b32 v83, v76, v72, s44
    ds_write_b128 v13, v[80:83] offset:0
    v_perm_b32 v84, v52, v48, s45
    v_perm_b32 v85, v60, v56, s45
    v_perm_b32 v86, v68, v64, s45
    v_perm_b32 v87, v76, v72, s45
    ds_write_b128 v13, v[84:87] offset:16
    v_perm_b32 v80, v53, v49, s44
    v_perm_b32 v81, v61, v57, s44
    v_perm_b32 v82, v69, v65, s44
    v_perm_b32 v83, v77, v73, s44
    ds_write_b128 v13, v[80:83] offset:32
    v_perm_b32 v84, v53, v49, s45
    v_perm_b32 v85, v61, v57, s45
    v_perm_b32 v86, v69, v65, s45
    v_perm_b32 v87, v77, v73, s45
    ds_write_b128 v13, v[84:87] offset:48
    v_perm_b32 v80, v54, v50, s44
    v_perm_b32 v81, v62, v58, s44
    v_perm_b32 v82, v70, v66, s44
    v_perm_b32 v83, v78, v74, s44
    ds_write_b128 v13, v[80:83] offset:4096
    v_perm_b32 v84, v54, v50, s45
    v_perm_b32 v85, v62, v58, s45
    v_perm_b32 v86, v70, v66, s45
    v_perm_b32 v87, v78, v74, s45
    ds_write_b128 v13, v[84:87] offset:4112
    v_perm_b32 v80, v55, v51, s44
    v_perm_b32 v81, v63, v59, s44
    v_perm_b32 v82, v71, v67, s44
    v_perm_b32 v83, v79, v75, s44
    ds_write_b128 v13, v[80:83] offset:4128
    v_perm_b32 v84, v55, v51, s45
    v_perm_b32 v85, v63, v59, s45
    v_perm_b32 v86, v71, v67, s45
    v_perm_b32 v87, v79, v75, s45
    ds_write_b128 v13, v[84:87] offset:4144
    v_and_b32 v13, 0x300, v0
    s_lshl_b32 s27, s21, 10
    s_add_u32 s27, s27, 131072
    v_add_u32 v13, s27, v13
    v_bfe_u32 v14, v0, 6, 2
    v_lshl_add_u32 v13, v14, 13, v13
    v_bfe_u32 v14, v0, 4, 2
    v_lshl_add_u32 v13, v14, 6, v13
    s_waitcnt vmcnt(6)
    v_perm_b32 v80, v20, v16, s44
    s_waitcnt vmcnt(4)
    v_perm_b32 v81, v28, v24, s44
    s_waitcnt vmcnt(2)
    v_perm_b32 v82, v36, v32, s44
    s_waitcnt vmcnt(0)
    v_perm_b32 v83, v44, v40, s44
    ds_write_b128 v13, v[80:83] offset:0
    v_perm_b32 v84, v20, v16, s45
    v_perm_b32 v85, v28, v24, s45
    v_perm_b32 v86, v36, v32, s45
    v_perm_b32 v87, v44, v40, s45
    ds_write_b128 v13, v[84:87] offset:16
    v_perm_b32 v80, v21, v17, s44
    v_perm_b32 v81, v29, v25, s44
    v_perm_b32 v82, v37, v33, s44
    v_perm_b32 v83, v45, v41, s44
    ds_write_b128 v13, v[80:83] offset:32
    v_perm_b32 v84, v21, v17, s45
    v_perm_b32 v85, v29, v25, s45
    v_perm_b32 v86, v37, v33, s45
    v_perm_b32 v87, v45, v41, s45
    ds_write_b128 v13, v[84:87] offset:48
    v_perm_b32 v80, v22, v18, s44
    v_perm_b32 v81, v30, v26, s44
    v_perm_b32 v82, v38, v34, s44
    v_perm_b32 v83, v46, v42, s44
    ds_write_b128 v13, v[80:83] offset:4096
    v_perm_b32 v84, v22, v18, s45
    v_perm_b32 v85, v30, v26, s45
    v_perm_b32 v86, v38, v34, s45
    v_perm_b32 v87, v46, v42, s45
    ds_write_b128 v13, v[84:87] offset:4112
    v_perm_b32 v80, v23, v19, s44
    v_perm_b32 v81, v31, v27, s44
    v_perm_b32 v82, v39, v35, s44
    v_perm_b32 v83, v47, v43, s44
    ds_write_b128 v13, v[80:83] offset:4128
    v_perm_b32 v84, v23, v19, s45
    v_perm_b32 v85, v31, v27, s45
    v_perm_b32 v86, v39, v35, s45
    v_perm_b32 v87, v47, v43, s45
    ds_write_b128 v13, v[84:87] offset:4144
    s_waitcnt lgkmcnt(0)
    s_barrier
    ds_read_b128 a[160:163], v7 offset:0
    ds_read_b128 a[164:167], v7 offset:1024
    ds_read_b128 a[168:171], v7 offset:2048
    ds_read_b128 a[172:175], v7 offset:3072
    ds_read_b128 a[176:179], v7 offset:4096
    ds_read_b128 a[180:183], v7 offset:5120
    ds_read_b128 a[184:187], v7 offset:6144
    ds_read_b128 a[188:191], v7 offset:7168
    ds_read_b128 a[192:195], v7 offset:8192
    ds_read_b128 a[196:199], v7 offset:9216
    ds_read_b128 a[200:203], v7 offset:10240
    ds_read_b128 a[204:207], v7 offset:11264
    ds_read_b128 a[208:211], v7 offset:12288
    ds_read_b128 a[212:215], v7 offset:13312
    ds_read_b128 a[216:219], v7 offset:14336
    ds_read_b128 a[220:223], v7 offset:15360
    ds_read_b128 a[224:227], v7 offset:16384
    ds_read_b128 a[228:231], v7 offset:17408
    ds_read_b128 a[232:235], v7 offset:18432
    ds_read_b128 a[236:239], v7 offset:19456
    ds_read_b128 a[240:243], v7 offset:20480
    ds_read_b128 a[244:247], v7 offset:21504
    ds_read_b128 a[248:251], v7 offset:22528
    ds_read_b128 a[252:255], v7 offset:23552
    ds_read_b128 v[192:195], v7 offset:24576
    ds_read_b128 v[196:199], v7 offset:25600
    ds_read_b128 v[200:203], v7 offset:26624
    ds_read_b128 v[204:207], v7 offset:27648
    ds_read_b128 v[208:211], v7 offset:28672
    ds_read_b128 v[212:215], v7 offset:29696
    ds_read_b128 v[216:219], v7 offset:30720
    ds_read_b128 v[220:223], v7 offset:31744
    ds_read_b128 v[224:227], v7 offset:32768
    ds_read_b128 v[228:231], v7 offset:33792
    ds_read_b128 v[232:235], v7 offset:34816
    ds_read_b128 v[236:239], v7 offset:35840
    ds_read_b128 v[240:243], v7 offset:36864
    ds_read_b128 v[244:247], v7 offset:37888
    ds_read_b128 v[248:251], v7 offset:38912
    ds_read_b128 v[252:255], v7 offset:39936
    s_waitcnt lgkmcnt(0)
    s_barrier
    s_mov_b32 s44, 0x05040100
    s_mov_b32 s45, 0x07060302
    s_add_u32 s26, s21, 0
    s_lshl_b32 s27, s26, 18
    s_add_u32 s27, s27, s46
    buffer_load_dwordx4 v[16:19], v12, s[72:75], s27 offen
    s_add_u32 s27, s27, 8192
    buffer_load_dwordx4 v[20:23], v12, s[72:75], s27 offen
    s_add_u32 s27, s27, 8192
    buffer_load_dwordx4 v[24:27], v12, s[72:75], s27 offen
    s_add_u32 s27, s27, 8192
    buffer_load_dwordx4 v[28:31], v12, s[72:75], s27 offen
    s_add_u32 s27, s27, 8192
    buffer_load_dwordx4 v[32:35], v12, s[72:75], s27 offen
    s_add_u32 s27, s27, 8192
    buffer_load_dwordx4 v[36:39], v12, s[72:75], s27 offen
    s_add_u32 s27, s27, 8192
    buffer_load_dwordx4 v[40:43], v12, s[72:75], s27 offen
    s_add_u32 s27, s27, 8192
    buffer_load_dwordx4 v[44:47], v12, s[72:75], s27 offen
    s_add_u32 s26, s21, 4
    s_lshl_b32 s27, s26, 18
    s_add_u32 s27, s27, s46
    buffer_load_dwordx4 v[48:51], v12, s[72:75], s27 offen
    s_add_u32 s27, s27, 8192
    buffer_load_dwordx4 v[52:55], v12, s[72:75], s27 offen
    s_add_u32 s27, s27, 8192
    buffer_load_dwordx4 v[56:59], v12, s[72:75], s27 offen
    s_add_u32 s27, s27, 8192
    buffer_load_dwordx4 v[60:63], v12, s[72:75], s27 offen
    s_add_u32 s27, s27, 8192
    buffer_load_dwordx4 v[64:67], v12, s[72:75], s27 offen
    s_add_u32 s27, s27, 8192
    buffer_load_dwordx4 v[68:71], v12, s[72:75], s27 offen
    s_add_u32 s27, s27, 8192
    buffer_load_dwordx4 v[72:75], v12, s[72:75], s27 offen
    s_add_u32 s27, s27, 8192
    buffer_load_dwordx4 v[76:79], v12, s[72:75], s27 offen
    s_lshl_b32 s27, s21, 11
    s_add_u32 s27, s27, 0
    v_add_u32 v13, s27, v0
    s_waitcnt vmcnt(14)
    v_perm_b32 v80, v20, v16, s44
    s_waitcnt vmcnt(12)
    v_perm_b32 v81, v28, v24, s44
    s_waitcnt vmcnt(10)
    v_perm_b32 v82, v36, v32, s44
    s_waitcnt vmcnt(8)
    v_perm_b32 v83, v44, v40, s44
    ds_write_b128 v13, v[80:83] offset:0
    v_perm_b32 v84, v20, v16, s45
    v_perm_b32 v85, v28, v24, s45
    v_perm_b32 v86, v36, v32, s45
    v_perm_b32 v87, v44, v40, s45
    ds_write_b128 v13, v[84:87] offset:1024
    v_perm_b32 v80, v21, v17, s44
    v_perm_b32 v81, v29, v25, s44
    v_perm_b32 v82, v37, v33, s44
    v_perm_b32 v83, v45, v41, s44
    ds_write_b128 v13, v[80:83] offset:8192
    v_perm_b32 v84, v21, v17, s45
    v_perm_b32 v85, v29, v25, s45
    v_perm_b32 v86, v37, v33, s45
    v_perm_b32 v87, v45, v41, s45
    ds_write_b128 v13, v[84:87] offset:9216
    v_perm_b32 v80, v22, v18, s44
    v_perm_b32 v81, v30, v26, s44
    v_perm_b32 v82, v38, v34, s44
    v_perm_b32 v83, v46, v42, s44
    ds_write_b128 v13, v[80:83] offset:16384
    v_perm_b32 v84, v22, v18, s45
    v_perm_b32 v85, v30, v26, s45
    v_perm_b32 v86, v38, v34, s45
    v_perm_b32 v87, v46, v42, s45
    ds_write_b128 v13, v[84:87] offset:17408
    v_perm_b32 v80, v23, v19, s44
    v_perm_b32 v81, v31, v27, s44
    v_perm_b32 v82, v39, v35, s44
    v_perm_b32 v83, v47, v43, s44
    ds_write_b128 v13, v[80:83] offset:24576
    v_perm_b32 v84, v23, v19, s45
    v_perm_b32 v85, v31, v27, s45
    v_perm_b32 v86, v39, v35, s45
    v_perm_b32 v87, v47, v43, s45
    ds_write_b128 v13, v[84:87] offset:25600
    s_add_u32 s26, s21, 8
    s_lshl_b32 s27, s26, 18
    s_add_u32 s27, s27, s46
    buffer_load_dwordx4 v[16:19], v12, s[72:75], s27 offen
    s_add_u32 s27, s27, 8192
    buffer_load_dwordx4 v[20:23], v12, s[72:75], s27 offen
    s_add_u32 s27, s27, 8192
    buffer_load_dwordx4 v[24:27], v12, s[72:75], s27 offen
    s_add_u32 s27, s27, 8192
    buffer_load_dwordx4 v[28:31], v12, s[72:75], s27 offen
    s_add_u32 s27, s27, 8192
    buffer_load_dwordx4 v[32:35], v12, s[72:75], s27 offen
    s_add_u32 s27, s27, 8192
    buffer_load_dwordx4 v[36:39], v12, s[72:75], s27 offen
    s_add_u32 s27, s27, 8192
    buffer_load_dwordx4 v[40:43], v12, s[72:75], s27 offen
    s_add_u32 s27, s27, 8192
    buffer_load_dwordx4 v[44:47], v12, s[72:75], s27 offen
    s_waitcnt lgkmcnt(0)
    s_barrier
    ds_read_b128 a[0:3], v4 offset:0
    ds_read_b128 a[80:83], v4 offset:1024
    ds_read_b128 a[4:7], v4 offset:2048
    ds_read_b128 a[84:87], v4 offset:3072
    ds_read_b128 a[8:11], v4 offset:4096
    ds_read_b128 a[88:91], v4 offset:5120
    ds_read_b128 a[12:15], v4 offset:6144
    ds_read_b128 a[92:95], v4 offset:7168
    s_lshl_b32 s27, s21, 11
    s_add_u32 s27, s27, 32768
    v_add_u32 v13, s27, v0
    s_waitcnt vmcnt(14)
    v_perm_b32 v80, v52, v48, s44
    s_waitcnt vmcnt(12)
    v_perm_b32 v81, v60, v56, s44
    s_waitcnt vmcnt(10)
    v_perm_b32 v82, v68, v64, s44
    s_waitcnt vmcnt(8)
    v_perm_b32 v83, v76, v72, s44
    ds_write_b128 v13, v[80:83] offset:0
    v_perm_b32 v84, v52, v48, s45
    v_perm_b32 v85, v60, v56, s45
    v_perm_b32 v86, v68, v64, s45
    v_perm_b32 v87, v76, v72, s45
    ds_write_b128 v13, v[84:87] offset:1024
    v_perm_b32 v80, v53, v49, s44
    v_perm_b32 v81, v61, v57, s44
    v_perm_b32 v82, v69, v65, s44
    v_perm_b32 v83, v77, v73, s44
    ds_write_b128 v13, v[80:83] offset:8192
    v_perm_b32 v84, v53, v49, s45
    v_perm_b32 v85, v61, v57, s45
    v_perm_b32 v86, v69, v65, s45
    v_perm_b32 v87, v77, v73, s45
    ds_write_b128 v13, v[84:87] offset:9216
    v_perm_b32 v80, v54, v50, s44
    v_perm_b32 v81, v62, v58, s44
    v_perm_b32 v82, v70, v66, s44
    v_perm_b32 v83, v78, v74, s44
    ds_write_b128 v13, v[80:83] offset:16384
    v_perm_b32 v84, v54, v50, s45
    v_perm_b32 v85, v62, v58, s45
    v_perm_b32 v86, v70, v66, s45
    v_perm_b32 v87, v78, v74, s45
    ds_write_b128 v13, v[84:87] offset:17408
    v_perm_b32 v80, v55, v51, s44
    v_perm_b32 v81, v63, v59, s44
    v_perm_b32 v82, v71, v67, s44
    v_perm_b32 v83, v79, v75, s44
    ds_write_b128 v13, v[80:83] offset:24576
    v_perm_b32 v84, v55, v51, s45
    v_perm_b32 v85, v63, v59, s45
    v_perm_b32 v86, v71, v67, s45
    v_perm_b32 v87, v79, v75, s45
    ds_write_b128 v13, v[84:87] offset:25600
    s_add_u32 s26, s21, 12
    s_lshl_b32 s27, s26, 18
    s_add_u32 s27, s27, s46
    buffer_load_dwordx4 v[48:51], v12, s[72:75], s27 offen
    s_add_u32 s27, s27, 8192
    buffer_load_dwordx4 v[52:55], v12, s[72:75], s27 offen
    s_add_u32 s27, s27, 8192
    buffer_load_dwordx4 v[56:59], v12, s[72:75], s27 offen
    s_add_u32 s27, s27, 8192
    buffer_load_dwordx4 v[60:63], v12, s[72:75], s27 offen
    s_add_u32 s27, s27, 8192
    buffer_load_dwordx4 v[64:67], v12, s[72:75], s27 offen
    s_add_u32 s27, s27, 8192
    buffer_load_dwordx4 v[68:71], v12, s[72:75], s27 offen
    s_add_u32 s27, s27, 8192
    buffer_load_dwordx4 v[72:75], v12, s[72:75], s27 offen
    s_add_u32 s27, s27, 8192
    buffer_load_dwordx4 v[76:79], v12, s[72:75], s27 offen
    s_waitcnt lgkmcnt(0)
    s_barrier
    ds_read_b128 a[16:19], v5 offset:0
    ds_read_b128 a[96:99], v5 offset:1024
    ds_read_b128 a[20:23], v5 offset:2048
    ds_read_b128 a[100:103], v5 offset:3072
    ds_read_b128 a[24:27], v5 offset:4096
    ds_read_b128 a[104:107], v5 offset:5120
    ds_read_b128 a[28:31], v5 offset:6144
    ds_read_b128 a[108:111], v5 offset:7168
    s_lshl_b32 s27, s21, 11
    s_add_u32 s27, s27, 0
    v_add_u32 v13, s27, v0
    s_waitcnt vmcnt(14)
    v_perm_b32 v80, v20, v16, s44
    s_waitcnt vmcnt(12)
    v_perm_b32 v81, v28, v24, s44
    s_waitcnt vmcnt(10)
    v_perm_b32 v82, v36, v32, s44
    s_waitcnt vmcnt(8)
    v_perm_b32 v83, v44, v40, s44
    ds_write_b128 v13, v[80:83] offset:0
    v_perm_b32 v84, v20, v16, s45
    v_perm_b32 v85, v28, v24, s45
    v_perm_b32 v86, v36, v32, s45
    v_perm_b32 v87, v44, v40, s45
    ds_write_b128 v13, v[84:87] offset:1024
    v_perm_b32 v80, v21, v17, s44
    v_perm_b32 v81, v29, v25, s44
    v_perm_b32 v82, v37, v33, s44
    v_perm_b32 v83, v45, v41, s44
    ds_write_b128 v13, v[80:83] offset:8192
    v_perm_b32 v84, v21, v17, s45
    v_perm_b32 v85, v29, v25, s45
    v_perm_b32 v86, v37, v33, s45
    v_perm_b32 v87, v45, v41, s45
    ds_write_b128 v13, v[84:87] offset:9216
    v_perm_b32 v80, v22, v18, s44
    v_perm_b32 v81, v30, v26, s44
    v_perm_b32 v82, v38, v34, s44
    v_perm_b32 v83, v46, v42, s44
    ds_write_b128 v13, v[80:83] offset:16384
    v_perm_b32 v84, v22, v18, s45
    v_perm_b32 v85, v30, v26, s45
    v_perm_b32 v86, v38, v34, s45
    v_perm_b32 v87, v46, v42, s45
    ds_write_b128 v13, v[84:87] offset:17408
    v_perm_b32 v80, v23, v19, s44
    v_perm_b32 v81, v31, v27, s44
    v_perm_b32 v82, v39, v35, s44
    v_perm_b32 v83, v47, v43, s44
    ds_write_b128 v13, v[80:83] offset:24576
    v_perm_b32 v84, v23, v19, s45
    v_perm_b32 v85, v31, v27, s45
    v_perm_b32 v86, v39, v35, s45
    v_perm_b32 v87, v47, v43, s45
    ds_write_b128 v13, v[84:87] offset:25600
    s_add_u32 s26, s21, 16
    s_lshl_b32 s27, s26, 18
    s_add_u32 s27, s27, s46
    buffer_load_dwordx4 v[16:19], v12, s[72:75], s27 offen
    s_add_u32 s27, s27, 8192
    buffer_load_dwordx4 v[20:23], v12, s[72:75], s27 offen
    s_add_u32 s27, s27, 8192
    buffer_load_dwordx4 v[24:27], v12, s[72:75], s27 offen
    s_add_u32 s27, s27, 8192
    buffer_load_dwordx4 v[28:31], v12, s[72:75], s27 offen
    s_add_u32 s27, s27, 8192
    buffer_load_dwordx4 v[32:35], v12, s[72:75], s27 offen
    s_add_u32 s27, s27, 8192
    buffer_load_dwordx4 v[36:39], v12, s[72:75], s27 offen
    s_add_u32 s27, s27, 8192
    buffer_load_dwordx4 v[40:43], v12, s[72:75], s27 offen
    s_add_u32 s27, s27, 8192
    buffer_load_dwordx4 v[44:47], v12, s[72:75], s27 offen
    s_waitcnt lgkmcnt(0)
    s_barrier
    ds_read_b128 a[32:35], v4 offset:0
    ds_read_b128 a[112:115], v4 offset:1024
    ds_read_b128 a[36:39], v4 offset:2048
    ds_read_b128 a[116:119], v4 offset:3072
    ds_read_b128 a[40:43], v4 offset:4096
    ds_read_b128 a[120:123], v4 offset:5120
    ds_read_b128 a[44:47], v4 offset:6144
    ds_read_b128 a[124:127], v4 offset:7168
    s_lshl_b32 s27, s21, 11
    s_add_u32 s27, s27, 32768
    v_add_u32 v13, s27, v0
    s_waitcnt vmcnt(14)
    v_perm_b32 v80, v52, v48, s44
    s_waitcnt vmcnt(12)
    v_perm_b32 v81, v60, v56, s44
    s_waitcnt vmcnt(10)
    v_perm_b32 v82, v68, v64, s44
    s_waitcnt vmcnt(8)
    v_perm_b32 v83, v76, v72, s44
    ds_write_b128 v13, v[80:83] offset:0
    v_perm_b32 v84, v52, v48, s45
    v_perm_b32 v85, v60, v56, s45
    v_perm_b32 v86, v68, v64, s45
    v_perm_b32 v87, v76, v72, s45
    ds_write_b128 v13, v[84:87] offset:1024
    v_perm_b32 v80, v53, v49, s44
    v_perm_b32 v81, v61, v57, s44
    v_perm_b32 v82, v69, v65, s44
    v_perm_b32 v83, v77, v73, s44
    ds_write_b128 v13, v[80:83] offset:8192
    v_perm_b32 v84, v53, v49, s45
    v_perm_b32 v85, v61, v57, s45
    v_perm_b32 v86, v69, v65, s45
    v_perm_b32 v87, v77, v73, s45
    ds_write_b128 v13, v[84:87] offset:9216
    v_perm_b32 v80, v54, v50, s44
    v_perm_b32 v81, v62, v58, s44
    v_perm_b32 v82, v70, v66, s44
    v_perm_b32 v83, v78, v74, s44
    ds_write_b128 v13, v[80:83] offset:16384
    v_perm_b32 v84, v54, v50, s45
    v_perm_b32 v85, v62, v58, s45
    v_perm_b32 v86, v70, v66, s45
    v_perm_b32 v87, v78, v74, s45
    ds_write_b128 v13, v[84:87] offset:17408
    v_perm_b32 v80, v55, v51, s44
    v_perm_b32 v81, v63, v59, s44
    v_perm_b32 v82, v71, v67, s44
    v_perm_b32 v83, v79, v75, s44
    ds_write_b128 v13, v[80:83] offset:24576
    v_perm_b32 v84, v55, v51, s45
    v_perm_b32 v85, v63, v59, s45
    v_perm_b32 v86, v71, v67, s45
    v_perm_b32 v87, v79, v75, s45
    ds_write_b128 v13, v[84:87] offset:25600
    s_waitcnt lgkmcnt(0)
    s_barrier
    ds_read_b128 a[48:51], v5 offset:0
    ds_read_b128 a[128:131], v5 offset:1024
    ds_read_b128 a[52:55], v5 offset:2048
    ds_read_b128 a[132:135], v5 offset:3072
    ds_read_b128 a[56:59], v5 offset:4096
    ds_read_b128 a[136:139], v5 offset:5120
    ds_read_b128 a[60:63], v5 offset:6144
    ds_read_b128 a[140:143], v5 offset:7168
    s_lshl_b32 s27, s21, 11
    s_add_u32 s27, s27, 0
    v_add_u32 v13, s27, v0
    s_waitcnt vmcnt(6)
    v_perm_b32 v80, v20, v16, s44
    s_waitcnt vmcnt(4)
    v_perm_b32 v81, v28, v24, s44
    s_waitcnt vmcnt(2)
    v_perm_b32 v82, v36, v32, s44
    s_waitcnt vmcnt(0)
    v_perm_b32 v83, v44, v40, s44
    ds_write_b128 v13, v[80:83] offset:0
    v_perm_b32 v84, v20, v16, s45
    v_perm_b32 v85, v28, v24, s45
    v_perm_b32 v86, v36, v32, s45
    v_perm_b32 v87, v44, v40, s45
    ds_write_b128 v13, v[84:87] offset:1024
    v_perm_b32 v80, v21, v17, s44
    v_perm_b32 v81, v29, v25, s44
    v_perm_b32 v82, v37, v33, s44
    v_perm_b32 v83, v45, v41, s44
    ds_write_b128 v13, v[80:83] offset:8192
    v_perm_b32 v84, v21, v17, s45
    v_perm_b32 v85, v29, v25, s45
    v_perm_b32 v86, v37, v33, s45
    v_perm_b32 v87, v45, v41, s45
    ds_write_b128 v13, v[84:87] offset:9216
    v_perm_b32 v80, v22, v18, s44
    v_perm_b32 v81, v30, v26, s44
    v_perm_b32 v82, v38, v34, s44
    v_perm_b32 v83, v46, v42, s44
    ds_write_b128 v13, v[80:83] offset:16384
    v_perm_b32 v84, v22, v18, s45
    v_perm_b32 v85, v30, v26, s45
    v_perm_b32 v86, v38, v34, s45
    v_perm_b32 v87, v46, v42, s45
    ds_write_b128 v13, v[84:87] offset:17408
    v_perm_b32 v80, v23, v19, s44
    v_perm_b32 v81, v31, v27, s44
    v_perm_b32 v82, v39, v35, s44
    v_perm_b32 v83, v47, v43, s44
    ds_write_b128 v13, v[80:83] offset:24576
    v_perm_b32 v84, v23, v19, s45
    v_perm_b32 v85, v31, v27, s45
    v_perm_b32 v86, v39, v35, s45
    v_perm_b32 v87, v47, v43, s45
    ds_write_b128 v13, v[84:87] offset:25600
    s_waitcnt lgkmcnt(0)
    s_barrier
    ds_read_b128 a[64:67], v4 offset:0
    ds_read_b128 a[144:147], v4 offset:1024
    ds_read_b128 a[68:71], v4 offset:2048
    ds_read_b128 a[148:151], v4 offset:3072
    ds_read_b128 a[72:75], v4 offset:4096
    ds_read_b128 a[152:155], v4 offset:5120
    ds_read_b128 a[76:79], v4 offset:6144
    ds_read_b128 a[156:159], v4 offset:7168
    s_waitcnt lgkmcnt(0)
    s_branch M_lw_done
M_bl_kv:
    s_mov_b32 s44, 0x05040100
    s_mov_b32 s45, 0x07060302
    s_add_u32 s26, s21, 0
    s_lshl_b32 s27, s26, 18
    s_add_u32 s27, s27, s46
    buffer_load_dwordx4 v[16:19], v12, s[76:79], s27 offen
    s_add_u32 s27, s27, 8192
    buffer_load_dwordx4 v[20:23], v12, s[76:79], s27 offen
    s_add_u32 s27, s27, 8192
    buffer_load_dwordx4 v[24:27], v12, s[76:79], s27 offen
    s_add_u32 s27, s27, 8192
    buffer_load_dwordx4 v[28:31], v12, s[76:79], s27 offen
    s_add_u32 s27, s27, 8192
    buffer_load_dwordx4 v[32:35], v12, s[76:79], s27 offen
    s_add_u32 s27, s27, 8192
    buffer_load_dwordx4 v[36:39], v12, s[76:79], s27 offen
    s_add_u32 s27, s27, 8192
    buffer_load_dwordx4 v[40:43], v12, s[76:79], s27 offen
    s_add_u32 s27, s27, 8192
    buffer_load_dwordx4 v[44:47], v12, s[76:79], s27 offen
    s_add_u32 s26, s21, 4
    s_lshl_b32 s27, s26, 18
    s_add_u32 s27, s27, s46
    buffer_load_dwordx4 v[48:51], v12, s[76:79], s27 offen
    s_add_u32 s27, s27, 8192
    buffer_load_dwordx4 v[52:55], v12, s[76:79], s27 offen
    s_add_u32 s27, s27, 8192
    buffer_load_dwordx4 v[56:59], v12, s[76:79], s27 offen
    s_add_u32 s27, s27, 8192
    buffer_load_dwordx4 v[60:63], v12, s[76:79], s27 offen
    s_add_u32 s27, s27, 8192
    buffer_load_dwordx4 v[64:67], v12, s[76:79], s27 offen
    s_add_u32 s27, s27, 8192
    buffer_load_dwordx4 v[68:71], v12, s[76:79], s27 offen
    s_add_u32 s27, s27, 8192
    buffer_load_dwordx4 v[72:75], v12, s[76:79], s27 offen
    s_add_u32 s27, s27, 8192
    buffer_load_dwordx4 v[76:79], v12, s[76:79], s27 offen
    s_lshl_b32 s27, s21, 11
    s_add_u32 s27, s27, 0
    v_add_u32 v13, s27, v0
    s_waitcnt vmcnt(14)
    v_perm_b32 v80, v20, v16, s44
    s_waitcnt vmcnt(12)
    v_perm_b32 v81, v28, v24, s44
    s_waitcnt vmcnt(10)
    v_perm_b32 v82, v36, v32, s44
    s_waitcnt vmcnt(8)
    v_perm_b32 v83, v44, v40, s44
    ds_write_b128 v13, v[80:83] offset:0
    v_perm_b32 v84, v20, v16, s45
    v_perm_b32 v85, v28, v24, s45
    v_perm_b32 v86, v36, v32, s45
    v_perm_b32 v87, v44, v40, s45
    ds_write_b128 v13, v[84:87] offset:1024
    v_perm_b32 v80, v21, v17, s44
    v_perm_b32 v81, v29, v25, s44
    v_perm_b32 v82, v37, v33, s44
    v_perm_b32 v83, v45, v41, s44
    ds_write_b128 v13, v[80:83] offset:8192
    v_perm_b32 v84, v21, v17, s45
    v_perm_b32 v85, v29, v25, s45
    v_perm_b32 v86, v37, v33, s45
    v_perm_b32 v87, v45, v41, s45
    ds_write_b128 v13, v[84:87] offset:9216
    v_perm_b32 v80, v22, v18, s44
    v_perm_b32 v81, v30, v26, s44
    v_perm_b32 v82, v38, v34, s44
    v_perm_b32 v83, v46, v42, s44
    ds_write_b128 v13, v[80:83] offset:16384
    v_perm_b32 v84, v22, v18, s45
    v_perm_b32 v85, v30, v26, s45
    v_perm_b32 v86, v38, v34, s45
    v_perm_b32 v87, v46, v42, s45
    ds_write_b128 v13, v[84:87] offset:17408
    v_perm_b32 v80, v23, v19, s44
    v_perm_b32 v81, v31, v27, s44
    v_perm_b32 v82, v39, v35, s44
    v_perm_b32 v83, v47, v43, s44
    ds_write_b128 v13, v[80:83] offset:24576
    v_perm_b32 v84, v23, v19, s45
    v_perm_b32 v85, v31, v27, s45
    v_perm_b32 v86, v39, v35, s45
    v_perm_b32 v87, v47, v43, s45
    ds_write_b128 v13, v[84:87] offset:25600
    s_add_u32 s26, s21, 8
    s_lshl_b32 s27, s26, 18
    s_add_u32 s27, s27, s46
    buffer_load_dwordx4 v[16:19], v12, s[76:79], s27 offen
    s_add_u32 s27, s27, 8192
    buffer_load_dwordx4 v[20:23], v12, s[76:79], s27 offen
    s_add_u32 s27, s27, 8192
    buffer_load_dwordx4 v[24:27], v12, s[76:79], s27 offen
    s_add_u32 s27, s27, 8192
    buffer_load_dwordx4 v[28:31], v12, s[76:79], s27 offen
    s_add_u32 s27, s27, 8192
    buffer_load_dwordx4 v[32:35], v12, s[76:79], s27 offen
    s_add_u32 s27, s27, 8192
    buffer_load_dwordx4 v[36:39], v12, s[76:79], s27 offen
    s_add_u32 s27, s27, 8192
    buffer_load_dwordx4 v[40:43], v12, s[76:79], s27 offen
    s_add_u32 s27, s27, 8192
    buffer_load_dwordx4 v[44:47], v12, s[76:79], s27 offen
    s_waitcnt lgkmcnt(0)
    s_barrier
    ds_read_b128 a[0:3], v4 offset:0
    ds_read_b128 a[80:83], v4 offset:1024
    ds_read_b128 a[4:7], v4 offset:2048
    ds_read_b128 a[84:87], v4 offset:3072
    ds_read_b128 a[8:11], v4 offset:4096
    ds_read_b128 a[88:91], v4 offset:5120
    ds_read_b128 a[12:15], v4 offset:6144
    ds_read_b128 a[92:95], v4 offset:7168
    s_lshl_b32 s27, s21, 11
    s_add_u32 s27, s27, 32768
    v_add_u32 v13, s27, v0
    s_waitcnt vmcnt(14)
    v_perm_b32 v80, v52, v48, s44
    s_waitcnt vmcnt(12)
    v_perm_b32 v81, v60, v56, s44
    s_waitcnt vmcnt(10)
    v_perm_b32 v82, v68, v64, s44
    s_waitcnt vmcnt(8)
    v_perm_b32 v83, v76, v72, s44
    ds_write_b128 v13, v[80:83] offset:0
    v_perm_b32 v84, v52, v48, s45
    v_perm_b32 v85, v60, v56, s45
    v_perm_b32 v86, v68, v64, s45
    v_perm_b32 v87, v76, v72, s45
    ds_write_b128 v13, v[84:87] offset:1024
    v_perm_b32 v80, v53, v49, s44
    v_perm_b32 v81, v61, v57, s44
    v_perm_b32 v82, v69, v65, s44
    v_perm_b32 v83, v77, v73, s44
    ds_write_b128 v13, v[80:83] offset:8192
    v_perm_b32 v84, v53, v49, s45
    v_perm_b32 v85, v61, v57, s45
    v_perm_b32 v86, v69, v65, s45
    v_perm_b32 v87, v77, v73, s45
    ds_write_b128 v13, v[84:87] offset:9216
    v_perm_b32 v80, v54, v50, s44
    v_perm_b32 v81, v62, v58, s44
    v_perm_b32 v82, v70, v66, s44
    v_perm_b32 v83, v78, v74, s44
    ds_write_b128 v13, v[80:83] offset:16384
    v_perm_b32 v84, v54, v50, s45
    v_perm_b32 v85, v62, v58, s45
    v_perm_b32 v86, v70, v66, s45
    v_perm_b32 v87, v78, v74, s45
    ds_write_b128 v13, v[84:87] offset:17408
    v_perm_b32 v80, v55, v51, s44
    v_perm_b32 v81, v63, v59, s44
    v_perm_b32 v82, v71, v67, s44
    v_perm_b32 v83, v79, v75, s44
    ds_write_b128 v13, v[80:83] offset:24576
    v_perm_b32 v84, v55, v51, s45
    v_perm_b32 v85, v63, v59, s45
    v_perm_b32 v86, v71, v67, s45
    v_perm_b32 v87, v79, v75, s45
    ds_write_b128 v13, v[84:87] offset:25600
    s_add_u32 s26, s21, 12
    s_lshl_b32 s27, s26, 18
    s_add_u32 s27, s27, s46
    buffer_load_dwordx4 v[48:51], v12, s[76:79], s27 offen
    s_add_u32 s27, s27, 8192
    buffer_load_dwordx4 v[52:55], v12, s[76:79], s27 offen
    s_add_u32 s27, s27, 8192
    buffer_load_dwordx4 v[56:59], v12, s[76:79], s27 offen
    s_add_u32 s27, s27, 8192
    buffer_load_dwordx4 v[60:63], v12, s[76:79], s27 offen
    s_add_u32 s27, s27, 8192
    buffer_load_dwordx4 v[64:67], v12, s[76:79], s27 offen
    s_add_u32 s27, s27, 8192
    buffer_load_dwordx4 v[68:71], v12, s[76:79], s27 offen
    s_add_u32 s27, s27, 8192
    buffer_load_dwordx4 v[72:75], v12, s[76:79], s27 offen
    s_add_u32 s27, s27, 8192
    buffer_load_dwordx4 v[76:79], v12, s[76:79], s27 offen
    s_waitcnt lgkmcnt(0)
    s_barrier
    ds_read_b128 a[16:19], v5 offset:0
    ds_read_b128 a[96:99], v5 offset:1024
    ds_read_b128 a[20:23], v5 offset:2048
    ds_read_b128 a[100:103], v5 offset:3072
    ds_read_b128 a[24:27], v5 offset:4096
    ds_read_b128 a[104:107], v5 offset:5120
    ds_read_b128 a[28:31], v5 offset:6144
    ds_read_b128 a[108:111], v5 offset:7168
    s_lshl_b32 s27, s21, 11
    s_add_u32 s27, s27, 0
    v_add_u32 v13, s27, v0
    s_waitcnt vmcnt(14)
    v_perm_b32 v80, v20, v16, s44
    s_waitcnt vmcnt(12)
    v_perm_b32 v81, v28, v24, s44
    s_waitcnt vmcnt(10)
    v_perm_b32 v82, v36, v32, s44
    s_waitcnt vmcnt(8)
    v_perm_b32 v83, v44, v40, s44
    ds_write_b128 v13, v[80:83] offset:0
    v_perm_b32 v84, v20, v16, s45
    v_perm_b32 v85, v28, v24, s45
    v_perm_b32 v86, v36, v32, s45
    v_perm_b32 v87, v44, v40, s45
    ds_write_b128 v13, v[84:87] offset:1024
    v_perm_b32 v80, v21, v17, s44
    v_perm_b32 v81, v29, v25, s44
    v_perm_b32 v82, v37, v33, s44
    v_perm_b32 v83, v45, v41, s44
    ds_write_b128 v13, v[80:83] offset:8192
    v_perm_b32 v84, v21, v17, s45
    v_perm_b32 v85, v29, v25, s45
    v_perm_b32 v86, v37, v33, s45
    v_perm_b32 v87, v45, v41, s45
    ds_write_b128 v13, v[84:87] offset:9216
    v_perm_b32 v80, v22, v18, s44
    v_perm_b32 v81, v30, v26, s44
    v_perm_b32 v82, v38, v34, s44
    v_perm_b32 v83, v46, v42, s44
    ds_write_b128 v13, v[80:83] offset:16384
    v_perm_b32 v84, v22, v18, s45
    v_perm_b32 v85, v30, v26, s45
    v_perm_b32 v86, v38, v34, s45
    v_perm_b32 v87, v46, v42, s45
    ds_write_b128 v13, v[84:87] offset:17408
    v_perm_b32 v80, v23, v19, s44
    v_perm_b32 v81, v31, v27, s44
    v_perm_b32 v82, v39, v35, s44
    v_perm_b32 v83, v47, v43, s44
    ds_write_b128 v13, v[80:83] offset:24576
    v_perm_b32 v84, v23, v19, s45
    v_perm_b32 v85, v31, v27, s45
    v_perm_b32 v86, v39, v35, s45
    v_perm_b32 v87, v47, v43, s45
    ds_write_b128 v13, v[84:87] offset:25600
    s_add_u32 s26, s21, 16
    s_lshl_b32 s27, s26, 18
    s_add_u32 s27, s27, s46
    buffer_load_dwordx4 v[16:19], v12, s[76:79], s27 offen
    s_add_u32 s27, s27, 8192
    buffer_load_dwordx4 v[20:23], v12, s[76:79], s27 offen
    s_add_u32 s27, s27, 8192
    buffer_load_dwordx4 v[24:27], v12, s[76:79], s27 offen
    s_add_u32 s27, s27, 8192
    buffer_load_dwordx4 v[28:31], v12, s[76:79], s27 offen
    s_add_u32 s27, s27, 8192
    buffer_load_dwordx4 v[32:35], v12, s[76:79], s27 offen
    s_add_u32 s27, s27, 8192
    buffer_load_dwordx4 v[36:39], v12, s[76:79], s27 offen
    s_add_u32 s27, s27, 8192
    buffer_load_dwordx4 v[40:43], v12, s[76:79], s27 offen
    s_add_u32 s27, s27, 8192
    buffer_load_dwordx4 v[44:47], v12, s[76:79], s27 offen
    s_waitcnt lgkmcnt(0)
    s_barrier
    ds_read_b128 a[32:35], v4 offset:0
    ds_read_b128 a[112:115], v4 offset:1024
    ds_read_b128 a[36:39], v4 offset:2048
    ds_read_b128 a[116:119], v4 offset:3072
    ds_read_b128 a[40:43], v4 offset:4096
    ds_read_b128 a[120:123], v4 offset:5120
    ds_read_b128 a[44:47], v4 offset:6144
    ds_read_b128 a[124:127], v4 offset:7168
    s_lshl_b32 s27, s21, 11
    s_add_u32 s27, s27, 32768
    v_add_u32 v13, s27, v0
    s_waitcnt vmcnt(14)
    v_perm_b32 v80, v52, v48, s44
    s_waitcnt vmcnt(12)
    v_perm_b32 v81, v60, v56, s44
    s_waitcnt vmcnt(10)
    v_perm_b32 v82, v68, v64, s44
    s_waitcnt vmcnt(8)
    v_perm_b32 v83, v76, v72, s44
    ds_write_b128 v13, v[80:83] offset:0
    v_perm_b32 v84, v52, v48, s45
    v_perm_b32 v85, v60, v56, s45
    v_perm_b32 v86, v68, v64, s45
    v_perm_b32 v87, v76, v72, s45
    ds_write_b128 v13, v[84:87] offset:1024
    v_perm_b32 v80, v53, v49, s44
    v_perm_b32 v81, v61, v57, s44
    v_perm_b32 v82, v69, v65, s44
    v_perm_b32 v83, v77, v73, s44
    ds_write_b128 v13, v[80:83] offset:8192
    v_perm_b32 v84, v53, v49, s45
    v_perm_b32 v85, v61, v57, s45
    v_perm_b32 v86, v69, v65, s45
    v_perm_b32 v87, v77, v73, s45
    ds_write_b128 v13, v[84:87] offset:9216
    v_perm_b32 v80, v54, v50, s44
    v_perm_b32 v81, v62, v58, s44
    v_perm_b32 v82, v70, v66, s44
    v_perm_b32 v83, v78, v74, s44
    ds_write_b128 v13, v[80:83] offset:16384
    v_perm_b32 v84, v54, v50, s45
    v_perm_b32 v85, v62, v58, s45
    v_perm_b32 v86, v70, v66, s45
    v_perm_b32 v87, v78, v74, s45
    ds_write_b128 v13, v[84:87] offset:17408
    v_perm_b32 v80, v55, v51, s44
    v_perm_b32 v81, v63, v59, s44
    v_perm_b32 v82, v71, v67, s44
    v_perm_b32 v83, v79, v75, s44
    ds_write_b128 v13, v[80:83] offset:24576
    v_perm_b32 v84, v55, v51, s45
    v_perm_b32 v85, v63, v59, s45
    v_perm_b32 v86, v71, v67, s45
    v_perm_b32 v87, v79, v75, s45
    ds_write_b128 v13, v[84:87] offset:25600
    s_add_u32 s26, s21, 0
    s_lshl_b32 s27, s26, 18
    s_add_u32 s27, s27, s46
    buffer_load_dwordx4 v[48:51], v12, s[80:83], s27 offen
    s_add_u32 s27, s27, 8192
    buffer_load_dwordx4 v[52:55], v12, s[80:83], s27 offen
    s_add_u32 s27, s27, 8192
    buffer_load_dwordx4 v[56:59], v12, s[80:83], s27 offen
    s_add_u32 s27, s27, 8192
    buffer_load_dwordx4 v[60:63], v12, s[80:83], s27 offen
    s_add_u32 s27, s27, 8192
    buffer_load_dwordx4 v[64:67], v12, s[80:83], s27 offen
    s_add_u32 s27, s27, 8192
    buffer_load_dwordx4 v[68:71], v12, s[80:83], s27 offen
    s_add_u32 s27, s27, 8192
    buffer_load_dwordx4 v[72:75], v12, s[80:83], s27 offen
    s_add_u32 s27, s27, 8192
    buffer_load_dwordx4 v[76:79], v12, s[80:83], s27 offen
    s_waitcnt lgkmcnt(0)
    s_barrier
    ds_read_b128 a[48:51], v5 offset:0
    ds_read_b128 a[128:131], v5 offset:1024
    ds_read_b128 a[52:55], v5 offset:2048
    ds_read_b128 a[132:135], v5 offset:3072
    ds_read_b128 a[56:59], v5 offset:4096
    ds_read_b128 a[136:139], v5 offset:5120
    ds_read_b128 a[60:63], v5 offset:6144
    ds_read_b128 a[140:143], v5 offset:7168
    s_lshl_b32 s27, s21, 11
    s_add_u32 s27, s27, 0
    v_add_u32 v13, s27, v0
    s_waitcnt vmcnt(14)
    v_perm_b32 v80, v20, v16, s44
    s_waitcnt vmcnt(12)
    v_perm_b32 v81, v28, v24, s44
    s_waitcnt vmcnt(10)
    v_perm_b32 v82, v36, v32, s44
    s_waitcnt vmcnt(8)
    v_perm_b32 v83, v44, v40, s44
    ds_write_b128 v13, v[80:83] offset:0
    v_perm_b32 v84, v20, v16, s45
    v_perm_b32 v85, v28, v24, s45
    v_perm_b32 v86, v36, v32, s45
    v_perm_b32 v87, v44, v40, s45
    ds_write_b128 v13, v[84:87] offset:1024
    v_perm_b32 v80, v21, v17, s44
    v_perm_b32 v81, v29, v25, s44
    v_perm_b32 v82, v37, v33, s44
    v_perm_b32 v83, v45, v41, s44
    ds_write_b128 v13, v[80:83] offset:8192
    v_perm_b32 v84, v21, v17, s45
    v_perm_b32 v85, v29, v25, s45
    v_perm_b32 v86, v37, v33, s45
    v_perm_b32 v87, v45, v41, s45
    ds_write_b128 v13, v[84:87] offset:9216
    v_perm_b32 v80, v22, v18, s44
    v_perm_b32 v81, v30, v26, s44
    v_perm_b32 v82, v38, v34, s44
    v_perm_b32 v83, v46, v42, s44
    ds_write_b128 v13, v[80:83] offset:16384
    v_perm_b32 v84, v22, v18, s45
    v_perm_b32 v85, v30, v26, s45
    v_perm_b32 v86, v38, v34, s45
    v_perm_b32 v87, v46, v42, s45
    ds_write_b128 v13, v[84:87] offset:17408
    v_perm_b32 v80, v23, v19, s44
    v_perm_b32 v81, v31, v27, s44
    v_perm_b32 v82, v39, v35, s44
    v_perm_b32 v83, v47, v43, s44
    ds_write_b128 v13, v[80:83] offset:24576
    v_perm_b32 v84, v23, v19, s45
    v_perm_b32 v85, v31, v27, s45
    v_perm_b32 v86, v39, v35, s45
    v_perm_b32 v87, v47, v43, s45
    ds_write_b128 v13, v[84:87] offset:25600
    s_add_u32 s26, s21, 4
    s_lshl_b32 s27, s26, 18
    s_add_u32 s27, s27, s46
    buffer_load_dwordx4 v[16:19], v12, s[80:83], s27 offen
    s_add_u32 s27, s27, 8192
    buffer_load_dwordx4 v[20:23], v12, s[80:83], s27 offen
    s_add_u32 s27, s27, 8192
    buffer_load_dwordx4 v[24:27], v12, s[80:83], s27 offen
    s_add_u32 s27, s27, 8192
    buffer_load_dwordx4 v[28:31], v12, s[80:83], s27 offen
    s_add_u32 s27, s27, 8192
    buffer_load_dwordx4 v[32:35], v12, s[80:83], s27 offen
    s_add_u32 s27, s27, 8192
    buffer_load_dwordx4 v[36:39], v12, s[80:83], s27 offen
    s_add_u32 s27, s27, 8192
    buffer_load_dwordx4 v[40:43], v12, s[80:83], s27 offen
    s_add_u32 s27, s27, 8192
    buffer_load_dwordx4 v[44:47], v12, s[80:83], s27 offen
    s_waitcnt lgkmcnt(0)
    s_barrier
    ds_read_b128 a[64:67], v4 offset:0
    ds_read_b128 a[144:147], v4 offset:1024
    ds_read_b128 a[68:71], v4 offset:2048
    ds_read_b128 a[148:151], v4 offset:3072
    ds_read_b128 a[72:75], v4 offset:4096
    ds_read_b128 a[152:155], v4 offset:5120
    ds_read_b128 a[76:79], v4 offset:6144
    ds_read_b128 a[156:159], v4 offset:7168
    s_lshl_b32 s27, s21, 11
    s_add_u32 s27, s27, 32768
    v_add_u32 v13, s27, v0
    s_waitcnt vmcnt(14)
    v_perm_b32 v80, v52, v48, s44
    s_waitcnt vmcnt(12)
    v_perm_b32 v81, v60, v56, s44
    s_waitcnt vmcnt(10)
    v_perm_b32 v82, v68, v64, s44
    s_waitcnt vmcnt(8)
    v_perm_b32 v83, v76, v72, s44
    ds_write_b128 v13, v[80:83] offset:0
    v_perm_b32 v84, v52, v48, s45
    v_perm_b32 v85, v60, v56, s45
    v_perm_b32 v86, v68, v64, s45
    v_perm_b32 v87, v76, v72, s45
    ds_write_b128 v13, v[84:87] offset:1024
    v_perm_b32 v80, v53, v49, s44
    v_perm_b32 v81, v61, v57, s44
    v_perm_b32 v82, v69, v65, s44
    v_perm_b32 v83, v77, v73, s44
    ds_write_b128 v13, v[80:83] offset:8192
    v_perm_b32 v84, v53, v49, s45
    v_perm_b32 v85, v61, v57, s45
    v_perm_b32 v86, v69, v65, s45
    v_perm_b32 v87, v77, v73, s45
    ds_write_b128 v13, v[84:87] offset:9216
    v_perm_b32 v80, v54, v50, s44
    v_perm_b32 v81, v62, v58, s44
    v_perm_b32 v82, v70, v66, s44
    v_perm_b32 v83, v78, v74, s44
    ds_write_b128 v13, v[80:83] offset:16384
    v_perm_b32 v84, v54, v50, s45
    v_perm_b32 v85, v62, v58, s45
    v_perm_b32 v86, v70, v66, s45
    v_perm_b32 v87, v78, v74, s45
    ds_write_b128 v13, v[84:87] offset:17408
    v_perm_b32 v80, v55, v51, s44
    v_perm_b32 v81, v63, v59, s44
    v_perm_b32 v82, v71, v67, s44
    v_perm_b32 v83, v79, v75, s44
    ds_write_b128 v13, v[80:83] offset:24576
    v_perm_b32 v84, v55, v51, s45
    v_perm_b32 v85, v63, v59, s45
    v_perm_b32 v86, v71, v67, s45
    v_perm_b32 v87, v79, v75, s45
    ds_write_b128 v13, v[84:87] offset:25600
    s_add_u32 s26, s21, 8
    s_lshl_b32 s27, s26, 18
    s_add_u32 s27, s27, s46
    buffer_load_dwordx4 v[48:51], v12, s[80:83], s27 offen
    s_add_u32 s27, s27, 8192
    buffer_load_dwordx4 v[52:55], v12, s[80:83], s27 offen
    s_add_u32 s27, s27, 8192
    buffer_load_dwordx4 v[56:59], v12, s[80:83], s27 offen
    s_add_u32 s27, s27, 8192
    buffer_load_dwordx4 v[60:63], v12, s[80:83], s27 offen
    s_add_u32 s27, s27, 8192
    buffer_load_dwordx4 v[64:67], v12, s[80:83], s27 offen
    s_add_u32 s27, s27, 8192
    buffer_load_dwordx4 v[68:71], v12, s[80:83], s27 offen
    s_add_u32 s27, s27, 8192
    buffer_load_dwordx4 v[72:75], v12, s[80:83], s27 offen
    s_add_u32 s27, s27, 8192
    buffer_load_dwordx4 v[76:79], v12, s[80:83], s27 offen
    s_waitcnt lgkmcnt(0)
    s_barrier
    ds_read_b128 a[160:163], v5 offset:0
    ds_read_b128 a[240:243], v5 offset:1024
    ds_read_b128 a[164:167], v5 offset:2048
    ds_read_b128 a[244:247], v5 offset:3072
    ds_read_b128 a[168:171], v5 offset:4096
    ds_read_b128 a[248:251], v5 offset:5120
    ds_read_b128 a[172:175], v5 offset:6144
    ds_read_b128 a[252:255], v5 offset:7168
    s_lshl_b32 s27, s21, 11
    s_add_u32 s27, s27, 0
    v_add_u32 v13, s27, v0
    s_waitcnt vmcnt(14)
    v_perm_b32 v80, v20, v16, s44
    s_waitcnt vmcnt(12)
    v_perm_b32 v81, v28, v24, s44
    s_waitcnt vmcnt(10)
    v_perm_b32 v82, v36, v32, s44
    s_waitcnt vmcnt(8)
    v_perm_b32 v83, v44, v40, s44
    ds_write_b128 v13, v[80:83] offset:0
    v_perm_b32 v84, v20, v16, s45
    v_perm_b32 v85, v28, v24, s45
    v_perm_b32 v86, v36, v32, s45
    v_perm_b32 v87, v44, v40, s45
    ds_write_b128 v13, v[84:87] offset:1024
    v_perm_b32 v80, v21, v17, s44
    v_perm_b32 v81, v29, v25, s44
    v_perm_b32 v82, v37, v33, s44
    v_perm_b32 v83, v45, v41, s44
    ds_write_b128 v13, v[80:83] offset:8192
    v_perm_b32 v84, v21, v17, s45
    v_perm_b32 v85, v29, v25, s45
    v_perm_b32 v86, v37, v33, s45
    v_perm_b32 v87, v45, v41, s45
    ds_write_b128 v13, v[84:87] offset:9216
    v_perm_b32 v80, v22, v18, s44
    v_perm_b32 v81, v30, v26, s44
    v_perm_b32 v82, v38, v34, s44
    v_perm_b32 v83, v46, v42, s44
    ds_write_b128 v13, v[80:83] offset:16384
    v_perm_b32 v84, v22, v18, s45
    v_perm_b32 v85, v30, v26, s45
    v_perm_b32 v86, v38, v34, s45
    v_perm_b32 v87, v46, v42, s45
    ds_write_b128 v13, v[84:87] offset:17408
    v_perm_b32 v80, v23, v19, s44
    v_perm_b32 v81, v31, v27, s44
    v_perm_b32 v82, v39, v35, s44
    v_perm_b32 v83, v47, v43, s44
    ds_write_b128 v13, v[80:83] offset:24576
    v_perm_b32 v84, v23, v19, s45
    v_perm_b32 v85, v31, v27, s45
    v_perm_b32 v86, v39, v35, s45
    v_perm_b32 v87, v47, v43, s45
    ds_write_b128 v13, v[84:87] offset:25600
    s_add_u32 s26, s21, 12
    s_lshl_b32 s27, s26, 18
    s_add_u32 s27, s27, s46
    buffer_load_dwordx4 v[16:19], v12, s[80:83], s27 offen
    s_add_u32 s27, s27, 8192
    buffer_load_dwordx4 v[20:23], v12, s[80:83], s27 offen
    s_add_u32 s27, s27, 8192
    buffer_load_dwordx4 v[24:27], v12, s[80:83], s27 offen
    s_add_u32 s27, s27, 8192
    buffer_load_dwordx4 v[28:31], v12, s[80:83], s27 offen
    s_add_u32 s27, s27, 8192
    buffer_load_dwordx4 v[32:35], v12, s[80:83], s27 offen
    s_add_u32 s27, s27, 8192
    buffer_load_dwordx4 v[36:39], v12, s[80:83], s27 offen
    s_add_u32 s27, s27, 8192
    buffer_load_dwordx4 v[40:43], v12, s[80:83], s27 offen
    s_add_u32 s27, s27, 8192
    buffer_load_dwordx4 v[44:47], v12, s[80:83], s27 offen
    s_waitcnt lgkmcnt(0)
    s_barrier
    ds_read_b128 a[176:179], v4 offset:0
    ds_read_b128 v[192:195], v4 offset:1024
    ds_read_b128 a[180:183], v4 offset:2048
    ds_read_b128 v[196:199], v4 offset:3072
    ds_read_b128 a[184:187], v4 offset:4096
    ds_read_b128 v[200:203], v4 offset:5120
    ds_read_b128 a[188:191], v4 offset:6144
    ds_read_b128 v[204:207], v4 offset:7168
    s_lshl_b32 s27, s21, 11
    s_add_u32 s27, s27, 32768
    v_add_u32 v13, s27, v0
    s_waitcnt vmcnt(14)
    v_perm_b32 v80, v52, v48, s44
    s_waitcnt vmcnt(12)
    v_perm_b32 v81, v60, v56, s44
    s_waitcnt vmcnt(10)
    v_perm_b32 v82, v68, v64, s44
    s_waitcnt vmcnt(8)
    v_perm_b32 v83, v76, v72, s44
    ds_write_b128 v13, v[80:83] offset:0
    v_perm_b32 v84, v52, v48, s45
    v_perm_b32 v85, v60, v56, s45
    v_perm_b32 v86, v68, v64, s45
    v_perm_b32 v87, v76, v72, s45
    ds_write_b128 v13, v[84:87] offset:1024
    v_perm_b32 v80, v53, v49, s44
    v_perm_b32 v81, v61, v57, s44
    v_perm_b32 v82, v69, v65, s44
    v_perm_b32 v83, v77, v73, s44
    ds_write_b128 v13, v[80:83] offset:8192
    v_perm_b32 v84, v53, v49, s45
    v_perm_b32 v85, v61, v57, s45
    v_perm_b32 v86, v69, v65, s45
    v_perm_b32 v87, v77, v73, s45
    ds_write_b128 v13, v[84:87] offset:9216
    v_perm_b32 v80, v54, v50, s44
    v_perm_b32 v81, v62, v58, s44
    v_perm_b32 v82, v70, v66, s44
    v_perm_b32 v83, v78, v74, s44
    ds_write_b128 v13, v[80:83] offset:16384
    v_perm_b32 v84, v54, v50, s45
    v_perm_b32 v85, v62, v58, s45
    v_perm_b32 v86, v70, v66, s45
    v_perm_b32 v87, v78, v74, s45
    ds_write_b128 v13, v[84:87] offset:17408
    v_perm_b32 v80, v55, v51, s44
    v_perm_b32 v81, v63, v59, s44
    v_perm_b32 v82, v71, v67, s44
    v_perm_b32 v83, v79, v75, s44
    ds_write_b128 v13, v[80:83] offset:24576
    v_perm_b32 v84, v55, v51, s45
    v_perm_b32 v85, v63, v59, s45
    v_perm_b32 v86, v71, v67, s45
    v_perm_b32 v87, v79, v75, s45
    ds_write_b128 v13, v[84:87] offset:25600
    s_add_u32 s26, s21, 16
    s_lshl_b32 s27, s26, 18
    s_add_u32 s27, s27, s46
    buffer_load_dwordx4 v[48:51], v12, s[80:83], s27 offen
    s_add_u32 s27, s27, 8192
    buffer_load_dwordx4 v[52:55], v12, s[80:83], s27 offen
    s_add_u32 s27, s27, 8192
    buffer_load_dwordx4 v[56:59], v12, s[80:83], s27 offen
    s_add_u32 s27, s27, 8192
    buffer_load_dwordx4 v[60:63], v12, s[80:83], s27 offen
    s_add_u32 s27, s27, 8192
    buffer_load_dwordx4 v[64:67], v12, s[80:83], s27 offen
    s_add_u32 s27, s27, 8192
    buffer_load_dwordx4 v[68:71], v12, s[80:83], s27 offen
    s_add_u32 s27, s27, 8192
    buffer_load_dwordx4 v[72:75], v12, s[80:83], s27 offen
    s_add_u32 s27, s27, 8192
    buffer_load_dwordx4 v[76:79], v12, s[80:83], s27 offen
    s_waitcnt lgkmcnt(0)
    s_barrier
    ds_read_b128 a[192:195], v5 offset:0
    ds_read_b128 v[208:211], v5 offset:1024
    ds_read_b128 a[196:199], v5 offset:2048
    ds_read_b128 v[212:215], v5 offset:3072
    ds_read_b128 a[200:203], v5 offset:4096
    ds_read_b128 v[216:219], v5 offset:5120
    ds_read_b128 a[204:207], v5 offset:6144
    ds_read_b128 v[220:223], v5 offset:7168
    s_lshl_b32 s27, s21, 11
    s_add_u32 s27, s27, 0
    v_add_u32 v13, s27, v0
    s_waitcnt vmcnt(14)
    v_perm_b32 v80, v20, v16, s44
    s_waitcnt vmcnt(12)
    v_perm_b32 v81, v28, v24, s44
    s_waitcnt vmcnt(10)
    v_perm_b32 v82, v36, v32, s44
    s_waitcnt vmcnt(8)
    v_perm_b32 v83, v44, v40, s44
    ds_write_b128 v13, v[80:83] offset:0
    v_perm_b32 v84, v20, v16, s45
    v_perm_b32 v85, v28, v24, s45
    v_perm_b32 v86, v36, v32, s45
    v_perm_b32 v87, v44, v40, s45
    ds_write_b128 v13, v[84:87] offset:1024
    v_perm_b32 v80, v21, v17, s44
    v_perm_b32 v81, v29, v25, s44
    v_perm_b32 v82, v37, v33, s44
    v_perm_b32 v83, v45, v41, s44
    ds_write_b128 v13, v[80:83] offset:8192
    v_perm_b32 v84, v21, v17, s45
    v_perm_b32 v85, v29, v25, s45
    v_perm_b32 v86, v37, v33, s45
    v_perm_b32 v87, v45, v41, s45
    ds_write_b128 v13, v[84:87] offset:9216
    v_perm_b32 v80, v22, v18, s44
    v_perm_b32 v81, v30, v26, s44
    v_perm_b32 v82, v38, v34, s44
    v_perm_b32 v83, v46, v42, s44
    ds_write_b128 v13, v[80:83] offset:16384
    v_perm_b32 v84, v22, v18, s45
    v_perm_b32 v85, v30, v26, s45
    v_perm_b32 v86, v38, v34, s45
    v_perm_b32 v87, v46, v42, s45
    ds_write_b128 v13, v[84:87] offset:17408
    v_perm_b32 v80, v23, v19, s44
    v_perm_b32 v81, v31, v27, s44
    v_perm_b32 v82, v39, v35, s44
    v_perm_b32 v83, v47, v43, s44
    ds_write_b128 v13, v[80:83] offset:24576
    v_perm_b32 v84, v23, v19, s45
    v_perm_b32 v85, v31, v27, s45
    v_perm_b32 v86, v39, v35, s45
    v_perm_b32 v87, v47, v43, s45
    ds_write_b128 v13, v[84:87] offset:25600
    s_waitcnt lgkmcnt(0)
    s_barrier
    ds_read_b128 a[208:211], v4 offset:0
    ds_read_b128 v[224:227], v4 offset:1024
    ds_read_b128 a[212:215], v4 offset:2048
    ds_read_b128 v[228:231], v4 offset:3072
    ds_read_b128 a[216:219], v4 offset:4096
    ds_read_b128 v[232:235], v4 offset:5120
    ds_read_b128 a[220:223], v4 offset:6144
    ds_read_b128 v[236:239], v4 offset:7168
    s_lshl_b32 s27, s21, 11
    s_add_u32 s27, s27, 32768
    v_add_u32 v13, s27, v0
    s_waitcnt vmcnt(6)
    v_perm_b32 v80, v52, v48, s44
    s_waitcnt vmcnt(4)
    v_perm_b32 v81, v60, v56, s44
    s_waitcnt vmcnt(2)
    v_perm_b32 v82, v68, v64, s44
    s_waitcnt vmcnt(0)
    v_perm_b32 v83, v76, v72, s44
    ds_write_b128 v13, v[80:83] offset:0
    v_perm_b32 v84, v52, v48, s45
    v_perm_b32 v85, v60, v56, s45
    v_perm_b32 v86, v68, v64, s45
    v_perm_b32 v87, v76, v72, s45
    ds_write_b128 v13, v[84:87] offset:1024
    v_perm_b32 v80, v53, v49, s44
    v_perm_b32 v81, v61, v57, s44
    v_perm_b32 v82, v69, v65, s44
    v_perm_b32 v83, v77, v73, s44
    ds_write_b128 v13, v[80:83] offset:8192
    v_perm_b32 v84, v53, v49, s45
    v_perm_b32 v85, v61, v57, s45
    v_perm_b32 v86, v69, v65, s45
    v_perm_b32 v87, v77, v73, s45
    ds_write_b128 v13, v[84:87] offset:9216
    v_perm_b32 v80, v54, v50, s44
    v_perm_b32 v81, v62, v58, s44
    v_perm_b32 v82, v70, v66, s44
    v_perm_b32 v83, v78, v74, s44
    ds_write_b128 v13, v[80:83] offset:16384
    v_perm_b32 v84, v54, v50, s45
    v_perm_b32 v85, v62, v58, s45
    v_perm_b32 v86, v70, v66, s45
    v_perm_b32 v87, v78, v74, s45
    ds_write_b128 v13, v[84:87] offset:17408
    v_perm_b32 v80, v55, v51, s44
    v_perm_b32 v81, v63, v59, s44
    v_perm_b32 v82, v71, v67, s44
    v_perm_b32 v83, v79, v75, s44
    ds_write_b128 v13, v[80:83] offset:24576
    v_perm_b32 v84, v55, v51, s45
    v_perm_b32 v85, v63, v59, s45
    v_perm_b32 v86, v71, v67, s45
    v_perm_b32 v87, v79, v75, s45
    ds_write_b128 v13, v[84:87] offset:25600
    s_waitcnt lgkmcnt(0)
    s_barrier
    ds_read_b128 a[224:227], v5 offset:0
    ds_read_b128 v[240:243], v5 offset:1024
    ds_read_b128 a[228:231], v5 offset:2048
    ds_read_b128 v[244:247], v5 offset:3072
    ds_read_b128 a[232:235], v5 offset:4096
    ds_read_b128 v[248:251], v5 offset:5120
    ds_read_b128 a[236:239], v5 offset:6144
    ds_read_b128 v[252:255], v5 offset:7168
    s_waitcnt lgkmcnt(0)
    s_branch M_lw_done
M_lw_chain:
    v_lshrrev_b32 v12, 8, v0
    v_lshlrev_b32 v12, 16, v12
    v_and_b32 v14, 0xf0, v0
    v_add_u32 v12, v12, v14
    s_lshl_b32 s46, s22, 8
    s_lshl_b32 s27, s21, 13
    s_add_u32 s28, s27, 106496
    v_add_u32 v4, s28, v0
    s_add_u32 s28, s27, 24576
    v_add_u32 v5, s28, v0
    s_lshl_b32 s27, s21, 12
    v_add_u32 v6, s27, v0
    s_mul_i32 s27, s21, 20480
    s_add_u32 s27, s27, 24576
    v_add_u32 v7, s27, v0
    s_mul_i32 s48, s20, 10
    s_and_b32 s27, s21, 1
    s_add_u32 s49, s27, 10
    s_sub_u32 s49, s49, s48
    s_add_u32 s48, s48, s27
    v_lshrrev_b32 v8, 9, v0
    v_lshlrev_b32 v8, 4, v8
    v_bfe_u32 v14, v0, 8, 1
    v_add_u32 v8, v8, v14
    v_mul_u32_u24 v8, 2560, v8
    s_and_b32 s47, s21, 1
    s_lshl_b32 s47, s47, 6
    s_lshr_b32 s27, s21, 1
    s_lshl_b32 s27, s27, 2
    s_add_u32 s47, s47, s27
    s_lshl_b32 s27, s22, 7
    s_add_u32 s47, s47, s27
    s_mul_i32 s47, s47, 1280
    s_mul_i32 s27, s20, 640
    s_add_u32 s47, s47, s27
    v_and_b32 v14, 0xf0, v0
    v_add_u32 v8, v8, v14
    s_mov_b32 s90, 5242880
    s_mov_b32 s91, 0x00020000
    s_mov_b32 s44, 0x05040100
    s_mov_b32 s45, 0x07060302
    s_add_u32 s27, s47, 0
    buffer_load_dwordx4 v[16:19], v8, s[84:87], s27 offen
    s_add_u32 s27, s47, 10240
    buffer_load_dwordx4 v[20:23], v8, s[84:87], s27 offen
    s_add_u32 s27, s47, 1280
    buffer_load_dwordx4 v[24:27], v8, s[84:87], s27 offen
    s_add_u32 s27, s47, 11520
    buffer_load_dwordx4 v[28:31], v8, s[84:87], s27 offen
    s_add_u32 s27, s47, 20480
    buffer_load_dwordx4 v[32:35], v8, s[84:87], s27 offen
    s_add_u32 s27, s47, 30720
    buffer_load_dwordx4 v[36:39], v8, s[84:87], s27 offen
    s_add_u32 s27, s47, 21760
    buffer_load_dwordx4 v[40:43], v8, s[84:87], s27 offen
    s_add_u32 s27, s47, 32000
    buffer_load_dwordx4 v[44:47], v8, s[84:87], s27 offen
    s_add_u32 s27, s47, 256
    buffer_load_dwordx4 v[48:51], v8, s[84:87], s27 offen
    s_add_u32 s27, s47, 10496
    buffer_load_dwordx4 v[52:55], v8, s[84:87], s27 offen
    s_add_u32 s27, s47, 1536
    buffer_load_dwordx4 v[56:59], v8, s[84:87], s27 offen
    s_add_u32 s27, s47, 11776
    buffer_load_dwordx4 v[60:63], v8, s[84:87], s27 offen
    s_add_u32 s27, s47, 20736
    buffer_load_dwordx4 v[64:67], v8, s[84:87], s27 offen
    s_add_u32 s27, s47, 30976
    buffer_load_dwordx4 v[68:71], v8, s[84:87], s27 offen
    s_add_u32 s27, s47, 22016
    buffer_load_dwordx4 v[72:75], v8, s[84:87], s27 offen
    s_add_u32 s27, s47, 32256
    buffer_load_dwordx4 v[76:79], v8, s[84:87], s27 offen
    v_and_b32 v13, 0x300, v0
    s_lshl_b32 s27, s21, 10
    s_add_u32 s27, s27, 24576
    v_add_u32 v13, s27, v13
    v_bfe_u32 v14, v0, 7, 1
    v_mul_u32_u24 v14, 20480, v14
    v_add_u32 v13, v13, v14
    v_bfe_u32 v14, v0, 5, 2
    v_lshl_add_u32 v13, v14, 6, v13
    v_and_b32 v14, 16, v0
    v_add_u32 v13, v13, v14
    s_waitcnt vmcnt(14)
    v_perm_b32 v80, v20, v16, s44
    s_waitcnt vmcnt(12)
    v_perm_b32 v81, v28, v24, s44
    s_waitcnt vmcnt(10)
    v_perm_b32 v82, v36, v32, s44
    s_waitcnt vmcnt(8)
    v_perm_b32 v83, v44, v40, s44
    ds_write_b128 v13, v[80:83] offset:0
    v_perm_b32 v84, v20, v16, s45
    v_perm_b32 v85, v28, v24, s45
    v_perm_b32 v86, v36, v32, s45
    v_perm_b32 v87, v44, v40, s45
    ds_write_b128 v13, v[84:87] offset:4096
    v_perm_b32 v80, v21, v17, s44
    v_perm_b32 v81, v29, v25, s44
    v_perm_b32 v82, v37, v33, s44
    v_perm_b32 v83, v45, v41, s44
    ds_write_b128 v13, v[80:83] offset:32
    v_perm_b32 v84, v21, v17, s45
    v_perm_b32 v85, v29, v25, s45
    v_perm_b32 v86, v37, v33, s45
    v_perm_b32 v87, v45, v41, s45
    ds_write_b128 v13, v[84:87] offset:4128
    v_perm_b32 v80, v22, v18, s44
    v_perm_b32 v81, v30, v26, s44
    v_perm_b32 v82, v38, v34, s44
    v_perm_b32 v83, v46, v42, s44
    ds_write_b128 v13, v[80:83] offset:8192
    v_perm_b32 v84, v22, v18, s45
    v_perm_b32 v85, v30, v26, s45
    v_perm_b32 v86, v38, v34, s45
    v_perm_b32 v87, v46, v42, s45
    ds_write_b128 v13, v[84:87] offset:12288
    v_perm_b32 v80, v23, v19, s44
    v_perm_b32 v81, v31, v27, s44
    v_perm_b32 v82, v39, v35, s44
    v_perm_b32 v83, v47, v43, s44
    ds_write_b128 v13, v[80:83] offset:8224
    v_perm_b32 v84, v23, v19, s45
    v_perm_b32 v85, v31, v27, s45
    v_perm_b32 v86, v39, v35, s45
    v_perm_b32 v87, v47, v43, s45
    ds_write_b128 v13, v[84:87] offset:12320
    s_mov_b32 exec_lo, 0x00ff00ff
    s_mov_b32 exec_hi, 0x00ff00ff
    s_add_u32 s27, s47, 512
    buffer_load_dwordx4 v[16:19], v8, s[84:87], s27 offen
    s_add_u32 s27, s47, 10752
    buffer_load_dwordx4 v[20:23], v8, s[84:87], s27 offen
    s_add_u32 s27, s47, 1792
    buffer_load_dwordx4 v[24:27], v8, s[84:87], s27 offen
    s_add_u32 s27, s47, 12032
    buffer_load_dwordx4 v[28:31], v8, s[84:87], s27 offen
    s_add_u32 s27, s47, 20992
    buffer_load_dwordx4 v[32:35], v8, s[84:87], s27 offen
    s_add_u32 s27, s47, 31232
    buffer_load_dwordx4 v[36:39], v8, s[84:87], s27 offen
    s_add_u32 s27, s47, 22272
    buffer_load_dwordx4 v[40:43], v8, s[84:87], s27 offen
    s_add_u32 s27, s47, 32512
    buffer_load_dwordx4 v[44:47], v8, s[84:87], s27 offen
    s_mov_b64 exec, -1
    v_and_b32 v13, 0x300, v0
    s_lshl_b32 s27, s21, 10
    s_add_u32 s27, s27, 65536
    v_add_u32 v13, s27, v13
    v_bfe_u32 v14, v0, 7, 1
    v_mul_u32_u24 v14, 20480, v14
    v_add_u32 v13, v13, v14
    v_bfe_u32 v14, v0, 5, 2
    v_lshl_add_u32 v13, v14, 6, v13
    v_and_b32 v14, 16, v0
    v_add_u32 v13, v13, v14
    s_waitcnt vmcnt(14)
    v_perm_b32 v80, v52, v48, s44
    s_waitcnt vmcnt(12)
    v_perm_b32 v81, v60, v56, s44
    s_waitcnt vmcnt(10)
    v_perm_b32 v82, v68, v64, s44
    s_waitcnt vmcnt(8)
    v_perm_b32 v83, v76, v72, s44
    ds_write_b128 v13, v[80:83] offset:0
    v_perm_b32 v84, v52, v48, s45
    v_perm_b32 v85, v60, v56, s45
    v_perm_b32 v86, v68, v64, s45
    v_perm_b32 v87, v76, v72, s45
    ds_write_b128 v13, v[84:87] offset:4096
    v_perm_b32 v80, v53, v49, s44
    v_perm_b32 v81, v61, v57, s44
    v_perm_b32 v82, v69, v65, s44
    v_perm_b32 v83, v77, v73, s44
    ds_write_b128 v13, v[80:83] offset:32
    v_perm_b32 v84, v53, v49, s45
    v_perm_b32 v85, v61, v57, s45
    v_perm_b32 v86, v69, v65, s45
    v_perm_b32 v87, v77, v73, s45
    ds_write_b128 v13, v[84:87] offset:4128
    v_perm_b32 v80, v54, v50, s44
    v_perm_b32 v81, v62, v58, s44
    v_perm_b32 v82, v70, v66, s44
    v_perm_b32 v83, v78, v74, s44
    ds_write_b128 v13, v[80:83] offset:8192
    v_perm_b32 v84, v54, v50, s45
    v_perm_b32 v85, v62, v58, s45
    v_perm_b32 v86, v70, v66, s45
    v_perm_b32 v87, v78, v74, s45
    ds_write_b128 v13, v[84:87] offset:12288
    v_perm_b32 v80, v55, v51, s44
    v_perm_b32 v81, v63, v59, s44
    v_perm_b32 v82, v71, v67, s44
    v_perm_b32 v83, v79, v75, s44
    ds_write_b128 v13, v[80:83] offset:8224
    v_perm_b32 v84, v55, v51, s45
    v_perm_b32 v85, v63, v59, s45
    v_perm_b32 v86, v71, v67, s45
    v_perm_b32 v87, v79, v75, s45
    ds_write_b128 v13, v[84:87] offset:12320
    s_cmp_lt_u32 s21, 2
    s_cselect_b32 s26, s48, s48
    s_cselect_b32 s27, 0, 2
    s_cselect_b64 s[88:89], s[76:77], s[76:77]
    s_add_u32 s26, s26, s27
    s_lshl_b32 s27, s26, 18
    s_add_u32 s27, s27, s46
    buffer_load_dwordx4 v[48:51], v12, s[88:91], s27 offen
    s_add_u32 s27, s27, 8192
    buffer_load_dwordx4 v[52:55], v12, s[88:91], s27 offen
    s_add_u32 s27, s27, 8192
    buffer_load_dwordx4 v[56:59], v12, s[88:91], s27 offen
    s_add_u32 s27, s27, 8192
    buffer_load_dwordx4 v[60:63], v12, s[88:91], s27 offen
    s_add_u32 s27, s27, 8192
    buffer_load_dwordx4 v[64:67], v12, s[88:91], s27 offen
    s_add_u32 s27, s27, 8192
    buffer_load_dwordx4 v[68:71], v12, s[88:91], s27 offen
    s_add_u32 s27, s27, 8192
    buffer_load_dwordx4 v[72:75], v12, s[88:91], s27 offen
    s_add_u32 s27, s27, 8192
    buffer_load_dwordx4 v[76:79], v12, s[88:91], s27 offen
    v_and_b32 v13, 0x300, v0
    s_lshl_b32 s27, s21, 10
    s_add_u32 s27, s27, 40960
    v_add_u32 v13, s27, v13
    v_bfe_u32 v14, v0, 5, 2
    v_mul_u32_u24 v14, 20480, v14
    v_add_u32 v13, v13, v14
    v_bfe_u32 v14, v0, 4, 1
    v_lshl_add_u32 v13, v14, 6, v13
    s_mov_b32 exec_lo, 0x00ff00ff
    s_mov_b32 exec_hi, 0x00ff00ff
    s_waitcnt vmcnt(14)
    v_perm_b32 v80, v20, v16, s44
    s_waitcnt vmcnt(12)
    v_perm_b32 v81, v28, v24, s44
    s_waitcnt vmcnt(10)
    v_perm_b32 v82, v36, v32, s44
    s_waitcnt vmcnt(8)
    v_perm_b32 v83, v44, v40, s44
    ds_write_b128 v13, v[80:83] offset:0
    v_perm_b32 v84, v20, v16, s45
    v_perm_b32 v85, v28, v24, s45
    v_perm_b32 v86, v36, v32, s45
    v_perm_b32 v87, v44, v40, s45
    ds_write_b128 v13, v[84:87] offset:16
    v_perm_b32 v80, v21, v17, s44
    v_perm_b32 v81, v29, v25, s44
    v_perm_b32 v82, v37, v33, s44
    v_perm_b32 v83, v45, v41, s44
    ds_write_b128 v13, v[80:83] offset:128
    v_perm_b32 v84, v21, v17, s45
    v_perm_b32 v85, v29, v25, s45
    v_perm_b32 v86, v37, v33, s45
    v_perm_b32 v87, v45, v41, s45
    ds_write_b128 v13, v[84:87] offset:144
    v_perm_b32 v80, v22, v18, s44
    v_perm_b32 v81, v30, v26, s44
    v_perm_b32 v82, v38, v34, s44
    v_perm_b32 v83, v46, v42, s44
    ds_write_b128 v13, v[80:83] offset:32
    v_perm_b32 v84, v22, v18, s45
    v_perm_b32 v85, v30, v26, s45
    v_perm_b32 v86, v38, v34, s45
    v_perm_b32 v87, v46, v42, s45
    ds_write_b128 v13, v[84:87] offset:48
    v_perm_b32 v80, v23, v19, s44
    v_perm_b32 v81, v31, v27, s44
    v_perm_b32 v82, v39, v35, s44
    v_perm_b32 v83, v47, v43, s44
    ds_write_b128 v13, v[80:83] offset:160
    v_perm_b32 v84, v23, v19, s45
    v_perm_b32 v85, v31, v27, s45
    v_perm_b32 v86, v39, v35, s45
    v_perm_b32 v87, v47, v43, s45
    ds_write_b128 v13, v[84:87] offset:176
    s_mov_b64 exec, -1
    s_cmp_lt_u32 s21, 2
    s_cselect_b32 s26, s48, s49
    s_cselect_b32 s27, 6, 4
    s_cselect_b64 s[88:89], s[76:77], s[72:73]
    s_add_u32 s26, s26, s27
    s_lshl_b32 s27, s26, 18
    s_add_u32 s27, s27, s46
    buffer_load_dwordx4 v[16:19], v12, s[88:91], s27 offen
    s_add_u32 s27, s27, 8192
    buffer_load_dwordx4 v[20:23], v12, s[88:91], s27 offen
    s_add_u32 s27, s27, 8192
    buffer_load_dwordx4 v[24:27], v12, s[88:91], s27 offen
    s_add_u32 s27, s27, 8192
    buffer_load_dwordx4 v[28:31], v12, s[88:91], s27 offen
    s_add_u32 s27, s27, 8192
    buffer_load_dwordx4 v[32:35], v12, s[88:91], s27 offen
    s_add_u32 s27, s27, 8192
    buffer_load_dwordx4 v[36:39], v12, s[88:91], s27 offen
    s_add_u32 s27, s27, 8192
    buffer_load_dwordx4 v[40:43], v12, s[88:91], s27 offen
    s_add_u32 s27, s27, 8192
    buffer_load_dwordx4 v[44:47], v12, s[88:91], s27 offen
    s_waitcnt lgkmcnt(0)
    s_barrier
    ds_read_b128 v[160:163], v7 offset:0
    ds_read_b128 v[164:167], v7 offset:1024
    ds_read_b128 v[152:155], v7 offset:2048
    ds_read_b128 v[156:159], v7 offset:3072
    ds_read_b128 v[144:147], v7 offset:4096
    ds_read_b128 v[148:151], v7 offset:5120
    ds_read_b128 v[136:139], v7 offset:6144
    ds_read_b128 v[140:143], v7 offset:7168
    ds_read_b128 v[128:131], v7 offset:8192
    ds_read_b128 v[132:135], v7 offset:9216
    ds_read_b128 v[120:123], v7 offset:10240
    ds_read_b128 v[124:127], v7 offset:11264
    ds_read_b128 v[112:115], v7 offset:12288
    ds_read_b128 v[116:119], v7 offset:13312
    ds_read_b128 v[104:107], v7 offset:14336
    ds_read_b128 v[108:111], v7 offset:15360
    ds_read_b128 v[96:99], v7 offset:16384
    ds_read_b128 v[100:103], v7 offset:17408
    ds_read_b128 v[88:91], v7 offset:18432
    ds_read_b128 v[92:95], v7 offset:19456
    s_lshl_b32 s27, s21, 11
    s_add_u32 s27, s27, 106496
    v_add_u32 v13, s27, v0
    s_waitcnt vmcnt(14)
    v_perm_b32 v80, v52, v48, s44
    s_waitcnt vmcnt(12)
    v_perm_b32 v81, v60, v56, s44
    s_waitcnt vmcnt(10)
    v_perm_b32 v82, v68, v64, s44
    s_waitcnt vmcnt(8)
    v_perm_b32 v83, v76, v72, s44
    ds_write_b128 v13, v[80:83] offset:0
    v_perm_b32 v84, v52, v48, s45
    v_perm_b32 v85, v60, v56, s45
    v_perm_b32 v86, v68, v64, s45
    v_perm_b32 v87, v76, v72, s45
    ds_write_b128 v13, v[84:87] offset:1024
    v_perm_b32 v80, v53, v49, s44
    v_perm_b32 v81, v61, v57, s44
    v_perm_b32 v82, v69, v65, s44
    v_perm_b32 v83, v77, v73, s44
    ds_write_b128 v13, v[80:83] offset:8192
    v_perm_b32 v84, v53, v49, s45
    v_perm_b32 v85, v61, v57, s45
    v_perm_b32 v86, v69, v65, s45
    v_perm_b32 v87, v77, v73, s45
    ds_write_b128 v13, v[84:87] offset:9216
    v_perm_b32 v80, v54, v50, s44
    v_perm_b32 v81, v62, v58, s44
    v_perm_b32 v82, v70, v66, s44
    v_perm_b32 v83, v78, v74, s44
    ds_write_b128 v13, v[80:83] offset:16384
    v_perm_b32 v84, v54, v50, s45
    v_perm_b32 v85, v62, v58, s45
    v_perm_b32 v86, v70, v66, s45
    v_perm_b32 v87, v78, v74, s45
    ds_write_b128 v13, v[84:87] offset:17408
    v_perm_b32 v80, v55, v51, s44
    v_perm_b32 v81, v63, v59, s44
    v_perm_b32 v82, v71, v67, s44
    v_perm_b32 v83, v79, v75, s44
    ds_write_b128 v13, v[80:83] offset:24576
    v_perm_b32 v84, v55, v51, s45
    v_perm_b32 v85, v63, v59, s45
    v_perm_b32 v86, v71, v67, s45
    v_perm_b32 v87, v79, v75, s45
    ds_write_b128 v13, v[84:87] offset:25600
    s_cmp_lt_u32 s21, 2
    s_cselect_b32 s26, s49, s49
    s_cselect_b32 s27, 4, 8
    s_cselect_b64 s[88:89], s[76:77], s[76:77]
    s_add_u32 s26, s26, s27
    s_lshl_b32 s27, s26, 18
    s_add_u32 s27, s27, s46
    buffer_load_dwordx4 v[48:51], v12, s[88:91], s27 offen
    s_add_u32 s27, s27, 8192
    buffer_load_dwordx4 v[52:55], v12, s[88:91], s27 offen
    s_add_u32 s27, s27, 8192
    buffer_load_dwordx4 v[56:59], v12, s[88:91], s27 offen
    s_add_u32 s27, s27, 8192
    buffer_load_dwordx4 v[60:63], v12, s[88:91], s27 offen
    s_add_u32 s27, s27, 8192
    buffer_load_dwordx4 v[64:67], v12, s[88:91], s27 offen
    s_add_u32 s27, s27, 8192
    buffer_load_dwordx4 v[68:71], v12, s[88:91], s27 offen
    s_add_u32 s27, s27, 8192
    buffer_load_dwordx4 v[72:75], v12, s[88:91], s27 offen
    s_add_u32 s27, s27, 8192
    buffer_load_dwordx4 v[76:79], v12, s[88:91], s27 offen
    s_waitcnt lgkmcnt(0)
    s_barrier
    ds_read_b128 a[248:251], v4 offset:0
    ds_read_b128 a[240:243], v4 offset:1024
    ds_read_b128 a[252:255], v4 offset:2048
    ds_read_b128 a[244:247], v4 offset:3072
    ds_read_b128 a[216:219], v4 offset:4096
    ds_read_b128 a[208:211], v4 offset:5120
    ds_read_b128 a[220:223], v4 offset:6144
    ds_read_b128 a[212:215], v4 offset:7168
    s_lshl_b32 s27, s21, 11
    s_add_u32 s27, s27, 24576
    v_add_u32 v13, s27, v0
    s_waitcnt vmcnt(14)
    v_perm_b32 v80, v20, v16, s44
    s_waitcnt vmcnt(12)
    v_perm_b32 v81, v28, v24, s44
    s_waitcnt vmcnt(10)
    v_perm_b32 v82, v36, v32, s44
    s_waitcnt vmcnt(8)
    v_perm_b32 v83, v44, v40, s44
    ds_write_b128 v13, v[80:83] offset:0
    v_perm_b32 v84, v20, v16, s45
    v_perm_b32 v85, v28, v24, s45
    v_perm_b32 v86, v36, v32, s45
    v_perm_b32 v87, v44, v40, s45
    ds_write_b128 v13, v[84:87] offset:1024
    v_perm_b32 v80, v21, v17, s44
    v_perm_b32 v81, v29, v25, s44
    v_perm_b32 v82, v37, v33, s44
    v_perm_b32 v83, v45, v41, s44
    ds_write_b128 v13, v[80:83] offset:8192
    v_perm_b32 v84, v21, v17, s45
    v_perm_b32 v85, v29, v25, s45
    v_perm_b32 v86, v37, v33, s45
    v_perm_b32 v87, v45, v41, s45
    ds_write_b128 v13, v[84:87] offset:9216
    v_perm_b32 v80, v22, v18, s44
    v_perm_b32 v81, v30, v26, s44
    v_perm_b32 v82, v38, v34, s44
    v_perm_b32 v83, v46, v42, s44
    ds_write_b128 v13, v[80:83] offset:16384
    v_perm_b32 v84, v22, v18, s45
    v_perm_b32 v85, v30, v26, s45
    v_perm_b32 v86, v38, v34, s45
    v_perm_b32 v87, v46, v42, s45
    ds_write_b128 v13, v[84:87] offset:17408
    v_perm_b32 v80, v23, v19, s44
    v_perm_b32 v81, v31, v27, s44
    v_perm_b32 v82, v39, v35, s44
    v_perm_b32 v83, v47, v43, s44
    ds_write_b128 v13, v[80:83] offset:24576
    v_perm_b32 v84, v23, v19, s45
    v_perm_b32 v85, v31, v27, s45
    v_perm_b32 v86, v39, v35, s45
    v_perm_b32 v87, v47, v43, s45
    ds_write_b128 v13, v[84:87] offset:25600
    s_cmp_lt_u32 s21, 2
    s_cselect_b32 s26, s49, s49
    s_cselect_b32 s27, 0, 2
    s_cselect_b64 s[88:89], s[80:81], s[80:81]
    s_add_u32 s26, s26, s27
    s_lshl_b32 s27, s26, 18
    s_add_u32 s27, s27, s46
    buffer_load_dwordx4 v[16:19], v12, s[88:91], s27 offen
    s_add_u32 s27, s27, 8192
    buffer_load_dwordx4 v[20:23], v12, s[88:91], s27 offen
    s_add_u32 s27, s27, 8192
    buffer_load_dwordx4 v[24:27], v12, s[88:91], s27 offen
    s_add_u32 s27, s27, 8192
    buffer_load_dwordx4 v[28:31], v12, s[88:91], s27 offen
    s_add_u32 s27, s27, 8192
    buffer_load_dwordx4 v[32:35], v12, s[88:91], s27 offen
    s_add_u32 s27, s27, 8192
    buffer_load_dwordx4 v[36:39], v12, s[88:91], s27 offen
    s_add_u32 s27, s27, 8192
    buffer_load_dwordx4 v[40:43], v12, s[88:91], s27 offen
    s_add_u32 s27, s27, 8192
    buffer_load_dwordx4 v[44:47], v12, s[88:91], s27 offen
    s_waitcnt lgkmcnt(0)
    s_barrier
    ds_read_b128 a[168:171], v5 offset:0
    ds_read_b128 a[160:163], v5 offset:1024
    ds_read_b128 a[172:175], v5 offset:2048
    ds_read_b128 a[164:167], v5 offset:3072
    ds_read_b128 a[120:123], v5 offset:4096
    ds_read_b128 a[112:115], v5 offset:5120
    ds_read_b128 a[124:127], v5 offset:6144
    ds_read_b128 a[116:119], v5 offset:7168
    s_lshl_b32 s27, s21, 11
    s_add_u32 s27, s27, 106496
    v_add_u32 v13, s27, v0
    s_waitcnt vmcnt(14)
    v_perm_b32 v80, v52, v48, s44
    s_waitcnt vmcnt(12)
    v_perm_b32 v81, v60, v56, s44
    s_waitcnt vmcnt(10)
    v_perm_b32 v82, v68, v64, s44
    s_waitcnt vmcnt(8)
    v_perm_b32 v83, v76, v72, s44
    ds_write_b128 v13, v[80:83] offset:0
    v_perm_b32 v84, v52, v48, s45
    v_perm_b32 v85, v60, v56, s45
    v_perm_b32 v86, v68, v64, s45
    v_perm_b32 v87, v76, v72, s45
    ds_write_b128 v13, v[84:87] offset:1024
    v_perm_b32 v80, v53, v49, s44
    v_perm_b32 v81, v61, v57, s44
    v_perm_b32 v82, v69, v65, s44
    v_perm_b32 v83, v77, v73, s44
    ds_write_b128 v13, v[80:83] offset:8192
    v_perm_b32 v84, v53, v49, s45
    v_perm_b32 v85, v61, v57, s45
    v_perm_b32 v86, v69, v65, s45
    v_perm_b32 v87, v77, v73, s45
    ds_write_b128 v13, v[84:87] offset:9216
    v_perm_b32 v80, v54, v50, s44
    v_perm_b32 v81, v62, v58, s44
    v_perm_b32 v82, v70, v66, s44
    v_perm_b32 v83, v78, v74, s44
    ds_write_b128 v13, v[80:83] offset:16384
    v_perm_b32 v84, v54, v50, s45
    v_perm_b32 v85, v62, v58, s45
    v_perm_b32 v86, v70, v66, s45
    v_perm_b32 v87, v78, v74, s45
    ds_write_b128 v13, v[84:87] offset:17408
    v_perm_b32 v80, v55, v51, s44
    v_perm_b32 v81, v63, v59, s44
    v_perm_b32 v82, v71, v67, s44
    v_perm_b32 v83, v79, v75, s44
    ds_write_b128 v13, v[80:83] offset:24576
    v_perm_b32 v84, v55, v51, s45
    v_perm_b32 v85, v63, v59, s45
    v_perm_b32 v86, v71, v67, s45
    v_perm_b32 v87, v79, v75, s45
    ds_write_b128 v13, v[84:87] offset:25600
    s_cmp_lt_u32 s21, 2
    s_cselect_b32 s26, s49, s49
    s_cselect_b32 s27, 4, 6
    s_cselect_b64 s[88:89], s[80:81], s[80:81]
    s_add_u32 s26, s26, s27
    s_lshl_b32 s27, s26, 18
    s_add_u32 s27, s27, s46
    buffer_load_dwordx4 v[48:51], v12, s[88:91], s27 offen
    s_add_u32 s27, s27, 8192
    buffer_load_dwordx4 v[52:55], v12, s[88:91], s27 offen
    s_add_u32 s27, s27, 8192
    buffer_load_dwordx4 v[56:59], v12, s[88:91], s27 offen
    s_add_u32 s27, s27, 8192
    buffer_load_dwordx4 v[60:63], v12, s[88:91], s27 offen
    s_add_u32 s27, s27, 8192
    buffer_load_dwordx4 v[64:67], v12, s[88:91], s27 offen
    s_add_u32 s27, s27, 8192
    buffer_load_dwordx4 v[68:71], v12, s[88:91], s27 offen
    s_add_u32 s27, s27, 8192
    buffer_load_dwordx4 v[72:75], v12, s[88:91], s27 offen
    s_add_u32 s27, s27, 8192
    buffer_load_dwordx4 v[76:79], v12, s[88:91], s27 offen
    s_waitcnt lgkmcnt(0)
    s_barrier
    ds_read_b128 a[72:75], v4 offset:0
    ds_read_b128 a[64:67], v4 offset:1024
    ds_read_b128 a[76:79], v4 offset:2048
    ds_read_b128 a[68:71], v4 offset:3072
    ds_read_b128 a[48:51], v4 offset:4096
    ds_read_b128 a[40:43], v4 offset:5120
    ds_read_b128 a[52:55], v4 offset:6144
    ds_read_b128 a[44:47], v4 offset:7168
    s_lshl_b32 s27, s21, 11
    s_add_u32 s27, s27, 24576
    v_add_u32 v13, s27, v0
    s_waitcnt vmcnt(14)
    v_perm_b32 v80, v20, v16, s44
    s_waitcnt vmcnt(12)
    v_perm_b32 v81, v28, v24, s44
    s_waitcnt vmcnt(10)
    v_perm_b32 v82, v36, v32, s44
    s_waitcnt vmcnt(8)
    v_perm_b32 v83, v44, v40, s44
    ds_write_b128 v13, v[80:83] offset:0
    v_perm_b32 v84, v20, v16, s45
    v_perm_b32 v85, v28, v24, s45
    v_perm_b32 v86, v36, v32, s45
    v_perm_b32 v87, v44, v40, s45
    ds_write_b128 v13, v[84:87] offset:1024
    v_perm_b32 v80, v21, v17, s44
    v_perm_b32 v81, v29, v25, s44
    v_perm_b32 v82, v37, v33, s44
    v_perm_b32 v83, v45, v41, s44
    ds_write_b128 v13, v[80:83] offset:8192
    v_perm_b32 v84, v21, v17, s45
    v_perm_b32 v85, v29, v25, s45
    v_perm_b32 v86, v37, v33, s45
    v_perm_b32 v87, v45, v41, s45
    ds_write_b128 v13, v[84:87] offset:9216
    v_perm_b32 v80, v22, v18, s44
    v_perm_b32 v81, v30, v26, s44
    v_perm_b32 v82, v38, v34, s44
    v_perm_b32 v83, v46, v42, s44
    ds_write_b128 v13, v[80:83] offset:16384
    v_perm_b32 v84, v22, v18, s45
    v_perm_b32 v85, v30, v26, s45
    v_perm_b32 v86, v38, v34, s45
    v_perm_b32 v87, v46, v42, s45
    ds_write_b128 v13, v[84:87] offset:17408
    v_perm_b32 v80, v23, v19, s44
    v_perm_b32 v81, v31, v27, s44
    v_perm_b32 v82, v39, v35, s44
    v_perm_b32 v83, v47, v43, s44
    ds_write_b128 v13, v[80:83] offset:24576
    v_perm_b32 v84, v23, v19, s45
    v_perm_b32 v85, v31, v27, s45
    v_perm_b32 v86, v39, v35, s45
    v_perm_b32 v87, v47, v43, s45
    ds_write_b128 v13, v[84:87] offset:25600
    s_cmp_lt_u32 s21, 2
    s_cselect_b32 s26, s49, s48
    s_cselect_b32 s27, 8, 4
    s_cselect_b64 s[88:89], s[80:81], s[80:81]
    s_add_u32 s26, s26, s27
    s_lshl_b32 s27, s26, 18
    s_add_u32 s27, s27, s46
    buffer_load_dwordx4 v[16:19], v12, s[88:91], s27 offen
    s_add_u32 s27, s27, 8192
    buffer_load_dwordx4 v[20:23], v12, s[88:91], s27 offen
    s_add_u32 s27, s27, 8192
    buffer_load_dwordx4 v[24:27], v12, s[88:91], s27 offen
    s_add_u32 s27, s27, 8192
    buffer_load_dwordx4 v[28:31], v12, s[88:91], s27 offen
    s_add_u32 s27, s27, 8192
    buffer_load_dwordx4 v[32:35], v12, s[88:91], s27 offen
    s_add_u32 s27, s27, 8192
    buffer_load_dwordx4 v[36:39], v12, s[88:91], s27 offen
    s_add_u32 s27, s27, 8192
    buffer_load_dwordx4 v[40:43], v12, s[88:91], s27 offen
    s_add_u32 s27, s27, 8192
    buffer_load_dwordx4 v[44:47], v12, s[88:91], s27 offen
    s_waitcnt lgkmcnt(0)
    s_barrier
    ds_read_b128 a[32:35], v5 offset:0
    ds_read_b128 a[24:27], v5 offset:1024
    ds_read_b128 a[36:39], v5 offset:2048
    ds_read_b128 a[28:31], v5 offset:3072
    ds_read_b128 a[16:19], v5 offset:4096
    ds_read_b128 a[8:11], v5 offset:5120
    ds_read_b128 a[20:23], v5 offset:6144
    ds_read_b128 a[12:15], v5 offset:7168
    s_lshl_b32 s27, s21, 11
    s_add_u32 s27, s27, 106496
    v_add_u32 v13, s27, v0
    s_waitcnt vmcnt(14)
    v_perm_b32 v80, v52, v48, s44
    s_waitcnt vmcnt(12)
    v_perm_b32 v81, v60, v56, s44
    s_waitcnt vmcnt(10)
    v_perm_b32 v82, v68, v64, s44
    s_waitcnt vmcnt(8)
    v_perm_b32 v83, v76, v72, s44
    ds_write_b128 v13, v[80:83] offset:0
    v_perm_b32 v84, v52, v48, s45
    v_perm_b32 v85, v60, v56, s45
    v_perm_b32 v86, v68, v64, s45
    v_perm_b32 v87, v76, v72, s45
    ds_write_b128 v13, v[84:87] offset:1024
    v_perm_b32 v80, v53, v49, s44
    v_perm_b32 v81, v61, v57, s44
    v_perm_b32 v82, v69, v65, s44
    v_perm_b32 v83, v77, v73, s44
    ds_write_b128 v13, v[80:83] offset:8192
    v_perm_b32 v84, v53, v49, s45
    v_perm_b32 v85, v61, v57, s45
    v_perm_b32 v86, v69, v65, s45
    v_perm_b32 v87, v77, v73, s45
    ds_write_b128 v13, v[84:87] offset:9216
    v_perm_b32 v80, v54, v50, s44
    v_perm_b32 v81, v62, v58, s44
    v_perm_b32 v82, v70, v66, s44
    v_perm_b32 v83, v78, v74, s44
    ds_write_b128 v13, v[80:83] offset:16384
    v_perm_b32 v84, v54, v50, s45
    v_perm_b32 v85, v62, v58, s45
    v_perm_b32 v86, v70, v66, s45
    v_perm_b32 v87, v78, v74, s45
    ds_write_b128 v13, v[84:87] offset:17408
    v_perm_b32 v80, v55, v51, s44
    v_perm_b32 v81, v63, v59, s44
    v_perm_b32 v82, v71, v67, s44
    v_perm_b32 v83, v79, v75, s44
    ds_write_b128 v13, v[80:83] offset:24576
    v_perm_b32 v84, v55, v51, s45
    v_perm_b32 v85, v63, v59, s45
    v_perm_b32 v86, v71, v67, s45
    v_perm_b32 v87, v79, v75, s45
    ds_write_b128 v13, v[84:87] offset:25600
    s_cmp_lt_u32 s21, 2
    s_cselect_b32 s26, s48, s48
    s_cselect_b32 s27, 6, 8
    s_cselect_b64 s[88:89], s[80:81], s[80:81]
    s_add_u32 s26, s26, s27
    s_lshl_b32 s27, s26, 18
    s_add_u32 s27, s27, s46
    buffer_load_dwordx4 v[48:51], v12, s[88:91], s27 offen
    s_add_u32 s27, s27, 8192
    buffer_load_dwordx4 v[52:55], v12, s[88:91], s27 offen
    s_add_u32 s27, s27, 8192
    buffer_load_dwordx4 v[56:59], v12, s[88:91], s27 offen
    s_add_u32 s27, s27, 8192
    buffer_load_dwordx4 v[60:63], v12, s[88:91], s27 offen
    s_add_u32 s27, s27, 8192
    buffer_load_dwordx4 v[64:67], v12, s[88:91], s27 offen
    s_add_u32 s27, s27, 8192
    buffer_load_dwordx4 v[68:71], v12, s[88:91], s27 offen
    s_add_u32 s27, s27, 8192
    buffer_load_dwordx4 v[72:75], v12, s[88:91], s27 offen
    s_add_u32 s27, s27, 8192
    buffer_load_dwordx4 v[76:79], v12, s[88:91], s27 offen
    s_waitcnt lgkmcnt(0)
    s_barrier
    ds_read_b128 a[0:3], v4 offset:0
    ds_read_b128 v[248:251], v4 offset:1024
    ds_read_b128 a[4:7], v4 offset:2048
    ds_read_b128 v[252:255], v4 offset:3072
    ds_read_b128 v[240:243], v4 offset:4096
    ds_read_b128 v[232:235], v4 offset:5120
    ds_read_b128 v[244:247], v4 offset:6144
    ds_read_b128 v[236:239], v4 offset:7168
    s_lshl_b32 s27, s21, 11
    s_add_u32 s27, s27, 24576
    v_add_u32 v13, s27, v0
    s_waitcnt vmcnt(14)
    v_perm_b32 v80, v20, v16, s44
    s_waitcnt vmcnt(12)
    v_perm_b32 v81, v28, v24, s44
    s_waitcnt vmcnt(10)
    v_perm_b32 v82, v36, v32, s44
    s_waitcnt vmcnt(8)
    v_perm_b32 v83, v44, v40, s44
    ds_write_b128 v13, v[80:83] offset:0
    v_perm_b32 v84, v20, v16, s45
    v_perm_b32 v85, v28, v24, s45
    v_perm_b32 v86, v36, v32, s45
    v_perm_b32 v87, v44, v40, s45
    ds_write_b128 v13, v[84:87] offset:1024
    v_perm_b32 v80, v21, v17, s44
    v_perm_b32 v81, v29, v25, s44
    v_perm_b32 v82, v37, v33, s44
    v_perm_b32 v83, v45, v41, s44
    ds_write_b128 v13, v[80:83] offset:8192
    v_perm_b32 v84, v21, v17, s45
    v_perm_b32 v85, v29, v25, s45
    v_perm_b32 v86, v37, v33, s45
    v_perm_b32 v87, v45, v41, s45
    ds_write_b128 v13, v[84:87] offset:9216
    v_perm_b32 v80, v22, v18, s44
    v_perm_b32 v81, v30, v26, s44
    v_perm_b32 v82, v38, v34, s44
    v_perm_b32 v83, v46, v42, s44
    ds_write_b128 v13, v[80:83] offset:16384
    v_perm_b32 v84, v22, v18, s45
    v_perm_b32 v85, v30, v26, s45
    v_perm_b32 v86, v38, v34, s45
    v_perm_b32 v87, v46, v42, s45
    ds_write_b128 v13, v[84:87] offset:17408
    v_perm_b32 v80, v23, v19, s44
    v_perm_b32 v81, v31, v27, s44
    v_perm_b32 v82, v39, v35, s44
    v_perm_b32 v83, v47, v43, s44
    ds_write_b128 v13, v[80:83] offset:24576
    v_perm_b32 v84, v23, v19, s45
    v_perm_b32 v85, v31, v27, s45
    v_perm_b32 v86, v39, v35, s45
    v_perm_b32 v87, v47, v43, s45
    ds_write_b128 v13, v[84:87] offset:25600
    s_cmp_lt_u32 s21, 2
    s_cselect_b32 s26, s48, s48
    s_cselect_b32 s27, 0, 0
    s_cselect_b64 s[88:89], s[72:73], s[80:81]
    s_add_u32 s26, s26, s27
    s_lshl_b32 s27, s26, 18
    s_add_u32 s27, s27, s46
    buffer_load_dwordx4 v[16:19], v12, s[88:91], s27 offen
    s_add_u32 s27, s27, 8192
    buffer_load_dwordx4 v[20:23], v12, s[88:91], s27 offen
    s_add_u32 s27, s27, 8192
    buffer_load_dwordx4 v[24:27], v12, s[88:91], s27 offen
    s_add_u32 s27, s27, 8192
    buffer_load_dwordx4 v[28:31], v12, s[88:91], s27 offen
    s_add_u32 s27, s27, 8192
    buffer_load_dwordx4 v[32:35], v12, s[88:91], s27 offen
    s_add_u32 s27, s27, 8192
    buffer_load_dwordx4 v[36:39], v12, s[88:91], s27 offen
    s_add_u32 s27, s27, 8192
    buffer_load_dwordx4 v[40:43], v12, s[88:91], s27 offen
    s_add_u32 s27, s27, 8192
    buffer_load_dwordx4 v[44:47], v12, s[88:91], s27 offen
    s_waitcnt lgkmcnt(0)
    s_barrier
    ds_read_b128 v[224:227], v5 offset:0
    ds_read_b128 v[216:219], v5 offset:1024
    ds_read_b128 v[228:231], v5 offset:2048
    ds_read_b128 v[220:223], v5 offset:3072
    ds_read_b128 v[208:211], v5 offset:4096
    ds_read_b128 v[200:203], v5 offset:5120
    ds_read_b128 v[212:215], v5 offset:6144
    ds_read_b128 v[204:207], v5 offset:7168
    s_lshl_b32 s27, s21, 11
    s_add_u32 s27, s27, 106496
    v_add_u32 v13, s27, v0
    s_waitcnt vmcnt(14)
    v_perm_b32 v80, v52, v48, s44
    s_waitcnt vmcnt(12)
    v_perm_b32 v81, v60, v56, s44
    s_waitcnt vmcnt(10)
    v_perm_b32 v82, v68, v64, s44
    s_waitcnt vmcnt(8)
    v_perm_b32 v83, v76, v72, s44
    ds_write_b128 v13, v[80:83] offset:0
    v_perm_b32 v84, v52, v48, s45
    v_perm_b32 v85, v60, v56, s45
    v_perm_b32 v86, v68, v64, s45
    v_perm_b32 v87, v76, v72, s45
    ds_write_b128 v13, v[84:87] offset:1024
    v_perm_b32 v80, v53, v49, s44
    v_perm_b32 v81, v61, v57, s44
    v_perm_b32 v82, v69, v65, s44
    v_perm_b32 v83, v77, v73, s44
    ds_write_b128 v13, v[80:83] offset:8192
    v_perm_b32 v84, v53, v49, s45
    v_perm_b32 v85, v61, v57, s45
    v_perm_b32 v86, v69, v65, s45
    v_perm_b32 v87, v77, v73, s45
    ds_write_b128 v13, v[84:87] offset:9216
    v_perm_b32 v80, v54, v50, s44
    v_perm_b32 v81, v62, v58, s44
    v_perm_b32 v82, v70, v66, s44
    v_perm_b32 v83, v78, v74, s44
    ds_write_b128 v13, v[80:83] offset:16384
    v_perm_b32 v84, v54, v50, s45
    v_perm_b32 v85, v62, v58, s45
    v_perm_b32 v86, v70, v66, s45
    v_perm_b32 v87, v78, v74, s45
    ds_write_b128 v13, v[84:87] offset:17408
    v_perm_b32 v80, v55, v51, s44
    v_perm_b32 v81, v63, v59, s44
    v_perm_b32 v82, v71, v67, s44
    v_perm_b32 v83, v79, v75, s44
    ds_write_b128 v13, v[80:83] offset:24576
    v_perm_b32 v84, v55, v51, s45
    v_perm_b32 v85, v63, v59, s45
    v_perm_b32 v86, v71, v67, s45
    v_perm_b32 v87, v79, v75, s45
    ds_write_b128 v13, v[84:87] offset:25600
    s_cmp_lt_u32 s21, 2
    s_cselect_b32 s26, s48, s48
    s_cselect_b32 s27, 2, 2
    s_cselect_b64 s[88:89], s[72:73], s[80:81]
    s_add_u32 s26, s26, s27
    s_lshl_b32 s27, s26, 18
    s_add_u32 s27, s27, s46
    buffer_load_dwordx4 v[48:51], v12, s[88:91], s27 offen
    s_add_u32 s27, s27, 8192
    buffer_load_dwordx4 v[52:55], v12, s[88:91], s27 offen
    s_add_u32 s27, s27, 8192
    buffer_load_dwordx4 v[56:59], v12, s[88:91], s27 offen
    s_add_u32 s27, s27, 8192
    buffer_load_dwordx4 v[60:63], v12, s[88:91], s27 offen
    s_add_u32 s27, s27, 8192
    buffer_load_dwordx4 v[64:67], v12, s[88:91], s27 offen
    s_add_u32 s27, s27, 8192
    buffer_load_dwordx4 v[68:71], v12, s[88:91], s27 offen
    s_add_u32 s27, s27, 8192
    buffer_load_dwordx4 v[72:75], v12, s[88:91], s27 offen
    s_add_u32 s27, s27, 8192
    buffer_load_dwordx4 v[76:79], v12, s[88:91], s27 offen
    s_waitcnt lgkmcnt(0)
    s_barrier
    ds_read_b128 v[192:195], v4 offset:0
    ds_read_b128 v[184:187], v4 offset:1024
    ds_read_b128 v[196:199], v4 offset:2048
    ds_read_b128 v[188:191], v4 offset:3072
    ds_read_b128 v[176:179], v4 offset:4096
    ds_read_b128 v[168:171], v4 offset:5120
    ds_read_b128 v[180:183], v4 offset:6144
    ds_read_b128 v[172:175], v4 offset:7168
    s_waitcnt lgkmcnt(0)
    s_barrier
    s_and_b32 s28, s21, 1
    s_lshl_b32 s28, s28, 10
    s_mov_b32 s29, 2048
    s_mov_b32 s30, 4096
    s_cmp_lt_u32 s21, 2
    s_cselect_b32 s29, 24576, s29
    s_cselect_b32 s30, 34816, s30
    s_add_u32 s29, s29, s28
    v_add_u32 v13, s29, v0
    s_add_u32 s29, s29, s30
    s_waitcnt vmcnt(14)
    v_perm_b32 v80, v20, v16, s44
    s_waitcnt vmcnt(12)
    v_perm_b32 v81, v28, v24, s44
    s_waitcnt vmcnt(10)
    v_perm_b32 v82, v36, v32, s44
    s_waitcnt vmcnt(8)
    v_perm_b32 v83, v44, v40, s44
    ds_write_b128 v13, v[80:83]
    v_add_u32 v14, s29, v0
    s_add_u32 s29, s29, s30
    v_perm_b32 v84, v21, v17, s44
    v_perm_b32 v85, v29, v25, s44
    v_perm_b32 v86, v37, v33, s44
    v_perm_b32 v87, v45, v41, s44
    ds_write_b128 v14, v[84:87]
    v_add_u32 v13, s29, v0
    s_add_u32 s29, s29, s30
    v_perm_b32 v80, v22, v18, s44
    v_perm_b32 v81, v30, v26, s44
    v_perm_b32 v82, v38, v34, s44
    v_perm_b32 v83, v46, v42, s44
    ds_write_b128 v13, v[80:83]
    v_add_u32 v14, s29, v0
    s_add_u32 s29, s29, s30
    v_perm_b32 v84, v23, v19, s44
    v_perm_b32 v85, v31, v27, s44
    v_perm_b32 v86, v39, v35, s44
    v_perm_b32 v87, v47, v43, s44
    ds_write_b128 v14, v[84:87]
    s_mov_b32 s29, 28672
    s_mov_b32 s30, 34816
    s_cmp_lt_u32 s21, 2
    s_cselect_b32 s29, 26624, s29
    s_cselect_b32 s30, 34816, s30
    s_add_u32 s29, s29, s28
    v_add_u32 v13, s29, v0
    s_add_u32 s29, s29, s30
    v_perm_b32 v80, v20, v16, s45
    v_perm_b32 v81, v28, v24, s45
    v_perm_b32 v82, v36, v32, s45
    v_perm_b32 v83, v44, v40, s45
    ds_write_b128 v13, v[80:83]
    v_add_u32 v14, s29, v0
    s_add_u32 s29, s29, s30
    v_perm_b32 v84, v21, v17, s45
    v_perm_b32 v85, v29, v25, s45
    v_perm_b32 v86, v37, v33, s45
    v_perm_b32 v87, v45, v41, s45
    ds_write_b128 v14, v[84:87]
    v_add_u32 v13, s29, v0
    s_add_u32 s29, s29, s30
    v_perm_b32 v80, v22, v18, s45
    v_perm_b32 v81, v30, v26, s45
    v_perm_b32 v82, v38, v34, s45
    v_perm_b32 v83, v46, v42, s45
    ds_write_b128 v13, v[80:83]
    v_add_u32 v14, s29, v0
    s_add_u32 s29, s29, s30
    v_perm_b32 v84, v23, v19, s45
    v_perm_b32 v85, v31, v27, s45
    v_perm_b32 v86, v39, v35, s45
    v_perm_b32 v87, v47, v43, s45
    ds_write_b128 v14, v[84:87]
    s_cmp_lt_u32 s21, 2
    s_cselect_b32 s26, s48, s48
    s_cselect_b32 s27, 4, 4
    s_cselect_b64 s[88:89], s[72:73], s[76:77]
    s_add_u32 s26, s26, s27
    s_lshl_b32 s27, s26, 18
    s_add_u32 s27, s27, s46
    buffer_load_dwordx4 v[16:19], v12, s[88:91], s27 offen
    s_add_u32 s27, s27, 8192
    buffer_load_dwordx4 v[20:23], v12, s[88:91], s27 offen
    s_add_u32 s27, s27, 8192
    buffer_load_dwordx4 v[24:27], v12, s[88:91], s27 offen
    s_add_u32 s27, s27, 8192
    buffer_load_dwordx4 v[28:31], v12, s[88:91], s27 offen
    s_add_u32 s27, s27, 8192
    buffer_load_dwordx4 v[32:35], v12, s[88:91], s27 offen
    s_add_u32 s27, s27, 8192
    buffer_load_dwordx4 v[36:39], v12, s[88:91], s27 offen
    s_add_u32 s27, s27, 8192
    buffer_load_dwordx4 v[40:43], v12, s[88:91], s27 offen
    s_add_u32 s27, s27, 8192
    buffer_load_dwordx4 v[44:47], v12, s[88:91], s27 offen
    s_waitcnt lgkmcnt(0)
    s_barrier
    ds_read_b128 a[232:235], v6 offset:2048
    ds_read_b128 a[236:239], v6 offset:3072
    s_waitcnt lgkmcnt(0)
    s_barrier
    s_and_b32 s28, s21, 1
    s_lshl_b32 s28, s28, 10
    s_mov_b32 s29, 32768
    s_mov_b32 s30, 34816
    s_cmp_lt_u32 s21, 2
    s_cselect_b32 s29, 0, s29
    s_cselect_b32 s30, 4096, s30
    s_add_u32 s29, s29, s28
    v_add_u32 v13, s29, v0
    s_add_u32 s29, s29, s30
    s_waitcnt vmcnt(14)
    v_perm_b32 v80, v52, v48, s44
    s_waitcnt vmcnt(12)
    v_perm_b32 v81, v60, v56, s44
    s_waitcnt vmcnt(10)
    v_perm_b32 v82, v68, v64, s44
    s_waitcnt vmcnt(8)
    v_perm_b32 v83, v76, v72, s44
    ds_write_b128 v13, v[80:83]
    v_add_u32 v14, s29, v0
    s_add_u32 s29, s29, s30
    v_perm_b32 v84, v53, v49, s44
    v_perm_b32 v85, v61, v57, s44
    v_perm_b32 v86, v69, v65, s44
    v_perm_b32 v87, v77, v73, s44
    ds_write_b128 v14, v[84:87]
    v_add_u32 v13, s29, v0
    s_add_u32 s29, s29, s30
    v_perm_b32 v80, v54, v50, s44
    v_perm_b32 v81, v62, v58, s44
    v_perm_b32 v82, v70, v66, s44
    v_perm_b32 v83, v78, v74, s44
    ds_write_b128 v13, v[80:83]
    v_add_u32 v14, s29, v0
    s_add_u32 s29, s29, s30
    v_perm_b32 v84, v55, v51, s44
    v_perm_b32 v85, v63, v59, s44
    v_perm_b32 v86, v71, v67, s44
    v_perm_b32 v87, v79, v75, s44
    ds_write_b128 v14, v[84:87]
    s_mov_b32 s29, 2048
    s_mov_b32 s30, 4096
    s_cmp_lt_u32 s21, 2
    s_cselect_b32 s29, 30720, s29
    s_cselect_b32 s30, 34816, s30
    s_add_u32 s29, s29, s28
    v_add_u32 v13, s29, v0
    s_add_u32 s29, s29, s30
    v_perm_b32 v80, v52, v48, s45
    v_perm_b32 v81, v60, v56, s45
    v_perm_b32 v82, v68, v64, s45
    v_perm_b32 v83, v76, v72, s45
    ds_write_b128 v13, v[80:83]
    v_add_u32 v14, s29, v0
    s_add_u32 s29, s29, s30
    v_perm_b32 v84, v53, v49, s45
    v_perm_b32 v85, v61, v57, s45
    v_perm_b32 v86, v69, v65, s45
    v_perm_b32 v87, v77, v73, s45
    ds_write_b128 v14, v[84:87]
    v_add_u32 v13, s29, v0
    s_add_u32 s29, s29, s30
    v_perm_b32 v80, v54, v50, s45
    v_perm_b32 v81, v62, v58, s45
    v_perm_b32 v82, v70, v66, s45
    v_perm_b32 v83, v78, v74, s45
    ds_write_b128 v13, v[80:83]
    v_add_u32 v14, s29, v0
    s_add_u32 s29, s29, s30
    v_perm_b32 v84, v55, v51, s45
    v_perm_b32 v85, v63, v59, s45
    v_perm_b32 v86, v71, v67, s45
    v_perm_b32 v87, v79, v75, s45
    ds_write_b128 v14, v[84:87]
    s_cmp_lt_u32 s21, 2
    s_cselect_b32 s26, s48, s48
    s_cselect_b32 s27, 6, 8
    s_cselect_b64 s[88:89], s[72:73], s[72:73]
    s_add_u32 s26, s26, s27
    s_lshl_b32 s27, s26, 18
    s_add_u32 s27, s27, s46
    buffer_load_dwordx4 v[48:51], v12, s[88:91], s27 offen
    s_add_u32 s27, s27, 8192
    buffer_load_dwordx4 v[52:55], v12, s[88:91], s27 offen
    s_add_u32 s27, s27, 8192
    buffer_load_dwordx4 v[56:59], v12, s[88:91], s27 offen
    s_add_u32 s27, s27, 8192
    buffer_load_dwordx4 v[60:63], v12, s[88:91], s27 offen
    s_add_u32 s27, s27, 8192
    buffer_load_dwordx4 v[64:67], v12, s[88:91], s27 offen
    s_add_u32 s27, s27, 8192
    buffer_load_dwordx4 v[68:71], v12, s[88:91], s27 offen
    s_add_u32 s27, s27, 8192
    buffer_load_dwordx4 v[72:75], v12, s[88:91], s27 offen
    s_add_u32 s27, s27, 8192
    buffer_load_dwordx4 v[76:79], v12, s[88:91], s27 offen
    s_waitcnt lgkmcnt(0)
    s_barrier
    ds_read_b128 a[224:227], v6 offset:0
    ds_read_b128 a[228:231], v6 offset:1024
    ds_read_b128 a[200:203], v6 offset:2048
    ds_read_b128 a[204:207], v6 offset:3072
    s_waitcnt lgkmcnt(0)
    s_barrier
    s_and_b32 s28, s21, 1
    s_lshl_b32 s28, s28, 10
    s_mov_b32 s29, 2048
    s_mov_b32 s30, 4096
    s_cmp_lt_u32 s21, 2
    s_cselect_b32 s29, 34816, s29
    s_cselect_b32 s30, 34816, s30
    s_add_u32 s29, s29, s28
    v_add_u32 v13, s29, v0
    s_add_u32 s29, s29, s30
    s_waitcnt vmcnt(14)
    v_perm_b32 v80, v20, v16, s44
    s_waitcnt vmcnt(12)
    v_perm_b32 v81, v28, v24, s44
    s_waitcnt vmcnt(10)
    v_perm_b32 v82, v36, v32, s44
    s_waitcnt vmcnt(8)
    v_perm_b32 v83, v44, v40, s44
    ds_write_b128 v13, v[80:83]
    v_add_u32 v14, s29, v0
    s_add_u32 s29, s29, s30
    v_perm_b32 v84, v21, v17, s44
    v_perm_b32 v85, v29, v25, s44
    v_perm_b32 v86, v37, v33, s44
    v_perm_b32 v87, v45, v41, s44
    ds_write_b128 v14, v[84:87]
    v_add_u32 v13, s29, v0
    s_add_u32 s29, s29, s30
    v_perm_b32 v80, v22, v18, s44
    v_perm_b32 v81, v30, v26, s44
    v_perm_b32 v82, v38, v34, s44
    v_perm_b32 v83, v46, v42, s44
    ds_write_b128 v13, v[80:83]
    v_add_u32 v14, s29, v0
    s_add_u32 s29, s29, s30
    v_perm_b32 v84, v23, v19, s44
    v_perm_b32 v85, v31, v27, s44
    v_perm_b32 v86, v39, v35, s44
    v_perm_b32 v87, v47, v43, s44
    ds_write_b128 v14, v[84:87]
    s_mov_b32 s29, 36864
    s_mov_b32 s30, 34816
    s_cmp_lt_u32 s21, 2
    s_cselect_b32 s29, 0, s29
    s_cselect_b32 s30, 4096, s30
    s_add_u32 s29, s29, s28
    v_add_u32 v13, s29, v0
    s_add_u32 s29, s29, s30
    v_perm_b32 v80, v20, v16, s45
    v_perm_b32 v81, v28, v24, s45
    v_perm_b32 v82, v36, v32, s45
    v_perm_b32 v83, v44, v40, s45
    ds_write_b128 v13, v[80:83]
    v_add_u32 v14, s29, v0
    s_add_u32 s29, s29, s30
    v_perm_b32 v84, v21, v17, s45
    v_perm_b32 v85, v29, v25, s45
    v_perm_b32 v86, v37, v33, s45
    v_perm_b32 v87, v45, v41, s45
    ds_write_b128 v14, v[84:87]
    v_add_u32 v13, s29, v0
    s_add_u32 s29, s29, s30
    v_perm_b32 v80, v22, v18, s45
    v_perm_b32 v81, v30, v26, s45
    v_perm_b32 v82, v38, v34, s45
    v_perm_b32 v83, v46, v42, s45
    ds_write_b128 v13, v[80:83]
    v_add_u32 v14, s29, v0
    s_add_u32 s29, s29, s30
    v_perm_b32 v84, v23, v19, s45
    v_perm_b32 v85, v31, v27, s45
    v_perm_b32 v86, v39, v35, s45
    v_perm_b32 v87, v47, v43, s45
    ds_write_b128 v14, v[84:87]
    s_cmp_lt_u32 s21, 2
    s_cselect_b32 s26, s48, s49
    s_cselect_b32 s27, 8, 0
    s_cselect_b64 s[88:89], s[76:77], s[72:73]
    s_add_u32 s26, s26, s27
    s_lshl_b32 s27, s26, 18
    s_add_u32 s27, s27, s46
    buffer_load_dwordx4 v[16:19], v12, s[88:91], s27 offen
    s_add_u32 s27, s27, 8192
    buffer_load_dwordx4 v[20:23], v12, s[88:91], s27 offen
    s_add_u32 s27, s27, 8192
    buffer_load_dwordx4 v[24:27], v12, s[88:91], s27 offen
    s_add_u32 s27, s27, 8192
    buffer_load_dwordx4 v[28:31], v12, s[88:91], s27 offen
    s_add_u32 s27, s27, 8192
    buffer_load_dwordx4 v[32:35], v12, s[88:91], s27 offen
    s_add_u32 s27, s27, 8192
    buffer_load_dwordx4 v[36:39], v12, s[88:91], s27 offen
    s_add_u32 s27, s27, 8192
    buffer_load_dwordx4 v[40:43], v12, s[88:91], s27 offen
    s_add_u32 s27, s27, 8192
    buffer_load_dwordx4 v[44:47], v12, s[88:91], s27 offen
    s_waitcnt lgkmcnt(0)
    s_barrier
    ds_read_b128 a[192:195], v6 offset:0
    ds_read_b128 a[196:199], v6 offset:1024
    ds_read_b128 a[184:187], v6 offset:2048
    ds_read_b128 a[188:191], v6 offset:3072
    s_waitcnt lgkmcnt(0)
    s_barrier
    s_and_b32 s28, s21, 1
    s_lshl_b32 s28, s28, 10
    s_mov_b32 s29, 40960
    s_mov_b32 s30, 34816
    s_cmp_lt_u32 s21, 2
    s_cselect_b32 s29, 0, s29
    s_cselect_b32 s30, 4096, s30
    s_add_u32 s29, s29, s28
    v_add_u32 v13, s29, v0
    s_add_u32 s29, s29, s30
    s_waitcnt vmcnt(14)
    v_perm_b32 v80, v52, v48, s44
    s_waitcnt vmcnt(12)
    v_perm_b32 v81, v60, v56, s44
    s_waitcnt vmcnt(10)
    v_perm_b32 v82, v68, v64, s44
    s_waitcnt vmcnt(8)
    v_perm_b32 v83, v76, v72, s44
    ds_write_b128 v13, v[80:83]
    v_add_u32 v14, s29, v0
    s_add_u32 s29, s29, s30
    v_perm_b32 v84, v53, v49, s44
    v_perm_b32 v85, v61, v57, s44
    v_perm_b32 v86, v69, v65, s44
    v_perm_b32 v87, v77, v73, s44
    ds_write_b128 v14, v[84:87]
    v_add_u32 v13, s29, v0
    s_add_u32 s29, s29, s30
    v_perm_b32 v80, v54, v50, s44
    v_perm_b32 v81, v62, v58, s44
    v_perm_b32 v82, v70, v66, s44
    v_perm_b32 v83, v78, v74, s44
    ds_write_b128 v13, v[80:83]
    v_add_u32 v14, s29, v0
    s_add_u32 s29, s29, s30
    v_perm_b32 v84, v55, v51, s44
    v_perm_b32 v85, v63, v59, s44
    v_perm_b32 v86, v71, v67, s44
    v_perm_b32 v87, v79, v75, s44
    ds_write_b128 v14, v[84:87]
    s_mov_b32 s29, 2048
    s_mov_b32 s30, 4096
    s_cmp_lt_u32 s21, 2
    s_cselect_b32 s29, 38912, s29
    s_cselect_b32 s30, 34816, s30
    s_add_u32 s29, s29, s28
    v_add_u32 v13, s29, v0
    s_add_u32 s29, s29, s30
    v_perm_b32 v80, v52, v48, s45
    v_perm_b32 v81, v60, v56, s45
    v_perm_b32 v82, v68, v64, s45
    v_perm_b32 v83, v76, v72, s45
    ds_write_b128 v13, v[80:83]
    v_add_u32 v14, s29, v0
    s_add_u32 s29, s29, s30
    v_perm_b32 v84, v53, v49, s45
    v_perm_b32 v85, v61, v57, s45
    v_perm_b32 v86, v69, v65, s45
    v_perm_b32 v87, v77, v73, s45
    ds_write_b128 v14, v[84:87]
    v_add_u32 v13, s29, v0
    s_add_u32 s29, s29, s30
    v_perm_b32 v80, v54, v50, s45
    v_perm_b32 v81, v62, v58, s45
    v_perm_b32 v82, v70, v66, s45
    v_perm_b32 v83, v78, v74, s45
    ds_write_b128 v13, v[80:83]
    v_add_u32 v14, s29, v0
    s_add_u32 s29, s29, s30
    v_perm_b32 v84, v55, v51, s45
    v_perm_b32 v85, v63, v59, s45
    v_perm_b32 v86, v71, v67, s45
    v_perm_b32 v87, v79, v75, s45
    ds_write_b128 v14, v[84:87]
    s_cmp_lt_u32 s21, 2
    s_cselect_b32 s26, s49, s49
    s_cselect_b32 s27, 2, 6
    s_cselect_b64 s[88:89], s[72:73], s[72:73]
    s_add_u32 s26, s26, s27
    s_lshl_b32 s27, s26, 18
    s_add_u32 s27, s27, s46
    buffer_load_dwordx4 v[48:51], v12, s[88:91], s27 offen
    s_add_u32 s27, s27, 8192
    buffer_load_dwordx4 v[52:55], v12, s[88:91], s27 offen
    s_add_u32 s27, s27, 8192
    buffer_load_dwordx4 v[56:59], v12, s[88:91], s27 offen
    s_add_u32 s27, s27, 8192
    buffer_load_dwordx4 v[60:63], v12, s[88:91], s27 offen
    s_add_u32 s27, s27, 8192
    buffer_load_dwordx4 v[64:67], v12, s[88:91], s27 offen
    s_add_u32 s27, s27, 8192
    buffer_load_dwordx4 v[68:71], v12, s[88:91], s27 offen
    s_add_u32 s27, s27, 8192
    buffer_load_dwordx4 v[72:75], v12, s[88:91], s27 offen
    s_add_u32 s27, s27, 8192
    buffer_load_dwordx4 v[76:79], v12, s[88:91], s27 offen
    s_waitcnt lgkmcnt(0)
    s_barrier
    ds_read_b128 a[176:179], v6 offset:0
    ds_read_b128 a[180:183], v6 offset:1024
    ds_read_b128 a[152:155], v6 offset:2048
    ds_read_b128 a[156:159], v6 offset:3072
    s_waitcnt lgkmcnt(0)
    s_barrier
    s_and_b32 s28, s21, 1
    s_lshl_b32 s28, s28, 10
    s_mov_b32 s29, 2048
    s_mov_b32 s30, 4096
    s_cmp_lt_u32 s21, 2
    s_cselect_b32 s29, 43008, s29
    s_cselect_b32 s30, 34816, s30
    s_add_u32 s29, s29, s28
    v_add_u32 v13, s29, v0
    s_add_u32 s29, s29, s30
    s_waitcnt vmcnt(14)
    v_perm_b32 v80, v20, v16, s44
    s_waitcnt vmcnt(12)
    v_perm_b32 v81, v28, v24, s44
    s_waitcnt vmcnt(10)
    v_perm_b32 v82, v36, v32, s44
    s_waitcnt vmcnt(8)
    v_perm_b32 v83, v44, v40, s44
    ds_write_b128 v13, v[80:83]
    v_add_u32 v14, s29, v0
    s_add_u32 s29, s29, s30
    v_perm_b32 v84, v21, v17, s44
    v_perm_b32 v85, v29, v25, s44
    v_perm_b32 v86, v37, v33, s44
    v_perm_b32 v87, v45, v41, s44
    ds_write_b128 v14, v[84:87]
    v_add_u32 v13, s29, v0
    s_add_u32 s29, s29, s30
    v_perm_b32 v80, v22, v18, s44
    v_perm_b32 v81, v30, v26, s44
    v_perm_b32 v82, v38, v34, s44
    v_perm_b32 v83, v46, v42, s44
    ds_write_b128 v13, v[80:83]
    v_add_u32 v14, s29, v0
    s_add_u32 s29, s29, s30
    v_perm_b32 v84, v23, v19, s44
    v_perm_b32 v85, v31, v27, s44
    v_perm_b32 v86, v39, v35, s44
    v_perm_b32 v87, v47, v43, s44
    ds_write_b128 v14, v[84:87]
    s_mov_b32 s29, 45056
    s_mov_b32 s30, 34816
    s_cmp_lt_u32 s21, 2
    s_cselect_b32 s29, 0, s29
    s_cselect_b32 s30, 4096, s30
    s_add_u32 s29, s29, s28
    v_add_u32 v13, s29, v0
    s_add_u32 s29, s29, s30
    v_perm_b32 v80, v20, v16, s45
    v_perm_b32 v81, v28, v24, s45
    v_perm_b32 v82, v36, v32, s45
    v_perm_b32 v83, v44, v40, s45
    ds_write_b128 v13, v[80:83]
    v_add_u32 v14, s29, v0
    s_add_u32 s29, s29, s30
    v_perm_b32 v84, v21, v17, s45
    v_perm_b32 v85, v29, v25, s45
    v_perm_b32 v86, v37, v33, s45
    v_perm_b32 v87, v45, v41, s45
    ds_write_b128 v14, v[84:87]
    v_add_u32 v13, s29, v0
    s_add_u32 s29, s29, s30
    v_perm_b32 v80, v22, v18, s45
    v_perm_b32 v81, v30, v26, s45
    v_perm_b32 v82, v38, v34, s45
    v_perm_b32 v83, v46, v42, s45
    ds_write_b128 v13, v[80:83]
    v_add_u32 v14, s29, v0
    s_add_u32 s29, s29, s30
    v_perm_b32 v84, v23, v19, s45
    v_perm_b32 v85, v31, v27, s45
    v_perm_b32 v86, v39, v35, s45
    v_perm_b32 v87, v47, v43, s45
    ds_write_b128 v14, v[84:87]
    s_cmp_lt_u32 s21, 2
    s_cselect_b32 s26, s49, s49
    s_cselect_b32 s27, 8, 0
    s_cselect_b64 s[88:89], s[72:73], s[76:77]
    s_add_u32 s26, s26, s27
    s_lshl_b32 s27, s26, 18
    s_add_u32 s27, s27, s46
    buffer_load_dwordx4 v[16:19], v12, s[88:91], s27 offen
    s_add_u32 s27, s27, 8192
    buffer_load_dwordx4 v[20:23], v12, s[88:91], s27 offen
    s_add_u32 s27, s27, 8192
    buffer_load_dwordx4 v[24:27], v12, s[88:91], s27 offen
    s_add_u32 s27, s27, 8192
    buffer_load_dwordx4 v[28:31], v12, s[88:91], s27 offen
    s_add_u32 s27, s27, 8192
    buffer_load_dwordx4 v[32:35], v12, s[88:91], s27 offen
    s_add_u32 s27, s27, 8192
    buffer_load_dwordx4 v[36:39], v12, s[88:91], s27 offen
    s_add_u32 s27, s27, 8192
    buffer_load_dwordx4 v[40:43], v12, s[88:91], s27 offen
    s_add_u32 s27, s27, 8192
    buffer_load_dwordx4 v[44:47], v12, s[88:91], s27 offen
    s_waitcnt lgkmcnt(0)
    s_barrier
    ds_read_b128 a[144:147], v6 offset:0
    ds_read_b128 a[148:151], v6 offset:1024
    ds_read_b128 a[136:139], v6 offset:2048
    ds_read_b128 a[140:143], v6 offset:3072
    s_waitcnt lgkmcnt(0)
    s_barrier
    s_and_b32 s28, s21, 1
    s_lshl_b32 s28, s28, 10
    s_mov_b32 s29, 49152
    s_mov_b32 s30, 34816
    s_cmp_lt_u32 s21, 2
    s_cselect_b32 s29, 0, s29
    s_cselect_b32 s30, 4096, s30
    s_add_u32 s29, s29, s28
    v_add_u32 v13, s29, v0
    s_add_u32 s29, s29, s30
    s_waitcnt vmcnt(14)
    v_perm_b32 v80, v52, v48, s44
    s_waitcnt vmcnt(12)
    v_perm_b32 v81, v60, v56, s44
    s_waitcnt vmcnt(10)
    v_perm_b32 v82, v68, v64, s44
    s_waitcnt vmcnt(8)
    v_perm_b32 v83, v76, v72, s44
    ds_write_b128 v13, v[80:83]
    v_add_u32 v14, s29, v0
    s_add_u32 s29, s29, s30
    v_perm_b32 v84, v53, v49, s44
    v_perm_b32 v85, v61, v57, s44
    v_perm_b32 v86, v69, v65, s44
    v_perm_b32 v87, v77, v73, s44
    ds_write_b128 v14, v[84:87]
    v_add_u32 v13, s29, v0
    s_add_u32 s29, s29, s30
    v_perm_b32 v80, v54, v50, s44
    v_perm_b32 v81, v62, v58, s44
    v_perm_b32 v82, v70, v66, s44
    v_perm_b32 v83, v78, v74, s44
    ds_write_b128 v13, v[80:83]
    v_add_u32 v14, s29, v0
    s_add_u32 s29, s29, s30
    v_perm_b32 v84, v55, v51, s44
    v_perm_b32 v85, v63, v59, s44
    v_perm_b32 v86, v71, v67, s44
    v_perm_b32 v87, v79, v75, s44
    ds_write_b128 v14, v[84:87]
    s_mov_b32 s29, 2048
    s_mov_b32 s30, 4096
    s_cmp_lt_u32 s21, 2
    s_cselect_b32 s29, 47104, s29
    s_cselect_b32 s30, 34816, s30
    s_add_u32 s29, s29, s28
    v_add_u32 v13, s29, v0
    s_add_u32 s29, s29, s30
    v_perm_b32 v80, v52, v48, s45
    v_perm_b32 v81, v60, v56, s45
    v_perm_b32 v82, v68, v64, s45
    v_perm_b32 v83, v76, v72, s45
    ds_write_b128 v13, v[80:83]
    v_add_u32 v14, s29, v0
    s_add_u32 s29, s29, s30
    v_perm_b32 v84, v53, v49, s45
    v_perm_b32 v85, v61, v57, s45
    v_perm_b32 v86, v69, v65, s45
    v_perm_b32 v87, v77, v73, s45
    ds_write_b128 v14, v[84:87]
    v_add_u32 v13, s29, v0
    s_add_u32 s29, s29, s30
    v_perm_b32 v80, v54, v50, s45
    v_perm_b32 v81, v62, v58, s45
    v_perm_b32 v82, v70, v66, s45
    v_perm_b32 v83, v78, v74, s45
    ds_write_b128 v13, v[80:83]
    v_add_u32 v14, s29, v0
    s_add_u32 s29, s29, s30
    v_perm_b32 v84, v55, v51, s45
    v_perm_b32 v85, v63, v59, s45
    v_perm_b32 v86, v71, v67, s45
    v_perm_b32 v87, v79, v75, s45
    ds_write_b128 v14, v[84:87]
    s_cmp_lt_u32 s21, 2
    s_cselect_b32 s26, s49, s49
    s_cselect_b32 s27, 2, 6
    s_cselect_b64 s[88:89], s[76:77], s[76:77]
    s_add_u32 s26, s26, s27
    s_lshl_b32 s27, s26, 18
    s_add_u32 s27, s27, s46
    buffer_load_dwordx4 v[48:51], v12, s[88:91], s27 offen
    s_add_u32 s27, s27, 8192
    buffer_load_dwordx4 v[52:55], v12, s[88:91], s27 offen
    s_add_u32 s27, s27, 8192
    buffer_load_dwordx4 v[56:59], v12, s[88:91], s27 offen
    s_add_u32 s27, s27, 8192
    buffer_load_dwordx4 v[60:63], v12, s[88:91], s27 offen
    s_add_u32 s27, s27, 8192
    buffer_load_dwordx4 v[64:67], v12, s[88:91], s27 offen
    s_add_u32 s27, s27, 8192
    buffer_load_dwordx4 v[68:71], v12, s[88:91], s27 offen
    s_add_u32 s27, s27, 8192
    buffer_load_dwordx4 v[72:75], v12, s[88:91], s27 offen
    s_add_u32 s27, s27, 8192
    buffer_load_dwordx4 v[76:79], v12, s[88:91], s27 offen
    s_waitcnt lgkmcnt(0)
    s_barrier
    ds_read_b128 a[128:131], v6 offset:0
    ds_read_b128 a[132:135], v6 offset:1024
    ds_read_b128 a[104:107], v6 offset:2048
    ds_read_b128 a[108:111], v6 offset:3072
    s_waitcnt lgkmcnt(0)
    s_barrier
    s_and_b32 s28, s21, 1
    s_lshl_b32 s28, s28, 10
    s_mov_b32 s29, 2048
    s_mov_b32 s30, 4096
    s_cmp_lt_u32 s21, 2
    s_cselect_b32 s29, 51200, s29
    s_cselect_b32 s30, 34816, s30
    s_add_u32 s29, s29, s28
    v_add_u32 v13, s29, v0
    s_add_u32 s29, s29, s30
    s_waitcnt vmcnt(14)
    v_perm_b32 v80, v20, v16, s44
    s_waitcnt vmcnt(12)
    v_perm_b32 v81, v28, v24, s44
    s_waitcnt vmcnt(10)
    v_perm_b32 v82, v36, v32, s44
    s_waitcnt vmcnt(8)
    v_perm_b32 v83, v44, v40, s44
    ds_write_b128 v13, v[80:83]
    v_add_u32 v14, s29, v0
    s_add_u32 s29, s29, s30
    v_perm_b32 v84, v21, v17, s44
    v_perm_b32 v85, v29, v25, s44
    v_perm_b32 v86, v37, v33, s44
    v_perm_b32 v87, v45, v41, s44
    ds_write_b128 v14, v[84:87]
    v_add_u32 v13, s29, v0
    s_add_u32 s29, s29, s30
    v_perm_b32 v80, v22, v18, s44
    v_perm_b32 v81, v30, v26, s44
    v_perm_b32 v82, v38, v34, s44
    v_perm_b32 v83, v46, v42, s44
    ds_write_b128 v13, v[80:83]
    v_add_u32 v14, s29, v0
    s_add_u32 s29, s29, s30
    v_perm_b32 v84, v23, v19, s44
    v_perm_b32 v85, v31, v27, s44
    v_perm_b32 v86, v39, v35, s44
    v_perm_b32 v87, v47, v43, s44
    ds_write_b128 v14, v[84:87]
    s_mov_b32 s29, 53248
    s_mov_b32 s30, 34816
    s_cmp_lt_u32 s21, 2
    s_cselect_b32 s29, 0, s29
    s_cselect_b32 s30, 4096, s30
    s_add_u32 s29, s29, s28
    v_add_u32 v13, s29, v0
    s_add_u32 s29, s29, s30
    v_perm_b32 v80, v20, v16, s45
    v_perm_b32 v81, v28, v24, s45
    v_perm_b32 v82, v36, v32, s45
    v_perm_b32 v83, v44, v40, s45
    ds_write_b128 v13, v[80:83]
    v_add_u32 v14, s29, v0
    s_add_u32 s29, s29, s30
    v_perm_b32 v84, v21, v17, s45
    v_perm_b32 v85, v29, v25, s45
    v_perm_b32 v86, v37, v33, s45
    v_perm_b32 v87, v45, v41, s45
    ds_write_b128 v14, v[84:87]
    v_add_u32 v13, s29, v0
    s_add_u32 s29, s29, s30
    v_perm_b32 v80, v22, v18, s45
    v_perm_b32 v81, v30, v26, s45
    v_perm_b32 v82, v38, v34, s45
    v_perm_b32 v83, v46, v42, s45
    ds_write_b128 v13, v[80:83]
    v_add_u32 v14, s29, v0
    s_add_u32 s29, s29, s30
    v_perm_b32 v84, v23, v19, s45
    v_perm_b32 v85, v31, v27, s45
    v_perm_b32 v86, v39, v35, s45
    v_perm_b32 v87, v47, v43, s45
    ds_write_b128 v14, v[84:87]
    s_waitcnt lgkmcnt(0)
    s_barrier
    ds_read_b128 a[96:99], v6 offset:0
    ds_read_b128 a[100:103], v6 offset:1024
    ds_read_b128 a[88:91], v6 offset:2048
    ds_read_b128 a[92:95], v6 offset:3072
    s_waitcnt lgkmcnt(0)
    s_barrier
    s_and_b32 s28, s21, 1
    s_lshl_b32 s28, s28, 10
    s_mov_b32 s29, 57344
    s_mov_b32 s30, 34816
    s_cmp_lt_u32 s21, 2
    s_cselect_b32 s29, 0, s29
    s_cselect_b32 s30, 4096, s30
    s_add_u32 s29, s29, s28
    v_add_u32 v13, s29, v0
    s_add_u32 s29, s29, s30
    s_waitcnt vmcnt(6)
    v_perm_b32 v80, v52, v48, s44
    s_waitcnt vmcnt(4)
    v_perm_b32 v81, v60, v56, s44
    s_waitcnt vmcnt(2)
    v_perm_b32 v82, v68, v64, s44
    s_waitcnt vmcnt(0)
    v_perm_b32 v83, v76, v72, s44
    ds_write_b128 v13, v[80:83]
    v_add_u32 v14, s29, v0
    s_add_u32 s29, s29, s30
    v_perm_b32 v84, v53, v49, s44
    v_perm_b32 v85, v61, v57, s44
    v_perm_b32 v86, v69, v65, s44
    v_perm_b32 v87, v77, v73, s44
    ds_write_b128 v14, v[84:87]
    v_add_u32 v13, s29, v0
    s_add_u32 s29, s29, s30
    v_perm_b32 v80, v54, v50, s44
    v_perm_b32 v81, v62, v58, s44
    v_perm_b32 v82, v70, v66, s44
    v_perm_b32 v83, v78, v74, s44
    ds_write_b128 v13, v[80:83]
    v_add_u32 v14, s29, v0
    s_add_u32 s29, s29, s30
    v_perm_b32 v84, v55, v51, s44
    v_perm_b32 v85, v63, v59, s44
    v_perm_b32 v86, v71, v67, s44
    v_perm_b32 v87, v79, v75, s44
    ds_write_b128 v14, v[84:87]
    s_mov_b32 s29, 2048
    s_mov_b32 s30, 4096
    s_cmp_lt_u32 s21, 2
    s_cselect_b32 s29, 55296, s29
    s_cselect_b32 s30, 34816, s30
    s_add_u32 s29, s29, s28
    v_add_u32 v13, s29, v0
    s_add_u32 s29, s29, s30
    v_perm_b32 v80, v52, v48, s45
    v_perm_b32 v81, v60, v56, s45
    v_perm_b32 v82, v68, v64, s45
    v_perm_b32 v83, v76, v72, s45
    ds_write_b128 v13, v[80:83]
    v_add_u32 v14, s29, v0
    s_add_u32 s29, s29, s30
    v_perm_b32 v84, v53, v49, s45
    v_perm_b32 v85, v61, v57, s45
    v_perm_b32 v86, v69, v65, s45
    v_perm_b32 v87, v77, v73, s45
    ds_write_b128 v14, v[84:87]
    v_add_u32 v13, s29, v0
    s_add_u32 s29, s29, s30
    v_perm_b32 v80, v54, v50, s45
    v_perm_b32 v81, v62, v58, s45
    v_perm_b32 v82, v70, v66, s45
    v_perm_b32 v83, v78, v74, s45
    ds_write_b128 v13, v[80:83]
    v_add_u32 v14, s29, v0
    s_add_u32 s29, s29, s30
    v_perm_b32 v84, v55, v51, s45
    v_perm_b32 v85, v63, v59, s45
    v_perm_b32 v86, v71, v67, s45
    v_perm_b32 v87, v79, v75, s45
    ds_write_b128 v14, v[84:87]
    s_waitcnt lgkmcnt(0)
    s_barrier
    ds_read_b128 a[80:83], v6 offset:0
    ds_read_b128 a[84:87], v6 offset:1024
    ds_read_b128 a[56:59], v6 offset:2048
    ds_read_b128 a[60:63], v6 offset:3072
    s_waitcnt lgkmcnt(0)
M_lw_done:
    s_cmp_lg_u32 s32, 0
    s_cbranch_scc1 M_role_ok
    s_mov_b32 s32, 1
    s_mov_b32 s30, 0
    v_bfe_u32 v12, v0, 4, 4
    v_lshlrev_b32 v12, 2, v12
M_modepoll:
    buffer_load_dword v13, v12, s[12:15], 0 offen sc1
    s_waitcnt vmcnt(0)
    v_readlane_b32 s31, v13, 8
    s_cmp_eq_u32 s31, 256
    s_cbranch_scc1 M_modegot
    s_sleep 2
    s_add_u32 s30, s30, 1
    s_cmp_lt_u32 s30, 60000
    s_cbranch_scc1 M_modepoll
    s_branch M_fail
M_modegot:
    s_cmp_eq_u32 s30, 0
    s_cbranch_scc1 M_moderd
    buffer_load_dword v13, v12, s[12:15], 0 offen sc1
    s_waitcnt vmcnt(0)
M_moderd:
    v_readlane_b32 s33, v13, 15
    s_nop 0
    s_and_b32 s33, s33, 3
    s_lshl_b32 s33, s33, 13
    s_xor_b32 s33, s33, 16384
    v_cmp_ne_u32 vcc, 32, v13
    s_and_b32 s31, vcc_lo, 0xff
    s_cmp_lg_u32 s31, 0
    s_cbranch_scc1 M_slowm
    s_cmp_ge_u32 s20, 3
    s_cbranch_scc1 M_loadw
    s_branch M_role_ok
M_slowm:
    s_mov_b32 s23, 1
    s_mov_b32 s31, s25
    v_readlane_b32 s30, v13, 0
    s_cmp_gt_u32 s24, 0
    s_cselect_b32 s30, s30, 0
    s_add_u32 s31, s31, s30
    v_readlane_b32 s30, v13, 1
    s_cmp_gt_u32 s24, 1
    s_cselect_b32 s30, s30, 0
    s_add_u32 s31, s31, s30
    v_readlane_b32 s30, v13, 2
    s_cmp_gt_u32 s24, 2
    s_cselect_b32 s30, s30, 0
    s_add_u32 s31, s31, s30
    v_readlane_b32 s30, v13, 3
    s_cmp_gt_u32 s24, 3
    s_cselect_b32 s30, s30, 0
    s_add_u32 s31, s31, s30
    v_readlane_b32 s30, v13, 4
    s_cmp_gt_u32 s24, 4
    s_cselect_b32 s30, s30, 0
    s_add_u32 s31, s31, s30
    v_readlane_b32 s30, v13, 5
    s_cmp_gt_u32 s24, 5
    s_cselect_b32 s30, s30, 0
    s_add_u32 s31, s31, s30
    v_readlane_b32 s30, v13, 6
    s_cmp_gt_u32 s24, 6
    s_cselect_b32 s30, s30, 0
    s_add_u32 s31, s31, s30
    s_lshr_b32 s20, s31, 5
    s_and_b32 s22, s31, 31
    s_and_b32 s20, s20, 7
    s_and_b32 s22, s22, 31
    s_branch M_loadw
M_role_ok:
    s_mov_b32 s25, s33
    s_cmp_ge_u32 s20, 2
    s_cbranch_scc1 M_bulk
    v_lshrrev_b32 v36, 8, v0
    v_bfe_u32 v37, v0, 4, 4
    v_bfe_u32 v38, v0, 4, 3
    v_bfe_u32 v39, v0, 7, 1
    s_mov_b32 s36, 0x00ff00ff
    s_mov_b32 s37, 0x00ff00ff
    s_not_b64 s[18:19], s[36:37]
    v_mov_b32 v1, 0x4444
    v_mov_b32 v40, 0xeeee
    v_cndmask_b32_e64 v1, v1, v40, s[18:19]
    v_and_b32 v40, 1, v36
    v_lshlrev_b32 v40, 2, v40
    v_lshrrev_b32 v41, 1, v36
    v_add_u32 v40, v40, v41
    v_mul_u32_u24 v40, 288, v40
    v_lshl_add_u32 v40, v37, 2, v40
    s_lshl_b32 s27, s21, 6
    v_add_u32 v2, s27, v40
    v_mul_u32_u24 v40, 288, v38
    v_lshl_add_u32 v3, v36, 4, v40
    s_lshr_b32 s27, s21, 1
    s_lshl_b32 s27, s27, 10
    s_and_b32 s28, s21, 1
    s_lshl_b32 s28, s28, 3
    s_add_u32 s27, s27, s28
    s_add_u32 s27, s27, 13312
    v_and_b32 v40, 0x37f, v0
    v_add_u32 v4, s27, v40
    s_mul_i32 s27, s21, 34816
    s_add_u32 s27, s27, 24576
    v_add_u32 v5, s27, v0
    v_and_b32 v6, 0x200, v0
    v_bfe_u32 v40, v0, 6, 1
    v_lshl_or_b32 v6, v40, 8, v6
    v_bfe_u32 v40, v0, 4, 1
    v_lshl_or_b32 v6, v40, 7, v6
    v_bfe_u32 v40, v0, 5, 1
    v_lshl_or_b32 v6, v40, 6, v6
    v_bfe_u32 v40, v0, 8, 1
    v_lshl_or_b32 v6, v40, 5, v6
    v_bfe_u32 v40, v0, 7, 1
    v_lshl_or_b32 v6, v40, 4, v6
    s_lshl_b32 s27, s21, 13
    s_lshl_b32 s28, s22, 5
    s_add_u32 s27, s27, s28
    s_add_u32 s27, s27, 135168
    v_lshrrev_b32 v40, 7, v0
    v_lshlrev_b32 v40, 10, v40
    v_lshl_add_u32 v40, v38, 2, v40
    v_add_u32 v7, s27, v40
    v_lshrrev_b32 v40, 7, v0
    v_mul_u32_u24 v40, 4224, v40
    v_lshl_add_u32 v8, v38, 4, v40
    v_lshlrev_b32 v9, 3, v0
    s_mul_i32 s34, s20, 671744
    s_add_u32 s34, s34, 172228608
    s_lshl_b32 s35, s21, 10
    s_mul_i32 s27, s22, 4224
    s_add_u32 s35, s35, s27
    s_and_b32 s27, s22, 1
    s_bfe_u32 s28, s22, 0x10001
    s_bfe_u32 s29, s22, 0x10002
    s_lshl_b32 s30, s27, 2
    s_lshl_b32 s31, s28, 1
    s_or_b32 s30, s30, s31
    s_or_b32 s30, s30, s29
    s_and_b32 s31, s22, 0x18
    s_or_b32 s30, s30, s31
    s_lshl_b32 s33, s30, 7
    s_lshl_b32 s32, s22, 7
    s_cmp_eq_u32 s21, 0
    s_cbranch_scc1 M_c_r0
    s_lshl_b32 s32, s22, 10
    s_add_u32 s32, s32, 135168
    s_lshl_b32 s33, s27, 4
    s_lshl_b32 s28, s28, 8
    s_or_b32 s33, s33, s28
    s_lshl_b32 s29, s29, 7
    s_or_b32 s33, s33, s29
    s_bfe_u32 s28, s22, 0x10003
    s_lshl_b32 s28, s28, 5
    s_or_b32 s33, s33, s28
    s_bfe_u32 s28, s22, 0x10004
    s_lshl_b32 s28, s28, 9
    s_or_b32 s33, s33, s28
    s_add_u32 s33, s33, 4096
M_c_r0:
    s_mul_i32 s41, s20, 20480
    s_add_u32 s41, s41, 173605504
    s_lshl_b32 s46, s20, 17
    s_add_u32 s46, s46, 171966464
    s_add_u32 s46, s46, s25
    s_xor_b32 s47, s46, 0x20000
    s_mov_b32 s38, 0x00ff00ff
    s_mov_b32 s39, 0
    s_mov_b32 s62, 0x00030003
    s_mov_b32 s63, 0x00030003
    s_mov_b32 s40, 0x3e0293ee
    s_movk_i32 s45, 0x3f80
    s_mov_b32 s68, 0x33800000
    s_mov_b32 s69, 0x18000000
    s_lshl_b32 s51, s22, 7
    s_add_u32 s52, s51, 167862272
    s_lshl_b32 s51, s22, 8
    s_add_u32 s51, s51, 167854080
    s_mov_b32 s24, 0x3f803f80
    s_mov_b32 s25, 0x3f803f80
    s_mov_b32 s16, 0x3f003f00
    s_mov_b32 s17, 0x3f003f00
    s_lshl_b32 s53, s22, 13
    s_add_u32 s53, s53, 218103808
    s_lshl_b32 s27, s20, 12
    s_add_u32 s53, s53, s27
    s_lshl_b32 s27, s20, 2
    s_add_u32 s52, s52, s27
    s_cmp_eq_u32 s20, 0
    s_cselect_b64 s[66:67], -1, 0
    s_mov_b32 s44, 0
    s_mov_b32 s54, 0
    s_mov_b32 s71, 0
    s_mov_b32 s4, 0x10000000
    s_mov_b32 s60, 0x10000000
    s_mov_b32 s64, 0x10000000
    s_mov_b32 s65, 0x10000000
    v_mov_b32 v40, 23296
    v_mov_b64 v[10:11], 0
    ds_write_b64 v40, v[10:11]
    s_waitcnt vmcnt(0) lgkmcnt(0)
    s_barrier
    s_cmp_lg_u32 s23, 0
    s_cbranch_scc1 M_c_slow
    s_cmp_eq_u32 s21, 1
    s_cbranch_scc1 M_c0_1_layer
    s_cmp_eq_u32 s21, 2
    s_cbranch_scc1 M_c0_2_layer
    s_cmp_eq_u32 s21, 3
    s_cbranch_scc1 M_c0_3_layer
M_c0_0_layer:
    s_lshr_b32 s27, s44, 6
    s_mul_i32 s50, s27, 33554432
    s_lshl_b32 s27, s22, 13
    s_add_u32 s50, s50, s27
    s_add_u32 s50, s50, 37748736
    s_barrier
    s_mov_b32 s26, 0x10010000
    s_mov_b32 s3, s26
    s_mul_i32 s27, s20, 5120
    s_add_u32 s48, s27, 167772160
    s_sub_u32 s49, 167777280, s27
    s_and_b32 s55, s44, 3
    s_mul_i32 s55, s55, 167936
    s_add_u32 s55, s55, s34
    s_add_u32 s58, s55, s35
    s_and_b32 s57, s44, 63
    s_add_u32 s43, s55, s32
    s_add_u32 s61, s43, 33792
    s_add_u32 s100, s43, 67584
    s_add_u32 s101, s43, 101376
    ds_read_b128 v[56:59], v5 offset:0
    ds_read_b128 v[60:63], v5 offset:1024
    ds_read_b128 v[64:67], v5 offset:2048
    ds_read_b128 v[68:71], v5 offset:3072
    v_mov_b64 v[12:13], 0
    v_mov_b64 v[14:15], 0
    v_mov_b64 v[16:17], 0
    v_mov_b64 v[18:19], 0
    v_mov_b64 v[20:21], 0
    v_mov_b64 v[22:23], 0
    v_mov_b64 v[24:25], 0
    v_mov_b64 v[26:27], 0
    v_mov_b64 v[28:29], 0
    v_mov_b64 v[30:31], 0
    v_mov_b64 v[32:33], 0
    v_mov_b64 v[34:35], 0
    s_mov_b32 s70, 0
    s_waitcnt lgkmcnt(0)
M_c0_0_top:
    s_nop 0
    s_barrier
    ds_read_b128 v[36:39], v6 offset:13312
    ds_read_b128 v[40:43], v6 offset:14336
    s_mov_b32 m0, 8192
    s_nop 0
    buffer_load_dwordx4 v0, s[8:11], s49 offen offset:0 sc1 lds
    buffer_load_dwordx4 v0, s[8:11], s49 offen offset:1024 sc1 lds
M_c0_0_lr_r:
    s_waitcnt lgkmcnt(1)
    v_smfmac_f32_16x16x64_bf16 v[20:23], v[36:39], v[56:63], v1
    ds_read_b128 v[56:59], v5 offset:4096
    v_smfmac_f32_16x16x64_bf16 v[24:27], v[36:39], v[64:71], v1
    ds_read_b128 v[60:63], v5 offset:5120
    v_smfmac_f32_16x16x64_bf16 v[28:31], v[36:39], a[248:255], v1
    ds_read_b128 v[64:67], v5 offset:6144
    v_smfmac_f32_16x16x64_bf16 v[32:35], v[36:39], a[240:247], v1
    ds_read_b128 v[68:71], v5 offset:7168
    v_smfmac_f32_16x16x64_bf16 v[12:15], v[36:39], a[232:239], v1
    ds_read_b128 v[44:47], v6 offset:15360
    s_waitcnt lgkmcnt(3)
    v_smfmac_f32_16x16x64_bf16 v[16:19], v[36:39], v[56:63], v1
    ds_read_b128 v[56:59], v5 offset:8192
    v_smfmac_f32_16x16x64_bf16 v[20:23], v[40:43], a[224:231], v1
    ds_read_b128 v[60:63], v5 offset:9216
    s_waitcnt lgkmcnt(3)
    v_smfmac_f32_16x16x64_bf16 v[24:27], v[40:43], v[64:71], v1
    ds_read_b128 v[64:67], v5 offset:10240
    v_smfmac_f32_16x16x64_bf16 v[28:31], v[40:43], a[216:223], v1
    ds_read_b128 v[68:71], v5 offset:11264
    v_smfmac_f32_16x16x64_bf16 v[32:35], v[40:43], a[208:215], v1
    ds_read_b128 v[48:51], v6 offset:16384
    s_waitcnt lgkmcnt(3)
    v_smfmac_f32_16x16x64_bf16 v[12:15], v[40:43], v[56:63], v1
    ds_read_b128 v[56:59], v5 offset:12288
    v_smfmac_f32_16x16x64_bf16 v[16:19], v[40:43], a[200:207], v1
    ds_read_b128 v[60:63], v5 offset:13312
    s_waitcnt lgkmcnt(3)
    v_smfmac_f32_16x16x64_bf16 v[20:23], v[44:47], v[64:71], v1
    ds_read_b128 v[64:67], v5 offset:14336
    v_smfmac_f32_16x16x64_bf16 v[24:27], v[44:47], a[192:199], v1
    ds_read_b128 v[68:71], v5 offset:15360
    v_smfmac_f32_16x16x64_bf16 v[28:31], v[44:47], a[184:191], v1
    ds_read_b128 v[52:55], v6 offset:17408
    s_waitcnt lgkmcnt(3)
    v_smfmac_f32_16x16x64_bf16 v[32:35], v[44:47], v[56:63], v1
    ds_read_b128 v[56:59], v5 offset:16384
    v_smfmac_f32_16x16x64_bf16 v[20:23], v[48:51], a[176:183], v1
    ds_read_b128 v[60:63], v5 offset:17408
    s_waitcnt lgkmcnt(3)
    v_max3_u32 v10, v36, v40, v44
    v_smfmac_f32_16x16x64_bf16 v[24:27], v[48:51], v[64:71], v1
    ds_read_b128 v[64:67], v5 offset:18432
    s_waitcnt lgkmcnt(3)
    v_max3_u32 v10, v10, v48, v52
    v_smfmac_f32_16x16x64_bf16 v[28:31], v[48:51], a[168:175], v1
    ds_read_b128 v[68:71], v5 offset:19456
    v_cmp_eq_u32 vcc, -1, v10
    v_smfmac_f32_16x16x64_bf16 v[32:35], v[48:51], a[160:167], v1
    s_cbranch_vccnz M_c0_0_lr
    s_waitcnt vmcnt(0)
    s_barrier
    ds_read_b128 v[36:39], v6 offset:8192
    ds_read_b128 v[40:43], v6 offset:9216
    s_waitcnt lgkmcnt(4)
    v_smfmac_f32_16x16x64_bf16 v[20:23], v[52:55], v[56:63], v1
    ds_read_b128 v[44:47], v6 offset:10240
    ds_read_b128 v[48:51], v6 offset:11264
    v_smfmac_f32_16x16x64_bf16 v[24:27], v[52:55], a[152:159], v1
    ds_read_b32 v11, v6 offset:12288
    ds_read_b128 v[56:59], v5 offset:20480
    s_waitcnt lgkmcnt(6)
    v_smfmac_f32_16x16x64_bf16 v[28:31], v[52:55], v[64:71], v1
    ds_read_b128 v[60:63], v5 offset:21504
    s_waitcnt lgkmcnt(4)
    v_max3_u32 v10, v36, v40, v44
    v_smfmac_f32_16x16x64_bf16 v[32:35], v[52:55], a[144:151], v1
    s_waitcnt lgkmcnt(2)
    v_max3_u32 v10, v10, v48, v11
    v_cmp_eq_u32 vcc, -1, v10
    s_cbranch_vccnz M_c0_0_rr
M_c0_0_rr_r:
    ds_read_b128 v[64:67], v5 offset:22528
    ds_read_b128 v[68:71], v5 offset:23552
    ds_read_b128 v[52:55], v6 offset:12288
    buffer_store_dwordx4 v[76:79], v0, s[8:11], s4 offen offset:0 sc1
    s_mov_b32 s4, 0x10000000
    s_mov_b64 exec, 0x3ff
    buffer_store_dwordx4 v[72:75], v0, s[8:11], s60 offen sc1
    s_mov_b64 exec, -1
    s_mov_b32 s60, 0x10000000
    v_smfmac_f32_16x16x64_bf16 v[20:23], v[36:39], a[136:143], v1
    s_waitcnt lgkmcnt(3)
    v_smfmac_f32_16x16x64_bf16 v[24:27], v[36:39], v[56:63], v1
    ds_read_b128 v[56:59], v5 offset:24576
    v_smfmac_f32_16x16x64_bf16 v[20:23], v[40:43], a[128:135], v1
    ds_read_b128 v[60:63], v5 offset:25600
    s_waitcnt lgkmcnt(3)
    v_smfmac_f32_16x16x64_bf16 v[24:27], v[40:43], v[64:71], v1
    ds_read_b128 v[64:67], v5 offset:26624
    v_smfmac_f32_16x16x64_bf16 v[20:23], v[44:47], a[120:127], v1
    ds_read_b128 v[68:71], v5 offset:27648
    v_smfmac_f32_16x16x64_bf16 v[24:27], v[44:47], a[112:119], v1
    s_waitcnt lgkmcnt(2)
    v_smfmac_f32_16x16x64_bf16 v[20:23], v[48:51], v[56:63], v1
    ds_read_b128 v[56:59], v5 offset:28672
    v_smfmac_f32_16x16x64_bf16 v[24:27], v[48:51], a[104:111], v1
    ds_read_b128 v[60:63], v5 offset:29696
    s_waitcnt lgkmcnt(2)
    v_smfmac_f32_16x16x64_bf16 v[20:23], v[52:55], v[64:71], v1
    ds_read_b128 v[64:67], v5 offset:30720
    v_smfmac_f32_16x16x64_bf16 v[24:27], v[52:55], a[96:103], v1
    ds_read_b128 v[68:71], v5 offset:31744
    v_smfmac_f32_16x16x64_bf16 v[28:31], v[36:39], a[88:95], v1
    s_cmp_eq_u32 s57, 0
    s_cbranch_scc1 M_c0_0_first
M_c0_0_first_r:
    s_waitcnt lgkmcnt(2)
    v_smfmac_f32_16x16x64_bf16 v[32:35], v[36:39], v[56:63], v1
    ds_read_b128 v[56:59], v5 offset:32768
    v_permlane32_swap_b32 v20, v21
    v_smfmac_f32_16x16x64_bf16 v[28:31], v[40:43], a[80:87], v1
    ds_read_b128 v[60:63], v5 offset:33792
    s_waitcnt lgkmcnt(2)
    v_permlane32_swap_b32 v22, v23
    v_smfmac_f32_16x16x64_bf16 v[32:35], v[40:43], v[64:71], v1
    ds_read_b128 v[64:67], v0 offset:2048
    v_permlane32_swap_b32 v24, v25
    v_smfmac_f32_16x16x64_bf16 v[28:31], v[44:47], a[72:79], v1
    ds_read_b128 v[68:71], v0 offset:3072
    v_permlane32_swap_b32 v26, v27
    v_smfmac_f32_16x16x64_bf16 v[32:35], v[44:47], a[64:71], v1
    s_waitcnt lgkmcnt(2)
    v_add_f32 v20, v20, v21
    v_add_f32 v22, v22, v23
    v_smfmac_f32_16x16x64_bf16 v[28:31], v[48:51], v[56:63], v1
    ds_read_b128 v[56:59], v0 offset:0
    v_add_f32 v24, v24, v25
    v_add_f32 v26, v26, v27
    v_smfmac_f32_16x16x64_bf16 v[32:35], v[48:51], a[56:63], v1
    ds_read_b128 v[60:63], v0 offset:1024
    v_mul_f32 v20, s40, v20
    v_mul_f32 v24, s40, v24
    v_smfmac_f32_16x16x64_bf16 v[28:31], v[52:55], a[48:55], v1
    v_mul_f32 v22, s40, v22
    v_mul_f32 v26, s40, v26
    v_smfmac_f32_16x16x64_bf16 v[32:35], v[52:55], a[40:47], v1
    v_cvt_pk_bf16_f32 v20, v20, v24
    v_cvt_pk_bf16_f32 v21, v22, v26
    v_smfmac_f32_16x16x64_bf16 v[12:15], v[36:39], a[32:39], v1
    ds_write_b32 v2, v20 offset:18432
    v_smfmac_f32_16x16x64_bf16 v[16:19], v[36:39], a[24:31], v1
    ds_write_b32 v2, v21 offset:19008
    v_permlane32_swap_b32 v28, v29
    v_smfmac_f32_16x16x64_bf16 v[12:15], v[40:43], a[16:23], v1
    ds_read_b128 v[36:39], v6 offset:15360
    v_permlane32_swap_b32 v30, v31
    v_smfmac_f32_16x16x64_bf16 v[16:19], v[40:43], a[8:15], v1
    ds_read_b128 v[40:43], v6 offset:16384
    v_permlane32_swap_b32 v32, v33
    v_smfmac_f32_16x16x64_bf16 v[12:15], v[44:47], a[0:7], v1
    s_waitcnt lgkmcnt(2)
    s_barrier
    v_permlane32_swap_b32 v34, v35
    v_smfmac_f32_16x16x64_bf16 v[16:19], v[44:47], v[248:255], v1
    ds_read_b128 v[20:23], v3 offset:18432
    v_add_f32 v28, v28, v29
    v_add_f32 v30, v30, v31
    v_smfmac_f32_16x16x64_bf16 v[12:15], v[48:51], v[240:247], v1
    ds_read_b128 v[24:27], v3 offset:18496
    v_add_f32 v32, v32, v33
    v_add_f32 v34, v34, v35
    v_smfmac_f32_16x16x64_bf16 v[16:19], v[48:51], v[232:239], v1
    ds_read_b128 v[72:75], v3 offset:18560
    v_cvt_pk_bf16_f32 v28, v28, v32
    v_cvt_pk_bf16_f32 v29, v30, v34
    v_smfmac_f32_16x16x64_bf16 v[12:15], v[52:55], v[224:231], v1
    ds_write_b32 v2, v28 offset:20736
    ds_read_b128 v[44:47], v3 offset:18624
    v_smfmac_f32_16x16x64_bf16 v[16:19], v[52:55], v[216:223], v1
    ds_write_b32 v2, v29 offset:21312
    s_waitcnt lgkmcnt(7)
    v_smfmac_f32_16x16x64_bf16 v[12:15], v[36:39], v[208:215], v1
    ds_read_b128 v[48:51], v6 offset:17408
    v_mov_b64 v[10:11], s[16:17]
    v_smfmac_f32_16x16x64_bf16 v[16:19], v[36:39], v[200:207], v1
    s_waitcnt lgkmcnt(6)
    v_mfma_f32_16x16x32_bf16 v[28:31], v[56:59], v[20:23], 0
    ds_read_b128 v[56:59], v0 offset:4096
    s_waitcnt lgkmcnt(6)
    v_mfma_f32_16x16x32_bf16 v[28:31], v[60:63], v[24:27], v[28:31]
    ds_read_b128 v[60:63], v0 offset:5120
    s_waitcnt lgkmcnt(3)
    s_barrier
    v_mfma_f32_16x16x32_bf16 v[28:31], v[64:67], v[72:75], v[28:31]
    ds_read_b128 v[64:67], v0 offset:6144
    v_mfma_f32_16x16x32_bf16 v[28:31], v[68:71], v[44:47], v[28:31]
    ds_read_b128 v[68:71], v0 offset:7168
    v_smfmac_f32_16x16x64_bf16 v[12:15], v[40:43], v[192:199], v1
    ds_read_b128 v[36:39], v3 offset:20736
    v_smfmac_f32_16x16x64_bf16 v[16:19], v[40:43], v[184:191], v1
    ds_read_b128 v[52:55], v3 offset:20800
    s_waitcnt lgkmcnt(4)
    v_mfma_f32_16x16x32_bf16 v[32:35], v[56:59], v[20:23], 0
    s_nop 0
    v_exp_f32 v28, v28
    ds_read_b128 v[56:59], v3 offset:20864
    v_mfma_f32_16x16x32_bf16 v[32:35], v[60:63], v[24:27], v[32:35]
    s_waitcnt lgkmcnt(3)
    v_exp_f32 v29, v29
    ds_read_b128 v[60:63], v3 offset:20928
    v_mfma_f32_16x16x32_bf16 v[32:35], v[64:67], v[72:75], v[32:35]
    v_exp_f32 v30, v30
    v_mfma_f32_16x16x32_bf16 v[32:35], v[68:71], v[44:47], v[32:35]
    s_waitcnt lgkmcnt(3)
    v_exp_f32 v31, v31
    v_mfma_f32_16x16x32_bf16 v[40:43], v[36:39], v[20:23], 0
    s_waitcnt lgkmcnt(2)
    v_cvt_pk_bf16_f32 v28, v28, v29
    v_cvt_pk_bf16_f32 v29, v30, v31
    v_mfma_f32_16x16x32_bf16 v[40:43], v[52:55], v[24:27], v[40:43]
    s_waitcnt lgkmcnt(1)
    v_mov_b64 v[64:65], s[24:25]
    v_mov_b64 v[66:67], s[24:25]
    v_mfma_f32_16x16x32_bf16 v[40:43], v[56:59], v[72:75], v[40:43]
    s_waitcnt lgkmcnt(0)
    v_exp_f32 v32, v32
    v_mfma_f32_16x16x32_bf16 v[40:43], v[60:63], v[44:47], v[40:43]
    v_exp_f32 v33, v33
    v_smfmac_f32_16x16x64_bf16 v[12:15], v[48:51], v[176:183], v1
    v_exp_f32 v34, v34
    v_smfmac_f32_16x16x64_bf16 v[16:19], v[48:51], v[168:175], v1
    v_exp_f32 v35, v35
    v_cvt_pk_bf16_f32 v30, v32, v33
    v_cvt_pk_bf16_f32 v31, v34, v35
    s_nop 0
    v_exp_f32 v40, v40
    v_mfma_f32_16x16x32_bf16 v[72:75], v[64:67], v[28:31], 0
    v_exp_f32 v41, v41
    v_mfma_f32_16x16x32_bf16 v[20:23], v[80:83], v[28:31], 0
    v_exp_f32 v42, v42
    v_mfma_f32_16x16x32_bf16 v[24:27], v[84:87], v[28:31], 0
    v_exp_f32 v43, v43
    v_cvt_pk_bf16_f32 v40, v40, v41
    v_cvt_pk_bf16_f32 v41, v42, v43
    v_cvt_pk_bf16_f32 v12, v12, v13
    v_cvt_pk_bf16_f32 v13, v14, v15
    v_mfma_f32_16x16x16_bf16 v[72:75], v[10:11], v[40:41], v[72:75]
    v_cvt_pk_bf16_f32 v14, v16, v17
    v_cvt_pk_bf16_f32 v15, v18, v19
M_c0_0_fin:
    v_mfma_f32_16x16x16_bf16 v[20:23], v[12:13], v[40:41], v[20:23]
    s_cmp_eq_u32 s57, 63
    v_cndmask_b32_e64 v76, v12, v36, s[66:67]
    v_cndmask_b32_e64 v77, v13, v37, s[66:67]
    v_mfma_f32_16x16x16_bf16 v[24:27], v[14:15], v[40:41], v[24:27]
    v_cndmask_b32_e64 v78, v14, v38, s[66:67]
    v_cndmask_b32_e64 v79, v15, v39, s[66:67]
    s_cbranch_scc1 M_c0_0_last
    v_rcp_f32 v74, v72
    v_subrev_u32 v73, s68, v72
    v_cmp_lt_u32 vcc, s69, v73
    v_mov_b64 v[44:45], 0
    v_mov_b64 v[46:47], 0
    v_cndmask_b32_e64 v20, v20, v24, s[18:19]
    v_cndmask_b32_e64 v21, v21, v25, s[18:19]
    v_cndmask_b32_e64 v22, v22, v26, s[18:19]
    v_cndmask_b32_e64 v23, v23, v27, s[18:19]
    v_pk_mul_f32 v[20:21], v[20:21], v[74:75] op_sel_hi:[1,0]
    v_pk_mul_f32 v[22:23], v[22:23], v[74:75] op_sel_hi:[1,0]
    v_cvt_pk_bf16_f32 v20, v20, v21
    v_cvt_pk_bf16_f32 v21, v22, v23
    ds_write_b64 v0, v[20:21] offset:13312
    s_cbranch_vccnz M_c0_0_zbad
M_c0_0_zok:
    s_cmp_eq_u32 s57, 0
    s_cbranch_scc1 M_c0_0_first2
M_c0_0_first2_r:
    buffer_load_dwordx4 v[80:83], v0, s[8:11], s3 offen offset:0 sc1
    buffer_load_dwordx4 v[84:87], v0, s[8:11], s3 offen offset:1024 sc1
    s_waitcnt lgkmcnt(0)
    s_barrier
    ds_read_b128 v[32:35], v0 offset:13312
    ds_read_b128 v[52:55], v0 offset:14336
    s_mov_b32 m0, 0
    s_nop 0
    buffer_load_dwordx4 v0, s[8:11], s26 offen offset:0 sc1 lds
    buffer_load_dwordx4 v0, s[8:11], s26 offen offset:1024 sc1 lds
    v_mov_b64 v[68:69], 0
    v_mov_b64 v[70:71], 0
    v_mov_b64 v[64:65], 0
    v_mov_b64 v[66:67], 0
    v_mov_b64 v[60:61], 0
    v_mov_b64 v[62:63], 0
    v_mov_b64 v[56:57], 0
    v_mov_b64 v[58:59], 0
    s_waitcnt lgkmcnt(1)
    s_nop 0
    v_smfmac_f32_16x16x64_bf16 v[56:59], v[32:35], v[160:167], v1
    v_smfmac_f32_16x16x64_bf16 v[60:63], v[32:35], v[144:151], v1
    s_waitcnt lgkmcnt(0)
    v_smfmac_f32_16x16x64_bf16 v[56:59], v[52:55], v[152:159], v1
    v_smfmac_f32_16x16x64_bf16 v[60:63], v[52:55], v[136:143], v1
    v_smfmac_f32_16x16x64_bf16 v[64:67], v[32:35], v[128:135], v1
    v_smfmac_f32_16x16x64_bf16 v[68:71], v[32:35], v[112:119], v1
    v_permlane32_swap_b32 v56, v57
    v_smfmac_f32_16x16x64_bf16 v[64:67], v[52:55], v[120:127], v1
    v_permlane32_swap_b32 v58, v59
    v_smfmac_f32_16x16x64_bf16 v[68:71], v[52:55], v[104:111], v1
    v_add_f32 v56, v56, v57
    v_add_f32 v58, v58, v59
    v_smfmac_f32_16x16x64_bf16 v[44:47], v[32:35], v[96:103], v1
    v_permlane32_swap_b32 v60, v61
    v_smfmac_f32_16x16x64_bf16 v[44:47], v[52:55], v[88:95], v1
    v_permlane32_swap_b32 v62, v63
    v_add_f32 v60, v60, v61
    v_add_f32 v62, v62, v63
    v_cvt_pk_bf16_f32 v36, v56, v60
    v_cvt_pk_bf16_f32 v38, v58, v62
    v_permlane32_swap_b32 v64, v65
    v_permlane32_swap_b32 v66, v67
    v_add_f32 v64, v64, v65
    v_add_f32 v66, v66, v67
    v_permlane32_swap_b32 v68, v69
    v_permlane32_swap_b32 v70, v71
    v_add_f32 v68, v68, v69
    v_add_f32 v70, v70, v71
    v_cvt_pk_bf16_f32 v37, v64, v68
    v_cvt_pk_bf16_f32 v39, v66, v70
    buffer_store_dwordx4 v[36:39], v0, s[8:11], s58 offen
    v_permlane32_swap_b32 v44, v45
    v_permlane32_swap_b32 v46, v47
    v_add_f32 v44, v44, v45
    v_add_f32 v46, v46, v47
    v_cvt_pk_bf16_f32 v44, v44, v46
    buffer_store_dword v44, v7, s[8:11], s55 offen
    v_and_b32 v32, 16, v0
    v_bfe_u32 v33, v0, 5, 2
    v_lshlrev_b32_e64 v32, v32, s45
    v_cmp_eq_u32_e64 s[64:65], 0, v33
    v_cmp_eq_u32_e64 vcc, 1, v33
    s_add_u32 s27, s44, 1
    s_and_b32 s27, s27, 3
    v_cndmask_b32_e64 v72, 0, v32, s[64:65]
    v_cndmask_b32_e64 v73, 0, v32, vcc
    v_cmp_eq_u32_e64 s[64:65], 2, v33
    v_cmp_eq_u32_e64 vcc, 3, v33
    s_mul_i32 s48, s27, 5120
    s_add_u32 s48, s48, s41
    v_cndmask_b32_e64 v74, 0, v32, s[64:65]
    v_cndmask_b32_e64 v75, 0, v32, vcc
    s_lshl_b32 s27, s27, 15
    s_add_u32 s49, s27, s47
    v_bfe_u32 v11, v0, 4, 3
    v_lshlrev_b32 v11, 3, v11
    v_lshrrev_b32 v32, 8, v0
    v_lshl_add_u32 v11, v32, 6, v11
    s_add_u32 s56, s27, s46
    s_add_u32 s56, s56, s33
    s_add_u32 s58, s48, s33
    v_mov_b32 v5, v5
    s_nop 1
    v_mov_b32 v5, v5
    s_nop 1
    v_mov_b32 v5, v5
    s_nop 1
    v_mov_b32 v5, v5
    s_nop 1
    v_mov_b32 v5, v5
    s_nop 1
    v_mov_b32 v5, v5
    s_nop 1
    v_mov_b32 v5, v5
    s_nop 1
    v_mov_b32 v5, v5
    s_nop 1
    buffer_load_dwordx4 v[12:15], v8, s[8:11], s43 offen sc1
    buffer_load_dwordx4 v[16:19], v8, s[8:11], s61 offen sc1
    buffer_load_dwordx4 v[20:23], v8, s[8:11], s100 offen sc1
    buffer_load_dwordx4 v[24:27], v8, s[8:11], s101 offen sc1
    v_mov_b32 v5, v5
    s_nop 1
    v_mov_b32 v5, v5
    s_nop 1
    v_mov_b32 v5, v5
    s_nop 1
    v_mov_b32 v5, v5
    s_nop 1
    v_mov_b32 v5, v5
    s_nop 1
    v_mov_b32 v5, v5
    s_nop 1
    v_mov_b32 v5, v5
    s_nop 1
    v_mov_b32 v5, v5
    s_nop 1
    buffer_load_dwordx4 v[40:43], v8, s[8:11], s43 offen sc1
    buffer_load_dwordx4 v[44:47], v8, s[8:11], s61 offen sc1
    buffer_load_dwordx4 v[48:51], v8, s[8:11], s100 offen sc1
    buffer_load_dwordx4 v[52:55], v8, s[8:11], s101 offen sc1
    v_mov_b32 v5, v5
    s_nop 1
    v_mov_b32 v5, v5
    s_nop 1
    v_mov_b32 v5, v5
    v_mov_b32 v5, v5
    s_waitcnt vmcnt(7)
    v_mfma_f32_16x16x32_bf16 v[28:31], v[72:75], v[12:15], 0
    s_waitcnt vmcnt(6)
    v_mfma_f32_16x16x32_bf16 v[28:31], v[72:75], v[16:19], v[28:31]
    s_waitcnt vmcnt(5)
    v_mfma_f32_16x16x32_bf16 v[28:31], v[72:75], v[20:23], v[28:31]
    s_waitcnt vmcnt(4)
    v_mfma_f32_16x16x32_bf16 v[28:31], v[72:75], v[24:27], v[28:31]
    v_max3_u32 v32, v12, v16, v20
    v_max_u32 v32, v32, v24
    v_cmp_eq_u32 vcc, -1, v32
    s_cbranch_vccnz M_c0_0_wq1
    v_mov_b32 v5, v5
    v_mov_b32 v5, v5
    v_mov_b32 v5, v5
    v_mov_b32 v5, v5
    v_add_f32_dpp v28, v28, v28 row_ror:8 row_mask:0xf bank_mask:0xf
    v_add_f32_dpp v29, v29, v29 row_ror:8 row_mask:0xf bank_mask:0xf
    v_add_f32_dpp v30, v30, v30 row_ror:8 row_mask:0xf bank_mask:0xf
    v_add_f32_dpp v31, v31, v31 row_ror:8 row_mask:0xf bank_mask:0xf
    v_cmp_u_f32 vcc, v28, v28
    v_cvt_pk_bf16_f32 v28, v28, v29
    v_cvt_pk_bf16_f32 v29, v30, v31
    s_cbranch_vccnz M_c0_0_wrb_e0
    s_mov_b64 exec, s[38:39]
    buffer_store_dwordx2 v[28:29], v11, s[8:11], s58 offen
M_c0_0_wrb_d:
    s_barrier
    buffer_store_dwordx2 v[28:29], v11, s[8:11], s56 offen sc1
M_c0_0_wrb_g:
    s_mov_b64 exec, -1
    s_waitcnt vmcnt(2)
    ds_read_b128 v[56:59], v5 offset:0
    ds_read_b128 v[60:63], v5 offset:1024
    ds_read_b128 v[64:67], v5 offset:2048
    ds_read_b128 v[68:71], v5 offset:3072
    v_mov_b64 v[12:13], 0
    v_mov_b64 v[14:15], 0
    v_mov_b64 v[16:17], 0
    v_mov_b64 v[18:19], 0
    v_mov_b64 v[20:21], 0
    v_mov_b64 v[22:23], 0
    v_mov_b64 v[24:25], 0
    v_mov_b64 v[26:27], 0
    v_mov_b64 v[28:29], 0
    v_mov_b64 v[30:31], 0
    v_mov_b64 v[32:33], 0
    v_mov_b64 v[34:35], 0
    s_and_b32 s26, s44, 63
    s_add_u32 s26, s26, 2
    s_min_u32 s26, s26, 63
    s_lshl_b32 s26, s26, 18
    s_add_u32 s26, s26, s50
    s_add_u32 s3, s26, 16777216
    s_lshl_b32 s4, s44, 18
    s_add_u32 s4, s4, s53
    v_mov_b64 v[72:73], -1
    v_mov_b64 v[74:75], -1
    s_add_u32 s28, s44, 3
    s_and_b32 s29, s28, 3
    s_mul_i32 s31, s22, 160
    s_mul_i32 s28, s29, 167936
    s_add_u32 s28, s28, s34
    s_add_u32 s64, s28, s35
    s_mul_i32 s65, s29, 5120
    s_add_u32 s65, s65, s41
    s_add_u32 s65, s65, s31
    s_lshl_b32 s60, s29, 15
    s_add_u32 s60, s60, s47
    s_add_u32 s60, s60, s31
    s_add_u32 s44, s44, 1
    s_and_b32 s55, s44, 3
    s_mul_i32 s55, s55, 167936
    s_add_u32 s55, s55, s34
    s_add_u32 s58, s55, s35
    s_and_b32 s57, s44, 63
    s_add_u32 s43, s55, s32
    s_add_u32 s61, s43, 33792
    s_add_u32 s100, s43, 67584
    s_add_u32 s101, s43, 101376
    s_nop 15
    s_nop 15
    s_nop 12
    buffer_store_dwordx4 v[72:75], v0, s[8:11], s64 offen offset:0
    buffer_store_dwordx4 v[72:75], v0, s[8:11], s64 offen offset:1024
    s_mov_b64 exec, 0x3ff
    buffer_store_dwordx4 v[72:75], v0, s[8:11], s65 offen
    s_mov_b64 exec, -1
    s_mov_b32 s65, 0x10000000
    s_mov_b32 s64, 0x10000000
    s_mov_b32 s70, 0
    s_waitcnt lgkmcnt(0)
    s_branch M_c0_0_top
M_c0_0_restart:
    s_waitcnt vmcnt(0) lgkmcnt(0)
    s_nop 7
    s_barrier
    ds_read_b128 v[56:59], v5 offset:0
    ds_read_b128 v[60:63], v5 offset:1024
    ds_read_b128 v[64:67], v5 offset:2048
    ds_read_b128 v[68:71], v5 offset:3072
    v_mov_b64 v[12:13], 0
    v_mov_b64 v[14:15], 0
    v_mov_b64 v[16:17], 0
    v_mov_b64 v[18:19], 0
    v_mov_b64 v[20:21], 0
    v_mov_b64 v[22:23], 0
    v_mov_b64 v[24:25], 0
    v_mov_b64 v[26:27], 0
    v_mov_b64 v[28:29], 0
    v_mov_b64 v[30:31], 0
    v_mov_b64 v[32:33], 0
    v_mov_b64 v[34:35], 0
    s_waitcnt vmcnt(0) lgkmcnt(0)
    s_branch M_c0_0_top
M_c0_0_zbad:
    s_cmp_eq_u32 s70, 2
    s_cbranch_scc1 M_c0_0_zok
    v_cmp_u_f32 vcc, v72, v72
    s_cbranch_vccz M_c0_0_exact
    s_cmp_eq_u32 s70, 1
    s_cbranch_scc1 M_c0_0_exact
M_c0_0_vfy0:
    s_mov_b32 s70, 1
    s_mov_b32 s30, 0
    s_waitcnt vmcnt(0) lgkmcnt(0)
    s_nop 7
M_c0_0_vfy:
    v_mov_b32 v10, 0
    s_add_u32 s59, s48, 4096
    buffer_load_dwordx4 v[36:39], v0, s[8:11], s48 offen offset:0 sc1
    buffer_load_dwordx4 v[40:43], v0, s[8:11], s48 offen offset:1024 sc1
    buffer_load_dwordx4 v[44:47], v0, s[8:11], s48 offen offset:2048 sc1
    buffer_load_dwordx4 v[48:51], v0, s[8:11], s48 offen offset:3072 sc1
    buffer_load_dwordx4 v[52:55], v0, s[8:11], s59 offen offset:0 sc1
    s_waitcnt vmcnt(4)
    v_max3_u32 v10, v10, v36, v37
    v_max3_u32 v10, v10, v38, v39
    s_waitcnt vmcnt(3)
    v_max3_u32 v10, v10, v40, v41
    v_max3_u32 v10, v10, v42, v43
    s_waitcnt vmcnt(2)
    v_max3_u32 v10, v10, v44, v45
    v_max3_u32 v10, v10, v46, v47
    s_waitcnt vmcnt(1)
    v_max3_u32 v10, v10, v48, v49
    v_max3_u32 v10, v10, v50, v51
    s_waitcnt vmcnt(0)
    v_max3_u32 v10, v10, v52, v53
    v_max3_u32 v10, v10, v54, v55
    s_add_u32 s59, s49, 4096
    buffer_load_dwordx4 v[36:39], v0, s[8:11], s49 offen offset:0 sc1
    buffer_load_dwordx4 v[40:43], v0, s[8:11], s49 offen offset:1024 sc1
    buffer_load_dwordx4 v[44:47], v0, s[8:11], s49 offen offset:2048 sc1
    buffer_load_dwordx4 v[48:51], v0, s[8:11], s49 offen offset:3072 sc1
    buffer_load_dwordx4 v[52:55], v0, s[8:11], s59 offen offset:0 sc1
    s_waitcnt vmcnt(4)
    v_max3_u32 v10, v10, v36, v37
    v_max3_u32 v10, v10, v38, v39
    s_waitcnt vmcnt(3)
    v_max3_u32 v10, v10, v40, v41
    v_max3_u32 v10, v10, v42, v43
    s_waitcnt vmcnt(2)
    v_max3_u32 v10, v10, v44, v45
    v_max3_u32 v10, v10, v46, v47
    s_waitcnt vmcnt(1)
    v_max3_u32 v10, v10, v48, v49
    v_max3_u32 v10, v10, v50, v51
    s_waitcnt vmcnt(0)
    v_max3_u32 v10, v10, v52, v53
    v_max3_u32 v10, v10, v54, v55
    v_cmp_eq_u32 vcc, -1, v10
    s_cbranch_vccz M_c0_0_restart
    s_add_u32 s30, s30, 1
    s_cmp_ge_u32 s30, 60000
    s_cbranch_scc1 M_fail
    s_branch M_c0_0_vfy
M_c0_0_exact:
    s_nop 7
    s_mov_b32 s70, 2
    s_waitcnt lgkmcnt(0)
    ds_read_b128 v[20:23], v3 offset:18432
    ds_read_b128 v[24:27], v3 offset:18496
    ds_read_b128 v[72:75], v3 offset:18560
    ds_read_b128 v[44:47], v3 offset:18624
    ds_read_b128 v[56:59], v0 offset:0
    s_waitcnt lgkmcnt(0)
    v_mfma_f32_16x16x32_bf16 v[28:31], v[56:59], v[20:23], 0
    s_nop 3
    ds_read_b128 v[60:63], v0 offset:1024
    s_waitcnt lgkmcnt(0)
    v_mfma_f32_16x16x32_bf16 v[28:31], v[60:63], v[24:27], v[28:31]
    s_nop 3
    ds_read_b128 v[56:59], v0 offset:2048
    s_waitcnt lgkmcnt(0)
    v_mfma_f32_16x16x32_bf16 v[28:31], v[56:59], v[72:75], v[28:31]
    s_nop 3
    ds_read_b128 v[60:63], v0 offset:3072
    s_waitcnt lgkmcnt(0)
    v_mfma_f32_16x16x32_bf16 v[28:31], v[60:63], v[44:47], v[28:31]
    s_nop 3
    ds_read_b128 v[56:59], v0 offset:4096
    s_waitcnt lgkmcnt(0)
    v_mfma_f32_16x16x32_bf16 v[32:35], v[56:59], v[20:23], 0
    s_nop 3
    ds_read_b128 v[60:63], v0 offset:5120
    s_waitcnt lgkmcnt(0)
    v_mfma_f32_16x16x32_bf16 v[32:35], v[60:63], v[24:27], v[32:35]
    s_nop 3
    ds_read_b128 v[56:59], v0 offset:6144
    s_waitcnt lgkmcnt(0)
    v_mfma_f32_16x16x32_bf16 v[32:35], v[56:59], v[72:75], v[32:35]
    s_nop 3
    ds_read_b128 v[60:63], v0 offset:7168
    s_waitcnt lgkmcnt(0)
    v_mfma_f32_16x16x32_bf16 v[32:35], v[60:63], v[44:47], v[32:35]
    s_nop 3
    ds_read_b128 v[56:59], v3 offset:20736
    s_waitcnt lgkmcnt(0)
    v_mfma_f32_16x16x32_bf16 v[40:43], v[56:59], v[20:23], 0
    s_nop 3
    ds_read_b128 v[60:63], v3 offset:20800
    s_waitcnt lgkmcnt(0)
    v_mfma_f32_16x16x32_bf16 v[40:43], v[60:63], v[24:27], v[40:43]
    s_nop 3
    ds_read_b128 v[56:59], v3 offset:20864
    s_waitcnt lgkmcnt(0)
    v_mfma_f32_16x16x32_bf16 v[40:43], v[56:59], v[72:75], v[40:43]
    s_nop 3
    ds_read_b128 v[60:63], v3 offset:20928
    s_waitcnt lgkmcnt(0)
    v_mfma_f32_16x16x32_bf16 v[40:43], v[60:63], v[44:47], v[40:43]
    s_nop 3
    v_max3_f32 v68, v28, v29, v30
    v_max3_f32 v68, v68, v31, v32
    v_max3_f32 v68, v68, v33, v34
    s_nop 0
    v_max3_f32 v68, v68, v35, v40
    v_max3_f32 v68, v68, v41, v42
    v_max_f32 v68, v68, v43
    v_mov_b32 v69, v68
    s_nop 1
    v_permlane16_swap_b32 v68, v69
    v_max_f32 v68, v68, v69
    v_mov_b32 v69, v68
    s_nop 1
    v_permlane32_swap_b32 v68, v69
    v_max_f32 v68, v68, v69
    v_sub_f32 v28, v28, v68
    v_exp_f32 v28, v28
    v_sub_f32 v29, v29, v68
    v_exp_f32 v29, v29
    v_sub_f32 v30, v30, v68
    v_exp_f32 v30, v30
    v_sub_f32 v31, v31, v68
    v_exp_f32 v31, v31
    v_sub_f32 v32, v32, v68
    v_exp_f32 v32, v32
    v_sub_f32 v33, v33, v68
    v_exp_f32 v33, v33
    v_sub_f32 v34, v34, v68
    v_exp_f32 v34, v34
    v_sub_f32 v35, v35, v68
    v_exp_f32 v35, v35
    v_sub_f32 v40, v40, v68
    v_exp_f32 v40, v40
    v_sub_f32 v41, v41, v68
    v_exp_f32 v41, v41
    v_sub_f32 v42, v42, v68
    v_exp_f32 v42, v42
    v_sub_f32 v43, v43, v68
    v_exp_f32 v43, v43
    v_cvt_pk_bf16_f32 v28, v28, v29
    v_cvt_pk_bf16_f32 v29, v30, v31
    v_cvt_pk_bf16_f32 v30, v32, v33
    v_cvt_pk_bf16_f32 v31, v34, v35
    v_cvt_pk_bf16_f32 v40, v40, v41
    v_cvt_pk_bf16_f32 v41, v42, v43
    v_mfma_f32_16x16x32_bf16 v[20:23], v[80:83], v[28:31], 0
    v_mfma_f32_16x16x32_bf16 v[24:27], v[84:87], v[28:31], 0
    v_mfma_f32_16x16x32_bf16 v[72:75], v[64:67], v[28:31], 0
    ds_read_b128 v[36:39], v3 offset:20736
    s_waitcnt lgkmcnt(0)
    s_nop 7
    v_mfma_f32_16x16x16_bf16 v[72:75], v[10:11], v[40:41], v[72:75]
    s_nop 7
    s_branch M_c0_0_fin
M_c0_0_last:
    s_cmp_lg_u32 s70, 0
    s_cbranch_scc1 M_c0_0_last2
    v_cmp_u_f32 vcc, v32, v32
    s_cbranch_vccnz M_c0_0_vfy0
M_c0_0_last2:
    s_lshl_b32 s4, s44, 18
    s_add_u32 s4, s4, s53
    buffer_store_dwordx4 v[76:79], v0, s[8:11], s4 offen offset:0 sc1
    s_mov_b32 s4, 0x10000000
    s_waitcnt vmcnt(0) lgkmcnt(0)
    s_barrier
    s_nop 7
    v_mov_b64 v[72:73], -1
    v_mov_b64 v[74:75], -1
    s_add_u32 s28, s44, 3
    s_and_b32 s29, s28, 3
    s_mul_i32 s31, s22, 160
    s_mul_i32 s28, s29, 167936
    s_add_u32 s28, s28, s34
    s_add_u32 s64, s28, s35
    s_mul_i32 s65, s29, 5120
    s_add_u32 s65, s65, s41
    s_add_u32 s65, s65, s31
    s_lshl_b32 s60, s29, 15
    s_add_u32 s60, s60, s47
    s_add_u32 s60, s60, s31
    buffer_store_dwordx4 v[72:75], v0, s[8:11], s64 offen offset:0
    buffer_store_dwordx4 v[72:75], v0, s[8:11], s64 offen offset:1024
    s_mov_b64 exec, 0x3ff
    buffer_store_dwordx4 v[72:75], v0, s[8:11], s65 offen
    s_mov_b64 exec, -1
    s_mov_b32 s65, 0x10000000
    s_mov_b32 s64, 0x10000000
    s_mov_b64 exec, 0x3ff
    buffer_store_dwordx4 v[72:75], v0, s[8:11], s60 offen sc1
    s_mov_b64 exec, -1
    s_mov_b32 s60, 0x10000000
    s_waitcnt vmcnt(0)
    s_add_u32 s44, s44, 1
    s_cmp_eq_u32 s44, 128
    s_cbranch_scc1 M_end
    s_branch M_c0_0_layer
M_c0_0_lr:
    s_mov_b32 s30, 0
M_c0_0_lr_l:
    s_waitcnt lgkmcnt(0)
    ds_read_b128 v[36:39], v6 offset:13312
    ds_read_b128 v[40:43], v6 offset:14336
    ds_read_b128 v[44:47], v6 offset:15360
    ds_read_b128 v[48:51], v6 offset:16384
    ds_read_b128 v[52:55], v6 offset:17408
    s_waitcnt lgkmcnt(2)
    v_max3_u32 v10, v36, v40, v44
    s_waitcnt lgkmcnt(0)
    v_max3_u32 v10, v10, v48, v52
    v_cmp_eq_u32 vcc, -1, v10
    s_cbranch_vccz M_c0_0_lr_d
    s_add_u32 s30, s30, 1
    s_cmp_ge_u32 s30, 480000
    s_cbranch_scc1 M_fail
    s_branch M_c0_0_lr_l
M_c0_0_lr_d:
    ds_read_b128 v[56:59], v5 offset:0
    ds_read_b128 v[60:63], v5 offset:1024
    ds_read_b128 v[64:67], v5 offset:2048
    ds_read_b128 v[68:71], v5 offset:3072
    v_mov_b64 v[12:13], 0
    v_mov_b64 v[14:15], 0
    v_mov_b64 v[16:17], 0
    v_mov_b64 v[18:19], 0
    v_mov_b64 v[20:21], 0
    v_mov_b64 v[22:23], 0
    v_mov_b64 v[24:25], 0
    v_mov_b64 v[26:27], 0
    v_mov_b64 v[28:29], 0
    v_mov_b64 v[30:31], 0
    v_mov_b64 v[32:33], 0
    v_mov_b64 v[34:35], 0
    s_waitcnt lgkmcnt(0)
    s_branch M_c0_0_lr_r
M_c0_0_rr:
    s_mov_b32 s30, 0
M_c0_0_rr_l:
    s_waitcnt lgkmcnt(0)
    s_and_b32 s27, s30, 1
    s_cbranch_scc1 M_c0_0_rr_n
    s_waitcnt vmcnt(2)
    s_mov_b32 m0, 8192
    s_nop 0
    buffer_load_dwordx4 v0, s[8:11], s49 offen offset:0 sc1 lds
    buffer_load_dwordx4 v0, s[8:11], s49 offen offset:1024 sc1 lds
M_c0_0_rr_n:
    ds_read_b128 v[36:39], v6 offset:8192
    ds_read_b128 v[40:43], v6 offset:9216
    ds_read_b128 v[44:47], v6 offset:10240
    ds_read_b128 v[48:51], v6 offset:11264
    ds_read_b32 v11, v6 offset:12288
    s_waitcnt lgkmcnt(2)
    v_max3_u32 v10, v36, v40, v44
    s_waitcnt lgkmcnt(0)
    v_max3_u32 v10, v10, v48, v11
    v_cmp_eq_u32 vcc, -1, v10
    s_cbranch_vccz M_c0_0_rr_d
    s_add_u32 s30, s30, 1
    s_cmp_ge_u32 s30, 480000
    s_cbranch_scc1 M_fail
    s_branch M_c0_0_rr_l
M_c0_0_rr_d:
    s_branch M_c0_0_rr_r
M_c0_0_first:
    s_mul_i32 s27, s21, 167936
    s_add_u32 s27, s27, s34
    s_mul_i32 s28, s22, 4224
    s_add_u32 s28, s28, s27
    s_mov_b32 exec_hi, 0
    buffer_load_dword v10, v9, s[8:11], s28 offen sc1
    s_lshl_b32 s28, s22, 10
    s_add_u32 s28, s28, s27
    s_add_u32 s28, s28, 135168
    s_mov_b64 exec, 0xff
    buffer_load_dword v10, v9, s[8:11], s28 offen sc1
    s_mul_i32 s27, s21, 5120
    s_add_u32 s27, s27, s41
    s_mul_i32 s28, s22, 160
    s_add_u32 s28, s28, s27
    s_mov_b64 exec, 3
    buffer_load_dword v10, v9, s[8:11], s28 offen sc1
    s_mov_b64 exec, -1
    s_barrier
    s_and_b32 s26, s44, 63
    s_lshl_b32 s26, s26, 18
    s_add_u32 s26, s26, s50
    s_add_u32 s3, s26, 16777216
    s_mov_b32 m0, 0
    s_nop 0
    buffer_load_dwordx4 v0, s[8:11], s26 offen offset:0 sc1 lds
    buffer_load_dwordx4 v0, s[8:11], s26 offen offset:1024 sc1 lds
    buffer_load_dwordx4 v[80:83], v0, s[8:11], s3 offen offset:0 sc1
    buffer_load_dwordx4 v[84:87], v0, s[8:11], s3 offen offset:1024 sc1
    s_and_b32 s26, s44, 63
    s_add_u32 s26, s26, 1
    s_min_u32 s26, s26, 63
    s_lshl_b32 s26, s26, 18
    s_add_u32 s26, s26, s50
    s_add_u32 s3, s26, 16777216
    s_waitcnt vmcnt(0) lgkmcnt(0)
    s_barrier
    s_branch M_c0_0_first_r
M_c0_0_first2:
    s_barrier
    s_branch M_c0_0_first2_r
M_c0_0_wq1:
    buffer_load_dwordx4 v[12:15], v8, s[8:11], s43 offen sc1
    buffer_load_dwordx4 v[16:19], v8, s[8:11], s61 offen sc1
    buffer_load_dwordx4 v[20:23], v8, s[8:11], s100 offen sc1
    buffer_load_dwordx4 v[24:27], v8, s[8:11], s101 offen sc1
    s_waitcnt vmcnt(7)
    v_mfma_f32_16x16x32_bf16 v[28:31], v[72:75], v[40:43], 0
    s_waitcnt vmcnt(6)
    v_mfma_f32_16x16x32_bf16 v[28:31], v[72:75], v[44:47], v[28:31]
    s_waitcnt vmcnt(5)
    v_mfma_f32_16x16x32_bf16 v[28:31], v[72:75], v[48:51], v[28:31]
    s_waitcnt vmcnt(4)
    v_mfma_f32_16x16x32_bf16 v[28:31], v[72:75], v[52:55], v[28:31]
    v_max3_u32 v32, v40, v44, v48
    v_max_u32 v32, v32, v52
    v_cmp_eq_u32 vcc, -1, v32
    s_cbranch_vccnz M_c0_0_wqx
    v_mov_b32 v5, v5
    v_mov_b32 v5, v5
    v_mov_b32 v5, v5
    v_mov_b32 v5, v5
    v_add_f32_dpp v28, v28, v28 row_ror:8 row_mask:0xf bank_mask:0xf
    v_add_f32_dpp v29, v29, v29 row_ror:8 row_mask:0xf bank_mask:0xf
    v_add_f32_dpp v30, v30, v30 row_ror:8 row_mask:0xf bank_mask:0xf
    v_add_f32_dpp v31, v31, v31 row_ror:8 row_mask:0xf bank_mask:0xf
    v_cmp_u_f32 vcc, v28, v28
    v_cvt_pk_bf16_f32 v28, v28, v29
    v_cvt_pk_bf16_f32 v29, v30, v31
    s_cbranch_vccnz M_c0_0_wqe1
    s_mov_b64 exec, s[38:39]
    buffer_store_dwordx2 v[28:29], v11, s[8:11], s58 offen
    s_barrier
    buffer_store_dwordx2 v[28:29], v11, s[8:11], s56 offen sc1
    s_branch M_c0_0_wrb_g
M_c0_0_wqx:
    s_branch M_c0_0_wrb_i1
M_c0_0_wqe1:
    s_waitcnt vmcnt(0)
    buffer_load_dwordx4 v[12:15], v8, s[8:11], s43 offen sc1
    buffer_load_dwordx4 v[16:19], v8, s[8:11], s61 offen sc1
    buffer_load_dwordx4 v[20:23], v8, s[8:11], s100 offen sc1
    buffer_load_dwordx4 v[24:27], v8, s[8:11], s101 offen sc1
    s_branch M_c0_0_wrb_e1
M_c0_0_wrb_l:
    s_waitcnt vmcnt(4)
    v_mfma_f32_16x16x32_bf16 v[28:31], v[72:75], v[12:15], 0
    v_mfma_f32_16x16x32_bf16 v[28:31], v[72:75], v[16:19], v[28:31]
    v_mfma_f32_16x16x32_bf16 v[28:31], v[72:75], v[20:23], v[28:31]
    v_mfma_f32_16x16x32_bf16 v[28:31], v[72:75], v[24:27], v[28:31]
    v_max3_u32 v32, v12, v16, v20
    v_max_u32 v32, v32, v24
    v_cmp_eq_u32 vcc, -1, v32
    s_cbranch_vccz M_c0_0_wrb_x0
M_c0_0_wrb_i0:
    buffer_load_dwordx4 v[12:15], v8, s[8:11], s43 offen sc1
    buffer_load_dwordx4 v[16:19], v8, s[8:11], s61 offen sc1
    buffer_load_dwordx4 v[20:23], v8, s[8:11], s100 offen sc1
    buffer_load_dwordx4 v[24:27], v8, s[8:11], s101 offen sc1
    s_waitcnt vmcnt(4)
    v_mfma_f32_16x16x32_bf16 v[28:31], v[72:75], v[40:43], 0
    v_mfma_f32_16x16x32_bf16 v[28:31], v[72:75], v[44:47], v[28:31]
    v_mfma_f32_16x16x32_bf16 v[28:31], v[72:75], v[48:51], v[28:31]
    v_mfma_f32_16x16x32_bf16 v[28:31], v[72:75], v[52:55], v[28:31]
    v_max3_u32 v32, v40, v44, v48
    v_max_u32 v32, v32, v52
    v_cmp_eq_u32 vcc, -1, v32
    s_cbranch_vccz M_c0_0_wrb_x1
M_c0_0_wrb_i1:
    buffer_load_dwordx4 v[40:43], v8, s[8:11], s43 offen sc1
    buffer_load_dwordx4 v[44:47], v8, s[8:11], s61 offen sc1
    buffer_load_dwordx4 v[48:51], v8, s[8:11], s100 offen sc1
    buffer_load_dwordx4 v[52:55], v8, s[8:11], s101 offen sc1
    s_add_u32 s71, s71, 1
    s_cmp_lt_u32 s71, 240000
    s_cbranch_scc1 M_c0_0_wrb_l
    s_branch M_fail
M_c0_0_wrb_x0:
    s_nop 3
    v_add_f32_dpp v28, v28, v28 row_ror:8 row_mask:0xf bank_mask:0xf
    v_add_f32_dpp v29, v29, v29 row_ror:8 row_mask:0xf bank_mask:0xf
    v_add_f32_dpp v30, v30, v30 row_ror:8 row_mask:0xf bank_mask:0xf
    v_add_f32_dpp v31, v31, v31 row_ror:8 row_mask:0xf bank_mask:0xf
    v_cmp_u_f32 vcc, v28, v28
    v_cvt_pk_bf16_f32 v28, v28, v29
    v_cvt_pk_bf16_f32 v29, v30, v31
    s_cbranch_vccz M_c0_0_wrb_n
M_c0_0_wrb_e0:
    v_max3_u32 v32, v12, v13, v14
    v_max3_u32 v32, v32, v15, v16
    v_max3_u32 v32, v32, v17, v18
    v_max3_u32 v32, v32, v19, v20
    v_max3_u32 v32, v32, v21, v22
    v_max3_u32 v32, v32, v23, v24
    v_max3_u32 v32, v32, v25, v26
    v_max_u32 v32, v32, v27
    v_cmp_eq_u32 vcc, -1, v32
    s_cbranch_vccnz M_c0_0_wrb_i0
    v_min_u32 v28, -2, v28
    v_min_u32 v29, -2, v29
    s_branch M_c0_0_wrb_n
M_c0_0_wrb_x1:
    s_nop 3
    v_add_f32_dpp v28, v28, v28 row_ror:8 row_mask:0xf bank_mask:0xf
    v_add_f32_dpp v29, v29, v29 row_ror:8 row_mask:0xf bank_mask:0xf
    v_add_f32_dpp v30, v30, v30 row_ror:8 row_mask:0xf bank_mask:0xf
    v_add_f32_dpp v31, v31, v31 row_ror:8 row_mask:0xf bank_mask:0xf
    v_cmp_u_f32 vcc, v28, v28
    v_cvt_pk_bf16_f32 v28, v28, v29
    v_cvt_pk_bf16_f32 v29, v30, v31
    s_cbranch_vccz M_c0_0_wrb_n
M_c0_0_wrb_e1:
    v_max3_u32 v32, v40, v41, v42
    v_max3_u32 v32, v32, v43, v44
    v_max3_u32 v32, v32, v45, v46
    v_max3_u32 v32, v32, v47, v48
    v_max3_u32 v32, v32, v49, v50
    v_max3_u32 v32, v32, v51, v52
    v_max3_u32 v32, v32, v53, v54
    v_max_u32 v32, v32, v55
    v_cmp_eq_u32 vcc, -1, v32
    s_cbranch_vccnz M_c0_0_wrb_i1
    v_min_u32 v28, -2, v28
    v_min_u32 v29, -2, v29
M_c0_0_wrb_n:
    s_mov_b64 exec, s[38:39]
    buffer_store_dwordx2 v[28:29], v11, s[8:11], s58 offen
    s_branch M_c0_0_wrb_d
M_c0_1_layer:
    s_lshr_b32 s27, s44, 6
    s_mul_i32 s50, s27, 33554432
    s_lshl_b32 s27, s22, 13
    s_add_u32 s50, s50, s27
    s_add_u32 s50, s50, 37748736
    s_barrier
    s_mov_b32 s26, 0x10010000
    s_mov_b32 s3, s26
    s_mul_i32 s27, s20, 5120
    s_add_u32 s48, s27, 167772160
    s_sub_u32 s49, 167777280, s27
    s_and_b32 s55, s44, 3
    s_mul_i32 s55, s55, 167936
    s_add_u32 s55, s55, s34
    s_add_u32 s58, s55, s35
    s_and_b32 s57, s44, 63
    s_add_u32 s43, s55, s32
    s_sub_u32 s27, s57, 1
    s_max_i32 s27, s27, 0
    s_lshl_b64 s[100:101], 1, s27
    s_lshl_b32 s27, s27, 7
    s_sub_u32 s61, s52, s27
    ds_read_b128 v[56:59], v5 offset:0
    ds_read_b128 v[60:63], v5 offset:1024
    ds_read_b128 v[64:67], v5 offset:2048
    ds_read_b128 v[68:71], v5 offset:3072
    v_mov_b64 v[12:13], 0
    v_mov_b64 v[14:15], 0
    v_mov_b64 v[16:17], 0
    v_mov_b64 v[18:19], 0
    v_mov_b64 v[20:21], 0
    v_mov_b64 v[22:23], 0
    v_mov_b64 v[24:25], 0
    v_mov_b64 v[26:27], 0
    v_mov_b64 v[28:29], 0
    v_mov_b64 v[30:31], 0
    v_mov_b64 v[32:33], 0
    v_mov_b64 v[34:35], 0
    s_mov_b32 s70, 0
    s_waitcnt lgkmcnt(0)
M_c0_1_top:
    s_nop 0
    s_barrier
    ds_read_b128 v[36:39], v6 offset:13312
    ds_read_b128 v[40:43], v6 offset:14336
    s_mov_b32 m0, 8192
    s_nop 0
    buffer_load_dwordx4 v0, s[8:11], s49 offen offset:2048 sc1 lds
M_c0_1_lr_r:
    s_waitcnt lgkmcnt(1)
    v_smfmac_f32_16x16x64_bf16 v[20:23], v[36:39], v[56:63], v1
    ds_read_b128 v[56:59], v5 offset:4096
    v_smfmac_f32_16x16x64_bf16 v[24:27], v[36:39], v[64:71], v1
    ds_read_b128 v[60:63], v5 offset:5120
    v_smfmac_f32_16x16x64_bf16 v[28:31], v[36:39], a[248:255], v1
    ds_read_b128 v[64:67], v5 offset:6144
    v_smfmac_f32_16x16x64_bf16 v[32:35], v[36:39], a[240:247], v1
    ds_read_b128 v[68:71], v5 offset:7168
    v_smfmac_f32_16x16x64_bf16 v[12:15], v[36:39], a[232:239], v1
    ds_read_b128 v[44:47], v6 offset:15360
    s_waitcnt lgkmcnt(3)
    v_smfmac_f32_16x16x64_bf16 v[16:19], v[36:39], v[56:63], v1
    ds_read_b128 v[56:59], v5 offset:8192
    v_smfmac_f32_16x16x64_bf16 v[20:23], v[40:43], a[224:231], v1
    ds_read_b128 v[60:63], v5 offset:9216
    s_waitcnt lgkmcnt(3)
    v_smfmac_f32_16x16x64_bf16 v[24:27], v[40:43], v[64:71], v1
    ds_read_b128 v[64:67], v5 offset:10240
    v_smfmac_f32_16x16x64_bf16 v[28:31], v[40:43], a[216:223], v1
    ds_read_b128 v[68:71], v5 offset:11264
    v_smfmac_f32_16x16x64_bf16 v[32:35], v[40:43], a[208:215], v1
    ds_read_b128 v[48:51], v6 offset:16384
    s_waitcnt lgkmcnt(3)
    v_smfmac_f32_16x16x64_bf16 v[12:15], v[40:43], v[56:63], v1
    ds_read_b128 v[56:59], v5 offset:12288
    v_smfmac_f32_16x16x64_bf16 v[16:19], v[40:43], a[200:207], v1
    ds_read_b128 v[60:63], v5 offset:13312
    s_waitcnt lgkmcnt(3)
    v_smfmac_f32_16x16x64_bf16 v[20:23], v[44:47], v[64:71], v1
    ds_read_b128 v[64:67], v5 offset:14336
    v_smfmac_f32_16x16x64_bf16 v[24:27], v[44:47], a[192:199], v1
    ds_read_b128 v[68:71], v5 offset:15360
    v_smfmac_f32_16x16x64_bf16 v[28:31], v[44:47], a[184:191], v1
    ds_read_b128 v[52:55], v6 offset:17408
    s_waitcnt lgkmcnt(3)
    v_smfmac_f32_16x16x64_bf16 v[32:35], v[44:47], v[56:63], v1
    ds_read_b128 v[56:59], v5 offset:16384
    v_smfmac_f32_16x16x64_bf16 v[20:23], v[48:51], a[176:183], v1
    ds_read_b128 v[60:63], v5 offset:17408
    s_waitcnt lgkmcnt(3)
    v_max3_u32 v10, v36, v40, v44
    v_smfmac_f32_16x16x64_bf16 v[24:27], v[48:51], v[64:71], v1
    ds_read_b128 v[64:67], v5 offset:18432
    s_waitcnt lgkmcnt(3)
    v_max3_u32 v10, v10, v48, v52
    v_smfmac_f32_16x16x64_bf16 v[28:31], v[48:51], a[168:175], v1
    ds_read_b128 v[68:71], v5 offset:19456
    v_cmp_eq_u32 vcc, -1, v10
    v_smfmac_f32_16x16x64_bf16 v[32:35], v[48:51], a[160:167], v1
    s_cbranch_vccnz M_c0_1_lr
    s_waitcnt vmcnt(0)
    s_barrier
    ds_read_b128 v[36:39], v6 offset:8192
    ds_read_b128 v[40:43], v6 offset:9216
    s_waitcnt lgkmcnt(4)
    v_smfmac_f32_16x16x64_bf16 v[20:23], v[52:55], v[56:63], v1
    ds_read_b128 v[44:47], v6 offset:10240
    ds_read_b128 v[48:51], v6 offset:11264
    v_smfmac_f32_16x16x64_bf16 v[24:27], v[52:55], a[152:159], v1
    ds_read_b32 v11, v6 offset:12288
    ds_read_b128 v[56:59], v5 offset:20480
    s_waitcnt lgkmcnt(6)
    v_smfmac_f32_16x16x64_bf16 v[28:31], v[52:55], v[64:71], v1
    ds_read_b128 v[60:63], v5 offset:21504
    s_waitcnt lgkmcnt(4)
    v_max3_u32 v10, v36, v40, v44
    v_smfmac_f32_16x16x64_bf16 v[32:35], v[52:55], a[144:151], v1
    s_waitcnt lgkmcnt(2)
    v_max3_u32 v10, v10, v48, v11
    v_cmp_eq_u32 vcc, -1, v10
    s_cbranch_vccnz M_c0_1_rr
M_c0_1_rr_r:
    s_mov_b32 m0, 23296
    ds_read_b128 v[64:67], v5 offset:22528
    ds_read_b128 v[68:71], v5 offset:23552
    ds_read_b128 v[52:55], v6 offset:12288
    buffer_store_dwordx4 v[76:79], v0, s[8:11], s4 offen offset:1024 sc1
    s_mov_b32 s4, 0x10000000
    s_mov_b64 exec, 3
    buffer_load_dword v9, s[8:11], s51 offen sc1 lds
    s_mov_b64 exec, s[100:101]
    buffer_store_dword v9, v9, s[8:11], s61 offen sc1
    s_mov_b64 exec, -1
    v_smfmac_f32_16x16x64_bf16 v[20:23], v[36:39], a[136:143], v1
    s_waitcnt lgkmcnt(3)
    v_smfmac_f32_16x16x64_bf16 v[24:27], v[36:39], v[56:63], v1
    ds_read_b128 v[56:59], v5 offset:24576
    v_smfmac_f32_16x16x64_bf16 v[20:23], v[40:43], a[128:135], v1
    ds_read_b128 v[60:63], v5 offset:25600
    s_waitcnt lgkmcnt(3)
    v_smfmac_f32_16x16x64_bf16 v[24:27], v[40:43], v[64:71], v1
    ds_read_b128 v[64:67], v5 offset:26624
    v_smfmac_f32_16x16x64_bf16 v[20:23], v[44:47], a[120:127], v1
    ds_read_b128 v[68:71], v5 offset:27648
    v_smfmac_f32_16x16x64_bf16 v[24:27], v[44:47], a[112:119], v1
    s_waitcnt lgkmcnt(2)
    v_smfmac_f32_16x16x64_bf16 v[20:23], v[48:51], v[56:63], v1
    ds_read_b128 v[56:59], v5 offset:28672
    v_smfmac_f32_16x16x64_bf16 v[24:27], v[48:51], a[104:111], v1
    ds_read_b128 v[60:63], v5 offset:29696
    s_waitcnt lgkmcnt(2)
    v_smfmac_f32_16x16x64_bf16 v[20:23], v[52:55], v[64:71], v1
    ds_read_b128 v[64:67], v5 offset:30720
    v_smfmac_f32_16x16x64_bf16 v[24:27], v[52:55], a[96:103], v1
    ds_read_b128 v[68:71], v5 offset:31744
    v_smfmac_f32_16x16x64_bf16 v[28:31], v[36:39], a[88:95], v1
    s_cmp_eq_u32 s57, 0
    s_cbranch_scc1 M_c0_1_first
M_c0_1_first_r:
    s_waitcnt lgkmcnt(2)
    v_smfmac_f32_16x16x64_bf16 v[32:35], v[36:39], v[56:63], v1
    ds_read_b128 v[56:59], v5 offset:32768
    v_permlane32_swap_b32 v20, v21
    v_smfmac_f32_16x16x64_bf16 v[28:31], v[40:43], a[80:87], v1
    ds_read_b128 v[60:63], v5 offset:33792
    s_waitcnt lgkmcnt(2)
    v_permlane32_swap_b32 v22, v23
    v_smfmac_f32_16x16x64_bf16 v[32:35], v[40:43], v[64:71], v1
    ds_read_b128 v[64:67], v0 offset:2048
    v_permlane32_swap_b32 v24, v25
    v_smfmac_f32_16x16x64_bf16 v[28:31], v[44:47], a[72:79], v1
    ds_read_b128 v[68:71], v0 offset:3072
    v_permlane32_swap_b32 v26, v27
    v_smfmac_f32_16x16x64_bf16 v[32:35], v[44:47], a[64:71], v1
    s_waitcnt lgkmcnt(2)
    v_add_f32 v20, v20, v21
    v_add_f32 v22, v22, v23
    v_smfmac_f32_16x16x64_bf16 v[28:31], v[48:51], v[56:63], v1
    ds_read_b128 v[56:59], v0 offset:0
    v_add_f32 v24, v24, v25
    v_add_f32 v26, v26, v27
    v_smfmac_f32_16x16x64_bf16 v[32:35], v[48:51], a[56:63], v1
    ds_read_b128 v[60:63], v0 offset:1024
    v_mul_f32 v20, s40, v20
    v_mul_f32 v24, s40, v24
    v_smfmac_f32_16x16x64_bf16 v[28:31], v[52:55], a[48:55], v1
    v_mul_f32 v22, s40, v22
    v_mul_f32 v26, s40, v26
    v_smfmac_f32_16x16x64_bf16 v[32:35], v[52:55], a[40:47], v1
    v_cvt_pk_bf16_f32 v20, v20, v24
    v_cvt_pk_bf16_f32 v21, v22, v26
    v_smfmac_f32_16x16x64_bf16 v[12:15], v[36:39], a[32:39], v1
    ds_write_b32 v2, v20 offset:18432
    v_smfmac_f32_16x16x64_bf16 v[16:19], v[36:39], a[24:31], v1
    ds_write_b32 v2, v21 offset:19008
    v_permlane32_swap_b32 v28, v29
    v_smfmac_f32_16x16x64_bf16 v[12:15], v[40:43], a[16:23], v1
    ds_read_b128 v[36:39], v6 offset:15360
    v_permlane32_swap_b32 v30, v31
    v_smfmac_f32_16x16x64_bf16 v[16:19], v[40:43], a[8:15], v1
    ds_read_b128 v[40:43], v6 offset:16384
    v_permlane32_swap_b32 v32, v33
    v_smfmac_f32_16x16x64_bf16 v[12:15], v[44:47], a[0:7], v1
    s_waitcnt lgkmcnt(2)
    s_barrier
    v_permlane32_swap_b32 v34, v35
    v_smfmac_f32_16x16x64_bf16 v[16:19], v[44:47], v[248:255], v1
    ds_read_b128 v[20:23], v3 offset:18432
    v_add_f32 v28, v28, v29
    v_add_f32 v30, v30, v31
    v_smfmac_f32_16x16x64_bf16 v[12:15], v[48:51], v[240:247], v1
    ds_read_b128 v[24:27], v3 offset:18496
    v_add_f32 v32, v32, v33
    v_add_f32 v34, v34, v35
    v_smfmac_f32_16x16x64_bf16 v[16:19], v[48:51], v[232:239], v1
    ds_read_b128 v[72:75], v3 offset:18560
    v_cvt_pk_bf16_f32 v28, v28, v32
    v_cvt_pk_bf16_f32 v29, v30, v34
    v_smfmac_f32_16x16x64_bf16 v[12:15], v[52:55], v[224:231], v1
    ds_write_b32 v2, v28 offset:20736
    ds_read_b128 v[44:47], v3 offset:18624
    v_smfmac_f32_16x16x64_bf16 v[16:19], v[52:55], v[216:223], v1
    ds_write_b32 v2, v29 offset:21312
    s_waitcnt lgkmcnt(7)
    v_smfmac_f32_16x16x64_bf16 v[12:15], v[36:39], v[208:215], v1
    ds_read_b128 v[48:51], v6 offset:17408
    v_mov_b64 v[10:11], s[16:17]
    v_smfmac_f32_16x16x64_bf16 v[16:19], v[36:39], v[200:207], v1
    s_waitcnt lgkmcnt(6)
    v_mfma_f32_16x16x32_bf16 v[28:31], v[56:59], v[20:23], 0
    ds_read_b128 v[56:59], v0 offset:4096
    s_waitcnt lgkmcnt(6)
    v_mfma_f32_16x16x32_bf16 v[28:31], v[60:63], v[24:27], v[28:31]
    ds_read_b128 v[60:63], v0 offset:5120
    s_waitcnt lgkmcnt(3)
    s_barrier
    v_mfma_f32_16x16x32_bf16 v[28:31], v[64:67], v[72:75], v[28:31]
    ds_read_b128 v[64:67], v0 offset:6144
    v_mfma_f32_16x16x32_bf16 v[28:31], v[68:71], v[44:47], v[28:31]
    ds_read_b128 v[68:71], v0 offset:7168
    v_smfmac_f32_16x16x64_bf16 v[12:15], v[40:43], v[192:199], v1
    ds_read_b128 v[36:39], v3 offset:20736
    v_smfmac_f32_16x16x64_bf16 v[16:19], v[40:43], v[184:191], v1
    ds_read_b128 v[52:55], v3 offset:20800
    s_waitcnt lgkmcnt(4)
    v_mfma_f32_16x16x32_bf16 v[32:35], v[56:59], v[20:23], 0
    s_nop 0
    v_exp_f32 v28, v28
    ds_read_b128 v[56:59], v3 offset:20864
    v_mfma_f32_16x16x32_bf16 v[32:35], v[60:63], v[24:27], v[32:35]
    s_waitcnt lgkmcnt(3)
    v_exp_f32 v29, v29
    ds_read_b128 v[60:63], v3 offset:20928
    v_mfma_f32_16x16x32_bf16 v[32:35], v[64:67], v[72:75], v[32:35]
    v_exp_f32 v30, v30
    v_mfma_f32_16x16x32_bf16 v[32:35], v[68:71], v[44:47], v[32:35]
    s_waitcnt lgkmcnt(3)
    v_exp_f32 v31, v31
    v_mfma_f32_16x16x32_bf16 v[40:43], v[36:39], v[20:23], 0
    s_waitcnt lgkmcnt(2)
    v_cvt_pk_bf16_f32 v28, v28, v29
    v_cvt_pk_bf16_f32 v29, v30, v31
    v_mfma_f32_16x16x32_bf16 v[40:43], v[52:55], v[24:27], v[40:43]
    s_waitcnt lgkmcnt(1)
    v_mov_b64 v[64:65], s[24:25]
    v_mov_b64 v[66:67], s[24:25]
    v_mfma_f32_16x16x32_bf16 v[40:43], v[56:59], v[72:75], v[40:43]
    s_waitcnt lgkmcnt(0)
    v_exp_f32 v32, v32
    v_mfma_f32_16x16x32_bf16 v[40:43], v[60:63], v[44:47], v[40:43]
    v_exp_f32 v33, v33
    v_smfmac_f32_16x16x64_bf16 v[12:15], v[48:51], v[176:183], v1
    v_exp_f32 v34, v34
    v_smfmac_f32_16x16x64_bf16 v[16:19], v[48:51], v[168:175], v1
    v_exp_f32 v35, v35
    v_cvt_pk_bf16_f32 v30, v32, v33
    v_cvt_pk_bf16_f32 v31, v34, v35
    s_nop 0
    v_exp_f32 v40, v40
    v_mfma_f32_16x16x32_bf16 v[72:75], v[64:67], v[28:31], 0
    v_exp_f32 v41, v41
    v_mfma_f32_16x16x32_bf16 v[20:23], v[80:83], v[28:31], 0
    v_exp_f32 v42, v42
    v_mfma_f32_16x16x32_bf16 v[24:27], v[84:87], v[28:31], 0
    v_exp_f32 v43, v43
    v_cvt_pk_bf16_f32 v40, v40, v41
    v_cvt_pk_bf16_f32 v41, v42, v43
    v_cvt_pk_bf16_f32 v12, v12, v13
    v_cvt_pk_bf16_f32 v13, v14, v15
    v_mfma_f32_16x16x16_bf16 v[72:75], v[10:11], v[40:41], v[72:75]
    v_cvt_pk_bf16_f32 v14, v16, v17
    v_cvt_pk_bf16_f32 v15, v18, v19
M_c0_1_fin:
    v_mfma_f32_16x16x16_bf16 v[20:23], v[12:13], v[40:41], v[20:23]
    s_cmp_eq_u32 s57, 63
    v_cndmask_b32_e64 v76, v12, v52, s[66:67]
    v_cndmask_b32_e64 v77, v13, v53, s[66:67]
    v_mfma_f32_16x16x16_bf16 v[24:27], v[14:15], v[40:41], v[24:27]
    v_cndmask_b32_e64 v78, v14, v54, s[66:67]
    v_cndmask_b32_e64 v79, v15, v55, s[66:67]
    s_cbranch_scc1 M_c0_1_last
    v_rcp_f32 v74, v72
    v_subrev_u32 v73, s68, v72
    v_cmp_lt_u32 vcc, s69, v73
    v_mov_b64 v[44:45], 0
    v_mov_b64 v[46:47], 0
    v_cndmask_b32_e64 v20, v20, v24, s[18:19]
    v_cndmask_b32_e64 v21, v21, v25, s[18:19]
    v_cndmask_b32_e64 v22, v22, v26, s[18:19]
    v_cndmask_b32_e64 v23, v23, v27, s[18:19]
    v_pk_mul_f32 v[20:21], v[20:21], v[74:75] op_sel_hi:[1,0]
    v_pk_mul_f32 v[22:23], v[22:23], v[74:75] op_sel_hi:[1,0]
    v_cvt_pk_bf16_f32 v20, v20, v21
    v_cvt_pk_bf16_f32 v21, v22, v23
    ds_write_b64 v0, v[20:21] offset:13320
    s_cbranch_vccnz M_c0_1_zbad
M_c0_1_zok:
    s_cmp_eq_u32 s57, 0
    s_cbranch_scc1 M_c0_1_first2
M_c0_1_first2_r:
    buffer_load_dwordx4 v[80:83], v0, s[8:11], s3 offen offset:0 sc1
    buffer_load_dwordx4 v[84:87], v0, s[8:11], s3 offen offset:1024 sc1
    s_waitcnt lgkmcnt(0)
    s_barrier
    ds_read_b128 v[32:35], v0 offset:13312
    ds_read_b128 v[52:55], v0 offset:14336
    s_mov_b32 m0, 2048
    s_nop 0
    buffer_load_dwordx4 v0, s[8:11], s26 offen offset:0 sc1 lds
    buffer_load_dwordx4 v0, s[8:11], s26 offen offset:1024 sc1 lds
    v_mov_b64 v[68:69], 0
    v_mov_b64 v[70:71], 0
    v_mov_b64 v[64:65], 0
    v_mov_b64 v[66:67], 0
    v_mov_b64 v[60:61], 0
    v_mov_b64 v[62:63], 0
    v_mov_b64 v[56:57], 0
    v_mov_b64 v[58:59], 0
    s_waitcnt lgkmcnt(1)
    s_nop 0
    v_smfmac_f32_16x16x64_bf16 v[56:59], v[32:35], v[160:167], v1
    v_smfmac_f32_16x16x64_bf16 v[60:63], v[32:35], v[144:151], v1
    s_waitcnt lgkmcnt(0)
    v_smfmac_f32_16x16x64_bf16 v[56:59], v[52:55], v[152:159], v1
    v_smfmac_f32_16x16x64_bf16 v[60:63], v[52:55], v[136:143], v1
    v_smfmac_f32_16x16x64_bf16 v[64:67], v[32:35], v[128:135], v1
    v_smfmac_f32_16x16x64_bf16 v[68:71], v[32:35], v[112:119], v1
    v_permlane32_swap_b32 v56, v57
    v_smfmac_f32_16x16x64_bf16 v[64:67], v[52:55], v[120:127], v1
    v_permlane32_swap_b32 v58, v59
    v_smfmac_f32_16x16x64_bf16 v[68:71], v[52:55], v[104:111], v1
    v_add_f32 v56, v56, v57
    v_add_f32 v58, v58, v59
    v_smfmac_f32_16x16x64_bf16 v[44:47], v[32:35], v[96:103], v1
    v_permlane32_swap_b32 v60, v61
    v_smfmac_f32_16x16x64_bf16 v[44:47], v[52:55], v[88:95], v1
    v_permlane32_swap_b32 v62, v63
    v_add_f32 v60, v60, v61
    v_add_f32 v62, v62, v63
    v_cvt_pk_bf16_f32 v36, v56, v60
    v_cvt_pk_bf16_f32 v38, v58, v62
    v_permlane32_swap_b32 v64, v65
    v_permlane32_swap_b32 v66, v67
    v_add_f32 v64, v64, v65
    v_add_f32 v66, v66, v67
    v_permlane32_swap_b32 v68, v69
    v_permlane32_swap_b32 v70, v71
    v_add_f32 v68, v68, v69
    v_add_f32 v70, v70, v71
    v_cvt_pk_bf16_f32 v37, v64, v68
    v_cvt_pk_bf16_f32 v39, v66, v70
    buffer_store_dwordx4 v[36:39], v0, s[8:11], s58 offen
    v_permlane32_swap_b32 v44, v45
    v_permlane32_swap_b32 v46, v47
    v_add_f32 v44, v44, v45
    v_add_f32 v46, v46, v47
    v_cvt_pk_bf16_f32 v44, v44, v46
    buffer_store_dword v44, v7, s[8:11], s55 offen
    v_bfe_u32 v34, v0, 4, 1
    v_bfe_u32 v33, v0, 7, 1
    v_lshl_add_u32 v33, v33, 1, v34
    v_bfe_u32 v32, v0, 6, 1
    v_lshlrev_b32 v32, 4, v32
    v_lshlrev_b32_e64 v32, v32, s45
    v_cmp_eq_u32_e64 s[64:65], 0, v33
    v_cmp_eq_u32_e64 vcc, 1, v33
    s_add_u32 s27, s44, 1
    s_and_b32 s27, s27, 3
    v_cndmask_b32_e64 v72, 0, v32, s[64:65]
    v_cndmask_b32_e64 v73, 0, v32, vcc
    v_cmp_eq_u32_e64 s[64:65], 2, v33
    v_cmp_eq_u32_e64 vcc, 3, v33
    s_mul_i32 s48, s27, 5120
    s_add_u32 s48, s48, s41
    v_cndmask_b32_e64 v74, 0, v32, s[64:65]
    v_cndmask_b32_e64 v75, 0, v32, vcc
    s_lshl_b32 s27, s27, 15
    s_add_u32 s49, s27, s47
    v_bfe_u32 v32, v0, 8, 1
    v_lshlrev_b32 v11, 6, v32
    v_lshl_add_u32 v11, v34, 3, v11
    v_lshrrev_b32 v33, 9, v0
    v_lshl_add_u32 v11, v33, 2, v11
    s_add_u32 s56, s27, s46
    s_add_u32 s56, s56, s33
    s_add_u32 s58, s48, s33
    v_mov_b32 v5, v5
    s_nop 1
    v_mov_b32 v5, v5
    s_nop 1
    v_mov_b32 v5, v5
    s_nop 1
    v_mov_b32 v5, v5
    s_nop 1
    v_mov_b32 v5, v5
    s_nop 1
    v_mov_b32 v5, v5
    s_nop 1
    v_mov_b32 v5, v5
    s_nop 1
    v_mov_b32 v5, v5
    s_nop 1
    buffer_load_dwordx4 v[12:15], v0, s[8:11], s43 offen sc1
    v_mov_b32 v5, v5
    s_nop 1
    v_mov_b32 v5, v5
    s_nop 1
    v_mov_b32 v5, v5
    s_nop 1
    v_mov_b32 v5, v5
    s_nop 1
    v_mov_b32 v5, v5
    s_nop 1
    v_mov_b32 v5, v5
    s_nop 1
    v_mov_b32 v5, v5
    s_nop 1
    v_mov_b32 v5, v5
    s_nop 1
    v_mov_b32 v5, v5
    s_nop 1
    v_mov_b32 v5, v5
    s_nop 1
    v_mov_b32 v5, v5
    s_nop 1
    v_mov_b32 v5, v5
    s_nop 1
    v_mov_b32 v5, v5
    v_mov_b32 v5, v5
    buffer_load_dwordx4 v[16:19], v0, s[8:11], s43 offen sc1
    v_mov_b32 v5, v5
    s_nop 1
    v_mov_b32 v5, v5
    s_nop 1
    v_mov_b32 v5, v5
    v_mov_b32 v5, v5
    s_waitcnt vmcnt(1)
    v_mfma_f32_16x16x32_bf16 v[28:31], v[72:75], v[12:15], 0
    v_cmp_eq_u32 vcc, -1, v12
    s_cbranch_vccnz M_c0_1_wq1
    v_mov_b32 v5, v5
    v_mov_b32 v5, v5
    v_mov_b32 v5, v5
    v_mov_b32 v5, v5
    v_mov_b32 v5, v5
    v_mov_b32 v5, v5
    v_add_f32_dpp v28, v28, v28 row_ror:8 row_mask:0xf bank_mask:0xf
    v_add_f32_dpp v29, v29, v29 row_ror:8 row_mask:0xf bank_mask:0xf
    s_nop 0
    v_add_f32_dpp v28, v28, v28 row_ror:4 row_mask:0xf bank_mask:0xf
    v_add_f32_dpp v29, v29, v29 row_ror:4 row_mask:0xf bank_mask:0xf
    s_nop 0
    v_add_f32_dpp v28, v28, v28 row_ror:2 row_mask:0xf bank_mask:0xf
    v_add_f32_dpp v29, v29, v29 row_ror:2 row_mask:0xf bank_mask:0xf
    v_cmp_u_f32 vcc, v28, v28
    v_cvt_pk_bf16_f32 v28, v28, v29
    s_cbranch_vccnz M_c0_1_wrb_e0
    s_mov_b64 exec, s[62:63]
    buffer_store_dword v28, v11, s[8:11], s58 offen
M_c0_1_wrb_d:
    s_barrier
    buffer_store_dword v28, v11, s[8:11], s56 offen sc1
M_c0_1_wrb_g:
    s_mov_b64 exec, -1
    s_waitcnt vmcnt(2)
    ds_read_b128 v[56:59], v5 offset:0
    ds_read_b128 v[60:63], v5 offset:1024
    ds_read_b128 v[64:67], v5 offset:2048
    ds_read_b128 v[68:71], v5 offset:3072
    v_mov_b64 v[12:13], 0
    v_mov_b64 v[14:15], 0
    v_mov_b64 v[16:17], 0
    v_mov_b64 v[18:19], 0
    v_mov_b64 v[20:21], 0
    v_mov_b64 v[22:23], 0
    v_mov_b64 v[24:25], 0
    v_mov_b64 v[26:27], 0
    v_mov_b64 v[28:29], 0
    v_mov_b64 v[30:31], 0
    v_mov_b64 v[32:33], 0
    v_mov_b64 v[34:35], 0
    s_and_b32 s26, s44, 63
    s_add_u32 s26, s26, 2
    s_min_u32 s26, s26, 63
    s_lshl_b32 s26, s26, 18
    s_add_u32 s26, s26, s50
    s_add_u32 s26, s26, 2048
    s_add_u32 s3, s26, 16777216
    s_lshl_b32 s4, s44, 18
    s_add_u32 s4, s4, s53
    v_mov_b64 v[72:73], -1
    v_mov_b64 v[74:75], -1
    s_add_u32 s28, s44, 3
    s_and_b32 s29, s28, 3
    s_mul_i32 s31, s22, 160
    s_mul_i32 s28, s29, 167936
    s_add_u32 s28, s28, s34
    s_add_u32 s64, s28, s35
    s_lshl_b32 s65, s22, 10
    s_add_u32 s65, s65, s28
    s_add_u32 s65, s65, 135168
    s_add_u32 s44, s44, 1
    s_and_b32 s55, s44, 3
    s_mul_i32 s55, s55, 167936
    s_add_u32 s55, s55, s34
    s_add_u32 s58, s55, s35
    s_and_b32 s57, s44, 63
    s_add_u32 s43, s55, s32
    s_sub_u32 s27, s57, 1
    s_max_i32 s27, s27, 0
    s_lshl_b64 s[100:101], 1, s27
    s_lshl_b32 s27, s27, 7
    s_sub_u32 s61, s52, s27
    s_nop 15
    s_nop 15
    s_nop 12
    buffer_store_dwordx4 v[72:75], v0, s[8:11], s64 offen offset:1024
    buffer_store_dwordx4 v[72:75], v0, s[8:11], s64 offen offset:2048
    buffer_store_dwordx4 v[72:75], v0, s[8:11], s65 offen
    s_mov_b32 s65, 0x10000000
    s_mov_b32 s64, 0x10000000
    s_mov_b32 s70, 0
    s_waitcnt lgkmcnt(0)
    s_branch M_c0_1_top
M_c0_1_restart:
    s_waitcnt vmcnt(0) lgkmcnt(0)
    s_nop 7
    s_barrier
    ds_read_b128 v[56:59], v5 offset:0
    ds_read_b128 v[60:63], v5 offset:1024
    ds_read_b128 v[64:67], v5 offset:2048
    ds_read_b128 v[68:71], v5 offset:3072
    v_mov_b64 v[12:13], 0
    v_mov_b64 v[14:15], 0
    v_mov_b64 v[16:17], 0
    v_mov_b64 v[18:19], 0
    v_mov_b64 v[20:21], 0
    v_mov_b64 v[22:23], 0
    v_mov_b64 v[24:25], 0
    v_mov_b64 v[26:27], 0
    v_mov_b64 v[28:29], 0
    v_mov_b64 v[30:31], 0
    v_mov_b64 v[32:33], 0
    v_mov_b64 v[34:35], 0
    s_waitcnt vmcnt(0) lgkmcnt(0)
    s_branch M_c0_1_top
M_c0_1_zbad:
    s_cmp_eq_u32 s70, 2
    s_cbranch_scc1 M_c0_1_zok
    v_cmp_u_f32 vcc, v72, v72
    s_cbranch_vccz M_c0_1_exact
    s_cmp_eq_u32 s70, 1
    s_cbranch_scc1 M_c0_1_exact
M_c0_1_vfy0:
    s_mov_b32 s70, 1
    s_mov_b32 s30, 0
    s_waitcnt vmcnt(0) lgkmcnt(0)
    s_nop 7
M_c0_1_vfy:
    v_mov_b32 v10, 0
    s_add_u32 s59, s48, 4096
    buffer_load_dwordx4 v[36:39], v0, s[8:11], s48 offen offset:0 sc1
    buffer_load_dwordx4 v[40:43], v0, s[8:11], s48 offen offset:1024 sc1
    buffer_load_dwordx4 v[44:47], v0, s[8:11], s48 offen offset:2048 sc1
    buffer_load_dwordx4 v[48:51], v0, s[8:11], s48 offen offset:3072 sc1
    buffer_load_dwordx4 v[52:55], v0, s[8:11], s59 offen offset:0 sc1
    s_waitcnt vmcnt(4)
    v_max3_u32 v10, v10, v36, v37
    v_max3_u32 v10, v10, v38, v39
    s_waitcnt vmcnt(3)
    v_max3_u32 v10, v10, v40, v41
    v_max3_u32 v10, v10, v42, v43
    s_waitcnt vmcnt(2)
    v_max3_u32 v10, v10, v44, v45
    v_max3_u32 v10, v10, v46, v47
    s_waitcnt vmcnt(1)
    v_max3_u32 v10, v10, v48, v49
    v_max3_u32 v10, v10, v50, v51
    s_waitcnt vmcnt(0)
    v_max3_u32 v10, v10, v52, v53
    v_max3_u32 v10, v10, v54, v55
    s_add_u32 s59, s49, 4096
    buffer_load_dwordx4 v[36:39], v0, s[8:11], s49 offen offset:0 sc1
    buffer_load_dwordx4 v[40:43], v0, s[8:11], s49 offen offset:1024 sc1
    buffer_load_dwordx4 v[44:47], v0, s[8:11], s49 offen offset:2048 sc1
    buffer_load_dwordx4 v[48:51], v0, s[8:11], s49 offen offset:3072 sc1
    buffer_load_dwordx4 v[52:55], v0, s[8:11], s59 offen offset:0 sc1
    s_waitcnt vmcnt(4)
    v_max3_u32 v10, v10, v36, v37
    v_max3_u32 v10, v10, v38, v39
    s_waitcnt vmcnt(3)
    v_max3_u32 v10, v10, v40, v41
    v_max3_u32 v10, v10, v42, v43
    s_waitcnt vmcnt(2)
    v_max3_u32 v10, v10, v44, v45
    v_max3_u32 v10, v10, v46, v47
    s_waitcnt vmcnt(1)
    v_max3_u32 v10, v10, v48, v49
    v_max3_u32 v10, v10, v50, v51
    s_waitcnt vmcnt(0)
    v_max3_u32 v10, v10, v52, v53
    v_max3_u32 v10, v10, v54, v55
    v_cmp_eq_u32 vcc, -1, v10
    s_cbranch_vccz M_c0_1_restart
    s_add_u32 s30, s30, 1
    s_cmp_ge_u32 s30, 60000
    s_cbranch_scc1 M_fail
    s_branch M_c0_1_vfy
M_c0_1_exact:
    s_nop 7
    s_mov_b32 s70, 2
    s_waitcnt lgkmcnt(0)
    ds_read_b128 v[20:23], v3 offset:18432
    ds_read_b128 v[24:27], v3 offset:18496
    ds_read_b128 v[72:75], v3 offset:18560
    ds_read_b128 v[44:47], v3 offset:18624
    ds_read_b128 v[56:59], v0 offset:0
    s_waitcnt lgkmcnt(0)
    v_mfma_f32_16x16x32_bf16 v[28:31], v[56:59], v[20:23], 0
    s_nop 3
    ds_read_b128 v[60:63], v0 offset:1024
    s_waitcnt lgkmcnt(0)
    v_mfma_f32_16x16x32_bf16 v[28:31], v[60:63], v[24:27], v[28:31]
    s_nop 3
    ds_read_b128 v[56:59], v0 offset:2048
    s_waitcnt lgkmcnt(0)
    v_mfma_f32_16x16x32_bf16 v[28:31], v[56:59], v[72:75], v[28:31]
    s_nop 3
    ds_read_b128 v[60:63], v0 offset:3072
    s_waitcnt lgkmcnt(0)
    v_mfma_f32_16x16x32_bf16 v[28:31], v[60:63], v[44:47], v[28:31]
    s_nop 3
    ds_read_b128 v[56:59], v0 offset:4096
    s_waitcnt lgkmcnt(0)
    v_mfma_f32_16x16x32_bf16 v[32:35], v[56:59], v[20:23], 0
    s_nop 3
    ds_read_b128 v[60:63], v0 offset:5120
    s_waitcnt lgkmcnt(0)
    v_mfma_f32_16x16x32_bf16 v[32:35], v[60:63], v[24:27], v[32:35]
    s_nop 3
    ds_read_b128 v[56:59], v0 offset:6144
    s_waitcnt lgkmcnt(0)
    v_mfma_f32_16x16x32_bf16 v[32:35], v[56:59], v[72:75], v[32:35]
    s_nop 3
    ds_read_b128 v[60:63], v0 offset:7168
    s_waitcnt lgkmcnt(0)
    v_mfma_f32_16x16x32_bf16 v[32:35], v[60:63], v[44:47], v[32:35]
    s_nop 3
    ds_read_b128 v[56:59], v3 offset:20736
    s_waitcnt lgkmcnt(0)
    v_mfma_f32_16x16x32_bf16 v[40:43], v[56:59], v[20:23], 0
    s_nop 3
    ds_read_b128 v[60:63], v3 offset:20800
    s_waitcnt lgkmcnt(0)
    v_mfma_f32_16x16x32_bf16 v[40:43], v[60:63], v[24:27], v[40:43]
    s_nop 3
    ds_read_b128 v[56:59], v3 offset:20864
    s_waitcnt lgkmcnt(0)
    v_mfma_f32_16x16x32_bf16 v[40:43], v[56:59], v[72:75], v[40:43]
    s_nop 3
    ds_read_b128 v[60:63], v3 offset:20928
    s_waitcnt lgkmcnt(0)
    v_mfma_f32_16x16x32_bf16 v[40:43], v[60:63], v[44:47], v[40:43]
    s_nop 3
    v_max3_f32 v68, v28, v29, v30
    v_max3_f32 v68, v68, v31, v32
    v_max3_f32 v68, v68, v33, v34
    s_nop 0
    v_max3_f32 v68, v68, v35, v40
    v_max3_f32 v68, v68, v41, v42
    v_max_f32 v68, v68, v43
    v_mov_b32 v69, v68
    s_nop 1
    v_permlane16_swap_b32 v68, v69
    v_max_f32 v68, v68, v69
    v_mov_b32 v69, v68
    s_nop 1
    v_permlane32_swap_b32 v68, v69
    v_max_f32 v68, v68, v69
    v_sub_f32 v28, v28, v68
    v_exp_f32 v28, v28
    v_sub_f32 v29, v29, v68
    v_exp_f32 v29, v29
    v_sub_f32 v30, v30, v68
    v_exp_f32 v30, v30
    v_sub_f32 v31, v31, v68
    v_exp_f32 v31, v31
    v_sub_f32 v32, v32, v68
    v_exp_f32 v32, v32
    v_sub_f32 v33, v33, v68
    v_exp_f32 v33, v33
    v_sub_f32 v34, v34, v68
    v_exp_f32 v34, v34
    v_sub_f32 v35, v35, v68
    v_exp_f32 v35, v35
    v_sub_f32 v40, v40, v68
    v_exp_f32 v40, v40
    v_sub_f32 v41, v41, v68
    v_exp_f32 v41, v41
    v_sub_f32 v42, v42, v68
    v_exp_f32 v42, v42
    v_sub_f32 v43, v43, v68
    v_exp_f32 v43, v43
    v_cvt_pk_bf16_f32 v28, v28, v29
    v_cvt_pk_bf16_f32 v29, v30, v31
    v_cvt_pk_bf16_f32 v30, v32, v33
    v_cvt_pk_bf16_f32 v31, v34, v35
    v_cvt_pk_bf16_f32 v40, v40, v41
    v_cvt_pk_bf16_f32 v41, v42, v43
    v_mfma_f32_16x16x32_bf16 v[20:23], v[80:83], v[28:31], 0
    v_mfma_f32_16x16x32_bf16 v[24:27], v[84:87], v[28:31], 0
    v_mfma_f32_16x16x32_bf16 v[72:75], v[64:67], v[28:31], 0
    ds_read_b128 v[52:55], v3 offset:20800
    s_waitcnt lgkmcnt(0)
    s_nop 7
    v_mfma_f32_16x16x16_bf16 v[72:75], v[10:11], v[40:41], v[72:75]
    s_nop 7
    s_branch M_c0_1_fin
M_c0_1_last:
    s_cmp_lg_u32 s70, 0
    s_cbranch_scc1 M_c0_1_last2
    v_cmp_u_f32 vcc, v32, v32
    s_cbranch_vccnz M_c0_1_vfy0
M_c0_1_last2:
    s_lshl_b32 s4, s44, 18
    s_add_u32 s4, s4, s53
    buffer_store_dwordx4 v[76:79], v0, s[8:11], s4 offen offset:1024 sc1
    s_mov_b32 s4, 0x10000000
    s_waitcnt vmcnt(0) lgkmcnt(0)
    s_barrier
    v_mov_b32 v11, 8192
    s_mov_b64 exec, 1
    buffer_store_dword v11, v0, s[8:11], s52 offen sc1
    s_mov_b64 exec, -1
    s_add_u32 s52, s52, 4096
    s_nop 7
    v_mov_b64 v[72:73], -1
    v_mov_b64 v[74:75], -1
    s_add_u32 s28, s44, 3
    s_and_b32 s29, s28, 3
    s_mul_i32 s31, s22, 160
    s_mul_i32 s28, s29, 167936
    s_add_u32 s28, s28, s34
    s_add_u32 s64, s28, s35
    s_lshl_b32 s65, s22, 10
    s_add_u32 s65, s65, s28
    s_add_u32 s65, s65, 135168
    buffer_store_dwordx4 v[72:75], v0, s[8:11], s64 offen offset:1024
    buffer_store_dwordx4 v[72:75], v0, s[8:11], s64 offen offset:2048
    buffer_store_dwordx4 v[72:75], v0, s[8:11], s65 offen
    s_mov_b32 s65, 0x10000000
    s_mov_b32 s64, 0x10000000
    s_waitcnt vmcnt(0)
    s_add_u32 s44, s44, 1
    s_cmp_eq_u32 s44, 128
    s_cbranch_scc1 M_end
    s_branch M_c0_1_layer
M_c0_1_lr:
    s_mov_b32 s30, 0
M_c0_1_lr_l:
    s_waitcnt lgkmcnt(0)
    ds_read_b128 v[36:39], v6 offset:13312
    ds_read_b128 v[40:43], v6 offset:14336
    ds_read_b128 v[44:47], v6 offset:15360
    ds_read_b128 v[48:51], v6 offset:16384
    ds_read_b128 v[52:55], v6 offset:17408
    s_waitcnt lgkmcnt(2)
    v_max3_u32 v10, v36, v40, v44
    s_waitcnt lgkmcnt(0)
    v_max3_u32 v10, v10, v48, v52
    v_cmp_eq_u32 vcc, -1, v10
    s_cbranch_vccz M_c0_1_lr_d
    s_add_u32 s30, s30, 1
    s_cmp_ge_u32 s30, 480000
    s_cbranch_scc1 M_fail
    s_branch M_c0_1_lr_l
M_c0_1_lr_d:
    ds_read_b128 v[56:59], v5 offset:0
    ds_read_b128 v[60:63], v5 offset:1024
    ds_read_b128 v[64:67], v5 offset:2048
    ds_read_b128 v[68:71], v5 offset:3072
    v_mov_b64 v[12:13], 0
    v_mov_b64 v[14:15], 0
    v_mov_b64 v[16:17], 0
    v_mov_b64 v[18:19], 0
    v_mov_b64 v[20:21], 0
    v_mov_b64 v[22:23], 0
    v_mov_b64 v[24:25], 0
    v_mov_b64 v[26:27], 0
    v_mov_b64 v[28:29], 0
    v_mov_b64 v[30:31], 0
    v_mov_b64 v[32:33], 0
    v_mov_b64 v[34:35], 0
    s_waitcnt lgkmcnt(0)
    s_branch M_c0_1_lr_r
M_c0_1_rr:
    s_mov_b32 s30, 0
M_c0_1_rr_l:
    s_waitcnt lgkmcnt(0)
    s_and_b32 s27, s30, 1
    s_cbranch_scc1 M_c0_1_rr_n
    s_waitcnt vmcnt(1)
    s_mov_b32 m0, 8192
    s_nop 0
    buffer_load_dwordx4 v0, s[8:11], s49 offen offset:2048 sc1 lds
M_c0_1_rr_n:
    ds_read_b128 v[36:39], v6 offset:8192
    ds_read_b128 v[40:43], v6 offset:9216
    ds_read_b128 v[44:47], v6 offset:10240
    ds_read_b128 v[48:51], v6 offset:11264
    ds_read_b32 v11, v6 offset:12288
    s_waitcnt lgkmcnt(2)
    v_max3_u32 v10, v36, v40, v44
    s_waitcnt lgkmcnt(0)
    v_max3_u32 v10, v10, v48, v11
    v_cmp_eq_u32 vcc, -1, v10
    s_cbranch_vccz M_c0_1_rr_d
    s_add_u32 s30, s30, 1
    s_cmp_ge_u32 s30, 480000
    s_cbranch_scc1 M_fail
    s_branch M_c0_1_rr_l
M_c0_1_rr_d:
    s_branch M_c0_1_rr_r
M_c0_1_first:
    s_mul_i32 s27, s21, 167936
    s_add_u32 s27, s27, s34
    s_mul_i32 s28, s22, 4224
    s_add_u32 s28, s28, s27
    s_mov_b32 exec_hi, 0
    buffer_load_dword v10, v9, s[8:11], s28 offen sc1
    s_lshl_b32 s28, s22, 10
    s_add_u32 s28, s28, s27
    s_add_u32 s28, s28, 135168
    s_mov_b64 exec, 0xff
    buffer_load_dword v10, v9, s[8:11], s28 offen sc1
    s_mul_i32 s27, s21, 5120
    s_add_u32 s27, s27, s41
    s_mul_i32 s28, s22, 160
    s_add_u32 s28, s28, s27
    s_mov_b64 exec, 3
    buffer_load_dword v10, v9, s[8:11], s28 offen sc1
    s_mov_b64 exec, -1
    s_barrier
    s_and_b32 s26, s44, 63
    s_lshl_b32 s26, s26, 18
    s_add_u32 s26, s26, s50
    s_add_u32 s26, s26, 2048
    s_add_u32 s3, s26, 16777216
    s_mov_b32 m0, 2048
    s_nop 0
    buffer_load_dwordx4 v0, s[8:11], s26 offen offset:0 sc1 lds
    buffer_load_dwordx4 v0, s[8:11], s26 offen offset:1024 sc1 lds
    buffer_load_dwordx4 v[80:83], v0, s[8:11], s3 offen offset:0 sc1
    buffer_load_dwordx4 v[84:87], v0, s[8:11], s3 offen offset:1024 sc1
    s_and_b32 s26, s44, 63
    s_add_u32 s26, s26, 1
    s_min_u32 s26, s26, 63
    s_lshl_b32 s26, s26, 18
    s_add_u32 s26, s26, s50
    s_add_u32 s26, s26, 2048
    s_add_u32 s3, s26, 16777216
    s_waitcnt vmcnt(0) lgkmcnt(0)
    s_barrier
    s_branch M_c0_1_first_r
M_c0_1_first2:
    s_barrier
    s_branch M_c0_1_first2_r
M_c0_1_wq1:
    buffer_load_dwordx4 v[12:15], v0, s[8:11], s43 offen sc1
    s_waitcnt vmcnt(1)
    v_mfma_f32_16x16x32_bf16 v[28:31], v[72:75], v[16:19], 0
    v_cmp_eq_u32 vcc, -1, v16
    s_cbranch_vccnz M_c0_1_wqx
    v_mov_b32 v5, v5
    v_mov_b32 v5, v5
    v_mov_b32 v5, v5
    v_mov_b32 v5, v5
    v_mov_b32 v5, v5
    v_mov_b32 v5, v5
    v_add_f32_dpp v28, v28, v28 row_ror:8 row_mask:0xf bank_mask:0xf
    v_add_f32_dpp v29, v29, v29 row_ror:8 row_mask:0xf bank_mask:0xf
    s_nop 0
    v_add_f32_dpp v28, v28, v28 row_ror:4 row_mask:0xf bank_mask:0xf
    v_add_f32_dpp v29, v29, v29 row_ror:4 row_mask:0xf bank_mask:0xf
    s_nop 0
    v_add_f32_dpp v28, v28, v28 row_ror:2 row_mask:0xf bank_mask:0xf
    v_add_f32_dpp v29, v29, v29 row_ror:2 row_mask:0xf bank_mask:0xf
    v_cmp_u_f32 vcc, v28, v28
    v_cvt_pk_bf16_f32 v28, v28, v29
    s_cbranch_vccnz M_c0_1_wqe1
    s_mov_b64 exec, s[62:63]
    buffer_store_dword v28, v11, s[8:11], s58 offen
    s_barrier
    buffer_store_dword v28, v11, s[8:11], s56 offen sc1
    s_branch M_c0_1_wrb_g
M_c0_1_wqx:
    s_branch M_c0_1_wrb_i1
M_c0_1_wqe1:
    s_waitcnt vmcnt(0)
    buffer_load_dwordx4 v[12:15], v0, s[8:11], s43 offen sc1
    s_branch M_c0_1_wrb_e1
M_c0_1_wrb_l:
    s_waitcnt vmcnt(1)
    v_mfma_f32_16x16x32_bf16 v[28:31], v[72:75], v[12:15], 0
    v_cmp_eq_u32 vcc, -1, v12
    s_cbranch_vccz M_c0_1_wrb_x0
M_c0_1_wrb_i0:
    buffer_load_dwordx4 v[12:15], v0, s[8:11], s43 offen sc1
    s_waitcnt vmcnt(1)
    v_mfma_f32_16x16x32_bf16 v[28:31], v[72:75], v[16:19], 0
    v_cmp_eq_u32 vcc, -1, v16
    s_cbranch_vccz M_c0_1_wrb_x1
M_c0_1_wrb_i1:
    buffer_load_dwordx4 v[16:19], v0, s[8:11], s43 offen sc1
    s_add_u32 s71, s71, 1
    s_cmp_lt_u32 s71, 240000
    s_cbranch_scc1 M_c0_1_wrb_l
    s_branch M_fail
M_c0_1_wrb_x0:
    s_nop 5
    v_add_f32_dpp v28, v28, v28 row_ror:8 row_mask:0xf bank_mask:0xf
    v_add_f32_dpp v29, v29, v29 row_ror:8 row_mask:0xf bank_mask:0xf
    s_nop 0
    v_add_f32_dpp v28, v28, v28 row_ror:4 row_mask:0xf bank_mask:0xf
    v_add_f32_dpp v29, v29, v29 row_ror:4 row_mask:0xf bank_mask:0xf
    s_nop 0
    v_add_f32_dpp v28, v28, v28 row_ror:2 row_mask:0xf bank_mask:0xf
    v_add_f32_dpp v29, v29, v29 row_ror:2 row_mask:0xf bank_mask:0xf
    v_cmp_u_f32 vcc, v28, v28
    v_cvt_pk_bf16_f32 v28, v28, v29
    s_cbranch_vccz M_c0_1_wrb_n
M_c0_1_wrb_e0:
    v_max3_u32 v32, v12, v13, v14
    v_max_u32 v32, v32, v15
    v_cmp_eq_u32 vcc, -1, v32
    s_cbranch_vccnz M_c0_1_wrb_i0
    v_min_u32 v28, -2, v28
    v_min_u32 v29, -2, v29
    s_branch M_c0_1_wrb_n
M_c0_1_wrb_x1:
    s_nop 5
    v_add_f32_dpp v28, v28, v28 row_ror:8 row_mask:0xf bank_mask:0xf
    v_add_f32_dpp v29, v29, v29 row_ror:8 row_mask:0xf bank_mask:0xf
    s_nop 0
    v_add_f32_dpp v28, v28, v28 row_ror:4 row_mask:0xf bank_mask:0xf
    v_add_f32_dpp v29, v29, v29 row_ror:4 row_mask:0xf bank_mask:0xf
    s_nop 0
    v_add_f32_dpp v28, v28, v28 row_ror:2 row_mask:0xf bank_mask:0xf
    v_add_f32_dpp v29, v29, v29 row_ror:2 row_mask:0xf bank_mask:0xf
    v_cmp_u_f32 vcc, v28, v28
    v_cvt_pk_bf16_f32 v28, v28, v29
    s_cbranch_vccz M_c0_1_wrb_n
M_c0_1_wrb_e1:
    v_max3_u32 v32, v16, v17, v18
    v_max_u32 v32, v32, v19
    v_cmp_eq_u32 vcc, -1, v32
    s_cbranch_vccnz M_c0_1_wrb_i1
    v_min_u32 v28, -2, v28
    v_min_u32 v29, -2, v29
M_c0_1_wrb_n:
    s_mov_b64 exec, s[62:63]
    buffer_store_dword v28, v11, s[8:11], s58 offen
    s_branch M_c0_1_wrb_d
M_c0_2_layer:
    s_lshr_b32 s27, s44, 6
    s_mul_i32 s50, s27, 33554432
    s_lshl_b32 s27, s22, 13
    s_add_u32 s50, s50, s27
    s_add_u32 s50, s50, 37748736
    s_barrier
    s_mov_b32 s26, 0x10010000
    s_mov_b32 s3, s26
    s_mul_i32 s27, s20, 5120
    s_add_u32 s48, s27, 167772160
    s_sub_u32 s49, 167777280, s27
    s_mov_b32 m0, 13312
    s_nop 0
    buffer_load_dwordx4 v0, s[8:11], s48 offen offset:0 sc1 lds
    buffer_load_dwordx4 v0, s[8:11], s48 offen offset:1024 sc1 lds
    buffer_load_dwordx4 v0, s[8:11], s48 offen offset:2048 sc1 lds
    s_and_b32 s55, s44, 3
    s_mul_i32 s55, s55, 167936
    s_add_u32 s55, s55, s34
    s_add_u32 s58, s55, s35
    s_and_b32 s57, s44, 63
    s_sub_u32 s61, s3, 4096
    ds_read_b128 v[56:59], v5 offset:0
    ds_read_b128 v[60:63], v5 offset:1024
    ds_read_b128 v[64:67], v5 offset:2048
    ds_read_b128 v[68:71], v5 offset:3072
    v_mov_b64 v[12:13], 0
    v_mov_b64 v[14:15], 0
    v_mov_b64 v[16:17], 0
    v_mov_b64 v[18:19], 0
    v_mov_b64 v[20:21], 0
    v_mov_b64 v[22:23], 0
    v_mov_b64 v[24:25], 0
    v_mov_b64 v[26:27], 0
    v_mov_b64 v[28:29], 0
    v_mov_b64 v[30:31], 0
    v_mov_b64 v[32:33], 0
    v_mov_b64 v[34:35], 0
    s_mov_b32 s70, 0
    s_waitcnt vmcnt(0) lgkmcnt(0)
M_c0_2_top:
    s_waitcnt vmcnt(6)
    s_barrier
    ds_read_b128 v[36:39], v6 offset:13312
    ds_read_b128 v[40:43], v6 offset:14336
    s_mov_b32 m0, 8192
    s_nop 0
    buffer_load_dwordx4 v0, s[8:11], s49 offen offset:3072 sc1 lds
M_c0_2_lr_r:
    s_waitcnt lgkmcnt(1)
    v_smfmac_f32_16x16x64_bf16 v[20:23], v[36:39], v[56:63], v1
    ds_read_b128 v[56:59], v5 offset:4096
    v_smfmac_f32_16x16x64_bf16 v[24:27], v[36:39], v[64:71], v1
    ds_read_b128 v[60:63], v5 offset:5120
    v_smfmac_f32_16x16x64_bf16 v[28:31], v[36:39], a[248:255], v1
    ds_read_b128 v[64:67], v5 offset:6144
    v_smfmac_f32_16x16x64_bf16 v[32:35], v[36:39], a[240:247], v1
    ds_read_b128 v[68:71], v5 offset:7168
    v_smfmac_f32_16x16x64_bf16 v[12:15], v[36:39], a[232:239], v1
    ds_read_b128 v[44:47], v6 offset:15360
    s_waitcnt lgkmcnt(3)
    v_smfmac_f32_16x16x64_bf16 v[16:19], v[36:39], v[56:63], v1
    ds_read_b128 v[56:59], v5 offset:8192
    v_smfmac_f32_16x16x64_bf16 v[20:23], v[40:43], a[224:231], v1
    ds_read_b128 v[60:63], v5 offset:9216
    s_waitcnt lgkmcnt(3)
    v_smfmac_f32_16x16x64_bf16 v[24:27], v[40:43], v[64:71], v1
    ds_read_b128 v[64:67], v5 offset:10240
    v_smfmac_f32_16x16x64_bf16 v[28:31], v[40:43], a[216:223], v1
    ds_read_b128 v[68:71], v5 offset:11264
    v_smfmac_f32_16x16x64_bf16 v[32:35], v[40:43], a[208:215], v1
    ds_read_b128 v[48:51], v6 offset:16384
    s_waitcnt lgkmcnt(3)
    v_smfmac_f32_16x16x64_bf16 v[12:15], v[40:43], v[56:63], v1
    ds_read_b128 v[56:59], v5 offset:12288
    v_smfmac_f32_16x16x64_bf16 v[16:19], v[40:43], a[200:207], v1
    ds_read_b128 v[60:63], v5 offset:13312
    s_waitcnt lgkmcnt(3)
    v_smfmac_f32_16x16x64_bf16 v[20:23], v[44:47], v[64:71], v1
    ds_read_b128 v[64:67], v5 offset:14336
    v_smfmac_f32_16x16x64_bf16 v[24:27], v[44:47], a[192:199], v1
    ds_read_b128 v[68:71], v5 offset:15360
    v_smfmac_f32_16x16x64_bf16 v[28:31], v[44:47], a[184:191], v1
    ds_read_b128 v[52:55], v6 offset:17408
    s_waitcnt lgkmcnt(3)
    v_smfmac_f32_16x16x64_bf16 v[32:35], v[44:47], v[56:63], v1
    ds_read_b128 v[56:59], v5 offset:16384
    v_smfmac_f32_16x16x64_bf16 v[20:23], v[48:51], a[176:183], v1
    ds_read_b128 v[60:63], v5 offset:17408
    s_waitcnt lgkmcnt(3)
    v_max3_u32 v10, v36, v40, v44
    v_smfmac_f32_16x16x64_bf16 v[24:27], v[48:51], v[64:71], v1
    ds_read_b128 v[64:67], v5 offset:18432
    s_waitcnt lgkmcnt(3)
    v_max3_u32 v10, v10, v48, v52
    v_smfmac_f32_16x16x64_bf16 v[28:31], v[48:51], a[168:175], v1
    ds_read_b128 v[68:71], v5 offset:19456
    v_cmp_eq_u32 vcc, -1, v10
    v_smfmac_f32_16x16x64_bf16 v[32:35], v[48:51], a[160:167], v1
    s_cbranch_vccnz M_c0_2_lr
    s_waitcnt vmcnt(0)
    s_barrier
    ds_read_b128 v[36:39], v6 offset:8192
    ds_read_b128 v[40:43], v6 offset:9216
    s_waitcnt lgkmcnt(4)
    v_smfmac_f32_16x16x64_bf16 v[20:23], v[52:55], v[56:63], v1
    ds_read_b128 v[44:47], v6 offset:10240
    ds_read_b128 v[48:51], v6 offset:11264
    v_smfmac_f32_16x16x64_bf16 v[24:27], v[52:55], a[152:159], v1
    ds_read_b32 v11, v6 offset:12288
    ds_read_b128 v[56:59], v5 offset:20480
    s_waitcnt lgkmcnt(6)
    v_smfmac_f32_16x16x64_bf16 v[28:31], v[52:55], v[64:71], v1
    ds_read_b128 v[60:63], v5 offset:21504
    s_waitcnt lgkmcnt(4)
    v_max3_u32 v10, v36, v40, v44
    v_smfmac_f32_16x16x64_bf16 v[32:35], v[52:55], a[144:151], v1
    s_waitcnt lgkmcnt(2)
    v_max3_u32 v10, v10, v48, v11
    v_cmp_eq_u32 vcc, -1, v10
    s_cbranch_vccnz M_c0_2_rr
M_c0_2_rr_r:
    s_mov_b32 m0, 23040
    ds_read_b128 v[64:67], v5 offset:22528
    ds_read_b128 v[68:71], v5 offset:23552
    ds_read_b128 v[52:55], v6 offset:12288
    buffer_store_dwordx4 v[76:79], v0, s[8:11], s4 offen offset:2048 sc1
    s_mov_b32 s4, 0x10000000
    buffer_load_dword v9, s[8:11], s61 offen sc1 lds
    v_smfmac_f32_16x16x64_bf16 v[20:23], v[36:39], a[136:143], v1
    s_waitcnt lgkmcnt(3)
    v_smfmac_f32_16x16x64_bf16 v[24:27], v[36:39], v[56:63], v1
    ds_read_b128 v[56:59], v5 offset:24576
    v_smfmac_f32_16x16x64_bf16 v[20:23], v[40:43], a[128:135], v1
    ds_read_b128 v[60:63], v5 offset:25600
    s_waitcnt lgkmcnt(3)
    v_smfmac_f32_16x16x64_bf16 v[24:27], v[40:43], v[64:71], v1
    ds_read_b128 v[64:67], v5 offset:26624
    v_smfmac_f32_16x16x64_bf16 v[20:23], v[44:47], a[120:127], v1
    ds_read_b128 v[68:71], v5 offset:27648
    v_smfmac_f32_16x16x64_bf16 v[24:27], v[44:47], a[112:119], v1
    s_waitcnt lgkmcnt(2)
    v_smfmac_f32_16x16x64_bf16 v[20:23], v[48:51], v[56:63], v1
    ds_read_b128 v[56:59], v5 offset:28672
    v_smfmac_f32_16x16x64_bf16 v[24:27], v[48:51], a[104:111], v1
    ds_read_b128 v[60:63], v5 offset:29696
    s_waitcnt lgkmcnt(2)
    v_smfmac_f32_16x16x64_bf16 v[20:23], v[52:55], v[64:71], v1
    ds_read_b128 v[64:67], v5 offset:30720
    v_smfmac_f32_16x16x64_bf16 v[24:27], v[52:55], a[96:103], v1
    ds_read_b128 v[68:71], v5 offset:31744
    v_smfmac_f32_16x16x64_bf16 v[28:31], v[36:39], a[88:95], v1
    s_cmp_eq_u32 s57, 0
    s_cbranch_scc1 M_c0_2_first
M_c0_2_first_r:
    s_waitcnt lgkmcnt(2)
    v_smfmac_f32_16x16x64_bf16 v[32:35], v[36:39], v[56:63], v1
    ds_read_b128 v[56:59], v5 offset:32768
    v_permlane32_swap_b32 v20, v21
    v_smfmac_f32_16x16x64_bf16 v[28:31], v[40:43], a[80:87], v1
    ds_read_b128 v[60:63], v5 offset:33792
    s_waitcnt lgkmcnt(2)
    v_permlane32_swap_b32 v22, v23
    v_smfmac_f32_16x16x64_bf16 v[32:35], v[40:43], v[64:71], v1
    ds_read_b128 v[64:67], v0 offset:2048
    v_permlane32_swap_b32 v24, v25
    v_smfmac_f32_16x16x64_bf16 v[28:31], v[44:47], a[72:79], v1
    ds_read_b128 v[68:71], v0 offset:3072
    v_permlane32_swap_b32 v26, v27
    v_smfmac_f32_16x16x64_bf16 v[32:35], v[44:47], a[64:71], v1
    s_waitcnt lgkmcnt(2)
    v_add_f32 v20, v20, v21
    v_add_f32 v22, v22, v23
    v_smfmac_f32_16x16x64_bf16 v[28:31], v[48:51], v[56:63], v1
    ds_read_b128 v[56:59], v0 offset:0
    v_add_f32 v24, v24, v25
    v_add_f32 v26, v26, v27
    v_smfmac_f32_16x16x64_bf16 v[32:35], v[48:51], a[56:63], v1
    ds_read_b128 v[60:63], v0 offset:1024
    v_mul_f32 v20, s40, v20
    v_mul_f32 v24, s40, v24
    v_smfmac_f32_16x16x64_bf16 v[28:31], v[52:55], a[48:55], v1
    v_mul_f32 v22, s40, v22
    v_mul_f32 v26, s40, v26
    v_smfmac_f32_16x16x64_bf16 v[32:35], v[52:55], a[40:47], v1
    v_cvt_pk_bf16_f32 v20, v20, v24
    v_cvt_pk_bf16_f32 v21, v22, v26
    v_smfmac_f32_16x16x64_bf16 v[12:15], v[36:39], a[32:39], v1
    ds_write_b32 v2, v20 offset:18432
    v_smfmac_f32_16x16x64_bf16 v[16:19], v[36:39], a[24:31], v1
    ds_write_b32 v2, v21 offset:19008
    v_permlane32_swap_b32 v28, v29
    v_smfmac_f32_16x16x64_bf16 v[12:15], v[40:43], a[16:23], v1
    ds_read_b128 v[36:39], v6 offset:15360
    v_permlane32_swap_b32 v30, v31
    v_smfmac_f32_16x16x64_bf16 v[16:19], v[40:43], a[8:15], v1
    ds_read_b128 v[40:43], v6 offset:16384
    v_permlane32_swap_b32 v32, v33
    v_smfmac_f32_16x16x64_bf16 v[12:15], v[44:47], a[0:7], v1
    s_waitcnt lgkmcnt(2)
    s_barrier
    v_permlane32_swap_b32 v34, v35
    v_smfmac_f32_16x16x64_bf16 v[16:19], v[44:47], v[248:255], v1
    ds_read_b128 v[20:23], v3 offset:18432
    v_add_f32 v28, v28, v29
    v_add_f32 v30, v30, v31
    v_smfmac_f32_16x16x64_bf16 v[12:15], v[48:51], v[240:247], v1
    ds_read_b128 v[24:27], v3 offset:18496
    v_add_f32 v32, v32, v33
    v_add_f32 v34, v34, v35
    v_smfmac_f32_16x16x64_bf16 v[16:19], v[48:51], v[232:239], v1
    ds_read_b128 v[72:75], v3 offset:18560
    v_cvt_pk_bf16_f32 v28, v28, v32
    v_cvt_pk_bf16_f32 v29, v30, v34
    v_smfmac_f32_16x16x64_bf16 v[12:15], v[52:55], v[224:231], v1
    ds_write_b32 v2, v28 offset:20736
    ds_read_b128 v[44:47], v3 offset:18624
    v_smfmac_f32_16x16x64_bf16 v[16:19], v[52:55], v[216:223], v1
    ds_write_b32 v2, v29 offset:21312
    s_waitcnt lgkmcnt(7)
    v_smfmac_f32_16x16x64_bf16 v[12:15], v[36:39], v[208:215], v1
    ds_read_b128 v[48:51], v6 offset:17408
    v_mov_b64 v[10:11], s[16:17]
    v_smfmac_f32_16x16x64_bf16 v[16:19], v[36:39], v[200:207], v1
    s_waitcnt lgkmcnt(6)
    v_mfma_f32_16x16x32_bf16 v[28:31], v[56:59], v[20:23], 0
    ds_read_b128 v[56:59], v0 offset:4096
    s_waitcnt lgkmcnt(6)
    v_mfma_f32_16x16x32_bf16 v[28:31], v[60:63], v[24:27], v[28:31]
    ds_read_b128 v[60:63], v0 offset:5120
    s_waitcnt lgkmcnt(3)
    s_barrier
    v_mfma_f32_16x16x32_bf16 v[28:31], v[64:67], v[72:75], v[28:31]
    ds_read_b128 v[64:67], v0 offset:6144
    v_mfma_f32_16x16x32_bf16 v[28:31], v[68:71], v[44:47], v[28:31]
    ds_read_b128 v[68:71], v0 offset:7168
    v_smfmac_f32_16x16x64_bf16 v[12:15], v[40:43], v[192:199], v1
    ds_read_b128 v[36:39], v3 offset:20736
    v_smfmac_f32_16x16x64_bf16 v[16:19], v[40:43], v[184:191], v1
    ds_read_b128 v[52:55], v3 offset:20800
    s_waitcnt lgkmcnt(4)
    v_mfma_f32_16x16x32_bf16 v[32:35], v[56:59], v[20:23], 0
    s_nop 0
    v_exp_f32 v28, v28
    ds_read_b128 v[56:59], v3 offset:20864
    v_mfma_f32_16x16x32_bf16 v[32:35], v[60:63], v[24:27], v[32:35]
    s_waitcnt lgkmcnt(3)
    v_exp_f32 v29, v29
    ds_read_b128 v[60:63], v3 offset:20928
    v_mfma_f32_16x16x32_bf16 v[32:35], v[64:67], v[72:75], v[32:35]
    v_exp_f32 v30, v30
    v_mfma_f32_16x16x32_bf16 v[32:35], v[68:71], v[44:47], v[32:35]
    s_waitcnt lgkmcnt(3)
    v_exp_f32 v31, v31
    v_mfma_f32_16x16x32_bf16 v[40:43], v[36:39], v[20:23], 0
    s_waitcnt lgkmcnt(2)
    v_cvt_pk_bf16_f32 v28, v28, v29
    v_cvt_pk_bf16_f32 v29, v30, v31
    v_mfma_f32_16x16x32_bf16 v[40:43], v[52:55], v[24:27], v[40:43]
    s_waitcnt lgkmcnt(1)
    v_mov_b64 v[64:65], s[24:25]
    v_mov_b64 v[66:67], s[24:25]
    v_mfma_f32_16x16x32_bf16 v[40:43], v[56:59], v[72:75], v[40:43]
    s_waitcnt lgkmcnt(0)
    v_exp_f32 v32, v32
    v_mfma_f32_16x16x32_bf16 v[40:43], v[60:63], v[44:47], v[40:43]
    v_exp_f32 v33, v33
    v_smfmac_f32_16x16x64_bf16 v[12:15], v[48:51], v[176:183], v1
    v_exp_f32 v34, v34
    v_smfmac_f32_16x16x64_bf16 v[16:19], v[48:51], v[168:175], v1
    v_exp_f32 v35, v35
    v_cvt_pk_bf16_f32 v30, v32, v33
    v_cvt_pk_bf16_f32 v31, v34, v35
    s_nop 0
    v_exp_f32 v40, v40
    v_mfma_f32_16x16x32_bf16 v[72:75], v[64:67], v[28:31], 0
    v_exp_f32 v41, v41
    v_mfma_f32_16x16x32_bf16 v[20:23], v[80:83], v[28:31], 0
    v_exp_f32 v42, v42
    v_mfma_f32_16x16x32_bf16 v[24:27], v[84:87], v[28:31], 0
    v_exp_f32 v43, v43
    v_cvt_pk_bf16_f32 v40, v40, v41
    v_cvt_pk_bf16_f32 v41, v42, v43
    v_cvt_pk_bf16_f32 v12, v12, v13
    v_cvt_pk_bf16_f32 v13, v14, v15
    v_mfma_f32_16x16x16_bf16 v[72:75], v[10:11], v[40:41], v[72:75]
    v_cvt_pk_bf16_f32 v14, v16, v17
    v_cvt_pk_bf16_f32 v15, v18, v19
M_c0_2_fin:
    v_mfma_f32_16x16x16_bf16 v[20:23], v[12:13], v[40:41], v[20:23]
    s_cmp_eq_u32 s57, 63
    v_cndmask_b32_e64 v76, v12, v56, s[66:67]
    v_cndmask_b32_e64 v77, v13, v57, s[66:67]
    v_mfma_f32_16x16x16_bf16 v[24:27], v[14:15], v[40:41], v[24:27]
    v_cndmask_b32_e64 v78, v14, v58, s[66:67]
    v_cndmask_b32_e64 v79, v15, v59, s[66:67]
    s_cbranch_scc1 M_c0_2_last
    v_rcp_f32 v74, v72
    v_subrev_u32 v73, s68, v72
    v_cmp_lt_u32 vcc, s69, v73
    v_mov_b64 v[44:45], 0
    v_mov_b64 v[46:47], 0
    v_cndmask_b32_e64 v20, v20, v24, s[18:19]
    v_cndmask_b32_e64 v21, v21, v25, s[18:19]
    v_cndmask_b32_e64 v22, v22, v26, s[18:19]
    v_cndmask_b32_e64 v23, v23, v27, s[18:19]
    v_pk_mul_f32 v[20:21], v[20:21], v[74:75] op_sel_hi:[1,0]
    v_pk_mul_f32 v[22:23], v[22:23], v[74:75] op_sel_hi:[1,0]
    v_cvt_pk_bf16_f32 v20, v20, v21
    v_cvt_pk_bf16_f32 v21, v22, v23
    ds_write_b64 v0, v[20:21] offset:14336
    s_cbranch_vccnz M_c0_2_zbad
M_c0_2_zok:
    s_cmp_eq_u32 s57, 0
    s_cbranch_scc1 M_c0_2_first2
M_c0_2_first2_r:
    buffer_load_dwordx4 v[80:83], v0, s[8:11], s3 offen offset:0 sc1
    buffer_load_dwordx4 v[84:87], v0, s[8:11], s3 offen offset:1024 sc1
    s_waitcnt lgkmcnt(0)
    s_barrier
    ds_read_b128 v[32:35], v0 offset:13312
    ds_read_b128 v[52:55], v0 offset:14336
    s_mov_b32 m0, 4096
    s_nop 0
    buffer_load_dwordx4 v0, s[8:11], s26 offen offset:0 sc1 lds
    buffer_load_dwordx4 v0, s[8:11], s26 offen offset:1024 sc1 lds
    v_mov_b64 v[68:69], 0
    v_mov_b64 v[70:71], 0
    v_mov_b64 v[64:65], 0
    v_mov_b64 v[66:67], 0
    v_mov_b64 v[60:61], 0
    v_mov_b64 v[62:63], 0
    v_mov_b64 v[56:57], 0
    v_mov_b64 v[58:59], 0
    s_waitcnt lgkmcnt(1)
    s_nop 0
    v_smfmac_f32_16x16x64_bf16 v[56:59], v[32:35], v[160:167], v1
    v_smfmac_f32_16x16x64_bf16 v[60:63], v[32:35], v[144:151], v1
    s_waitcnt lgkmcnt(0)
    v_smfmac_f32_16x16x64_bf16 v[56:59], v[52:55], v[152:159], v1
    v_smfmac_f32_16x16x64_bf16 v[60:63], v[52:55], v[136:143], v1
    v_smfmac_f32_16x16x64_bf16 v[64:67], v[32:35], v[128:135], v1
    v_smfmac_f32_16x16x64_bf16 v[68:71], v[32:35], v[112:119], v1
    v_permlane32_swap_b32 v56, v57
    v_smfmac_f32_16x16x64_bf16 v[64:67], v[52:55], v[120:127], v1
    v_permlane32_swap_b32 v58, v59
    v_smfmac_f32_16x16x64_bf16 v[68:71], v[52:55], v[104:111], v1
    v_add_f32 v56, v56, v57
    v_add_f32 v58, v58, v59
    v_smfmac_f32_16x16x64_bf16 v[44:47], v[32:35], v[96:103], v1
    v_permlane32_swap_b32 v60, v61
    v_smfmac_f32_16x16x64_bf16 v[44:47], v[52:55], v[88:95], v1
    v_permlane32_swap_b32 v62, v63
    v_add_f32 v60, v60, v61
    v_add_f32 v62, v62, v63
    v_cvt_pk_bf16_f32 v36, v56, v60
    v_cvt_pk_bf16_f32 v38, v58, v62
    v_permlane32_swap_b32 v64, v65
    v_permlane32_swap_b32 v66, v67
    v_add_f32 v64, v64, v65
    v_add_f32 v66, v66, v67
    v_permlane32_swap_b32 v68, v69
    v_permlane32_swap_b32 v70, v71
    v_add_f32 v68, v68, v69
    v_add_f32 v70, v70, v71
    v_cvt_pk_bf16_f32 v37, v64, v68
    v_cvt_pk_bf16_f32 v39, v66, v70
    buffer_store_dwordx4 v[36:39], v0, s[8:11], s58 offen
    v_permlane32_swap_b32 v44, v45
    v_permlane32_swap_b32 v46, v47
    v_add_f32 v44, v44, v45
    v_add_f32 v46, v46, v47
    v_cvt_pk_bf16_f32 v44, v44, v46
    buffer_store_dword v44, v7, s[8:11], s55 offen
    s_add_u32 s27, s44, 1
    s_and_b32 s27, s27, 3
    s_mul_i32 s48, s27, 5120
    s_add_u32 s48, s48, s41
    s_lshl_b32 s27, s27, 15
    s_add_u32 s49, s27, s47
    ds_read_b128 v[56:59], v5 offset:0
    ds_read_b128 v[60:63], v5 offset:1024
    ds_read_b128 v[64:67], v5 offset:2048
    ds_read_b128 v[68:71], v5 offset:3072
    v_mov_b64 v[12:13], 0
    v_mov_b64 v[14:15], 0
    v_mov_b64 v[16:17], 0
    v_mov_b64 v[18:19], 0
    v_mov_b64 v[20:21], 0
    v_mov_b64 v[22:23], 0
    v_mov_b64 v[24:25], 0
    v_mov_b64 v[26:27], 0
    v_mov_b64 v[28:29], 0
    v_mov_b64 v[30:31], 0
    v_mov_b64 v[32:33], 0
    v_mov_b64 v[34:35], 0
    s_barrier
    s_and_b32 s26, s44, 63
    s_add_u32 s26, s26, 2
    s_min_u32 s26, s26, 63
    s_lshl_b32 s26, s26, 18
    s_add_u32 s26, s26, s50
    s_add_u32 s26, s26, 4096
    s_add_u32 s3, s26, 16777216
    s_lshl_b32 s4, s44, 18
    s_add_u32 s4, s4, s53
    s_add_u32 s44, s44, 1
    s_and_b32 s55, s44, 3
    s_mul_i32 s55, s55, 167936
    s_add_u32 s55, s55, s34
    s_add_u32 s58, s55, s35
    s_and_b32 s57, s44, 63
    s_sub_u32 s61, s3, 4096
    s_nop 15
    s_nop 15
    s_nop 7
    s_mov_b32 m0, 13312
    s_nop 0
    buffer_load_dwordx4 v0, s[8:11], s48 offen offset:0 sc1 lds
    buffer_load_dwordx4 v0, s[8:11], s48 offen offset:1024 sc1 lds
    buffer_load_dwordx4 v0, s[8:11], s48 offen offset:2048 sc1 lds
    s_nop 11
    s_mov_b32 m0, 13312
    s_nop 0
    buffer_load_dwordx4 v0, s[8:11], s48 offen offset:0 sc1 lds
    buffer_load_dwordx4 v0, s[8:11], s48 offen offset:1024 sc1 lds
    buffer_load_dwordx4 v0, s[8:11], s48 offen offset:2048 sc1 lds
    s_nop 11
    s_mov_b32 m0, 13312
    s_nop 0
    buffer_load_dwordx4 v0, s[8:11], s48 offen offset:0 sc1 lds
    buffer_load_dwordx4 v0, s[8:11], s48 offen offset:1024 sc1 lds
    buffer_load_dwordx4 v0, s[8:11], s48 offen offset:2048 sc1 lds
    s_mov_b32 s70, 0
    s_waitcnt lgkmcnt(0)
    s_branch M_c0_2_top
M_c0_2_restart:
    s_waitcnt vmcnt(0) lgkmcnt(0)
    s_nop 7
    s_barrier
    s_mov_b32 m0, 13312
    s_nop 0
    buffer_load_dwordx4 v0, s[8:11], s48 offen offset:0 sc1 lds
    buffer_load_dwordx4 v0, s[8:11], s48 offen offset:1024 sc1 lds
    buffer_load_dwordx4 v0, s[8:11], s48 offen offset:2048 sc1 lds
    ds_read_b128 v[56:59], v5 offset:0
    ds_read_b128 v[60:63], v5 offset:1024
    ds_read_b128 v[64:67], v5 offset:2048
    ds_read_b128 v[68:71], v5 offset:3072
    v_mov_b64 v[12:13], 0
    v_mov_b64 v[14:15], 0
    v_mov_b64 v[16:17], 0
    v_mov_b64 v[18:19], 0
    v_mov_b64 v[20:21], 0
    v_mov_b64 v[22:23], 0
    v_mov_b64 v[24:25], 0
    v_mov_b64 v[26:27], 0
    v_mov_b64 v[28:29], 0
    v_mov_b64 v[30:31], 0
    v_mov_b64 v[32:33], 0
    v_mov_b64 v[34:35], 0
    s_waitcnt vmcnt(0) lgkmcnt(0)
    s_branch M_c0_2_top
M_c0_2_zbad:
    s_cmp_eq_u32 s70, 2
    s_cbranch_scc1 M_c0_2_zok
    v_cmp_u_f32 vcc, v72, v72
    s_cbranch_vccz M_c0_2_exact
    s_cmp_eq_u32 s70, 1
    s_cbranch_scc1 M_c0_2_exact
M_c0_2_vfy0:
    s_mov_b32 s70, 1
    s_mov_b32 s30, 0
    s_waitcnt vmcnt(0) lgkmcnt(0)
    s_nop 7
M_c0_2_vfy:
    v_mov_b32 v10, 0
    s_add_u32 s59, s48, 4096
    buffer_load_dwordx4 v[36:39], v0, s[8:11], s48 offen offset:0 sc1
    buffer_load_dwordx4 v[40:43], v0, s[8:11], s48 offen offset:1024 sc1
    buffer_load_dwordx4 v[44:47], v0, s[8:11], s48 offen offset:2048 sc1
    buffer_load_dwordx4 v[48:51], v0, s[8:11], s48 offen offset:3072 sc1
    buffer_load_dwordx4 v[52:55], v0, s[8:11], s59 offen offset:0 sc1
    s_waitcnt vmcnt(4)
    v_max3_u32 v10, v10, v36, v37
    v_max3_u32 v10, v10, v38, v39
    s_waitcnt vmcnt(3)
    v_max3_u32 v10, v10, v40, v41
    v_max3_u32 v10, v10, v42, v43
    s_waitcnt vmcnt(2)
    v_max3_u32 v10, v10, v44, v45
    v_max3_u32 v10, v10, v46, v47
    s_waitcnt vmcnt(1)
    v_max3_u32 v10, v10, v48, v49
    v_max3_u32 v10, v10, v50, v51
    s_waitcnt vmcnt(0)
    v_max3_u32 v10, v10, v52, v53
    v_max3_u32 v10, v10, v54, v55
    s_add_u32 s59, s49, 4096
    buffer_load_dwordx4 v[36:39], v0, s[8:11], s49 offen offset:0 sc1
    buffer_load_dwordx4 v[40:43], v0, s[8:11], s49 offen offset:1024 sc1
    buffer_load_dwordx4 v[44:47], v0, s[8:11], s49 offen offset:2048 sc1
    buffer_load_dwordx4 v[48:51], v0, s[8:11], s49 offen offset:3072 sc1
    buffer_load_dwordx4 v[52:55], v0, s[8:11], s59 offen offset:0 sc1
    s_waitcnt vmcnt(4)
    v_max3_u32 v10, v10, v36, v37
    v_max3_u32 v10, v10, v38, v39
    s_waitcnt vmcnt(3)
    v_max3_u32 v10, v10, v40, v41
    v_max3_u32 v10, v10, v42, v43
    s_waitcnt vmcnt(2)
    v_max3_u32 v10, v10, v44, v45
    v_max3_u32 v10, v10, v46, v47
    s_waitcnt vmcnt(1)
    v_max3_u32 v10, v10, v48, v49
    v_max3_u32 v10, v10, v50, v51
    s_waitcnt vmcnt(0)
    v_max3_u32 v10, v10, v52, v53
    v_max3_u32 v10, v10, v54, v55
    v_cmp_eq_u32 vcc, -1, v10
    s_cbranch_vccz M_c0_2_restart
    s_add_u32 s30, s30, 1
    s_cmp_ge_u32 s30, 60000
    s_cbranch_scc1 M_fail
    s_branch M_c0_2_vfy
M_c0_2_exact:
    s_nop 7
    s_mov_b32 s70, 2
    s_waitcnt lgkmcnt(0)
    ds_read_b128 v[20:23], v3 offset:18432
    ds_read_b128 v[24:27], v3 offset:18496
    ds_read_b128 v[72:75], v3 offset:18560
    ds_read_b128 v[44:47], v3 offset:18624
    ds_read_b128 v[56:59], v0 offset:0
    s_waitcnt lgkmcnt(0)
    v_mfma_f32_16x16x32_bf16 v[28:31], v[56:59], v[20:23], 0
    s_nop 3
    ds_read_b128 v[60:63], v0 offset:1024
    s_waitcnt lgkmcnt(0)
    v_mfma_f32_16x16x32_bf16 v[28:31], v[60:63], v[24:27], v[28:31]
    s_nop 3
    ds_read_b128 v[56:59], v0 offset:2048
    s_waitcnt lgkmcnt(0)
    v_mfma_f32_16x16x32_bf16 v[28:31], v[56:59], v[72:75], v[28:31]
    s_nop 3
    ds_read_b128 v[60:63], v0 offset:3072
    s_waitcnt lgkmcnt(0)
    v_mfma_f32_16x16x32_bf16 v[28:31], v[60:63], v[44:47], v[28:31]
    s_nop 3
    ds_read_b128 v[56:59], v0 offset:4096
    s_waitcnt lgkmcnt(0)
    v_mfma_f32_16x16x32_bf16 v[32:35], v[56:59], v[20:23], 0
    s_nop 3
    ds_read_b128 v[60:63], v0 offset:5120
    s_waitcnt lgkmcnt(0)
    v_mfma_f32_16x16x32_bf16 v[32:35], v[60:63], v[24:27], v[32:35]
    s_nop 3
    ds_read_b128 v[56:59], v0 offset:6144
    s_waitcnt lgkmcnt(0)
    v_mfma_f32_16x16x32_bf16 v[32:35], v[56:59], v[72:75], v[32:35]
    s_nop 3
    ds_read_b128 v[60:63], v0 offset:7168
    s_waitcnt lgkmcnt(0)
    v_mfma_f32_16x16x32_bf16 v[32:35], v[60:63], v[44:47], v[32:35]
    s_nop 3
    ds_read_b128 v[56:59], v3 offset:20736
    s_waitcnt lgkmcnt(0)
    v_mfma_f32_16x16x32_bf16 v[40:43], v[56:59], v[20:23], 0
    s_nop 3
    ds_read_b128 v[60:63], v3 offset:20800
    s_waitcnt lgkmcnt(0)
    v_mfma_f32_16x16x32_bf16 v[40:43], v[60:63], v[24:27], v[40:43]
    s_nop 3
    ds_read_b128 v[56:59], v3 offset:20864
    s_waitcnt lgkmcnt(0)
    v_mfma_f32_16x16x32_bf16 v[40:43], v[56:59], v[72:75], v[40:43]
    s_nop 3
    ds_read_b128 v[60:63], v3 offset:20928
    s_waitcnt lgkmcnt(0)
    v_mfma_f32_16x16x32_bf16 v[40:43], v[60:63], v[44:47], v[40:43]
    s_nop 3
    v_max3_f32 v68, v28, v29, v30
    v_max3_f32 v68, v68, v31, v32
    v_max3_f32 v68, v68, v33, v34
    s_nop 0
    v_max3_f32 v68, v68, v35, v40
    v_max3_f32 v68, v68, v41, v42
    v_max_f32 v68, v68, v43
    v_mov_b32 v69, v68
    s_nop 1
    v_permlane16_swap_b32 v68, v69
    v_max_f32 v68, v68, v69
    v_mov_b32 v69, v68
    s_nop 1
    v_permlane32_swap_b32 v68, v69
    v_max_f32 v68, v68, v69
    v_sub_f32 v28, v28, v68
    v_exp_f32 v28, v28
    v_sub_f32 v29, v29, v68
    v_exp_f32 v29, v29
    v_sub_f32 v30, v30, v68
    v_exp_f32 v30, v30
    v_sub_f32 v31, v31, v68
    v_exp_f32 v31, v31
    v_sub_f32 v32, v32, v68
    v_exp_f32 v32, v32
    v_sub_f32 v33, v33, v68
    v_exp_f32 v33, v33
    v_sub_f32 v34, v34, v68
    v_exp_f32 v34, v34
    v_sub_f32 v35, v35, v68
    v_exp_f32 v35, v35
    v_sub_f32 v40, v40, v68
    v_exp_f32 v40, v40
    v_sub_f32 v41, v41, v68
    v_exp_f32 v41, v41
    v_sub_f32 v42, v42, v68
    v_exp_f32 v42, v42
    v_sub_f32 v43, v43, v68
    v_exp_f32 v43, v43
    v_cvt_pk_bf16_f32 v28, v28, v29
    v_cvt_pk_bf16_f32 v29, v30, v31
    v_cvt_pk_bf16_f32 v30, v32, v33
    v_cvt_pk_bf16_f32 v31, v34, v35
    v_cvt_pk_bf16_f32 v40, v40, v41
    v_cvt_pk_bf16_f32 v41, v42, v43
    v_mfma_f32_16x16x32_bf16 v[20:23], v[80:83], v[28:31], 0
    v_mfma_f32_16x16x32_bf16 v[24:27], v[84:87], v[28:31], 0
    v_mfma_f32_16x16x32_bf16 v[72:75], v[64:67], v[28:31], 0
    ds_read_b128 v[56:59], v3 offset:20864
    s_waitcnt lgkmcnt(0)
    s_nop 7
    v_mfma_f32_16x16x16_bf16 v[72:75], v[10:11], v[40:41], v[72:75]
    s_nop 7
    s_branch M_c0_2_fin
M_c0_2_last:
    s_cmp_lg_u32 s70, 0
    s_cbranch_scc1 M_c0_2_last2
    v_cmp_u_f32 vcc, v32, v32
    s_cbranch_vccnz M_c0_2_vfy0
M_c0_2_last2:
    s_lshl_b32 s4, s44, 18
    s_add_u32 s4, s4, s53
    buffer_store_dwordx4 v[76:79], v0, s[8:11], s4 offen offset:2048 sc1
    s_mov_b32 s4, 0x10000000
    s_waitcnt vmcnt(0) lgkmcnt(0)
    s_barrier
    s_nop 7
    v_mov_b64 v[72:73], -1
    v_mov_b64 v[74:75], -1
    s_add_u32 s28, s44, 3
    s_and_b32 s29, s28, 3
    s_mul_i32 s31, s22, 160
    s_waitcnt vmcnt(0)
    s_add_u32 s44, s44, 1
    s_cmp_eq_u32 s44, 128
    s_cbranch_scc1 M_end
    s_branch M_c0_2_layer
M_c0_2_lr:
    s_mov_b32 s30, 0
M_c0_2_lr_l:
    s_waitcnt lgkmcnt(0)
    s_and_b32 s27, s30, 1
    s_cbranch_scc0 M_c0_2_lr_n
    s_waitcnt vmcnt(3)
    s_mov_b32 m0, 13312
    s_nop 0
    buffer_load_dwordx4 v0, s[8:11], s48 offen offset:0 sc1 lds
    buffer_load_dwordx4 v0, s[8:11], s48 offen offset:1024 sc1 lds
    buffer_load_dwordx4 v0, s[8:11], s48 offen offset:2048 sc1 lds
M_c0_2_lr_n:
    ds_read_b128 v[36:39], v6 offset:13312
    ds_read_b128 v[40:43], v6 offset:14336
    ds_read_b128 v[44:47], v6 offset:15360
    ds_read_b128 v[48:51], v6 offset:16384
    ds_read_b128 v[52:55], v6 offset:17408
    s_waitcnt lgkmcnt(2)
    v_max3_u32 v10, v36, v40, v44
    s_waitcnt lgkmcnt(0)
    v_max3_u32 v10, v10, v48, v52
    v_cmp_eq_u32 vcc, -1, v10
    s_cbranch_vccz M_c0_2_lr_d
    s_add_u32 s30, s30, 1
    s_cmp_ge_u32 s30, 480000
    s_cbranch_scc1 M_fail
    s_branch M_c0_2_lr_l
M_c0_2_lr_d:
    ds_read_b128 v[56:59], v5 offset:0
    ds_read_b128 v[60:63], v5 offset:1024
    ds_read_b128 v[64:67], v5 offset:2048
    ds_read_b128 v[68:71], v5 offset:3072
    v_mov_b64 v[12:13], 0
    v_mov_b64 v[14:15], 0
    v_mov_b64 v[16:17], 0
    v_mov_b64 v[18:19], 0
    v_mov_b64 v[20:21], 0
    v_mov_b64 v[22:23], 0
    v_mov_b64 v[24:25], 0
    v_mov_b64 v[26:27], 0
    v_mov_b64 v[28:29], 0
    v_mov_b64 v[30:31], 0
    v_mov_b64 v[32:33], 0
    v_mov_b64 v[34:35], 0
    s_waitcnt lgkmcnt(0)
    s_branch M_c0_2_lr_r
M_c0_2_rr:
    s_mov_b32 s30, 0
M_c0_2_rr_l:
    s_waitcnt lgkmcnt(0)
    s_and_b32 s27, s30, 1
    s_cbranch_scc1 M_c0_2_rr_n
    s_waitcnt vmcnt(1)
    s_mov_b32 m0, 8192
    s_nop 0
    buffer_load_dwordx4 v0, s[8:11], s49 offen offset:3072 sc1 lds
M_c0_2_rr_n:
    ds_read_b128 v[36:39], v6 offset:8192
    ds_read_b128 v[40:43], v6 offset:9216
    ds_read_b128 v[44:47], v6 offset:10240
    ds_read_b128 v[48:51], v6 offset:11264
    ds_read_b32 v11, v6 offset:12288
    s_waitcnt lgkmcnt(2)
    v_max3_u32 v10, v36, v40, v44
    s_waitcnt lgkmcnt(0)
    v_max3_u32 v10, v10, v48, v11
    v_cmp_eq_u32 vcc, -1, v10
    s_cbranch_vccz M_c0_2_rr_d
    s_add_u32 s30, s30, 1
    s_cmp_ge_u32 s30, 480000
    s_cbranch_scc1 M_fail
    s_branch M_c0_2_rr_l
M_c0_2_rr_d:
    s_branch M_c0_2_rr_r
M_c0_2_first:
    s_mul_i32 s27, s21, 167936
    s_add_u32 s27, s27, s34
    s_mul_i32 s28, s22, 4224
    s_add_u32 s28, s28, s27
    s_mov_b32 exec_hi, 0
    buffer_load_dword v10, v9, s[8:11], s28 offen sc1
    s_lshl_b32 s28, s22, 10
    s_add_u32 s28, s28, s27
    s_add_u32 s28, s28, 135168
    s_mov_b64 exec, 0xff
    buffer_load_dword v10, v9, s[8:11], s28 offen sc1
    s_mul_i32 s27, s21, 5120
    s_add_u32 s27, s27, s41
    s_mul_i32 s28, s22, 160
    s_add_u32 s28, s28, s27
    s_mov_b64 exec, 3
    buffer_load_dword v10, v9, s[8:11], s28 offen sc1
    s_mov_b64 exec, -1
    s_barrier
    s_and_b32 s26, s44, 63
    s_lshl_b32 s26, s26, 18
    s_add_u32 s26, s26, s50
    s_add_u32 s26, s26, 4096
    s_add_u32 s3, s26, 16777216
    s_mov_b32 m0, 4096
    s_nop 0
    buffer_load_dwordx4 v0, s[8:11], s26 offen offset:0 sc1 lds
    buffer_load_dwordx4 v0, s[8:11], s26 offen offset:1024 sc1 lds
    buffer_load_dwordx4 v[80:83], v0, s[8:11], s3 offen offset:0 sc1
    buffer_load_dwordx4 v[84:87], v0, s[8:11], s3 offen offset:1024 sc1
    s_and_b32 s26, s44, 63
    s_add_u32 s26, s26, 1
    s_min_u32 s26, s26, 63
    s_lshl_b32 s26, s26, 18
    s_add_u32 s26, s26, s50
    s_add_u32 s26, s26, 4096
    s_add_u32 s3, s26, 16777216
    s_waitcnt vmcnt(0) lgkmcnt(0)
    s_barrier
    s_branch M_c0_2_first_r
M_c0_2_first2:
    s_barrier
    s_branch M_c0_2_first2_r
M_c0_3_layer:
    s_lshr_b32 s27, s44, 6
    s_mul_i32 s50, s27, 33554432
    s_lshl_b32 s27, s22, 13
    s_add_u32 s50, s50, s27
    s_add_u32 s50, s50, 37748736
    s_barrier
    s_mov_b32 s26, 0x10010000
    s_mov_b32 s3, s26
    s_mul_i32 s27, s20, 5120
    s_add_u32 s48, s27, 167772160
    s_sub_u32 s49, 167777280, s27
    s_mov_b32 m0, 13312
    s_nop 0
    buffer_load_dwordx4 v0, s[8:11], s48 offen offset:3072 sc1 lds
    s_mov_b32 m0, 17408
    s_add_u32 s59, s48, 4096
    buffer_load_dwordx4 v0, s[8:11], s59 offen offset:0 sc1 lds
    s_and_b32 s55, s44, 3
    s_mul_i32 s55, s55, 167936
    s_add_u32 s55, s55, s34
    s_add_u32 s58, s55, s35
    s_and_b32 s57, s44, 63
    s_sub_u32 s61, s26, 6144
    ds_read_b128 v[56:59], v5 offset:0
    ds_read_b128 v[60:63], v5 offset:1024
    ds_read_b128 v[64:67], v5 offset:2048
    ds_read_b128 v[68:71], v5 offset:3072
    v_mov_b64 v[12:13], 0
    v_mov_b64 v[14:15], 0
    v_mov_b64 v[16:17], 0
    v_mov_b64 v[18:19], 0
    v_mov_b64 v[20:21], 0
    v_mov_b64 v[22:23], 0
    v_mov_b64 v[24:25], 0
    v_mov_b64 v[26:27], 0
    v_mov_b64 v[28:29], 0
    v_mov_b64 v[30:31], 0
    v_mov_b64 v[32:33], 0
    v_mov_b64 v[34:35], 0
    s_mov_b32 s70, 0
    s_waitcnt vmcnt(0) lgkmcnt(0)
M_c0_3_top:
    s_waitcnt vmcnt(4)
    s_barrier
    ds_read_b128 v[36:39], v6 offset:13312
    ds_read_b128 v[40:43], v6 offset:14336
    s_mov_b32 m0, 12288
    s_add_u32 s59, s49, 4096
    buffer_load_dwordx4 v0, s[8:11], s59 offen offset:0 sc1 lds
M_c0_3_lr_r:
    s_waitcnt lgkmcnt(1)
    v_smfmac_f32_16x16x64_bf16 v[20:23], v[36:39], v[56:63], v1
    ds_read_b128 v[56:59], v5 offset:4096
    v_smfmac_f32_16x16x64_bf16 v[24:27], v[36:39], v[64:71], v1
    ds_read_b128 v[60:63], v5 offset:5120
    v_smfmac_f32_16x16x64_bf16 v[28:31], v[36:39], a[248:255], v1
    ds_read_b128 v[64:67], v5 offset:6144
    v_smfmac_f32_16x16x64_bf16 v[32:35], v[36:39], a[240:247], v1
    ds_read_b128 v[68:71], v5 offset:7168
    v_smfmac_f32_16x16x64_bf16 v[12:15], v[36:39], a[232:239], v1
    ds_read_b128 v[44:47], v6 offset:15360
    s_waitcnt lgkmcnt(3)
    v_smfmac_f32_16x16x64_bf16 v[16:19], v[36:39], v[56:63], v1
    ds_read_b128 v[56:59], v5 offset:8192
    v_smfmac_f32_16x16x64_bf16 v[20:23], v[40:43], a[224:231], v1
    ds_read_b128 v[60:63], v5 offset:9216
    s_waitcnt lgkmcnt(3)
    v_smfmac_f32_16x16x64_bf16 v[24:27], v[40:43], v[64:71], v1
    ds_read_b128 v[64:67], v5 offset:10240
    v_smfmac_f32_16x16x64_bf16 v[28:31], v[40:43], a[216:223], v1
    ds_read_b128 v[68:71], v5 offset:11264
    v_smfmac_f32_16x16x64_bf16 v[32:35], v[40:43], a[208:215], v1
    ds_read_b128 v[48:51], v6 offset:16384
    s_waitcnt lgkmcnt(3)
    v_smfmac_f32_16x16x64_bf16 v[12:15], v[40:43], v[56:63], v1
    ds_read_b128 v[56:59], v5 offset:12288
    v_smfmac_f32_16x16x64_bf16 v[16:19], v[40:43], a[200:207], v1
    ds_read_b128 v[60:63], v5 offset:13312
    s_waitcnt lgkmcnt(3)
    v_smfmac_f32_16x16x64_bf16 v[20:23], v[44:47], v[64:71], v1
    ds_read_b128 v[64:67], v5 offset:14336
    v_smfmac_f32_16x16x64_bf16 v[24:27], v[44:47], a[192:199], v1
    ds_read_b128 v[68:71], v5 offset:15360
    v_smfmac_f32_16x16x64_bf16 v[28:31], v[44:47], a[184:191], v1
    ds_read_b128 v[52:55], v6 offset:17408
    s_waitcnt lgkmcnt(3)
    v_smfmac_f32_16x16x64_bf16 v[32:35], v[44:47], v[56:63], v1
    ds_read_b128 v[56:59], v5 offset:16384
    v_smfmac_f32_16x16x64_bf16 v[20:23], v[48:51], a[176:183], v1
    ds_read_b128 v[60:63], v5 offset:17408
    s_waitcnt lgkmcnt(3)
    v_max3_u32 v10, v36, v40, v44
    v_smfmac_f32_16x16x64_bf16 v[24:27], v[48:51], v[64:71], v1
    ds_read_b128 v[64:67], v5 offset:18432
    s_waitcnt lgkmcnt(3)
    v_max3_u32 v10, v10, v48, v52
    v_smfmac_f32_16x16x64_bf16 v[28:31], v[48:51], a[168:175], v1
    ds_read_b128 v[68:71], v5 offset:19456
    v_cmp_eq_u32 vcc, -1, v10
    v_smfmac_f32_16x16x64_bf16 v[32:35], v[48:51], a[160:167], v1
    s_cbranch_vccnz M_c0_3_lr
    s_waitcnt vmcnt(0)
    s_barrier
    ds_read_b128 v[36:39], v6 offset:8192
    ds_read_b128 v[40:43], v6 offset:9216
    s_waitcnt lgkmcnt(4)
    v_smfmac_f32_16x16x64_bf16 v[20:23], v[52:55], v[56:63], v1
    ds_read_b128 v[44:47], v6 offset:10240
    ds_read_b128 v[48:51], v6 offset:11264
    v_smfmac_f32_16x16x64_bf16 v[24:27], v[52:55], a[152:159], v1
    ds_read_b32 v11, v6 offset:12288
    ds_read_b128 v[56:59], v5 offset:20480
    s_waitcnt lgkmcnt(6)
    v_smfmac_f32_16x16x64_bf16 v[28:31], v[52:55], v[64:71], v1
    ds_read_b128 v[60:63], v5 offset:21504
    s_waitcnt lgkmcnt(4)
    v_max3_u32 v10, v36, v40, v44
    v_smfmac_f32_16x16x64_bf16 v[32:35], v[52:55], a[144:151], v1
    s_waitcnt lgkmcnt(2)
    v_max3_u32 v10, v10, v48, v11
    v_cmp_eq_u32 vcc, -1, v10
    s_cbranch_vccnz M_c0_3_rr
M_c0_3_rr_r:
    s_mov_b32 m0, 23040
    ds_read_b128 v[64:67], v5 offset:22528
    ds_read_b128 v[68:71], v5 offset:23552
    ds_read_b128 v[52:55], v6 offset:12288
    buffer_store_dwordx4 v[76:79], v0, s[8:11], s4 offen offset:3072 sc1
    s_mov_b32 s4, 0x10000000
    buffer_load_dword v9, s[8:11], s61 offen sc1 lds
    v_smfmac_f32_16x16x64_bf16 v[20:23], v[36:39], a[136:143], v1
    s_waitcnt lgkmcnt(3)
    v_smfmac_f32_16x16x64_bf16 v[24:27], v[36:39], v[56:63], v1
    ds_read_b128 v[56:59], v5 offset:24576
    v_smfmac_f32_16x16x64_bf16 v[20:23], v[40:43], a[128:135], v1
    ds_read_b128 v[60:63], v5 offset:25600
    s_waitcnt lgkmcnt(3)
    v_smfmac_f32_16x16x64_bf16 v[24:27], v[40:43], v[64:71], v1
    ds_read_b128 v[64:67], v5 offset:26624
    v_smfmac_f32_16x16x64_bf16 v[20:23], v[44:47], a[120:127], v1
    ds_read_b128 v[68:71], v5 offset:27648
    v_smfmac_f32_16x16x64_bf16 v[24:27], v[44:47], a[112:119], v1
    s_waitcnt lgkmcnt(2)
    v_smfmac_f32_16x16x64_bf16 v[20:23], v[48:51], v[56:63], v1
    ds_read_b128 v[56:59], v5 offset:28672
    v_smfmac_f32_16x16x64_bf16 v[24:27], v[48:51], a[104:111], v1
    ds_read_b128 v[60:63], v5 offset:29696
    s_waitcnt lgkmcnt(2)
    v_smfmac_f32_16x16x64_bf16 v[20:23], v[52:55], v[64:71], v1
    ds_read_b128 v[64:67], v5 offset:30720
    v_smfmac_f32_16x16x64_bf16 v[24:27], v[52:55], a[96:103], v1
    ds_read_b128 v[68:71], v5 offset:31744
    v_smfmac_f32_16x16x64_bf16 v[28:31], v[36:39], a[88:95], v1
    s_cmp_eq_u32 s57, 0
    s_cbranch_scc1 M_c0_3_first
M_c0_3_first_r:
    s_waitcnt lgkmcnt(2)
    v_smfmac_f32_16x16x64_bf16 v[32:35], v[36:39], v[56:63], v1
    ds_read_b128 v[56:59], v5 offset:32768
    v_permlane32_swap_b32 v20, v21
    v_smfmac_f32_16x16x64_bf16 v[28:31], v[40:43], a[80:87], v1
    ds_read_b128 v[60:63], v5 offset:33792
    s_waitcnt lgkmcnt(2)
    v_permlane32_swap_b32 v22, v23
    v_smfmac_f32_16x16x64_bf16 v[32:35], v[40:43], v[64:71], v1
    ds_read_b128 v[64:67], v0 offset:2048
    v_permlane32_swap_b32 v24, v25
    v_smfmac_f32_16x16x64_bf16 v[28:31], v[44:47], a[72:79], v1
    ds_read_b128 v[68:71], v0 offset:3072
    v_permlane32_swap_b32 v26, v27
    v_smfmac_f32_16x16x64_bf16 v[32:35], v[44:47], a[64:71], v1
    s_waitcnt lgkmcnt(2)
    v_add_f32 v20, v20, v21
    v_add_f32 v22, v22, v23
    v_smfmac_f32_16x16x64_bf16 v[28:31], v[48:51], v[56:63], v1
    ds_read_b128 v[56:59], v0 offset:0
    v_add_f32 v24, v24, v25
    v_add_f32 v26, v26, v27
    v_smfmac_f32_16x16x64_bf16 v[32:35], v[48:51], a[56:63], v1
    ds_read_b128 v[60:63], v0 offset:1024
    v_mul_f32 v20, s40, v20
    v_mul_f32 v24, s40, v24
    v_smfmac_f32_16x16x64_bf16 v[28:31], v[52:55], a[48:55], v1
    v_mul_f32 v22, s40, v22
    v_mul_f32 v26, s40, v26
    v_smfmac_f32_16x16x64_bf16 v[32:35], v[52:55], a[40:47], v1
    v_cvt_pk_bf16_f32 v20, v20, v24
    v_cvt_pk_bf16_f32 v21, v22, v26
    v_smfmac_f32_16x16x64_bf16 v[12:15], v[36:39], a[32:39], v1
    ds_write_b32 v2, v20 offset:18432
    v_smfmac_f32_16x16x64_bf16 v[16:19], v[36:39], a[24:31], v1
    ds_write_b32 v2, v21 offset:19008
    v_permlane32_swap_b32 v28, v29
    v_smfmac_f32_16x16x64_bf16 v[12:15], v[40:43], a[16:23], v1
    ds_read_b128 v[36:39], v6 offset:15360
    v_permlane32_swap_b32 v30, v31
    v_smfmac_f32_16x16x64_bf16 v[16:19], v[40:43], a[8:15], v1
    ds_read_b128 v[40:43], v6 offset:16384
    v_permlane32_swap_b32 v32, v33
    v_smfmac_f32_16x16x64_bf16 v[12:15], v[44:47], a[0:7], v1
    s_waitcnt lgkmcnt(2)
    s_barrier
    v_permlane32_swap_b32 v34, v35
    v_smfmac_f32_16x16x64_bf16 v[16:19], v[44:47], v[248:255], v1
    ds_read_b128 v[20:23], v3 offset:18432
    v_add_f32 v28, v28, v29
    v_add_f32 v30, v30, v31
    v_smfmac_f32_16x16x64_bf16 v[12:15], v[48:51], v[240:247], v1
    ds_read_b128 v[24:27], v3 offset:18496
    v_add_f32 v32, v32, v33
    v_add_f32 v34, v34, v35
    v_smfmac_f32_16x16x64_bf16 v[16:19], v[48:51], v[232:239], v1
    ds_read_b128 v[72:75], v3 offset:18560
    v_cvt_pk_bf16_f32 v28, v28, v32
    v_cvt_pk_bf16_f32 v29, v30, v34
    v_smfmac_f32_16x16x64_bf16 v[12:15], v[52:55], v[224:231], v1
    ds_write_b32 v2, v28 offset:20736
    ds_read_b128 v[44:47], v3 offset:18624
    v_smfmac_f32_16x16x64_bf16 v[16:19], v[52:55], v[216:223], v1
    ds_write_b32 v2, v29 offset:21312
    s_waitcnt lgkmcnt(7)
    v_smfmac_f32_16x16x64_bf16 v[12:15], v[36:39], v[208:215], v1
    ds_read_b128 v[48:51], v6 offset:17408
    v_mov_b64 v[10:11], s[16:17]
    v_smfmac_f32_16x16x64_bf16 v[16:19], v[36:39], v[200:207], v1
    s_waitcnt lgkmcnt(6)
    v_mfma_f32_16x16x32_bf16 v[28:31], v[56:59], v[20:23], 0
    ds_read_b128 v[56:59], v0 offset:4096
    s_waitcnt lgkmcnt(6)
    v_mfma_f32_16x16x32_bf16 v[28:31], v[60:63], v[24:27], v[28:31]
    ds_read_b128 v[60:63], v0 offset:5120
    s_waitcnt lgkmcnt(3)
    s_barrier
    v_mfma_f32_16x16x32_bf16 v[28:31], v[64:67], v[72:75], v[28:31]
    ds_read_b128 v[64:67], v0 offset:6144
    v_mfma_f32_16x16x32_bf16 v[28:31], v[68:71], v[44:47], v[28:31]
    ds_read_b128 v[68:71], v0 offset:7168
    v_smfmac_f32_16x16x64_bf16 v[12:15], v[40:43], v[192:199], v1
    ds_read_b128 v[36:39], v3 offset:20736
    v_smfmac_f32_16x16x64_bf16 v[16:19], v[40:43], v[184:191], v1
    ds_read_b128 v[52:55], v3 offset:20800
    s_waitcnt lgkmcnt(4)
    v_mfma_f32_16x16x32_bf16 v[32:35], v[56:59], v[20:23], 0
    s_nop 0
    v_exp_f32 v28, v28
    ds_read_b128 v[56:59], v3 offset:20864
    v_mfma_f32_16x16x32_bf16 v[32:35], v[60:63], v[24:27], v[32:35]
    s_waitcnt lgkmcnt(3)
    v_exp_f32 v29, v29
    ds_read_b128 v[60:63], v3 offset:20928
    v_mfma_f32_16x16x32_bf16 v[32:35], v[64:67], v[72:75], v[32:35]
    v_exp_f32 v30, v30
    v_mfma_f32_16x16x32_bf16 v[32:35], v[68:71], v[44:47], v[32:35]
    s_waitcnt lgkmcnt(3)
    v_exp_f32 v31, v31
    v_mfma_f32_16x16x32_bf16 v[40:43], v[36:39], v[20:23], 0
    s_waitcnt lgkmcnt(2)
    v_cvt_pk_bf16_f32 v28, v28, v29
    v_cvt_pk_bf16_f32 v29, v30, v31
    v_mfma_f32_16x16x32_bf16 v[40:43], v[52:55], v[24:27], v[40:43]
    s_waitcnt lgkmcnt(1)
    v_mov_b64 v[64:65], s[24:25]
    v_mov_b64 v[66:67], s[24:25]
    v_mfma_f32_16x16x32_bf16 v[40:43], v[56:59], v[72:75], v[40:43]
    s_waitcnt lgkmcnt(0)
    v_exp_f32 v32, v32
    v_mfma_f32_16x16x32_bf16 v[40:43], v[60:63], v[44:47], v[40:43]
    v_exp_f32 v33, v33
    v_smfmac_f32_16x16x64_bf16 v[12:15], v[48:51], v[176:183], v1
    v_exp_f32 v34, v34
    v_smfmac_f32_16x16x64_bf16 v[16:19], v[48:51], v[168:175], v1
    v_exp_f32 v35, v35
    v_cvt_pk_bf16_f32 v30, v32, v33
    v_cvt_pk_bf16_f32 v31, v34, v35
    s_nop 0
    v_exp_f32 v40, v40
    v_mfma_f32_16x16x32_bf16 v[72:75], v[64:67], v[28:31], 0
    v_exp_f32 v41, v41
    v_mfma_f32_16x16x32_bf16 v[20:23], v[80:83], v[28:31], 0
    v_exp_f32 v42, v42
    v_mfma_f32_16x16x32_bf16 v[24:27], v[84:87], v[28:31], 0
    v_exp_f32 v43, v43
    v_cvt_pk_bf16_f32 v40, v40, v41
    v_cvt_pk_bf16_f32 v41, v42, v43
    v_cvt_pk_bf16_f32 v12, v12, v13
    v_cvt_pk_bf16_f32 v13, v14, v15
    v_mfma_f32_16x16x16_bf16 v[72:75], v[10:11], v[40:41], v[72:75]
    v_cvt_pk_bf16_f32 v14, v16, v17
    v_cvt_pk_bf16_f32 v15, v18, v19
M_c0_3_fin:
    v_mfma_f32_16x16x16_bf16 v[20:23], v[12:13], v[40:41], v[20:23]
    s_cmp_eq_u32 s57, 63
    v_cndmask_b32_e64 v76, v12, v60, s[66:67]
    v_cndmask_b32_e64 v77, v13, v61, s[66:67]
    v_mfma_f32_16x16x16_bf16 v[24:27], v[14:15], v[40:41], v[24:27]
    v_cndmask_b32_e64 v78, v14, v62, s[66:67]
    v_cndmask_b32_e64 v79, v15, v63, s[66:67]
    s_cbranch_scc1 M_c0_3_last
    v_rcp_f32 v74, v72
    v_subrev_u32 v73, s68, v72
    v_cmp_lt_u32 vcc, s69, v73
    v_mov_b64 v[44:45], 0
    v_mov_b64 v[46:47], 0
    v_cndmask_b32_e64 v20, v20, v24, s[18:19]
    v_cndmask_b32_e64 v21, v21, v25, s[18:19]
    v_cndmask_b32_e64 v22, v22, v26, s[18:19]
    v_cndmask_b32_e64 v23, v23, v27, s[18:19]
    v_pk_mul_f32 v[20:21], v[20:21], v[74:75] op_sel_hi:[1,0]
    v_pk_mul_f32 v[22:23], v[22:23], v[74:75] op_sel_hi:[1,0]
    v_cvt_pk_bf16_f32 v20, v20, v21
    v_cvt_pk_bf16_f32 v21, v22, v23
    ds_write_b64 v0, v[20:21] offset:14344
    s_cbranch_vccnz M_c0_3_zbad
M_c0_3_zok:
    s_cmp_eq_u32 s57, 0
    s_cbranch_scc1 M_c0_3_first2
M_c0_3_first2_r:
    buffer_load_dwordx4 v[80:83], v0, s[8:11], s3 offen offset:0 sc1
    buffer_load_dwordx4 v[84:87], v0, s[8:11], s3 offen offset:1024 sc1
    s_waitcnt lgkmcnt(0)
    s_barrier
    ds_read_b128 v[32:35], v0 offset:13312
    ds_read_b128 v[52:55], v0 offset:14336
    s_mov_b32 m0, 6144
    s_nop 0
    buffer_load_dwordx4 v0, s[8:11], s26 offen offset:0 sc1 lds
    buffer_load_dwordx4 v0, s[8:11], s26 offen offset:1024 sc1 lds
    v_mov_b64 v[68:69], 0
    v_mov_b64 v[70:71], 0
    v_mov_b64 v[64:65], 0
    v_mov_b64 v[66:67], 0
    v_mov_b64 v[60:61], 0
    v_mov_b64 v[62:63], 0
    v_mov_b64 v[56:57], 0
    v_mov_b64 v[58:59], 0
    s_waitcnt lgkmcnt(1)
    s_nop 0
    v_smfmac_f32_16x16x64_bf16 v[56:59], v[32:35], v[160:167], v1
    v_smfmac_f32_16x16x64_bf16 v[60:63], v[32:35], v[144:151], v1
    s_waitcnt lgkmcnt(0)
    v_smfmac_f32_16x16x64_bf16 v[56:59], v[52:55], v[152:159], v1
    v_smfmac_f32_16x16x64_bf16 v[60:63], v[52:55], v[136:143], v1
    v_smfmac_f32_16x16x64_bf16 v[64:67], v[32:35], v[128:135], v1
    v_smfmac_f32_16x16x64_bf16 v[68:71], v[32:35], v[112:119], v1
    v_permlane32_swap_b32 v56, v57
    v_smfmac_f32_16x16x64_bf16 v[64:67], v[52:55], v[120:127], v1
    v_permlane32_swap_b32 v58, v59
    v_smfmac_f32_16x16x64_bf16 v[68:71], v[52:55], v[104:111], v1
    v_add_f32 v56, v56, v57
    v_add_f32 v58, v58, v59
    v_smfmac_f32_16x16x64_bf16 v[44:47], v[32:35], v[96:103], v1
    v_permlane32_swap_b32 v60, v61
    v_smfmac_f32_16x16x64_bf16 v[44:47], v[52:55], v[88:95], v1
    v_permlane32_swap_b32 v62, v63
    v_add_f32 v60, v60, v61
    v_add_f32 v62, v62, v63
    v_cvt_pk_bf16_f32 v36, v56, v60
    v_cvt_pk_bf16_f32 v38, v58, v62
    v_permlane32_swap_b32 v64, v65
    v_permlane32_swap_b32 v66, v67
    v_add_f32 v64, v64, v65
    v_add_f32 v66, v66, v67
    v_permlane32_swap_b32 v68, v69
    v_permlane32_swap_b32 v70, v71
    v_add_f32 v68, v68, v69
    v_add_f32 v70, v70, v71
    v_cvt_pk_bf16_f32 v37, v64, v68
    v_cvt_pk_bf16_f32 v39, v66, v70
    buffer_store_dwordx4 v[36:39], v0, s[8:11], s58 offen
    v_permlane32_swap_b32 v44, v45
    v_permlane32_swap_b32 v46, v47
    v_add_f32 v44, v44, v45
    v_add_f32 v46, v46, v47
    v_cvt_pk_bf16_f32 v44, v44, v46
    buffer_store_dword v44, v7, s[8:11], s55 offen
    s_add_u32 s27, s44, 1
    s_and_b32 s27, s27, 3
    s_mul_i32 s48, s27, 5120
    s_add_u32 s48, s48, s41
    s_lshl_b32 s27, s27, 15
    s_add_u32 s49, s27, s47
    ds_read_b128 v[56:59], v5 offset:0
    ds_read_b128 v[60:63], v5 offset:1024
    ds_read_b128 v[64:67], v5 offset:2048
    ds_read_b128 v[68:71], v5 offset:3072
    v_mov_b64 v[12:13], 0
    v_mov_b64 v[14:15], 0
    v_mov_b64 v[16:17], 0
    v_mov_b64 v[18:19], 0
    v_mov_b64 v[20:21], 0
    v_mov_b64 v[22:23], 0
    v_mov_b64 v[24:25], 0
    v_mov_b64 v[26:27], 0
    v_mov_b64 v[28:29], 0
    v_mov_b64 v[30:31], 0
    v_mov_b64 v[32:33], 0
    v_mov_b64 v[34:35], 0
    ds_read_b64 v[10:11], v0 offset:23296
    s_waitcnt lgkmcnt(0)
    v_min_u32 v10, v10, v11
    s_nop 0
    v_readfirstlane_b32 s28, v10
    s_nop 0
    s_max_u32 s54, s54, s28
    s_barrier
    s_and_b32 s26, s44, 63
    s_add_u32 s26, s26, 2
    s_min_u32 s26, s26, 63
    s_lshl_b32 s26, s26, 18
    s_add_u32 s26, s26, s50
    s_add_u32 s26, s26, 6144
    s_add_u32 s3, s26, 16777216
    s_lshl_b32 s4, s44, 18
    s_add_u32 s4, s4, s53
    s_add_u32 s44, s44, 1
    s_and_b32 s55, s44, 3
    s_mul_i32 s55, s55, 167936
    s_add_u32 s55, s55, s34
    s_add_u32 s58, s55, s35
    s_and_b32 s57, s44, 63
    s_sub_u32 s61, s26, 6144
    s_nop 15
    s_nop 15
    s_nop 7
    s_mov_b32 m0, 13312
    s_nop 0
    buffer_load_dwordx4 v0, s[8:11], s48 offen offset:3072 sc1 lds
    s_mov_b32 m0, 17408
    s_add_u32 s59, s48, 4096
    buffer_load_dwordx4 v0, s[8:11], s59 offen offset:0 sc1 lds
    s_nop 11
    s_mov_b32 m0, 13312
    s_nop 0
    buffer_load_dwordx4 v0, s[8:11], s48 offen offset:3072 sc1 lds
    s_mov_b32 m0, 17408
    s_add_u32 s59, s48, 4096
    buffer_load_dwordx4 v0, s[8:11], s59 offen offset:0 sc1 lds
    s_nop 11
    s_mov_b32 m0, 13312
    s_nop 0
    buffer_load_dwordx4 v0, s[8:11], s48 offen offset:3072 sc1 lds
    s_mov_b32 m0, 17408
    s_add_u32 s59, s48, 4096
    buffer_load_dwordx4 v0, s[8:11], s59 offen offset:0 sc1 lds
    s_add_u32 s27, s44, 2
    s_or_b32 s28, s44, 63
    s_add_u32 s28, s28, 1
    s_min_u32 s27, s27, s28
    s_cmp_lt_u32 s54, s27
    s_cbranch_scc1 M_c0_3_wkw
M_c0_3_wkw_r:
    s_mov_b32 s70, 0
    s_branch M_c0_3_top
M_c0_3_restart:
    s_waitcnt vmcnt(0) lgkmcnt(0)
    s_nop 7
    s_barrier
    s_mov_b32 m0, 13312
    s_nop 0
    buffer_load_dwordx4 v0, s[8:11], s48 offen offset:3072 sc1 lds
    s_mov_b32 m0, 17408
    s_add_u32 s59, s48, 4096
    buffer_load_dwordx4 v0, s[8:11], s59 offen offset:0 sc1 lds
    ds_read_b128 v[56:59], v5 offset:0
    ds_read_b128 v[60:63], v5 offset:1024
    ds_read_b128 v[64:67], v5 offset:2048
    ds_read_b128 v[68:71], v5 offset:3072
    v_mov_b64 v[12:13], 0
    v_mov_b64 v[14:15], 0
    v_mov_b64 v[16:17], 0
    v_mov_b64 v[18:19], 0
    v_mov_b64 v[20:21], 0
    v_mov_b64 v[22:23], 0
    v_mov_b64 v[24:25], 0
    v_mov_b64 v[26:27], 0
    v_mov_b64 v[28:29], 0
    v_mov_b64 v[30:31], 0
    v_mov_b64 v[32:33], 0
    v_mov_b64 v[34:35], 0
    s_waitcnt vmcnt(0) lgkmcnt(0)
    s_branch M_c0_3_top
M_c0_3_zbad:
    s_cmp_eq_u32 s70, 2
    s_cbranch_scc1 M_c0_3_zok
    v_cmp_u_f32 vcc, v72, v72
    s_cbranch_vccz M_c0_3_exact
    s_cmp_eq_u32 s70, 1
    s_cbranch_scc1 M_c0_3_exact
M_c0_3_vfy0:
    s_mov_b32 s70, 1
    s_mov_b32 s30, 0
    s_waitcnt vmcnt(0) lgkmcnt(0)
    s_nop 7
M_c0_3_vfy:
    v_mov_b32 v10, 0
    s_add_u32 s59, s48, 4096
    buffer_load_dwordx4 v[36:39], v0, s[8:11], s48 offen offset:0 sc1
    buffer_load_dwordx4 v[40:43], v0, s[8:11], s48 offen offset:1024 sc1
    buffer_load_dwordx4 v[44:47], v0, s[8:11], s48 offen offset:2048 sc1
    buffer_load_dwordx4 v[48:51], v0, s[8:11], s48 offen offset:3072 sc1
    buffer_load_dwordx4 v[52:55], v0, s[8:11], s59 offen offset:0 sc1
    s_waitcnt vmcnt(4)
    v_max3_u32 v10, v10, v36, v37
    v_max3_u32 v10, v10, v38, v39
    s_waitcnt vmcnt(3)
    v_max3_u32 v10, v10, v40, v41
    v_max3_u32 v10, v10, v42, v43
    s_waitcnt vmcnt(2)
    v_max3_u32 v10, v10, v44, v45
    v_max3_u32 v10, v10, v46, v47
    s_waitcnt vmcnt(1)
    v_max3_u32 v10, v10, v48, v49
    v_max3_u32 v10, v10, v50, v51
    s_waitcnt vmcnt(0)
    v_max3_u32 v10, v10, v52, v53
    v_max3_u32 v10, v10, v54, v55
    s_add_u32 s59, s49, 4096
    buffer_load_dwordx4 v[36:39], v0, s[8:11], s49 offen offset:0 sc1
    buffer_load_dwordx4 v[40:43], v0, s[8:11], s49 offen offset:1024 sc1
    buffer_load_dwordx4 v[44:47], v0, s[8:11], s49 offen offset:2048 sc1
    buffer_load_dwordx4 v[48:51], v0, s[8:11], s49 offen offset:3072 sc1
    buffer_load_dwordx4 v[52:55], v0, s[8:11], s59 offen offset:0 sc1
    s_waitcnt vmcnt(4)
    v_max3_u32 v10, v10, v36, v37
    v_max3_u32 v10, v10, v38, v39
    s_waitcnt vmcnt(3)
    v_max3_u32 v10, v10, v40, v41
    v_max3_u32 v10, v10, v42, v43
    s_waitcnt vmcnt(2)
    v_max3_u32 v10, v10, v44, v45
    v_max3_u32 v10, v10, v46, v47
    s_waitcnt vmcnt(1)
    v_max3_u32 v10, v10, v48, v49
    v_max3_u32 v10, v10, v50, v51
    s_waitcnt vmcnt(0)
    v_max3_u32 v10, v10, v52, v53
    v_max3_u32 v10, v10, v54, v55
    v_cmp_eq_u32 vcc, -1, v10
    s_cbranch_vccz M_c0_3_restart
    s_add_u32 s30, s30, 1
    s_cmp_ge_u32 s30, 60000
    s_cbranch_scc1 M_fail
    s_branch M_c0_3_vfy
M_c0_3_exact:
    s_nop 7
    s_mov_b32 s70, 2
    s_waitcnt lgkmcnt(0)
    ds_read_b128 v[20:23], v3 offset:18432
    ds_read_b128 v[24:27], v3 offset:18496
    ds_read_b128 v[72:75], v3 offset:18560
    ds_read_b128 v[44:47], v3 offset:18624
    ds_read_b128 v[56:59], v0 offset:0
    s_waitcnt lgkmcnt(0)
    v_mfma_f32_16x16x32_bf16 v[28:31], v[56:59], v[20:23], 0
    s_nop 3
    ds_read_b128 v[60:63], v0 offset:1024
    s_waitcnt lgkmcnt(0)
    v_mfma_f32_16x16x32_bf16 v[28:31], v[60:63], v[24:27], v[28:31]
    s_nop 3
    ds_read_b128 v[56:59], v0 offset:2048
    s_waitcnt lgkmcnt(0)
    v_mfma_f32_16x16x32_bf16 v[28:31], v[56:59], v[72:75], v[28:31]
    s_nop 3
    ds_read_b128 v[60:63], v0 offset:3072
    s_waitcnt lgkmcnt(0)
    v_mfma_f32_16x16x32_bf16 v[28:31], v[60:63], v[44:47], v[28:31]
    s_nop 3
    ds_read_b128 v[56:59], v0 offset:4096
    s_waitcnt lgkmcnt(0)
    v_mfma_f32_16x16x32_bf16 v[32:35], v[56:59], v[20:23], 0
    s_nop 3
    ds_read_b128 v[60:63], v0 offset:5120
    s_waitcnt lgkmcnt(0)
    v_mfma_f32_16x16x32_bf16 v[32:35], v[60:63], v[24:27], v[32:35]
    s_nop 3
    ds_read_b128 v[56:59], v0 offset:6144
    s_waitcnt lgkmcnt(0)
    v_mfma_f32_16x16x32_bf16 v[32:35], v[56:59], v[72:75], v[32:35]
    s_nop 3
    ds_read_b128 v[60:63], v0 offset:7168
    s_waitcnt lgkmcnt(0)
    v_mfma_f32_16x16x32_bf16 v[32:35], v[60:63], v[44:47], v[32:35]
    s_nop 3
    ds_read_b128 v[56:59], v3 offset:20736
    s_waitcnt lgkmcnt(0)
    v_mfma_f32_16x16x32_bf16 v[40:43], v[56:59], v[20:23], 0
    s_nop 3
    ds_read_b128 v[60:63], v3 offset:20800
    s_waitcnt lgkmcnt(0)
    v_mfma_f32_16x16x32_bf16 v[40:43], v[60:63], v[24:27], v[40:43]
    s_nop 3
    ds_read_b128 v[56:59], v3 offset:20864
    s_waitcnt lgkmcnt(0)
    v_mfma_f32_16x16x32_bf16 v[40:43], v[56:59], v[72:75], v[40:43]
    s_nop 3
    ds_read_b128 v[60:63], v3 offset:20928
    s_waitcnt lgkmcnt(0)
    v_mfma_f32_16x16x32_bf16 v[40:43], v[60:63], v[44:47], v[40:43]
    s_nop 3
    v_max3_f32 v68, v28, v29, v30
    v_max3_f32 v68, v68, v31, v32
    v_max3_f32 v68, v68, v33, v34
    s_nop 0
    v_max3_f32 v68, v68, v35, v40
    v_max3_f32 v68, v68, v41, v42
    v_max_f32 v68, v68, v43
    v_mov_b32 v69, v68
    s_nop 1
    v_permlane16_swap_b32 v68, v69
    v_max_f32 v68, v68, v69
    v_mov_b32 v69, v68
    s_nop 1
    v_permlane32_swap_b32 v68, v69
    v_max_f32 v68, v68, v69
    v_sub_f32 v28, v28, v68
    v_exp_f32 v28, v28
    v_sub_f32 v29, v29, v68
    v_exp_f32 v29, v29
    v_sub_f32 v30, v30, v68
    v_exp_f32 v30, v30
    v_sub_f32 v31, v31, v68
    v_exp_f32 v31, v31
    v_sub_f32 v32, v32, v68
    v_exp_f32 v32, v32
    v_sub_f32 v33, v33, v68
    v_exp_f32 v33, v33
    v_sub_f32 v34, v34, v68
    v_exp_f32 v34, v34
    v_sub_f32 v35, v35, v68
    v_exp_f32 v35, v35
    v_sub_f32 v40, v40, v68
    v_exp_f32 v40, v40
    v_sub_f32 v41, v41, v68
    v_exp_f32 v41, v41
    v_sub_f32 v42, v42, v68
    v_exp_f32 v42, v42
    v_sub_f32 v43, v43, v68
    v_exp_f32 v43, v43
    v_cvt_pk_bf16_f32 v28, v28, v29
    v_cvt_pk_bf16_f32 v29, v30, v31
    v_cvt_pk_bf16_f32 v30, v32, v33
    v_cvt_pk_bf16_f32 v31, v34, v35
    v_cvt_pk_bf16_f32 v40, v40, v41
    v_cvt_pk_bf16_f32 v41, v42, v43
    v_mfma_f32_16x16x32_bf16 v[20:23], v[80:83], v[28:31], 0
    v_mfma_f32_16x16x32_bf16 v[24:27], v[84:87], v[28:31], 0
    v_mfma_f32_16x16x32_bf16 v[72:75], v[64:67], v[28:31], 0
    ds_read_b128 v[60:63], v3 offset:20928
    s_waitcnt lgkmcnt(0)
    s_nop 7
    v_mfma_f32_16x16x16_bf16 v[72:75], v[10:11], v[40:41], v[72:75]
    s_nop 7
    s_branch M_c0_3_fin
M_c0_3_last:
    s_cmp_lg_u32 s70, 0
    s_cbranch_scc1 M_c0_3_last2
    v_cmp_u_f32 vcc, v32, v32
    s_cbranch_vccnz M_c0_3_vfy0
M_c0_3_last2:
    s_lshl_b32 s4, s44, 18
    s_add_u32 s4, s4, s53
    buffer_store_dwordx4 v[76:79], v0, s[8:11], s4 offen offset:3072 sc1
    s_mov_b32 s4, 0x10000000
    s_waitcnt vmcnt(0) lgkmcnt(0)
    s_barrier
    s_nop 7
    v_mov_b64 v[72:73], -1
    v_mov_b64 v[74:75], -1
    s_add_u32 s28, s44, 3
    s_and_b32 s29, s28, 3
    s_mul_i32 s31, s22, 160
    s_waitcnt vmcnt(0)
    s_add_u32 s44, s44, 1
    s_cmp_eq_u32 s44, 128
    s_cbranch_scc1 M_end
    s_branch M_c0_3_layer
M_c0_3_lr:
    s_mov_b32 s30, 0
M_c0_3_lr_l:
    s_waitcnt lgkmcnt(0)
    s_and_b32 s27, s30, 1
    s_cbranch_scc0 M_c0_3_lr_n
    s_waitcnt vmcnt(2)
    s_mov_b32 m0, 13312
    s_nop 0
    buffer_load_dwordx4 v0, s[8:11], s48 offen offset:3072 sc1 lds
    s_mov_b32 m0, 17408
    s_add_u32 s59, s48, 4096
    buffer_load_dwordx4 v0, s[8:11], s59 offen offset:0 sc1 lds
M_c0_3_lr_n:
    ds_read_b128 v[36:39], v6 offset:13312
    ds_read_b128 v[40:43], v6 offset:14336
    ds_read_b128 v[44:47], v6 offset:15360
    ds_read_b128 v[48:51], v6 offset:16384
    ds_read_b128 v[52:55], v6 offset:17408
    s_waitcnt lgkmcnt(2)
    v_max3_u32 v10, v36, v40, v44
    s_waitcnt lgkmcnt(0)
    v_max3_u32 v10, v10, v48, v52
    v_cmp_eq_u32 vcc, -1, v10
    s_cbranch_vccz M_c0_3_lr_d
    s_add_u32 s30, s30, 1
    s_cmp_ge_u32 s30, 480000
    s_cbranch_scc1 M_fail
    s_branch M_c0_3_lr_l
M_c0_3_lr_d:
    ds_read_b128 v[56:59], v5 offset:0
    ds_read_b128 v[60:63], v5 offset:1024
    ds_read_b128 v[64:67], v5 offset:2048
    ds_read_b128 v[68:71], v5 offset:3072
    v_mov_b64 v[12:13], 0
    v_mov_b64 v[14:15], 0
    v_mov_b64 v[16:17], 0
    v_mov_b64 v[18:19], 0
    v_mov_b64 v[20:21], 0
    v_mov_b64 v[22:23], 0
    v_mov_b64 v[24:25], 0
    v_mov_b64 v[26:27], 0
    v_mov_b64 v[28:29], 0
    v_mov_b64 v[30:31], 0
    v_mov_b64 v[32:33], 0
    v_mov_b64 v[34:35], 0
    s_waitcnt lgkmcnt(0)
    s_branch M_c0_3_lr_r
M_c0_3_rr:
    s_mov_b32 s30, 0
M_c0_3_rr_l:
    s_waitcnt lgkmcnt(0)
    s_and_b32 s27, s30, 1
    s_cbranch_scc1 M_c0_3_rr_n
    s_waitcnt vmcnt(1)
    s_mov_b32 m0, 12288
    s_add_u32 s59, s49, 4096
    buffer_load_dwordx4 v0, s[8:11], s59 offen offset:0 sc1 lds
M_c0_3_rr_n:
    ds_read_b128 v[36:39], v6 offset:8192
    ds_read_b128 v[40:43], v6 offset:9216
    ds_read_b128 v[44:47], v6 offset:10240
    ds_read_b128 v[48:51], v6 offset:11264
    ds_read_b32 v11, v6 offset:12288
    s_waitcnt lgkmcnt(2)
    v_max3_u32 v10, v36, v40, v44
    s_waitcnt lgkmcnt(0)
    v_max3_u32 v10, v10, v48, v11
    v_cmp_eq_u32 vcc, -1, v10
    s_cbranch_vccz M_c0_3_rr_d
    s_add_u32 s30, s30, 1
    s_cmp_ge_u32 s30, 480000
    s_cbranch_scc1 M_fail
    s_branch M_c0_3_rr_l
M_c0_3_rr_d:
    s_branch M_c0_3_rr_r
M_c0_3_first:
    s_mul_i32 s27, s21, 167936
    s_add_u32 s27, s27, s34
    s_mul_i32 s28, s22, 4224
    s_add_u32 s28, s28, s27
    s_mov_b32 exec_hi, 0
    buffer_load_dword v10, v9, s[8:11], s28 offen sc1
    s_lshl_b32 s28, s22, 10
    s_add_u32 s28, s28, s27
    s_add_u32 s28, s28, 135168
    s_mov_b64 exec, 0xff
    buffer_load_dword v10, v9, s[8:11], s28 offen sc1
    s_mul_i32 s27, s21, 5120
    s_add_u32 s27, s27, s41
    s_mul_i32 s28, s22, 160
    s_add_u32 s28, s28, s27
    s_mov_b64 exec, 3
    buffer_load_dword v10, v9, s[8:11], s28 offen sc1
    s_mov_b64 exec, -1
    s_add_u32 s27, s44, 1
    s_or_b32 s28, s44, 63
    s_add_u32 s28, s28, 1
    s_min_u32 s27, s27, s28
    s_cmp_lt_u32 s54, s27
    s_cbranch_scc1 M_c0_3_p1
M_c0_3_p1_r:
    s_barrier
    s_and_b32 s26, s44, 63
    s_lshl_b32 s26, s26, 18
    s_add_u32 s26, s26, s50
    s_add_u32 s26, s26, 6144
    s_add_u32 s3, s26, 16777216
    s_mov_b32 m0, 6144
    s_nop 0
    buffer_load_dwordx4 v0, s[8:11], s26 offen offset:0 sc1 lds
    buffer_load_dwordx4 v0, s[8:11], s26 offen offset:1024 sc1 lds
    buffer_load_dwordx4 v[80:83], v0, s[8:11], s3 offen offset:0 sc1
    buffer_load_dwordx4 v[84:87], v0, s[8:11], s3 offen offset:1024 sc1
    s_and_b32 s26, s44, 63
    s_add_u32 s26, s26, 1
    s_min_u32 s26, s26, 63
    s_lshl_b32 s26, s26, 18
    s_add_u32 s26, s26, s50
    s_add_u32 s26, s26, 6144
    s_add_u32 s3, s26, 16777216
    s_waitcnt vmcnt(0) lgkmcnt(0)
    s_barrier
    s_branch M_c0_3_first_r
M_c0_3_first2:
    s_add_u32 s27, s44, 2
    s_or_b32 s28, s44, 63
    s_add_u32 s28, s28, 1
    s_min_u32 s27, s27, s28
    s_cmp_lt_u32 s54, s27
    s_cbranch_scc1 M_c0_3_p2
M_c0_3_p2_r:
    s_barrier
    s_branch M_c0_3_first2_r
M_c0_3_wkw:
    s_mov_b32 s30, 0
M_c0_3_wkw_l:
    s_waitcnt lgkmcnt(0)
    s_mov_b64 exec, 3
    buffer_load_dword v10, v9, s[8:11], s51 offen sc1
    s_waitcnt vmcnt(0)
    s_mov_b64 exec, -1
    v_readlane_b32 s54, v10, 0
    v_readlane_b32 s28, v10, 1
    s_nop 3
    s_min_u32 s54, s54, s28
    s_cmp_ge_u32 s54, s27
    s_cbranch_scc1 M_c0_3_wkw_r
    s_sleep 2
    s_add_u32 s30, s30, 1
    s_cmp_ge_u32 s30, 240000
    s_cbranch_scc1 M_fail
    s_branch M_c0_3_wkw_l
M_c0_3_p1:
    s_mov_b32 s30, 0
M_c0_3_p1_l:
    s_waitcnt lgkmcnt(0)
    s_mov_b64 exec, 3
    buffer_load_dword v10, v9, s[8:11], s51 offen sc1
    s_waitcnt vmcnt(0)
    s_mov_b64 exec, -1
    v_readlane_b32 s54, v10, 0
    v_readlane_b32 s28, v10, 1
    s_nop 3
    s_min_u32 s54, s54, s28
    s_cmp_ge_u32 s54, s27
    s_cbranch_scc1 M_c0_3_p1_r
    s_sleep 2
    s_add_u32 s30, s30, 1
    s_cmp_ge_u32 s30, 240000
    s_cbranch_scc1 M_fail
    s_branch M_c0_3_p1_l
M_c0_3_p2:
    s_mov_b32 s30, 0
M_c0_3_p2_l:
    s_waitcnt lgkmcnt(0)
    s_mov_b64 exec, 3
    buffer_load_dword v10, v9, s[8:11], s51 offen sc1
    s_waitcnt vmcnt(0)
    s_mov_b64 exec, -1
    v_readlane_b32 s54, v10, 0
    v_readlane_b32 s28, v10, 1
    s_nop 3
    s_min_u32 s54, s54, s28
    s_cmp_ge_u32 s54, s27
    s_cbranch_scc1 M_c0_3_p2_r
    s_sleep 2
    s_add_u32 s30, s30, 1
    s_cmp_ge_u32 s30, 240000
    s_cbranch_scc1 M_fail
    s_branch M_c0_3_p2_l
M_c_slow:
    s_cmp_eq_u32 s21, 1
    s_cbranch_scc1 M_c1_1_layer
    s_cmp_eq_u32 s21, 2
    s_cbranch_scc1 M_c1_2_layer
    s_cmp_eq_u32 s21, 3
    s_cbranch_scc1 M_c1_3_layer
M_c1_0_layer:
    s_lshr_b32 s27, s44, 6
    s_mul_i32 s50, s27, 33554432
    s_lshl_b32 s27, s22, 13
    s_add_u32 s50, s50, s27
    s_add_u32 s50, s50, 37748736
    s_barrier
    s_mov_b32 s26, 0x10010000
    s_mov_b32 s3, s26
    s_mul_i32 s27, s20, 5120
    s_add_u32 s48, s27, 167772160
    s_sub_u32 s49, 167777280, s27
    s_and_b32 s55, s44, 3
    s_mul_i32 s55, s55, 167936
    s_add_u32 s55, s55, s34
    s_add_u32 s58, s55, s35
    s_and_b32 s57, s44, 63
    s_add_u32 s43, s55, s32
    s_add_u32 s61, s43, 33792
    s_add_u32 s100, s43, 67584
    s_add_u32 s101, s43, 101376
    ds_read_b128 v[56:59], v5 offset:0
    ds_read_b128 v[60:63], v5 offset:1024
    ds_read_b128 v[64:67], v5 offset:2048
    ds_read_b128 v[68:71], v5 offset:3072
    v_mov_b64 v[12:13], 0
    v_mov_b64 v[14:15], 0
    v_mov_b64 v[16:17], 0
    v_mov_b64 v[18:19], 0
    v_mov_b64 v[20:21], 0
    v_mov_b64 v[22:23], 0
    v_mov_b64 v[24:25], 0
    v_mov_b64 v[26:27], 0
    v_mov_b64 v[28:29], 0
    v_mov_b64 v[30:31], 0
    v_mov_b64 v[32:33], 0
    v_mov_b64 v[34:35], 0
    s_mov_b32 s70, 0
    s_waitcnt lgkmcnt(0)
M_c1_0_top:
    s_nop 0
    s_barrier
    ds_read_b128 v[36:39], v6 offset:13312
    ds_read_b128 v[40:43], v6 offset:14336
    s_mov_b32 m0, 8192
    s_nop 0
    buffer_load_dwordx4 v0, s[8:11], s49 offen offset:0 sc1 lds
    buffer_load_dwordx4 v0, s[8:11], s49 offen offset:1024 sc1 lds
M_c1_0_lr_r:
    s_waitcnt lgkmcnt(1)
    v_smfmac_f32_16x16x64_bf16 v[20:23], v[36:39], v[56:63], v1
    ds_read_b128 v[56:59], v5 offset:4096
    v_smfmac_f32_16x16x64_bf16 v[24:27], v[36:39], v[64:71], v1
    ds_read_b128 v[60:63], v5 offset:5120
    v_smfmac_f32_16x16x64_bf16 v[28:31], v[36:39], a[248:255], v1
    ds_read_b128 v[64:67], v5 offset:6144
    v_smfmac_f32_16x16x64_bf16 v[32:35], v[36:39], a[240:247], v1
    ds_read_b128 v[68:71], v5 offset:7168
    v_smfmac_f32_16x16x64_bf16 v[12:15], v[36:39], a[232:239], v1
    ds_read_b128 v[44:47], v6 offset:15360
    s_waitcnt lgkmcnt(3)
    v_smfmac_f32_16x16x64_bf16 v[16:19], v[36:39], v[56:63], v1
    ds_read_b128 v[56:59], v5 offset:8192
    v_smfmac_f32_16x16x64_bf16 v[20:23], v[40:43], a[224:231], v1
    ds_read_b128 v[60:63], v5 offset:9216
    s_waitcnt lgkmcnt(3)
    v_smfmac_f32_16x16x64_bf16 v[24:27], v[40:43], v[64:71], v1
    ds_read_b128 v[64:67], v5 offset:10240
    v_smfmac_f32_16x16x64_bf16 v[28:31], v[40:43], a[216:223], v1
    ds_read_b128 v[68:71], v5 offset:11264
    v_smfmac_f32_16x16x64_bf16 v[32:35], v[40:43], a[208:215], v1
    ds_read_b128 v[48:51], v6 offset:16384
    s_waitcnt lgkmcnt(3)
    v_smfmac_f32_16x16x64_bf16 v[12:15], v[40:43], v[56:63], v1
    ds_read_b128 v[56:59], v5 offset:12288
    v_smfmac_f32_16x16x64_bf16 v[16:19], v[40:43], a[200:207], v1
    ds_read_b128 v[60:63], v5 offset:13312
    s_waitcnt lgkmcnt(3)
    v_smfmac_f32_16x16x64_bf16 v[20:23], v[44:47], v[64:71], v1
    ds_read_b128 v[64:67], v5 offset:14336
    v_smfmac_f32_16x16x64_bf16 v[24:27], v[44:47], a[192:199], v1
    ds_read_b128 v[68:71], v5 offset:15360
    v_smfmac_f32_16x16x64_bf16 v[28:31], v[44:47], a[184:191], v1
    ds_read_b128 v[52:55], v6 offset:17408
    s_waitcnt lgkmcnt(3)
    v_smfmac_f32_16x16x64_bf16 v[32:35], v[44:47], v[56:63], v1
    ds_read_b128 v[56:59], v5 offset:16384
    v_smfmac_f32_16x16x64_bf16 v[20:23], v[48:51], a[176:183], v1
    ds_read_b128 v[60:63], v5 offset:17408
    s_waitcnt lgkmcnt(3)
    v_max3_u32 v10, v36, v40, v44
    v_smfmac_f32_16x16x64_bf16 v[24:27], v[48:51], v[64:71], v1
    ds_read_b128 v[64:67], v5 offset:18432
    s_waitcnt lgkmcnt(3)
    v_max3_u32 v10, v10, v48, v52
    v_smfmac_f32_16x16x64_bf16 v[28:31], v[48:51], a[168:175], v1
    ds_read_b128 v[68:71], v5 offset:19456
    v_cmp_eq_u32 vcc, -1, v10
    v_smfmac_f32_16x16x64_bf16 v[32:35], v[48:51], a[160:167], v1
    s_cbranch_vccnz M_c1_0_lr
    s_waitcnt vmcnt(0)
    s_barrier
    ds_read_b128 v[36:39], v6 offset:8192
    ds_read_b128 v[40:43], v6 offset:9216
    s_waitcnt lgkmcnt(4)
    v_smfmac_f32_16x16x64_bf16 v[20:23], v[52:55], v[56:63], v1
    ds_read_b128 v[44:47], v6 offset:10240
    ds_read_b128 v[48:51], v6 offset:11264
    v_smfmac_f32_16x16x64_bf16 v[24:27], v[52:55], a[152:159], v1
    ds_read_b32 v11, v6 offset:12288
    ds_read_b128 v[56:59], v5 offset:20480
    s_waitcnt lgkmcnt(6)
    v_smfmac_f32_16x16x64_bf16 v[28:31], v[52:55], v[64:71], v1
    ds_read_b128 v[60:63], v5 offset:21504
    s_waitcnt lgkmcnt(4)
    v_max3_u32 v10, v36, v40, v44
    v_smfmac_f32_16x16x64_bf16 v[32:35], v[52:55], a[144:151], v1
    s_waitcnt lgkmcnt(2)
    v_max3_u32 v10, v10, v48, v11
    v_cmp_eq_u32 vcc, -1, v10
    s_cbranch_vccnz M_c1_0_rr
M_c1_0_rr_r:
    ds_read_b128 v[64:67], v5 offset:22528
    ds_read_b128 v[68:71], v5 offset:23552
    ds_read_b128 v[52:55], v6 offset:12288
    buffer_store_dwordx4 v[76:79], v0, s[8:11], s4 offen offset:0 sc1
    s_mov_b32 s4, 0x10000000
    s_mov_b64 exec, 0x3ff
    buffer_store_dwordx4 v[72:75], v0, s[8:11], s60 offen sc1
    s_mov_b64 exec, -1
    s_mov_b32 s60, 0x10000000
    v_smfmac_f32_16x16x64_bf16 v[20:23], v[36:39], a[136:143], v1
    s_waitcnt lgkmcnt(3)
    v_smfmac_f32_16x16x64_bf16 v[24:27], v[36:39], v[56:63], v1
    ds_read_b128 v[56:59], v5 offset:24576
    v_smfmac_f32_16x16x64_bf16 v[20:23], v[40:43], a[128:135], v1
    ds_read_b128 v[60:63], v5 offset:25600
    s_waitcnt lgkmcnt(3)
    v_smfmac_f32_16x16x64_bf16 v[24:27], v[40:43], v[64:71], v1
    ds_read_b128 v[64:67], v5 offset:26624
    v_smfmac_f32_16x16x64_bf16 v[20:23], v[44:47], a[120:127], v1
    ds_read_b128 v[68:71], v5 offset:27648
    v_smfmac_f32_16x16x64_bf16 v[24:27], v[44:47], a[112:119], v1
    s_waitcnt lgkmcnt(2)
    v_smfmac_f32_16x16x64_bf16 v[20:23], v[48:51], v[56:63], v1
    ds_read_b128 v[56:59], v5 offset:28672
    v_smfmac_f32_16x16x64_bf16 v[24:27], v[48:51], a[104:111], v1
    ds_read_b128 v[60:63], v5 offset:29696
    s_waitcnt lgkmcnt(2)
    v_smfmac_f32_16x16x64_bf16 v[20:23], v[52:55], v[64:71], v1
    ds_read_b128 v[64:67], v5 offset:30720
    v_smfmac_f32_16x16x64_bf16 v[24:27], v[52:55], a[96:103], v1
    ds_read_b128 v[68:71], v5 offset:31744
    v_smfmac_f32_16x16x64_bf16 v[28:31], v[36:39], a[88:95], v1
    s_cmp_eq_u32 s57, 0
    s_cbranch_scc1 M_c1_0_first
M_c1_0_first_r:
    s_waitcnt lgkmcnt(2)
    v_smfmac_f32_16x16x64_bf16 v[32:35], v[36:39], v[56:63], v1
    ds_read_b128 v[56:59], v5 offset:32768
    v_permlane32_swap_b32 v20, v21
    v_smfmac_f32_16x16x64_bf16 v[28:31], v[40:43], a[80:87], v1
    ds_read_b128 v[60:63], v5 offset:33792
    s_waitcnt lgkmcnt(2)
    v_permlane32_swap_b32 v22, v23
    v_smfmac_f32_16x16x64_bf16 v[32:35], v[40:43], v[64:71], v1
    ds_read_b128 v[64:67], v0 offset:2048
    v_permlane32_swap_b32 v24, v25
    v_smfmac_f32_16x16x64_bf16 v[28:31], v[44:47], a[72:79], v1
    ds_read_b128 v[68:71], v0 offset:3072
    v_permlane32_swap_b32 v26, v27
    v_smfmac_f32_16x16x64_bf16 v[32:35], v[44:47], a[64:71], v1
    s_waitcnt lgkmcnt(2)
    v_add_f32 v20, v20, v21
    v_add_f32 v22, v22, v23
    v_smfmac_f32_16x16x64_bf16 v[28:31], v[48:51], v[56:63], v1
    ds_read_b128 v[56:59], v0 offset:0
    v_add_f32 v24, v24, v25
    v_add_f32 v26, v26, v27
    v_smfmac_f32_16x16x64_bf16 v[32:35], v[48:51], a[56:63], v1
    ds_read_b128 v[60:63], v0 offset:1024
    v_mul_f32 v20, s40, v20
    v_mul_f32 v24, s40, v24
    v_smfmac_f32_16x16x64_bf16 v[28:31], v[52:55], a[48:55], v1
    v_mul_f32 v22, s40, v22
    v_mul_f32 v26, s40, v26
    v_smfmac_f32_16x16x64_bf16 v[32:35], v[52:55], a[40:47], v1
    v_cvt_pk_bf16_f32 v20, v20, v24
    v_cvt_pk_bf16_f32 v21, v22, v26
    v_smfmac_f32_16x16x64_bf16 v[12:15], v[36:39], a[32:39], v1
    ds_write_b32 v2, v20 offset:18432
    v_smfmac_f32_16x16x64_bf16 v[16:19], v[36:39], a[24:31], v1
    ds_write_b32 v2, v21 offset:19008
    v_permlane32_swap_b32 v28, v29
    v_smfmac_f32_16x16x64_bf16 v[12:15], v[40:43], a[16:23], v1
    ds_read_b128 v[36:39], v6 offset:15360
    v_permlane32_swap_b32 v30, v31
    v_smfmac_f32_16x16x64_bf16 v[16:19], v[40:43], a[8:15], v1
    ds_read_b128 v[40:43], v6 offset:16384
    v_permlane32_swap_b32 v32, v33
    v_smfmac_f32_16x16x64_bf16 v[12:15], v[44:47], a[0:7], v1
    s_waitcnt lgkmcnt(2)
    s_barrier
    v_permlane32_swap_b32 v34, v35
    v_smfmac_f32_16x16x64_bf16 v[16:19], v[44:47], v[248:255], v1
    ds_read_b128 v[20:23], v3 offset:18432
    v_add_f32 v28, v28, v29
    v_add_f32 v30, v30, v31
    v_smfmac_f32_16x16x64_bf16 v[12:15], v[48:51], v[240:247], v1
    ds_read_b128 v[24:27], v3 offset:18496
    v_add_f32 v32, v32, v33
    v_add_f32 v34, v34, v35
    v_smfmac_f32_16x16x64_bf16 v[16:19], v[48:51], v[232:239], v1
    ds_read_b128 v[72:75], v3 offset:18560
    v_cvt_pk_bf16_f32 v28, v28, v32
    v_cvt_pk_bf16_f32 v29, v30, v34
    v_smfmac_f32_16x16x64_bf16 v[12:15], v[52:55], v[224:231], v1
    ds_write_b32 v2, v28 offset:20736
    ds_read_b128 v[44:47], v3 offset:18624
    v_smfmac_f32_16x16x64_bf16 v[16:19], v[52:55], v[216:223], v1
    ds_write_b32 v2, v29 offset:21312
    s_waitcnt lgkmcnt(7)
    v_smfmac_f32_16x16x64_bf16 v[12:15], v[36:39], v[208:215], v1
    ds_read_b128 v[48:51], v6 offset:17408
    v_mov_b64 v[10:11], s[16:17]
    v_smfmac_f32_16x16x64_bf16 v[16:19], v[36:39], v[200:207], v1
    s_waitcnt lgkmcnt(6)
    v_mfma_f32_16x16x32_bf16 v[28:31], v[56:59], v[20:23], 0
    ds_read_b128 v[56:59], v0 offset:4096
    s_waitcnt lgkmcnt(6)
    v_mfma_f32_16x16x32_bf16 v[28:31], v[60:63], v[24:27], v[28:31]
    ds_read_b128 v[60:63], v0 offset:5120
    s_waitcnt lgkmcnt(3)
    s_barrier
    v_mfma_f32_16x16x32_bf16 v[28:31], v[64:67], v[72:75], v[28:31]
    ds_read_b128 v[64:67], v0 offset:6144
    v_mfma_f32_16x16x32_bf16 v[28:31], v[68:71], v[44:47], v[28:31]
    ds_read_b128 v[68:71], v0 offset:7168
    v_smfmac_f32_16x16x64_bf16 v[12:15], v[40:43], v[192:199], v1
    ds_read_b128 v[36:39], v3 offset:20736
    v_smfmac_f32_16x16x64_bf16 v[16:19], v[40:43], v[184:191], v1
    ds_read_b128 v[52:55], v3 offset:20800
    s_waitcnt lgkmcnt(4)
    v_mfma_f32_16x16x32_bf16 v[32:35], v[56:59], v[20:23], 0
    s_nop 0
    v_exp_f32 v28, v28
    ds_read_b128 v[56:59], v3 offset:20864
    v_mfma_f32_16x16x32_bf16 v[32:35], v[60:63], v[24:27], v[32:35]
    s_waitcnt lgkmcnt(3)
    v_exp_f32 v29, v29
    ds_read_b128 v[60:63], v3 offset:20928
    v_mfma_f32_16x16x32_bf16 v[32:35], v[64:67], v[72:75], v[32:35]
    v_exp_f32 v30, v30
    v_mfma_f32_16x16x32_bf16 v[32:35], v[68:71], v[44:47], v[32:35]
    s_waitcnt lgkmcnt(3)
    v_exp_f32 v31, v31
    v_mfma_f32_16x16x32_bf16 v[40:43], v[36:39], v[20:23], 0
    s_waitcnt lgkmcnt(2)
    v_cvt_pk_bf16_f32 v28, v28, v29
    v_cvt_pk_bf16_f32 v29, v30, v31
    v_mfma_f32_16x16x32_bf16 v[40:43], v[52:55], v[24:27], v[40:43]
    s_waitcnt lgkmcnt(1)
    v_mov_b64 v[64:65], s[24:25]
    v_mov_b64 v[66:67], s[24:25]
    v_mfma_f32_16x16x32_bf16 v[40:43], v[56:59], v[72:75], v[40:43]
    s_waitcnt lgkmcnt(0)
    v_exp_f32 v32, v32
    v_mfma_f32_16x16x32_bf16 v[40:43], v[60:63], v[44:47], v[40:43]
    v_exp_f32 v33, v33
    v_smfmac_f32_16x16x64_bf16 v[12:15], v[48:51], v[176:183], v1
    v_exp_f32 v34, v34
    v_smfmac_f32_16x16x64_bf16 v[16:19], v[48:51], v[168:175], v1
    v_exp_f32 v35, v35
    v_cvt_pk_bf16_f32 v30, v32, v33
    v_cvt_pk_bf16_f32 v31, v34, v35
    s_nop 0
    v_exp_f32 v40, v40
    v_mfma_f32_16x16x32_bf16 v[72:75], v[64:67], v[28:31], 0
    v_exp_f32 v41, v41
    v_mfma_f32_16x16x32_bf16 v[20:23], v[80:83], v[28:31], 0
    v_exp_f32 v42, v42
    v_mfma_f32_16x16x32_bf16 v[24:27], v[84:87], v[28:31], 0
    v_exp_f32 v43, v43
    v_cvt_pk_bf16_f32 v40, v40, v41
    v_cvt_pk_bf16_f32 v41, v42, v43
    v_cvt_pk_bf16_f32 v12, v12, v13
    v_cvt_pk_bf16_f32 v13, v14, v15
    v_mfma_f32_16x16x16_bf16 v[72:75], v[10:11], v[40:41], v[72:75]
    v_cvt_pk_bf16_f32 v14, v16, v17
    v_cvt_pk_bf16_f32 v15, v18, v19
M_c1_0_fin:
    v_mfma_f32_16x16x16_bf16 v[20:23], v[12:13], v[40:41], v[20:23]
    s_cmp_eq_u32 s57, 63
    v_cndmask_b32_e64 v76, v12, v36, s[66:67]
    v_cndmask_b32_e64 v77, v13, v37, s[66:67]
    v_mfma_f32_16x16x16_bf16 v[24:27], v[14:15], v[40:41], v[24:27]
    v_cndmask_b32_e64 v78, v14, v38, s[66:67]
    v_cndmask_b32_e64 v79, v15, v39, s[66:67]
    s_cbranch_scc1 M_c1_0_last
    v_rcp_f32 v74, v72
    v_subrev_u32 v73, s68, v72
    v_cmp_lt_u32 vcc, s69, v73
    v_mov_b64 v[44:45], 0
    v_mov_b64 v[46:47], 0
    v_cndmask_b32_e64 v20, v20, v24, s[18:19]
    v_cndmask_b32_e64 v21, v21, v25, s[18:19]
    v_cndmask_b32_e64 v22, v22, v26, s[18:19]
    v_cndmask_b32_e64 v23, v23, v27, s[18:19]
    v_pk_mul_f32 v[20:21], v[20:21], v[74:75] op_sel_hi:[1,0]
    v_pk_mul_f32 v[22:23], v[22:23], v[74:75] op_sel_hi:[1,0]
    v_cvt_pk_bf16_f32 v20, v20, v21
    v_cvt_pk_bf16_f32 v21, v22, v23
    ds_write_b64 v0, v[20:21] offset:13312
    s_cbranch_vccnz M_c1_0_zbad
M_c1_0_zok:
    s_cmp_eq_u32 s57, 0
    s_cbranch_scc1 M_c1_0_first2
M_c1_0_first2_r:
    buffer_load_dwordx4 v[80:83], v0, s[8:11], s3 offen offset:0 sc1
    buffer_load_dwordx4 v[84:87], v0, s[8:11], s3 offen offset:1024 sc1
    s_waitcnt lgkmcnt(0)
    s_barrier
    ds_read_b128 v[32:35], v0 offset:13312
    ds_read_b128 v[52:55], v0 offset:14336
    s_mov_b32 m0, 0
    s_nop 0
    buffer_load_dwordx4 v0, s[8:11], s26 offen offset:0 sc1 lds
    buffer_load_dwordx4 v0, s[8:11], s26 offen offset:1024 sc1 lds
    v_mov_b64 v[68:69], 0
    v_mov_b64 v[70:71], 0
    v_mov_b64 v[64:65], 0
    v_mov_b64 v[66:67], 0
    v_mov_b64 v[60:61], 0
    v_mov_b64 v[62:63], 0
    v_mov_b64 v[56:57], 0
    v_mov_b64 v[58:59], 0
    s_waitcnt lgkmcnt(1)
    s_nop 0
    v_smfmac_f32_16x16x64_bf16 v[56:59], v[32:35], v[160:167], v1
    v_smfmac_f32_16x16x64_bf16 v[60:63], v[32:35], v[144:151], v1
    s_waitcnt lgkmcnt(0)
    v_smfmac_f32_16x16x64_bf16 v[56:59], v[52:55], v[152:159], v1
    v_smfmac_f32_16x16x64_bf16 v[60:63], v[52:55], v[136:143], v1
    v_smfmac_f32_16x16x64_bf16 v[64:67], v[32:35], v[128:135], v1
    v_smfmac_f32_16x16x64_bf16 v[68:71], v[32:35], v[112:119], v1
    v_permlane32_swap_b32 v56, v57
    v_smfmac_f32_16x16x64_bf16 v[64:67], v[52:55], v[120:127], v1
    v_permlane32_swap_b32 v58, v59
    v_smfmac_f32_16x16x64_bf16 v[68:71], v[52:55], v[104:111], v1
    v_add_f32 v56, v56, v57
    v_add_f32 v58, v58, v59
    v_smfmac_f32_16x16x64_bf16 v[44:47], v[32:35], v[96:103], v1
    v_permlane32_swap_b32 v60, v61
    v_smfmac_f32_16x16x64_bf16 v[44:47], v[52:55], v[88:95], v1
    v_permlane32_swap_b32 v62, v63
    v_add_f32 v60, v60, v61
    v_add_f32 v62, v62, v63
    v_cvt_pk_bf16_f32 v36, v56, v60
    v_cvt_pk_bf16_f32 v38, v58, v62
    v_permlane32_swap_b32 v64, v65
    v_permlane32_swap_b32 v66, v67
    v_add_f32 v64, v64, v65
    v_add_f32 v66, v66, v67
    v_permlane32_swap_b32 v68, v69
    v_permlane32_swap_b32 v70, v71
    v_add_f32 v68, v68, v69
    v_add_f32 v70, v70, v71
    v_cvt_pk_bf16_f32 v37, v64, v68
    v_cvt_pk_bf16_f32 v39, v66, v70
    buffer_store_dwordx4 v[36:39], v0, s[8:11], s58 offen sc1
    v_permlane32_swap_b32 v44, v45
    v_permlane32_swap_b32 v46, v47
    v_add_f32 v44, v44, v45
    v_add_f32 v46, v46, v47
    v_cvt_pk_bf16_f32 v44, v44, v46
    buffer_store_dword v44, v7, s[8:11], s55 offen sc1
    v_and_b32 v32, 16, v0
    v_bfe_u32 v33, v0, 5, 2
    v_lshlrev_b32_e64 v32, v32, s45
    v_cmp_eq_u32_e64 s[64:65], 0, v33
    v_cmp_eq_u32_e64 vcc, 1, v33
    s_add_u32 s27, s44, 1
    s_and_b32 s27, s27, 3
    v_cndmask_b32_e64 v72, 0, v32, s[64:65]
    v_cndmask_b32_e64 v73, 0, v32, vcc
    v_cmp_eq_u32_e64 s[64:65], 2, v33
    v_cmp_eq_u32_e64 vcc, 3, v33
    s_mul_i32 s48, s27, 5120
    s_add_u32 s48, s48, s41
    v_cndmask_b32_e64 v74, 0, v32, s[64:65]
    v_cndmask_b32_e64 v75, 0, v32, vcc
    s_lshl_b32 s27, s27, 15
    s_add_u32 s49, s27, s47
    v_bfe_u32 v11, v0, 4, 3
    v_lshlrev_b32 v11, 3, v11
    v_lshrrev_b32 v32, 8, v0
    v_lshl_add_u32 v11, v32, 6, v11
    s_add_u32 s56, s27, s46
    s_add_u32 s56, s56, s33
    s_add_u32 s58, s48, s33
    v_mov_b32 v5, v5
    s_nop 1
    v_mov_b32 v5, v5
    s_nop 1
    v_mov_b32 v5, v5
    s_nop 1
    v_mov_b32 v5, v5
    s_nop 1
    v_mov_b32 v5, v5
    s_nop 1
    v_mov_b32 v5, v5
    s_nop 1
    v_mov_b32 v5, v5
    s_nop 1
    v_mov_b32 v5, v5
    s_nop 1
    buffer_load_dwordx4 v[12:15], v8, s[8:11], s43 offen sc1
    buffer_load_dwordx4 v[16:19], v8, s[8:11], s61 offen sc1
    buffer_load_dwordx4 v[20:23], v8, s[8:11], s100 offen sc1
    buffer_load_dwordx4 v[24:27], v8, s[8:11], s101 offen sc1
    v_mov_b32 v5, v5
    s_nop 1
    v_mov_b32 v5, v5
    s_nop 1
    v_mov_b32 v5, v5
    s_nop 1
    v_mov_b32 v5, v5
    s_nop 1
    v_mov_b32 v5, v5
    s_nop 1
    v_mov_b32 v5, v5
    s_nop 1
    v_mov_b32 v5, v5
    s_nop 1
    v_mov_b32 v5, v5
    s_nop 1
    buffer_load_dwordx4 v[40:43], v8, s[8:11], s43 offen sc1
    buffer_load_dwordx4 v[44:47], v8, s[8:11], s61 offen sc1
    buffer_load_dwordx4 v[48:51], v8, s[8:11], s100 offen sc1
    buffer_load_dwordx4 v[52:55], v8, s[8:11], s101 offen sc1
    v_mov_b32 v5, v5
    s_nop 1
    v_mov_b32 v5, v5
    s_nop 1
    v_mov_b32 v5, v5
    v_mov_b32 v5, v5
    s_waitcnt vmcnt(7)
    v_mfma_f32_16x16x32_bf16 v[28:31], v[72:75], v[12:15], 0
    s_waitcnt vmcnt(6)
    v_mfma_f32_16x16x32_bf16 v[28:31], v[72:75], v[16:19], v[28:31]
    s_waitcnt vmcnt(5)
    v_mfma_f32_16x16x32_bf16 v[28:31], v[72:75], v[20:23], v[28:31]
    s_waitcnt vmcnt(4)
    v_mfma_f32_16x16x32_bf16 v[28:31], v[72:75], v[24:27], v[28:31]
    v_max3_u32 v32, v12, v16, v20
    v_max_u32 v32, v32, v24
    v_cmp_eq_u32 vcc, -1, v32
    s_cbranch_vccnz M_c1_0_wq1
    v_mov_b32 v5, v5
    v_mov_b32 v5, v5
    v_mov_b32 v5, v5
    v_mov_b32 v5, v5
    v_add_f32_dpp v28, v28, v28 row_ror:8 row_mask:0xf bank_mask:0xf
    v_add_f32_dpp v29, v29, v29 row_ror:8 row_mask:0xf bank_mask:0xf
    v_add_f32_dpp v30, v30, v30 row_ror:8 row_mask:0xf bank_mask:0xf
    v_add_f32_dpp v31, v31, v31 row_ror:8 row_mask:0xf bank_mask:0xf
    v_cmp_u_f32 vcc, v28, v28
    v_cvt_pk_bf16_f32 v28, v28, v29
    v_cvt_pk_bf16_f32 v29, v30, v31
    s_cbranch_vccnz M_c1_0_wrb_e0
    s_mov_b64 exec, s[38:39]
    buffer_store_dwordx2 v[28:29], v11, s[8:11], s58 offen sc1
M_c1_0_wrb_d:
    s_barrier
    buffer_store_dwordx2 v[28:29], v11, s[8:11], s56 offen sc1
M_c1_0_wrb_g:
    s_mov_b64 exec, -1
    s_waitcnt vmcnt(2)
    ds_read_b128 v[56:59], v5 offset:0
    ds_read_b128 v[60:63], v5 offset:1024
    ds_read_b128 v[64:67], v5 offset:2048
    ds_read_b128 v[68:71], v5 offset:3072
    v_mov_b64 v[12:13], 0
    v_mov_b64 v[14:15], 0
    v_mov_b64 v[16:17], 0
    v_mov_b64 v[18:19], 0
    v_mov_b64 v[20:21], 0
    v_mov_b64 v[22:23], 0
    v_mov_b64 v[24:25], 0
    v_mov_b64 v[26:27], 0
    v_mov_b64 v[28:29], 0
    v_mov_b64 v[30:31], 0
    v_mov_b64 v[32:33], 0
    v_mov_b64 v[34:35], 0
    s_and_b32 s26, s44, 63
    s_add_u32 s26, s26, 2
    s_min_u32 s26, s26, 63
    s_lshl_b32 s26, s26, 18
    s_add_u32 s26, s26, s50
    s_add_u32 s3, s26, 16777216
    s_lshl_b32 s4, s44, 18
    s_add_u32 s4, s4, s53
    v_mov_b64 v[72:73], -1
    v_mov_b64 v[74:75], -1
    s_add_u32 s28, s44, 3
    s_and_b32 s29, s28, 3
    s_mul_i32 s31, s22, 160
    s_mul_i32 s28, s29, 167936
    s_add_u32 s28, s28, s34
    s_add_u32 s64, s28, s35
    s_mul_i32 s65, s29, 5120
    s_add_u32 s65, s65, s41
    s_add_u32 s65, s65, s31
    s_lshl_b32 s60, s29, 15
    s_add_u32 s60, s60, s47
    s_add_u32 s60, s60, s31
    s_add_u32 s44, s44, 1
    s_and_b32 s55, s44, 3
    s_mul_i32 s55, s55, 167936
    s_add_u32 s55, s55, s34
    s_add_u32 s58, s55, s35
    s_and_b32 s57, s44, 63
    s_add_u32 s43, s55, s32
    s_add_u32 s61, s43, 33792
    s_add_u32 s100, s43, 67584
    s_add_u32 s101, s43, 101376
    s_nop 15
    s_nop 15
    s_nop 12
    buffer_store_dwordx4 v[72:75], v0, s[8:11], s64 offen offset:0 sc1
    buffer_store_dwordx4 v[72:75], v0, s[8:11], s64 offen offset:1024 sc1
    s_mov_b64 exec, 0x3ff
    buffer_store_dwordx4 v[72:75], v0, s[8:11], s65 offen sc1
    s_mov_b64 exec, -1
    s_mov_b32 s65, 0x10000000
    s_mov_b32 s64, 0x10000000
    s_mov_b32 s70, 0
    s_waitcnt lgkmcnt(0)
    s_branch M_c1_0_top
M_c1_0_restart:
    s_waitcnt vmcnt(0) lgkmcnt(0)
    s_nop 7
    s_barrier
    ds_read_b128 v[56:59], v5 offset:0
    ds_read_b128 v[60:63], v5 offset:1024
    ds_read_b128 v[64:67], v5 offset:2048
    ds_read_b128 v[68:71], v5 offset:3072
    v_mov_b64 v[12:13], 0
    v_mov_b64 v[14:15], 0
    v_mov_b64 v[16:17], 0
    v_mov_b64 v[18:19], 0
    v_mov_b64 v[20:21], 0
    v_mov_b64 v[22:23], 0
    v_mov_b64 v[24:25], 0
    v_mov_b64 v[26:27], 0
    v_mov_b64 v[28:29], 0
    v_mov_b64 v[30:31], 0
    v_mov_b64 v[32:33], 0
    v_mov_b64 v[34:35], 0
    s_waitcnt vmcnt(0) lgkmcnt(0)
    s_branch M_c1_0_top
M_c1_0_zbad:
    s_cmp_eq_u32 s70, 2
    s_cbranch_scc1 M_c1_0_zok
    v_cmp_u_f32 vcc, v72, v72
    s_cbranch_vccz M_c1_0_exact
    s_cmp_eq_u32 s70, 1
    s_cbranch_scc1 M_c1_0_exact
M_c1_0_vfy0:
    s_mov_b32 s70, 1
    s_mov_b32 s30, 0
    s_waitcnt vmcnt(0) lgkmcnt(0)
    s_nop 7
M_c1_0_vfy:
    v_mov_b32 v10, 0
    s_add_u32 s59, s48, 4096
    buffer_load_dwordx4 v[36:39], v0, s[8:11], s48 offen offset:0 sc1
    buffer_load_dwordx4 v[40:43], v0, s[8:11], s48 offen offset:1024 sc1
    buffer_load_dwordx4 v[44:47], v0, s[8:11], s48 offen offset:2048 sc1
    buffer_load_dwordx4 v[48:51], v0, s[8:11], s48 offen offset:3072 sc1
    buffer_load_dwordx4 v[52:55], v0, s[8:11], s59 offen offset:0 sc1
    s_waitcnt vmcnt(4)
    v_max3_u32 v10, v10, v36, v37
    v_max3_u32 v10, v10, v38, v39
    s_waitcnt vmcnt(3)
    v_max3_u32 v10, v10, v40, v41
    v_max3_u32 v10, v10, v42, v43
    s_waitcnt vmcnt(2)
    v_max3_u32 v10, v10, v44, v45
    v_max3_u32 v10, v10, v46, v47
    s_waitcnt vmcnt(1)
    v_max3_u32 v10, v10, v48, v49
    v_max3_u32 v10, v10, v50, v51
    s_waitcnt vmcnt(0)
    v_max3_u32 v10, v10, v52, v53
    v_max3_u32 v10, v10, v54, v55
    s_add_u32 s59, s49, 4096
    buffer_load_dwordx4 v[36:39], v0, s[8:11], s49 offen offset:0 sc1
    buffer_load_dwordx4 v[40:43], v0, s[8:11], s49 offen offset:1024 sc1
    buffer_load_dwordx4 v[44:47], v0, s[8:11], s49 offen offset:2048 sc1
    buffer_load_dwordx4 v[48:51], v0, s[8:11], s49 offen offset:3072 sc1
    buffer_load_dwordx4 v[52:55], v0, s[8:11], s59 offen offset:0 sc1
    s_waitcnt vmcnt(4)
    v_max3_u32 v10, v10, v36, v37
    v_max3_u32 v10, v10, v38, v39
    s_waitcnt vmcnt(3)
    v_max3_u32 v10, v10, v40, v41
    v_max3_u32 v10, v10, v42, v43
    s_waitcnt vmcnt(2)
    v_max3_u32 v10, v10, v44, v45
    v_max3_u32 v10, v10, v46, v47
    s_waitcnt vmcnt(1)
    v_max3_u32 v10, v10, v48, v49
    v_max3_u32 v10, v10, v50, v51
    s_waitcnt vmcnt(0)
    v_max3_u32 v10, v10, v52, v53
    v_max3_u32 v10, v10, v54, v55
    v_cmp_eq_u32 vcc, -1, v10
    s_cbranch_vccz M_c1_0_restart
    s_add_u32 s30, s30, 1
    s_cmp_ge_u32 s30, 60000
    s_cbranch_scc1 M_fail
    s_branch M_c1_0_vfy
M_c1_0_exact:
    s_nop 7
    s_mov_b32 s70, 2
    s_waitcnt lgkmcnt(0)
    ds_read_b128 v[20:23], v3 offset:18432
    ds_read_b128 v[24:27], v3 offset:18496
    ds_read_b128 v[72:75], v3 offset:18560
    ds_read_b128 v[44:47], v3 offset:18624
    ds_read_b128 v[56:59], v0 offset:0
    s_waitcnt lgkmcnt(0)
    v_mfma_f32_16x16x32_bf16 v[28:31], v[56:59], v[20:23], 0
    s_nop 3
    ds_read_b128 v[60:63], v0 offset:1024
    s_waitcnt lgkmcnt(0)
    v_mfma_f32_16x16x32_bf16 v[28:31], v[60:63], v[24:27], v[28:31]
    s_nop 3
    ds_read_b128 v[56:59], v0 offset:2048
    s_waitcnt lgkmcnt(0)
    v_mfma_f32_16x16x32_bf16 v[28:31], v[56:59], v[72:75], v[28:31]
    s_nop 3
    ds_read_b128 v[60:63], v0 offset:3072
    s_waitcnt lgkmcnt(0)
    v_mfma_f32_16x16x32_bf16 v[28:31], v[60:63], v[44:47], v[28:31]
    s_nop 3
    ds_read_b128 v[56:59], v0 offset:4096
    s_waitcnt lgkmcnt(0)
    v_mfma_f32_16x16x32_bf16 v[32:35], v[56:59], v[20:23], 0
    s_nop 3
    ds_read_b128 v[60:63], v0 offset:5120
    s_waitcnt lgkmcnt(0)
    v_mfma_f32_16x16x32_bf16 v[32:35], v[60:63], v[24:27], v[32:35]
    s_nop 3
    ds_read_b128 v[56:59], v0 offset:6144
    s_waitcnt lgkmcnt(0)
    v_mfma_f32_16x16x32_bf16 v[32:35], v[56:59], v[72:75], v[32:35]
    s_nop 3
    ds_read_b128 v[60:63], v0 offset:7168
    s_waitcnt lgkmcnt(0)
    v_mfma_f32_16x16x32_bf16 v[32:35], v[60:63], v[44:47], v[32:35]
    s_nop 3
    ds_read_b128 v[56:59], v3 offset:20736
    s_waitcnt lgkmcnt(0)
    v_mfma_f32_16x16x32_bf16 v[40:43], v[56:59], v[20:23], 0
    s_nop 3
    ds_read_b128 v[60:63], v3 offset:20800
    s_waitcnt lgkmcnt(0)
    v_mfma_f32_16x16x32_bf16 v[40:43], v[60:63], v[24:27], v[40:43]
    s_nop 3
    ds_read_b128 v[56:59], v3 offset:20864
    s_waitcnt lgkmcnt(0)
    v_mfma_f32_16x16x32_bf16 v[40:43], v[56:59], v[72:75], v[40:43]
    s_nop 3
    ds_read_b128 v[60:63], v3 offset:20928
    s_waitcnt lgkmcnt(0)
    v_mfma_f32_16x16x32_bf16 v[40:43], v[60:63], v[44:47], v[40:43]
    s_nop 3
    v_max3_f32 v68, v28, v29, v30
    v_max3_f32 v68, v68, v31, v32
    v_max3_f32 v68, v68, v33, v34
    s_nop 0
    v_max3_f32 v68, v68, v35, v40
    v_max3_f32 v68, v68, v41, v42
    v_max_f32 v68, v68, v43
    v_mov_b32 v69, v68
    s_nop 1
    v_permlane16_swap_b32 v68, v69
    v_max_f32 v68, v68, v69
    v_mov_b32 v69, v68
    s_nop 1
    v_permlane32_swap_b32 v68, v69
    v_max_f32 v68, v68, v69
    v_sub_f32 v28, v28, v68
    v_exp_f32 v28, v28
    v_sub_f32 v29, v29, v68
    v_exp_f32 v29, v29
    v_sub_f32 v30, v30, v68
    v_exp_f32 v30, v30
    v_sub_f32 v31, v31, v68
    v_exp_f32 v31, v31
    v_sub_f32 v32, v32, v68
    v_exp_f32 v32, v32
    v_sub_f32 v33, v33, v68
    v_exp_f32 v33, v33
    v_sub_f32 v34, v34, v68
    v_exp_f32 v34, v34
    v_sub_f32 v35, v35, v68
    v_exp_f32 v35, v35
    v_sub_f32 v40, v40, v68
    v_exp_f32 v40, v40
    v_sub_f32 v41, v41, v68
    v_exp_f32 v41, v41
    v_sub_f32 v42, v42, v68
    v_exp_f32 v42, v42
    v_sub_f32 v43, v43, v68
    v_exp_f32 v43, v43
    v_cvt_pk_bf16_f32 v28, v28, v29
    v_cvt_pk_bf16_f32 v29, v30, v31
    v_cvt_pk_bf16_f32 v30, v32, v33
    v_cvt_pk_bf16_f32 v31, v34, v35
    v_cvt_pk_bf16_f32 v40, v40, v41
    v_cvt_pk_bf16_f32 v41, v42, v43
    v_mfma_f32_16x16x32_bf16 v[20:23], v[80:83], v[28:31], 0
    v_mfma_f32_16x16x32_bf16 v[24:27], v[84:87], v[28:31], 0
    v_mfma_f32_16x16x32_bf16 v[72:75], v[64:67], v[28:31], 0
    ds_read_b128 v[36:39], v3 offset:20736
    s_waitcnt lgkmcnt(0)
    s_nop 7
    v_mfma_f32_16x16x16_bf16 v[72:75], v[10:11], v[40:41], v[72:75]
    s_nop 7
    s_branch M_c1_0_fin
M_c1_0_last:
    s_cmp_lg_u32 s70, 0
    s_cbranch_scc1 M_c1_0_last2
    v_cmp_u_f32 vcc, v32, v32
    s_cbranch_vccnz M_c1_0_vfy0
M_c1_0_last2:
    s_lshl_b32 s4, s44, 18
    s_add_u32 s4, s4, s53
    buffer_store_dwordx4 v[76:79], v0, s[8:11], s4 offen offset:0 sc1
    s_mov_b32 s4, 0x10000000
    s_waitcnt vmcnt(0) lgkmcnt(0)
    s_barrier
    s_nop 7
    v_mov_b64 v[72:73], -1
    v_mov_b64 v[74:75], -1
    s_add_u32 s28, s44, 3
    s_and_b32 s29, s28, 3
    s_mul_i32 s31, s22, 160
    s_mul_i32 s28, s29, 167936
    s_add_u32 s28, s28, s34
    s_add_u32 s64, s28, s35
    s_mul_i32 s65, s29, 5120
    s_add_u32 s65, s65, s41
    s_add_u32 s65, s65, s31
    s_lshl_b32 s60, s29, 15
    s_add_u32 s60, s60, s47
    s_add_u32 s60, s60, s31
    buffer_store_dwordx4 v[72:75], v0, s[8:11], s64 offen offset:0 sc1
    buffer_store_dwordx4 v[72:75], v0, s[8:11], s64 offen offset:1024 sc1
    s_mov_b64 exec, 0x3ff
    buffer_store_dwordx4 v[72:75], v0, s[8:11], s65 offen sc1
    s_mov_b64 exec, -1
    s_mov_b32 s65, 0x10000000
    s_mov_b32 s64, 0x10000000
    s_mov_b64 exec, 0x3ff
    buffer_store_dwordx4 v[72:75], v0, s[8:11], s60 offen sc1
    s_mov_b64 exec, -1
    s_mov_b32 s60, 0x10000000
    s_waitcnt vmcnt(0)
    s_add_u32 s44, s44, 1
    s_cmp_eq_u32 s44, 128
    s_cbranch_scc1 M_end
    s_branch M_c1_0_layer
M_c1_0_lr:
    s_mov_b32 s30, 0
M_c1_0_lr_l:
    s_waitcnt lgkmcnt(0)
    ds_read_b128 v[36:39], v6 offset:13312
    ds_read_b128 v[40:43], v6 offset:14336
    ds_read_b128 v[44:47], v6 offset:15360
    ds_read_b128 v[48:51], v6 offset:16384
    ds_read_b128 v[52:55], v6 offset:17408
    s_waitcnt lgkmcnt(2)
    v_max3_u32 v10, v36, v40, v44
    s_waitcnt lgkmcnt(0)
    v_max3_u32 v10, v10, v48, v52
    v_cmp_eq_u32 vcc, -1, v10
    s_cbranch_vccz M_c1_0_lr_d
    s_add_u32 s30, s30, 1
    s_cmp_ge_u32 s30, 480000
    s_cbranch_scc1 M_fail
    s_branch M_c1_0_lr_l
M_c1_0_lr_d:
    ds_read_b128 v[56:59], v5 offset:0
    ds_read_b128 v[60:63], v5 offset:1024
    ds_read_b128 v[64:67], v5 offset:2048
    ds_read_b128 v[68:71], v5 offset:3072
    v_mov_b64 v[12:13], 0
    v_mov_b64 v[14:15], 0
    v_mov_b64 v[16:17], 0
    v_mov_b64 v[18:19], 0
    v_mov_b64 v[20:21], 0
    v_mov_b64 v[22:23], 0
    v_mov_b64 v[24:25], 0
    v_mov_b64 v[26:27], 0
    v_mov_b64 v[28:29], 0
    v_mov_b64 v[30:31], 0
    v_mov_b64 v[32:33], 0
    v_mov_b64 v[34:35], 0
    s_waitcnt lgkmcnt(0)
    s_branch M_c1_0_lr_r
M_c1_0_rr:
    s_mov_b32 s30, 0
M_c1_0_rr_l:
    s_waitcnt lgkmcnt(0)
    s_and_b32 s27, s30, 1
    s_cbranch_scc1 M_c1_0_rr_n
    s_waitcnt vmcnt(2)
    s_mov_b32 m0, 8192
    s_nop 0
    buffer_load_dwordx4 v0, s[8:11], s49 offen offset:0 sc1 lds
    buffer_load_dwordx4 v0, s[8:11], s49 offen offset:1024 sc1 lds
M_c1_0_rr_n:
    ds_read_b128 v[36:39], v6 offset:8192
    ds_read_b128 v[40:43], v6 offset:9216
    ds_read_b128 v[44:47], v6 offset:10240
    ds_read_b128 v[48:51], v6 offset:11264
    ds_read_b32 v11, v6 offset:12288
    s_waitcnt lgkmcnt(2)
    v_max3_u32 v10, v36, v40, v44
    s_waitcnt lgkmcnt(0)
    v_max3_u32 v10, v10, v48, v11
    v_cmp_eq_u32 vcc, -1, v10
    s_cbranch_vccz M_c1_0_rr_d
    s_add_u32 s30, s30, 1
    s_cmp_ge_u32 s30, 480000
    s_cbranch_scc1 M_fail
    s_branch M_c1_0_rr_l
M_c1_0_rr_d:
    s_branch M_c1_0_rr_r
M_c1_0_first:
    s_mul_i32 s27, s21, 167936
    s_add_u32 s27, s27, s34
    s_mul_i32 s28, s22, 4224
    s_add_u32 s28, s28, s27
    s_mov_b32 exec_hi, 0
    buffer_load_dword v10, v9, s[8:11], s28 offen sc1
    s_lshl_b32 s28, s22, 10
    s_add_u32 s28, s28, s27
    s_add_u32 s28, s28, 135168
    s_mov_b64 exec, 0xff
    buffer_load_dword v10, v9, s[8:11], s28 offen sc1
    s_mul_i32 s27, s21, 5120
    s_add_u32 s27, s27, s41
    s_mul_i32 s28, s22, 160
    s_add_u32 s28, s28, s27
    s_mov_b64 exec, 3
    buffer_load_dword v10, v9, s[8:11], s28 offen sc1
    s_mov_b64 exec, -1
    s_barrier
    s_and_b32 s26, s44, 63
    s_lshl_b32 s26, s26, 18
    s_add_u32 s26, s26, s50
    s_add_u32 s3, s26, 16777216
    s_mov_b32 m0, 0
    s_nop 0
    buffer_load_dwordx4 v0, s[8:11], s26 offen offset:0 sc1 lds
    buffer_load_dwordx4 v0, s[8:11], s26 offen offset:1024 sc1 lds
    buffer_load_dwordx4 v[80:83], v0, s[8:11], s3 offen offset:0 sc1
    buffer_load_dwordx4 v[84:87], v0, s[8:11], s3 offen offset:1024 sc1
    s_and_b32 s26, s44, 63
    s_add_u32 s26, s26, 1
    s_min_u32 s26, s26, 63
    s_lshl_b32 s26, s26, 18
    s_add_u32 s26, s26, s50
    s_add_u32 s3, s26, 16777216
    s_waitcnt vmcnt(0) lgkmcnt(0)
    s_barrier
    s_branch M_c1_0_first_r
M_c1_0_first2:
    s_barrier
    s_branch M_c1_0_first2_r
M_c1_0_wq1:
    buffer_load_dwordx4 v[12:15], v8, s[8:11], s43 offen sc1
    buffer_load_dwordx4 v[16:19], v8, s[8:11], s61 offen sc1
    buffer_load_dwordx4 v[20:23], v8, s[8:11], s100 offen sc1
    buffer_load_dwordx4 v[24:27], v8, s[8:11], s101 offen sc1
    s_waitcnt vmcnt(7)
    v_mfma_f32_16x16x32_bf16 v[28:31], v[72:75], v[40:43], 0
    s_waitcnt vmcnt(6)
    v_mfma_f32_16x16x32_bf16 v[28:31], v[72:75], v[44:47], v[28:31]
    s_waitcnt vmcnt(5)
    v_mfma_f32_16x16x32_bf16 v[28:31], v[72:75], v[48:51], v[28:31]
    s_waitcnt vmcnt(4)
    v_mfma_f32_16x16x32_bf16 v[28:31], v[72:75], v[52:55], v[28:31]
    v_max3_u32 v32, v40, v44, v48
    v_max_u32 v32, v32, v52
    v_cmp_eq_u32 vcc, -1, v32
    s_cbranch_vccnz M_c1_0_wqx
    v_mov_b32 v5, v5
    v_mov_b32 v5, v5
    v_mov_b32 v5, v5
    v_mov_b32 v5, v5
    v_add_f32_dpp v28, v28, v28 row_ror:8 row_mask:0xf bank_mask:0xf
    v_add_f32_dpp v29, v29, v29 row_ror:8 row_mask:0xf bank_mask:0xf
    v_add_f32_dpp v30, v30, v30 row_ror:8 row_mask:0xf bank_mask:0xf
    v_add_f32_dpp v31, v31, v31 row_ror:8 row_mask:0xf bank_mask:0xf
    v_cmp_u_f32 vcc, v28, v28
    v_cvt_pk_bf16_f32 v28, v28, v29
    v_cvt_pk_bf16_f32 v29, v30, v31
    s_cbranch_vccnz M_c1_0_wqe1
    s_mov_b64 exec, s[38:39]
    buffer_store_dwordx2 v[28:29], v11, s[8:11], s58 offen sc1
    s_barrier
    buffer_store_dwordx2 v[28:29], v11, s[8:11], s56 offen sc1
    s_branch M_c1_0_wrb_g
M_c1_0_wqx:
    s_branch M_c1_0_wrb_i1
M_c1_0_wqe1:
    s_waitcnt vmcnt(0)
    buffer_load_dwordx4 v[12:15], v8, s[8:11], s43 offen sc1
    buffer_load_dwordx4 v[16:19], v8, s[8:11], s61 offen sc1
    buffer_load_dwordx4 v[20:23], v8, s[8:11], s100 offen sc1
    buffer_load_dwordx4 v[24:27], v8, s[8:11], s101 offen sc1
    s_branch M_c1_0_wrb_e1
M_c1_0_wrb_l:
    s_waitcnt vmcnt(4)
    v_mfma_f32_16x16x32_bf16 v[28:31], v[72:75], v[12:15], 0
    v_mfma_f32_16x16x32_bf16 v[28:31], v[72:75], v[16:19], v[28:31]
    v_mfma_f32_16x16x32_bf16 v[28:31], v[72:75], v[20:23], v[28:31]
    v_mfma_f32_16x16x32_bf16 v[28:31], v[72:75], v[24:27], v[28:31]
    v_max3_u32 v32, v12, v16, v20
    v_max_u32 v32, v32, v24
    v_cmp_eq_u32 vcc, -1, v32
    s_cbranch_vccz M_c1_0_wrb_x0
M_c1_0_wrb_i0:
    buffer_load_dwordx4 v[12:15], v8, s[8:11], s43 offen sc1
    buffer_load_dwordx4 v[16:19], v8, s[8:11], s61 offen sc1
    buffer_load_dwordx4 v[20:23], v8, s[8:11], s100 offen sc1
    buffer_load_dwordx4 v[24:27], v8, s[8:11], s101 offen sc1
    s_waitcnt vmcnt(4)
    v_mfma_f32_16x16x32_bf16 v[28:31], v[72:75], v[40:43], 0
    v_mfma_f32_16x16x32_bf16 v[28:31], v[72:75], v[44:47], v[28:31]
    v_mfma_f32_16x16x32_bf16 v[28:31], v[72:75], v[48:51], v[28:31]
    v_mfma_f32_16x16x32_bf16 v[28:31], v[72:75], v[52:55], v[28:31]
    v_max3_u32 v32, v40, v44, v48
    v_max_u32 v32, v32, v52
    v_cmp_eq_u32 vcc, -1, v32
    s_cbranch_vccz M_c1_0_wrb_x1
M_c1_0_wrb_i1:
    buffer_load_dwordx4 v[40:43], v8, s[8:11], s43 offen sc1
    buffer_load_dwordx4 v[44:47], v8, s[8:11], s61 offen sc1
    buffer_load_dwordx4 v[48:51], v8, s[8:11], s100 offen sc1
    buffer_load_dwordx4 v[52:55], v8, s[8:11], s101 offen sc1
    s_add_u32 s71, s71, 1
    s_cmp_lt_u32 s71, 240000
    s_cbranch_scc1 M_c1_0_wrb_l
    s_branch M_fail
M_c1_0_wrb_x0:
    s_nop 3
    v_add_f32_dpp v28, v28, v28 row_ror:8 row_mask:0xf bank_mask:0xf
    v_add_f32_dpp v29, v29, v29 row_ror:8 row_mask:0xf bank_mask:0xf
    v_add_f32_dpp v30, v30, v30 row_ror:8 row_mask:0xf bank_mask:0xf
    v_add_f32_dpp v31, v31, v31 row_ror:8 row_mask:0xf bank_mask:0xf
    v_cmp_u_f32 vcc, v28, v28
    v_cvt_pk_bf16_f32 v28, v28, v29
    v_cvt_pk_bf16_f32 v29, v30, v31
    s_cbranch_vccz M_c1_0_wrb_n
M_c1_0_wrb_e0:
    v_max3_u32 v32, v12, v13, v14
    v_max3_u32 v32, v32, v15, v16
    v_max3_u32 v32, v32, v17, v18
    v_max3_u32 v32, v32, v19, v20
    v_max3_u32 v32, v32, v21, v22
    v_max3_u32 v32, v32, v23, v24
    v_max3_u32 v32, v32, v25, v26
    v_max_u32 v32, v32, v27
    v_cmp_eq_u32 vcc, -1, v32
    s_cbranch_vccnz M_c1_0_wrb_i0
    v_min_u32 v28, -2, v28
    v_min_u32 v29, -2, v29
    s_branch M_c1_0_wrb_n
M_c1_0_wrb_x1:
    s_nop 3
    v_add_f32_dpp v28, v28, v28 row_ror:8 row_mask:0xf bank_mask:0xf
    v_add_f32_dpp v29, v29, v29 row_ror:8 row_mask:0xf bank_mask:0xf
    v_add_f32_dpp v30, v30, v30 row_ror:8 row_mask:0xf bank_mask:0xf
    v_add_f32_dpp v31, v31, v31 row_ror:8 row_mask:0xf bank_mask:0xf
    v_cmp_u_f32 vcc, v28, v28
    v_cvt_pk_bf16_f32 v28, v28, v29
    v_cvt_pk_bf16_f32 v29, v30, v31
    s_cbranch_vccz M_c1_0_wrb_n
M_c1_0_wrb_e1:
    v_max3_u32 v32, v40, v41, v42
    v_max3_u32 v32, v32, v43, v44
    v_max3_u32 v32, v32, v45, v46
    v_max3_u32 v32, v32, v47, v48
    v_max3_u32 v32, v32, v49, v50
    v_max3_u32 v32, v32, v51, v52
    v_max3_u32 v32, v32, v53, v54
    v_max_u32 v32, v32, v55
    v_cmp_eq_u32 vcc, -1, v32
    s_cbranch_vccnz M_c1_0_wrb_i1
    v_min_u32 v28, -2, v28
    v_min_u32 v29, -2, v29
M_c1_0_wrb_n:
    s_mov_b64 exec, s[38:39]
    buffer_store_dwordx2 v[28:29], v11, s[8:11], s58 offen sc1
    s_branch M_c1_0_wrb_d
M_c1_1_layer:
    s_lshr_b32 s27, s44, 6
    s_mul_i32 s50, s27, 33554432
    s_lshl_b32 s27, s22, 13
    s_add_u32 s50, s50, s27
    s_add_u32 s50, s50, 37748736
    s_barrier
    s_mov_b32 s26, 0x10010000
    s_mov_b32 s3, s26
    s_mul_i32 s27, s20, 5120
    s_add_u32 s48, s27, 167772160
    s_sub_u32 s49, 167777280, s27
    s_and_b32 s55, s44, 3
    s_mul_i32 s55, s55, 167936
    s_add_u32 s55, s55, s34
    s_add_u32 s58, s55, s35
    s_and_b32 s57, s44, 63
    s_add_u32 s43, s55, s32
    s_sub_u32 s27, s57, 1
    s_max_i32 s27, s27, 0
    s_lshl_b64 s[100:101], 1, s27
    s_lshl_b32 s27, s27, 7
    s_sub_u32 s61, s52, s27
    ds_read_b128 v[56:59], v5 offset:0
    ds_read_b128 v[60:63], v5 offset:1024
    ds_read_b128 v[64:67], v5 offset:2048
    ds_read_b128 v[68:71], v5 offset:3072
    v_mov_b64 v[12:13], 0
    v_mov_b64 v[14:15], 0
    v_mov_b64 v[16:17], 0
    v_mov_b64 v[18:19], 0
    v_mov_b64 v[20:21], 0
    v_mov_b64 v[22:23], 0
    v_mov_b64 v[24:25], 0
    v_mov_b64 v[26:27], 0
    v_mov_b64 v[28:29], 0
    v_mov_b64 v[30:31], 0
    v_mov_b64 v[32:33], 0
    v_mov_b64 v[34:35], 0
    s_mov_b32 s70, 0
    s_waitcnt lgkmcnt(0)
M_c1_1_top:
    s_nop 0
    s_barrier
    ds_read_b128 v[36:39], v6 offset:13312
    ds_read_b128 v[40:43], v6 offset:14336
    s_mov_b32 m0, 8192
    s_nop 0
    buffer_load_dwordx4 v0, s[8:11], s49 offen offset:2048 sc1 lds
M_c1_1_lr_r:
    s_waitcnt lgkmcnt(1)
    v_smfmac_f32_16x16x64_bf16 v[20:23], v[36:39], v[56:63], v1
    ds_read_b128 v[56:59], v5 offset:4096
    v_smfmac_f32_16x16x64_bf16 v[24:27], v[36:39], v[64:71], v1
    ds_read_b128 v[60:63], v5 offset:5120
    v_smfmac_f32_16x16x64_bf16 v[28:31], v[36:39], a[248:255], v1
    ds_read_b128 v[64:67], v5 offset:6144
    v_smfmac_f32_16x16x64_bf16 v[32:35], v[36:39], a[240:247], v1
    ds_read_b128 v[68:71], v5 offset:7168
    v_smfmac_f32_16x16x64_bf16 v[12:15], v[36:39], a[232:239], v1
    ds_read_b128 v[44:47], v6 offset:15360
    s_waitcnt lgkmcnt(3)
    v_smfmac_f32_16x16x64_bf16 v[16:19], v[36:39], v[56:63], v1
    ds_read_b128 v[56:59], v5 offset:8192
    v_smfmac_f32_16x16x64_bf16 v[20:23], v[40:43], a[224:231], v1
    ds_read_b128 v[60:63], v5 offset:9216
    s_waitcnt lgkmcnt(3)
    v_smfmac_f32_16x16x64_bf16 v[24:27], v[40:43], v[64:71], v1
    ds_read_b128 v[64:67], v5 offset:10240
    v_smfmac_f32_16x16x64_bf16 v[28:31], v[40:43], a[216:223], v1
    ds_read_b128 v[68:71], v5 offset:11264
    v_smfmac_f32_16x16x64_bf16 v[32:35], v[40:43], a[208:215], v1
    ds_read_b128 v[48:51], v6 offset:16384
    s_waitcnt lgkmcnt(3)
    v_smfmac_f32_16x16x64_bf16 v[12:15], v[40:43], v[56:63], v1
    ds_read_b128 v[56:59], v5 offset:12288
    v_smfmac_f32_16x16x64_bf16 v[16:19], v[40:43], a[200:207], v1
    ds_read_b128 v[60:63], v5 offset:13312
    s_waitcnt lgkmcnt(3)
    v_smfmac_f32_16x16x64_bf16 v[20:23], v[44:47], v[64:71], v1
    ds_read_b128 v[64:67], v5 offset:14336
    v_smfmac_f32_16x16x64_bf16 v[24:27], v[44:47], a[192:199], v1
    ds_read_b128 v[68:71], v5 offset:15360
    v_smfmac_f32_16x16x64_bf16 v[28:31], v[44:47], a[184:191], v1
    ds_read_b128 v[52:55], v6 offset:17408
    s_waitcnt lgkmcnt(3)
    v_smfmac_f32_16x16x64_bf16 v[32:35], v[44:47], v[56:63], v1
    ds_read_b128 v[56:59], v5 offset:16384
    v_smfmac_f32_16x16x64_bf16 v[20:23], v[48:51], a[176:183], v1
    ds_read_b128 v[60:63], v5 offset:17408
    s_waitcnt lgkmcnt(3)
    v_max3_u32 v10, v36, v40, v44
    v_smfmac_f32_16x16x64_bf16 v[24:27], v[48:51], v[64:71], v1
    ds_read_b128 v[64:67], v5 offset:18432
    s_waitcnt lgkmcnt(3)
    v_max3_u32 v10, v10, v48, v52
    v_smfmac_f32_16x16x64_bf16 v[28:31], v[48:51], a[168:175], v1
    ds_read_b128 v[68:71], v5 offset:19456
    v_cmp_eq_u32 vcc, -1, v10
    v_smfmac_f32_16x16x64_bf16 v[32:35], v[48:51], a[160:167], v1
    s_cbranch_vccnz M_c1_1_lr
    s_waitcnt vmcnt(0)
    s_barrier
    ds_read_b128 v[36:39], v6 offset:8192
    ds_read_b128 v[40:43], v6 offset:9216
    s_waitcnt lgkmcnt(4)
    v_smfmac_f32_16x16x64_bf16 v[20:23], v[52:55], v[56:63], v1
    ds_read_b128 v[44:47], v6 offset:10240
    ds_read_b128 v[48:51], v6 offset:11264
    v_smfmac_f32_16x16x64_bf16 v[24:27], v[52:55], a[152:159], v1
    ds_read_b32 v11, v6 offset:12288
    ds_read_b128 v[56:59], v5 offset:20480
    s_waitcnt lgkmcnt(6)
    v_smfmac_f32_16x16x64_bf16 v[28:31], v[52:55], v[64:71], v1
    ds_read_b128 v[60:63], v5 offset:21504
    s_waitcnt lgkmcnt(4)
    v_max3_u32 v10, v36, v40, v44
    v_smfmac_f32_16x16x64_bf16 v[32:35], v[52:55], a[144:151], v1
    s_waitcnt lgkmcnt(2)
    v_max3_u32 v10, v10, v48, v11
    v_cmp_eq_u32 vcc, -1, v10
    s_cbranch_vccnz M_c1_1_rr
M_c1_1_rr_r:
    s_mov_b32 m0, 23296
    ds_read_b128 v[64:67], v5 offset:22528
    ds_read_b128 v[68:71], v5 offset:23552
    ds_read_b128 v[52:55], v6 offset:12288
    buffer_store_dwordx4 v[76:79], v0, s[8:11], s4 offen offset:1024 sc1
    s_mov_b32 s4, 0x10000000
    s_mov_b64 exec, 3
    buffer_load_dword v9, s[8:11], s51 offen sc1 lds
    s_mov_b64 exec, s[100:101]
    buffer_store_dword v9, v9, s[8:11], s61 offen sc1
    s_mov_b64 exec, -1
    v_smfmac_f32_16x16x64_bf16 v[20:23], v[36:39], a[136:143], v1
    s_waitcnt lgkmcnt(3)
    v_smfmac_f32_16x16x64_bf16 v[24:27], v[36:39], v[56:63], v1
    ds_read_b128 v[56:59], v5 offset:24576
    v_smfmac_f32_16x16x64_bf16 v[20:23], v[40:43], a[128:135], v1
    ds_read_b128 v[60:63], v5 offset:25600
    s_waitcnt lgkmcnt(3)
    v_smfmac_f32_16x16x64_bf16 v[24:27], v[40:43], v[64:71], v1
    ds_read_b128 v[64:67], v5 offset:26624
    v_smfmac_f32_16x16x64_bf16 v[20:23], v[44:47], a[120:127], v1
    ds_read_b128 v[68:71], v5 offset:27648
    v_smfmac_f32_16x16x64_bf16 v[24:27], v[44:47], a[112:119], v1
    s_waitcnt lgkmcnt(2)
    v_smfmac_f32_16x16x64_bf16 v[20:23], v[48:51], v[56:63], v1
    ds_read_b128 v[56:59], v5 offset:28672
    v_smfmac_f32_16x16x64_bf16 v[24:27], v[48:51], a[104:111], v1
    ds_read_b128 v[60:63], v5 offset:29696
    s_waitcnt lgkmcnt(2)
    v_smfmac_f32_16x16x64_bf16 v[20:23], v[52:55], v[64:71], v1
    ds_read_b128 v[64:67], v5 offset:30720
    v_smfmac_f32_16x16x64_bf16 v[24:27], v[52:55], a[96:103], v1
    ds_read_b128 v[68:71], v5 offset:31744
    v_smfmac_f32_16x16x64_bf16 v[28:31], v[36:39], a[88:95], v1
    s_cmp_eq_u32 s57, 0
    s_cbranch_scc1 M_c1_1_first
M_c1_1_first_r:
    s_waitcnt lgkmcnt(2)
    v_smfmac_f32_16x16x64_bf16 v[32:35], v[36:39], v[56:63], v1
    ds_read_b128 v[56:59], v5 offset:32768
    v_permlane32_swap_b32 v20, v21
    v_smfmac_f32_16x16x64_bf16 v[28:31], v[40:43], a[80:87], v1
    ds_read_b128 v[60:63], v5 offset:33792
    s_waitcnt lgkmcnt(2)
    v_permlane32_swap_b32 v22, v23
    v_smfmac_f32_16x16x64_bf16 v[32:35], v[40:43], v[64:71], v1
    ds_read_b128 v[64:67], v0 offset:2048
    v_permlane32_swap_b32 v24, v25
    v_smfmac_f32_16x16x64_bf16 v[28:31], v[44:47], a[72:79], v1
    ds_read_b128 v[68:71], v0 offset:3072
    v_permlane32_swap_b32 v26, v27
    v_smfmac_f32_16x16x64_bf16 v[32:35], v[44:47], a[64:71], v1
    s_waitcnt lgkmcnt(2)
    v_add_f32 v20, v20, v21
    v_add_f32 v22, v22, v23
    v_smfmac_f32_16x16x64_bf16 v[28:31], v[48:51], v[56:63], v1
    ds_read_b128 v[56:59], v0 offset:0
    v_add_f32 v24, v24, v25
    v_add_f32 v26, v26, v27
    v_smfmac_f32_16x16x64_bf16 v[32:35], v[48:51], a[56:63], v1
    ds_read_b128 v[60:63], v0 offset:1024
    v_mul_f32 v20, s40, v20
    v_mul_f32 v24, s40, v24
    v_smfmac_f32_16x16x64_bf16 v[28:31], v[52:55], a[48:55], v1
    v_mul_f32 v22, s40, v22
    v_mul_f32 v26, s40, v26
    v_smfmac_f32_16x16x64_bf16 v[32:35], v[52:55], a[40:47], v1
    v_cvt_pk_bf16_f32 v20, v20, v24
    v_cvt_pk_bf16_f32 v21, v22, v26
    v_smfmac_f32_16x16x64_bf16 v[12:15], v[36:39], a[32:39], v1
    ds_write_b32 v2, v20 offset:18432
    v_smfmac_f32_16x16x64_bf16 v[16:19], v[36:39], a[24:31], v1
    ds_write_b32 v2, v21 offset:19008
    v_permlane32_swap_b32 v28, v29
    v_smfmac_f32_16x16x64_bf16 v[12:15], v[40:43], a[16:23], v1
    ds_read_b128 v[36:39], v6 offset:15360
    v_permlane32_swap_b32 v30, v31
    v_smfmac_f32_16x16x64_bf16 v[16:19], v[40:43], a[8:15], v1
    ds_read_b128 v[40:43], v6 offset:16384
    v_permlane32_swap_b32 v32, v33
    v_smfmac_f32_16x16x64_bf16 v[12:15], v[44:47], a[0:7], v1
    s_waitcnt lgkmcnt(2)
    s_barrier
    v_permlane32_swap_b32 v34, v35
    v_smfmac_f32_16x16x64_bf16 v[16:19], v[44:47], v[248:255], v1
    ds_read_b128 v[20:23], v3 offset:18432
    v_add_f32 v28, v28, v29
    v_add_f32 v30, v30, v31
    v_smfmac_f32_16x16x64_bf16 v[12:15], v[48:51], v[240:247], v1
    ds_read_b128 v[24:27], v3 offset:18496
    v_add_f32 v32, v32, v33
    v_add_f32 v34, v34, v35
    v_smfmac_f32_16x16x64_bf16 v[16:19], v[48:51], v[232:239], v1
    ds_read_b128 v[72:75], v3 offset:18560
    v_cvt_pk_bf16_f32 v28, v28, v32
    v_cvt_pk_bf16_f32 v29, v30, v34
    v_smfmac_f32_16x16x64_bf16 v[12:15], v[52:55], v[224:231], v1
    ds_write_b32 v2, v28 offset:20736
    ds_read_b128 v[44:47], v3 offset:18624
    v_smfmac_f32_16x16x64_bf16 v[16:19], v[52:55], v[216:223], v1
    ds_write_b32 v2, v29 offset:21312
    s_waitcnt lgkmcnt(7)
    v_smfmac_f32_16x16x64_bf16 v[12:15], v[36:39], v[208:215], v1
    ds_read_b128 v[48:51], v6 offset:17408
    v_mov_b64 v[10:11], s[16:17]
    v_smfmac_f32_16x16x64_bf16 v[16:19], v[36:39], v[200:207], v1
    s_waitcnt lgkmcnt(6)
    v_mfma_f32_16x16x32_bf16 v[28:31], v[56:59], v[20:23], 0
    ds_read_b128 v[56:59], v0 offset:4096
    s_waitcnt lgkmcnt(6)
    v_mfma_f32_16x16x32_bf16 v[28:31], v[60:63], v[24:27], v[28:31]
    ds_read_b128 v[60:63], v0 offset:5120
    s_waitcnt lgkmcnt(3)
    s_barrier
    v_mfma_f32_16x16x32_bf16 v[28:31], v[64:67], v[72:75], v[28:31]
    ds_read_b128 v[64:67], v0 offset:6144
    v_mfma_f32_16x16x32_bf16 v[28:31], v[68:71], v[44:47], v[28:31]
    ds_read_b128 v[68:71], v0 offset:7168
    v_smfmac_f32_16x16x64_bf16 v[12:15], v[40:43], v[192:199], v1
    ds_read_b128 v[36:39], v3 offset:20736
    v_smfmac_f32_16x16x64_bf16 v[16:19], v[40:43], v[184:191], v1
    ds_read_b128 v[52:55], v3 offset:20800
    s_waitcnt lgkmcnt(4)
    v_mfma_f32_16x16x32_bf16 v[32:35], v[56:59], v[20:23], 0
    s_nop 0
    v_exp_f32 v28, v28
    ds_read_b128 v[56:59], v3 offset:20864
    v_mfma_f32_16x16x32_bf16 v[32:35], v[60:63], v[24:27], v[32:35]
    s_waitcnt lgkmcnt(3)
    v_exp_f32 v29, v29
    ds_read_b128 v[60:63], v3 offset:20928
    v_mfma_f32_16x16x32_bf16 v[32:35], v[64:67], v[72:75], v[32:35]
    v_exp_f32 v30, v30
    v_mfma_f32_16x16x32_bf16 v[32:35], v[68:71], v[44:47], v[32:35]
    s_waitcnt lgkmcnt(3)
    v_exp_f32 v31, v31
    v_mfma_f32_16x16x32_bf16 v[40:43], v[36:39], v[20:23], 0
    s_waitcnt lgkmcnt(2)
    v_cvt_pk_bf16_f32 v28, v28, v29
    v_cvt_pk_bf16_f32 v29, v30, v31
    v_mfma_f32_16x16x32_bf16 v[40:43], v[52:55], v[24:27], v[40:43]
    s_waitcnt lgkmcnt(1)
    v_mov_b64 v[64:65], s[24:25]
    v_mov_b64 v[66:67], s[24:25]
    v_mfma_f32_16x16x32_bf16 v[40:43], v[56:59], v[72:75], v[40:43]
    s_waitcnt lgkmcnt(0)
    v_exp_f32 v32, v32
    v_mfma_f32_16x16x32_bf16 v[40:43], v[60:63], v[44:47], v[40:43]
    v_exp_f32 v33, v33
    v_smfmac_f32_16x16x64_bf16 v[12:15], v[48:51], v[176:183], v1
    v_exp_f32 v34, v34
    v_smfmac_f32_16x16x64_bf16 v[16:19], v[48:51], v[168:175], v1
    v_exp_f32 v35, v35
    v_cvt_pk_bf16_f32 v30, v32, v33
    v_cvt_pk_bf16_f32 v31, v34, v35
    s_nop 0
    v_exp_f32 v40, v40
    v_mfma_f32_16x16x32_bf16 v[72:75], v[64:67], v[28:31], 0
    v_exp_f32 v41, v41
    v_mfma_f32_16x16x32_bf16 v[20:23], v[80:83], v[28:31], 0
    v_exp_f32 v42, v42
    v_mfma_f32_16x16x32_bf16 v[24:27], v[84:87], v[28:31], 0
    v_exp_f32 v43, v43
    v_cvt_pk_bf16_f32 v40, v40, v41
    v_cvt_pk_bf16_f32 v41, v42, v43
    v_cvt_pk_bf16_f32 v12, v12, v13
    v_cvt_pk_bf16_f32 v13, v14, v15
    v_mfma_f32_16x16x16_bf16 v[72:75], v[10:11], v[40:41], v[72:75]
    v_cvt_pk_bf16_f32 v14, v16, v17
    v_cvt_pk_bf16_f32 v15, v18, v19
M_c1_1_fin:
    v_mfma_f32_16x16x16_bf16 v[20:23], v[12:13], v[40:41], v[20:23]
    s_cmp_eq_u32 s57, 63
    v_cndmask_b32_e64 v76, v12, v52, s[66:67]
    v_cndmask_b32_e64 v77, v13, v53, s[66:67]
    v_mfma_f32_16x16x16_bf16 v[24:27], v[14:15], v[40:41], v[24:27]
    v_cndmask_b32_e64 v78, v14, v54, s[66:67]
    v_cndmask_b32_e64 v79, v15, v55, s[66:67]
    s_cbranch_scc1 M_c1_1_last
    v_rcp_f32 v74, v72
    v_subrev_u32 v73, s68, v72
    v_cmp_lt_u32 vcc, s69, v73
    v_mov_b64 v[44:45], 0
    v_mov_b64 v[46:47], 0
    v_cndmask_b32_e64 v20, v20, v24, s[18:19]
    v_cndmask_b32_e64 v21, v21, v25, s[18:19]
    v_cndmask_b32_e64 v22, v22, v26, s[18:19]
    v_cndmask_b32_e64 v23, v23, v27, s[18:19]
    v_pk_mul_f32 v[20:21], v[20:21], v[74:75] op_sel_hi:[1,0]
    v_pk_mul_f32 v[22:23], v[22:23], v[74:75] op_sel_hi:[1,0]
    v_cvt_pk_bf16_f32 v20, v20, v21
    v_cvt_pk_bf16_f32 v21, v22, v23
    ds_write_b64 v0, v[20:21] offset:13320
    s_cbranch_vccnz M_c1_1_zbad
M_c1_1_zok:
    s_cmp_eq_u32 s57, 0
    s_cbranch_scc1 M_c1_1_first2
M_c1_1_first2_r:
    buffer_load_dwordx4 v[80:83], v0, s[8:11], s3 offen offset:0 sc1
    buffer_load_dwordx4 v[84:87], v0, s[8:11], s3 offen offset:1024 sc1
    s_waitcnt lgkmcnt(0)
    s_barrier
    ds_read_b128 v[32:35], v0 offset:13312
    ds_read_b128 v[52:55], v0 offset:14336
    s_mov_b32 m0, 2048
    s_nop 0
    buffer_load_dwordx4 v0, s[8:11], s26 offen offset:0 sc1 lds
    buffer_load_dwordx4 v0, s[8:11], s26 offen offset:1024 sc1 lds
    v_mov_b64 v[68:69], 0
    v_mov_b64 v[70:71], 0
    v_mov_b64 v[64:65], 0
    v_mov_b64 v[66:67], 0
    v_mov_b64 v[60:61], 0
    v_mov_b64 v[62:63], 0
    v_mov_b64 v[56:57], 0
    v_mov_b64 v[58:59], 0
    s_waitcnt lgkmcnt(1)
    s_nop 0
    v_smfmac_f32_16x16x64_bf16 v[56:59], v[32:35], v[160:167], v1
    v_smfmac_f32_16x16x64_bf16 v[60:63], v[32:35], v[144:151], v1
    s_waitcnt lgkmcnt(0)
    v_smfmac_f32_16x16x64_bf16 v[56:59], v[52:55], v[152:159], v1
    v_smfmac_f32_16x16x64_bf16 v[60:63], v[52:55], v[136:143], v1
    v_smfmac_f32_16x16x64_bf16 v[64:67], v[32:35], v[128:135], v1
    v_smfmac_f32_16x16x64_bf16 v[68:71], v[32:35], v[112:119], v1
    v_permlane32_swap_b32 v56, v57
    v_smfmac_f32_16x16x64_bf16 v[64:67], v[52:55], v[120:127], v1
    v_permlane32_swap_b32 v58, v59
    v_smfmac_f32_16x16x64_bf16 v[68:71], v[52:55], v[104:111], v1
    v_add_f32 v56, v56, v57
    v_add_f32 v58, v58, v59
    v_smfmac_f32_16x16x64_bf16 v[44:47], v[32:35], v[96:103], v1
    v_permlane32_swap_b32 v60, v61
    v_smfmac_f32_16x16x64_bf16 v[44:47], v[52:55], v[88:95], v1
    v_permlane32_swap_b32 v62, v63
    v_add_f32 v60, v60, v61
    v_add_f32 v62, v62, v63
    v_cvt_pk_bf16_f32 v36, v56, v60
    v_cvt_pk_bf16_f32 v38, v58, v62
    v_permlane32_swap_b32 v64, v65
    v_permlane32_swap_b32 v66, v67
    v_add_f32 v64, v64, v65
    v_add_f32 v66, v66, v67
    v_permlane32_swap_b32 v68, v69
    v_permlane32_swap_b32 v70, v71
    v_add_f32 v68, v68, v69
    v_add_f32 v70, v70, v71
    v_cvt_pk_bf16_f32 v37, v64, v68
    v_cvt_pk_bf16_f32 v39, v66, v70
    buffer_store_dwordx4 v[36:39], v0, s[8:11], s58 offen sc1
    v_permlane32_swap_b32 v44, v45
    v_permlane32_swap_b32 v46, v47
    v_add_f32 v44, v44, v45
    v_add_f32 v46, v46, v47
    v_cvt_pk_bf16_f32 v44, v44, v46
    buffer_store_dword v44, v7, s[8:11], s55 offen sc1
    v_bfe_u32 v34, v0, 4, 1
    v_bfe_u32 v33, v0, 7, 1
    v_lshl_add_u32 v33, v33, 1, v34
    v_bfe_u32 v32, v0, 6, 1
    v_lshlrev_b32 v32, 4, v32
    v_lshlrev_b32_e64 v32, v32, s45
    v_cmp_eq_u32_e64 s[64:65], 0, v33
    v_cmp_eq_u32_e64 vcc, 1, v33
    s_add_u32 s27, s44, 1
    s_and_b32 s27, s27, 3
    v_cndmask_b32_e64 v72, 0, v32, s[64:65]
    v_cndmask_b32_e64 v73, 0, v32, vcc
    v_cmp_eq_u32_e64 s[64:65], 2, v33
    v_cmp_eq_u32_e64 vcc, 3, v33
    s_mul_i32 s48, s27, 5120
    s_add_u32 s48, s48, s41
    v_cndmask_b32_e64 v74, 0, v32, s[64:65]
    v_cndmask_b32_e64 v75, 0, v32, vcc
    s_lshl_b32 s27, s27, 15
    s_add_u32 s49, s27, s47
    v_bfe_u32 v32, v0, 8, 1
    v_lshlrev_b32 v11, 6, v32
    v_lshl_add_u32 v11, v34, 3, v11
    v_lshrrev_b32 v33, 9, v0
    v_lshl_add_u32 v11, v33, 2, v11
    s_add_u32 s56, s27, s46
    s_add_u32 s56, s56, s33
    s_add_u32 s58, s48, s33
    v_mov_b32 v5, v5
    s_nop 1
    v_mov_b32 v5, v5
    s_nop 1
    v_mov_b32 v5, v5
    s_nop 1
    v_mov_b32 v5, v5
    s_nop 1
    v_mov_b32 v5, v5
    s_nop 1
    v_mov_b32 v5, v5
    s_nop 1
    v_mov_b32 v5, v5
    s_nop 1
    v_mov_b32 v5, v5
    s_nop 1
    buffer_load_dwordx4 v[12:15], v0, s[8:11], s43 offen sc1
    v_mov_b32 v5, v5
    s_nop 1
    v_mov_b32 v5, v5
    s_nop 1
    v_mov_b32 v5, v5
    s_nop 1
    v_mov_b32 v5, v5
    s_nop 1
    v_mov_b32 v5, v5
    s_nop 1
    v_mov_b32 v5, v5
    s_nop 1
    v_mov_b32 v5, v5
    s_nop 1
    v_mov_b32 v5, v5
    s_nop 1
    v_mov_b32 v5, v5
    s_nop 1
    v_mov_b32 v5, v5
    s_nop 1
    v_mov_b32 v5, v5
    s_nop 1
    v_mov_b32 v5, v5
    s_nop 1
    v_mov_b32 v5, v5
    v_mov_b32 v5, v5
    buffer_load_dwordx4 v[16:19], v0, s[8:11], s43 offen sc1
    v_mov_b32 v5, v5
    s_nop 1
    v_mov_b32 v5, v5
    s_nop 1
    v_mov_b32 v5, v5
    v_mov_b32 v5, v5
    s_waitcnt vmcnt(1)
    v_mfma_f32_16x16x32_bf16 v[28:31], v[72:75], v[12:15], 0
    v_cmp_eq_u32 vcc, -1, v12
    s_cbranch_vccnz M_c1_1_wq1
    v_mov_b32 v5, v5
    v_mov_b32 v5, v5
    v_mov_b32 v5, v5
    v_mov_b32 v5, v5
    v_mov_b32 v5, v5
    v_mov_b32 v5, v5
    v_add_f32_dpp v28, v28, v28 row_ror:8 row_mask:0xf bank_mask:0xf
    v_add_f32_dpp v29, v29, v29 row_ror:8 row_mask:0xf bank_mask:0xf
    s_nop 0
    v_add_f32_dpp v28, v28, v28 row_ror:4 row_mask:0xf bank_mask:0xf
    v_add_f32_dpp v29, v29, v29 row_ror:4 row_mask:0xf bank_mask:0xf
    s_nop 0
    v_add_f32_dpp v28, v28, v28 row_ror:2 row_mask:0xf bank_mask:0xf
    v_add_f32_dpp v29, v29, v29 row_ror:2 row_mask:0xf bank_mask:0xf
    v_cmp_u_f32 vcc, v28, v28
    v_cvt_pk_bf16_f32 v28, v28, v29
    s_cbranch_vccnz M_c1_1_wrb_e0
    s_mov_b64 exec, s[62:63]
    buffer_store_dword v28, v11, s[8:11], s58 offen sc1
M_c1_1_wrb_d:
    s_barrier
    buffer_store_dword v28, v11, s[8:11], s56 offen sc1
M_c1_1_wrb_g:
    s_mov_b64 exec, -1
    s_waitcnt vmcnt(2)
    ds_read_b128 v[56:59], v5 offset:0
    ds_read_b128 v[60:63], v5 offset:1024
    ds_read_b128 v[64:67], v5 offset:2048
    ds_read_b128 v[68:71], v5 offset:3072
    v_mov_b64 v[12:13], 0
    v_mov_b64 v[14:15], 0
    v_mov_b64 v[16:17], 0
    v_mov_b64 v[18:19], 0
    v_mov_b64 v[20:21], 0
    v_mov_b64 v[22:23], 0
    v_mov_b64 v[24:25], 0
    v_mov_b64 v[26:27], 0
    v_mov_b64 v[28:29], 0
    v_mov_b64 v[30:31], 0
    v_mov_b64 v[32:33], 0
    v_mov_b64 v[34:35], 0
    s_and_b32 s26, s44, 63
    s_add_u32 s26, s26, 2
    s_min_u32 s26, s26, 63
    s_lshl_b32 s26, s26, 18
    s_add_u32 s26, s26, s50
    s_add_u32 s26, s26, 2048
    s_add_u32 s3, s26, 16777216
    s_lshl_b32 s4, s44, 18
    s_add_u32 s4, s4, s53
    v_mov_b64 v[72:73], -1
    v_mov_b64 v[74:75], -1
    s_add_u32 s28, s44, 3
    s_and_b32 s29, s28, 3
    s_mul_i32 s31, s22, 160
    s_mul_i32 s28, s29, 167936
    s_add_u32 s28, s28, s34
    s_add_u32 s64, s28, s35
    s_lshl_b32 s65, s22, 10
    s_add_u32 s65, s65, s28
    s_add_u32 s65, s65, 135168
    s_add_u32 s44, s44, 1
    s_and_b32 s55, s44, 3
    s_mul_i32 s55, s55, 167936
    s_add_u32 s55, s55, s34
    s_add_u32 s58, s55, s35
    s_and_b32 s57, s44, 63
    s_add_u32 s43, s55, s32
    s_sub_u32 s27, s57, 1
    s_max_i32 s27, s27, 0
    s_lshl_b64 s[100:101], 1, s27
    s_lshl_b32 s27, s27, 7
    s_sub_u32 s61, s52, s27
    s_nop 15
    s_nop 15
    s_nop 12
    buffer_store_dwordx4 v[72:75], v0, s[8:11], s64 offen offset:1024 sc1
    buffer_store_dwordx4 v[72:75], v0, s[8:11], s64 offen offset:2048 sc1
    buffer_store_dwordx4 v[72:75], v0, s[8:11], s65 offen sc1
    s_mov_b32 s65, 0x10000000
    s_mov_b32 s64, 0x10000000
    s_mov_b32 s70, 0
    s_waitcnt lgkmcnt(0)
    s_branch M_c1_1_top
M_c1_1_restart:
    s_waitcnt vmcnt(0) lgkmcnt(0)
    s_nop 7
    s_barrier
    ds_read_b128 v[56:59], v5 offset:0
    ds_read_b128 v[60:63], v5 offset:1024
    ds_read_b128 v[64:67], v5 offset:2048
    ds_read_b128 v[68:71], v5 offset:3072
    v_mov_b64 v[12:13], 0
    v_mov_b64 v[14:15], 0
    v_mov_b64 v[16:17], 0
    v_mov_b64 v[18:19], 0
    v_mov_b64 v[20:21], 0
    v_mov_b64 v[22:23], 0
    v_mov_b64 v[24:25], 0
    v_mov_b64 v[26:27], 0
    v_mov_b64 v[28:29], 0
    v_mov_b64 v[30:31], 0
    v_mov_b64 v[32:33], 0
    v_mov_b64 v[34:35], 0
    s_waitcnt vmcnt(0) lgkmcnt(0)
    s_branch M_c1_1_top
M_c1_1_zbad:
    s_cmp_eq_u32 s70, 2
    s_cbranch_scc1 M_c1_1_zok
    v_cmp_u_f32 vcc, v72, v72
    s_cbranch_vccz M_c1_1_exact
    s_cmp_eq_u32 s70, 1
    s_cbranch_scc1 M_c1_1_exact
M_c1_1_vfy0:
    s_mov_b32 s70, 1
    s_mov_b32 s30, 0
    s_waitcnt vmcnt(0) lgkmcnt(0)
    s_nop 7
M_c1_1_vfy:
    v_mov_b32 v10, 0
    s_add_u32 s59, s48, 4096
    buffer_load_dwordx4 v[36:39], v0, s[8:11], s48 offen offset:0 sc1
    buffer_load_dwordx4 v[40:43], v0, s[8:11], s48 offen offset:1024 sc1
    buffer_load_dwordx4 v[44:47], v0, s[8:11], s48 offen offset:2048 sc1
    buffer_load_dwordx4 v[48:51], v0, s[8:11], s48 offen offset:3072 sc1
    buffer_load_dwordx4 v[52:55], v0, s[8:11], s59 offen offset:0 sc1
    s_waitcnt vmcnt(4)
    v_max3_u32 v10, v10, v36, v37
    v_max3_u32 v10, v10, v38, v39
    s_waitcnt vmcnt(3)
    v_max3_u32 v10, v10, v40, v41
    v_max3_u32 v10, v10, v42, v43
    s_waitcnt vmcnt(2)
    v_max3_u32 v10, v10, v44, v45
    v_max3_u32 v10, v10, v46, v47
    s_waitcnt vmcnt(1)
    v_max3_u32 v10, v10, v48, v49
    v_max3_u32 v10, v10, v50, v51
    s_waitcnt vmcnt(0)
    v_max3_u32 v10, v10, v52, v53
    v_max3_u32 v10, v10, v54, v55
    s_add_u32 s59, s49, 4096
    buffer_load_dwordx4 v[36:39], v0, s[8:11], s49 offen offset:0 sc1
    buffer_load_dwordx4 v[40:43], v0, s[8:11], s49 offen offset:1024 sc1
    buffer_load_dwordx4 v[44:47], v0, s[8:11], s49 offen offset:2048 sc1
    buffer_load_dwordx4 v[48:51], v0, s[8:11], s49 offen offset:3072 sc1
    buffer_load_dwordx4 v[52:55], v0, s[8:11], s59 offen offset:0 sc1
    s_waitcnt vmcnt(4)
    v_max3_u32 v10, v10, v36, v37
    v_max3_u32 v10, v10, v38, v39
    s_waitcnt vmcnt(3)
    v_max3_u32 v10, v10, v40, v41
    v_max3_u32 v10, v10, v42, v43
    s_waitcnt vmcnt(2)
    v_max3_u32 v10, v10, v44, v45
    v_max3_u32 v10, v10, v46, v47
    s_waitcnt vmcnt(1)
    v_max3_u32 v10, v10, v48, v49
    v_max3_u32 v10, v10, v50, v51
    s_waitcnt vmcnt(0)
    v_max3_u32 v10, v10, v52, v53
    v_max3_u32 v10, v10, v54, v55
    v_cmp_eq_u32 vcc, -1, v10
    s_cbranch_vccz M_c1_1_restart
    s_add_u32 s30, s30, 1
    s_cmp_ge_u32 s30, 60000
    s_cbranch_scc1 M_fail
    s_branch M_c1_1_vfy
M_c1_1_exact:
    s_nop 7
    s_mov_b32 s70, 2
    s_waitcnt lgkmcnt(0)
    ds_read_b128 v[20:23], v3 offset:18432
    ds_read_b128 v[24:27], v3 offset:18496
    ds_read_b128 v[72:75], v3 offset:18560
    ds_read_b128 v[44:47], v3 offset:18624
    ds_read_b128 v[56:59], v0 offset:0
    s_waitcnt lgkmcnt(0)
    v_mfma_f32_16x16x32_bf16 v[28:31], v[56:59], v[20:23], 0
    s_nop 3
    ds_read_b128 v[60:63], v0 offset:1024
    s_waitcnt lgkmcnt(0)
    v_mfma_f32_16x16x32_bf16 v[28:31], v[60:63], v[24:27], v[28:31]
    s_nop 3
    ds_read_b128 v[56:59], v0 offset:2048
    s_waitcnt lgkmcnt(0)
    v_mfma_f32_16x16x32_bf16 v[28:31], v[56:59], v[72:75], v[28:31]
    s_nop 3
    ds_read_b128 v[60:63], v0 offset:3072
    s_waitcnt lgkmcnt(0)
    v_mfma_f32_16x16x32_bf16 v[28:31], v[60:63], v[44:47], v[28:31]
    s_nop 3
    ds_read_b128 v[56:59], v0 offset:4096
    s_waitcnt lgkmcnt(0)
    v_mfma_f32_16x16x32_bf16 v[32:35], v[56:59], v[20:23], 0
    s_nop 3
    ds_read_b128 v[60:63], v0 offset:5120
    s_waitcnt lgkmcnt(0)
    v_mfma_f32_16x16x32_bf16 v[32:35], v[60:63], v[24:27], v[32:35]
    s_nop 3
    ds_read_b128 v[56:59], v0 offset:6144
    s_waitcnt lgkmcnt(0)
    v_mfma_f32_16x16x32_bf16 v[32:35], v[56:59], v[72:75], v[32:35]
    s_nop 3
    ds_read_b128 v[60:63], v0 offset:7168
    s_waitcnt lgkmcnt(0)
    v_mfma_f32_16x16x32_bf16 v[32:35], v[60:63], v[44:47], v[32:35]
    s_nop 3
    ds_read_b128 v[56:59], v3 offset:20736
    s_waitcnt lgkmcnt(0)
    v_mfma_f32_16x16x32_bf16 v[40:43], v[56:59], v[20:23], 0
    s_nop 3
    ds_read_b128 v[60:63], v3 offset:20800
    s_waitcnt lgkmcnt(0)
    v_mfma_f32_16x16x32_bf16 v[40:43], v[60:63], v[24:27], v[40:43]
    s_nop 3
    ds_read_b128 v[56:59], v3 offset:20864
    s_waitcnt lgkmcnt(0)
    v_mfma_f32_16x16x32_bf16 v[40:43], v[56:59], v[72:75], v[40:43]
    s_nop 3
    ds_read_b128 v[60:63], v3 offset:20928
    s_waitcnt lgkmcnt(0)
    v_mfma_f32_16x16x32_bf16 v[40:43], v[60:63], v[44:47], v[40:43]
    s_nop 3
    v_max3_f32 v68, v28, v29, v30
    v_max3_f32 v68, v68, v31, v32
    v_max3_f32 v68, v68, v33, v34
    s_nop 0
    v_max3_f32 v68, v68, v35, v40
    v_max3_f32 v68, v68, v41, v42
    v_max_f32 v68, v68, v43
    v_mov_b32 v69, v68
    s_nop 1
    v_permlane16_swap_b32 v68, v69
    v_max_f32 v68, v68, v69
    v_mov_b32 v69, v68
    s_nop 1
    v_permlane32_swap_b32 v68, v69
    v_max_f32 v68, v68, v69
    v_sub_f32 v28, v28, v68
    v_exp_f32 v28, v28
    v_sub_f32 v29, v29, v68
    v_exp_f32 v29, v29
    v_sub_f32 v30, v30, v68
    v_exp_f32 v30, v30
    v_sub_f32 v31, v31, v68
    v_exp_f32 v31, v31
    v_sub_f32 v32, v32, v68
    v_exp_f32 v32, v32
    v_sub_f32 v33, v33, v68
    v_exp_f32 v33, v33
    v_sub_f32 v34, v34, v68
    v_exp_f32 v34, v34
    v_sub_f32 v35, v35, v68
    v_exp_f32 v35, v35
    v_sub_f32 v40, v40, v68
    v_exp_f32 v40, v40
    v_sub_f32 v41, v41, v68
    v_exp_f32 v41, v41
    v_sub_f32 v42, v42, v68
    v_exp_f32 v42, v42
    v_sub_f32 v43, v43, v68
    v_exp_f32 v43, v43
    v_cvt_pk_bf16_f32 v28, v28, v29
    v_cvt_pk_bf16_f32 v29, v30, v31
    v_cvt_pk_bf16_f32 v30, v32, v33
    v_cvt_pk_bf16_f32 v31, v34, v35
    v_cvt_pk_bf16_f32 v40, v40, v41
    v_cvt_pk_bf16_f32 v41, v42, v43
    v_mfma_f32_16x16x32_bf16 v[20:23], v[80:83], v[28:31], 0
    v_mfma_f32_16x16x32_bf16 v[24:27], v[84:87], v[28:31], 0
    v_mfma_f32_16x16x32_bf16 v[72:75], v[64:67], v[28:31], 0
    ds_read_b128 v[52:55], v3 offset:20800
    s_waitcnt lgkmcnt(0)
    s_nop 7
    v_mfma_f32_16x16x16_bf16 v[72:75], v[10:11], v[40:41], v[72:75]
    s_nop 7
    s_branch M_c1_1_fin
M_c1_1_last:
    s_cmp_lg_u32 s70, 0
    s_cbranch_scc1 M_c1_1_last2
    v_cmp_u_f32 vcc, v32, v32
    s_cbranch_vccnz M_c1_1_vfy0
M_c1_1_last2:
    s_lshl_b32 s4, s44, 18
    s_add_u32 s4, s4, s53
    buffer_store_dwordx4 v[76:79], v0, s[8:11], s4 offen offset:1024 sc1
    s_mov_b32 s4, 0x10000000
    s_waitcnt vmcnt(0) lgkmcnt(0)
    s_barrier
    v_mov_b32 v11, 8192
    s_mov_b64 exec, 1
    buffer_store_dword v11, v0, s[8:11], s52 offen sc1
    s_mov_b64 exec, -1
    s_add_u32 s52, s52, 4096
    s_nop 7
    v_mov_b64 v[72:73], -1
    v_mov_b64 v[74:75], -1
    s_add_u32 s28, s44, 3
    s_and_b32 s29, s28, 3
    s_mul_i32 s31, s22, 160
    s_mul_i32 s28, s29, 167936
    s_add_u32 s28, s28, s34
    s_add_u32 s64, s28, s35
    s_lshl_b32 s65, s22, 10
    s_add_u32 s65, s65, s28
    s_add_u32 s65, s65, 135168
    buffer_store_dwordx4 v[72:75], v0, s[8:11], s64 offen offset:1024 sc1
    buffer_store_dwordx4 v[72:75], v0, s[8:11], s64 offen offset:2048 sc1
    buffer_store_dwordx4 v[72:75], v0, s[8:11], s65 offen sc1
    s_mov_b32 s65, 0x10000000
    s_mov_b32 s64, 0x10000000
    s_waitcnt vmcnt(0)
    s_add_u32 s44, s44, 1
    s_cmp_eq_u32 s44, 128
    s_cbranch_scc1 M_end
    s_branch M_c1_1_layer
M_c1_1_lr:
    s_mov_b32 s30, 0
M_c1_1_lr_l:
    s_waitcnt lgkmcnt(0)
    ds_read_b128 v[36:39], v6 offset:13312
    ds_read_b128 v[40:43], v6 offset:14336
    ds_read_b128 v[44:47], v6 offset:15360
    ds_read_b128 v[48:51], v6 offset:16384
    ds_read_b128 v[52:55], v6 offset:17408
    s_waitcnt lgkmcnt(2)
    v_max3_u32 v10, v36, v40, v44
    s_waitcnt lgkmcnt(0)
    v_max3_u32 v10, v10, v48, v52
    v_cmp_eq_u32 vcc, -1, v10
    s_cbranch_vccz M_c1_1_lr_d
    s_add_u32 s30, s30, 1
    s_cmp_ge_u32 s30, 480000
    s_cbranch_scc1 M_fail
    s_branch M_c1_1_lr_l
M_c1_1_lr_d:
    ds_read_b128 v[56:59], v5 offset:0
    ds_read_b128 v[60:63], v5 offset:1024
    ds_read_b128 v[64:67], v5 offset:2048
    ds_read_b128 v[68:71], v5 offset:3072
    v_mov_b64 v[12:13], 0
    v_mov_b64 v[14:15], 0
    v_mov_b64 v[16:17], 0
    v_mov_b64 v[18:19], 0
    v_mov_b64 v[20:21], 0
    v_mov_b64 v[22:23], 0
    v_mov_b64 v[24:25], 0
    v_mov_b64 v[26:27], 0
    v_mov_b64 v[28:29], 0
    v_mov_b64 v[30:31], 0
    v_mov_b64 v[32:33], 0
    v_mov_b64 v[34:35], 0
    s_waitcnt lgkmcnt(0)
    s_branch M_c1_1_lr_r
M_c1_1_rr:
    s_mov_b32 s30, 0
M_c1_1_rr_l:
    s_waitcnt lgkmcnt(0)
    s_and_b32 s27, s30, 1
    s_cbranch_scc1 M_c1_1_rr_n
    s_waitcnt vmcnt(1)
    s_mov_b32 m0, 8192
    s_nop 0
    buffer_load_dwordx4 v0, s[8:11], s49 offen offset:2048 sc1 lds
M_c1_1_rr_n:
    ds_read_b128 v[36:39], v6 offset:8192
    ds_read_b128 v[40:43], v6 offset:9216
    ds_read_b128 v[44:47], v6 offset:10240
    ds_read_b128 v[48:51], v6 offset:11264
    ds_read_b32 v11, v6 offset:12288
    s_waitcnt lgkmcnt(2)
    v_max3_u32 v10, v36, v40, v44
    s_waitcnt lgkmcnt(0)
    v_max3_u32 v10, v10, v48, v11
    v_cmp_eq_u32 vcc, -1, v10
    s_cbranch_vccz M_c1_1_rr_d
    s_add_u32 s30, s30, 1
    s_cmp_ge_u32 s30, 480000
    s_cbranch_scc1 M_fail
    s_branch M_c1_1_rr_l
M_c1_1_rr_d:
    s_branch M_c1_1_rr_r
M_c1_1_first:
    s_mul_i32 s27, s21, 167936
    s_add_u32 s27, s27, s34
    s_mul_i32 s28, s22, 4224
    s_add_u32 s28, s28, s27
    s_mov_b32 exec_hi, 0
    buffer_load_dword v10, v9, s[8:11], s28 offen sc1
    s_lshl_b32 s28, s22, 10
    s_add_u32 s28, s28, s27
    s_add_u32 s28, s28, 135168
    s_mov_b64 exec, 0xff
    buffer_load_dword v10, v9, s[8:11], s28 offen sc1
    s_mul_i32 s27, s21, 5120
    s_add_u32 s27, s27, s41
    s_mul_i32 s28, s22, 160
    s_add_u32 s28, s28, s27
    s_mov_b64 exec, 3
    buffer_load_dword v10, v9, s[8:11], s28 offen sc1
    s_mov_b64 exec, -1
    s_barrier
    s_and_b32 s26, s44, 63
    s_lshl_b32 s26, s26, 18
    s_add_u32 s26, s26, s50
    s_add_u32 s26, s26, 2048
    s_add_u32 s3, s26, 16777216
    s_mov_b32 m0, 2048
    s_nop 0
    buffer_load_dwordx4 v0, s[8:11], s26 offen offset:0 sc1 lds
    buffer_load_dwordx4 v0, s[8:11], s26 offen offset:1024 sc1 lds
    buffer_load_dwordx4 v[80:83], v0, s[8:11], s3 offen offset:0 sc1
    buffer_load_dwordx4 v[84:87], v0, s[8:11], s3 offen offset:1024 sc1
    s_and_b32 s26, s44, 63
    s_add_u32 s26, s26, 1
    s_min_u32 s26, s26, 63
    s_lshl_b32 s26, s26, 18
    s_add_u32 s26, s26, s50
    s_add_u32 s26, s26, 2048
    s_add_u32 s3, s26, 16777216
    s_waitcnt vmcnt(0) lgkmcnt(0)
    s_barrier
    s_branch M_c1_1_first_r
M_c1_1_first2:
    s_barrier
    s_branch M_c1_1_first2_r
M_c1_1_wq1:
    buffer_load_dwordx4 v[12:15], v0, s[8:11], s43 offen sc1
    s_waitcnt vmcnt(1)
    v_mfma_f32_16x16x32_bf16 v[28:31], v[72:75], v[16:19], 0
    v_cmp_eq_u32 vcc, -1, v16
    s_cbranch_vccnz M_c1_1_wqx
    v_mov_b32 v5, v5
    v_mov_b32 v5, v5
    v_mov_b32 v5, v5
    v_mov_b32 v5, v5
    v_mov_b32 v5, v5
    v_mov_b32 v5, v5
    v_add_f32_dpp v28, v28, v28 row_ror:8 row_mask:0xf bank_mask:0xf
    v_add_f32_dpp v29, v29, v29 row_ror:8 row_mask:0xf bank_mask:0xf
    s_nop 0
    v_add_f32_dpp v28, v28, v28 row_ror:4 row_mask:0xf bank_mask:0xf
    v_add_f32_dpp v29, v29, v29 row_ror:4 row_mask:0xf bank_mask:0xf
    s_nop 0
    v_add_f32_dpp v28, v28, v28 row_ror:2 row_mask:0xf bank_mask:0xf
    v_add_f32_dpp v29, v29, v29 row_ror:2 row_mask:0xf bank_mask:0xf
    v_cmp_u_f32 vcc, v28, v28
    v_cvt_pk_bf16_f32 v28, v28, v29
    s_cbranch_vccnz M_c1_1_wqe1
    s_mov_b64 exec, s[62:63]
    buffer_store_dword v28, v11, s[8:11], s58 offen sc1
    s_barrier
    buffer_store_dword v28, v11, s[8:11], s56 offen sc1
    s_branch M_c1_1_wrb_g
M_c1_1_wqx:
    s_branch M_c1_1_wrb_i1
M_c1_1_wqe1:
    s_waitcnt vmcnt(0)
    buffer_load_dwordx4 v[12:15], v0, s[8:11], s43 offen sc1
    s_branch M_c1_1_wrb_e1
M_c1_1_wrb_l:
    s_waitcnt vmcnt(1)
    v_mfma_f32_16x16x32_bf16 v[28:31], v[72:75], v[12:15], 0
    v_cmp_eq_u32 vcc, -1, v12
    s_cbranch_vccz M_c1_1_wrb_x0
M_c1_1_wrb_i0:
    buffer_load_dwordx4 v[12:15], v0, s[8:11], s43 offen sc1
    s_waitcnt vmcnt(1)
    v_mfma_f32_16x16x32_bf16 v[28:31], v[72:75], v[16:19], 0
    v_cmp_eq_u32 vcc, -1, v16
    s_cbranch_vccz M_c1_1_wrb_x1
M_c1_1_wrb_i1:
    buffer_load_dwordx4 v[16:19], v0, s[8:11], s43 offen sc1
    s_add_u32 s71, s71, 1
    s_cmp_lt_u32 s71, 240000
    s_cbranch_scc1 M_c1_1_wrb_l
    s_branch M_fail
M_c1_1_wrb_x0:
    s_nop 5
    v_add_f32_dpp v28, v28, v28 row_ror:8 row_mask:0xf bank_mask:0xf
    v_add_f32_dpp v29, v29, v29 row_ror:8 row_mask:0xf bank_mask:0xf
    s_nop 0
    v_add_f32_dpp v28, v28, v28 row_ror:4 row_mask:0xf bank_mask:0xf
    v_add_f32_dpp v29, v29, v29 row_ror:4 row_mask:0xf bank_mask:0xf
    s_nop 0
    v_add_f32_dpp v28, v28, v28 row_ror:2 row_mask:0xf bank_mask:0xf
    v_add_f32_dpp v29, v29, v29 row_ror:2 row_mask:0xf bank_mask:0xf
    v_cmp_u_f32 vcc, v28, v28
    v_cvt_pk_bf16_f32 v28, v28, v29
    s_cbranch_vccz M_c1_1_wrb_n
M_c1_1_wrb_e0:
    v_max3_u32 v32, v12, v13, v14
    v_max_u32 v32, v32, v15
    v_cmp_eq_u32 vcc, -1, v32
    s_cbranch_vccnz M_c1_1_wrb_i0
    v_min_u32 v28, -2, v28
    v_min_u32 v29, -2, v29
    s_branch M_c1_1_wrb_n
M_c1_1_wrb_x1:
    s_nop 5
    v_add_f32_dpp v28, v28, v28 row_ror:8 row_mask:0xf bank_mask:0xf
    v_add_f32_dpp v29, v29, v29 row_ror:8 row_mask:0xf bank_mask:0xf
    s_nop 0
    v_add_f32_dpp v28, v28, v28 row_ror:4 row_mask:0xf bank_mask:0xf
    v_add_f32_dpp v29, v29, v29 row_ror:4 row_mask:0xf bank_mask:0xf
    s_nop 0
    v_add_f32_dpp v28, v28, v28 row_ror:2 row_mask:0xf bank_mask:0xf
    v_add_f32_dpp v29, v29, v29 row_ror:2 row_mask:0xf bank_mask:0xf
    v_cmp_u_f32 vcc, v28, v28
    v_cvt_pk_bf16_f32 v28, v28, v29
    s_cbranch_vccz M_c1_1_wrb_n
M_c1_1_wrb_e1:
    v_max3_u32 v32, v16, v17, v18
    v_max_u32 v32, v32, v19
    v_cmp_eq_u32 vcc, -1, v32
    s_cbranch_vccnz M_c1_1_wrb_i1
    v_min_u32 v28, -2, v28
    v_min_u32 v29, -2, v29
M_c1_1_wrb_n:
    s_mov_b64 exec, s[62:63]
    buffer_store_dword v28, v11, s[8:11], s58 offen sc1
    s_branch M_c1_1_wrb_d
M_c1_2_layer:
    s_lshr_b32 s27, s44, 6
    s_mul_i32 s50, s27, 33554432
    s_lshl_b32 s27, s22, 13
    s_add_u32 s50, s50, s27
    s_add_u32 s50, s50, 37748736
    s_barrier
    s_mov_b32 s26, 0x10010000
    s_mov_b32 s3, s26
    s_mul_i32 s27, s20, 5120
    s_add_u32 s48, s27, 167772160
    s_sub_u32 s49, 167777280, s27
    s_mov_b32 m0, 13312
    s_nop 0
    buffer_load_dwordx4 v0, s[8:11], s48 offen offset:0 sc1 lds
    buffer_load_dwordx4 v0, s[8:11], s48 offen offset:1024 sc1 lds
    buffer_load_dwordx4 v0, s[8:11], s48 offen offset:2048 sc1 lds
    s_and_b32 s55, s44, 3
    s_mul_i32 s55, s55, 167936
    s_add_u32 s55, s55, s34
    s_add_u32 s58, s55, s35
    s_and_b32 s57, s44, 63
    s_sub_u32 s61, s3, 4096
    ds_read_b128 v[56:59], v5 offset:0
    ds_read_b128 v[60:63], v5 offset:1024
    ds_read_b128 v[64:67], v5 offset:2048
    ds_read_b128 v[68:71], v5 offset:3072
    v_mov_b64 v[12:13], 0
    v_mov_b64 v[14:15], 0
    v_mov_b64 v[16:17], 0
    v_mov_b64 v[18:19], 0
    v_mov_b64 v[20:21], 0
    v_mov_b64 v[22:23], 0
    v_mov_b64 v[24:25], 0
    v_mov_b64 v[26:27], 0
    v_mov_b64 v[28:29], 0
    v_mov_b64 v[30:31], 0
    v_mov_b64 v[32:33], 0
    v_mov_b64 v[34:35], 0
    s_mov_b32 s70, 0
    s_waitcnt vmcnt(0) lgkmcnt(0)
M_c1_2_top:
    s_waitcnt vmcnt(6)
    s_barrier
    ds_read_b128 v[36:39], v6 offset:13312
    ds_read_b128 v[40:43], v6 offset:14336
    s_mov_b32 m0, 8192
    s_nop 0
    buffer_load_dwordx4 v0, s[8:11], s49 offen offset:3072 sc1 lds
M_c1_2_lr_r:
    s_waitcnt lgkmcnt(1)
    v_smfmac_f32_16x16x64_bf16 v[20:23], v[36:39], v[56:63], v1
    ds_read_b128 v[56:59], v5 offset:4096
    v_smfmac_f32_16x16x64_bf16 v[24:27], v[36:39], v[64:71], v1
    ds_read_b128 v[60:63], v5 offset:5120
    v_smfmac_f32_16x16x64_bf16 v[28:31], v[36:39], a[248:255], v1
    ds_read_b128 v[64:67], v5 offset:6144
    v_smfmac_f32_16x16x64_bf16 v[32:35], v[36:39], a[240:247], v1
    ds_read_b128 v[68:71], v5 offset:7168
    v_smfmac_f32_16x16x64_bf16 v[12:15], v[36:39], a[232:239], v1
    ds_read_b128 v[44:47], v6 offset:15360
    s_waitcnt lgkmcnt(3)
    v_smfmac_f32_16x16x64_bf16 v[16:19], v[36:39], v[56:63], v1
    ds_read_b128 v[56:59], v5 offset:8192
    v_smfmac_f32_16x16x64_bf16 v[20:23], v[40:43], a[224:231], v1
    ds_read_b128 v[60:63], v5 offset:9216
    s_waitcnt lgkmcnt(3)
    v_smfmac_f32_16x16x64_bf16 v[24:27], v[40:43], v[64:71], v1
    ds_read_b128 v[64:67], v5 offset:10240
    v_smfmac_f32_16x16x64_bf16 v[28:31], v[40:43], a[216:223], v1
    ds_read_b128 v[68:71], v5 offset:11264
    v_smfmac_f32_16x16x64_bf16 v[32:35], v[40:43], a[208:215], v1
    ds_read_b128 v[48:51], v6 offset:16384
    s_waitcnt lgkmcnt(3)
    v_smfmac_f32_16x16x64_bf16 v[12:15], v[40:43], v[56:63], v1
    ds_read_b128 v[56:59], v5 offset:12288
    v_smfmac_f32_16x16x64_bf16 v[16:19], v[40:43], a[200:207], v1
    ds_read_b128 v[60:63], v5 offset:13312
    s_waitcnt lgkmcnt(3)
    v_smfmac_f32_16x16x64_bf16 v[20:23], v[44:47], v[64:71], v1
    ds_read_b128 v[64:67], v5 offset:14336
    v_smfmac_f32_16x16x64_bf16 v[24:27], v[44:47], a[192:199], v1
    ds_read_b128 v[68:71], v5 offset:15360
    v_smfmac_f32_16x16x64_bf16 v[28:31], v[44:47], a[184:191], v1
    ds_read_b128 v[52:55], v6 offset:17408
    s_waitcnt lgkmcnt(3)
    v_smfmac_f32_16x16x64_bf16 v[32:35], v[44:47], v[56:63], v1
    ds_read_b128 v[56:59], v5 offset:16384
    v_smfmac_f32_16x16x64_bf16 v[20:23], v[48:51], a[176:183], v1
    ds_read_b128 v[60:63], v5 offset:17408
    s_waitcnt lgkmcnt(3)
    v_max3_u32 v10, v36, v40, v44
    v_smfmac_f32_16x16x64_bf16 v[24:27], v[48:51], v[64:71], v1
    ds_read_b128 v[64:67], v5 offset:18432
    s_waitcnt lgkmcnt(3)
    v_max3_u32 v10, v10, v48, v52
    v_smfmac_f32_16x16x64_bf16 v[28:31], v[48:51], a[168:175], v1
    ds_read_b128 v[68:71], v5 offset:19456
    v_cmp_eq_u32 vcc, -1, v10
    v_smfmac_f32_16x16x64_bf16 v[32:35], v[48:51], a[160:167], v1
    s_cbranch_vccnz M_c1_2_lr
    s_waitcnt vmcnt(0)
    s_barrier
    ds_read_b128 v[36:39], v6 offset:8192
    ds_read_b128 v[40:43], v6 offset:9216
    s_waitcnt lgkmcnt(4)
    v_smfmac_f32_16x16x64_bf16 v[20:23], v[52:55], v[56:63], v1
    ds_read_b128 v[44:47], v6 offset:10240
    ds_read_b128 v[48:51], v6 offset:11264
    v_smfmac_f32_16x16x64_bf16 v[24:27], v[52:55], a[152:159], v1
    ds_read_b32 v11, v6 offset:12288
    ds_read_b128 v[56:59], v5 offset:20480
    s_waitcnt lgkmcnt(6)
    v_smfmac_f32_16x16x64_bf16 v[28:31], v[52:55], v[64:71], v1
    ds_read_b128 v[60:63], v5 offset:21504
    s_waitcnt lgkmcnt(4)
    v_max3_u32 v10, v36, v40, v44
    v_smfmac_f32_16x16x64_bf16 v[32:35], v[52:55], a[144:151], v1
    s_waitcnt lgkmcnt(2)
    v_max3_u32 v10, v10, v48, v11
    v_cmp_eq_u32 vcc, -1, v10
    s_cbranch_vccnz M_c1_2_rr
M_c1_2_rr_r:
    s_mov_b32 m0, 23040
    ds_read_b128 v[64:67], v5 offset:22528
    ds_read_b128 v[68:71], v5 offset:23552
    ds_read_b128 v[52:55], v6 offset:12288
    buffer_store_dwordx4 v[76:79], v0, s[8:11], s4 offen offset:2048 sc1
    s_mov_b32 s4, 0x10000000
    buffer_load_dword v9, s[8:11], s61 offen sc1 lds
    v_smfmac_f32_16x16x64_bf16 v[20:23], v[36:39], a[136:143], v1
    s_waitcnt lgkmcnt(3)
    v_smfmac_f32_16x16x64_bf16 v[24:27], v[36:39], v[56:63], v1
    ds_read_b128 v[56:59], v5 offset:24576
    v_smfmac_f32_16x16x64_bf16 v[20:23], v[40:43], a[128:135], v1
    ds_read_b128 v[60:63], v5 offset:25600
    s_waitcnt lgkmcnt(3)
    v_smfmac_f32_16x16x64_bf16 v[24:27], v[40:43], v[64:71], v1
    ds_read_b128 v[64:67], v5 offset:26624
    v_smfmac_f32_16x16x64_bf16 v[20:23], v[44:47], a[120:127], v1
    ds_read_b128 v[68:71], v5 offset:27648
    v_smfmac_f32_16x16x64_bf16 v[24:27], v[44:47], a[112:119], v1
    s_waitcnt lgkmcnt(2)
    v_smfmac_f32_16x16x64_bf16 v[20:23], v[48:51], v[56:63], v1
    ds_read_b128 v[56:59], v5 offset:28672
    v_smfmac_f32_16x16x64_bf16 v[24:27], v[48:51], a[104:111], v1
    ds_read_b128 v[60:63], v5 offset:29696
    s_waitcnt lgkmcnt(2)
    v_smfmac_f32_16x16x64_bf16 v[20:23], v[52:55], v[64:71], v1
    ds_read_b128 v[64:67], v5 offset:30720
    v_smfmac_f32_16x16x64_bf16 v[24:27], v[52:55], a[96:103], v1
    ds_read_b128 v[68:71], v5 offset:31744
    v_smfmac_f32_16x16x64_bf16 v[28:31], v[36:39], a[88:95], v1
    s_cmp_eq_u32 s57, 0
    s_cbranch_scc1 M_c1_2_first
M_c1_2_first_r:
    s_waitcnt lgkmcnt(2)
    v_smfmac_f32_16x16x64_bf16 v[32:35], v[36:39], v[56:63], v1
    ds_read_b128 v[56:59], v5 offset:32768
    v_permlane32_swap_b32 v20, v21
    v_smfmac_f32_16x16x64_bf16 v[28:31], v[40:43], a[80:87], v1
    ds_read_b128 v[60:63], v5 offset:33792
    s_waitcnt lgkmcnt(2)
    v_permlane32_swap_b32 v22, v23
    v_smfmac_f32_16x16x64_bf16 v[32:35], v[40:43], v[64:71], v1
    ds_read_b128 v[64:67], v0 offset:2048
    v_permlane32_swap_b32 v24, v25
    v_smfmac_f32_16x16x64_bf16 v[28:31], v[44:47], a[72:79], v1
    ds_read_b128 v[68:71], v0 offset:3072
    v_permlane32_swap_b32 v26, v27
    v_smfmac_f32_16x16x64_bf16 v[32:35], v[44:47], a[64:71], v1
    s_waitcnt lgkmcnt(2)
    v_add_f32 v20, v20, v21
    v_add_f32 v22, v22, v23
    v_smfmac_f32_16x16x64_bf16 v[28:31], v[48:51], v[56:63], v1
    ds_read_b128 v[56:59], v0 offset:0
    v_add_f32 v24, v24, v25
    v_add_f32 v26, v26, v27
    v_smfmac_f32_16x16x64_bf16 v[32:35], v[48:51], a[56:63], v1
    ds_read_b128 v[60:63], v0 offset:1024
    v_mul_f32 v20, s40, v20
    v_mul_f32 v24, s40, v24
    v_smfmac_f32_16x16x64_bf16 v[28:31], v[52:55], a[48:55], v1
    v_mul_f32 v22, s40, v22
    v_mul_f32 v26, s40, v26
    v_smfmac_f32_16x16x64_bf16 v[32:35], v[52:55], a[40:47], v1
    v_cvt_pk_bf16_f32 v20, v20, v24
    v_cvt_pk_bf16_f32 v21, v22, v26
    v_smfmac_f32_16x16x64_bf16 v[12:15], v[36:39], a[32:39], v1
    ds_write_b32 v2, v20 offset:18432
    v_smfmac_f32_16x16x64_bf16 v[16:19], v[36:39], a[24:31], v1
    ds_write_b32 v2, v21 offset:19008
    v_permlane32_swap_b32 v28, v29
    v_smfmac_f32_16x16x64_bf16 v[12:15], v[40:43], a[16:23], v1
    ds_read_b128 v[36:39], v6 offset:15360
    v_permlane32_swap_b32 v30, v31
    v_smfmac_f32_16x16x64_bf16 v[16:19], v[40:43], a[8:15], v1
    ds_read_b128 v[40:43], v6 offset:16384
    v_permlane32_swap_b32 v32, v33
    v_smfmac_f32_16x16x64_bf16 v[12:15], v[44:47], a[0:7], v1
    s_waitcnt lgkmcnt(2)
    s_barrier
    v_permlane32_swap_b32 v34, v35
    v_smfmac_f32_16x16x64_bf16 v[16:19], v[44:47], v[248:255], v1
    ds_read_b128 v[20:23], v3 offset:18432
    v_add_f32 v28, v28, v29
    v_add_f32 v30, v30, v31
    v_smfmac_f32_16x16x64_bf16 v[12:15], v[48:51], v[240:247], v1
    ds_read_b128 v[24:27], v3 offset:18496
    v_add_f32 v32, v32, v33
    v_add_f32 v34, v34, v35
    v_smfmac_f32_16x16x64_bf16 v[16:19], v[48:51], v[232:239], v1
    ds_read_b128 v[72:75], v3 offset:18560
    v_cvt_pk_bf16_f32 v28, v28, v32
    v_cvt_pk_bf16_f32 v29, v30, v34
    v_smfmac_f32_16x16x64_bf16 v[12:15], v[52:55], v[224:231], v1
    ds_write_b32 v2, v28 offset:20736
    ds_read_b128 v[44:47], v3 offset:18624
    v_smfmac_f32_16x16x64_bf16 v[16:19], v[52:55], v[216:223], v1
    ds_write_b32 v2, v29 offset:21312
    s_waitcnt lgkmcnt(7)
    v_smfmac_f32_16x16x64_bf16 v[12:15], v[36:39], v[208:215], v1
    ds_read_b128 v[48:51], v6 offset:17408
    v_mov_b64 v[10:11], s[16:17]
    v_smfmac_f32_16x16x64_bf16 v[16:19], v[36:39], v[200:207], v1
    s_waitcnt lgkmcnt(6)
    v_mfma_f32_16x16x32_bf16 v[28:31], v[56:59], v[20:23], 0
    ds_read_b128 v[56:59], v0 offset:4096
    s_waitcnt lgkmcnt(6)
    v_mfma_f32_16x16x32_bf16 v[28:31], v[60:63], v[24:27], v[28:31]
    ds_read_b128 v[60:63], v0 offset:5120
    s_waitcnt lgkmcnt(3)
    s_barrier
    v_mfma_f32_16x16x32_bf16 v[28:31], v[64:67], v[72:75], v[28:31]
    ds_read_b128 v[64:67], v0 offset:6144
    v_mfma_f32_16x16x32_bf16 v[28:31], v[68:71], v[44:47], v[28:31]
    ds_read_b128 v[68:71], v0 offset:7168
    v_smfmac_f32_16x16x64_bf16 v[12:15], v[40:43], v[192:199], v1
    ds_read_b128 v[36:39], v3 offset:20736
    v_smfmac_f32_16x16x64_bf16 v[16:19], v[40:43], v[184:191], v1
    ds_read_b128 v[52:55], v3 offset:20800
    s_waitcnt lgkmcnt(4)
    v_mfma_f32_16x16x32_bf16 v[32:35], v[56:59], v[20:23], 0
    s_nop 0
    v_exp_f32 v28, v28
    ds_read_b128 v[56:59], v3 offset:20864
    v_mfma_f32_16x16x32_bf16 v[32:35], v[60:63], v[24:27], v[32:35]
    s_waitcnt lgkmcnt(3)
    v_exp_f32 v29, v29
    ds_read_b128 v[60:63], v3 offset:20928
    v_mfma_f32_16x16x32_bf16 v[32:35], v[64:67], v[72:75], v[32:35]
    v_exp_f32 v30, v30
    v_mfma_f32_16x16x32_bf16 v[32:35], v[68:71], v[44:47], v[32:35]
    s_waitcnt lgkmcnt(3)
    v_exp_f32 v31, v31
    v_mfma_f32_16x16x32_bf16 v[40:43], v[36:39], v[20:23], 0
    s_waitcnt lgkmcnt(2)
    v_cvt_pk_bf16_f32 v28, v28, v29
    v_cvt_pk_bf16_f32 v29, v30, v31
    v_mfma_f32_16x16x32_bf16 v[40:43], v[52:55], v[24:27], v[40:43]
    s_waitcnt lgkmcnt(1)
    v_mov_b64 v[64:65], s[24:25]
    v_mov_b64 v[66:67], s[24:25]
    v_mfma_f32_16x16x32_bf16 v[40:43], v[56:59], v[72:75], v[40:43]
    s_waitcnt lgkmcnt(0)
    v_exp_f32 v32, v32
    v_mfma_f32_16x16x32_bf16 v[40:43], v[60:63], v[44:47], v[40:43]
    v_exp_f32 v33, v33
    v_smfmac_f32_16x16x64_bf16 v[12:15], v[48:51], v[176:183], v1
    v_exp_f32 v34, v34
    v_smfmac_f32_16x16x64_bf16 v[16:19], v[48:51], v[168:175], v1
    v_exp_f32 v35, v35
    v_cvt_pk_bf16_f32 v30, v32, v33
    v_cvt_pk_bf16_f32 v31, v34, v35
    s_nop 0
    v_exp_f32 v40, v40
    v_mfma_f32_16x16x32_bf16 v[72:75], v[64:67], v[28:31], 0
    v_exp_f32 v41, v41
    v_mfma_f32_16x16x32_bf16 v[20:23], v[80:83], v[28:31], 0
    v_exp_f32 v42, v42
    v_mfma_f32_16x16x32_bf16 v[24:27], v[84:87], v[28:31], 0
    v_exp_f32 v43, v43
    v_cvt_pk_bf16_f32 v40, v40, v41
    v_cvt_pk_bf16_f32 v41, v42, v43
    v_cvt_pk_bf16_f32 v12, v12, v13
    v_cvt_pk_bf16_f32 v13, v14, v15
    v_mfma_f32_16x16x16_bf16 v[72:75], v[10:11], v[40:41], v[72:75]
    v_cvt_pk_bf16_f32 v14, v16, v17
    v_cvt_pk_bf16_f32 v15, v18, v19
M_c1_2_fin:
    v_mfma_f32_16x16x16_bf16 v[20:23], v[12:13], v[40:41], v[20:23]
    s_cmp_eq_u32 s57, 63
    v_cndmask_b32_e64 v76, v12, v56, s[66:67]
    v_cndmask_b32_e64 v77, v13, v57, s[66:67]
    v_mfma_f32_16x16x16_bf16 v[24:27], v[14:15], v[40:41], v[24:27]
    v_cndmask_b32_e64 v78, v14, v58, s[66:67]
    v_cndmask_b32_e64 v79, v15, v59, s[66:67]
    s_cbranch_scc1 M_c1_2_last
    v_rcp_f32 v74, v72
    v_subrev_u32 v73, s68, v72
    v_cmp_lt_u32 vcc, s69, v73
    v_mov_b64 v[44:45], 0
    v_mov_b64 v[46:47], 0
    v_cndmask_b32_e64 v20, v20, v24, s[18:19]
    v_cndmask_b32_e64 v21, v21, v25, s[18:19]
    v_cndmask_b32_e64 v22, v22, v26, s[18:19]
    v_cndmask_b32_e64 v23, v23, v27, s[18:19]
    v_pk_mul_f32 v[20:21], v[20:21], v[74:75] op_sel_hi:[1,0]
    v_pk_mul_f32 v[22:23], v[22:23], v[74:75] op_sel_hi:[1,0]
    v_cvt_pk_bf16_f32 v20, v20, v21
    v_cvt_pk_bf16_f32 v21, v22, v23
    ds_write_b64 v0, v[20:21] offset:14336
    s_cbranch_vccnz M_c1_2_zbad
M_c1_2_zok:
    s_cmp_eq_u32 s57, 0
    s_cbranch_scc1 M_c1_2_first2
M_c1_2_first2_r:
    buffer_load_dwordx4 v[80:83], v0, s[8:11], s3 offen offset:0 sc1
    buffer_load_dwordx4 v[84:87], v0, s[8:11], s3 offen offset:1024 sc1
    s_waitcnt lgkmcnt(0)
    s_barrier
    ds_read_b128 v[32:35], v0 offset:13312
    ds_read_b128 v[52:55], v0 offset:14336
    s_mov_b32 m0, 4096
    s_nop 0
    buffer_load_dwordx4 v0, s[8:11], s26 offen offset:0 sc1 lds
    buffer_load_dwordx4 v0, s[8:11], s26 offen offset:1024 sc1 lds
    v_mov_b64 v[68:69], 0
    v_mov_b64 v[70:71], 0
    v_mov_b64 v[64:65], 0
    v_mov_b64 v[66:67], 0
    v_mov_b64 v[60:61], 0
    v_mov_b64 v[62:63], 0
    v_mov_b64 v[56:57], 0
    v_mov_b64 v[58:59], 0
    s_waitcnt lgkmcnt(1)
    s_nop 0
    v_smfmac_f32_16x16x64_bf16 v[56:59], v[32:35], v[160:167], v1
    v_smfmac_f32_16x16x64_bf16 v[60:63], v[32:35], v[144:151], v1
    s_waitcnt lgkmcnt(0)
    v_smfmac_f32_16x16x64_bf16 v[56:59], v[52:55], v[152:159], v1
    v_smfmac_f32_16x16x64_bf16 v[60:63], v[52:55], v[136:143], v1
    v_smfmac_f32_16x16x64_bf16 v[64:67], v[32:35], v[128:135], v1
    v_smfmac_f32_16x16x64_bf16 v[68:71], v[32:35], v[112:119], v1
    v_permlane32_swap_b32 v56, v57
    v_smfmac_f32_16x16x64_bf16 v[64:67], v[52:55], v[120:127], v1
    v_permlane32_swap_b32 v58, v59
    v_smfmac_f32_16x16x64_bf16 v[68:71], v[52:55], v[104:111], v1
    v_add_f32 v56, v56, v57
    v_add_f32 v58, v58, v59
    v_smfmac_f32_16x16x64_bf16 v[44:47], v[32:35], v[96:103], v1
    v_permlane32_swap_b32 v60, v61
    v_smfmac_f32_16x16x64_bf16 v[44:47], v[52:55], v[88:95], v1
    v_permlane32_swap_b32 v62, v63
    v_add_f32 v60, v60, v61
    v_add_f32 v62, v62, v63
    v_cvt_pk_bf16_f32 v36, v56, v60
    v_cvt_pk_bf16_f32 v38, v58, v62
    v_permlane32_swap_b32 v64, v65
    v_permlane32_swap_b32 v66, v67
    v_add_f32 v64, v64, v65
    v_add_f32 v66, v66, v67
    v_permlane32_swap_b32 v68, v69
    v_permlane32_swap_b32 v70, v71
    v_add_f32 v68, v68, v69
    v_add_f32 v70, v70, v71
    v_cvt_pk_bf16_f32 v37, v64, v68
    v_cvt_pk_bf16_f32 v39, v66, v70
    buffer_store_dwordx4 v[36:39], v0, s[8:11], s58 offen sc1
    v_permlane32_swap_b32 v44, v45
    v_permlane32_swap_b32 v46, v47
    v_add_f32 v44, v44, v45
    v_add_f32 v46, v46, v47
    v_cvt_pk_bf16_f32 v44, v44, v46
    buffer_store_dword v44, v7, s[8:11], s55 offen sc1
    s_add_u32 s27, s44, 1
    s_and_b32 s27, s27, 3
    s_mul_i32 s48, s27, 5120
    s_add_u32 s48, s48, s41
    s_lshl_b32 s27, s27, 15
    s_add_u32 s49, s27, s47
    ds_read_b128 v[56:59], v5 offset:0
    ds_read_b128 v[60:63], v5 offset:1024
    ds_read_b128 v[64:67], v5 offset:2048
    ds_read_b128 v[68:71], v5 offset:3072
    v_mov_b64 v[12:13], 0
    v_mov_b64 v[14:15], 0
    v_mov_b64 v[16:17], 0
    v_mov_b64 v[18:19], 0
    v_mov_b64 v[20:21], 0
    v_mov_b64 v[22:23], 0
    v_mov_b64 v[24:25], 0
    v_mov_b64 v[26:27], 0
    v_mov_b64 v[28:29], 0
    v_mov_b64 v[30:31], 0
    v_mov_b64 v[32:33], 0
    v_mov_b64 v[34:35], 0
    s_barrier
    s_and_b32 s26, s44, 63
    s_add_u32 s26, s26, 2
    s_min_u32 s26, s26, 63
    s_lshl_b32 s26, s26, 18
    s_add_u32 s26, s26, s50
    s_add_u32 s26, s26, 4096
    s_add_u32 s3, s26, 16777216
    s_lshl_b32 s4, s44, 18
    s_add_u32 s4, s4, s53
    s_add_u32 s44, s44, 1
    s_and_b32 s55, s44, 3
    s_mul_i32 s55, s55, 167936
    s_add_u32 s55, s55, s34
    s_add_u32 s58, s55, s35
    s_and_b32 s57, s44, 63
    s_sub_u32 s61, s3, 4096
    s_nop 15
    s_nop 15
    s_nop 7
    s_mov_b32 m0, 13312
    s_nop 0
    buffer_load_dwordx4 v0, s[8:11], s48 offen offset:0 sc1 lds
    buffer_load_dwordx4 v0, s[8:11], s48 offen offset:1024 sc1 lds
    buffer_load_dwordx4 v0, s[8:11], s48 offen offset:2048 sc1 lds
    s_nop 11
    s_mov_b32 m0, 13312
    s_nop 0
    buffer_load_dwordx4 v0, s[8:11], s48 offen offset:0 sc1 lds
    buffer_load_dwordx4 v0, s[8:11], s48 offen offset:1024 sc1 lds
    buffer_load_dwordx4 v0, s[8:11], s48 offen offset:2048 sc1 lds
    s_nop 11
    s_mov_b32 m0, 13312
    s_nop 0
    buffer_load_dwordx4 v0, s[8:11], s48 offen offset:0 sc1 lds
    buffer_load_dwordx4 v0, s[8:11], s48 offen offset:1024 sc1 lds
    buffer_load_dwordx4 v0, s[8:11], s48 offen offset:2048 sc1 lds
    s_mov_b32 s70, 0
    s_waitcnt lgkmcnt(0)
    s_branch M_c1_2_top
M_c1_2_restart:
    s_waitcnt vmcnt(0) lgkmcnt(0)
    s_nop 7
    s_barrier
    s_mov_b32 m0, 13312
    s_nop 0
    buffer_load_dwordx4 v0, s[8:11], s48 offen offset:0 sc1 lds
    buffer_load_dwordx4 v0, s[8:11], s48 offen offset:1024 sc1 lds
    buffer_load_dwordx4 v0, s[8:11], s48 offen offset:2048 sc1 lds
    ds_read_b128 v[56:59], v5 offset:0
    ds_read_b128 v[60:63], v5 offset:1024
    ds_read_b128 v[64:67], v5 offset:2048
    ds_read_b128 v[68:71], v5 offset:3072
    v_mov_b64 v[12:13], 0
    v_mov_b64 v[14:15], 0
    v_mov_b64 v[16:17], 0
    v_mov_b64 v[18:19], 0
    v_mov_b64 v[20:21], 0
    v_mov_b64 v[22:23], 0
    v_mov_b64 v[24:25], 0
    v_mov_b64 v[26:27], 0
    v_mov_b64 v[28:29], 0
    v_mov_b64 v[30:31], 0
    v_mov_b64 v[32:33], 0
    v_mov_b64 v[34:35], 0
    s_waitcnt vmcnt(0) lgkmcnt(0)
    s_branch M_c1_2_top
M_c1_2_zbad:
    s_cmp_eq_u32 s70, 2
    s_cbranch_scc1 M_c1_2_zok
    v_cmp_u_f32 vcc, v72, v72
    s_cbranch_vccz M_c1_2_exact
    s_cmp_eq_u32 s70, 1
    s_cbranch_scc1 M_c1_2_exact
M_c1_2_vfy0:
    s_mov_b32 s70, 1
    s_mov_b32 s30, 0
    s_waitcnt vmcnt(0) lgkmcnt(0)
    s_nop 7
M_c1_2_vfy:
    v_mov_b32 v10, 0
    s_add_u32 s59, s48, 4096
    buffer_load_dwordx4 v[36:39], v0, s[8:11], s48 offen offset:0 sc1
    buffer_load_dwordx4 v[40:43], v0, s[8:11], s48 offen offset:1024 sc1
    buffer_load_dwordx4 v[44:47], v0, s[8:11], s48 offen offset:2048 sc1
    buffer_load_dwordx4 v[48:51], v0, s[8:11], s48 offen offset:3072 sc1
    buffer_load_dwordx4 v[52:55], v0, s[8:11], s59 offen offset:0 sc1
    s_waitcnt vmcnt(4)
    v_max3_u32 v10, v10, v36, v37
    v_max3_u32 v10, v10, v38, v39
    s_waitcnt vmcnt(3)
    v_max3_u32 v10, v10, v40, v41
    v_max3_u32 v10, v10, v42, v43
    s_waitcnt vmcnt(2)
    v_max3_u32 v10, v10, v44, v45
    v_max3_u32 v10, v10, v46, v47
    s_waitcnt vmcnt(1)
    v_max3_u32 v10, v10, v48, v49
    v_max3_u32 v10, v10, v50, v51
    s_waitcnt vmcnt(0)
    v_max3_u32 v10, v10, v52, v53
    v_max3_u32 v10, v10, v54, v55
    s_add_u32 s59, s49, 4096
    buffer_load_dwordx4 v[36:39], v0, s[8:11], s49 offen offset:0 sc1
    buffer_load_dwordx4 v[40:43], v0, s[8:11], s49 offen offset:1024 sc1
    buffer_load_dwordx4 v[44:47], v0, s[8:11], s49 offen offset:2048 sc1
    buffer_load_dwordx4 v[48:51], v0, s[8:11], s49 offen offset:3072 sc1
    buffer_load_dwordx4 v[52:55], v0, s[8:11], s59 offen offset:0 sc1
    s_waitcnt vmcnt(4)
    v_max3_u32 v10, v10, v36, v37
    v_max3_u32 v10, v10, v38, v39
    s_waitcnt vmcnt(3)
    v_max3_u32 v10, v10, v40, v41
    v_max3_u32 v10, v10, v42, v43
    s_waitcnt vmcnt(2)
    v_max3_u32 v10, v10, v44, v45
    v_max3_u32 v10, v10, v46, v47
    s_waitcnt vmcnt(1)
    v_max3_u32 v10, v10, v48, v49
    v_max3_u32 v10, v10, v50, v51
    s_waitcnt vmcnt(0)
    v_max3_u32 v10, v10, v52, v53
    v_max3_u32 v10, v10, v54, v55
    v_cmp_eq_u32 vcc, -1, v10
    s_cbranch_vccz M_c1_2_restart
    s_add_u32 s30, s30, 1
    s_cmp_ge_u32 s30, 60000
    s_cbranch_scc1 M_fail
    s_branch M_c1_2_vfy
M_c1_2_exact:
    s_nop 7
    s_mov_b32 s70, 2
    s_waitcnt lgkmcnt(0)
    ds_read_b128 v[20:23], v3 offset:18432
    ds_read_b128 v[24:27], v3 offset:18496
    ds_read_b128 v[72:75], v3 offset:18560
    ds_read_b128 v[44:47], v3 offset:18624
    ds_read_b128 v[56:59], v0 offset:0
    s_waitcnt lgkmcnt(0)
    v_mfma_f32_16x16x32_bf16 v[28:31], v[56:59], v[20:23], 0
    s_nop 3
    ds_read_b128 v[60:63], v0 offset:1024
    s_waitcnt lgkmcnt(0)
    v_mfma_f32_16x16x32_bf16 v[28:31], v[60:63], v[24:27], v[28:31]
    s_nop 3
    ds_read_b128 v[56:59], v0 offset:2048
    s_waitcnt lgkmcnt(0)
    v_mfma_f32_16x16x32_bf16 v[28:31], v[56:59], v[72:75], v[28:31]
    s_nop 3
    ds_read_b128 v[60:63], v0 offset:3072
    s_waitcnt lgkmcnt(0)
    v_mfma_f32_16x16x32_bf16 v[28:31], v[60:63], v[44:47], v[28:31]
    s_nop 3
    ds_read_b128 v[56:59], v0 offset:4096
    s_waitcnt lgkmcnt(0)
    v_mfma_f32_16x16x32_bf16 v[32:35], v[56:59], v[20:23], 0
    s_nop 3
    ds_read_b128 v[60:63], v0 offset:5120
    s_waitcnt lgkmcnt(0)
    v_mfma_f32_16x16x32_bf16 v[32:35], v[60:63], v[24:27], v[32:35]
    s_nop 3
    ds_read_b128 v[56:59], v0 offset:6144
    s_waitcnt lgkmcnt(0)
    v_mfma_f32_16x16x32_bf16 v[32:35], v[56:59], v[72:75], v[32:35]
    s_nop 3
    ds_read_b128 v[60:63], v0 offset:7168
    s_waitcnt lgkmcnt(0)
    v_mfma_f32_16x16x32_bf16 v[32:35], v[60:63], v[44:47], v[32:35]
    s_nop 3
    ds_read_b128 v[56:59], v3 offset:20736
    s_waitcnt lgkmcnt(0)
    v_mfma_f32_16x16x32_bf16 v[40:43], v[56:59], v[20:23], 0
    s_nop 3
    ds_read_b128 v[60:63], v3 offset:20800
    s_waitcnt lgkmcnt(0)
    v_mfma_f32_16x16x32_bf16 v[40:43], v[60:63], v[24:27], v[40:43]
    s_nop 3
    ds_read_b128 v[56:59], v3 offset:20864
    s_waitcnt lgkmcnt(0)
    v_mfma_f32_16x16x32_bf16 v[40:43], v[56:59], v[72:75], v[40:43]
    s_nop 3
    ds_read_b128 v[60:63], v3 offset:20928
    s_waitcnt lgkmcnt(0)
    v_mfma_f32_16x16x32_bf16 v[40:43], v[60:63], v[44:47], v[40:43]
    s_nop 3
    v_max3_f32 v68, v28, v29, v30
    v_max3_f32 v68, v68, v31, v32
    v_max3_f32 v68, v68, v33, v34
    s_nop 0
    v_max3_f32 v68, v68, v35, v40
    v_max3_f32 v68, v68, v41, v42
    v_max_f32 v68, v68, v43
    v_mov_b32 v69, v68
    s_nop 1
    v_permlane16_swap_b32 v68, v69
    v_max_f32 v68, v68, v69
    v_mov_b32 v69, v68
    s_nop 1
    v_permlane32_swap_b32 v68, v69
    v_max_f32 v68, v68, v69
    v_sub_f32 v28, v28, v68
    v_exp_f32 v28, v28
    v_sub_f32 v29, v29, v68
    v_exp_f32 v29, v29
    v_sub_f32 v30, v30, v68
    v_exp_f32 v30, v30
    v_sub_f32 v31, v31, v68
    v_exp_f32 v31, v31
    v_sub_f32 v32, v32, v68
    v_exp_f32 v32, v32
    v_sub_f32 v33, v33, v68
    v_exp_f32 v33, v33
    v_sub_f32 v34, v34, v68
    v_exp_f32 v34, v34
    v_sub_f32 v35, v35, v68
    v_exp_f32 v35, v35
    v_sub_f32 v40, v40, v68
    v_exp_f32 v40, v40
    v_sub_f32 v41, v41, v68
    v_exp_f32 v41, v41
    v_sub_f32 v42, v42, v68
    v_exp_f32 v42, v42
    v_sub_f32 v43, v43, v68
    v_exp_f32 v43, v43
    v_cvt_pk_bf16_f32 v28, v28, v29
    v_cvt_pk_bf16_f32 v29, v30, v31
    v_cvt_pk_bf16_f32 v30, v32, v33
    v_cvt_pk_bf16_f32 v31, v34, v35
    v_cvt_pk_bf16_f32 v40, v40, v41
    v_cvt_pk_bf16_f32 v41, v42, v43
    v_mfma_f32_16x16x32_bf16 v[20:23], v[80:83], v[28:31], 0
    v_mfma_f32_16x16x32_bf16 v[24:27], v[84:87], v[28:31], 0
    v_mfma_f32_16x16x32_bf16 v[72:75], v[64:67], v[28:31], 0
    ds_read_b128 v[56:59], v3 offset:20864
    s_waitcnt lgkmcnt(0)
    s_nop 7
    v_mfma_f32_16x16x16_bf16 v[72:75], v[10:11], v[40:41], v[72:75]
    s_nop 7
    s_branch M_c1_2_fin
M_c1_2_last:
    s_cmp_lg_u32 s70, 0
    s_cbranch_scc1 M_c1_2_last2
    v_cmp_u_f32 vcc, v32, v32
    s_cbranch_vccnz M_c1_2_vfy0
M_c1_2_last2:
    s_lshl_b32 s4, s44, 18
    s_add_u32 s4, s4, s53
    buffer_store_dwordx4 v[76:79], v0, s[8:11], s4 offen offset:2048 sc1
    s_mov_b32 s4, 0x10000000
    s_waitcnt vmcnt(0) lgkmcnt(0)
    s_barrier
    s_nop 7
    v_mov_b64 v[72:73], -1
    v_mov_b64 v[74:75], -1
    s_add_u32 s28, s44, 3
    s_and_b32 s29, s28, 3
    s_mul_i32 s31, s22, 160
    s_waitcnt vmcnt(0)
    s_add_u32 s44, s44, 1
    s_cmp_eq_u32 s44, 128
    s_cbranch_scc1 M_end
    s_branch M_c1_2_layer
M_c1_2_lr:
    s_mov_b32 s30, 0
M_c1_2_lr_l:
    s_waitcnt lgkmcnt(0)
    s_and_b32 s27, s30, 1
    s_cbranch_scc0 M_c1_2_lr_n
    s_waitcnt vmcnt(3)
    s_mov_b32 m0, 13312
    s_nop 0
    buffer_load_dwordx4 v0, s[8:11], s48 offen offset:0 sc1 lds
    buffer_load_dwordx4 v0, s[8:11], s48 offen offset:1024 sc1 lds
    buffer_load_dwordx4 v0, s[8:11], s48 offen offset:2048 sc1 lds
M_c1_2_lr_n:
    ds_read_b128 v[36:39], v6 offset:13312
    ds_read_b128 v[40:43], v6 offset:14336
    ds_read_b128 v[44:47], v6 offset:15360
    ds_read_b128 v[48:51], v6 offset:16384
    ds_read_b128 v[52:55], v6 offset:17408
    s_waitcnt lgkmcnt(2)
    v_max3_u32 v10, v36, v40, v44
    s_waitcnt lgkmcnt(0)
    v_max3_u32 v10, v10, v48, v52
    v_cmp_eq_u32 vcc, -1, v10
    s_cbranch_vccz M_c1_2_lr_d
    s_add_u32 s30, s30, 1
    s_cmp_ge_u32 s30, 480000
    s_cbranch_scc1 M_fail
    s_branch M_c1_2_lr_l
M_c1_2_lr_d:
    ds_read_b128 v[56:59], v5 offset:0
    ds_read_b128 v[60:63], v5 offset:1024
    ds_read_b128 v[64:67], v5 offset:2048
    ds_read_b128 v[68:71], v5 offset:3072
    v_mov_b64 v[12:13], 0
    v_mov_b64 v[14:15], 0
    v_mov_b64 v[16:17], 0
    v_mov_b64 v[18:19], 0
    v_mov_b64 v[20:21], 0
    v_mov_b64 v[22:23], 0
    v_mov_b64 v[24:25], 0
    v_mov_b64 v[26:27], 0
    v_mov_b64 v[28:29], 0
    v_mov_b64 v[30:31], 0
    v_mov_b64 v[32:33], 0
    v_mov_b64 v[34:35], 0
    s_waitcnt lgkmcnt(0)
    s_branch M_c1_2_lr_r
M_c1_2_rr:
    s_mov_b32 s30, 0
M_c1_2_rr_l:
    s_waitcnt lgkmcnt(0)
    s_and_b32 s27, s30, 1
    s_cbranch_scc1 M_c1_2_rr_n
    s_waitcnt vmcnt(1)
    s_mov_b32 m0, 8192
    s_nop 0
    buffer_load_dwordx4 v0, s[8:11], s49 offen offset:3072 sc1 lds
M_c1_2_rr_n:
    ds_read_b128 v[36:39], v6 offset:8192
    ds_read_b128 v[40:43], v6 offset:9216
    ds_read_b128 v[44:47], v6 offset:10240
    ds_read_b128 v[48:51], v6 offset:11264
    ds_read_b32 v11, v6 offset:12288
    s_waitcnt lgkmcnt(2)
    v_max3_u32 v10, v36, v40, v44
    s_waitcnt lgkmcnt(0)
    v_max3_u32 v10, v10, v48, v11
    v_cmp_eq_u32 vcc, -1, v10
    s_cbranch_vccz M_c1_2_rr_d
    s_add_u32 s30, s30, 1
    s_cmp_ge_u32 s30, 480000
    s_cbranch_scc1 M_fail
    s_branch M_c1_2_rr_l
M_c1_2_rr_d:
    s_branch M_c1_2_rr_r
M_c1_2_first:
    s_mul_i32 s27, s21, 167936
    s_add_u32 s27, s27, s34
    s_mul_i32 s28, s22, 4224
    s_add_u32 s28, s28, s27
    s_mov_b32 exec_hi, 0
    buffer_load_dword v10, v9, s[8:11], s28 offen sc1
    s_lshl_b32 s28, s22, 10
    s_add_u32 s28, s28, s27
    s_add_u32 s28, s28, 135168
    s_mov_b64 exec, 0xff
    buffer_load_dword v10, v9, s[8:11], s28 offen sc1
    s_mul_i32 s27, s21, 5120
    s_add_u32 s27, s27, s41
    s_mul_i32 s28, s22, 160
    s_add_u32 s28, s28, s27
    s_mov_b64 exec, 3
    buffer_load_dword v10, v9, s[8:11], s28 offen sc1
    s_mov_b64 exec, -1
    s_barrier
    s_and_b32 s26, s44, 63
    s_lshl_b32 s26, s26, 18
    s_add_u32 s26, s26, s50
    s_add_u32 s26, s26, 4096
    s_add_u32 s3, s26, 16777216
    s_mov_b32 m0, 4096
    s_nop 0
    buffer_load_dwordx4 v0, s[8:11], s26 offen offset:0 sc1 lds
    buffer_load_dwordx4 v0, s[8:11], s26 offen offset:1024 sc1 lds
    buffer_load_dwordx4 v[80:83], v0, s[8:11], s3 offen offset:0 sc1
    buffer_load_dwordx4 v[84:87], v0, s[8:11], s3 offen offset:1024 sc1
    s_and_b32 s26, s44, 63
    s_add_u32 s26, s26, 1
    s_min_u32 s26, s26, 63
    s_lshl_b32 s26, s26, 18
    s_add_u32 s26, s26, s50
    s_add_u32 s26, s26, 4096
    s_add_u32 s3, s26, 16777216
    s_waitcnt vmcnt(0) lgkmcnt(0)
    s_barrier
    s_branch M_c1_2_first_r
M_c1_2_first2:
    s_barrier
    s_branch M_c1_2_first2_r
M_c1_3_layer:
    s_lshr_b32 s27, s44, 6
    s_mul_i32 s50, s27, 33554432
    s_lshl_b32 s27, s22, 13
    s_add_u32 s50, s50, s27
    s_add_u32 s50, s50, 37748736
    s_barrier
    s_mov_b32 s26, 0x10010000
    s_mov_b32 s3, s26
    s_mul_i32 s27, s20, 5120
    s_add_u32 s48, s27, 167772160
    s_sub_u32 s49, 167777280, s27
    s_mov_b32 m0, 13312
    s_nop 0
    buffer_load_dwordx4 v0, s[8:11], s48 offen offset:3072 sc1 lds
    s_mov_b32 m0, 17408
    s_add_u32 s59, s48, 4096
    buffer_load_dwordx4 v0, s[8:11], s59 offen offset:0 sc1 lds
    s_and_b32 s55, s44, 3
    s_mul_i32 s55, s55, 167936
    s_add_u32 s55, s55, s34
    s_add_u32 s58, s55, s35
    s_and_b32 s57, s44, 63
    s_sub_u32 s61, s26, 6144
    ds_read_b128 v[56:59], v5 offset:0
    ds_read_b128 v[60:63], v5 offset:1024
    ds_read_b128 v[64:67], v5 offset:2048
    ds_read_b128 v[68:71], v5 offset:3072
    v_mov_b64 v[12:13], 0
    v_mov_b64 v[14:15], 0
    v_mov_b64 v[16:17], 0
    v_mov_b64 v[18:19], 0
    v_mov_b64 v[20:21], 0
    v_mov_b64 v[22:23], 0
    v_mov_b64 v[24:25], 0
    v_mov_b64 v[26:27], 0
    v_mov_b64 v[28:29], 0
    v_mov_b64 v[30:31], 0
    v_mov_b64 v[32:33], 0
    v_mov_b64 v[34:35], 0
    s_mov_b32 s70, 0
    s_waitcnt vmcnt(0) lgkmcnt(0)
M_c1_3_top:
    s_waitcnt vmcnt(4)
    s_barrier
    ds_read_b128 v[36:39], v6 offset:13312
    ds_read_b128 v[40:43], v6 offset:14336
    s_mov_b32 m0, 12288
    s_add_u32 s59, s49, 4096
    buffer_load_dwordx4 v0, s[8:11], s59 offen offset:0 sc1 lds
M_c1_3_lr_r:
    s_waitcnt lgkmcnt(1)
    v_smfmac_f32_16x16x64_bf16 v[20:23], v[36:39], v[56:63], v1
    ds_read_b128 v[56:59], v5 offset:4096
    v_smfmac_f32_16x16x64_bf16 v[24:27], v[36:39], v[64:71], v1
    ds_read_b128 v[60:63], v5 offset:5120
    v_smfmac_f32_16x16x64_bf16 v[28:31], v[36:39], a[248:255], v1
    ds_read_b128 v[64:67], v5 offset:6144
    v_smfmac_f32_16x16x64_bf16 v[32:35], v[36:39], a[240:247], v1
    ds_read_b128 v[68:71], v5 offset:7168
    v_smfmac_f32_16x16x64_bf16 v[12:15], v[36:39], a[232:239], v1
    ds_read_b128 v[44:47], v6 offset:15360
    s_waitcnt lgkmcnt(3)
    v_smfmac_f32_16x16x64_bf16 v[16:19], v[36:39], v[56:63], v1
    ds_read_b128 v[56:59], v5 offset:8192
    v_smfmac_f32_16x16x64_bf16 v[20:23], v[40:43], a[224:231], v1
    ds_read_b128 v[60:63], v5 offset:9216
    s_waitcnt lgkmcnt(3)
    v_smfmac_f32_16x16x64_bf16 v[24:27], v[40:43], v[64:71], v1
    ds_read_b128 v[64:67], v5 offset:10240
    v_smfmac_f32_16x16x64_bf16 v[28:31], v[40:43], a[216:223], v1
    ds_read_b128 v[68:71], v5 offset:11264
    v_smfmac_f32_16x16x64_bf16 v[32:35], v[40:43], a[208:215], v1
    ds_read_b128 v[48:51], v6 offset:16384
    s_waitcnt lgkmcnt(3)
    v_smfmac_f32_16x16x64_bf16 v[12:15], v[40:43], v[56:63], v1
    ds_read_b128 v[56:59], v5 offset:12288
    v_smfmac_f32_16x16x64_bf16 v[16:19], v[40:43], a[200:207], v1
    ds_read_b128 v[60:63], v5 offset:13312
    s_waitcnt lgkmcnt(3)
    v_smfmac_f32_16x16x64_bf16 v[20:23], v[44:47], v[64:71], v1
    ds_read_b128 v[64:67], v5 offset:14336
    v_smfmac_f32_16x16x64_bf16 v[24:27], v[44:47], a[192:199], v1
    ds_read_b128 v[68:71], v5 offset:15360
    v_smfmac_f32_16x16x64_bf16 v[28:31], v[44:47], a[184:191], v1
    ds_read_b128 v[52:55], v6 offset:17408
    s_waitcnt lgkmcnt(3)
    v_smfmac_f32_16x16x64_bf16 v[32:35], v[44:47], v[56:63], v1
    ds_read_b128 v[56:59], v5 offset:16384
    v_smfmac_f32_16x16x64_bf16 v[20:23], v[48:51], a[176:183], v1
    ds_read_b128 v[60:63], v5 offset:17408
    s_waitcnt lgkmcnt(3)
    v_max3_u32 v10, v36, v40, v44
    v_smfmac_f32_16x16x64_bf16 v[24:27], v[48:51], v[64:71], v1
    ds_read_b128 v[64:67], v5 offset:18432
    s_waitcnt lgkmcnt(3)
    v_max3_u32 v10, v10, v48, v52
    v_smfmac_f32_16x16x64_bf16 v[28:31], v[48:51], a[168:175], v1
    ds_read_b128 v[68:71], v5 offset:19456
    v_cmp_eq_u32 vcc, -1, v10
    v_smfmac_f32_16x16x64_bf16 v[32:35], v[48:51], a[160:167], v1
    s_cbranch_vccnz M_c1_3_lr
    s_waitcnt vmcnt(0)
    s_barrier
    ds_read_b128 v[36:39], v6 offset:8192
    ds_read_b128 v[40:43], v6 offset:9216
    s_waitcnt lgkmcnt(4)
    v_smfmac_f32_16x16x64_bf16 v[20:23], v[52:55], v[56:63], v1
    ds_read_b128 v[44:47], v6 offset:10240
    ds_read_b128 v[48:51], v6 offset:11264
    v_smfmac_f32_16x16x64_bf16 v[24:27], v[52:55], a[152:159], v1
    ds_read_b32 v11, v6 offset:12288
    ds_read_b128 v[56:59], v5 offset:20480
    s_waitcnt lgkmcnt(6)
    v_smfmac_f32_16x16x64_bf16 v[28:31], v[52:55], v[64:71], v1
    ds_read_b128 v[60:63], v5 offset:21504
    s_waitcnt lgkmcnt(4)
    v_max3_u32 v10, v36, v40, v44
    v_smfmac_f32_16x16x64_bf16 v[32:35], v[52:55], a[144:151], v1
    s_waitcnt lgkmcnt(2)
    v_max3_u32 v10, v10, v48, v11
    v_cmp_eq_u32 vcc, -1, v10
    s_cbranch_vccnz M_c1_3_rr
M_c1_3_rr_r:
    s_mov_b32 m0, 23040
    ds_read_b128 v[64:67], v5 offset:22528
    ds_read_b128 v[68:71], v5 offset:23552
    ds_read_b128 v[52:55], v6 offset:12288
    buffer_store_dwordx4 v[76:79], v0, s[8:11], s4 offen offset:3072 sc1
    s_mov_b32 s4, 0x10000000
    buffer_load_dword v9, s[8:11], s61 offen sc1 lds
    v_smfmac_f32_16x16x64_bf16 v[20:23], v[36:39], a[136:143], v1
    s_waitcnt lgkmcnt(3)
    v_smfmac_f32_16x16x64_bf16 v[24:27], v[36:39], v[56:63], v1
    ds_read_b128 v[56:59], v5 offset:24576
    v_smfmac_f32_16x16x64_bf16 v[20:23], v[40:43], a[128:135], v1
    ds_read_b128 v[60:63], v5 offset:25600
    s_waitcnt lgkmcnt(3)
    v_smfmac_f32_16x16x64_bf16 v[24:27], v[40:43], v[64:71], v1
    ds_read_b128 v[64:67], v5 offset:26624
    v_smfmac_f32_16x16x64_bf16 v[20:23], v[44:47], a[120:127], v1
    ds_read_b128 v[68:71], v5 offset:27648
    v_smfmac_f32_16x16x64_bf16 v[24:27], v[44:47], a[112:119], v1
    s_waitcnt lgkmcnt(2)
    v_smfmac_f32_16x16x64_bf16 v[20:23], v[48:51], v[56:63], v1
    ds_read_b128 v[56:59], v5 offset:28672
    v_smfmac_f32_16x16x64_bf16 v[24:27], v[48:51], a[104:111], v1
    ds_read_b128 v[60:63], v5 offset:29696
    s_waitcnt lgkmcnt(2)
    v_smfmac_f32_16x16x64_bf16 v[20:23], v[52:55], v[64:71], v1
    ds_read_b128 v[64:67], v5 offset:30720
    v_smfmac_f32_16x16x64_bf16 v[24:27], v[52:55], a[96:103], v1
    ds_read_b128 v[68:71], v5 offset:31744
    v_smfmac_f32_16x16x64_bf16 v[28:31], v[36:39], a[88:95], v1
    s_cmp_eq_u32 s57, 0
    s_cbranch_scc1 M_c1_3_first
M_c1_3_first_r:
    s_waitcnt lgkmcnt(2)
    v_smfmac_f32_16x16x64_bf16 v[32:35], v[36:39], v[56:63], v1
    ds_read_b128 v[56:59], v5 offset:32768
    v_permlane32_swap_b32 v20, v21
    v_smfmac_f32_16x16x64_bf16 v[28:31], v[40:43], a[80:87], v1
    ds_read_b128 v[60:63], v5 offset:33792
    s_waitcnt lgkmcnt(2)
    v_permlane32_swap_b32 v22, v23
    v_smfmac_f32_16x16x64_bf16 v[32:35], v[40:43], v[64:71], v1
    ds_read_b128 v[64:67], v0 offset:2048
    v_permlane32_swap_b32 v24, v25
    v_smfmac_f32_16x16x64_bf16 v[28:31], v[44:47], a[72:79], v1
    ds_read_b128 v[68:71], v0 offset:3072
    v_permlane32_swap_b32 v26, v27
    v_smfmac_f32_16x16x64_bf16 v[32:35], v[44:47], a[64:71], v1
    s_waitcnt lgkmcnt(2)
    v_add_f32 v20, v20, v21
    v_add_f32 v22, v22, v23
    v_smfmac_f32_16x16x64_bf16 v[28:31], v[48:51], v[56:63], v1
    ds_read_b128 v[56:59], v0 offset:0
    v_add_f32 v24, v24, v25
    v_add_f32 v26, v26, v27
    v_smfmac_f32_16x16x64_bf16 v[32:35], v[48:51], a[56:63], v1
    ds_read_b128 v[60:63], v0 offset:1024
    v_mul_f32 v20, s40, v20
    v_mul_f32 v24, s40, v24
    v_smfmac_f32_16x16x64_bf16 v[28:31], v[52:55], a[48:55], v1
    v_mul_f32 v22, s40, v22
    v_mul_f32 v26, s40, v26
    v_smfmac_f32_16x16x64_bf16 v[32:35], v[52:55], a[40:47], v1
    v_cvt_pk_bf16_f32 v20, v20, v24
    v_cvt_pk_bf16_f32 v21, v22, v26
    v_smfmac_f32_16x16x64_bf16 v[12:15], v[36:39], a[32:39], v1
    ds_write_b32 v2, v20 offset:18432
    v_smfmac_f32_16x16x64_bf16 v[16:19], v[36:39], a[24:31], v1
    ds_write_b32 v2, v21 offset:19008
    v_permlane32_swap_b32 v28, v29
    v_smfmac_f32_16x16x64_bf16 v[12:15], v[40:43], a[16:23], v1
    ds_read_b128 v[36:39], v6 offset:15360
    v_permlane32_swap_b32 v30, v31
    v_smfmac_f32_16x16x64_bf16 v[16:19], v[40:43], a[8:15], v1
    ds_read_b128 v[40:43], v6 offset:16384
    v_permlane32_swap_b32 v32, v33
    v_smfmac_f32_16x16x64_bf16 v[12:15], v[44:47], a[0:7], v1
    s_waitcnt lgkmcnt(2)
    s_barrier
    v_permlane32_swap_b32 v34, v35
    v_smfmac_f32_16x16x64_bf16 v[16:19], v[44:47], v[248:255], v1
    ds_read_b128 v[20:23], v3 offset:18432
    v_add_f32 v28, v28, v29
    v_add_f32 v30, v30, v31
    v_smfmac_f32_16x16x64_bf16 v[12:15], v[48:51], v[240:247], v1
    ds_read_b128 v[24:27], v3 offset:18496
    v_add_f32 v32, v32, v33
    v_add_f32 v34, v34, v35
    v_smfmac_f32_16x16x64_bf16 v[16:19], v[48:51], v[232:239], v1
    ds_read_b128 v[72:75], v3 offset:18560
    v_cvt_pk_bf16_f32 v28, v28, v32
    v_cvt_pk_bf16_f32 v29, v30, v34
    v_smfmac_f32_16x16x64_bf16 v[12:15], v[52:55], v[224:231], v1
    ds_write_b32 v2, v28 offset:20736
    ds_read_b128 v[44:47], v3 offset:18624
    v_smfmac_f32_16x16x64_bf16 v[16:19], v[52:55], v[216:223], v1
    ds_write_b32 v2, v29 offset:21312
    s_waitcnt lgkmcnt(7)
    v_smfmac_f32_16x16x64_bf16 v[12:15], v[36:39], v[208:215], v1
    ds_read_b128 v[48:51], v6 offset:17408
    v_mov_b64 v[10:11], s[16:17]
    v_smfmac_f32_16x16x64_bf16 v[16:19], v[36:39], v[200:207], v1
    s_waitcnt lgkmcnt(6)
    v_mfma_f32_16x16x32_bf16 v[28:31], v[56:59], v[20:23], 0
    ds_read_b128 v[56:59], v0 offset:4096
    s_waitcnt lgkmcnt(6)
    v_mfma_f32_16x16x32_bf16 v[28:31], v[60:63], v[24:27], v[28:31]
    ds_read_b128 v[60:63], v0 offset:5120
    s_waitcnt lgkmcnt(3)
    s_barrier
    v_mfma_f32_16x16x32_bf16 v[28:31], v[64:67], v[72:75], v[28:31]
    ds_read_b128 v[64:67], v0 offset:6144
    v_mfma_f32_16x16x32_bf16 v[28:31], v[68:71], v[44:47], v[28:31]
    ds_read_b128 v[68:71], v0 offset:7168
    v_smfmac_f32_16x16x64_bf16 v[12:15], v[40:43], v[192:199], v1
    ds_read_b128 v[36:39], v3 offset:20736
    v_smfmac_f32_16x16x64_bf16 v[16:19], v[40:43], v[184:191], v1
    ds_read_b128 v[52:55], v3 offset:20800
    s_waitcnt lgkmcnt(4)
    v_mfma_f32_16x16x32_bf16 v[32:35], v[56:59], v[20:23], 0
    s_nop 0
    v_exp_f32 v28, v28
    ds_read_b128 v[56:59], v3 offset:20864
    v_mfma_f32_16x16x32_bf16 v[32:35], v[60:63], v[24:27], v[32:35]
    s_waitcnt lgkmcnt(3)
    v_exp_f32 v29, v29
    ds_read_b128 v[60:63], v3 offset:20928
    v_mfma_f32_16x16x32_bf16 v[32:35], v[64:67], v[72:75], v[32:35]
    v_exp_f32 v30, v30
    v_mfma_f32_16x16x32_bf16 v[32:35], v[68:71], v[44:47], v[32:35]
    s_waitcnt lgkmcnt(3)
    v_exp_f32 v31, v31
    v_mfma_f32_16x16x32_bf16 v[40:43], v[36:39], v[20:23], 0
    s_waitcnt lgkmcnt(2)
    v_cvt_pk_bf16_f32 v28, v28, v29
    v_cvt_pk_bf16_f32 v29, v30, v31
    v_mfma_f32_16x16x32_bf16 v[40:43], v[52:55], v[24:27], v[40:43]
    s_waitcnt lgkmcnt(1)
    v_mov_b64 v[64:65], s[24:25]
    v_mov_b64 v[66:67], s[24:25]
    v_mfma_f32_16x16x32_bf16 v[40:43], v[56:59], v[72:75], v[40:43]
    s_waitcnt lgkmcnt(0)
    v_exp_f32 v32, v32
    v_mfma_f32_16x16x32_bf16 v[40:43], v[60:63], v[44:47], v[40:43]
    v_exp_f32 v33, v33
    v_smfmac_f32_16x16x64_bf16 v[12:15], v[48:51], v[176:183], v1
    v_exp_f32 v34, v34
    v_smfmac_f32_16x16x64_bf16 v[16:19], v[48:51], v[168:175], v1
    v_exp_f32 v35, v35
    v_cvt_pk_bf16_f32 v30, v32, v33
    v_cvt_pk_bf16_f32 v31, v34, v35
    s_nop 0
    v_exp_f32 v40, v40
    v_mfma_f32_16x16x32_bf16 v[72:75], v[64:67], v[28:31], 0
    v_exp_f32 v41, v41
    v_mfma_f32_16x16x32_bf16 v[20:23], v[80:83], v[28:31], 0
    v_exp_f32 v42, v42
    v_mfma_f32_16x16x32_bf16 v[24:27], v[84:87], v[28:31], 0
    v_exp_f32 v43, v43
    v_cvt_pk_bf16_f32 v40, v40, v41
    v_cvt_pk_bf16_f32 v41, v42, v43
    v_cvt_pk_bf16_f32 v12, v12, v13
    v_cvt_pk_bf16_f32 v13, v14, v15
    v_mfma_f32_16x16x16_bf16 v[72:75], v[10:11], v[40:41], v[72:75]
    v_cvt_pk_bf16_f32 v14, v16, v17
    v_cvt_pk_bf16_f32 v15, v18, v19
M_c1_3_fin:
    v_mfma_f32_16x16x16_bf16 v[20:23], v[12:13], v[40:41], v[20:23]
    s_cmp_eq_u32 s57, 63
    v_cndmask_b32_e64 v76, v12, v60, s[66:67]
    v_cndmask_b32_e64 v77, v13, v61, s[66:67]
    v_mfma_f32_16x16x16_bf16 v[24:27], v[14:15], v[40:41], v[24:27]
    v_cndmask_b32_e64 v78, v14, v62, s[66:67]
    v_cndmask_b32_e64 v79, v15, v63, s[66:67]
    s_cbranch_scc1 M_c1_3_last
    v_rcp_f32 v74, v72
    v_subrev_u32 v73, s68, v72
    v_cmp_lt_u32 vcc, s69, v73
    v_mov_b64 v[44:45], 0
    v_mov_b64 v[46:47], 0
    v_cndmask_b32_e64 v20, v20, v24, s[18:19]
    v_cndmask_b32_e64 v21, v21, v25, s[18:19]
    v_cndmask_b32_e64 v22, v22, v26, s[18:19]
    v_cndmask_b32_e64 v23, v23, v27, s[18:19]
    v_pk_mul_f32 v[20:21], v[20:21], v[74:75] op_sel_hi:[1,0]
    v_pk_mul_f32 v[22:23], v[22:23], v[74:75] op_sel_hi:[1,0]
    v_cvt_pk_bf16_f32 v20, v20, v21
    v_cvt_pk_bf16_f32 v21, v22, v23
    ds_write_b64 v0, v[20:21] offset:14344
    s_cbranch_vccnz M_c1_3_zbad
M_c1_3_zok:
    s_cmp_eq_u32 s57, 0
    s_cbranch_scc1 M_c1_3_first2
M_c1_3_first2_r:
    buffer_load_dwordx4 v[80:83], v0, s[8:11], s3 offen offset:0 sc1
    buffer_load_dwordx4 v[84:87], v0, s[8:11], s3 offen offset:1024 sc1
    s_waitcnt lgkmcnt(0)
    s_barrier
    ds_read_b128 v[32:35], v0 offset:13312
    ds_read_b128 v[52:55], v0 offset:14336
    s_mov_b32 m0, 6144
    s_nop 0
    buffer_load_dwordx4 v0, s[8:11], s26 offen offset:0 sc1 lds
    buffer_load_dwordx4 v0, s[8:11], s26 offen offset:1024 sc1 lds
    v_mov_b64 v[68:69], 0
    v_mov_b64 v[70:71], 0
    v_mov_b64 v[64:65], 0
    v_mov_b64 v[66:67], 0
    v_mov_b64 v[60:61], 0
    v_mov_b64 v[62:63], 0
    v_mov_b64 v[56:57], 0
    v_mov_b64 v[58:59], 0
    s_waitcnt lgkmcnt(1)
    s_nop 0
    v_smfmac_f32_16x16x64_bf16 v[56:59], v[32:35], v[160:167], v1
    v_smfmac_f32_16x16x64_bf16 v[60:63], v[32:35], v[144:151], v1
    s_waitcnt lgkmcnt(0)
    v_smfmac_f32_16x16x64_bf16 v[56:59], v[52:55], v[152:159], v1
    v_smfmac_f32_16x16x64_bf16 v[60:63], v[52:55], v[136:143], v1
    v_smfmac_f32_16x16x64_bf16 v[64:67], v[32:35], v[128:135], v1
    v_smfmac_f32_16x16x64_bf16 v[68:71], v[32:35], v[112:119], v1
    v_permlane32_swap_b32 v56, v57
    v_smfmac_f32_16x16x64_bf16 v[64:67], v[52:55], v[120:127], v1
    v_permlane32_swap_b32 v58, v59
    v_smfmac_f32_16x16x64_bf16 v[68:71], v[52:55], v[104:111], v1
    v_add_f32 v56, v56, v57
    v_add_f32 v58, v58, v59
    v_smfmac_f32_16x16x64_bf16 v[44:47], v[32:35], v[96:103], v1
    v_permlane32_swap_b32 v60, v61
    v_smfmac_f32_16x16x64_bf16 v[44:47], v[52:55], v[88:95], v1
    v_permlane32_swap_b32 v62, v63
    v_add_f32 v60, v60, v61
    v_add_f32 v62, v62, v63
    v_cvt_pk_bf16_f32 v36, v56, v60
    v_cvt_pk_bf16_f32 v38, v58, v62
    v_permlane32_swap_b32 v64, v65
    v_permlane32_swap_b32 v66, v67
    v_add_f32 v64, v64, v65
    v_add_f32 v66, v66, v67
    v_permlane32_swap_b32 v68, v69
    v_permlane32_swap_b32 v70, v71
    v_add_f32 v68, v68, v69
    v_add_f32 v70, v70, v71
    v_cvt_pk_bf16_f32 v37, v64, v68
    v_cvt_pk_bf16_f32 v39, v66, v70
    buffer_store_dwordx4 v[36:39], v0, s[8:11], s58 offen sc1
    v_permlane32_swap_b32 v44, v45
    v_permlane32_swap_b32 v46, v47
    v_add_f32 v44, v44, v45
    v_add_f32 v46, v46, v47
    v_cvt_pk_bf16_f32 v44, v44, v46
    buffer_store_dword v44, v7, s[8:11], s55 offen sc1
    s_add_u32 s27, s44, 1
    s_and_b32 s27, s27, 3
    s_mul_i32 s48, s27, 5120
    s_add_u32 s48, s48, s41
    s_lshl_b32 s27, s27, 15
    s_add_u32 s49, s27, s47
    ds_read_b128 v[56:59], v5 offset:0
    ds_read_b128 v[60:63], v5 offset:1024
    ds_read_b128 v[64:67], v5 offset:2048
    ds_read_b128 v[68:71], v5 offset:3072
    v_mov_b64 v[12:13], 0
    v_mov_b64 v[14:15], 0
    v_mov_b64 v[16:17], 0
    v_mov_b64 v[18:19], 0
    v_mov_b64 v[20:21], 0
    v_mov_b64 v[22:23], 0
    v_mov_b64 v[24:25], 0
    v_mov_b64 v[26:27], 0
    v_mov_b64 v[28:29], 0
    v_mov_b64 v[30:31], 0
    v_mov_b64 v[32:33], 0
    v_mov_b64 v[34:35], 0
    ds_read_b64 v[10:11], v0 offset:23296
    s_waitcnt lgkmcnt(0)
    v_min_u32 v10, v10, v11
    s_nop 0
    v_readfirstlane_b32 s28, v10
    s_nop 0
    s_max_u32 s54, s54, s28
    s_barrier
    s_and_b32 s26, s44, 63
    s_add_u32 s26, s26, 2
    s_min_u32 s26, s26, 63
    s_lshl_b32 s26, s26, 18
    s_add_u32 s26, s26, s50
    s_add_u32 s26, s26, 6144
    s_add_u32 s3, s26, 16777216
    s_lshl_b32 s4, s44, 18
    s_add_u32 s4, s4, s53
    s_add_u32 s44, s44, 1
    s_and_b32 s55, s44, 3
    s_mul_i32 s55, s55, 167936
    s_add_u32 s55, s55, s34
    s_add_u32 s58, s55, s35
    s_and_b32 s57, s44, 63
    s_sub_u32 s61, s26, 6144
    s_nop 15
    s_nop 15
    s_nop 7
    s_mov_b32 m0, 13312
    s_nop 0
    buffer_load_dwordx4 v0, s[8:11], s48 offen offset:3072 sc1 lds
    s_mov_b32 m0, 17408
    s_add_u32 s59, s48, 4096
    buffer_load_dwordx4 v0, s[8:11], s59 offen offset:0 sc1 lds
    s_nop 11
    s_mov_b32 m0, 13312
    s_nop 0
    buffer_load_dwordx4 v0, s[8:11], s48 offen offset:3072 sc1 lds
    s_mov_b32 m0, 17408
    s_add_u32 s59, s48, 4096
    buffer_load_dwordx4 v0, s[8:11], s59 offen offset:0 sc1 lds
    s_nop 11
    s_mov_b32 m0, 13312
    s_nop 0
    buffer_load_dwordx4 v0, s[8:11], s48 offen offset:3072 sc1 lds
    s_mov_b32 m0, 17408
    s_add_u32 s59, s48, 4096
    buffer_load_dwordx4 v0, s[8:11], s59 offen offset:0 sc1 lds
    s_add_u32 s27, s44, 2
    s_or_b32 s28, s44, 63
    s_add_u32 s28, s28, 1
    s_min_u32 s27, s27, s28
    s_cmp_lt_u32 s54, s27
    s_cbranch_scc1 M_c1_3_wkw
M_c1_3_wkw_r:
    s_mov_b32 s70, 0
    s_branch M_c1_3_top
M_c1_3_restart:
    s_waitcnt vmcnt(0) lgkmcnt(0)
    s_nop 7
    s_barrier
    s_mov_b32 m0, 13312
    s_nop 0
    buffer_load_dwordx4 v0, s[8:11], s48 offen offset:3072 sc1 lds
    s_mov_b32 m0, 17408
    s_add_u32 s59, s48, 4096
    buffer_load_dwordx4 v0, s[8:11], s59 offen offset:0 sc1 lds
    ds_read_b128 v[56:59], v5 offset:0
    ds_read_b128 v[60:63], v5 offset:1024
    ds_read_b128 v[64:67], v5 offset:2048
    ds_read_b128 v[68:71], v5 offset:3072
    v_mov_b64 v[12:13], 0
    v_mov_b64 v[14:15], 0
    v_mov_b64 v[16:17], 0
    v_mov_b64 v[18:19], 0
    v_mov_b64 v[20:21], 0
    v_mov_b64 v[22:23], 0
    v_mov_b64 v[24:25], 0
    v_mov_b64 v[26:27], 0
    v_mov_b64 v[28:29], 0
    v_mov_b64 v[30:31], 0
    v_mov_b64 v[32:33], 0
    v_mov_b64 v[34:35], 0
    s_waitcnt vmcnt(0) lgkmcnt(0)
    s_branch M_c1_3_top
M_c1_3_zbad:
    s_cmp_eq_u32 s70, 2
    s_cbranch_scc1 M_c1_3_zok
    v_cmp_u_f32 vcc, v72, v72
    s_cbranch_vccz M_c1_3_exact
    s_cmp_eq_u32 s70, 1
    s_cbranch_scc1 M_c1_3_exact
M_c1_3_vfy0:
    s_mov_b32 s70, 1
    s_mov_b32 s30, 0
    s_waitcnt vmcnt(0) lgkmcnt(0)
    s_nop 7
M_c1_3_vfy:
    v_mov_b32 v10, 0
    s_add_u32 s59, s48, 4096
    buffer_load_dwordx4 v[36:39], v0, s[8:11], s48 offen offset:0 sc1
    buffer_load_dwordx4 v[40:43], v0, s[8:11], s48 offen offset:1024 sc1
    buffer_load_dwordx4 v[44:47], v0, s[8:11], s48 offen offset:2048 sc1
    buffer_load_dwordx4 v[48:51], v0, s[8:11], s48 offen offset:3072 sc1
    buffer_load_dwordx4 v[52:55], v0, s[8:11], s59 offen offset:0 sc1
    s_waitcnt vmcnt(4)
    v_max3_u32 v10, v10, v36, v37
    v_max3_u32 v10, v10, v38, v39
    s_waitcnt vmcnt(3)
    v_max3_u32 v10, v10, v40, v41
    v_max3_u32 v10, v10, v42, v43
    s_waitcnt vmcnt(2)
    v_max3_u32 v10, v10, v44, v45
    v_max3_u32 v10, v10, v46, v47
    s_waitcnt vmcnt(1)
    v_max3_u32 v10, v10, v48, v49
    v_max3_u32 v10, v10, v50, v51
    s_waitcnt vmcnt(0)
    v_max3_u32 v10, v10, v52, v53
    v_max3_u32 v10, v10, v54, v55
    s_add_u32 s59, s49, 4096
    buffer_load_dwordx4 v[36:39], v0, s[8:11], s49 offen offset:0 sc1
    buffer_load_dwordx4 v[40:43], v0, s[8:11], s49 offen offset:1024 sc1
    buffer_load_dwordx4 v[44:47], v0, s[8:11], s49 offen offset:2048 sc1
    buffer_load_dwordx4 v[48:51], v0, s[8:11], s49 offen offset:3072 sc1
    buffer_load_dwordx4 v[52:55], v0, s[8:11], s59 offen offset:0 sc1
    s_waitcnt vmcnt(4)
    v_max3_u32 v10, v10, v36, v37
    v_max3_u32 v10, v10, v38, v39
    s_waitcnt vmcnt(3)
    v_max3_u32 v10, v10, v40, v41
    v_max3_u32 v10, v10, v42, v43
    s_waitcnt vmcnt(2)
    v_max3_u32 v10, v10, v44, v45
    v_max3_u32 v10, v10, v46, v47
    s_waitcnt vmcnt(1)
    v_max3_u32 v10, v10, v48, v49
    v_max3_u32 v10, v10, v50, v51
    s_waitcnt vmcnt(0)
    v_max3_u32 v10, v10, v52, v53
    v_max3_u32 v10, v10, v54, v55
    v_cmp_eq_u32 vcc, -1, v10
    s_cbranch_vccz M_c1_3_restart
    s_add_u32 s30, s30, 1
    s_cmp_ge_u32 s30, 60000
    s_cbranch_scc1 M_fail
    s_branch M_c1_3_vfy
M_c1_3_exact:
    s_nop 7
    s_mov_b32 s70, 2
    s_waitcnt lgkmcnt(0)
    ds_read_b128 v[20:23], v3 offset:18432
    ds_read_b128 v[24:27], v3 offset:18496
    ds_read_b128 v[72:75], v3 offset:18560
    ds_read_b128 v[44:47], v3 offset:18624
    ds_read_b128 v[56:59], v0 offset:0
    s_waitcnt lgkmcnt(0)
    v_mfma_f32_16x16x32_bf16 v[28:31], v[56:59], v[20:23], 0
    s_nop 3
    ds_read_b128 v[60:63], v0 offset:1024
    s_waitcnt lgkmcnt(0)
    v_mfma_f32_16x16x32_bf16 v[28:31], v[60:63], v[24:27], v[28:31]
    s_nop 3
    ds_read_b128 v[56:59], v0 offset:2048
    s_waitcnt lgkmcnt(0)
    v_mfma_f32_16x16x32_bf16 v[28:31], v[56:59], v[72:75], v[28:31]
    s_nop 3
    ds_read_b128 v[60:63], v0 offset:3072
    s_waitcnt lgkmcnt(0)
    v_mfma_f32_16x16x32_bf16 v[28:31], v[60:63], v[44:47], v[28:31]
    s_nop 3
    ds_read_b128 v[56:59], v0 offset:4096
    s_waitcnt lgkmcnt(0)
    v_mfma_f32_16x16x32_bf16 v[32:35], v[56:59], v[20:23], 0
    s_nop 3
    ds_read_b128 v[60:63], v0 offset:5120
    s_waitcnt lgkmcnt(0)
    v_mfma_f32_16x16x32_bf16 v[32:35], v[60:63], v[24:27], v[32:35]
    s_nop 3
    ds_read_b128 v[56:59], v0 offset:6144
    s_waitcnt lgkmcnt(0)
    v_mfma_f32_16x16x32_bf16 v[32:35], v[56:59], v[72:75], v[32:35]
    s_nop 3
    ds_read_b128 v[60:63], v0 offset:7168
    s_waitcnt lgkmcnt(0)
    v_mfma_f32_16x16x32_bf16 v[32:35], v[60:63], v[44:47], v[32:35]
    s_nop 3
    ds_read_b128 v[56:59], v3 offset:20736
    s_waitcnt lgkmcnt(0)
    v_mfma_f32_16x16x32_bf16 v[40:43], v[56:59], v[20:23], 0
    s_nop 3
    ds_read_b128 v[60:63], v3 offset:20800
    s_waitcnt lgkmcnt(0)
    v_mfma_f32_16x16x32_bf16 v[40:43], v[60:63], v[24:27], v[40:43]
    s_nop 3
    ds_read_b128 v[56:59], v3 offset:20864
    s_waitcnt lgkmcnt(0)
    v_mfma_f32_16x16x32_bf16 v[40:43], v[56:59], v[72:75], v[40:43]
    s_nop 3
    ds_read_b128 v[60:63], v3 offset:20928
    s_waitcnt lgkmcnt(0)
    v_mfma_f32_16x16x32_bf16 v[40:43], v[60:63], v[44:47], v[40:43]
    s_nop 3
    v_max3_f32 v68, v28, v29, v30
    v_max3_f32 v68, v68, v31, v32
    v_max3_f32 v68, v68, v33, v34
    s_nop 0
    v_max3_f32 v68, v68, v35, v40
    v_max3_f32 v68, v68, v41, v42
    v_max_f32 v68, v68, v43
    v_mov_b32 v69, v68
    s_nop 1
    v_permlane16_swap_b32 v68, v69
    v_max_f32 v68, v68, v69
    v_mov_b32 v69, v68
    s_nop 1
    v_permlane32_swap_b32 v68, v69
    v_max_f32 v68, v68, v69
    v_sub_f32 v28, v28, v68
    v_exp_f32 v28, v28
    v_sub_f32 v29, v29, v68
    v_exp_f32 v29, v29
    v_sub_f32 v30, v30, v68
    v_exp_f32 v30, v30
    v_sub_f32 v31, v31, v68
    v_exp_f32 v31, v31
    v_sub_f32 v32, v32, v68
    v_exp_f32 v32, v32
    v_sub_f32 v33, v33, v68
    v_exp_f32 v33, v33
    v_sub_f32 v34, v34, v68
    v_exp_f32 v34, v34
    v_sub_f32 v35, v35, v68
    v_exp_f32 v35, v35
    v_sub_f32 v40, v40, v68
    v_exp_f32 v40, v40
    v_sub_f32 v41, v41, v68
    v_exp_f32 v41, v41
    v_sub_f32 v42, v42, v68
    v_exp_f32 v42, v42
    v_sub_f32 v43, v43, v68
    v_exp_f32 v43, v43
    v_cvt_pk_bf16_f32 v28, v28, v29
    v_cvt_pk_bf16_f32 v29, v30, v31
    v_cvt_pk_bf16_f32 v30, v32, v33
    v_cvt_pk_bf16_f32 v31, v34, v35
    v_cvt_pk_bf16_f32 v40, v40, v41
    v_cvt_pk_bf16_f32 v41, v42, v43
    v_mfma_f32_16x16x32_bf16 v[20:23], v[80:83], v[28:31], 0
    v_mfma_f32_16x16x32_bf16 v[24:27], v[84:87], v[28:31], 0
    v_mfma_f32_16x16x32_bf16 v[72:75], v[64:67], v[28:31], 0
    ds_read_b128 v[60:63], v3 offset:20928
    s_waitcnt lgkmcnt(0)
    s_nop 7
    v_mfma_f32_16x16x16_bf16 v[72:75], v[10:11], v[40:41], v[72:75]
    s_nop 7
    s_branch M_c1_3_fin
M_c1_3_last:
    s_cmp_lg_u32 s70, 0
    s_cbranch_scc1 M_c1_3_last2
    v_cmp_u_f32 vcc, v32, v32
    s_cbranch_vccnz M_c1_3_vfy0
M_c1_3_last2:
    s_lshl_b32 s4, s44, 18
    s_add_u32 s4, s4, s53
    buffer_store_dwordx4 v[76:79], v0, s[8:11], s4 offen offset:3072 sc1
    s_mov_b32 s4, 0x10000000
    s_waitcnt vmcnt(0) lgkmcnt(0)
    s_barrier
    s_nop 7
    v_mov_b64 v[72:73], -1
    v_mov_b64 v[74:75], -1
    s_add_u32 s28, s44, 3
    s_and_b32 s29, s28, 3
    s_mul_i32 s31, s22, 160
    s_waitcnt vmcnt(0)
    s_add_u32 s44, s44, 1
    s_cmp_eq_u32 s44, 128
    s_cbranch_scc1 M_end
    s_branch M_c1_3_layer
M_c1_3_lr:
    s_mov_b32 s30, 0
M_c1_3_lr_l:
    s_waitcnt lgkmcnt(0)
    s_and_b32 s27, s30, 1
    s_cbranch_scc0 M_c1_3_lr_n
    s_waitcnt vmcnt(2)
    s_mov_b32 m0, 13312
    s_nop 0
    buffer_load_dwordx4 v0, s[8:11], s48 offen offset:3072 sc1 lds
    s_mov_b32 m0, 17408
    s_add_u32 s59, s48, 4096
    buffer_load_dwordx4 v0, s[8:11], s59 offen offset:0 sc1 lds
M_c1_3_lr_n:
    ds_read_b128 v[36:39], v6 offset:13312
    ds_read_b128 v[40:43], v6 offset:14336
    ds_read_b128 v[44:47], v6 offset:15360
    ds_read_b128 v[48:51], v6 offset:16384
    ds_read_b128 v[52:55], v6 offset:17408
    s_waitcnt lgkmcnt(2)
    v_max3_u32 v10, v36, v40, v44
    s_waitcnt lgkmcnt(0)
    v_max3_u32 v10, v10, v48, v52
    v_cmp_eq_u32 vcc, -1, v10
    s_cbranch_vccz M_c1_3_lr_d
    s_add_u32 s30, s30, 1
    s_cmp_ge_u32 s30, 480000
    s_cbranch_scc1 M_fail
    s_branch M_c1_3_lr_l
M_c1_3_lr_d:
    ds_read_b128 v[56:59], v5 offset:0
    ds_read_b128 v[60:63], v5 offset:1024
    ds_read_b128 v[64:67], v5 offset:2048
    ds_read_b128 v[68:71], v5 offset:3072
    v_mov_b64 v[12:13], 0
    v_mov_b64 v[14:15], 0
    v_mov_b64 v[16:17], 0
    v_mov_b64 v[18:19], 0
    v_mov_b64 v[20:21], 0
    v_mov_b64 v[22:23], 0
    v_mov_b64 v[24:25], 0
    v_mov_b64 v[26:27], 0
    v_mov_b64 v[28:29], 0
    v_mov_b64 v[30:31], 0
    v_mov_b64 v[32:33], 0
    v_mov_b64 v[34:35], 0
    s_waitcnt lgkmcnt(0)
    s_branch M_c1_3_lr_r
M_c1_3_rr:
    s_mov_b32 s30, 0
M_c1_3_rr_l:
    s_waitcnt lgkmcnt(0)
    s_and_b32 s27, s30, 1
    s_cbranch_scc1 M_c1_3_rr_n
    s_waitcnt vmcnt(1)
    s_mov_b32 m0, 12288
    s_add_u32 s59, s49, 4096
    buffer_load_dwordx4 v0, s[8:11], s59 offen offset:0 sc1 lds
M_c1_3_rr_n:
    ds_read_b128 v[36:39], v6 offset:8192
    ds_read_b128 v[40:43], v6 offset:9216
    ds_read_b128 v[44:47], v6 offset:10240
    ds_read_b128 v[48:51], v6 offset:11264
    ds_read_b32 v11, v6 offset:12288
    s_waitcnt lgkmcnt(2)
    v_max3_u32 v10, v36, v40, v44
    s_waitcnt lgkmcnt(0)
    v_max3_u32 v10, v10, v48, v11
    v_cmp_eq_u32 vcc, -1, v10
    s_cbranch_vccz M_c1_3_rr_d
    s_add_u32 s30, s30, 1
    s_cmp_ge_u32 s30, 480000
    s_cbranch_scc1 M_fail
    s_branch M_c1_3_rr_l
M_c1_3_rr_d:
    s_branch M_c1_3_rr_r
M_c1_3_first:
    s_mul_i32 s27, s21, 167936
    s_add_u32 s27, s27, s34
    s_mul_i32 s28, s22, 4224
    s_add_u32 s28, s28, s27
    s_mov_b32 exec_hi, 0
    buffer_load_dword v10, v9, s[8:11], s28 offen sc1
    s_lshl_b32 s28, s22, 10
    s_add_u32 s28, s28, s27
    s_add_u32 s28, s28, 135168
    s_mov_b64 exec, 0xff
    buffer_load_dword v10, v9, s[8:11], s28 offen sc1
    s_mul_i32 s27, s21, 5120
    s_add_u32 s27, s27, s41
    s_mul_i32 s28, s22, 160
    s_add_u32 s28, s28, s27
    s_mov_b64 exec, 3
    buffer_load_dword v10, v9, s[8:11], s28 offen sc1
    s_mov_b64 exec, -1
    s_add_u32 s27, s44, 1
    s_or_b32 s28, s44, 63
    s_add_u32 s28, s28, 1
    s_min_u32 s27, s27, s28
    s_cmp_lt_u32 s54, s27
    s_cbranch_scc1 M_c1_3_p1
M_c1_3_p1_r:
    s_barrier
    s_and_b32 s26, s44, 63
    s_lshl_b32 s26, s26, 18
    s_add_u32 s26, s26, s50
    s_add_u32 s26, s26, 6144
    s_add_u32 s3, s26, 16777216
    s_mov_b32 m0, 6144
    s_nop 0
    buffer_load_dwordx4 v0, s[8:11], s26 offen offset:0 sc1 lds
    buffer_load_dwordx4 v0, s[8:11], s26 offen offset:1024 sc1 lds
    buffer_load_dwordx4 v[80:83], v0, s[8:11], s3 offen offset:0 sc1
    buffer_load_dwordx4 v[84:87], v0, s[8:11], s3 offen offset:1024 sc1
    s_and_b32 s26, s44, 63
    s_add_u32 s26, s26, 1
    s_min_u32 s26, s26, 63
    s_lshl_b32 s26, s26, 18
    s_add_u32 s26, s26, s50
    s_add_u32 s26, s26, 6144
    s_add_u32 s3, s26, 16777216
    s_waitcnt vmcnt(0) lgkmcnt(0)
    s_barrier
    s_branch M_c1_3_first_r
M_c1_3_first2:
    s_add_u32 s27, s44, 2
    s_or_b32 s28, s44, 63
    s_add_u32 s28, s28, 1
    s_min_u32 s27, s27, s28
    s_cmp_lt_u32 s54, s27
    s_cbranch_scc1 M_c1_3_p2
M_c1_3_p2_r:
    s_barrier
    s_branch M_c1_3_first2_r
M_c1_3_wkw:
    s_mov_b32 s30, 0
M_c1_3_wkw_l:
    s_waitcnt lgkmcnt(0)
    s_mov_b64 exec, 3
    buffer_load_dword v10, v9, s[8:11], s51 offen sc1
    s_waitcnt vmcnt(0)
    s_mov_b64 exec, -1
    v_readlane_b32 s54, v10, 0
    v_readlane_b32 s28, v10, 1
    s_nop 3
    s_min_u32 s54, s54, s28
    s_cmp_ge_u32 s54, s27
    s_cbranch_scc1 M_c1_3_wkw_r
    s_sleep 2
    s_add_u32 s30, s30, 1
    s_cmp_ge_u32 s30, 240000
    s_cbranch_scc1 M_fail
    s_branch M_c1_3_wkw_l
M_c1_3_p1:
    s_mov_b32 s30, 0
M_c1_3_p1_l:
    s_waitcnt lgkmcnt(0)
    s_mov_b64 exec, 3
    buffer_load_dword v10, v9, s[8:11], s51 offen sc1
    s_waitcnt vmcnt(0)
    s_mov_b64 exec, -1
    v_readlane_b32 s54, v10, 0
    v_readlane_b32 s28, v10, 1
    s_nop 3
    s_min_u32 s54, s54, s28
    s_cmp_ge_u32 s54, s27
    s_cbranch_scc1 M_c1_3_p1_r
    s_sleep 2
    s_add_u32 s30, s30, 1
    s_cmp_ge_u32 s30, 240000
    s_cbranch_scc1 M_fail
    s_branch M_c1_3_p1_l
M_c1_3_p2:
    s_mov_b32 s30, 0
M_c1_3_p2_l:
    s_waitcnt lgkmcnt(0)
    s_mov_b64 exec, 3
    buffer_load_dword v10, v9, s[8:11], s51 offen sc1
    s_waitcnt vmcnt(0)
    s_mov_b64 exec, -1
    v_readlane_b32 s54, v10, 0
    v_readlane_b32 s28, v10, 1
    s_nop 3
    s_min_u32 s54, s54, s28
    s_cmp_ge_u32 s54, s27
    s_cbranch_scc1 M_c1_3_p2_r
    s_sleep 2
    s_add_u32 s30, s30, 1
    s_cmp_ge_u32 s30, 240000
    s_cbranch_scc1 M_fail
    s_branch M_c1_3_p2_l
M_bulk:
    s_waitcnt vmcnt(0)
    s_barrier
    s_mul_i32 s42, s21, 10240
    s_mul_i32 s47, s101, 3145728
    s_add_u32 s47, s47, s42
    s_add_u32 s47, s47, 29360128
    s_mul_i32 s50, s101, 33554432
    s_lshl_b32 s27, s22, 13
    s_add_u32 s50, s50, s27
    s_add_u32 s50, s50, 37748736
    s_lshl_b32 s43, s101, 6
    s_sub_u32 s82, s20, 2
    s_mov_b32 s83, s21
    s_mov_b32 s84, s22
    s_mov_b32 s85, s23
    s_lshl_b32 s87, s82, 5
    s_add_u32 s87, s87, s22
    s_mul_i32 s86, s101, 8192
    s_mul_i32 s80, s101, 8388608
    s_add_u32 s80, s80, 134217728
    s_load_dwordx2 s[98:99], s[0:1], 80
    s_cmp_eq_u32 s87, 160
    s_cselect_b32 s81, 191, s87
    s_cmp_eq_u32 s87, 191
    s_cselect_b32 s81, 160, s81
    s_waitcnt lgkmcnt(0)
    s_mul_i32 s27, s22, 26
    s_lshr_b32 s27, s27, 8
    s_mul_i32 s28, s27, 10
    s_sub_u32 s88, s22, s28
    s_mul_i32 s28, s20, 3
    s_sub_u32 s28, s28, 8
    s_cmp_lt_u32 s20, 3
    s_cselect_b32 s28, 0, s28
    s_cselect_b32 s29, 1, 3
    s_add_u32 s28, s28, s27
    s_lshl_b32 s89, s28, 2
    s_add_u32 s89, s89, s21
    s_cmp_lt_u32 s27, s29
    s_cselect_b32 s89, s89, 64
    s_cmp_ge_u32 s20, 3
    s_cbranch_scc1 M_qao
    s_lshl_b32 s28, s21, 11
    s_add_u32 s52, s50, s28
    s_add_u32 s52, s52, 16777216
    s_lshl_b32 s28, s21, 10
    s_add_u32 s50, s50, s28
    s_lshl_b32 s51, s22, 8
    s_add_u32 s51, s51, 167854080
    v_lshlrev_b32 v3, 3, v0
    s_mov_b32 s44, 0
    s_mov_b32 s45, 0
    s_mul_i32 s53, s101, 76546048
    s_cmp_lg_u32 s101, 0
    s_cbranch_scc1 M_kv_l1
    s_cmp_lg_u32 s21, 0
    s_cbranch_scc1 M_kx_1
    v_lshlrev_b32 v190, 3, v0
    s_mov_b64 exec, 15
    s_mov_b32 s30, 0
    s_lshl_b32 s27, s101, 13
    s_add_u32 s27, s27, 167911424
M_kx_2:
    buffer_load_dwordx4 v[176:179], v190, s[8:11], s27 offen sc1
    buffer_load_dwordx4 v[180:183], v190, s[8:11], s27 offen offset:16 sc1
    buffer_load_dwordx2 v[184:185], v190, s[8:11], s27 offen offset:32 sc1
    s_add_u32 s30, s30, 1
    s_cmp_ge_u32 s30, 60000
    s_cbranch_scc1 M_fail
    s_waitcnt vmcnt(0)
    v_min3_u32 v176, v176, v177, v178
    v_min3_u32 v176, v176, v179, v180
    v_min3_u32 v176, v176, v181, v182
    v_min3_u32 v176, v176, v183, v184
    v_min_u32 v176, v176, v185
    v_cmp_eq_u32 vcc, 0, v176
    s_cbranch_vccz M_kx_2d
    s_sleep 4
    s_branch M_kx_2
M_kx_2d:
    s_mov_b64 exec, -1
M_kx_1:
    s_barrier
M_kx_3:
    s_branch M_kv_l2
M_kv_l1:
    s_mov_b32 s54, 167956480
    s_cmp_lg_u32 s21, 0
    s_cbranch_scc1 M_kl_4
    s_mov_b64 exec, 0x3ff
    s_mov_b32 s30, 0
    v_lshrrev_b32 v190, 2, v0
M_kl_5:
    buffer_load_dword v191, v190, s[8:11], s54 offen sc1
    s_add_u32 s30, s30, 1
    s_cmp_ge_u32 s30, 60000
    s_cbranch_scc1 M_fail
    s_waitcnt vmcnt(0)
    v_cmp_ne_u32 vcc, 0x01010101, v191
    s_cbranch_vccz M_kl_5d
    s_sleep 1
    s_branch M_kl_5
M_kl_5d:
    s_mov_b64 exec, -1
M_kl_4:
    s_barrier
M_kv_l2:
    s_min_u32 s27, s44, 63
    s_mul_i32 s27, s27, 40960
    s_add_u32 s27, s27, s47
    s_cmp_lt_u32 s44, 4
    s_cselect_b32 s28, s53, 0
    s_add_u32 s27, s27, s28
    s_add_u32 s28, s45, s42
    s_mov_b32 m0, s28
    s_nop 0
    buffer_load_dwordx4 v0, s[8:11], s27 offen offset:0 sc1 lds
    buffer_load_dwordx4 v0, s[8:11], s27 offen offset:1024 sc1 lds
    buffer_load_dwordx4 v0, s[8:11], s27 offen offset:2048 sc1 lds
    buffer_load_dwordx4 v0, s[8:11], s27 offen offset:3072 sc1 lds
    s_add_u32 s27, s27, 4096
    s_add_u32 s28, s28, 4096
    s_mov_b32 m0, s28
    s_nop 0
    buffer_load_dwordx4 v0, s[8:11], s27 offen offset:0 sc1 lds
    buffer_load_dwordx4 v0, s[8:11], s27 offen offset:1024 sc1 lds
    buffer_load_dwordx4 v0, s[8:11], s27 offen offset:2048 sc1 lds
    buffer_load_dwordx4 v0, s[8:11], s27 offen offset:3072 sc1 lds
    s_add_u32 s27, s27, 4096
    s_add_u32 s28, s28, 4096
    s_mov_b32 m0, s28
    s_nop 0
    buffer_load_dwordx4 v0, s[8:11], s27 offen offset:0 sc1 lds
    buffer_load_dwordx4 v0, s[8:11], s27 offen offset:1024 sc1 lds
    s_lshl_b32 s55, s89, 7
    s_lshl_b32 s27, s88, 2
    s_add_u32 s55, s55, s27
    s_add_u32 s55, s55, 167919616
    s_cmp_lt_u32 s89, 64
    s_cselect_b32 s27, s101, 0
    s_cmp_lg_u32 s27, 0
    s_cselect_b32 s55, s55, 0x10000000
    s_cbranch_scc1 M_kv_d1
    s_waitcnt vmcnt(0)
    s_barrier
    s_branch M_kv_d2
M_kv_d1:
    s_waitcnt vmcnt(0)
    s_barrier
    v_bfe_u32 v5, v0, 4, 4
    v_mul_u32_u24 v5, 1280, v5
    v_lshrrev_b32 v6, 8, v0
    v_lshl_add_u32 v5, v6, 4, v5
    buffer_store_dwordx4 v[12:15], v0, s[8:11], s68 offen offset:0 sc1
    buffer_store_dwordx4 v[104:107], v5, s[16:19], s70 offen offset:0 sc1
    buffer_store_dwordx4 v[16:19], v0, s[8:11], s68 offen offset:1024 sc1
    buffer_store_dwordx4 v[108:111], v5, s[16:19], s70 offen offset:64 sc1
    buffer_store_dwordx4 v[28:31], v0, s[8:11], s69 offen offset:0 sc1
    buffer_store_dwordx4 v[112:115], v5, s[16:19], s71 offen offset:0 sc1
    buffer_store_dwordx4 v[32:35], v0, s[8:11], s69 offen offset:1024 sc1
    buffer_store_dwordx4 v[116:119], v5, s[16:19], s71 offen offset:64 sc1
M_kv_d2:
    v_mov_b32 v6, 1
    v_mov_b32 v1, v0
    ds_read_b128 v[56:59], v1 offset:0
    ds_read_b128 v[60:63], v1 offset:1024
    ds_read_b128 v[64:67], v1 offset:2048
    ds_read_b128 v[68:71], v1 offset:3072
M_kv_top:
    s_add_u32 s27, s44, s43
    v_mov_b32 v2, s27
    s_sub_u32 s45, 40960, s45
    s_add_u32 s44, s44, 1
    v_add_u32 v4, s45, v0
    ds_read_b128 v[72:75], v1 offset:4096
    s_waitcnt lgkmcnt(4)
    v_mfma_f32_16x16x32_bf16 v[8:11], a[0:3], v[56:59], 0
    v_mfma_f32_16x16x32_bf16 v[24:27], v[56:59], a[160:163], 0
    v_mfma_f32_16x16x32_bf16 v[12:15], a[80:83], v[56:59], 0
    v_mfma_f32_16x16x32_bf16 v[28:31], v[56:59], a[240:243], 0
    ds_read_b128 v[56:59], v1 offset:5120
    s_waitcnt lgkmcnt(4)
    v_mfma_f32_16x16x32_bf16 v[8:11], a[4:7], v[60:63], v[8:11]
    v_mfma_f32_16x16x32_bf16 v[24:27], v[60:63], a[164:167], v[24:27]
    v_mfma_f32_16x16x32_bf16 v[12:15], a[84:87], v[60:63], v[12:15]
    v_mfma_f32_16x16x32_bf16 v[28:31], v[60:63], a[244:247], v[28:31]
    s_min_u32 s27, s44, 63
    s_mul_i32 s27, s27, 40960
    s_add_u32 s27, s27, s47
    s_cmp_lt_u32 s44, 4
    s_cselect_b32 s28, s53, 0
    s_add_u32 s27, s27, s28
    s_add_u32 s28, s45, s42
    s_mov_b32 m0, s28
    s_nop 0
    buffer_load_dwordx4 v0, s[8:11], s27 offen offset:0 sc1 lds
    buffer_load_dwordx4 v0, s[8:11], s27 offen offset:1024 sc1 lds
    ds_read_b128 v[60:63], v1 offset:6144
    s_waitcnt lgkmcnt(4)
    v_mfma_f32_16x16x32_bf16 v[8:11], a[8:11], v[64:67], v[8:11]
    v_mfma_f32_16x16x32_bf16 v[24:27], v[64:67], a[168:171], v[24:27]
    v_mfma_f32_16x16x32_bf16 v[12:15], a[88:91], v[64:67], v[12:15]
    v_mfma_f32_16x16x32_bf16 v[28:31], v[64:67], a[248:251], v[28:31]
    ds_read_b128 v[64:67], v1 offset:7168
    s_waitcnt lgkmcnt(4)
    v_mfma_f32_16x16x32_bf16 v[8:11], a[12:15], v[68:71], v[8:11]
    v_mfma_f32_16x16x32_bf16 v[24:27], v[68:71], a[172:175], v[24:27]
    v_mfma_f32_16x16x32_bf16 v[12:15], a[92:95], v[68:71], v[12:15]
    v_mfma_f32_16x16x32_bf16 v[28:31], v[68:71], a[252:255], v[28:31]
    ds_read_b128 v[68:71], v1 offset:8192
    s_waitcnt lgkmcnt(4)
    v_mfma_f32_16x16x32_bf16 v[8:11], a[16:19], v[72:75], v[8:11]
    v_mfma_f32_16x16x32_bf16 v[24:27], v[72:75], a[176:179], v[24:27]
    v_mfma_f32_16x16x32_bf16 v[12:15], a[96:99], v[72:75], v[12:15]
    v_mfma_f32_16x16x32_bf16 v[28:31], v[72:75], v[192:195], v[28:31]
    ds_read_b128 v[72:75], v1 offset:9216
    s_waitcnt lgkmcnt(4)
    v_mfma_f32_16x16x32_bf16 v[8:11], a[20:23], v[56:59], v[8:11]
    v_mfma_f32_16x16x32_bf16 v[24:27], v[56:59], a[180:183], v[24:27]
    v_mfma_f32_16x16x32_bf16 v[12:15], a[100:103], v[56:59], v[12:15]
    v_mfma_f32_16x16x32_bf16 v[28:31], v[56:59], v[196:199], v[28:31]
    buffer_load_dwordx4 v0, s[8:11], s27 offen offset:2048 sc1 lds
    buffer_load_dwordx4 v0, s[8:11], s27 offen offset:3072 sc1 lds
    ds_read_b128 v[56:59], v1 offset:10240
    s_waitcnt lgkmcnt(4)
    v_mfma_f32_16x16x32_bf16 v[8:11], a[24:27], v[60:63], v[8:11]
    v_mfma_f32_16x16x32_bf16 v[24:27], v[60:63], a[184:187], v[24:27]
    v_mfma_f32_16x16x32_bf16 v[12:15], a[104:107], v[60:63], v[12:15]
    v_mfma_f32_16x16x32_bf16 v[28:31], v[60:63], v[200:203], v[28:31]
    ds_read_b128 v[60:63], v1 offset:11264
    s_waitcnt lgkmcnt(4)
    v_mfma_f32_16x16x32_bf16 v[8:11], a[28:31], v[64:67], v[8:11]
    v_mfma_f32_16x16x32_bf16 v[24:27], v[64:67], a[188:191], v[24:27]
    v_mfma_f32_16x16x32_bf16 v[12:15], a[108:111], v[64:67], v[12:15]
    v_mfma_f32_16x16x32_bf16 v[28:31], v[64:67], v[204:207], v[28:31]
    ds_read_b128 v[64:67], v1 offset:12288
    s_waitcnt lgkmcnt(4)
    v_mfma_f32_16x16x32_bf16 v[8:11], a[32:35], v[68:71], v[8:11]
    v_mfma_f32_16x16x32_bf16 v[24:27], v[68:71], a[192:195], v[24:27]
    v_mfma_f32_16x16x32_bf16 v[12:15], a[112:115], v[68:71], v[12:15]
    v_mfma_f32_16x16x32_bf16 v[28:31], v[68:71], v[208:211], v[28:31]
    ds_read_b128 v[68:71], v1 offset:13312
    s_waitcnt lgkmcnt(4)
    v_mfma_f32_16x16x32_bf16 v[8:11], a[36:39], v[72:75], v[8:11]
    v_mfma_f32_16x16x32_bf16 v[24:27], v[72:75], a[196:199], v[24:27]
    v_mfma_f32_16x16x32_bf16 v[12:15], a[116:119], v[72:75], v[12:15]
    v_mfma_f32_16x16x32_bf16 v[28:31], v[72:75], v[212:215], v[28:31]
    s_waitcnt vmcnt(4)
    s_barrier
    s_cmp_lg_u32 s21, 0
    s_cbranch_scc1 M_kv_f0
    s_mov_b64 exec, 3
    buffer_store_dword v2, v3, s[8:11], s51 offen sc1
    s_mov_b64 exec, -1
M_kv_f0:
    s_mov_b64 exec, 1
    buffer_store_dword v6, v0, s[8:11], s55 offen sc1
    s_mov_b64 exec, -1
    s_mov_b32 s55, 0x10000000
    s_add_u32 s27, s27, 4096
    s_add_u32 s28, s28, 4096
    s_mov_b32 m0, s28
    s_nop 0
    buffer_load_dwordx4 v0, s[8:11], s27 offen offset:0 sc1 lds
    buffer_load_dwordx4 v0, s[8:11], s27 offen offset:1024 sc1 lds
    ds_read_b128 v[72:75], v1 offset:14336
    s_waitcnt lgkmcnt(4)
    v_mfma_f32_16x16x32_bf16 v[8:11], a[40:43], v[56:59], v[8:11]
    v_mfma_f32_16x16x32_bf16 v[24:27], v[56:59], a[200:203], v[24:27]
    v_mfma_f32_16x16x32_bf16 v[12:15], a[120:123], v[56:59], v[12:15]
    v_mfma_f32_16x16x32_bf16 v[28:31], v[56:59], v[216:219], v[28:31]
    ds_read_b128 v[56:59], v1 offset:15360
    s_waitcnt lgkmcnt(4)
    v_mfma_f32_16x16x32_bf16 v[8:11], a[44:47], v[60:63], v[8:11]
    v_mfma_f32_16x16x32_bf16 v[24:27], v[60:63], a[204:207], v[24:27]
    v_mfma_f32_16x16x32_bf16 v[12:15], a[124:127], v[60:63], v[12:15]
    v_mfma_f32_16x16x32_bf16 v[28:31], v[60:63], v[220:223], v[28:31]
    ds_read_b128 v[60:63], v1 offset:16384
    s_waitcnt lgkmcnt(4)
    v_mfma_f32_16x16x32_bf16 v[8:11], a[48:51], v[64:67], v[8:11]
    v_mfma_f32_16x16x32_bf16 v[24:27], v[64:67], a[208:211], v[24:27]
    v_mfma_f32_16x16x32_bf16 v[12:15], a[128:131], v[64:67], v[12:15]
    v_mfma_f32_16x16x32_bf16 v[28:31], v[64:67], v[224:227], v[28:31]
    ds_read_b128 v[64:67], v1 offset:17408
    s_waitcnt lgkmcnt(4)
    v_mfma_f32_16x16x32_bf16 v[8:11], a[52:55], v[68:71], v[8:11]
    v_mfma_f32_16x16x32_bf16 v[24:27], v[68:71], a[212:215], v[24:27]
    v_mfma_f32_16x16x32_bf16 v[12:15], a[132:135], v[68:71], v[12:15]
    v_mfma_f32_16x16x32_bf16 v[28:31], v[68:71], v[228:231], v[28:31]
    buffer_load_dwordx4 v0, s[8:11], s27 offen offset:2048 sc1 lds
    buffer_load_dwordx4 v0, s[8:11], s27 offen offset:3072 sc1 lds
    ds_read_b128 v[68:71], v1 offset:18432
    s_waitcnt lgkmcnt(4)
    v_mfma_f32_16x16x32_bf16 v[8:11], a[56:59], v[72:75], v[8:11]
    v_mfma_f32_16x16x32_bf16 v[24:27], v[72:75], a[216:219], v[24:27]
    v_mfma_f32_16x16x32_bf16 v[12:15], a[136:139], v[72:75], v[12:15]
    v_mfma_f32_16x16x32_bf16 v[28:31], v[72:75], v[232:235], v[28:31]
    ds_read_b128 v[72:75], v1 offset:19456
    s_waitcnt lgkmcnt(4)
    v_mfma_f32_16x16x32_bf16 v[8:11], a[60:63], v[56:59], v[8:11]
    v_mfma_f32_16x16x32_bf16 v[24:27], v[56:59], a[220:223], v[24:27]
    v_mfma_f32_16x16x32_bf16 v[12:15], a[140:143], v[56:59], v[12:15]
    v_mfma_f32_16x16x32_bf16 v[28:31], v[56:59], v[236:239], v[28:31]
    ds_read_b128 v[56:59], v1 offset:20480
    s_waitcnt lgkmcnt(4)
    v_mfma_f32_16x16x32_bf16 v[8:11], a[64:67], v[60:63], v[8:11]
    v_mfma_f32_16x16x32_bf16 v[24:27], v[60:63], a[224:227], v[24:27]
    v_mfma_f32_16x16x32_bf16 v[12:15], a[144:147], v[60:63], v[12:15]
    v_mfma_f32_16x16x32_bf16 v[28:31], v[60:63], v[240:243], v[28:31]
    ds_read_b128 v[60:63], v1 offset:21504
    s_waitcnt lgkmcnt(4)
    v_mfma_f32_16x16x32_bf16 v[8:11], a[68:71], v[64:67], v[8:11]
    v_mfma_f32_16x16x32_bf16 v[24:27], v[64:67], a[228:231], v[24:27]
    v_mfma_f32_16x16x32_bf16 v[12:15], a[148:151], v[64:67], v[12:15]
    v_mfma_f32_16x16x32_bf16 v[28:31], v[64:67], v[244:247], v[28:31]
    s_add_u32 s27, s27, 4096
    s_add_u32 s28, s28, 4096
    s_mov_b32 m0, s28
    s_nop 0
    buffer_load_dwordx4 v0, s[8:11], s27 offen offset:0 sc1 lds
    buffer_load_dwordx4 v0, s[8:11], s27 offen offset:1024 sc1 lds
    ds_read_b128 v[64:67], v1 offset:22528
    s_waitcnt lgkmcnt(4)
    v_mfma_f32_16x16x32_bf16 v[8:11], a[72:75], v[68:71], v[8:11]
    v_mfma_f32_16x16x32_bf16 v[24:27], v[68:71], a[232:235], v[24:27]
    v_mfma_f32_16x16x32_bf16 v[12:15], a[152:155], v[68:71], v[12:15]
    v_mfma_f32_16x16x32_bf16 v[28:31], v[68:71], v[248:251], v[28:31]
    ds_read_b128 v[68:71], v1 offset:23552
    s_waitcnt lgkmcnt(4)
    v_mfma_f32_16x16x32_bf16 v[8:11], a[76:79], v[72:75], v[8:11]
    v_mfma_f32_16x16x32_bf16 v[24:27], v[72:75], a[236:239], v[24:27]
    v_mfma_f32_16x16x32_bf16 v[12:15], a[156:159], v[72:75], v[12:15]
    v_mfma_f32_16x16x32_bf16 v[28:31], v[72:75], v[252:255], v[28:31]
    ds_read_b128 v[72:75], v1 offset:24576
    s_waitcnt lgkmcnt(4)
    v_mfma_f32_16x16x32_bf16 v[16:19], a[0:3], v[56:59], 0
    v_mfma_f32_16x16x32_bf16 v[32:35], v[56:59], a[160:163], 0
    v_mfma_f32_16x16x32_bf16 v[20:23], a[80:83], v[56:59], 0
    v_mfma_f32_16x16x32_bf16 v[36:39], v[56:59], a[240:243], 0
    ds_read_b128 v[56:59], v1 offset:25600
    s_waitcnt lgkmcnt(4)
    v_mfma_f32_16x16x32_bf16 v[16:19], a[4:7], v[60:63], v[16:19]
    v_mfma_f32_16x16x32_bf16 v[32:35], v[60:63], a[164:167], v[32:35]
    v_mfma_f32_16x16x32_bf16 v[20:23], a[84:87], v[60:63], v[20:23]
    v_mfma_f32_16x16x32_bf16 v[36:39], v[60:63], a[244:247], v[36:39]
    ds_read_b128 v[60:63], v1 offset:26624
    s_waitcnt lgkmcnt(4)
    v_mfma_f32_16x16x32_bf16 v[16:19], a[8:11], v[64:67], v[16:19]
    v_cvt_pk_bf16_f32 v40, v8, v12
    v_mfma_f32_16x16x32_bf16 v[32:35], v[64:67], a[168:171], v[32:35]
    v_mfma_f32_16x16x32_bf16 v[20:23], a[88:91], v[64:67], v[20:23]
    v_cvt_pk_bf16_f32 v41, v9, v13
    v_mfma_f32_16x16x32_bf16 v[36:39], v[64:67], a[248:251], v[36:39]
    ds_read_b128 v[64:67], v1 offset:27648
    s_waitcnt lgkmcnt(4)
    v_mfma_f32_16x16x32_bf16 v[16:19], a[12:15], v[68:71], v[16:19]
    v_cvt_pk_bf16_f32 v42, v10, v14
    v_mfma_f32_16x16x32_bf16 v[32:35], v[68:71], a[172:175], v[32:35]
    v_mfma_f32_16x16x32_bf16 v[20:23], a[92:95], v[68:71], v[20:23]
    v_cvt_pk_bf16_f32 v43, v11, v15
    v_mfma_f32_16x16x32_bf16 v[36:39], v[68:71], a[252:255], v[36:39]
    ds_read_b128 v[68:71], v1 offset:28672
    s_waitcnt lgkmcnt(4)
    v_mfma_f32_16x16x32_bf16 v[16:19], a[16:19], v[72:75], v[16:19]
    v_cvt_pk_bf16_f32 v48, v24, v25
    v_mfma_f32_16x16x32_bf16 v[32:35], v[72:75], a[176:179], v[32:35]
    v_mfma_f32_16x16x32_bf16 v[20:23], a[96:99], v[72:75], v[20:23]
    v_cvt_pk_bf16_f32 v49, v26, v27
    v_mfma_f32_16x16x32_bf16 v[36:39], v[72:75], v[192:195], v[36:39]
    ds_read_b128 v[72:75], v1 offset:29696
    s_waitcnt lgkmcnt(4)
    v_mfma_f32_16x16x32_bf16 v[16:19], a[20:23], v[56:59], v[16:19]
    v_cvt_pk_bf16_f32 v52, v28, v29
    v_mfma_f32_16x16x32_bf16 v[32:35], v[56:59], a[180:183], v[32:35]
    v_mfma_f32_16x16x32_bf16 v[20:23], a[100:103], v[56:59], v[20:23]
    v_cvt_pk_bf16_f32 v53, v30, v31
    v_mfma_f32_16x16x32_bf16 v[36:39], v[56:59], v[196:199], v[36:39]
    ds_read_b128 v[56:59], v1 offset:30720
    s_waitcnt lgkmcnt(4)
    v_mfma_f32_16x16x32_bf16 v[16:19], a[24:27], v[60:63], v[16:19]
    v_mfma_f32_16x16x32_bf16 v[32:35], v[60:63], a[184:187], v[32:35]
    v_mfma_f32_16x16x32_bf16 v[20:23], a[104:107], v[60:63], v[20:23]
    v_mfma_f32_16x16x32_bf16 v[36:39], v[60:63], v[200:203], v[36:39]
    ds_read_b128 v[60:63], v1 offset:31744
    s_waitcnt lgkmcnt(4)
    v_mfma_f32_16x16x32_bf16 v[16:19], a[28:31], v[64:67], v[16:19]
    v_mfma_f32_16x16x32_bf16 v[32:35], v[64:67], a[188:191], v[32:35]
    v_mfma_f32_16x16x32_bf16 v[20:23], a[108:111], v[64:67], v[20:23]
    v_mfma_f32_16x16x32_bf16 v[36:39], v[64:67], v[204:207], v[36:39]
    ds_read_b128 v[64:67], v1 offset:32768
    s_waitcnt lgkmcnt(4)
    v_mfma_f32_16x16x32_bf16 v[16:19], a[32:35], v[68:71], v[16:19]
    v_mfma_f32_16x16x32_bf16 v[32:35], v[68:71], a[192:195], v[32:35]
    v_mfma_f32_16x16x32_bf16 v[20:23], a[112:115], v[68:71], v[20:23]
    v_mfma_f32_16x16x32_bf16 v[36:39], v[68:71], v[208:211], v[36:39]
    ds_read_b128 v[68:71], v1 offset:33792
    s_waitcnt lgkmcnt(4)
    v_mfma_f32_16x16x32_bf16 v[16:19], a[36:39], v[72:75], v[16:19]
    v_mfma_f32_16x16x32_bf16 v[32:35], v[72:75], a[196:199], v[32:35]
    v_mfma_f32_16x16x32_bf16 v[20:23], a[116:119], v[72:75], v[20:23]
    v_mfma_f32_16x16x32_bf16 v[36:39], v[72:75], v[212:215], v[36:39]
    ds_read_b128 v[72:75], v1 offset:34816
    s_waitcnt lgkmcnt(4)
    v_mfma_f32_16x16x32_bf16 v[16:19], a[40:43], v[56:59], v[16:19]
    v_mfma_f32_16x16x32_bf16 v[32:35], v[56:59], a[200:203], v[32:35]
    v_mfma_f32_16x16x32_bf16 v[20:23], a[120:123], v[56:59], v[20:23]
    v_mfma_f32_16x16x32_bf16 v[36:39], v[56:59], v[216:219], v[36:39]
    ds_read_b128 v[56:59], v1 offset:35840
    s_waitcnt lgkmcnt(4)
    v_mfma_f32_16x16x32_bf16 v[16:19], a[44:47], v[60:63], v[16:19]
    v_mfma_f32_16x16x32_bf16 v[32:35], v[60:63], a[204:207], v[32:35]
    v_mfma_f32_16x16x32_bf16 v[20:23], a[124:127], v[60:63], v[20:23]
    v_mfma_f32_16x16x32_bf16 v[36:39], v[60:63], v[220:223], v[36:39]
    ds_read_b128 v[60:63], v1 offset:36864
    s_waitcnt lgkmcnt(4)
    v_mfma_f32_16x16x32_bf16 v[16:19], a[48:51], v[64:67], v[16:19]
    v_mfma_f32_16x16x32_bf16 v[32:35], v[64:67], a[208:211], v[32:35]
    v_mfma_f32_16x16x32_bf16 v[20:23], a[128:131], v[64:67], v[20:23]
    v_mfma_f32_16x16x32_bf16 v[36:39], v[64:67], v[224:227], v[36:39]
    ds_read_b128 v[64:67], v1 offset:37888
    s_waitcnt lgkmcnt(4)
    v_mfma_f32_16x16x32_bf16 v[16:19], a[52:55], v[68:71], v[16:19]
    v_mfma_f32_16x16x32_bf16 v[32:35], v[68:71], a[212:215], v[32:35]
    v_mfma_f32_16x16x32_bf16 v[20:23], a[132:135], v[68:71], v[20:23]
    v_mfma_f32_16x16x32_bf16 v[36:39], v[68:71], v[228:231], v[36:39]
    ds_read_b128 v[68:71], v1 offset:38912
    s_waitcnt lgkmcnt(4)
    v_mfma_f32_16x16x32_bf16 v[16:19], a[56:59], v[72:75], v[16:19]
    v_mfma_f32_16x16x32_bf16 v[32:35], v[72:75], a[216:219], v[32:35]
    v_mfma_f32_16x16x32_bf16 v[20:23], a[136:139], v[72:75], v[20:23]
    v_mfma_f32_16x16x32_bf16 v[36:39], v[72:75], v[232:235], v[36:39]
    ds_read_b128 v[72:75], v1 offset:39936
    s_waitcnt lgkmcnt(4)
    v_mfma_f32_16x16x32_bf16 v[16:19], a[60:63], v[56:59], v[16:19]
    v_mfma_f32_16x16x32_bf16 v[32:35], v[56:59], a[220:223], v[32:35]
    v_mfma_f32_16x16x32_bf16 v[20:23], a[140:143], v[56:59], v[20:23]
    v_mfma_f32_16x16x32_bf16 v[36:39], v[56:59], v[236:239], v[36:39]
    s_waitcnt vmcnt(0)
    s_barrier
    ds_read_b128 v[56:59], v4 offset:0
    s_waitcnt lgkmcnt(4)
    v_mfma_f32_16x16x32_bf16 v[16:19], a[64:67], v[60:63], v[16:19]
    v_mfma_f32_16x16x32_bf16 v[32:35], v[60:63], a[224:227], v[32:35]
    v_mfma_f32_16x16x32_bf16 v[20:23], a[144:147], v[60:63], v[20:23]
    v_mfma_f32_16x16x32_bf16 v[36:39], v[60:63], v[240:243], v[36:39]
    ds_read_b128 v[60:63], v4 offset:1024
    s_waitcnt lgkmcnt(4)
    v_mfma_f32_16x16x32_bf16 v[16:19], a[68:71], v[64:67], v[16:19]
    v_mfma_f32_16x16x32_bf16 v[32:35], v[64:67], a[228:231], v[32:35]
    v_mfma_f32_16x16x32_bf16 v[20:23], a[148:151], v[64:67], v[20:23]
    v_mfma_f32_16x16x32_bf16 v[36:39], v[64:67], v[244:247], v[36:39]
    ds_read_b128 v[64:67], v4 offset:2048
    s_waitcnt lgkmcnt(4)
    v_mfma_f32_16x16x32_bf16 v[16:19], a[72:75], v[68:71], v[16:19]
    v_mfma_f32_16x16x32_bf16 v[32:35], v[68:71], a[232:235], v[32:35]
    v_mfma_f32_16x16x32_bf16 v[20:23], a[152:155], v[68:71], v[20:23]
    v_mfma_f32_16x16x32_bf16 v[36:39], v[68:71], v[248:251], v[36:39]
    ds_read_b128 v[68:71], v4 offset:3072
    s_waitcnt lgkmcnt(4)
    v_mfma_f32_16x16x32_bf16 v[16:19], a[76:79], v[72:75], v[16:19]
    v_mfma_f32_16x16x32_bf16 v[32:35], v[72:75], a[236:239], v[32:35]
    v_mfma_f32_16x16x32_bf16 v[20:23], a[156:159], v[72:75], v[20:23]
    v_mfma_f32_16x16x32_bf16 v[36:39], v[72:75], v[252:255], v[36:39]
    s_add_u32 s27, s50, 4096
    v_mov_b32 v1, v4
    buffer_store_dwordx4 v[40:43], v0, s[8:11], s50 offen sc1
    s_nop 3
    v_cvt_pk_bf16_f32 v44, v16, v20
    v_cvt_pk_bf16_f32 v45, v17, v21
    v_cvt_pk_bf16_f32 v46, v18, v22
    v_cvt_pk_bf16_f32 v47, v19, v23
    v_cvt_pk_bf16_f32 v50, v32, v33
    v_cvt_pk_bf16_f32 v51, v34, v35
    v_cvt_pk_bf16_f32 v54, v36, v37
    v_cvt_pk_bf16_f32 v55, v38, v39
    buffer_store_dwordx4 v[44:47], v0, s[8:11], s27 offen sc1
    buffer_store_dwordx4 v[48:51], v0, s[8:11], s52 offen offset:0 sc1
    buffer_store_dwordx4 v[52:55], v0, s[8:11], s52 offen offset:1024 sc1
    s_add_u32 s50, s50, 262144
    s_add_u32 s52, s52, 262144
    s_barrier
    s_cmp_lg_u32 s44, 3
    s_cbranch_scc1 M_kv_np
    s_cmp_lg_u32 s21, 0
    s_cbranch_scc1 M_kx_6
    v_lshlrev_b32 v190, 3, v0
    s_mov_b64 exec, -1
    s_mov_b32 s30, 0
    s_lshl_b32 s27, s101, 13
    s_add_u32 s27, s27, 167911424
M_kx_7:
    buffer_load_dwordx4 v[176:179], v190, s[8:11], s27 offen sc1
    buffer_load_dwordx4 v[180:183], v190, s[8:11], s27 offen offset:16 sc1
    buffer_load_dwordx2 v[184:185], v190, s[8:11], s27 offen offset:32 sc1
    s_add_u32 s30, s30, 1
    s_cmp_ge_u32 s30, 60000
    s_cbranch_scc1 M_fail
    s_waitcnt vmcnt(0)
    v_min3_u32 v176, v176, v177, v178
    v_min3_u32 v176, v176, v179, v180
    v_min3_u32 v176, v176, v181, v182
    v_min3_u32 v176, v176, v183, v184
    v_min_u32 v176, v176, v185
    v_cmp_eq_u32 vcc, 0, v176
    s_cbranch_vccz M_kx_7d
    s_sleep 4
    s_branch M_kx_7
M_kx_7d:
    s_mov_b64 exec, -1
M_kx_6:
    s_barrier
M_kx_8:
M_kv_np:
    s_cmp_lt_u32 s44, 64
    s_cbranch_scc1 M_kv_top
    s_add_u32 s27, s44, s43
    v_mov_b32 v2, s27
    s_waitcnt vmcnt(0) lgkmcnt(0)
    s_barrier
    s_cmp_lg_u32 s21, 0
    s_cbranch_scc1 M_kv_f2
    s_mov_b64 exec, 3
    buffer_store_dword v2, v3, s[8:11], s51 offen sc1
    s_mov_b64 exec, -1
M_kv_f2:
    s_branch M_bphase
M_qao:
    s_cmp_lg_u32 s101, 0
    s_cbranch_scc1 M_q_ft
    v_lshrrev_b32 v1, 4, v0
    v_lshrrev_b32 v3, 8, v0
    v_and_b32 v4, 15, v1
    v_mov_b32 v5, v0
    s_min_u32 s36, s22, 19
    s_mul_i32 s36, s36, 40
    s_mul_i32 s27, s21, 10
    s_add_u32 s36, s36, s27
    s_add_u32 s35, s36, 10
    s_add_u32 s27, s42, 122880
    v_add_u32 v2, s27, v0
M_q_ftl:
    s_mul_hi_u32 s37, s36, 0xccccccd
    s_mul_i32 s38, s37, 20
    s_sub_u32 s38, s36, s38
    s_lshl_b32 s37, s37, 4
    s_lshl_b32 s38, s38, 5
    v_lshlrev_b32 v7, 3, v3
    v_add_u32 v7, s38, v7
    s_mov_b32 s39, 0x666667
    s_movk_i32 s40, 640
    v_add_u32 v6, s37, v4
    v_cmp_lt_u32 vcc, 320, v6
    v_subrev_u32 v8, 320, v6
    s_nop 1
    v_cndmask_b32 v8, v6, v8, vcc
    v_mov_b32 v9, 0
    v_mov_b32 v10, 0x3e800000
    v_cndmask_b32 v9, v9, v10, vcc
    v_add_u32 v11, 0, v7
    v_mul_u32_u24 v11, v11, v8
    v_mul_hi_u32 v12, v11, s39
    v_mul_lo_u32 v12, v12, s40
    v_sub_u32 v11, v11, v12
    v_cvt_f32_u32 v11, v11
    v_mov_b32 v12, v9
    v_fmac_f32 v12, 0x3acccccd, v11
    v_cos_f32 v16, v12
    v_add_u32 v11, 1, v7
    v_mul_u32_u24 v11, v11, v8
    v_mul_hi_u32 v12, v11, s39
    v_mul_lo_u32 v12, v12, s40
    v_sub_u32 v11, v11, v12
    v_cvt_f32_u32 v11, v11
    v_mov_b32 v12, v9
    v_fmac_f32 v12, 0x3acccccd, v11
    v_cos_f32 v17, v12
    v_add_u32 v11, 2, v7
    v_mul_u32_u24 v11, v11, v8
    v_mul_hi_u32 v12, v11, s39
    v_mul_lo_u32 v12, v12, s40
    v_sub_u32 v11, v11, v12
    v_cvt_f32_u32 v11, v11
    v_mov_b32 v12, v9
    v_fmac_f32 v12, 0x3acccccd, v11
    v_cos_f32 v18, v12
    v_add_u32 v11, 3, v7
    v_mul_u32_u24 v11, v11, v8
    v_mul_hi_u32 v12, v11, s39
    v_mul_lo_u32 v12, v12, s40
    v_sub_u32 v11, v11, v12
    v_cvt_f32_u32 v11, v11
    v_mov_b32 v12, v9
    v_fmac_f32 v12, 0x3acccccd, v11
    v_cos_f32 v19, v12
    v_add_u32 v11, 4, v7
    v_mul_u32_u24 v11, v11, v8
    v_mul_hi_u32 v12, v11, s39
    v_mul_lo_u32 v12, v12, s40
    v_sub_u32 v11, v11, v12
    v_cvt_f32_u32 v11, v11
    v_mov_b32 v12, v9
    v_fmac_f32 v12, 0x3acccccd, v11
    v_cos_f32 v20, v12
    v_add_u32 v11, 5, v7
    v_mul_u32_u24 v11, v11, v8
    v_mul_hi_u32 v12, v11, s39
    v_mul_lo_u32 v12, v12, s40
    v_sub_u32 v11, v11, v12
    v_cvt_f32_u32 v11, v11
    v_mov_b32 v12, v9
    v_fmac_f32 v12, 0x3acccccd, v11
    v_cos_f32 v21, v12
    v_add_u32 v11, 6, v7
    v_mul_u32_u24 v11, v11, v8
    v_mul_hi_u32 v12, v11, s39
    v_mul_lo_u32 v12, v12, s40
    v_sub_u32 v11, v11, v12
    v_cvt_f32_u32 v11, v11
    v_mov_b32 v12, v9
    v_fmac_f32 v12, 0x3acccccd, v11
    v_cos_f32 v22, v12
    v_add_u32 v11, 7, v7
    v_mul_u32_u24 v11, v11, v8
    v_mul_hi_u32 v12, v11, s39
    v_mul_lo_u32 v12, v12, s40
    v_sub_u32 v11, v11, v12
    v_cvt_f32_u32 v11, v11
    v_mov_b32 v12, v9
    v_fmac_f32 v12, 0x3acccccd, v11
    v_cos_f32 v23, v12
    s_nop 0
    v_cvt_pk_f16_f32 v24, v16, v17
    v_cvt_pk_f16_f32 v25, v18, v19
    v_cvt_pk_f16_f32 v26, v20, v21
    v_cvt_pk_f16_f32 v27, v22, v23
    ds_write_b128 v2, v[24:27]
    v_add_u32 v2, 1024, v2
    s_add_u32 s36, s36, 1
    s_cmp_lt_u32 s36, s35
    s_cbranch_scc1 M_q_ftl
    s_waitcnt lgkmcnt(0)
M_q_ft:
    v_lshrrev_b32 v1, 8, v0
    v_bfe_u32 v2, v0, 4, 4
    v_add_u32 v3, 81920, v0
    v_add_u32 v14, 122880, v0
    s_mul_i32 s28, s21, 320
    v_mul_u32_u24 v10, 40960, v2
    v_lshl_add_u32 v10, v1, 4, v10
    s_mul_i32 s27, s22, 1280
    s_add_u32 s29, s27, s28
    v_add_u32 v4, s29, v10
    v_mul_u32_u24 v10, 1280, v1
    s_mul_i32 s27, s22, 40960
    s_add_u32 s27, s27, s28
    v_add_u32 v10, s27, v10
    v_lshl_add_u32 v5, v2, 4, v10
    v_lshrrev_b32 v11, 2, v2
    v_mul_u32_u24 v15, 5120, v11
    v_add_u32 v10, v10, v15
    v_and_b32 v15, 0x30, v0
    v_add_u32 v6, v10, v15
    v_and_b32 v10, 1, v1
    v_lshlrev_b32 v10, 3, v10
    v_add_u32 v8, s29, v10
    v_lshl_add_u32 v7, v2, 4, v8
    v_add_u32 v8, v8, v15
    v_lshl_add_u32 v10, v11, 10, v10
    v_lshl_add_u32 v10, v15, 4, v10
    s_mul_i32 s27, s21, 5120
    s_and_b32 s28, s22, 15
    s_lshl_b32 s28, s28, 4
    s_add_u32 s27, s27, s28
    s_lshr_b32 s28, s22, 4
    s_mul_i32 s28, s28, 20480
    s_add_u32 s27, s27, s28
    v_add_u32 v12, s27, v10
    v_lshlrev_b32 v10, 13, v2
    v_lshl_add_u32 v10, v1, 4, v10
    s_lshl_b32 s27, s22, 18
    s_lshl_b32 s28, s21, 6
    s_add_u32 s27, s27, s28
    v_add_u32 v13, s27, v10
    s_and_b32 s58, s21, 1
    s_lshr_b32 s59, s21, 1
    v_lshlrev_b32 v10, 2, v1
    v_sub_u32 v10, v2, v10
    s_lshl_b32 s27, s58, 4
    v_add_u32 v9, s27, v10
    v_and_b32 v10, 16, v0
    s_movk_i32 s27, 0x3f80
    v_lshlrev_b32_e64 v10, v10, s27
    v_bfe_u32 v11, v0, 5, 2
    v_cmp_eq_u32 vcc, 0, v11
    s_nop 1
    v_cndmask_b32 v16, 0, v10, vcc
    v_cmp_eq_u32 vcc, 1, v11
    s_nop 1
    v_cndmask_b32 v17, 0, v10, vcc
    v_cmp_eq_u32 vcc, 2, v11
    s_nop 1
    v_cndmask_b32 v18, 0, v10, vcc
    v_cmp_eq_u32 vcc, 3, v11
    s_nop 1
    v_cndmask_b32 v19, 0, v10, vcc
    s_mov_b32 s40, 0x3e0293ee
    s_mov_b32 s41, s40
    s_sub_u32 s44, s20, 4
    s_min_u32 s44, s44, 4
    s_mov_b32 s45, 0
    s_load_dwordx2 s[72:73], s[0:1], 64
    s_load_dwordx2 s[76:77], s[0:1], 72
    s_mul_i32 s94, s44, 12
    s_add_u32 s94, s94, s22
    s_sub_u32 s94, s94, 20
    s_lshl_b32 s95, s94, 7
    s_add_u32 s95, s95, 167948288
    s_lshl_b32 s94, s94, 2
    s_add_u32 s94, s94, s21
    s_cmp_lg_u32 s101, 0
    s_cselect_b32 s94, 5000, s94
    s_waitcnt lgkmcnt(0)
    s_and_b32 s73, s73, 0xffff
    s_mov_b32 s74, 1314816
    s_mov_b32 s75, 0x00020000
    s_and_b32 s77, s77, 0xffff
    s_mov_b32 s78, 1314816
    s_mov_b32 s79, 0x00020000
    s_mul_i32 s48, s44, 2621440
    s_add_u32 s48, s48, 117440512
    s_mov_b32 s49, 0
    s_lshl_b32 s51, s44, 12
    s_lshl_b32 s27, s101, 11
    s_add_u32 s51, s51, s27
    s_add_u32 s51, s51, 167870464
    s_lshl_b32 s52, s22, 7
    s_lshl_b32 s27, s101, 12
    s_add_u32 s52, s52, s27
    s_add_u32 s52, s52, 167862272
    s_lshl_b32 s53, s22, 13
    s_add_u32 s53, s53, 218103808
    s_mul_i32 s54, s101, 8388608
    s_add_u32 s54, s54, 134217728
    s_lshl_b32 s60, s22, 8
    s_add_u32 s60, s60, 167854080
    s_mul_i32 s63, s44, 65536
    s_add_u32 s63, s63, 104857600
    s_add_u32 s64, s63, 4096
    s_cmp_lg_u32 s21, 0
    s_cbranch_scc1 M_qx_9
    v_lshlrev_b32 v190, 3, v0
    s_mov_b64 exec, -1
    s_mov_b32 s30, 0
    s_lshl_b32 s27, s101, 13
    s_add_u32 s27, s27, 167911424
M_qx_10:
    buffer_load_dwordx4 v[176:179], v190, s[8:11], s27 offen sc1
    buffer_load_dwordx4 v[180:183], v190, s[8:11], s27 offen offset:16 sc1
    buffer_load_dwordx2 v[184:185], v190, s[8:11], s27 offen offset:32 sc1
    s_add_u32 s30, s30, 1
    s_cmp_ge_u32 s30, 60000
    s_cbranch_scc1 M_fail
    s_waitcnt vmcnt(0)
    v_min3_u32 v176, v176, v177, v178
    v_min3_u32 v176, v176, v179, v180
    v_min3_u32 v176, v176, v181, v182
    v_min3_u32 v176, v176, v183, v184
    v_min_u32 v176, v176, v185
    v_cmp_eq_u32 vcc, 0, v176
    s_cbranch_vccz M_qx_10d
    s_sleep 32
    s_branch M_qx_10
M_qx_10d:
    s_mov_b64 exec, -1
M_qx_9:
    s_barrier
M_qx_11:
    s_min_u32 s27, s44, 63
    s_mul_i32 s27, s27, 40960
    s_add_u32 s27, s27, s47
    s_add_u32 s28, 0, s42
    s_mov_b32 m0, s28
    s_nop 0
    buffer_load_dwordx4 v0, s[8:11], s27 offen offset:0 sc1 lds
    buffer_load_dwordx4 v0, s[8:11], s27 offen offset:1024 sc1 lds
    buffer_load_dwordx4 v0, s[8:11], s27 offen offset:2048 sc1 lds
    buffer_load_dwordx4 v0, s[8:11], s27 offen offset:3072 sc1 lds
    s_add_u32 s27, s27, 4096
    s_add_u32 s28, s28, 4096
    s_mov_b32 m0, s28
    s_nop 0
    buffer_load_dwordx4 v0, s[8:11], s27 offen offset:0 sc1 lds
    buffer_load_dwordx4 v0, s[8:11], s27 offen offset:1024 sc1 lds
    buffer_load_dwordx4 v0, s[8:11], s27 offen offset:2048 sc1 lds
    buffer_load_dwordx4 v0, s[8:11], s27 offen offset:3072 sc1 lds
    s_add_u32 s27, s27, 4096
    s_add_u32 s28, s28, 4096
    s_mov_b32 m0, s28
    s_nop 0
    buffer_load_dwordx4 v0, s[8:11], s27 offen offset:0 sc1 lds
    buffer_load_dwordx4 v0, s[8:11], s27 offen offset:1024 sc1 lds
    s_add_u32 s46, s44, 5
    s_min_u32 s27, s46, 63
    s_mul_i32 s27, s27, 40960
    s_add_u32 s27, s27, s47
    s_add_u32 s28, 40960, s42
    s_mov_b32 m0, s28
    s_nop 0
    buffer_load_dwordx4 v0, s[8:11], s27 offen offset:0 sc1 lds
    buffer_load_dwordx4 v0, s[8:11], s27 offen offset:1024 sc1 lds
    buffer_load_dwordx4 v0, s[8:11], s27 offen offset:2048 sc1 lds
    buffer_load_dwordx4 v0, s[8:11], s27 offen offset:3072 sc1 lds
    s_add_u32 s27, s27, 4096
    s_add_u32 s28, s28, 4096
    s_mov_b32 m0, s28
    s_nop 0
    buffer_load_dwordx4 v0, s[8:11], s27 offen offset:0 sc1 lds
    buffer_load_dwordx4 v0, s[8:11], s27 offen offset:1024 sc1 lds
    buffer_load_dwordx4 v0, s[8:11], s27 offen offset:2048 sc1 lds
    buffer_load_dwordx4 v0, s[8:11], s27 offen offset:3072 sc1 lds
    s_add_u32 s27, s27, 4096
    s_add_u32 s28, s28, 4096
    s_mov_b32 m0, s28
    s_nop 0
    buffer_load_dwordx4 v0, s[8:11], s27 offen offset:0 sc1 lds
    buffer_load_dwordx4 v0, s[8:11], s27 offen offset:1024 sc1 lds
    s_waitcnt vmcnt(0)
    s_barrier
    s_mov_b32 s65, 0
    s_mov_b32 s66, s44
    s_mov_b32 s62, 0x10000000
    s_mov_b32 s67, 0x10000000
    s_mov_b32 s68, 0x10000000
M_q_front:
    s_add_u32 s56, s66, s43
    s_mov_b32 s30, 0
M_q_kf:
    s_cmp_gt_u32 s65, s56
    s_cbranch_scc1 M_q_kg
    v_lshlrev_b32 v10, 3, v0
    s_mov_b64 exec, 3
    buffer_load_dword v15, v10, s[8:11], s60 offen sc1
    s_mov_b64 exec, -1
    s_waitcnt vmcnt(0)
    v_readlane_b32 s65, v15, 0
    v_readlane_b32 s27, v15, 1
    s_nop 3
    s_min_u32 s65, s65, s27
    s_sleep 1
    s_add_u32 s30, s30, 1
    s_cmp_lt_u32 s30, 60000
    s_cbranch_scc1 M_q_kf
    s_branch M_fail
M_q_kg:
    s_nop 1
    s_lshl_b32 s27, s66, 18
    s_add_u32 s27, s27, s50
    s_add_u32 s28, s27, 4096
    buffer_load_dwordx4 v[72:75], v0, s[8:11], s27 offen offset:0 sc1
    buffer_load_dwordx4 v[76:79], v0, s[8:11], s27 offen offset:1024 sc1
    buffer_load_dwordx4 v[80:83], v0, s[8:11], s27 offen offset:2048 sc1
    buffer_load_dwordx4 v[84:87], v0, s[8:11], s27 offen offset:3072 sc1
    buffer_load_dwordx4 v[88:91], v0, s[8:11], s28 offen offset:0 sc1
    buffer_load_dwordx4 v[92:95], v0, s[8:11], s28 offen offset:1024 sc1
    buffer_load_dwordx4 v[96:99], v0, s[8:11], s28 offen offset:2048 sc1
    buffer_load_dwordx4 v[100:103], v0, s[8:11], s28 offen offset:3072 sc1
    s_lshl_b32 s28, s59, 12
    s_add_u32 s27, s27, s28
    s_add_u32 s27, s27, 16777216
    buffer_load_dwordx4 v[104:107], v0, s[8:11], s27 offen offset:0 sc1
    buffer_load_dwordx4 v[108:111], v0, s[8:11], s27 offen offset:1024 sc1
    buffer_load_dwordx4 v[112:115], v0, s[8:11], s27 offen offset:2048 sc1
    buffer_load_dwordx4 v[116:119], v0, s[8:11], s27 offen offset:3072 sc1
    s_mul_i32 s27, s66, 40960
    buffer_load_dwordx2 v[184:185], v7, s[16:19], s27 offen sc1
    buffer_load_dwordx2 v[186:187], v8, s[16:19], s27 offen offset:256 sc1
    v_lshlrev_b32 v10, 3, v0
    s_mov_b64 exec, 3
    buffer_load_dword v15, v10, s[8:11], s60 offen sc1
    s_mov_b64 exec, -1
    v_add_u32 v11, s45, v0
    s_sub_u32 s45, 40960, s45
    ds_read_b128 v[40:43], v11 offset:0
    ds_read_b128 v[44:47], v11 offset:1024
    ds_read_b128 v[48:51], v11 offset:2048
    ds_read_b128 v[52:55], v11 offset:3072
    ds_read_b128 v[56:59], v11 offset:4096
    ds_read_b128 v[60:63], v11 offset:5120
    s_waitcnt lgkmcnt(5)
    v_mfma_f32_16x16x32_bf16 v[24:27], a[0:3], v[40:43], 0
    v_mfma_f32_16x16x32_bf16 v[28:31], a[80:83], v[40:43], 0
    ds_read_b128 v[40:43], v11 offset:6144
    s_waitcnt lgkmcnt(5)
    v_mfma_f32_16x16x32_bf16 v[24:27], a[4:7], v[44:47], v[24:27]
    v_mfma_f32_16x16x32_bf16 v[28:31], a[84:87], v[44:47], v[28:31]
    ds_read_b128 v[44:47], v11 offset:7168
    s_waitcnt lgkmcnt(5)
    v_mfma_f32_16x16x32_bf16 v[24:27], a[8:11], v[48:51], v[24:27]
    v_mfma_f32_16x16x32_bf16 v[28:31], a[88:91], v[48:51], v[28:31]
    ds_read_b128 v[48:51], v11 offset:8192
    s_waitcnt lgkmcnt(5)
    v_mfma_f32_16x16x32_bf16 v[24:27], a[12:15], v[52:55], v[24:27]
    v_mfma_f32_16x16x32_bf16 v[28:31], a[92:95], v[52:55], v[28:31]
    ds_read_b128 v[52:55], v11 offset:9216
    s_waitcnt lgkmcnt(5)
    v_mfma_f32_16x16x32_bf16 v[24:27], a[16:19], v[56:59], v[24:27]
    v_mfma_f32_16x16x32_bf16 v[28:31], a[96:99], v[56:59], v[28:31]
    ds_read_b128 v[56:59], v11 offset:10240
    s_waitcnt lgkmcnt(5)
    v_mfma_f32_16x16x32_bf16 v[24:27], a[20:23], v[60:63], v[24:27]
    v_mfma_f32_16x16x32_bf16 v[28:31], a[100:103], v[60:63], v[28:31]
    ds_read_b128 v[60:63], v11 offset:11264
    s_waitcnt lgkmcnt(5)
    v_mfma_f32_16x16x32_bf16 v[24:27], a[24:27], v[40:43], v[24:27]
    v_mfma_f32_16x16x32_bf16 v[28:31], a[104:107], v[40:43], v[28:31]
    ds_read_b128 v[40:43], v11 offset:12288
    s_waitcnt lgkmcnt(5)
    v_mfma_f32_16x16x32_bf16 v[24:27], a[28:31], v[44:47], v[24:27]
    v_mfma_f32_16x16x32_bf16 v[28:31], a[108:111], v[44:47], v[28:31]
    ds_read_b128 v[44:47], v11 offset:13312
    s_waitcnt lgkmcnt(5)
    v_mfma_f32_16x16x32_bf16 v[24:27], a[32:35], v[48:51], v[24:27]
    v_mfma_f32_16x16x32_bf16 v[28:31], a[112:115], v[48:51], v[28:31]
    ds_read_b128 v[48:51], v11 offset:14336
    s_waitcnt lgkmcnt(5)
    v_mfma_f32_16x16x32_bf16 v[24:27], a[36:39], v[52:55], v[24:27]
    v_mfma_f32_16x16x32_bf16 v[28:31], a[116:119], v[52:55], v[28:31]
    ds_read_b128 v[52:55], v11 offset:15360
    s_waitcnt lgkmcnt(5)
    v_mfma_f32_16x16x32_bf16 v[24:27], a[40:43], v[56:59], v[24:27]
    v_mfma_f32_16x16x32_bf16 v[28:31], a[120:123], v[56:59], v[28:31]
    ds_read_b128 v[56:59], v11 offset:16384
    s_waitcnt lgkmcnt(5)
    v_mfma_f32_16x16x32_bf16 v[24:27], a[44:47], v[60:63], v[24:27]
    v_mfma_f32_16x16x32_bf16 v[28:31], a[124:127], v[60:63], v[28:31]
    ds_read_b128 v[60:63], v11 offset:17408
    s_waitcnt lgkmcnt(5)
    v_mfma_f32_16x16x32_bf16 v[24:27], a[48:51], v[40:43], v[24:27]
    v_mfma_f32_16x16x32_bf16 v[28:31], a[128:131], v[40:43], v[28:31]
    ds_read_b128 v[40:43], v11 offset:18432
    s_waitcnt lgkmcnt(5)
    v_mfma_f32_16x16x32_bf16 v[24:27], a[52:55], v[44:47], v[24:27]
    v_mfma_f32_16x16x32_bf16 v[28:31], a[132:135], v[44:47], v[28:31]
    ds_read_b128 v[44:47], v11 offset:19456
    s_waitcnt lgkmcnt(5)
    v_mfma_f32_16x16x32_bf16 v[24:27], a[56:59], v[48:51], v[24:27]
    v_mfma_f32_16x16x32_bf16 v[28:31], a[136:139], v[48:51], v[28:31]
    ds_read_b128 v[48:51], v11 offset:20480
    s_waitcnt lgkmcnt(5)
    v_mfma_f32_16x16x32_bf16 v[24:27], a[60:63], v[52:55], v[24:27]
    v_mfma_f32_16x16x32_bf16 v[28:31], a[140:143], v[52:55], v[28:31]
    ds_read_b128 v[52:55], v11 offset:21504
    s_waitcnt lgkmcnt(5)
    v_mfma_f32_16x16x32_bf16 v[24:27], a[64:67], v[56:59], v[24:27]
    v_mfma_f32_16x16x32_bf16 v[28:31], a[144:147], v[56:59], v[28:31]
    ds_read_b128 v[56:59], v11 offset:22528
    s_waitcnt lgkmcnt(5)
    v_mfma_f32_16x16x32_bf16 v[24:27], a[68:71], v[60:63], v[24:27]
    v_mfma_f32_16x16x32_bf16 v[28:31], a[148:151], v[60:63], v[28:31]
    ds_read_b128 v[60:63], v11 offset:23552
    s_waitcnt lgkmcnt(5)
    v_mfma_f32_16x16x32_bf16 v[24:27], a[72:75], v[40:43], v[24:27]
    v_mfma_f32_16x16x32_bf16 v[28:31], a[152:155], v[40:43], v[28:31]
    ds_read_b128 v[40:43], v11 offset:24576
    s_waitcnt lgkmcnt(5)
    v_mfma_f32_16x16x32_bf16 v[24:27], a[76:79], v[44:47], v[24:27]
    v_mfma_f32_16x16x32_bf16 v[28:31], a[156:159], v[44:47], v[28:31]
    ds_read_b128 v[44:47], v11 offset:25600
    s_waitcnt lgkmcnt(5)
    v_mfma_f32_16x16x32_bf16 v[32:35], a[0:3], v[48:51], 0
    v_mfma_f32_16x16x32_bf16 v[36:39], a[80:83], v[48:51], 0
    ds_read_b128 v[48:51], v11 offset:26624
    s_waitcnt lgkmcnt(5)
    v_mfma_f32_16x16x32_bf16 v[32:35], a[4:7], v[52:55], v[32:35]
    v_mfma_f32_16x16x32_bf16 v[36:39], a[84:87], v[52:55], v[36:39]
    ds_read_b128 v[52:55], v11 offset:27648
    s_waitcnt lgkmcnt(5)
    v_mfma_f32_16x16x32_bf16 v[32:35], a[8:11], v[56:59], v[32:35]
    v_mfma_f32_16x16x32_bf16 v[36:39], a[88:91], v[56:59], v[36:39]
    ds_read_b128 v[56:59], v11 offset:28672
    s_waitcnt lgkmcnt(5)
    v_mfma_f32_16x16x32_bf16 v[32:35], a[12:15], v[60:63], v[32:35]
    v_mfma_f32_16x16x32_bf16 v[36:39], a[92:95], v[60:63], v[36:39]
    ds_read_b128 v[60:63], v11 offset:29696
    s_waitcnt lgkmcnt(5)
    v_mfma_f32_16x16x32_bf16 v[32:35], a[16:19], v[40:43], v[32:35]
    v_mfma_f32_16x16x32_bf16 v[36:39], a[96:99], v[40:43], v[36:39]
    ds_read_b128 v[40:43], v11 offset:30720
    s_waitcnt lgkmcnt(5)
    v_mfma_f32_16x16x32_bf16 v[32:35], a[20:23], v[44:47], v[32:35]
    v_mfma_f32_16x16x32_bf16 v[36:39], a[100:103], v[44:47], v[36:39]
    ds_read_b128 v[44:47], v11 offset:31744
    s_waitcnt lgkmcnt(5)
    v_mfma_f32_16x16x32_bf16 v[32:35], a[24:27], v[48:51], v[32:35]
    v_mfma_f32_16x16x32_bf16 v[36:39], a[104:107], v[48:51], v[36:39]
    ds_read_b128 v[48:51], v11 offset:32768
    s_waitcnt lgkmcnt(5)
    v_mfma_f32_16x16x32_bf16 v[32:35], a[28:31], v[52:55], v[32:35]
    v_mfma_f32_16x16x32_bf16 v[36:39], a[108:111], v[52:55], v[36:39]
    ds_read_b128 v[52:55], v11 offset:33792
    s_waitcnt lgkmcnt(5)
    v_mfma_f32_16x16x32_bf16 v[32:35], a[32:35], v[56:59], v[32:35]
    v_mfma_f32_16x16x32_bf16 v[36:39], a[112:115], v[56:59], v[36:39]
    ds_read_b128 v[56:59], v11 offset:34816
    s_waitcnt lgkmcnt(5)
    v_mfma_f32_16x16x32_bf16 v[32:35], a[36:39], v[60:63], v[32:35]
    v_mfma_f32_16x16x32_bf16 v[36:39], a[116:119], v[60:63], v[36:39]
    ds_read_b128 v[60:63], v11 offset:35840
    s_waitcnt lgkmcnt(5)
    v_mfma_f32_16x16x32_bf16 v[32:35], a[40:43], v[40:43], v[32:35]
    v_mfma_f32_16x16x32_bf16 v[36:39], a[120:123], v[40:43], v[36:39]
    ds_read_b128 v[40:43], v11 offset:36864
    s_waitcnt lgkmcnt(5)
    v_mfma_f32_16x16x32_bf16 v[32:35], a[44:47], v[44:47], v[32:35]
    v_mfma_f32_16x16x32_bf16 v[36:39], a[124:127], v[44:47], v[36:39]
    ds_read_b128 v[44:47], v11 offset:37888
    s_waitcnt lgkmcnt(5)
    v_mfma_f32_16x16x32_bf16 v[32:35], a[48:51], v[48:51], v[32:35]
    v_mfma_f32_16x16x32_bf16 v[36:39], a[128:131], v[48:51], v[36:39]
    ds_read_b128 v[48:51], v11 offset:38912
    s_waitcnt lgkmcnt(5)
    v_mfma_f32_16x16x32_bf16 v[32:35], a[52:55], v[52:55], v[32:35]
    v_mfma_f32_16x16x32_bf16 v[36:39], a[132:135], v[52:55], v[36:39]
    ds_read_b128 v[52:55], v11 offset:39936
    s_waitcnt lgkmcnt(5)
    v_mfma_f32_16x16x32_bf16 v[32:35], a[56:59], v[56:59], v[32:35]
    v_mfma_f32_16x16x32_bf16 v[36:39], a[136:139], v[56:59], v[36:39]
    s_waitcnt lgkmcnt(4)
    v_mfma_f32_16x16x32_bf16 v[32:35], a[60:63], v[60:63], v[32:35]
    v_mfma_f32_16x16x32_bf16 v[36:39], a[140:143], v[60:63], v[36:39]
    s_waitcnt lgkmcnt(3)
    v_mfma_f32_16x16x32_bf16 v[32:35], a[64:67], v[40:43], v[32:35]
    v_mfma_f32_16x16x32_bf16 v[36:39], a[144:147], v[40:43], v[36:39]
    s_waitcnt lgkmcnt(2)
    v_mfma_f32_16x16x32_bf16 v[32:35], a[68:71], v[44:47], v[32:35]
    v_mfma_f32_16x16x32_bf16 v[36:39], a[148:151], v[44:47], v[36:39]
    s_waitcnt lgkmcnt(1)
    v_mfma_f32_16x16x32_bf16 v[32:35], a[72:75], v[48:51], v[32:35]
    v_mfma_f32_16x16x32_bf16 v[36:39], a[152:155], v[48:51], v[36:39]
    s_waitcnt lgkmcnt(0)
    v_mfma_f32_16x16x32_bf16 v[32:35], a[76:79], v[52:55], v[32:35]
    v_mfma_f32_16x16x32_bf16 v[36:39], a[156:159], v[52:55], v[36:39]
    v_pk_mul_f32 v[24:25], v[24:25], s[40:41]
    v_pk_mul_f32 v[26:27], v[26:27], s[40:41]
    v_pk_mul_f32 v[28:29], v[28:29], s[40:41]
    v_pk_mul_f32 v[30:31], v[30:31], s[40:41]
    s_nop 2
    v_pk_mul_f32 v[32:33], v[32:33], s[40:41]
    v_pk_mul_f32 v[34:35], v[34:35], s[40:41]
    v_pk_mul_f32 v[36:37], v[36:37], s[40:41]
    v_pk_mul_f32 v[38:39], v[38:39], s[40:41]
    s_lshl_b32 s27, s21, 10
    v_add_u32 v10, s27, v3
    v_cvt_pk_bf16_f32 v40, v24, v28
    v_cvt_pk_bf16_f32 v41, v25, v29
    v_cvt_pk_bf16_f32 v42, v26, v30
    v_cvt_pk_bf16_f32 v43, v27, v31
    ds_write_b128 v10, v[40:43] offset:0
    v_cvt_pk_bf16_f32 v44, v32, v36
    v_cvt_pk_bf16_f32 v45, v33, v37
    v_cvt_pk_bf16_f32 v46, v34, v38
    v_cvt_pk_bf16_f32 v47, v35, v39
    ds_write_b128 v10, v[44:47] offset:4096
    s_lshl_b32 s27, s58, 12
    v_add_u32 v10, s27, v3
    s_waitcnt vmcnt(15) lgkmcnt(0)
    s_barrier
    ds_read_b128 v[160:163], v10 offset:0
    ds_read_b128 v[164:167], v10 offset:1024
    ds_read_b128 v[168:171], v10 offset:2048
    ds_read_b128 v[172:175], v10 offset:3072
    s_waitcnt vmcnt(0)
    s_cmp_lg_u32 s21, 0
    s_cbranch_scc1 M_q_fa
    s_mov_b64 exec, 1
    v_mov_b32 v10, s22
    v_mov_b32 v11, 1
    s_cmp_lg_u32 s23, 0
    s_cbranch_scc1 M_ls_12
    buffer_store_byte v11, v10, s[8:11], s62 offen
M_ls_12_r:
    s_mov_b64 exec, -1
M_q_fa:
    v_mov_b32 v11, 0xf149f2ca
    v_cmp_gt_i32 vcc, 0, v9
    s_nop 1
    v_cndmask_b32 v120, 0, v11, vcc
    v_cmp_gt_i32 vcc, 1, v9
    s_nop 1
    v_cndmask_b32 v121, 0, v11, vcc
    v_cmp_gt_i32 vcc, 2, v9
    s_nop 1
    v_cndmask_b32 v122, 0, v11, vcc
    v_cmp_gt_i32 vcc, 3, v9
    s_nop 1
    v_cndmask_b32 v123, 0, v11, vcc
    v_cmp_gt_i32 vcc, 16, v9
    s_nop 1
    v_cndmask_b32 v124, 0, v11, vcc
    v_cmp_gt_i32 vcc, 17, v9
    s_nop 1
    v_cndmask_b32 v125, 0, v11, vcc
    v_cmp_gt_i32 vcc, 18, v9
    s_nop 1
    v_cndmask_b32 v126, 0, v11, vcc
    v_cmp_gt_i32 vcc, 19, v9
    s_nop 1
    v_cndmask_b32 v127, 0, v11, vcc
    s_waitcnt lgkmcnt(3)
    v_mfma_f32_16x16x32_bf16 v[120:123], v[72:75], v[160:163], v[120:123]
    v_mfma_f32_16x16x32_bf16 v[124:127], v[88:91], v[160:163], v[124:127]
    s_waitcnt lgkmcnt(2)
    v_mfma_f32_16x16x32_bf16 v[120:123], v[76:79], v[164:167], v[120:123]
    v_mfma_f32_16x16x32_bf16 v[124:127], v[92:95], v[164:167], v[124:127]
    s_waitcnt lgkmcnt(1)
    v_mfma_f32_16x16x32_bf16 v[120:123], v[80:83], v[168:171], v[120:123]
    v_mfma_f32_16x16x32_bf16 v[124:127], v[96:99], v[168:171], v[124:127]
    s_waitcnt lgkmcnt(0)
    v_mfma_f32_16x16x32_bf16 v[120:123], v[84:87], v[172:175], v[120:123]
    v_mfma_f32_16x16x32_bf16 v[124:127], v[100:103], v[172:175], v[124:127]
    v_readlane_b32 s65, v15, 0
    v_readlane_b32 s27, v15, 1
    s_nop 3
    s_min_u32 s65, s65, s27
    v_max3_f32 v176, v120, v121, v122
    v_max3_f32 v176, v176, v123, v124
    v_max3_f32 v176, v176, v125, v126
    v_max_f32 v176, v176, v127
    v_mov_b32 v178, v176
    s_nop 1
    v_permlane16_swap_b32 v176, v178
    v_max_f32 v176, v176, v178
    v_mov_b32 v178, v176
    s_nop 1
    v_permlane32_swap_b32 v176, v178
    v_max_f32 v176, v176, v178
    v_sub_f32 v120, v120, v176
    v_sub_f32 v121, v121, v176
    v_sub_f32 v122, v122, v176
    v_sub_f32 v123, v123, v176
    v_sub_f32 v124, v124, v176
    v_sub_f32 v125, v125, v176
    v_sub_f32 v126, v126, v176
    v_sub_f32 v127, v127, v176
    v_exp_f32 v120, v120
    v_exp_f32 v121, v121
    v_exp_f32 v122, v122
    v_exp_f32 v123, v123
    v_exp_f32 v124, v124
    v_exp_f32 v125, v125
    v_exp_f32 v126, v126
    v_exp_f32 v127, v127
    v_cvt_pk_bf16_f32 v128, v120, v121
    v_cvt_pk_bf16_f32 v129, v122, v123
    v_cvt_pk_bf16_f32 v130, v124, v125
    v_cvt_pk_bf16_f32 v131, v126, v127
    v_add_f32 v177, v120, v121
    v_add_f32 v177, v177, v122
    v_add_f32 v177, v177, v123
    v_add_f32 v177, v177, v124
    v_add_f32 v177, v177, v125
    v_add_f32 v177, v177, v126
    v_add_f32 v177, v177, v127
    v_mfma_f32_16x16x32_bf16 v[144:147], v[104:107], v[128:131], 0
    v_mfma_f32_16x16x32_bf16 v[148:151], v[108:111], v[128:131], 0
    v_mfma_f32_16x16x32_bf16 v[152:155], v[112:115], v[128:131], 0
    v_mfma_f32_16x16x32_bf16 v[156:159], v[116:119], v[128:131], 0
    v_mov_b32 v178, v177
    s_nop 1
    v_permlane16_swap_b32 v177, v178
    v_add_f32 v177, v177, v178
    v_mov_b32 v178, v177
    s_nop 1
    v_permlane32_swap_b32 v177, v178
    v_add_f32 v177, v177, v178
    s_cmp_lg_u32 s66, s44
    s_cbranch_scc1 M_q_back2
M_q_top:
    s_add_u32 s56, s44, s43
    s_lshl_b32 s57, s44, 7
    s_mul_i32 s55, s44, 40960
    s_lshl_b32 s26, s56, 18
    s_add_u32 s26, s26, s53
    s_lshl_b32 s28, s59, 11
    s_add_u32 s29, s26, s28
    s_add_u32 s29, s29, 4096
    s_lshl_b32 s27, s58, 12
    s_add_u32 s27, s27, s28
    v_add_u32 v10, s27, v3
    s_cmp_lg_u32 s21, 0
    s_cbranch_scc1 M_cf_13
    s_mov_b64 exec, 0x3
    s_mov_b32 s30, 0
    v_lshrrev_b32 v190, 2, v0
M_cf_14:
    buffer_load_dword v191, v190, s[8:11], s52 offen sc1
    s_add_u32 s30, s30, 1
    s_cmp_ge_u32 s30, 60000
    s_cbranch_scc1 M_fail
    s_waitcnt vmcnt(0)
    v_cmp_ge_u32 vcc, s57, v191
    s_cbranch_vccz M_cf_14d
    s_sleep 1
    s_branch M_cf_14
M_cf_14d:
    s_mov_b64 exec, -1
M_cf_13:
    s_barrier
    buffer_load_dwordx4 v[24:27], v0, s[8:11], s26 offen offset:0 sc1
    buffer_load_dwordx4 v[28:31], v0, s[8:11], s26 offen offset:1024 sc1
    buffer_load_dwordx4 v[32:35], v0, s[8:11], s26 offen offset:2048 sc1
    buffer_load_dwordx4 v[36:39], v0, s[8:11], s26 offen offset:3072 sc1
    buffer_load_dwordx4 v[40:43], v0, s[8:11], s29 offen offset:0 sc1
    buffer_load_dwordx4 v[44:47], v0, s[8:11], s29 offen offset:1024 sc1
    s_waitcnt vmcnt(5)
    v_mfma_f32_16x16x32_bf16 v[48:51], v[24:27], v[160:163], 0
    s_waitcnt vmcnt(4)
    v_mfma_f32_16x16x32_bf16 v[48:51], v[28:31], v[164:167], v[48:51]
    s_waitcnt vmcnt(3)
    v_mfma_f32_16x16x32_bf16 v[48:51], v[32:35], v[168:171], v[48:51]
    s_waitcnt vmcnt(2)
    v_mfma_f32_16x16x32_bf16 v[48:51], v[36:39], v[172:175], v[48:51]
    s_nop 7
    v_max3_f32 v179, v176, v48, v49
    v_max3_f32 v179, v179, v50, v51
    v_mov_b32 v178, v179
    s_nop 1
    v_permlane16_swap_b32 v179, v178
    v_max_f32 v179, v179, v178
    v_sub_f32 v180, v176, v179
    v_sub_f32 v48, v48, v179
    v_sub_f32 v49, v49, v179
    v_sub_f32 v50, v50, v179
    v_sub_f32 v51, v51, v179
    v_exp_f32 v180, v180
    v_exp_f32 v48, v48
    v_exp_f32 v49, v49
    v_exp_f32 v50, v50
    v_exp_f32 v51, v51
    v_add_f32 v179, v48, v49
    v_add_f32 v176, v50, v51
    v_add_f32 v179, v179, v176
    v_mov_b32 v178, v179
    s_nop 1
    v_permlane16_swap_b32 v179, v178
    v_add_f32 v179, v179, v178
    v_fmac_f32 v179, v180, v177
    v_rcp_f32 v179, v179
    s_nop 0
    v_mul_f32 v180, v180, v179
    v_mul_f32 v48, v48, v179
    v_mul_f32 v49, v49, v179
    v_mul_f32 v50, v50, v179
    v_mul_f32 v51, v51, v179
    v_cvt_pk_bf16_f32 v48, v48, v49
    v_cvt_pk_bf16_f32 v49, v50, v51
    v_pk_mul_f32 v[144:145], v[144:145], v[180:181] op_sel_hi:[1,0]
    v_pk_mul_f32 v[146:147], v[146:147], v[180:181] op_sel_hi:[1,0]
    v_pk_mul_f32 v[148:149], v[148:149], v[180:181] op_sel_hi:[1,0]
    v_pk_mul_f32 v[150:151], v[150:151], v[180:181] op_sel_hi:[1,0]
    v_pk_mul_f32 v[152:153], v[152:153], v[180:181] op_sel_hi:[1,0]
    v_pk_mul_f32 v[154:155], v[154:155], v[180:181] op_sel_hi:[1,0]
    v_pk_mul_f32 v[156:157], v[156:157], v[180:181] op_sel_hi:[1,0]
    v_pk_mul_f32 v[158:159], v[158:159], v[180:181] op_sel_hi:[1,0]
    s_waitcnt vmcnt(1)
    v_mfma_f32_16x16x16_bf16 v[144:147], v[40:41], v[48:49], v[144:147]
    v_mfma_f32_16x16x16_bf16 v[148:151], v[42:43], v[48:49], v[148:151]
    s_waitcnt vmcnt(0)
    v_mfma_f32_16x16x16_bf16 v[152:155], v[44:45], v[48:49], v[152:155]
    v_mfma_f32_16x16x16_bf16 v[156:159], v[46:47], v[48:49], v[156:159]
    s_nop 4
    v_cvt_pk_bf16_f32 v56, v144, v148
    v_cvt_pk_bf16_f32 v57, v145, v149
    v_cvt_pk_bf16_f32 v58, v146, v150
    v_cvt_pk_bf16_f32 v59, v147, v151
    ds_write_b128 v10, v[56:59] offset:8192
    v_cvt_pk_bf16_f32 v60, v152, v156
    v_cvt_pk_bf16_f32 v61, v153, v157
    v_cvt_pk_bf16_f32 v62, v154, v158
    v_cvt_pk_bf16_f32 v63, v155, v159
    ds_write_b128 v10, v[60:63] offset:9216
    s_waitcnt lgkmcnt(0)
    s_barrier
    ds_read_b128 v[24:27], v3 offset:8192
    ds_read_b128 v[40:43], v3 offset:12288
    ds_read_b128 v[28:31], v3 offset:9216
    ds_read_b128 v[44:47], v3 offset:13312
    ds_read_b128 v[32:35], v3 offset:10240
    ds_read_b128 v[48:51], v3 offset:14336
    ds_read_b128 v[36:39], v3 offset:11264
    ds_read_b128 v[52:55], v3 offset:15360
    s_add_u32 s28, s68, 131072
    buffer_store_dwordx4 v[104:107], v13, s[8:11], s68 offen sc1
    buffer_store_dwordx4 v[108:111], v13, s[8:11], s28 offen sc1
    s_mov_b32 exec_hi, 0
    buffer_store_dwordx2 v[20:21], v7, s[8:11], s67 offen sc1
    s_mov_b32 exec_lo, 0x000f000f
    buffer_store_dwordx2 v[22:23], v7, s[8:11], s67 offen offset:256 sc1
    s_mov_b64 exec, -1
    v_mov_b64 v[20:21], v[184:185]
    v_mov_b64 v[22:23], v[186:187]
    s_add_u32 s46, s44, 10
    s_cmp_ge_u32 s46, 64
    s_cbranch_scc1 M_q_tb
    s_sub_u32 s29, 40960, s45
    s_min_u32 s27, s46, 63
    s_mul_i32 s27, s27, 40960
    s_add_u32 s27, s27, s47
    s_add_u32 s28, s29, s42
    s_mov_b32 m0, s28
    s_nop 0
    buffer_load_dwordx4 v0, s[8:11], s27 offen offset:0 sc1 lds
    buffer_load_dwordx4 v0, s[8:11], s27 offen offset:1024 sc1 lds
    buffer_load_dwordx4 v0, s[8:11], s27 offen offset:2048 sc1 lds
    buffer_load_dwordx4 v0, s[8:11], s27 offen offset:3072 sc1 lds
    s_add_u32 s27, s27, 4096
    s_add_u32 s28, s28, 4096
    s_mov_b32 m0, s28
    s_nop 0
    buffer_load_dwordx4 v0, s[8:11], s27 offen offset:0 sc1 lds
    buffer_load_dwordx4 v0, s[8:11], s27 offen offset:1024 sc1 lds
    buffer_load_dwordx4 v0, s[8:11], s27 offen offset:2048 sc1 lds
    buffer_load_dwordx4 v0, s[8:11], s27 offen offset:3072 sc1 lds
    s_add_u32 s27, s27, 4096
    s_add_u32 s28, s28, 4096
    s_mov_b32 m0, s28
    s_nop 0
    buffer_load_dwordx4 v0, s[8:11], s27 offen offset:0 sc1 lds
    buffer_load_dwordx4 v0, s[8:11], s27 offen offset:1024 sc1 lds
M_q_nx:
    s_mov_b32 s62, s51
    s_add_u32 s27, s48, 655360
    s_waitcnt lgkmcnt(7)
    v_mfma_f32_16x16x32_bf16 v[64:67], a[160:163], v[24:27], 0
    v_mfma_f32_16x16x32_bf16 v[68:71], a[176:179], v[24:27], 0
    s_waitcnt lgkmcnt(6)
    v_mfma_f32_16x16x32_bf16 v[72:75], a[160:163], v[40:43], 0
    v_mfma_f32_16x16x32_bf16 v[76:79], a[176:179], v[40:43], 0
    s_waitcnt lgkmcnt(5)
    v_mfma_f32_16x16x32_bf16 v[64:67], a[164:167], v[28:31], v[64:67]
    v_mfma_f32_16x16x32_bf16 v[68:71], a[180:183], v[28:31], v[68:71]
    s_waitcnt lgkmcnt(4)
    v_mfma_f32_16x16x32_bf16 v[72:75], a[164:167], v[44:47], v[72:75]
    v_mfma_f32_16x16x32_bf16 v[76:79], a[180:183], v[44:47], v[76:79]
    s_waitcnt lgkmcnt(3)
    v_mfma_f32_16x16x32_bf16 v[64:67], a[168:171], v[32:35], v[64:67]
    v_mfma_f32_16x16x32_bf16 v[68:71], a[184:187], v[32:35], v[68:71]
    s_waitcnt lgkmcnt(2)
    v_mfma_f32_16x16x32_bf16 v[72:75], a[168:171], v[48:51], v[72:75]
    v_mfma_f32_16x16x32_bf16 v[76:79], a[184:187], v[48:51], v[76:79]
    s_waitcnt lgkmcnt(1)
    v_mfma_f32_16x16x32_bf16 v[64:67], a[172:175], v[36:39], v[64:67]
    v_mfma_f32_16x16x32_bf16 v[68:71], a[188:191], v[36:39], v[68:71]
    s_waitcnt lgkmcnt(0)
    v_mfma_f32_16x16x32_bf16 v[72:75], a[172:175], v[52:55], v[72:75]
    v_mfma_f32_16x16x32_bf16 v[76:79], a[188:191], v[52:55], v[76:79]
    v_mfma_f32_16x16x32_bf16 v[80:83], a[192:195], v[24:27], 0
    v_mfma_f32_16x16x32_bf16 v[84:87], a[208:211], v[24:27], 0
    v_mfma_f32_16x16x32_bf16 v[88:91], a[192:195], v[40:43], 0
    v_mfma_f32_16x16x32_bf16 v[92:95], a[208:211], v[40:43], 0
    v_mfma_f32_16x16x32_bf16 v[80:83], a[196:199], v[28:31], v[80:83]
    v_cvt_pk_bf16_f32 v64, v64, v65
    v_cvt_pk_bf16_f32 v65, v66, v67
    v_mfma_f32_16x16x32_bf16 v[84:87], a[212:215], v[28:31], v[84:87]
    v_cvt_pk_bf16_f32 v66, v68, v69
    v_cvt_pk_bf16_f32 v67, v70, v71
    v_mfma_f32_16x16x32_bf16 v[88:91], a[196:199], v[44:47], v[88:91]
    v_cvt_pk_bf16_f32 v72, v72, v73
    v_cvt_pk_bf16_f32 v73, v74, v75
    v_mfma_f32_16x16x32_bf16 v[92:95], a[212:215], v[44:47], v[92:95]
    v_cvt_pk_bf16_f32 v74, v76, v77
    v_cvt_pk_bf16_f32 v75, v78, v79
    s_cmp_lg_u32 s23, 0
    s_cbranch_scc1 M_ls_15
    buffer_store_dwordx4 v[64:67], v4, s[8:11], s48 offen offset:0
    buffer_store_dwordx4 v[72:75], v4, s[8:11], s27 offen offset:0
M_ls_15_r:
    v_mfma_f32_16x16x32_bf16 v[80:83], a[200:203], v[32:35], v[80:83]
    v_mfma_f32_16x16x32_bf16 v[84:87], a[216:219], v[32:35], v[84:87]
    v_mfma_f32_16x16x32_bf16 v[88:91], a[200:203], v[48:51], v[88:91]
    v_mfma_f32_16x16x32_bf16 v[92:95], a[216:219], v[48:51], v[92:95]
    v_mfma_f32_16x16x32_bf16 v[80:83], a[204:207], v[36:39], v[80:83]
    v_mfma_f32_16x16x32_bf16 v[84:87], a[220:223], v[36:39], v[84:87]
    v_mfma_f32_16x16x32_bf16 v[88:91], a[204:207], v[52:55], v[88:91]
    v_mfma_f32_16x16x32_bf16 v[92:95], a[220:223], v[52:55], v[92:95]
    v_mfma_f32_16x16x32_bf16 v[96:99], a[224:227], v[24:27], 0
    v_mfma_f32_16x16x32_bf16 v[100:103], a[240:243], v[24:27], 0
    v_mfma_f32_16x16x32_bf16 v[104:107], a[224:227], v[40:43], 0
    v_mfma_f32_16x16x32_bf16 v[108:111], a[240:243], v[40:43], 0
    v_mfma_f32_16x16x32_bf16 v[96:99], a[228:231], v[28:31], v[96:99]
    v_cvt_pk_bf16_f32 v80, v80, v81
    v_cvt_pk_bf16_f32 v81, v82, v83
    v_mfma_f32_16x16x32_bf16 v[100:103], a[244:247], v[28:31], v[100:103]
    v_cvt_pk_bf16_f32 v82, v84, v85
    v_cvt_pk_bf16_f32 v83, v86, v87
    v_mfma_f32_16x16x32_bf16 v[104:107], a[228:231], v[44:47], v[104:107]
    v_cvt_pk_bf16_f32 v88, v88, v89
    v_cvt_pk_bf16_f32 v89, v90, v91
    v_mfma_f32_16x16x32_bf16 v[108:111], a[244:247], v[44:47], v[108:111]
    v_cvt_pk_bf16_f32 v90, v92, v93
    v_cvt_pk_bf16_f32 v91, v94, v95
    s_cmp_lg_u32 s23, 0
    s_cbranch_scc1 M_ls_16
    buffer_store_dwordx4 v[80:83], v4, s[8:11], s48 offen offset:64
    buffer_store_dwordx4 v[88:91], v4, s[8:11], s27 offen offset:64
M_ls_16_r:
    v_mfma_f32_16x16x32_bf16 v[96:99], a[232:235], v[32:35], v[96:99]
    v_mfma_f32_16x16x32_bf16 v[100:103], a[248:251], v[32:35], v[100:103]
    v_mfma_f32_16x16x32_bf16 v[104:107], a[232:235], v[48:51], v[104:107]
    v_mfma_f32_16x16x32_bf16 v[108:111], a[248:251], v[48:51], v[108:111]
    v_mfma_f32_16x16x32_bf16 v[96:99], a[236:239], v[36:39], v[96:99]
    v_mfma_f32_16x16x32_bf16 v[100:103], a[252:255], v[36:39], v[100:103]
    v_mfma_f32_16x16x32_bf16 v[104:107], a[236:239], v[52:55], v[104:107]
    v_mfma_f32_16x16x32_bf16 v[108:111], a[252:255], v[52:55], v[108:111]
    v_mfma_f32_16x16x32_bf16 v[112:115], v[192:195], v[24:27], 0
    v_mfma_f32_16x16x32_bf16 v[116:119], v[208:211], v[24:27], 0
    v_mfma_f32_16x16x32_bf16 v[120:123], v[192:195], v[40:43], 0
    v_mfma_f32_16x16x32_bf16 v[124:127], v[208:211], v[40:43], 0
    v_mfma_f32_16x16x32_bf16 v[112:115], v[196:199], v[28:31], v[112:115]
    v_cvt_pk_bf16_f32 v96, v96, v97
    v_cvt_pk_bf16_f32 v97, v98, v99
    v_mfma_f32_16x16x32_bf16 v[116:119], v[212:215], v[28:31], v[116:119]
    v_cvt_pk_bf16_f32 v98, v100, v101
    v_cvt_pk_bf16_f32 v99, v102, v103
    v_mfma_f32_16x16x32_bf16 v[120:123], v[196:199], v[44:47], v[120:123]
    v_cvt_pk_bf16_f32 v104, v104, v105
    v_cvt_pk_bf16_f32 v105, v106, v107
    v_mfma_f32_16x16x32_bf16 v[124:127], v[212:215], v[44:47], v[124:127]
    v_cvt_pk_bf16_f32 v106, v108, v109
    v_cvt_pk_bf16_f32 v107, v110, v111
    s_cmp_lg_u32 s23, 0
    s_cbranch_scc1 M_ls_17
    buffer_store_dwordx4 v[96:99], v4, s[8:11], s48 offen offset:128
    buffer_store_dwordx4 v[104:107], v4, s[8:11], s27 offen offset:128
M_ls_17_r:
    v_mfma_f32_16x16x32_bf16 v[112:115], v[200:203], v[32:35], v[112:115]
    v_mfma_f32_16x16x32_bf16 v[116:119], v[216:219], v[32:35], v[116:119]
    v_mfma_f32_16x16x32_bf16 v[120:123], v[200:203], v[48:51], v[120:123]
    v_mfma_f32_16x16x32_bf16 v[124:127], v[216:219], v[48:51], v[124:127]
    v_mfma_f32_16x16x32_bf16 v[112:115], v[204:207], v[36:39], v[112:115]
    v_mfma_f32_16x16x32_bf16 v[116:119], v[220:223], v[36:39], v[116:119]
    v_mfma_f32_16x16x32_bf16 v[120:123], v[204:207], v[52:55], v[120:123]
    v_mfma_f32_16x16x32_bf16 v[124:127], v[220:223], v[52:55], v[124:127]
    v_mfma_f32_16x16x32_bf16 v[128:131], v[224:227], v[24:27], 0
    v_mfma_f32_16x16x32_bf16 v[132:135], v[240:243], v[24:27], 0
    v_mfma_f32_16x16x32_bf16 v[136:139], v[224:227], v[40:43], 0
    v_mfma_f32_16x16x32_bf16 v[140:143], v[240:243], v[40:43], 0
    v_mfma_f32_16x16x32_bf16 v[128:131], v[228:231], v[28:31], v[128:131]
    v_cvt_pk_bf16_f32 v112, v112, v113
    v_cvt_pk_bf16_f32 v113, v114, v115
    v_mfma_f32_16x16x32_bf16 v[132:135], v[244:247], v[28:31], v[132:135]
    v_cvt_pk_bf16_f32 v114, v116, v117
    v_cvt_pk_bf16_f32 v115, v118, v119
    v_mfma_f32_16x16x32_bf16 v[136:139], v[228:231], v[44:47], v[136:139]
    v_cvt_pk_bf16_f32 v120, v120, v121
    v_cvt_pk_bf16_f32 v121, v122, v123
    v_mfma_f32_16x16x32_bf16 v[140:143], v[244:247], v[44:47], v[140:143]
    v_cvt_pk_bf16_f32 v122, v124, v125
    v_cvt_pk_bf16_f32 v123, v126, v127
    s_cmp_lg_u32 s23, 0
    s_cbranch_scc1 M_ls_18
    buffer_store_dwordx4 v[112:115], v4, s[8:11], s48 offen offset:192
    buffer_store_dwordx4 v[120:123], v4, s[8:11], s27 offen offset:192
M_ls_18_r:
    v_mfma_f32_16x16x32_bf16 v[128:131], v[232:235], v[32:35], v[128:131]
    v_mfma_f32_16x16x32_bf16 v[132:135], v[248:251], v[32:35], v[132:135]
    v_mfma_f32_16x16x32_bf16 v[136:139], v[232:235], v[48:51], v[136:139]
    v_mfma_f32_16x16x32_bf16 v[140:143], v[248:251], v[48:51], v[140:143]
    v_mfma_f32_16x16x32_bf16 v[128:131], v[236:239], v[36:39], v[128:131]
    v_mfma_f32_16x16x32_bf16 v[132:135], v[252:255], v[36:39], v[132:135]
    v_mfma_f32_16x16x32_bf16 v[136:139], v[236:239], v[52:55], v[136:139]
    v_mfma_f32_16x16x32_bf16 v[140:143], v[252:255], v[52:55], v[140:143]
    s_nop 4
    v_cvt_pk_bf16_f32 v128, v128, v129
    v_cvt_pk_bf16_f32 v129, v130, v131
    v_cvt_pk_bf16_f32 v130, v132, v133
    v_cvt_pk_bf16_f32 v131, v134, v135
    v_cvt_pk_bf16_f32 v136, v136, v137
    v_cvt_pk_bf16_f32 v137, v138, v139
    v_cvt_pk_bf16_f32 v138, v140, v141
    v_cvt_pk_bf16_f32 v139, v142, v143
    s_cmp_lg_u32 s23, 0
    s_cbranch_scc1 M_ls_19
    buffer_store_dwordx4 v[128:131], v4, s[8:11], s48 offen offset:256
    buffer_store_dwordx4 v[136:139], v4, s[8:11], s27 offen offset:256
M_ls_19_r:
    s_add_u32 s66, s44, 5
    s_cmp_lt_u32 s66, 64
    s_cbranch_scc1 M_q_front
    s_waitcnt vmcnt(0)
    s_barrier
    s_cmp_lg_u32 s21, 0
    s_cbranch_scc1 M_q_na
    s_mov_b64 exec, 1
    v_mov_b32 v10, s22
    v_mov_b32 v11, 1
    s_cmp_lg_u32 s23, 0
    s_cbranch_scc1 M_ls_20
    buffer_store_byte v11, v10, s[8:11], s62 offen
M_ls_20_r:
    s_mov_b64 exec, -1
M_q_na:
M_q_back2:
    s_sub_u32 s27, s44, 48
    s_lshr_b32 s29, s27, 3
    s_add_u32 s29, s29, 1
    s_and_b32 s27, s27, 0xfffffff7
    s_cmp_ge_u32 s27, 5
    s_cbranch_scc1 M_q_nf1
    s_cmp_lg_u32 s21, 3
    s_cbranch_scc1 M_q_nf1
    s_lshl_b32 s27, s20, 12
    s_lshl_b32 s28, s22, 7
    s_add_u32 s27, s27, s28
    s_add_u32 s27, s27, 167915520
    s_lshl_b32 s28, s101, 2
    s_add_u32 s28, s28, s29
    v_mov_b32 v11, s28
    s_mov_b64 exec, 1
    buffer_store_dword v11, v0, s[8:11], s27 offen sc1
    s_mov_b64 exec, -1
M_q_nf1:
    s_cmp_lg_u32 s21, 0
    s_cbranch_scc1 M_ar_21
    s_mov_b64 exec, 0xff
    s_mov_b32 s30, 0
    v_lshrrev_b32 v190, 2, v0
M_ar_22:
    buffer_load_dword v191, v190, s[8:11], s62 offen sc1
    s_add_u32 s30, s30, 1
    s_cmp_ge_u32 s30, 60000
    s_cbranch_scc1 M_fail
    s_waitcnt vmcnt(0)
    v_cmp_ne_u32 vcc, 0x01010101, v191
    s_cbranch_vccz M_ar_22d
    s_branch M_ar_22
M_ar_22d:
    s_mov_b64 exec, -1
M_ar_21:
    s_barrier
    buffer_load_dwordx4 v[24:27], v5, s[8:11], s48 offen sc1
    buffer_load_dwordx4 v[56:59], v6, s[8:11], s48 offen offset:256 sc1
    s_add_u32 s27, s48, 5120
    buffer_load_dwordx4 v[28:31], v5, s[8:11], s27 offen sc1
    s_add_u32 s27, s48, 10240
    buffer_load_dwordx4 v[32:35], v5, s[8:11], s27 offen sc1
    s_add_u32 s27, s48, 15360
    buffer_load_dwordx4 v[36:39], v5, s[8:11], s27 offen sc1
    s_add_u32 s27, s48, 20480
    buffer_load_dwordx4 v[40:43], v5, s[8:11], s27 offen sc1
    buffer_load_dwordx4 v[60:63], v6, s[8:11], s27 offen offset:256 sc1
    s_add_u32 s27, s48, 25600
    buffer_load_dwordx4 v[44:47], v5, s[8:11], s27 offen sc1
    s_add_u32 s27, s48, 30720
    buffer_load_dwordx4 v[48:51], v5, s[8:11], s27 offen sc1
    s_add_u32 s27, s48, 35840
    buffer_load_dwordx4 v[52:55], v5, s[8:11], s27 offen sc1
    v_lshlrev_b32 v72, 16, v20
    v_and_b32 v73, 0xffff0000, v20
    v_lshlrev_b32 v74, 16, v21
    v_and_b32 v75, 0xffff0000, v21
    v_lshlrev_b32 v76, 16, v22
    v_and_b32 v77, 0xffff0000, v22
    v_lshlrev_b32 v78, 16, v23
    v_and_b32 v79, 0xffff0000, v23
    s_add_u32 s67, s55, s54
    s_waitcnt vmcnt(9)
    v_mfma_f32_16x16x32_bf16 v[64:67], v[16:19], v[24:27], 0
    s_waitcnt vmcnt(8)
    v_mfma_f32_16x16x32_bf16 v[68:71], v[16:19], v[56:59], 0
    s_waitcnt vmcnt(7)
    v_mfma_f32_16x16x32_bf16 v[64:67], v[16:19], v[28:31], v[64:67]
    s_waitcnt vmcnt(6)
    v_mfma_f32_16x16x32_bf16 v[64:67], v[16:19], v[32:35], v[64:67]
    s_waitcnt vmcnt(5)
    v_mfma_f32_16x16x32_bf16 v[64:67], v[16:19], v[36:39], v[64:67]
    s_waitcnt vmcnt(4)
    v_mfma_f32_16x16x32_bf16 v[64:67], v[16:19], v[40:43], v[64:67]
    s_waitcnt vmcnt(3)
    v_mfma_f32_16x16x32_bf16 v[68:71], v[16:19], v[60:63], v[68:71]
    s_waitcnt vmcnt(2)
    v_mfma_f32_16x16x32_bf16 v[64:67], v[16:19], v[44:47], v[64:67]
    s_waitcnt vmcnt(1)
    v_mfma_f32_16x16x32_bf16 v[64:67], v[16:19], v[48:51], v[64:67]
    s_waitcnt vmcnt(0)
    v_mfma_f32_16x16x32_bf16 v[64:67], v[16:19], v[52:55], v[64:67]
    s_nop 1
    v_add_f32_dpp v68, v68, v68 row_ror:8 row_mask:0xf bank_mask:0xf
    v_add_f32_dpp v69, v69, v69 row_ror:8 row_mask:0xf bank_mask:0xf
    v_add_f32_dpp v70, v70, v70 row_ror:8 row_mask:0xf bank_mask:0xf
    v_add_f32_dpp v71, v71, v71 row_ror:8 row_mask:0xf bank_mask:0xf
    v_add_f32_dpp v68, v68, v68 row_ror:4 row_mask:0xf bank_mask:0xf
    v_add_f32_dpp v69, v69, v69 row_ror:4 row_mask:0xf bank_mask:0xf
    v_add_f32_dpp v70, v70, v70 row_ror:4 row_mask:0xf bank_mask:0xf
    v_add_f32_dpp v71, v71, v71 row_ror:4 row_mask:0xf bank_mask:0xf
    v_pk_add_f32 v[72:73], v[72:73], v[64:65]
    v_pk_add_f32 v[74:75], v[74:75], v[66:67]
    v_pk_add_f32 v[76:77], v[76:77], v[68:69]
    v_pk_add_f32 v[78:79], v[78:79], v[70:71]
    v_cvt_pk_bf16_f32 v20, v72, v73
    v_cvt_pk_bf16_f32 v21, v74, v75
    v_cvt_pk_bf16_f32 v22, v76, v77
    v_cvt_pk_bf16_f32 v23, v78, v79
    v_lshlrev_b32 v72, 16, v20
    v_and_b32 v73, 0xffff0000, v20
    v_lshlrev_b32 v74, 16, v21
    v_and_b32 v75, 0xffff0000, v21
    v_lshlrev_b32 v76, 16, v22
    v_and_b32 v77, 0xffff0000, v22
    v_lshlrev_b32 v78, 16, v23
    v_and_b32 v79, 0xffff0000, v23
    v_pk_add_f32 v[92:93], v[72:73], v[74:75]
    v_pk_add_f32 v[94:95], v[76:77], v[78:79]
    v_add_f32 v92, v92, v93
    v_add_f32 v94, v94, v95
    v_mul_f32 v94, 0x3e800000, v94
    v_add_f32 v80, v92, v94
    s_nop 1
    v_add_f32_dpp v80, v80, v80 row_ror:8 row_mask:0xf bank_mask:0xf
    s_nop 1
    v_add_f32_dpp v80, v80, v80 row_ror:4 row_mask:0xf bank_mask:0xf
    s_nop 1
    v_add_f32_dpp v80, v80, v80 row_ror:2 row_mask:0xf bank_mask:0xf
    s_nop 1
    v_add_f32_dpp v80, v80, v80 row_ror:1 row_mask:0xf bank_mask:0xf
    v_mov_b32 v178, v80
    s_nop 1
    v_permlane16_swap_b32 v80, v178
    v_add_f32 v80, v80, v178
    v_mul_f32 v80, 0x3bcccccd, v80
    v_pk_add_f32 v[84:85], v[72:73], v[80:81] op_sel_hi:[1,0] neg_lo:[0,1] neg_hi:[0,1]
    v_pk_add_f32 v[86:87], v[74:75], v[80:81] op_sel_hi:[1,0] neg_lo:[0,1] neg_hi:[0,1]
    v_pk_add_f32 v[88:89], v[76:77], v[80:81] op_sel_hi:[1,0] neg_lo:[0,1] neg_hi:[0,1]
    v_pk_add_f32 v[90:91], v[78:79], v[80:81] op_sel_hi:[1,0] neg_lo:[0,1] neg_hi:[0,1]
    v_pk_mul_f32 v[84:85], v[84:85], v[84:85]
    v_pk_mul_f32 v[86:87], v[86:87], v[86:87]
    v_pk_mul_f32 v[88:89], v[88:89], v[88:89]
    v_pk_mul_f32 v[90:91], v[90:91], v[90:91]
    v_pk_add_f32 v[92:93], v[84:85], v[86:87]
    v_pk_add_f32 v[94:95], v[88:89], v[90:91]
    v_add_f32 v92, v92, v93
    v_add_f32 v94, v94, v95
    v_mul_f32 v94, 0x3e800000, v94
    v_add_f32 v81, v92, v94
    s_nop 1
    v_add_f32_dpp v81, v81, v81 row_ror:8 row_mask:0xf bank_mask:0xf
    s_nop 1
    v_add_f32_dpp v81, v81, v81 row_ror:4 row_mask:0xf bank_mask:0xf
    s_nop 1
    v_add_f32_dpp v81, v81, v81 row_ror:2 row_mask:0xf bank_mask:0xf
    s_nop 1
    v_add_f32_dpp v81, v81, v81 row_ror:1 row_mask:0xf bank_mask:0xf
    v_mov_b32 v178, v81
    s_nop 1
    v_permlane16_swap_b32 v81, v178
    v_add_f32 v81, v81, v178
    s_lshl_b32 s27, s21, 3
    s_add_u32 s27, s27, 98304
    v_mov_b32 v10, s27
    v_mov_b32 v11, 98304
    ds_write_b64 v10, v[80:81]
    s_waitcnt lgkmcnt(0)
    s_barrier
    ds_read_b128 v[84:87], v11 offset:0
    ds_read_b128 v[88:91], v11 offset:16
    s_waitcnt lgkmcnt(1)
    v_pk_add_f32 v[80:81], v[84:85], v[86:87]
    s_waitcnt lgkmcnt(0)
    v_pk_add_f32 v[92:93], v[88:89], v[90:91]
    v_pk_add_f32 v[80:81], v[80:81], v[92:93]
    v_mul_f32 v80, 0x3e800000, v80
    v_sub_f32 v84, v84, v80
    v_sub_f32 v86, v86, v80
    v_sub_f32 v88, v88, v80
    v_sub_f32 v90, v90, v80
    v_mul_f32 v85, 0x43200000, v84
    v_mul_f32 v87, 0x43200000, v86
    v_mul_f32 v89, 0x43200000, v88
    v_mul_f32 v91, 0x43200000, v90
    v_fmac_f32 v81, v84, v85
    v_fmac_f32 v81, v86, v87
    v_fmac_f32 v81, v88, v89
    v_fmac_f32 v81, v90, v91
    v_mov_b32 v82, 0x3727c5ac
    v_fmac_f32 v82, 0x3acccccd, v81
    v_rsq_f32 v82, v82
    v_pk_add_f32 v[72:73], v[72:73], v[80:81] op_sel_hi:[1,0] neg_lo:[0,1] neg_hi:[0,1]
    v_pk_add_f32 v[74:75], v[74:75], v[80:81] op_sel_hi:[1,0] neg_lo:[0,1] neg_hi:[0,1]
    v_pk_add_f32 v[76:77], v[76:77], v[80:81] op_sel_hi:[1,0] neg_lo:[0,1] neg_hi:[0,1]
    v_pk_add_f32 v[78:79], v[78:79], v[80:81] op_sel_hi:[1,0] neg_lo:[0,1] neg_hi:[0,1]
    v_pk_mul_f32 v[72:73], v[72:73], v[82:83] op_sel_hi:[1,0]
    v_pk_mul_f32 v[74:75], v[74:75], v[82:83] op_sel_hi:[1,0]
    v_pk_mul_f32 v[76:77], v[76:77], v[82:83] op_sel_hi:[1,0]
    v_pk_mul_f32 v[78:79], v[78:79], v[82:83] op_sel_hi:[1,0]
    v_cvt_pk_f16_f32 v72, v72, v73
    v_cvt_pk_f16_f32 v73, v74, v75
    v_cvt_pk_f16_f32 v74, v76, v77
    v_cvt_pk_f16_f32 v75, v78, v79
    s_cmp_lg_u32 s23, 0
    s_cbranch_scc1 M_ls_23
    s_mov_b32 exec_hi, 0
    buffer_store_dwordx2 v[72:73], v12, s[8:11], s63 offen
    s_mov_b32 exec_lo, 0x000f000f
    buffer_store_dwordx2 v[74:75], v12, s[8:11], s64 offen
    s_mov_b64 exec, -1
M_ls_23_r:
    s_add_u32 s62, s51, 20480
    s_waitcnt vmcnt(0)
    s_barrier
    s_cmp_lg_u32 s21, 0
    s_cbranch_scc1 M_q_nb
    s_mov_b64 exec, 1
    v_mov_b32 v10, s22
    v_mov_b32 v11, 1
    s_cmp_lg_u32 s23, 0
    s_cbranch_scc1 M_ls_24
    buffer_store_byte v11, v10, s[8:11], s62 offen
M_ls_24_r:
    s_mov_b64 exec, -1
M_q_nb:
    s_cmp_ge_u32 s22, 20
    s_cbranch_scc1 M_q_tab
    s_cmp_lg_u32 s21, 0
    s_cbranch_scc1 M_ar_25
    s_mov_b64 exec, 0xff
    s_mov_b32 s30, 0
    v_lshrrev_b32 v190, 2, v0
M_ar_26:
    buffer_load_dword v191, v190, s[8:11], s62 offen sc1
    s_add_u32 s30, s30, 1
    s_cmp_ge_u32 s30, 60000
    s_cbranch_scc1 M_fail
    s_waitcnt vmcnt(0)
    v_cmp_ne_u32 vcc, 0x01010101, v191
    s_cbranch_vccz M_ar_26d
    s_branch M_ar_26
M_ar_26d:
    s_mov_b64 exec, -1
M_ar_25:
    s_barrier
    s_cmp_ge_u32 s21, 2
    s_cbranch_scc1 M_q_nd
    s_mul_i32 s27, s21, 20480
    s_add_u32 s27, s27, s63
    buffer_load_dwordx4 v[24:27], v0, s[8:11], s27 offen offset:0 sc1
    buffer_load_dwordx4 v[28:31], v0, s[8:11], s27 offen offset:1024 sc1
    buffer_load_dwordx4 v[32:35], v0, s[8:11], s27 offen offset:2048 sc1
    buffer_load_dwordx4 v[36:39], v0, s[8:11], s27 offen offset:3072 sc1
    s_add_u32 s27, s27, 4096
    buffer_load_dwordx4 v[40:43], v0, s[8:11], s27 offen offset:0 sc1
    buffer_load_dwordx4 v[44:47], v0, s[8:11], s27 offen offset:1024 sc1
    buffer_load_dwordx4 v[48:51], v0, s[8:11], s27 offen offset:2048 sc1
    buffer_load_dwordx4 v[52:55], v0, s[8:11], s27 offen offset:3072 sc1
    s_add_u32 s27, s27, 4096
    buffer_load_dwordx4 v[56:59], v0, s[8:11], s27 offen offset:0 sc1
    buffer_load_dwordx4 v[60:63], v0, s[8:11], s27 offen offset:1024 sc1
    buffer_load_dwordx4 v[64:67], v0, s[8:11], s27 offen offset:2048 sc1
    buffer_load_dwordx4 v[68:71], v0, s[8:11], s27 offen offset:3072 sc1
    s_add_u32 s27, s27, 4096
    buffer_load_dwordx4 v[72:75], v0, s[8:11], s27 offen offset:0 sc1
    buffer_load_dwordx4 v[76:79], v0, s[8:11], s27 offen offset:1024 sc1
    buffer_load_dwordx4 v[80:83], v0, s[8:11], s27 offen offset:2048 sc1
    buffer_load_dwordx4 v[84:87], v0, s[8:11], s27 offen offset:3072 sc1
    s_add_u32 s27, s27, 4096
    buffer_load_dwordx4 v[88:91], v0, s[8:11], s27 offen offset:0 sc1
    buffer_load_dwordx4 v[92:95], v0, s[8:11], s27 offen offset:1024 sc1
    buffer_load_dwordx4 v[96:99], v0, s[8:11], s27 offen offset:2048 sc1
    buffer_load_dwordx4 v[100:103], v0, s[8:11], s27 offen offset:3072 sc1
    s_add_u32 s27, s27, 4096
    ds_read_b128 v[112:115], v14 offset:0
    ds_read_b128 v[116:119], v14 offset:20480
    ds_read_b128 v[120:123], v14 offset:1024
    ds_read_b128 v[124:127], v14 offset:21504
    ds_read_b128 v[128:131], v14 offset:2048
    ds_read_b128 v[132:135], v14 offset:22528
    ds_read_b128 v[136:139], v14 offset:3072
    s_lshl_b32 s27, s44, 7
    s_mul_i32 s68, s101, 6291456
    s_add_u32 s68, s68, s27
    s_add_u32 s68, s68, 176160768
    s_waitcnt vmcnt(19) lgkmcnt(6)
    v_mfma_f32_16x16x32_f16 v[104:107], v[24:27], v[112:115], 0
    ds_read_b128 v[140:143], v14 offset:23552
    s_waitcnt lgkmcnt(6)
    v_mfma_f32_16x16x32_f16 v[108:111], v[24:27], v[116:119], 0
    ds_read_b128 v[112:115], v14 offset:4096
    s_waitcnt vmcnt(18) lgkmcnt(6)
    v_mfma_f32_16x16x32_f16 v[104:107], v[28:31], v[120:123], v[104:107]
    ds_read_b128 v[116:119], v14 offset:24576
    s_waitcnt lgkmcnt(6)
    v_mfma_f32_16x16x32_f16 v[108:111], v[28:31], v[124:127], v[108:111]
    ds_read_b128 v[120:123], v14 offset:5120
    s_waitcnt vmcnt(17) lgkmcnt(6)
    v_mfma_f32_16x16x32_f16 v[104:107], v[32:35], v[128:131], v[104:107]
    ds_read_b128 v[124:127], v14 offset:25600
    s_waitcnt lgkmcnt(6)
    v_mfma_f32_16x16x32_f16 v[108:111], v[32:35], v[132:135], v[108:111]
    ds_read_b128 v[128:131], v14 offset:6144
    s_waitcnt vmcnt(16) lgkmcnt(6)
    v_mfma_f32_16x16x32_f16 v[104:107], v[36:39], v[136:139], v[104:107]
    ds_read_b128 v[132:135], v14 offset:26624
    s_waitcnt lgkmcnt(6)
    v_mfma_f32_16x16x32_f16 v[108:111], v[36:39], v[140:143], v[108:111]
    ds_read_b128 v[136:139], v14 offset:7168
    s_waitcnt vmcnt(15) lgkmcnt(6)
    v_mfma_f32_16x16x32_f16 v[104:107], v[40:43], v[112:115], v[104:107]
    ds_read_b128 v[140:143], v14 offset:27648
    s_waitcnt lgkmcnt(6)
    v_mfma_f32_16x16x32_f16 v[108:111], v[40:43], v[116:119], v[108:111]
    ds_read_b128 v[112:115], v14 offset:8192
    s_waitcnt vmcnt(14) lgkmcnt(6)
    v_mfma_f32_16x16x32_f16 v[104:107], v[44:47], v[120:123], v[104:107]
    ds_read_b128 v[116:119], v14 offset:28672
    s_waitcnt lgkmcnt(6)
    v_mfma_f32_16x16x32_f16 v[108:111], v[44:47], v[124:127], v[108:111]
    ds_read_b128 v[120:123], v14 offset:9216
    s_waitcnt vmcnt(13) lgkmcnt(6)
    v_mfma_f32_16x16x32_f16 v[104:107], v[48:51], v[128:131], v[104:107]
    ds_read_b128 v[124:127], v14 offset:29696
    s_waitcnt lgkmcnt(6)
    v_mfma_f32_16x16x32_f16 v[108:111], v[48:51], v[132:135], v[108:111]
    ds_read_b128 v[128:131], v14 offset:10240
    s_waitcnt vmcnt(12) lgkmcnt(6)
    v_mfma_f32_16x16x32_f16 v[104:107], v[52:55], v[136:139], v[104:107]
    ds_read_b128 v[132:135], v14 offset:30720
    s_waitcnt lgkmcnt(6)
    v_mfma_f32_16x16x32_f16 v[108:111], v[52:55], v[140:143], v[108:111]
    ds_read_b128 v[136:139], v14 offset:11264
    s_waitcnt vmcnt(11) lgkmcnt(6)
    v_mfma_f32_16x16x32_f16 v[104:107], v[56:59], v[112:115], v[104:107]
    ds_read_b128 v[140:143], v14 offset:31744
    s_waitcnt lgkmcnt(6)
    v_mfma_f32_16x16x32_f16 v[108:111], v[56:59], v[116:119], v[108:111]
    ds_read_b128 v[112:115], v14 offset:12288
    s_waitcnt vmcnt(10) lgkmcnt(6)
    v_mfma_f32_16x16x32_f16 v[104:107], v[60:63], v[120:123], v[104:107]
    ds_read_b128 v[116:119], v14 offset:32768
    s_waitcnt lgkmcnt(6)
    v_mfma_f32_16x16x32_f16 v[108:111], v[60:63], v[124:127], v[108:111]
    ds_read_b128 v[120:123], v14 offset:13312
    s_waitcnt vmcnt(9) lgkmcnt(6)
    v_mfma_f32_16x16x32_f16 v[104:107], v[64:67], v[128:131], v[104:107]
    ds_read_b128 v[124:127], v14 offset:33792
    s_waitcnt lgkmcnt(6)
    v_mfma_f32_16x16x32_f16 v[108:111], v[64:67], v[132:135], v[108:111]
    ds_read_b128 v[128:131], v14 offset:14336
    s_waitcnt vmcnt(8) lgkmcnt(6)
    v_mfma_f32_16x16x32_f16 v[104:107], v[68:71], v[136:139], v[104:107]
    ds_read_b128 v[132:135], v14 offset:34816
    s_waitcnt lgkmcnt(6)
    v_mfma_f32_16x16x32_f16 v[108:111], v[68:71], v[140:143], v[108:111]
    ds_read_b128 v[136:139], v14 offset:15360
    s_waitcnt vmcnt(7) lgkmcnt(6)
    v_mfma_f32_16x16x32_f16 v[104:107], v[72:75], v[112:115], v[104:107]
    ds_read_b128 v[140:143], v14 offset:35840
    s_waitcnt lgkmcnt(6)
    v_mfma_f32_16x16x32_f16 v[108:111], v[72:75], v[116:119], v[108:111]
    ds_read_b128 v[112:115], v14 offset:16384
    s_waitcnt vmcnt(6) lgkmcnt(6)
    v_mfma_f32_16x16x32_f16 v[104:107], v[76:79], v[120:123], v[104:107]
    ds_read_b128 v[116:119], v14 offset:36864
    s_waitcnt lgkmcnt(6)
    v_mfma_f32_16x16x32_f16 v[108:111], v[76:79], v[124:127], v[108:111]
    ds_read_b128 v[120:123], v14 offset:17408
    s_waitcnt vmcnt(5) lgkmcnt(6)
    v_mfma_f32_16x16x32_f16 v[104:107], v[80:83], v[128:131], v[104:107]
    ds_read_b128 v[124:127], v14 offset:37888
    s_waitcnt lgkmcnt(6)
    v_mfma_f32_16x16x32_f16 v[108:111], v[80:83], v[132:135], v[108:111]
    ds_read_b128 v[128:131], v14 offset:18432
    s_waitcnt vmcnt(4) lgkmcnt(6)
    v_mfma_f32_16x16x32_f16 v[104:107], v[84:87], v[136:139], v[104:107]
    ds_read_b128 v[132:135], v14 offset:38912
    s_waitcnt lgkmcnt(6)
    v_mfma_f32_16x16x32_f16 v[108:111], v[84:87], v[140:143], v[108:111]
    ds_read_b128 v[136:139], v14 offset:19456
    s_waitcnt vmcnt(3) lgkmcnt(6)
    v_mfma_f32_16x16x32_f16 v[104:107], v[88:91], v[112:115], v[104:107]
    ds_read_b128 v[140:143], v14 offset:39936
    s_waitcnt lgkmcnt(6)
    v_mfma_f32_16x16x32_f16 v[108:111], v[88:91], v[116:119], v[108:111]
    s_waitcnt vmcnt(2) lgkmcnt(5)
    v_mfma_f32_16x16x32_f16 v[104:107], v[92:95], v[120:123], v[104:107]
    s_waitcnt lgkmcnt(4)
    v_mfma_f32_16x16x32_f16 v[108:111], v[92:95], v[124:127], v[108:111]
    s_waitcnt vmcnt(1) lgkmcnt(3)
    v_mfma_f32_16x16x32_f16 v[104:107], v[96:99], v[128:131], v[104:107]
    s_waitcnt lgkmcnt(2)
    v_mfma_f32_16x16x32_f16 v[108:111], v[96:99], v[132:135], v[108:111]
    s_waitcnt vmcnt(0) lgkmcnt(1)
    v_mfma_f32_16x16x32_f16 v[104:107], v[100:103], v[136:139], v[104:107]
    s_waitcnt lgkmcnt(0)
    v_mfma_f32_16x16x32_f16 v[108:111], v[100:103], v[140:143], v[108:111]
    s_nop 7
M_q_nd:
    s_sub_u32 s27, s44, 54
    s_cmp_ge_u32 s27, 5
    s_cbranch_scc1 M_q_nt
    s_sub_u32 s27, 40960, s45
    s_mul_i32 s29, s21, 10240
    s_add_u32 s29, s29, s27
    s_mul_i32 s28, s88, 81920
    s_add_u32 s28, s28, s29
    s_add_u32 s28, s28, 147849216
    s_mov_b32 m0, s29
    s_nop 0
    buffer_load_dwordx4 v0, s[8:11], s28 offen offset:0 sc1 lds
    buffer_load_dwordx4 v0, s[8:11], s28 offen offset:1024 sc1 lds
    buffer_load_dwordx4 v0, s[8:11], s28 offen offset:2048 sc1 lds
    buffer_load_dwordx4 v0, s[8:11], s28 offen offset:3072 sc1 lds
    s_add_u32 s29, s29, 4096
    s_add_u32 s28, s28, 4096
    s_mov_b32 m0, s29
    s_nop 0
    buffer_load_dwordx4 v0, s[8:11], s28 offen offset:0 sc1 lds
    buffer_load_dwordx4 v0, s[8:11], s28 offen offset:1024 sc1 lds
    buffer_load_dwordx4 v0, s[8:11], s28 offen offset:2048 sc1 lds
    buffer_load_dwordx4 v0, s[8:11], s28 offen offset:3072 sc1 lds
    s_add_u32 s29, s29, 4096
    s_add_u32 s28, s28, 4096
    s_mov_b32 m0, s29
    s_nop 0
    buffer_load_dwordx4 v0, s[8:11], s28 offen offset:0 sc1 lds
    buffer_load_dwordx4 v0, s[8:11], s28 offen offset:1024 sc1 lds
M_q_nt:
    s_add_u32 s48, s48, s49
    s_sub_u32 s49, 0, s49
    s_add_u32 s51, s51, 128
    s_add_u32 s44, s44, 5
    s_cmp_lt_u32 s44, 64
    s_cbranch_scc1 M_q_top
    s_cmp_ge_u32 s21, 2
    s_cbranch_scc1 M_q_e1
    s_add_u32 s28, s68, 131072
    buffer_store_dwordx4 v[104:107], v13, s[8:11], s68 offen sc1
    buffer_store_dwordx4 v[108:111], v13, s[8:11], s28 offen sc1
    s_mov_b32 exec_hi, 0
    buffer_store_dwordx2 v[20:21], v7, s[8:11], s67 offen sc1
    s_mov_b32 exec_lo, 0x000f000f
    buffer_store_dwordx2 v[22:23], v7, s[8:11], s67 offen offset:256 sc1
    s_mov_b64 exec, -1
    s_waitcnt vmcnt(2)
    s_barrier
    s_cmp_lg_u32 s21, 0
    s_cbranch_scc1 M_bphase
    s_lshl_b32 s27, s20, 12
    s_lshl_b32 s28, s22, 7
    s_add_u32 s27, s27, s28
    s_add_u32 s27, s27, 167915520
    s_lshl_b32 s28, s101, 2
    s_add_u32 s28, s28, 3
    v_mov_b32 v11, s28
    s_mov_b64 exec, 1
    buffer_store_dword v11, v0, s[8:11], s27 offen sc1
    s_mov_b64 exec, -1
    s_branch M_bphase
M_q_tb:
    s_cmp_ge_u32 s44, 59
    s_cbranch_scc1 M_q_nx
    s_cmp_lg_u32 s101, 0
    s_cbranch_scc1 M_q_tp2
    v_lshlrev_b32 v190, 3, v0
    s_mov_b32 exec_hi, 0x0fffffff
    s_mov_b32 s28, 167948288
    s_mov_b32 s30, 0
M_q_tpl:
    buffer_load_dword v191, v190, s[8:11], s28 offen sc1
    s_add_u32 s30, s30, 1
    s_cmp_ge_u32 s30, 240000
    s_cbranch_scc1 M_fail
    s_waitcnt vmcnt(0)
    v_cmp_ne_u32 vcc, 0x01010101, v191
    s_cbranch_vccz M_q_tpd
    s_sleep 8
    s_branch M_q_tpl
M_q_tpd:
    s_mov_b64 exec, -1
M_q_tp2:
    s_sub_u32 s27, 40960, s45
    s_mul_i32 s29, s21, 10240
    s_add_u32 s29, s29, s27
    s_mul_i32 s28, s88, 81920
    s_add_u32 s28, s28, s29
    s_add_u32 s28, s28, 147849216
    s_mov_b32 m0, s29
    s_nop 0
    buffer_load_dwordx4 v0, s[8:11], s28 offen offset:0 sc1 lds
    buffer_load_dwordx4 v0, s[8:11], s28 offen offset:1024 sc1 lds
    buffer_load_dwordx4 v0, s[8:11], s28 offen offset:2048 sc1 lds
    buffer_load_dwordx4 v0, s[8:11], s28 offen offset:3072 sc1 lds
    s_add_u32 s29, s29, 4096
    s_add_u32 s28, s28, 4096
    s_mov_b32 m0, s29
    s_nop 0
    buffer_load_dwordx4 v0, s[8:11], s28 offen offset:0 sc1 lds
    buffer_load_dwordx4 v0, s[8:11], s28 offen offset:1024 sc1 lds
    buffer_load_dwordx4 v0, s[8:11], s28 offen offset:2048 sc1 lds
    buffer_load_dwordx4 v0, s[8:11], s28 offen offset:3072 sc1 lds
    s_add_u32 s29, s29, 4096
    s_add_u32 s28, s28, 4096
    s_mov_b32 m0, s29
    s_nop 0
    buffer_load_dwordx4 v0, s[8:11], s28 offen offset:0 sc1 lds
    buffer_load_dwordx4 v0, s[8:11], s28 offen offset:1024 sc1 lds
    s_branch M_q_nx
M_q_tab:
    s_cmp_ge_u32 s44, 59
    s_cbranch_scc1 M_q_nd
    s_cmp_lg_u32 s21, 0
    s_cbranch_scc1 M_ar_27
    s_mov_b64 exec, 0xff
    s_mov_b32 s30, 0
    v_lshrrev_b32 v190, 2, v0
M_ar_28:
    buffer_load_dword v191, v190, s[8:11], s62 offen sc1
    s_add_u32 s30, s30, 1
    s_cmp_ge_u32 s30, 60000
    s_cbranch_scc1 M_fail
    s_waitcnt vmcnt(0)
    v_cmp_ne_u32 vcc, 0x01010101, v191
    s_cbranch_vccz M_ar_28d
    s_sleep 1
    s_branch M_ar_28
M_ar_28d:
    s_mov_b64 exec, -1
M_ar_27:
    s_barrier
    s_cmp_ge_u32 s94, 2400
    s_cbranch_scc1 M_q_nd
    v_mov_b32 v32, v0
    v_mov_b32 v33, v1
    v_mov_b32 v34, v2
    v_mov_b32 v35, v3
    v_mov_b32 v36, v4
    v_mov_b32 v37, v5
    v_mov_b32 v38, v6
    v_mov_b32 v39, v7
    v_mov_b32 v40, v8
    v_mov_b32 v41, v9
    v_mov_b32 v42, v10
    v_mov_b32 v43, v11
    v_mov_b32 v44, v12
    v_mov_b32 v45, v13
    v_mov_b32 v46, v14
    v_mov_b32 v47, v15
    v_mov_b32 v48, v16
    v_mov_b32 v49, v17
    v_mov_b32 v50, v18
    v_mov_b32 v51, v19
    v_mov_b32 v52, v20
    v_mov_b32 v53, v21
    v_mov_b32 v54, v22
    v_mov_b32 v55, v23
    v_lshrrev_b32 v1, 4, v0
    v_lshrrev_b32 v3, 8, v0
    v_and_b32 v4, 15, v1
    v_mov_b32 v5, v0
    s_cmp_ge_u32 s94, 800
    s_cbranch_scc1 M_q_wt
    s_mov_b32 s36, s94
    s_mul_hi_u32 s37, s36, 0xccccccd
    s_mul_i32 s38, s37, 20
    s_sub_u32 s38, s36, s38
    s_lshl_b32 s37, s37, 4
    s_lshl_b32 s38, s38, 5
    v_lshlrev_b32 v7, 3, v3
    v_add_u32 v7, s38, v7
    s_mov_b32 s39, 0x666667
    s_movk_i32 s40, 640
    s_and_b32 s41, s37, 16
    s_sub_u32 s37, s37, s41
    s_lshr_b32 s41, s41, 2
    s_add_u32 s37, s37, s41
    v_and_b32 v6, 12, v4
    v_add_u32 v6, v6, v4
    v_add_u32 v6, s37, v6
    v_lshrrev_b32 v8, 1, v7
    v_cmp_eq_u32 vcc, 0, v7
    v_add_u32 v11, 0, v8
    v_mov_b32 v13, 0x00000000
    v_mov_b32 v14, 0x35cccccd
    v_mov_b32 v15, 0x354ccccd
    v_cndmask_b32 v14, v14, v15, vcc
    v_mul_u32_u24 v11, v11, v6
    v_mul_hi_u32 v12, v11, s39
    v_mul_lo_u32 v12, v12, s40
    v_sub_u32 v11, v11, v12
    v_cvt_f32_u32 v11, v11
    v_fmac_f32 v13, 0x3acccccd, v11
    v_cos_f32 v13, v13
    s_nop 0
    v_mul_f32 v16, v13, v14
    v_add_u32 v11, 0, v8
    v_mov_b32 v13, 0x3e800000
    v_mov_b32 v14, 0x35cccccd
    v_mov_b32 v15, 0x354ccccd
    v_cndmask_b32 v14, v14, v15, vcc
    v_mov_b32 v15, 320
    v_cndmask_b32 v11, v11, v15, vcc
    v_mov_b32 v15, 0
    v_cndmask_b32 v13, v13, v15, vcc
    v_mul_u32_u24 v11, v11, v6
    v_mul_hi_u32 v12, v11, s39
    v_mul_lo_u32 v12, v12, s40
    v_sub_u32 v11, v11, v12
    v_cvt_f32_u32 v11, v11
    v_fmac_f32 v13, 0x3acccccd, v11
    v_cos_f32 v13, v13
    s_nop 0
    v_mul_f32 v17, v13, v14
    v_add_u32 v11, 1, v8
    v_mov_b32 v13, 0x00000000
    v_mov_b32 v14, 0x35cccccd
    v_mul_u32_u24 v11, v11, v6
    v_mul_hi_u32 v12, v11, s39
    v_mul_lo_u32 v12, v12, s40
    v_sub_u32 v11, v11, v12
    v_cvt_f32_u32 v11, v11
    v_fmac_f32 v13, 0x3acccccd, v11
    v_cos_f32 v13, v13
    s_nop 0
    v_mul_f32 v18, v13, v14
    v_add_u32 v11, 1, v8
    v_mov_b32 v13, 0x3e800000
    v_mov_b32 v14, 0x35cccccd
    v_mul_u32_u24 v11, v11, v6
    v_mul_hi_u32 v12, v11, s39
    v_mul_lo_u32 v12, v12, s40
    v_sub_u32 v11, v11, v12
    v_cvt_f32_u32 v11, v11
    v_fmac_f32 v13, 0x3acccccd, v11
    v_cos_f32 v13, v13
    s_nop 0
    v_mul_f32 v19, v13, v14
    v_add_u32 v11, 2, v8
    v_mov_b32 v13, 0x00000000
    v_mov_b32 v14, 0x35cccccd
    v_mul_u32_u24 v11, v11, v6
    v_mul_hi_u32 v12, v11, s39
    v_mul_lo_u32 v12, v12, s40
    v_sub_u32 v11, v11, v12
    v_cvt_f32_u32 v11, v11
    v_fmac_f32 v13, 0x3acccccd, v11
    v_cos_f32 v13, v13
    s_nop 0
    v_mul_f32 v20, v13, v14
    v_add_u32 v11, 2, v8
    v_mov_b32 v13, 0x3e800000
    v_mov_b32 v14, 0x35cccccd
    v_mul_u32_u24 v11, v11, v6
    v_mul_hi_u32 v12, v11, s39
    v_mul_lo_u32 v12, v12, s40
    v_sub_u32 v11, v11, v12
    v_cvt_f32_u32 v11, v11
    v_fmac_f32 v13, 0x3acccccd, v11
    v_cos_f32 v13, v13
    s_nop 0
    v_mul_f32 v21, v13, v14
    v_add_u32 v11, 3, v8
    v_mov_b32 v13, 0x00000000
    v_mov_b32 v14, 0x35cccccd
    v_mul_u32_u24 v11, v11, v6
    v_mul_hi_u32 v12, v11, s39
    v_mul_lo_u32 v12, v12, s40
    v_sub_u32 v11, v11, v12
    v_cvt_f32_u32 v11, v11
    v_fmac_f32 v13, 0x3acccccd, v11
    v_cos_f32 v13, v13
    s_nop 0
    v_mul_f32 v22, v13, v14
    v_add_u32 v11, 3, v8
    v_mov_b32 v13, 0x3e800000
    v_mov_b32 v14, 0x35cccccd
    v_mul_u32_u24 v11, v11, v6
    v_mul_hi_u32 v12, v11, s39
    v_mul_lo_u32 v12, v12, s40
    v_sub_u32 v11, v11, v12
    v_cvt_f32_u32 v11, v11
    v_fmac_f32 v13, 0x3acccccd, v11
    v_cos_f32 v13, v13
    s_nop 0
    v_mul_f32 v23, v13, v14
    v_cvt_pk_bf16_f32 v24, v16, v17
    v_cvt_pk_bf16_f32 v25, v18, v19
    v_cvt_pk_bf16_f32 v26, v20, v21
    v_cvt_pk_bf16_f32 v27, v22, v23
    s_lshl_b32 s37, s36, 10
    s_add_u32 s37, s37, 147849216
    buffer_store_dwordx4 v[24:27], v5, s[8:11], s37 offen sc1
    s_branch M_q_te
M_q_wt:
    s_sub_u32 s37, s94, 800
    s_lshr_b32 s36, s37, 8
    s_and_b32 s37, s37, 255
    s_lshl_b32 s38, s36, 6
    v_add_u32 v6, s38, v1
    s_lshr_b32 s38, s37, 5
    s_bfe_u32 s39, s37, 0x30002
    s_lshl_b32 s39, s39, 3
    s_add_u32 s38, s38, s39
    s_and_b32 s39, s37, 3
    s_lshl_b32 s39, s39, 7
    s_add_u32 s38, s38, s39
    s_mul_i32 s38, s38, 642
    v_lshlrev_b32 v7, 1, v6
    v_lshrrev_b32 v2, 1, v6
    v_lshlrev_b32 v2, 14, v2
    v_and_b32 v24, 1, v6
    v_lshl_add_u32 v2, v24, 4, v2
    v_cmp_gt_u32 vcc, 321, v6
    s_and_saveexec_b64 s[90:91], vcc
    s_cbranch_execz M_q_ws
    s_add_u32 s39, s38, 0
    buffer_load_ushort v8, v7, s[72:75], s39 offen
    buffer_load_ushort v16, v7, s[76:79], s39 offen
    s_add_u32 s39, s38, 328704
    buffer_load_ushort v9, v7, s[72:75], s39 offen
    buffer_load_ushort v17, v7, s[76:79], s39 offen
    s_add_u32 s39, s38, 657408
    buffer_load_ushort v10, v7, s[72:75], s39 offen
    buffer_load_ushort v18, v7, s[76:79], s39 offen
    s_add_u32 s39, s38, 986112
    buffer_load_ushort v11, v7, s[72:75], s39 offen
    buffer_load_ushort v19, v7, s[76:79], s39 offen
    s_add_u32 s39, s38, 41088
    buffer_load_ushort v12, v7, s[72:75], s39 offen
    buffer_load_ushort v20, v7, s[76:79], s39 offen
    s_add_u32 s39, s38, 369792
    buffer_load_ushort v13, v7, s[72:75], s39 offen
    buffer_load_ushort v21, v7, s[76:79], s39 offen
    s_add_u32 s39, s38, 698496
    buffer_load_ushort v14, v7, s[72:75], s39 offen
    buffer_load_ushort v22, v7, s[76:79], s39 offen
    s_add_u32 s39, s38, 1027200
    buffer_load_ushort v15, v7, s[72:75], s39 offen
    buffer_load_ushort v23, v7, s[76:79], s39 offen
    s_lshl_b32 s39, s37, 6
    s_add_u32 s39, s39, 148897792
    s_waitcnt vmcnt(0)
    v_lshl_or_b32 v8, v16, 16, v8
    v_lshl_or_b32 v9, v17, 16, v9
    v_lshl_or_b32 v10, v18, 16, v10
    v_lshl_or_b32 v11, v19, 16, v11
    v_lshl_or_b32 v12, v20, 16, v12
    v_lshl_or_b32 v13, v21, 16, v13
    v_lshl_or_b32 v14, v22, 16, v14
    v_lshl_or_b32 v15, v23, 16, v15
    buffer_store_dwordx4 v[8:11], v2, s[8:11], s39 offen sc1
    buffer_store_dwordx4 v[12:15], v2, s[8:11], s39 offen offset:32 sc1
M_q_ws:
    s_mov_b64 exec, s[90:91]
M_q_te:
    s_add_u32 s94, s94, 240
    s_mov_b32 s40, 0x3e0293ee
    s_mov_b32 s41, s40
    s_cmp_lt_u32 s94, 2400
    s_cbranch_scc1 M_q_tr
    s_waitcnt vmcnt(0)
    v_mov_b32 v1, s21
    v_mov_b32 v2, 1
    s_mov_b64 exec, 1
    buffer_store_byte v2, v1, s[8:11], s95 offen sc1
    s_mov_b64 exec, -1
M_q_tr:
    s_nop 1
    v_mov_b32 v1, v33
    v_mov_b32 v2, v34
    v_mov_b32 v3, v35
    v_mov_b32 v4, v36
    v_mov_b32 v5, v37
    v_mov_b32 v6, v38
    v_mov_b32 v7, v39
    v_mov_b32 v8, v40
    v_mov_b32 v9, v41
    v_mov_b32 v10, v42
    v_mov_b32 v11, v43
    v_mov_b32 v12, v44
    v_mov_b32 v13, v45
    v_mov_b32 v14, v46
    v_mov_b32 v15, v47
    v_mov_b32 v16, v48
    v_mov_b32 v17, v49
    v_mov_b32 v18, v50
    v_mov_b32 v19, v51
    v_mov_b32 v20, v52
    v_mov_b32 v21, v53
    v_mov_b32 v22, v54
    v_mov_b32 v23, v55
    s_branch M_q_nd
M_q_e1:
    s_barrier
    s_add_u32 s28, s68, 131072
    buffer_store_dwordx4 v[104:107], v13, s[8:11], s68 offen sc1
    buffer_store_dwordx4 v[108:111], v13, s[8:11], s28 offen sc1
    s_mov_b32 exec_hi, 0
    buffer_store_dwordx2 v[20:21], v7, s[8:11], s67 offen sc1
    s_mov_b32 exec_lo, 0x000f000f
    buffer_store_dwordx2 v[22:23], v7, s[8:11], s67 offen offset:256 sc1
    s_mov_b64 exec, -1
M_bphase:
    s_mov_b32 s16, s98
    s_and_b32 s17, s99, 0xffff
    s_cmp_eq_u32 s101, 1
    s_cbranch_scc1 M_osrd
    s_add_u32 s16, s8, 138412032
    s_addc_u32 s17, s9, 0
M_osrd:
    s_cmp_ge_u32 s82, 1
    s_cbranch_scc1 M_tabok2
    s_cmp_lg_u32 s101, 0
    s_cbranch_scc1 M_b_tp2
    v_lshlrev_b32 v190, 3, v0
    s_mov_b32 exec_hi, 0x0fffffff
    s_mov_b32 s28, 167948288
    s_mov_b32 s30, 0
M_b_tpl:
    buffer_load_dword v191, v190, s[8:11], s28 offen sc1
    s_add_u32 s30, s30, 1
    s_cmp_ge_u32 s30, 240000
    s_cbranch_scc1 M_fail
    s_waitcnt vmcnt(0)
    v_cmp_ne_u32 vcc, 0x01010101, v191
    s_cbranch_vccz M_b_tpd
    s_sleep 8
    s_branch M_b_tpl
M_b_tpd:
    s_mov_b64 exec, -1
M_b_tp2:
    s_mul_i32 s29, s83, 10240
    s_add_u32 s29, s29, 0
    s_mul_i32 s28, s88, 81920
    s_add_u32 s28, s28, s29
    s_add_u32 s28, s28, 147849216
    s_mov_b32 m0, s29
    s_nop 0
    buffer_load_dwordx4 v0, s[8:11], s28 offen offset:0 sc1 lds
    buffer_load_dwordx4 v0, s[8:11], s28 offen offset:1024 sc1 lds
    buffer_load_dwordx4 v0, s[8:11], s28 offen offset:2048 sc1 lds
    buffer_load_dwordx4 v0, s[8:11], s28 offen offset:3072 sc1 lds
    s_add_u32 s29, s29, 4096
    s_add_u32 s28, s28, 4096
    s_mov_b32 m0, s29
    s_nop 0
    buffer_load_dwordx4 v0, s[8:11], s28 offen offset:0 sc1 lds
    buffer_load_dwordx4 v0, s[8:11], s28 offen offset:1024 sc1 lds
    buffer_load_dwordx4 v0, s[8:11], s28 offen offset:2048 sc1 lds
    buffer_load_dwordx4 v0, s[8:11], s28 offen offset:3072 sc1 lds
    s_add_u32 s29, s29, 4096
    s_add_u32 s28, s28, 4096
    s_mov_b32 m0, s29
    s_nop 0
    buffer_load_dwordx4 v0, s[8:11], s28 offen offset:0 sc1 lds
    buffer_load_dwordx4 v0, s[8:11], s28 offen offset:1024 sc1 lds
    s_mul_i32 s29, s83, 10240
    s_add_u32 s29, s29, 40960
    s_mul_i32 s28, s88, 81920
    s_add_u32 s28, s28, s29
    s_add_u32 s28, s28, 147849216
    s_mov_b32 m0, s29
    s_nop 0
    buffer_load_dwordx4 v0, s[8:11], s28 offen offset:0 sc1 lds
    buffer_load_dwordx4 v0, s[8:11], s28 offen offset:1024 sc1 lds
    buffer_load_dwordx4 v0, s[8:11], s28 offen offset:2048 sc1 lds
    buffer_load_dwordx4 v0, s[8:11], s28 offen offset:3072 sc1 lds
    s_add_u32 s29, s29, 4096
    s_add_u32 s28, s28, 4096
    s_mov_b32 m0, s29
    s_nop 0
    buffer_load_dwordx4 v0, s[8:11], s28 offen offset:0 sc1 lds
    buffer_load_dwordx4 v0, s[8:11], s28 offen offset:1024 sc1 lds
    buffer_load_dwordx4 v0, s[8:11], s28 offen offset:2048 sc1 lds
    buffer_load_dwordx4 v0, s[8:11], s28 offen offset:3072 sc1 lds
    s_add_u32 s29, s29, 4096
    s_add_u32 s28, s28, 4096
    s_mov_b32 m0, s29
    s_nop 0
    buffer_load_dwordx4 v0, s[8:11], s28 offen offset:0 sc1 lds
    buffer_load_dwordx4 v0, s[8:11], s28 offen offset:1024 sc1 lds
M_tabok2:
    v_mbcnt_lo_u32_b32 v0, -1, 0
    v_mbcnt_hi_u32_b32 v0, -1, v0
    s_lshl_b32 s27, s83, 6
    v_add_u32 v0, s27, v0
    s_mov_b32 s2, s81
    v_lshlrev_b32 v1, 2, v0
    v_and_b32 v102, 63, v0
    v_lshlrev_b32 v102, 4, v102
    v_lshlrev_b32 v2, 6, v0
    s_cmp_lt_u32 s2, 161
    s_cbranch_scc1 M_fft_go
    s_min_u32 s28, s89, 63
    s_lshl_b32 s29, s28, 12
    s_add_u32 s29, s29, 173654016
    v_lshlrev_b32 v190, 3, v102
    s_mov_b32 exec_hi, 0
    buffer_load_dword v191, v190, s[8:11], s29 offen sc1
    s_mov_b64 exec, 1
    s_mul_i32 s28, s28, 40960
    s_lshl_b32 s29, s88, 7
    s_add_u32 s29, s29, s28
    buffer_load_dword v191, v190, s[16:19], s29 offen sc1
    s_lshl_b32 s29, s88, 11
    s_add_u32 s29, s29, s28
    s_add_u32 s29, s29, 32505856
    buffer_load_dword v191, v190, s[8:11], s29 offen sc1
    s_mul_i32 s28, s101, 3145728
    s_min_u32 s29, s2, 159
    s_lshl_b32 s29, s29, 14
    s_add_u32 s28, s28, s29
    s_lshl_b32 s29, s83, 9
    s_add_u32 s28, s28, s29
    s_add_u32 s28, s28, 157286400
    s_cmp_lt_u32 s2, 160
    s_cselect_b32 s28, s28, 0x10000000
    buffer_load_dword v191, v190, s[8:11], s28 offen sc1
    s_mov_b64 exec, -1
    s_branch M_fft_end
M_fft_go:
    s_mov_b32 s26, 0x3f3504f3
    s_mov_b32 s27, s26
    s_lshl_b32 s34, s2, 1
    s_add_u32 s35, s34, 1
    s_cmp_eq_u32 s2, 0
    s_cselect_b32 s35, 320, s35
    s_cmp_eq_u32 s2, 160
    s_cselect_b32 s34, 1, s34
    s_cselect_b32 s35, 1, s35
    s_mul_i32 s21, s101, 6291456
    s_add_u32 s21, s21, 176160768
    s_lshl_b32 s20, s34, 13
    s_add_u32 s20, s20, s21
    s_lshl_b32 s36, s35, 13
    s_add_u32 s36, s36, s21
    s_add_u32 s21, s20, 2621440
    s_add_u32 s37, s36, 2621440
    s_cmp_eq_u32 s2, 0
    s_cselect_b32 s21, 0x10000000, s21
    s_cselect_b32 s37, 0x10000000, s37
    s_add_u32 s22, s20, 4096
    s_add_u32 s23, s21, 4096
    s_add_u32 s38, s36, 4096
    s_add_u32 s39, s37, 4096
    s_cmp_lg_u32 s83, 0
    s_cbranch_scc1 M_dp_29
    v_and_b32 v190, 7, v0
    v_lshlrev_b32 v190, 12, v190
    v_bfe_u32 v191, v0, 3, 1
    v_mul_u32_u24 v191, 1280, v191
    v_add_u32 v190, v190, v191
    s_mov_b64 exec, 0x1f1f
    s_lshr_b32 s31, s34, 5
    s_lshl_b32 s31, s31, 7
    s_add_u32 s31, s31, 167927808
    s_lshl_b32 s32, s101, 2
    s_add_u32 s32, s32, 2
    s_mov_b32 s30, 0
M_dp_30:
    buffer_load_dword v191, v190, s[8:11], s31 offen sc1
    s_add_u32 s30, s30, 1
    s_cmp_ge_u32 s30, 240000
    s_cbranch_scc1 M_fail
    s_sleep 4
    s_waitcnt vmcnt(0)
    v_cmp_gt_u32 vcc, s32, v191
    s_cbranch_vccnz M_dp_30
    s_mov_b64 exec, -1
M_dp_29:
    s_barrier
    buffer_load_dword v8, v1, s[8:11], s20 offen offset:0 sc1
    buffer_load_dword v9, v1, s[8:11], s21 offen offset:0 sc1
    buffer_load_dword v10, v1, s[8:11], s20 offen offset:1024 sc1
    buffer_load_dword v11, v1, s[8:11], s21 offen offset:1024 sc1
    buffer_load_dword v12, v1, s[8:11], s20 offen offset:2048 sc1
    buffer_load_dword v13, v1, s[8:11], s21 offen offset:2048 sc1
    buffer_load_dword v14, v1, s[8:11], s20 offen offset:3072 sc1
    buffer_load_dword v15, v1, s[8:11], s21 offen offset:3072 sc1
    buffer_load_dword v16, v1, s[8:11], s22 offen offset:0 sc1
    buffer_load_dword v17, v1, s[8:11], s23 offen offset:0 sc1
    buffer_load_dword v18, v1, s[8:11], s22 offen offset:1024 sc1
    buffer_load_dword v19, v1, s[8:11], s23 offen offset:1024 sc1
    buffer_load_dword v20, v1, s[8:11], s22 offen offset:2048 sc1
    buffer_load_dword v21, v1, s[8:11], s23 offen offset:2048 sc1
    buffer_load_dword v112, v1, s[8:11], s36 offen offset:0 sc1
    buffer_load_dword v113, v1, s[8:11], s37 offen offset:0 sc1
    buffer_load_dword v114, v1, s[8:11], s36 offen offset:1024 sc1
    buffer_load_dword v115, v1, s[8:11], s37 offen offset:1024 sc1
    buffer_load_dword v116, v1, s[8:11], s36 offen offset:2048 sc1
    buffer_load_dword v117, v1, s[8:11], s37 offen offset:2048 sc1
    buffer_load_dword v118, v1, s[8:11], s36 offen offset:3072 sc1
    buffer_load_dword v119, v1, s[8:11], s37 offen offset:3072 sc1
    buffer_load_dword v120, v1, s[8:11], s38 offen offset:0 sc1
    buffer_load_dword v121, v1, s[8:11], s39 offen offset:0 sc1
    buffer_load_dword v122, v1, s[8:11], s38 offen offset:1024 sc1
    buffer_load_dword v123, v1, s[8:11], s39 offen offset:1024 sc1
    buffer_load_dword v124, v1, s[8:11], s38 offen offset:2048 sc1
    buffer_load_dword v125, v1, s[8:11], s39 offen offset:2048 sc1
    s_lshr_b32 s24, s34, 1
    s_lshl_b32 s24, s24, 14
    s_and_b32 s25, s34, 1
    s_lshl_b32 s25, s25, 4
    s_add_u32 s24, s24, s25
    s_add_u32 s24, s24, 148897792
    buffer_load_dwordx4 v[92:95], v2, s[8:11], s24 offen sc1
    buffer_load_dwordx4 v[96:99], v2, s[8:11], s24 offen offset:32 sc1
    s_lshr_b32 s24, s35, 1
    s_lshl_b32 s24, s24, 14
    s_and_b32 s25, s35, 1
    s_lshl_b32 s25, s25, 4
    s_add_u32 s24, s24, s25
    s_add_u32 s24, s24, 148897792
    buffer_load_dwordx4 v[104:107], v2, s[8:11], s24 offen sc1
    buffer_load_dwordx4 v[108:111], v2, s[8:11], s24 offen offset:32 sc1
    s_min_u32 s28, s89, 63
    s_lshl_b32 s29, s28, 12
    s_add_u32 s29, s29, 173654016
    v_lshlrev_b32 v190, 3, v102
    s_mov_b32 exec_hi, 0
    buffer_load_dword v191, v190, s[8:11], s29 offen sc1
    s_mov_b64 exec, 1
    s_mul_i32 s28, s28, 40960
    s_lshl_b32 s29, s88, 7
    s_add_u32 s29, s29, s28
    buffer_load_dword v191, v190, s[16:19], s29 offen sc1
    s_lshl_b32 s29, s88, 11
    s_add_u32 s29, s29, s28
    s_add_u32 s29, s29, 32505856
    buffer_load_dword v191, v190, s[8:11], s29 offen sc1
    s_mul_i32 s28, s101, 3145728
    s_min_u32 s29, s2, 159
    s_lshl_b32 s29, s29, 14
    s_add_u32 s28, s28, s29
    s_lshl_b32 s29, s83, 9
    s_add_u32 s28, s28, s29
    s_add_u32 s28, s28, 157286400
    s_cmp_lt_u32 s2, 160
    s_cselect_b32 s28, s28, 0x10000000
    buffer_load_dword v191, v190, s[8:11], s28 offen sc1
    s_mov_b64 exec, -1
    v_and_b32 v3, 255, v0
    v_cvt_f32_u32 v3, v3
    v_mul_f32 v4, 0xba000000, v3
    v_cos_f32 v48, v4
    v_sin_f32 v49, v4
    v_mul_f32 v4, 0xba800000, v3
    v_cos_f32 v50, v4
    v_sin_f32 v51, v4
    v_mul_f32 v4, 0xbac00000, v3
    v_cos_f32 v52, v4
    v_sin_f32 v53, v4
    v_mul_f32 v4, 0xbb000000, v3
    v_cos_f32 v54, v4
    v_sin_f32 v55, v4
    v_mul_f32 v4, 0xbb200000, v3
    v_cos_f32 v56, v4
    v_sin_f32 v57, v4
    v_mul_f32 v4, 0xbb400000, v3
    v_cos_f32 v58, v4
    v_sin_f32 v59, v4
    v_mul_f32 v4, 0xbb600000, v3
    v_cos_f32 v60, v4
    v_sin_f32 v61, v4
    v_and_b32 v3, 31, v0
    v_cvt_f32_u32 v3, v3
    v_mul_f32 v4, 0xbb800000, v3
    v_cos_f32 v62, v4
    v_sin_f32 v63, v4
    v_mul_f32 v4, 0xbc000000, v3
    v_cos_f32 v64, v4
    v_sin_f32 v65, v4
    v_mul_f32 v4, 0xbc400000, v3
    v_cos_f32 v66, v4
    v_sin_f32 v67, v4
    v_mul_f32 v4, 0xbc800000, v3
    v_cos_f32 v68, v4
    v_sin_f32 v69, v4
    v_mul_f32 v4, 0xbca00000, v3
    v_cos_f32 v70, v4
    v_sin_f32 v71, v4
    v_mul_f32 v4, 0xbcc00000, v3
    v_cos_f32 v72, v4
    v_sin_f32 v73, v4
    v_mul_f32 v4, 0xbce00000, v3
    v_cos_f32 v74, v4
    v_sin_f32 v75, v4
    v_and_b32 v3, 3, v0
    v_cvt_f32_u32 v3, v3
    v_mul_f32 v4, 0xbd000000, v3
    v_cos_f32 v76, v4
    v_sin_f32 v77, v4
    v_mul_f32 v4, 0xbd800000, v3
    v_cos_f32 v78, v4
    v_sin_f32 v79, v4
    v_mul_f32 v4, 0xbdc00000, v3
    v_cos_f32 v80, v4
    v_sin_f32 v81, v4
    v_mul_f32 v4, 0xbe000000, v3
    v_cos_f32 v82, v4
    v_sin_f32 v83, v4
    v_mul_f32 v4, 0xbe200000, v3
    v_cos_f32 v84, v4
    v_sin_f32 v85, v4
    v_mul_f32 v4, 0xbe400000, v3
    v_cos_f32 v86, v4
    v_sin_f32 v87, v4
    v_mul_f32 v4, 0xbe600000, v3
    v_cos_f32 v88, v4
    v_sin_f32 v89, v4
    v_lshlrev_b32 v3, 3, v0
    v_lshrrev_b32 v4, 5, v0
    v_mul_u32_u24 v4, 2304, v4
    v_add_u32 v3, 81920, v3
    v_add_u32 v4, 81920, v4
    v_and_b32 v5, 31, v0
    v_lshl_add_u32 v5, v5, 3, v4
    v_bfe_u32 v6, v0, 2, 3
    v_mul_u32_u24 v6, 288, v6
    v_add_u32 v6, v6, v4
    v_and_b32 v7, 3, v0
    v_lshl_add_u32 v100, v7, 6, v6
    v_lshl_add_u32 v6, v7, 3, v6
    v_and_b32 v101, 0xe0, v0
    v_and_b32 v7, 15, v0
    v_lshl_add_u32 v101, v7, 1, v101
    v_bfe_u32 v7, v0, 4, 1
    v_add_u32 v101, v101, v7
    v_lshlrev_b32 v101, 3, v101
    s_waitcnt vmcnt(0)
    s_cmp_lg_u32 s83, 0
    s_cbranch_scc1 M_dp_31
    v_and_b32 v190, 7, v0
    v_lshlrev_b32 v190, 12, v190
    v_bfe_u32 v191, v0, 3, 1
    v_mul_u32_u24 v191, 1280, v191
    v_add_u32 v190, v190, v191
    s_mov_b64 exec, 0x1f1f
    s_lshr_b32 s31, s34, 5
    s_lshl_b32 s31, s31, 7
    s_add_u32 s31, s31, 167927808
    s_lshl_b32 s32, s101, 2
    s_add_u32 s32, s32, 3
    s_mov_b32 s30, 0
M_dp_32:
    buffer_load_dword v191, v190, s[8:11], s31 offen sc1
    s_add_u32 s30, s30, 1
    s_cmp_ge_u32 s30, 240000
    s_cbranch_scc1 M_fail
    s_waitcnt vmcnt(0)
    v_cmp_gt_u32 vcc, s32, v191
    s_cbranch_vccnz M_dp_32
    s_mov_b64 exec, -1
M_dp_31:
    s_barrier
    buffer_load_dword v22, v1, s[8:11], s22 offen offset:3072 sc1
    buffer_load_dword v23, v1, s[8:11], s23 offen offset:3072 sc1
    buffer_load_dword v126, v1, s[8:11], s38 offen offset:3072 sc1
    buffer_load_dword v127, v1, s[8:11], s39 offen offset:3072 sc1
    v_pk_add_f32 v[24:25], v[8:9], v[16:17]
    v_pk_add_f32 v[26:27], v[8:9], v[16:17] neg_lo:[0,1] neg_hi:[0,1]
    v_pk_add_f32 v[28:29], v[10:11], v[18:19]
    v_pk_add_f32 v[30:31], v[10:11], v[18:19] neg_lo:[0,1] neg_hi:[0,1]
    v_pk_add_f32 v[32:33], v[12:13], v[20:21]
    v_pk_add_f32 v[34:35], v[12:13], v[20:21] neg_lo:[0,1] neg_hi:[0,1]
    s_waitcnt vmcnt(2)
    v_pk_add_f32 v[36:37], v[14:15], v[22:23]
    v_pk_add_f32 v[38:39], v[14:15], v[22:23] neg_lo:[0,1] neg_hi:[0,1]
    v_pk_add_f32 v[40:41], v[24:25], v[32:33]
    v_pk_add_f32 v[42:43], v[24:25], v[32:33] neg_lo:[0,1] neg_hi:[0,1]
    v_pk_add_f32 v[44:45], v[28:29], v[36:37]
    v_pk_add_f32 v[46:47], v[28:29], v[36:37] neg_lo:[0,1] neg_hi:[0,1]
    v_pk_add_f32 v[8:9], v[40:41], v[44:45]
    v_pk_add_f32 v[16:17], v[40:41], v[44:45] neg_lo:[0,1] neg_hi:[0,1]
    v_pk_add_f32 v[10:11], v[42:43], v[46:47] op_sel:[0,1] op_sel_hi:[1,0] neg_lo:[0,0] neg_hi:[0,1]
    v_pk_add_f32 v[18:19], v[42:43], v[46:47] op_sel:[0,1] op_sel_hi:[1,0] neg_lo:[0,1] neg_hi:[0,0]
    v_pk_add_f32 v[12:13], v[30:31], v[30:31] op_sel:[0,1] op_sel_hi:[1,0] neg_lo:[0,0] neg_hi:[0,1]
    v_pk_add_f32 v[20:21], v[38:39], v[38:39] op_sel:[0,1] op_sel_hi:[1,0] neg_lo:[1,0] neg_hi:[1,1]
    v_pk_add_f32 v[14:15], v[26:27], v[34:35] op_sel:[0,1] op_sel_hi:[1,0] neg_lo:[0,0] neg_hi:[0,1]
    v_pk_add_f32 v[22:23], v[26:27], v[34:35] op_sel:[0,1] op_sel_hi:[1,0] neg_lo:[0,1] neg_hi:[0,0]
    v_pk_add_f32 v[24:25], v[12:13], v[20:21]
    v_pk_add_f32 v[28:29], v[12:13], v[20:21] neg_lo:[0,1] neg_hi:[0,1]
    v_pk_fma_f32 v[32:33], v[24:25], s[26:27], v[14:15] neg_lo:[0,0,0] neg_hi:[0,0,0]
    v_pk_fma_f32 v[36:37], v[24:25], s[26:27], v[14:15] neg_lo:[1,0,0] neg_hi:[1,0,0]
    v_pk_fma_f32 v[40:41], v[28:29], s[26:27], v[22:23] op_sel:[1,0,0] op_sel_hi:[0,1,1] neg_lo:[0,0,0] neg_hi:[1,0,0]
    v_pk_fma_f32 v[42:43], v[28:29], s[26:27], v[22:23] op_sel:[1,0,0] op_sel_hi:[0,1,1] neg_lo:[1,0,0] neg_hi:[0,0,0]
    v_pk_mul_f32 v[44:45], v[32:33], v[48:49] op_sel:[0,0] op_sel_hi:[1,0]
    v_pk_mul_f32 v[46:47], v[10:11], v[50:51] op_sel:[0,0] op_sel_hi:[1,0]
    v_pk_mul_f32 v[26:27], v[40:41], v[52:53] op_sel:[0,0] op_sel_hi:[1,0]
    v_pk_mul_f32 v[30:31], v[16:17], v[54:55] op_sel:[0,0] op_sel_hi:[1,0]
    v_pk_mul_f32 v[34:35], v[36:37], v[56:57] op_sel:[0,0] op_sel_hi:[1,0]
    v_pk_mul_f32 v[38:39], v[18:19], v[58:59] op_sel:[0,0] op_sel_hi:[1,0]
    v_pk_mul_f32 v[12:13], v[42:43], v[60:61] op_sel:[0,0] op_sel_hi:[1,0]
    v_pk_fma_f32 v[44:45], v[32:33], v[48:49], v[44:45] op_sel:[1,1,0] op_sel_hi:[0,1,1] neg_lo:[1,0,0] neg_hi:[0,0,0]
    v_pk_fma_f32 v[46:47], v[10:11], v[50:51], v[46:47] op_sel:[1,1,0] op_sel_hi:[0,1,1] neg_lo:[1,0,0] neg_hi:[0,0,0]
    v_pk_fma_f32 v[26:27], v[40:41], v[52:53], v[26:27] op_sel:[1,1,0] op_sel_hi:[0,1,1] neg_lo:[1,0,0] neg_hi:[0,0,0]
    v_pk_fma_f32 v[30:31], v[16:17], v[54:55], v[30:31] op_sel:[1,1,0] op_sel_hi:[0,1,1] neg_lo:[1,0,0] neg_hi:[0,0,0]
    v_pk_fma_f32 v[34:35], v[36:37], v[56:57], v[34:35] op_sel:[1,1,0] op_sel_hi:[0,1,1] neg_lo:[1,0,0] neg_hi:[0,0,0]
    v_pk_fma_f32 v[38:39], v[18:19], v[58:59], v[38:39] op_sel:[1,1,0] op_sel_hi:[0,1,1] neg_lo:[1,0,0] neg_hi:[0,0,0]
    v_pk_fma_f32 v[12:13], v[42:43], v[60:61], v[12:13] op_sel:[1,1,0] op_sel_hi:[0,1,1] neg_lo:[1,0,0] neg_hi:[0,0,0]
    ds_write_b64 v3, v[8:9] offset:0
    v_pk_add_f32 v[128:129], v[112:113], v[120:121]
    v_pk_add_f32 v[130:131], v[112:113], v[120:121] neg_lo:[0,1] neg_hi:[0,1]
    v_pk_add_f32 v[132:133], v[114:115], v[122:123]
    ds_write_b64 v3, v[44:45] offset:2304
    v_pk_add_f32 v[134:135], v[114:115], v[122:123] neg_lo:[0,1] neg_hi:[0,1]
    v_pk_add_f32 v[136:137], v[116:117], v[124:125]
    v_pk_add_f32 v[138:139], v[116:117], v[124:125] neg_lo:[0,1] neg_hi:[0,1]
    ds_write_b64 v3, v[46:47] offset:4608
    s_waitcnt vmcnt(0)
    v_pk_add_f32 v[140:141], v[118:119], v[126:127]
    v_pk_add_f32 v[142:143], v[118:119], v[126:127] neg_lo:[0,1] neg_hi:[0,1]
    v_pk_add_f32 v[144:145], v[128:129], v[136:137]
    ds_write_b64 v3, v[26:27] offset:6912
    v_pk_add_f32 v[146:147], v[128:129], v[136:137] neg_lo:[0,1] neg_hi:[0,1]
    v_pk_add_f32 v[148:149], v[132:133], v[140:141]
    v_pk_add_f32 v[150:151], v[132:133], v[140:141] neg_lo:[0,1] neg_hi:[0,1]
    ds_write_b64 v3, v[30:31] offset:9216
    v_pk_add_f32 v[112:113], v[144:145], v[148:149]
    v_pk_add_f32 v[120:121], v[144:145], v[148:149] neg_lo:[0,1] neg_hi:[0,1]
    v_pk_add_f32 v[114:115], v[146:147], v[150:151] op_sel:[0,1] op_sel_hi:[1,0] neg_lo:[0,0] neg_hi:[0,1]
    ds_write_b64 v3, v[34:35] offset:11520
    v_pk_add_f32 v[122:123], v[146:147], v[150:151] op_sel:[0,1] op_sel_hi:[1,0] neg_lo:[0,1] neg_hi:[0,0]
    v_pk_add_f32 v[116:117], v[134:135], v[134:135] op_sel:[0,1] op_sel_hi:[1,0] neg_lo:[0,0] neg_hi:[0,1]
    v_pk_add_f32 v[124:125], v[142:143], v[142:143] op_sel:[0,1] op_sel_hi:[1,0] neg_lo:[1,0] neg_hi:[1,1]
    ds_write_b64 v3, v[38:39] offset:13824
    v_pk_add_f32 v[118:119], v[130:131], v[138:139] op_sel:[0,1] op_sel_hi:[1,0] neg_lo:[0,0] neg_hi:[0,1]
    v_pk_add_f32 v[126:127], v[130:131], v[138:139] op_sel:[0,1] op_sel_hi:[1,0] neg_lo:[0,1] neg_hi:[0,0]
    v_pk_add_f32 v[128:129], v[116:117], v[124:125]
    ds_write_b64 v3, v[12:13] offset:16128
    v_pk_add_f32 v[132:133], v[116:117], v[124:125] neg_lo:[0,1] neg_hi:[0,1]
    v_pk_fma_f32 v[136:137], v[128:129], s[26:27], v[118:119] neg_lo:[0,0,0] neg_hi:[0,0,0]
    v_pk_fma_f32 v[140:141], v[128:129], s[26:27], v[118:119] neg_lo:[1,0,0] neg_hi:[1,0,0]
    v_pk_fma_f32 v[144:145], v[132:133], s[26:27], v[126:127] op_sel:[1,0,0] op_sel_hi:[0,1,1] neg_lo:[0,0,0] neg_hi:[1,0,0]
    v_pk_fma_f32 v[146:147], v[132:133], s[26:27], v[126:127] op_sel:[1,0,0] op_sel_hi:[0,1,1] neg_lo:[1,0,0] neg_hi:[0,0,0]
    v_pk_mul_f32 v[148:149], v[136:137], v[48:49] op_sel:[0,0] op_sel_hi:[1,0]
    v_pk_mul_f32 v[150:151], v[114:115], v[50:51] op_sel:[0,0] op_sel_hi:[1,0]
    v_pk_mul_f32 v[130:131], v[144:145], v[52:53] op_sel:[0,0] op_sel_hi:[1,0]
    v_pk_mul_f32 v[134:135], v[120:121], v[54:55] op_sel:[0,0] op_sel_hi:[1,0]
    v_pk_mul_f32 v[138:139], v[140:141], v[56:57] op_sel:[0,0] op_sel_hi:[1,0]
    v_pk_mul_f32 v[142:143], v[122:123], v[58:59] op_sel:[0,0] op_sel_hi:[1,0]
    v_pk_mul_f32 v[116:117], v[146:147], v[60:61] op_sel:[0,0] op_sel_hi:[1,0]
    v_pk_fma_f32 v[148:149], v[136:137], v[48:49], v[148:149] op_sel:[1,1,0] op_sel_hi:[0,1,1] neg_lo:[1,0,0] neg_hi:[0,0,0]
    v_pk_fma_f32 v[150:151], v[114:115], v[50:51], v[150:151] op_sel:[1,1,0] op_sel_hi:[0,1,1] neg_lo:[1,0,0] neg_hi:[0,0,0]
    v_pk_fma_f32 v[130:131], v[144:145], v[52:53], v[130:131] op_sel:[1,1,0] op_sel_hi:[0,1,1] neg_lo:[1,0,0] neg_hi:[0,0,0]
    v_pk_fma_f32 v[134:135], v[120:121], v[54:55], v[134:135] op_sel:[1,1,0] op_sel_hi:[0,1,1] neg_lo:[1,0,0] neg_hi:[0,0,0]
    v_pk_fma_f32 v[138:139], v[140:141], v[56:57], v[138:139] op_sel:[1,1,0] op_sel_hi:[0,1,1] neg_lo:[1,0,0] neg_hi:[0,0,0]
    v_pk_fma_f32 v[142:143], v[122:123], v[58:59], v[142:143] op_sel:[1,1,0] op_sel_hi:[0,1,1] neg_lo:[1,0,0] neg_hi:[0,0,0]
    v_pk_fma_f32 v[116:117], v[146:147], v[60:61], v[116:117] op_sel:[1,1,0] op_sel_hi:[0,1,1] neg_lo:[1,0,0] neg_hi:[0,0,0]
    ds_write_b64 v3, v[112:113] offset:18432
    ds_write_b64 v3, v[148:149] offset:20736
    ds_write_b64 v3, v[150:151] offset:23040
    ds_write_b64 v3, v[130:131] offset:25344
    ds_write_b64 v3, v[134:135] offset:27648
    ds_write_b64 v3, v[138:139] offset:29952
    ds_write_b64 v3, v[142:143] offset:32256
    ds_write_b64 v3, v[116:117] offset:34560
    s_waitcnt lgkmcnt(0)
    s_barrier
    ds_read_b64 v[20:21], v5 offset:0
    ds_read_b64 v[14:15], v5 offset:256
    ds_read_b64 v[22:23], v5 offset:512
    ds_read_b64 v[24:25], v5 offset:768
    ds_read_b64 v[28:29], v5 offset:1024
    ds_read_b64 v[32:33], v5 offset:1280
    ds_read_b64 v[10:11], v5 offset:1536
    ds_read_b64 v[40:41], v5 offset:1792
    ds_read_b64 v[124:125], v5 offset:18432
    ds_read_b64 v[118:119], v5 offset:18688
    ds_read_b64 v[126:127], v5 offset:18944
    ds_read_b64 v[128:129], v5 offset:19200
    ds_read_b64 v[132:133], v5 offset:19456
    ds_read_b64 v[136:137], v5 offset:19712
    ds_read_b64 v[114:115], v5 offset:19968
    ds_read_b64 v[144:145], v5 offset:20224
    s_waitcnt lgkmcnt(11)
    v_pk_add_f32 v[16:17], v[20:21], v[28:29]
    v_pk_add_f32 v[36:37], v[20:21], v[28:29] neg_lo:[0,1] neg_hi:[0,1]
    s_waitcnt lgkmcnt(10)
    v_pk_add_f32 v[18:19], v[14:15], v[32:33]
    v_pk_add_f32 v[42:43], v[14:15], v[32:33] neg_lo:[0,1] neg_hi:[0,1]
    s_waitcnt lgkmcnt(9)
    v_pk_add_f32 v[8:9], v[22:23], v[10:11]
    v_pk_add_f32 v[44:45], v[22:23], v[10:11] neg_lo:[0,1] neg_hi:[0,1]
    s_waitcnt lgkmcnt(8)
    v_pk_add_f32 v[46:47], v[24:25], v[40:41]
    v_pk_add_f32 v[26:27], v[24:25], v[40:41] neg_lo:[0,1] neg_hi:[0,1]
    v_pk_add_f32 v[30:31], v[16:17], v[8:9]
    v_pk_add_f32 v[34:35], v[16:17], v[8:9] neg_lo:[0,1] neg_hi:[0,1]
    v_pk_add_f32 v[38:39], v[18:19], v[46:47]
    v_pk_add_f32 v[12:13], v[18:19], v[46:47] neg_lo:[0,1] neg_hi:[0,1]
    v_pk_add_f32 v[20:21], v[30:31], v[38:39]
    v_pk_add_f32 v[28:29], v[30:31], v[38:39] neg_lo:[0,1] neg_hi:[0,1]
    v_pk_add_f32 v[14:15], v[34:35], v[12:13] op_sel:[0,1] op_sel_hi:[1,0] neg_lo:[0,0] neg_hi:[0,1]
    v_pk_add_f32 v[32:33], v[34:35], v[12:13] op_sel:[0,1] op_sel_hi:[1,0] neg_lo:[0,1] neg_hi:[0,0]
    v_pk_add_f32 v[22:23], v[42:43], v[42:43] op_sel:[0,1] op_sel_hi:[1,0] neg_lo:[0,0] neg_hi:[0,1]
    v_pk_add_f32 v[10:11], v[26:27], v[26:27] op_sel:[0,1] op_sel_hi:[1,0] neg_lo:[1,0] neg_hi:[1,1]
    v_pk_add_f32 v[24:25], v[36:37], v[44:45] op_sel:[0,1] op_sel_hi:[1,0] neg_lo:[0,0] neg_hi:[0,1]
    v_pk_add_f32 v[40:41], v[36:37], v[44:45] op_sel:[0,1] op_sel_hi:[1,0] neg_lo:[0,1] neg_hi:[0,0]
    v_pk_add_f32 v[16:17], v[22:23], v[10:11]
    v_pk_add_f32 v[18:19], v[22:23], v[10:11] neg_lo:[0,1] neg_hi:[0,1]
    v_pk_fma_f32 v[8:9], v[16:17], s[26:27], v[24:25] neg_lo:[0,0,0] neg_hi:[0,0,0]
    v_pk_fma_f32 v[46:47], v[16:17], s[26:27], v[24:25] neg_lo:[1,0,0] neg_hi:[1,0,0]
    v_pk_fma_f32 v[30:31], v[18:19], s[26:27], v[40:41] op_sel:[1,0,0] op_sel_hi:[0,1,1] neg_lo:[0,0,0] neg_hi:[1,0,0]
    v_pk_fma_f32 v[34:35], v[18:19], s[26:27], v[40:41] op_sel:[1,0,0] op_sel_hi:[0,1,1] neg_lo:[1,0,0] neg_hi:[0,0,0]
    v_pk_mul_f32 v[38:39], v[8:9], v[62:63] op_sel:[0,0] op_sel_hi:[1,0]
    v_pk_mul_f32 v[12:13], v[14:15], v[64:65] op_sel:[0,0] op_sel_hi:[1,0]
    v_pk_mul_f32 v[36:37], v[30:31], v[66:67] op_sel:[0,0] op_sel_hi:[1,0]
    v_pk_mul_f32 v[42:43], v[28:29], v[68:69] op_sel:[0,0] op_sel_hi:[1,0]
    v_pk_mul_f32 v[44:45], v[46:47], v[70:71] op_sel:[0,0] op_sel_hi:[1,0]
    v_pk_mul_f32 v[26:27], v[32:33], v[72:73] op_sel:[0,0] op_sel_hi:[1,0]
    v_pk_mul_f32 v[22:23], v[34:35], v[74:75] op_sel:[0,0] op_sel_hi:[1,0]
    v_pk_fma_f32 v[38:39], v[8:9], v[62:63], v[38:39] op_sel:[1,1,0] op_sel_hi:[0,1,1] neg_lo:[1,0,0] neg_hi:[0,0,0]
    v_pk_fma_f32 v[12:13], v[14:15], v[64:65], v[12:13] op_sel:[1,1,0] op_sel_hi:[0,1,1] neg_lo:[1,0,0] neg_hi:[0,0,0]
    v_pk_fma_f32 v[36:37], v[30:31], v[66:67], v[36:37] op_sel:[1,1,0] op_sel_hi:[0,1,1] neg_lo:[1,0,0] neg_hi:[0,0,0]
    v_pk_fma_f32 v[42:43], v[28:29], v[68:69], v[42:43] op_sel:[1,1,0] op_sel_hi:[0,1,1] neg_lo:[1,0,0] neg_hi:[0,0,0]
    v_pk_fma_f32 v[44:45], v[46:47], v[70:71], v[44:45] op_sel:[1,1,0] op_sel_hi:[0,1,1] neg_lo:[1,0,0] neg_hi:[0,0,0]
    v_pk_fma_f32 v[26:27], v[32:33], v[72:73], v[26:27] op_sel:[1,1,0] op_sel_hi:[0,1,1] neg_lo:[1,0,0] neg_hi:[0,0,0]
    v_pk_fma_f32 v[22:23], v[34:35], v[74:75], v[22:23] op_sel:[1,1,0] op_sel_hi:[0,1,1] neg_lo:[1,0,0] neg_hi:[0,0,0]
    ds_write_b64 v5, v[20:21] offset:0
    s_waitcnt lgkmcnt(4)
    v_pk_add_f32 v[120:121], v[124:125], v[132:133]
    v_pk_add_f32 v[140:141], v[124:125], v[132:133] neg_lo:[0,1] neg_hi:[0,1]
    s_waitcnt lgkmcnt(3)
    v_pk_add_f32 v[122:123], v[118:119], v[136:137]
    ds_write_b64 v5, v[38:39] offset:288
    v_pk_add_f32 v[146:147], v[118:119], v[136:137] neg_lo:[0,1] neg_hi:[0,1]
    s_waitcnt lgkmcnt(3)
    v_pk_add_f32 v[112:113], v[126:127], v[114:115]
    v_pk_add_f32 v[148:149], v[126:127], v[114:115] neg_lo:[0,1] neg_hi:[0,1]
    ds_write_b64 v5, v[12:13] offset:576
    s_waitcnt lgkmcnt(3)
    v_pk_add_f32 v[150:151], v[128:129], v[144:145]
    v_pk_add_f32 v[130:131], v[128:129], v[144:145] neg_lo:[0,1] neg_hi:[0,1]
    v_pk_add_f32 v[134:135], v[120:121], v[112:113]
    ds_write_b64 v5, v[36:37] offset:864
    v_pk_add_f32 v[138:139], v[120:121], v[112:113] neg_lo:[0,1] neg_hi:[0,1]
    v_pk_add_f32 v[142:143], v[122:123], v[150:151]
    v_pk_add_f32 v[116:117], v[122:123], v[150:151] neg_lo:[0,1] neg_hi:[0,1]
    ds_write_b64 v5, v[42:43] offset:1152
    v_pk_add_f32 v[124:125], v[134:135], v[142:143]
    v_pk_add_f32 v[132:133], v[134:135], v[142:143] neg_lo:[0,1] neg_hi:[0,1]
    v_pk_add_f32 v[118:119], v[138:139], v[116:117] op_sel:[0,1] op_sel_hi:[1,0] neg_lo:[0,0] neg_hi:[0,1]
    ds_write_b64 v5, v[44:45] offset:1440
    v_pk_add_f32 v[136:137], v[138:139], v[116:117] op_sel:[0,1] op_sel_hi:[1,0] neg_lo:[0,1] neg_hi:[0,0]
    v_pk_add_f32 v[126:127], v[146:147], v[146:147] op_sel:[0,1] op_sel_hi:[1,0] neg_lo:[0,0] neg_hi:[0,1]
    v_pk_add_f32 v[114:115], v[130:131], v[130:131] op_sel:[0,1] op_sel_hi:[1,0] neg_lo:[1,0] neg_hi:[1,1]
    ds_write_b64 v5, v[26:27] offset:1728
    v_pk_add_f32 v[128:129], v[140:141], v[148:149] op_sel:[0,1] op_sel_hi:[1,0] neg_lo:[0,0] neg_hi:[0,1]
    v_pk_add_f32 v[144:145], v[140:141], v[148:149] op_sel:[0,1] op_sel_hi:[1,0] neg_lo:[0,1] neg_hi:[0,0]
    v_pk_add_f32 v[120:121], v[126:127], v[114:115]
    ds_write_b64 v5, v[22:23] offset:2016
    v_pk_add_f32 v[122:123], v[126:127], v[114:115] neg_lo:[0,1] neg_hi:[0,1]
    v_pk_fma_f32 v[112:113], v[120:121], s[26:27], v[128:129] neg_lo:[0,0,0] neg_hi:[0,0,0]
    ds_read_b64 v[10:11], v6 offset:0
    v_pk_fma_f32 v[150:151], v[120:121], s[26:27], v[128:129] neg_lo:[1,0,0] neg_hi:[1,0,0]
    v_pk_fma_f32 v[134:135], v[122:123], s[26:27], v[144:145] op_sel:[1,0,0] op_sel_hi:[0,1,1] neg_lo:[0,0,0] neg_hi:[1,0,0]
    ds_read_b64 v[24:25], v6 offset:32
    v_pk_fma_f32 v[138:139], v[122:123], s[26:27], v[144:145] op_sel:[1,0,0] op_sel_hi:[0,1,1] neg_lo:[1,0,0] neg_hi:[0,0,0]
    v_pk_mul_f32 v[142:143], v[112:113], v[62:63] op_sel:[0,0] op_sel_hi:[1,0]
    ds_read_b64 v[40:41], v6 offset:64
    v_pk_mul_f32 v[116:117], v[118:119], v[64:65] op_sel:[0,0] op_sel_hi:[1,0]
    v_pk_mul_f32 v[140:141], v[134:135], v[66:67] op_sel:[0,0] op_sel_hi:[1,0]
    ds_read_b64 v[16:17], v6 offset:96
    v_pk_mul_f32 v[146:147], v[132:133], v[68:69] op_sel:[0,0] op_sel_hi:[1,0]
    v_pk_mul_f32 v[148:149], v[150:151], v[70:71] op_sel:[0,0] op_sel_hi:[1,0]
    ds_read_b64 v[18:19], v6 offset:128
    v_pk_mul_f32 v[130:131], v[136:137], v[72:73] op_sel:[0,0] op_sel_hi:[1,0]
    v_pk_mul_f32 v[126:127], v[138:139], v[74:75] op_sel:[0,0] op_sel_hi:[1,0]
    ds_read_b64 v[8:9], v6 offset:160
    v_pk_fma_f32 v[142:143], v[112:113], v[62:63], v[142:143] op_sel:[1,1,0] op_sel_hi:[0,1,1] neg_lo:[1,0,0] neg_hi:[0,0,0]
    v_pk_fma_f32 v[116:117], v[118:119], v[64:65], v[116:117] op_sel:[1,1,0] op_sel_hi:[0,1,1] neg_lo:[1,0,0] neg_hi:[0,0,0]
    ds_read_b64 v[14:15], v6 offset:192
    v_pk_fma_f32 v[140:141], v[134:135], v[66:67], v[140:141] op_sel:[1,1,0] op_sel_hi:[0,1,1] neg_lo:[1,0,0] neg_hi:[0,0,0]
    v_pk_fma_f32 v[146:147], v[132:133], v[68:69], v[146:147] op_sel:[1,1,0] op_sel_hi:[0,1,1] neg_lo:[1,0,0] neg_hi:[0,0,0]
    ds_read_b64 v[30:31], v6 offset:224
    v_pk_fma_f32 v[148:149], v[150:151], v[70:71], v[148:149] op_sel:[1,1,0] op_sel_hi:[0,1,1] neg_lo:[1,0,0] neg_hi:[0,0,0]
    v_pk_fma_f32 v[130:131], v[136:137], v[72:73], v[130:131] op_sel:[1,1,0] op_sel_hi:[0,1,1] neg_lo:[1,0,0] neg_hi:[0,0,0]
    v_pk_fma_f32 v[126:127], v[138:139], v[74:75], v[126:127] op_sel:[1,1,0] op_sel_hi:[0,1,1] neg_lo:[1,0,0] neg_hi:[0,0,0]
    ds_write_b64 v5, v[124:125] offset:18432
    s_waitcnt lgkmcnt(4)
    v_pk_add_f32 v[28:29], v[10:11], v[18:19]
    v_pk_add_f32 v[46:47], v[10:11], v[18:19] neg_lo:[0,1] neg_hi:[0,1]
    s_waitcnt lgkmcnt(3)
    v_pk_add_f32 v[32:33], v[24:25], v[8:9]
    ds_write_b64 v5, v[142:143] offset:18720
    v_pk_add_f32 v[34:35], v[24:25], v[8:9] neg_lo:[0,1] neg_hi:[0,1]
    s_waitcnt lgkmcnt(3)
    v_pk_add_f32 v[20:21], v[40:41], v[14:15]
    v_pk_add_f32 v[38:39], v[40:41], v[14:15] neg_lo:[0,1] neg_hi:[0,1]
    ds_write_b64 v5, v[116:117] offset:19008
    s_waitcnt lgkmcnt(3)
    v_pk_add_f32 v[12:13], v[16:17], v[30:31]
    v_pk_add_f32 v[36:37], v[16:17], v[30:31] neg_lo:[0,1] neg_hi:[0,1]
    v_pk_add_f32 v[42:43], v[28:29], v[20:21]
    ds_write_b64 v5, v[140:141] offset:19296
    v_pk_add_f32 v[44:45], v[28:29], v[20:21] neg_lo:[0,1] neg_hi:[0,1]
    v_pk_add_f32 v[26:27], v[32:33], v[12:13]
    v_pk_add_f32 v[22:23], v[32:33], v[12:13] neg_lo:[0,1] neg_hi:[0,1]
    ds_write_b64 v5, v[146:147] offset:19584
    v_pk_add_f32 v[10:11], v[42:43], v[26:27]
    v_pk_add_f32 v[18:19], v[42:43], v[26:27] neg_lo:[0,1] neg_hi:[0,1]
    v_pk_add_f32 v[24:25], v[44:45], v[22:23] op_sel:[0,1] op_sel_hi:[1,0] neg_lo:[0,0] neg_hi:[0,1]
    ds_write_b64 v5, v[148:149] offset:19872
    v_pk_add_f32 v[8:9], v[44:45], v[22:23] op_sel:[0,1] op_sel_hi:[1,0] neg_lo:[0,1] neg_hi:[0,0]
    v_pk_add_f32 v[40:41], v[34:35], v[34:35] op_sel:[0,1] op_sel_hi:[1,0] neg_lo:[0,0] neg_hi:[0,1]
    v_pk_add_f32 v[14:15], v[36:37], v[36:37] op_sel:[0,1] op_sel_hi:[1,0] neg_lo:[1,0] neg_hi:[1,1]
    ds_write_b64 v5, v[130:131] offset:20160
    v_pk_add_f32 v[16:17], v[46:47], v[38:39] op_sel:[0,1] op_sel_hi:[1,0] neg_lo:[0,0] neg_hi:[0,1]
    v_pk_add_f32 v[30:31], v[46:47], v[38:39] op_sel:[0,1] op_sel_hi:[1,0] neg_lo:[0,1] neg_hi:[0,0]
    v_pk_add_f32 v[28:29], v[40:41], v[14:15]
    ds_write_b64 v5, v[126:127] offset:20448
    v_pk_add_f32 v[32:33], v[40:41], v[14:15] neg_lo:[0,1] neg_hi:[0,1]
    v_pk_fma_f32 v[20:21], v[28:29], s[26:27], v[16:17] neg_lo:[0,0,0] neg_hi:[0,0,0]
    ds_read_b64 v[114:115], v6 offset:18432
    v_pk_fma_f32 v[12:13], v[28:29], s[26:27], v[16:17] neg_lo:[1,0,0] neg_hi:[1,0,0]
    v_pk_fma_f32 v[42:43], v[32:33], s[26:27], v[30:31] op_sel:[1,0,0] op_sel_hi:[0,1,1] neg_lo:[0,0,0] neg_hi:[1,0,0]
    ds_read_b64 v[128:129], v6 offset:18464
    v_pk_fma_f32 v[44:45], v[32:33], s[26:27], v[30:31] op_sel:[1,0,0] op_sel_hi:[0,1,1] neg_lo:[1,0,0] neg_hi:[0,0,0]
    v_pk_mul_f32 v[26:27], v[20:21], v[76:77] op_sel:[0,0] op_sel_hi:[1,0]
    ds_read_b64 v[144:145], v6 offset:18496
    v_pk_mul_f32 v[22:23], v[24:25], v[78:79] op_sel:[0,0] op_sel_hi:[1,0]
    v_pk_mul_f32 v[46:47], v[42:43], v[80:81] op_sel:[0,0] op_sel_hi:[1,0]
    ds_read_b64 v[120:121], v6 offset:18528
    v_pk_mul_f32 v[34:35], v[18:19], v[82:83] op_sel:[0,0] op_sel_hi:[1,0]
    v_pk_mul_f32 v[38:39], v[12:13], v[84:85] op_sel:[0,0] op_sel_hi:[1,0]
    ds_read_b64 v[122:123], v6 offset:18560
    v_pk_mul_f32 v[36:37], v[8:9], v[86:87] op_sel:[0,0] op_sel_hi:[1,0]
    v_pk_mul_f32 v[40:41], v[44:45], v[88:89] op_sel:[0,0] op_sel_hi:[1,0]
    ds_read_b64 v[112:113], v6 offset:18592
    v_pk_fma_f32 v[26:27], v[20:21], v[76:77], v[26:27] op_sel:[1,1,0] op_sel_hi:[0,1,1] neg_lo:[1,0,0] neg_hi:[0,0,0]
    v_pk_fma_f32 v[22:23], v[24:25], v[78:79], v[22:23] op_sel:[1,1,0] op_sel_hi:[0,1,1] neg_lo:[1,0,0] neg_hi:[0,0,0]
    ds_read_b64 v[118:119], v6 offset:18624
    v_pk_fma_f32 v[46:47], v[42:43], v[80:81], v[46:47] op_sel:[1,1,0] op_sel_hi:[0,1,1] neg_lo:[1,0,0] neg_hi:[0,0,0]
    v_pk_fma_f32 v[34:35], v[18:19], v[82:83], v[34:35] op_sel:[1,1,0] op_sel_hi:[0,1,1] neg_lo:[1,0,0] neg_hi:[0,0,0]
    ds_read_b64 v[134:135], v6 offset:18656
    v_pk_fma_f32 v[38:39], v[12:13], v[84:85], v[38:39] op_sel:[1,1,0] op_sel_hi:[0,1,1] neg_lo:[1,0,0] neg_hi:[0,0,0]
    v_pk_fma_f32 v[36:37], v[8:9], v[86:87], v[36:37] op_sel:[1,1,0] op_sel_hi:[0,1,1] neg_lo:[1,0,0] neg_hi:[0,0,0]
    v_pk_fma_f32 v[40:41], v[44:45], v[88:89], v[40:41] op_sel:[1,1,0] op_sel_hi:[0,1,1] neg_lo:[1,0,0] neg_hi:[0,0,0]
    ds_write_b64 v6, v[10:11] offset:0
    s_waitcnt lgkmcnt(4)
    v_pk_add_f32 v[132:133], v[114:115], v[122:123]
    v_pk_add_f32 v[150:151], v[114:115], v[122:123] neg_lo:[0,1] neg_hi:[0,1]
    s_waitcnt lgkmcnt(3)
    v_pk_add_f32 v[136:137], v[128:129], v[112:113]
    ds_write_b64 v6, v[26:27] offset:32
    v_pk_add_f32 v[138:139], v[128:129], v[112:113] neg_lo:[0,1] neg_hi:[0,1]
    s_waitcnt lgkmcnt(3)
    v_pk_add_f32 v[124:125], v[144:145], v[118:119]
    v_pk_add_f32 v[142:143], v[144:145], v[118:119] neg_lo:[0,1] neg_hi:[0,1]
    ds_write_b64 v6, v[22:23] offset:64
    s_waitcnt lgkmcnt(3)
    v_pk_add_f32 v[116:117], v[120:121], v[134:135]
    v_pk_add_f32 v[140:141], v[120:121], v[134:135] neg_lo:[0,1] neg_hi:[0,1]
    v_pk_add_f32 v[146:147], v[132:133], v[124:125]
    ds_write_b64 v6, v[46:47] offset:96
    v_pk_add_f32 v[148:149], v[132:133], v[124:125] neg_lo:[0,1] neg_hi:[0,1]
    v_pk_add_f32 v[130:131], v[136:137], v[116:117]
    v_pk_add_f32 v[126:127], v[136:137], v[116:117] neg_lo:[0,1] neg_hi:[0,1]
    ds_write_b64 v6, v[34:35] offset:128
    v_pk_add_f32 v[114:115], v[146:147], v[130:131]
    v_pk_add_f32 v[122:123], v[146:147], v[130:131] neg_lo:[0,1] neg_hi:[0,1]
    v_pk_add_f32 v[128:129], v[148:149], v[126:127] op_sel:[0,1] op_sel_hi:[1,0] neg_lo:[0,0] neg_hi:[0,1]
    ds_write_b64 v6, v[38:39] offset:160
    v_pk_add_f32 v[112:113], v[148:149], v[126:127] op_sel:[0,1] op_sel_hi:[1,0] neg_lo:[0,1] neg_hi:[0,0]
    v_pk_add_f32 v[144:145], v[138:139], v[138:139] op_sel:[0,1] op_sel_hi:[1,0] neg_lo:[0,0] neg_hi:[0,1]
    v_pk_add_f32 v[118:119], v[140:141], v[140:141] op_sel:[0,1] op_sel_hi:[1,0] neg_lo:[1,0] neg_hi:[1,1]
    ds_write_b64 v6, v[36:37] offset:192
    v_pk_add_f32 v[120:121], v[150:151], v[142:143] op_sel:[0,1] op_sel_hi:[1,0] neg_lo:[0,0] neg_hi:[0,1]
    v_pk_add_f32 v[134:135], v[150:151], v[142:143] op_sel:[0,1] op_sel_hi:[1,0] neg_lo:[0,1] neg_hi:[0,0]
    v_pk_add_f32 v[132:133], v[144:145], v[118:119]
    ds_write_b64 v6, v[40:41] offset:224
    v_pk_add_f32 v[136:137], v[144:145], v[118:119] neg_lo:[0,1] neg_hi:[0,1]
    v_pk_fma_f32 v[124:125], v[132:133], s[26:27], v[120:121] neg_lo:[0,0,0] neg_hi:[0,0,0]
    ds_read_b64 v[14:15], v100 offset:0
    v_pk_fma_f32 v[116:117], v[132:133], s[26:27], v[120:121] neg_lo:[1,0,0] neg_hi:[1,0,0]
    v_pk_fma_f32 v[146:147], v[136:137], s[26:27], v[134:135] op_sel:[1,0,0] op_sel_hi:[0,1,1] neg_lo:[0,0,0] neg_hi:[1,0,0]
    ds_read_b64 v[16:17], v100 offset:8
    v_pk_fma_f32 v[148:149], v[136:137], s[26:27], v[134:135] op_sel:[1,0,0] op_sel_hi:[0,1,1] neg_lo:[1,0,0] neg_hi:[0,0,0]
    v_pk_mul_f32 v[130:131], v[124:125], v[76:77] op_sel:[0,0] op_sel_hi:[1,0]
    ds_read_b64 v[30:31], v100 offset:16
    v_pk_mul_f32 v[126:127], v[128:129], v[78:79] op_sel:[0,0] op_sel_hi:[1,0]
    v_pk_mul_f32 v[150:151], v[146:147], v[80:81] op_sel:[0,0] op_sel_hi:[1,0]
    ds_read_b64 v[28:29], v100 offset:24
    v_pk_mul_f32 v[138:139], v[122:123], v[82:83] op_sel:[0,0] op_sel_hi:[1,0]
    v_pk_mul_f32 v[142:143], v[116:117], v[84:85] op_sel:[0,0] op_sel_hi:[1,0]
    ds_read_b64 v[32:33], v100 offset:32
    v_pk_mul_f32 v[140:141], v[112:113], v[86:87] op_sel:[0,0] op_sel_hi:[1,0]
    v_pk_mul_f32 v[144:145], v[148:149], v[88:89] op_sel:[0,0] op_sel_hi:[1,0]
    ds_read_b64 v[20:21], v100 offset:40
    v_pk_fma_f32 v[130:131], v[124:125], v[76:77], v[130:131] op_sel:[1,1,0] op_sel_hi:[0,1,1] neg_lo:[1,0,0] neg_hi:[0,0,0]
    v_pk_fma_f32 v[126:127], v[128:129], v[78:79], v[126:127] op_sel:[1,1,0] op_sel_hi:[0,1,1] neg_lo:[1,0,0] neg_hi:[0,0,0]
    ds_read_b64 v[24:25], v100 offset:48
    v_pk_fma_f32 v[150:151], v[146:147], v[80:81], v[150:151] op_sel:[1,1,0] op_sel_hi:[0,1,1] neg_lo:[1,0,0] neg_hi:[0,0,0]
    v_pk_fma_f32 v[138:139], v[122:123], v[82:83], v[138:139] op_sel:[1,1,0] op_sel_hi:[0,1,1] neg_lo:[1,0,0] neg_hi:[0,0,0]
    ds_read_b64 v[42:43], v100 offset:56
    v_pk_fma_f32 v[142:143], v[116:117], v[84:85], v[142:143] op_sel:[1,1,0] op_sel_hi:[0,1,1] neg_lo:[1,0,0] neg_hi:[0,0,0]
    v_pk_fma_f32 v[140:141], v[112:113], v[86:87], v[140:141] op_sel:[1,1,0] op_sel_hi:[0,1,1] neg_lo:[1,0,0] neg_hi:[0,0,0]
    v_pk_fma_f32 v[144:145], v[148:149], v[88:89], v[144:145] op_sel:[1,1,0] op_sel_hi:[0,1,1] neg_lo:[1,0,0] neg_hi:[0,0,0]
    ds_write_b64 v6, v[114:115] offset:18432
    s_waitcnt lgkmcnt(6)
    v_pk_add_f32 v[18:19], v[14:15], v[30:31]
    v_pk_add_f32 v[12:13], v[14:15], v[30:31] neg_lo:[0,1] neg_hi:[0,1]
    s_waitcnt lgkmcnt(5)
    v_pk_add_f32 v[8:9], v[16:17], v[28:29]
    ds_write_b64 v6, v[130:131] offset:18464
    v_pk_add_f32 v[44:45], v[16:17], v[28:29] neg_lo:[0,1] neg_hi:[0,1]
    v_pk_add_f32 v[10:11], v[18:19], v[8:9]
    v_pk_add_f32 v[26:27], v[18:19], v[8:9] neg_lo:[0,1] neg_hi:[0,1]
    ds_write_b64 v6, v[126:127] offset:18496
    v_pk_add_f32 v[22:23], v[12:13], v[44:45] op_sel:[0,1] op_sel_hi:[1,0] neg_lo:[0,0] neg_hi:[0,1]
    v_pk_add_f32 v[46:47], v[12:13], v[44:45] op_sel:[0,1] op_sel_hi:[1,0] neg_lo:[0,1] neg_hi:[0,0]
    s_waitcnt lgkmcnt(4)
    v_pk_add_f32 v[34:35], v[32:33], v[24:25]
    ds_write_b64 v6, v[150:151] offset:18528
    v_pk_add_f32 v[38:39], v[32:33], v[24:25] neg_lo:[0,1] neg_hi:[0,1]
    s_waitcnt lgkmcnt(4)
    v_pk_add_f32 v[36:37], v[20:21], v[42:43]
    v_pk_add_f32 v[40:41], v[20:21], v[42:43] neg_lo:[0,1] neg_hi:[0,1]
    ds_write_b64 v6, v[138:139] offset:18560
    v_pk_add_f32 v[14:15], v[34:35], v[36:37]
    v_pk_add_f32 v[16:17], v[34:35], v[36:37] neg_lo:[0,1] neg_hi:[0,1]
    v_pk_add_f32 v[30:31], v[38:39], v[40:41] op_sel:[0,1] op_sel_hi:[1,0] neg_lo:[0,0] neg_hi:[0,1]
    ds_write_b64 v6, v[142:143] offset:18592
    v_pk_add_f32 v[28:29], v[38:39], v[40:41] op_sel:[0,1] op_sel_hi:[1,0] neg_lo:[0,1] neg_hi:[0,0]
    v_lshlrev_b32 v18, 16, v92
    v_and_b32 v19, 0xffff0000, v92
    ds_write_b64 v6, v[140:141] offset:18624
    v_lshlrev_b32 v12, 16, v93
    v_and_b32 v13, 0xffff0000, v93
    v_lshlrev_b32 v8, 16, v94
    ds_write_b64 v6, v[144:145] offset:18656
    v_and_b32 v9, 0xffff0000, v94
    v_lshlrev_b32 v44, 16, v95
    ds_read_b64 v[118:119], v100 offset:18432
    v_and_b32 v45, 0xffff0000, v95
    v_pk_mul_f32 v[32:33], v[10:11], v[18:19] op_sel:[0,0] op_sel_hi:[1,0]
    ds_read_b64 v[120:121], v100 offset:18440
    v_pk_mul_f32 v[20:21], v[22:23], v[12:13] op_sel:[0,0] op_sel_hi:[1,0]
    v_pk_mul_f32 v[24:25], v[26:27], v[8:9] op_sel:[0,0] op_sel_hi:[1,0]
    ds_read_b64 v[134:135], v100 offset:18448
    v_pk_mul_f32 v[42:43], v[46:47], v[44:45] op_sel:[0,0] op_sel_hi:[1,0]
    v_pk_fma_f32 v[32:33], v[10:11], v[18:19], v[32:33] op_sel:[1,1,0] op_sel_hi:[0,1,1] neg_lo:[1,0,0] neg_hi:[0,0,0]
    ds_read_b64 v[132:133], v100 offset:18456
    v_pk_fma_f32 v[20:21], v[22:23], v[12:13], v[20:21] op_sel:[1,1,0] op_sel_hi:[0,1,1] neg_lo:[1,0,0] neg_hi:[0,0,0]
    v_pk_fma_f32 v[24:25], v[26:27], v[8:9], v[24:25] op_sel:[1,1,0] op_sel_hi:[0,1,1] neg_lo:[1,0,0] neg_hi:[0,0,0]
    ds_read_b64 v[136:137], v100 offset:18464
    v_pk_fma_f32 v[42:43], v[46:47], v[44:45], v[42:43] op_sel:[1,1,0] op_sel_hi:[0,1,1] neg_lo:[1,0,0] neg_hi:[0,0,0]
    v_lshlrev_b32 v34, 16, v96
    ds_read_b64 v[124:125], v100 offset:18472
    v_and_b32 v35, 0xffff0000, v96
    v_lshlrev_b32 v38, 16, v97
    ds_read_b64 v[128:129], v100 offset:18480
    v_and_b32 v39, 0xffff0000, v97
    v_lshlrev_b32 v36, 16, v98
    ds_read_b64 v[146:147], v100 offset:18488
    v_and_b32 v37, 0xffff0000, v98
    v_lshlrev_b32 v40, 16, v99
    v_and_b32 v41, 0xffff0000, v99
    v_pk_mul_f32 v[10:11], v[14:15], v[34:35] op_sel:[0,0] op_sel_hi:[1,0]
    v_pk_mul_f32 v[22:23], v[30:31], v[38:39] op_sel:[0,0] op_sel_hi:[1,0]
    v_pk_mul_f32 v[26:27], v[16:17], v[36:37] op_sel:[0,0] op_sel_hi:[1,0]
    v_pk_mul_f32 v[46:47], v[28:29], v[40:41] op_sel:[0,0] op_sel_hi:[1,0]
    v_pk_fma_f32 v[10:11], v[14:15], v[34:35], v[10:11] op_sel:[1,1,0] op_sel_hi:[0,1,1] neg_lo:[1,0,0] neg_hi:[0,0,0]
    v_pk_fma_f32 v[22:23], v[30:31], v[38:39], v[22:23] op_sel:[1,1,0] op_sel_hi:[0,1,1] neg_lo:[1,0,0] neg_hi:[0,0,0]
    v_pk_fma_f32 v[26:27], v[16:17], v[36:37], v[26:27] op_sel:[1,1,0] op_sel_hi:[0,1,1] neg_lo:[1,0,0] neg_hi:[0,0,0]
    v_pk_fma_f32 v[46:47], v[28:29], v[40:41], v[46:47] op_sel:[1,1,0] op_sel_hi:[0,1,1] neg_lo:[1,0,0] neg_hi:[0,0,0]
    v_pk_add_f32 v[18:19], v[32:33], v[24:25]
    v_pk_add_f32 v[12:13], v[32:33], v[24:25] neg_lo:[0,1] neg_hi:[0,1]
    v_pk_add_f32 v[8:9], v[20:21], v[42:43]
    v_pk_add_f32 v[44:45], v[20:21], v[42:43] neg_lo:[0,1] neg_hi:[0,1]
    v_pk_add_f32 v[14:15], v[18:19], v[8:9]
    v_pk_add_f32 v[30:31], v[18:19], v[8:9] neg_lo:[0,1] neg_hi:[0,1]
    v_pk_add_f32 v[16:17], v[12:13], v[44:45] op_sel:[0,1] op_sel_hi:[1,0] neg_lo:[0,1] neg_hi:[0,0]
    v_pk_add_f32 v[28:29], v[12:13], v[44:45] op_sel:[0,1] op_sel_hi:[1,0] neg_lo:[0,0] neg_hi:[0,1]
    v_pk_add_f32 v[34:35], v[10:11], v[26:27]
    v_pk_add_f32 v[38:39], v[10:11], v[26:27] neg_lo:[0,1] neg_hi:[0,1]
    v_pk_add_f32 v[36:37], v[22:23], v[46:47]
    v_pk_add_f32 v[40:41], v[22:23], v[46:47] neg_lo:[0,1] neg_hi:[0,1]
    v_pk_add_f32 v[32:33], v[34:35], v[36:37]
    v_pk_add_f32 v[20:21], v[34:35], v[36:37] neg_lo:[0,1] neg_hi:[0,1]
    v_pk_add_f32 v[24:25], v[38:39], v[40:41] op_sel:[0,1] op_sel_hi:[1,0] neg_lo:[0,1] neg_hi:[0,0]
    v_pk_add_f32 v[42:43], v[38:39], v[40:41] op_sel:[0,1] op_sel_hi:[1,0] neg_lo:[0,0] neg_hi:[0,1]
    ds_write_b64 v100, v[14:15] offset:0
    s_waitcnt lgkmcnt(6)
    v_pk_add_f32 v[122:123], v[118:119], v[134:135]
    v_pk_add_f32 v[116:117], v[118:119], v[134:135] neg_lo:[0,1] neg_hi:[0,1]
    s_waitcnt lgkmcnt(5)
    v_pk_add_f32 v[112:113], v[120:121], v[132:133]
    ds_write_b64 v100, v[16:17] offset:8
    v_pk_add_f32 v[148:149], v[120:121], v[132:133] neg_lo:[0,1] neg_hi:[0,1]
    v_pk_add_f32 v[114:115], v[122:123], v[112:113]
    v_pk_add_f32 v[130:131], v[122:123], v[112:113] neg_lo:[0,1] neg_hi:[0,1]
    ds_write_b64 v100, v[30:31] offset:16
    v_pk_add_f32 v[126:127], v[116:117], v[148:149] op_sel:[0,1] op_sel_hi:[1,0] neg_lo:[0,0] neg_hi:[0,1]
    v_pk_add_f32 v[150:151], v[116:117], v[148:149] op_sel:[0,1] op_sel_hi:[1,0] neg_lo:[0,1] neg_hi:[0,0]
    s_waitcnt lgkmcnt(4)
    v_pk_add_f32 v[138:139], v[136:137], v[128:129]
    ds_write_b64 v100, v[28:29] offset:24
    v_pk_add_f32 v[142:143], v[136:137], v[128:129] neg_lo:[0,1] neg_hi:[0,1]
    s_waitcnt lgkmcnt(4)
    v_pk_add_f32 v[140:141], v[124:125], v[146:147]
    v_pk_add_f32 v[144:145], v[124:125], v[146:147] neg_lo:[0,1] neg_hi:[0,1]
    ds_write_b64 v100, v[32:33] offset:32
    v_pk_add_f32 v[118:119], v[138:139], v[140:141]
    v_pk_add_f32 v[120:121], v[138:139], v[140:141] neg_lo:[0,1] neg_hi:[0,1]
    v_pk_add_f32 v[134:135], v[142:143], v[144:145] op_sel:[0,1] op_sel_hi:[1,0] neg_lo:[0,0] neg_hi:[0,1]
    ds_write_b64 v100, v[24:25] offset:40
    v_pk_add_f32 v[132:133], v[142:143], v[144:145] op_sel:[0,1] op_sel_hi:[1,0] neg_lo:[0,1] neg_hi:[0,0]
    v_lshlrev_b32 v122, 16, v104
    v_and_b32 v123, 0xffff0000, v104
    ds_write_b64 v100, v[20:21] offset:48
    v_lshlrev_b32 v116, 16, v105
    v_and_b32 v117, 0xffff0000, v105
    v_lshlrev_b32 v112, 16, v106
    ds_write_b64 v100, v[42:43] offset:56
    v_and_b32 v113, 0xffff0000, v106
    v_lshlrev_b32 v148, 16, v107
    ds_read_b64 v[18:19], v6 offset:0
    v_and_b32 v149, 0xffff0000, v107
    v_pk_mul_f32 v[136:137], v[114:115], v[122:123] op_sel:[0,0] op_sel_hi:[1,0]
    ds_read_b64 v[12:13], v6 offset:32
    v_pk_mul_f32 v[124:125], v[126:127], v[116:117] op_sel:[0,0] op_sel_hi:[1,0]
    v_pk_mul_f32 v[128:129], v[130:131], v[112:113] op_sel:[0,0] op_sel_hi:[1,0]
    ds_read_b64 v[8:9], v6 offset:64
    v_pk_mul_f32 v[146:147], v[150:151], v[148:149] op_sel:[0,0] op_sel_hi:[1,0]
    v_pk_fma_f32 v[136:137], v[114:115], v[122:123], v[136:137] op_sel:[1,1,0] op_sel_hi:[0,1,1] neg_lo:[1,0,0] neg_hi:[0,0,0]
    ds_read_b64 v[44:45], v6 offset:96
    v_pk_fma_f32 v[124:125], v[126:127], v[116:117], v[124:125] op_sel:[1,1,0] op_sel_hi:[0,1,1] neg_lo:[1,0,0] neg_hi:[0,0,0]
    v_pk_fma_f32 v[128:129], v[130:131], v[112:113], v[128:129] op_sel:[1,1,0] op_sel_hi:[0,1,1] neg_lo:[1,0,0] neg_hi:[0,0,0]
    ds_read_b64 v[10:11], v6 offset:128
    v_pk_fma_f32 v[146:147], v[150:151], v[148:149], v[146:147] op_sel:[1,1,0] op_sel_hi:[0,1,1] neg_lo:[1,0,0] neg_hi:[0,0,0]
    v_lshlrev_b32 v138, 16, v108
    ds_read_b64 v[22:23], v6 offset:160
    v_and_b32 v139, 0xffff0000, v108
    v_lshlrev_b32 v142, 16, v109
    ds_read_b64 v[26:27], v6 offset:192
    v_and_b32 v143, 0xffff0000, v109
    v_lshlrev_b32 v140, 16, v110
    ds_read_b64 v[46:47], v6 offset:224
    v_and_b32 v141, 0xffff0000, v110
    v_lshlrev_b32 v144, 16, v111
    v_and_b32 v145, 0xffff0000, v111
    v_pk_mul_f32 v[114:115], v[118:119], v[138:139] op_sel:[0,0] op_sel_hi:[1,0]
    v_pk_mul_f32 v[126:127], v[134:135], v[142:143] op_sel:[0,0] op_sel_hi:[1,0]
    v_pk_mul_f32 v[130:131], v[120:121], v[140:141] op_sel:[0,0] op_sel_hi:[1,0]
    v_pk_mul_f32 v[150:151], v[132:133], v[144:145] op_sel:[0,0] op_sel_hi:[1,0]
    v_pk_fma_f32 v[114:115], v[118:119], v[138:139], v[114:115] op_sel:[1,1,0] op_sel_hi:[0,1,1] neg_lo:[1,0,0] neg_hi:[0,0,0]
    v_pk_fma_f32 v[126:127], v[134:135], v[142:143], v[126:127] op_sel:[1,1,0] op_sel_hi:[0,1,1] neg_lo:[1,0,0] neg_hi:[0,0,0]
    v_pk_fma_f32 v[130:131], v[120:121], v[140:141], v[130:131] op_sel:[1,1,0] op_sel_hi:[0,1,1] neg_lo:[1,0,0] neg_hi:[0,0,0]
    v_pk_fma_f32 v[150:151], v[132:133], v[144:145], v[150:151] op_sel:[1,1,0] op_sel_hi:[0,1,1] neg_lo:[1,0,0] neg_hi:[0,0,0]
    v_pk_add_f32 v[122:123], v[136:137], v[128:129]
    v_pk_add_f32 v[116:117], v[136:137], v[128:129] neg_lo:[0,1] neg_hi:[0,1]
    v_pk_add_f32 v[112:113], v[124:125], v[146:147]
    v_pk_add_f32 v[148:149], v[124:125], v[146:147] neg_lo:[0,1] neg_hi:[0,1]
    v_pk_add_f32 v[118:119], v[122:123], v[112:113]
    v_pk_add_f32 v[134:135], v[122:123], v[112:113] neg_lo:[0,1] neg_hi:[0,1]
    v_pk_add_f32 v[120:121], v[116:117], v[148:149] op_sel:[0,1] op_sel_hi:[1,0] neg_lo:[0,1] neg_hi:[0,0]
    v_pk_add_f32 v[132:133], v[116:117], v[148:149] op_sel:[0,1] op_sel_hi:[1,0] neg_lo:[0,0] neg_hi:[0,1]
    v_pk_add_f32 v[138:139], v[114:115], v[130:131]
    v_pk_add_f32 v[142:143], v[114:115], v[130:131] neg_lo:[0,1] neg_hi:[0,1]
    v_pk_add_f32 v[140:141], v[126:127], v[150:151]
    v_pk_add_f32 v[144:145], v[126:127], v[150:151] neg_lo:[0,1] neg_hi:[0,1]
    v_pk_add_f32 v[136:137], v[138:139], v[140:141]
    v_pk_add_f32 v[124:125], v[138:139], v[140:141] neg_lo:[0,1] neg_hi:[0,1]
    v_pk_add_f32 v[128:129], v[142:143], v[144:145] op_sel:[0,1] op_sel_hi:[1,0] neg_lo:[0,1] neg_hi:[0,0]
    v_pk_add_f32 v[146:147], v[142:143], v[144:145] op_sel:[0,1] op_sel_hi:[1,0] neg_lo:[0,0] neg_hi:[0,1]
    ds_write_b64 v100, v[118:119] offset:18432
    s_waitcnt lgkmcnt(7)
    v_pk_mul_f32 v[34:35], v[12:13], v[76:77] op_sel:[0,0] op_sel_hi:[1,0]
    s_waitcnt lgkmcnt(6)
    v_pk_mul_f32 v[38:39], v[8:9], v[78:79] op_sel:[0,0] op_sel_hi:[1,0]
    s_waitcnt lgkmcnt(5)
    v_pk_mul_f32 v[36:37], v[44:45], v[80:81] op_sel:[0,0] op_sel_hi:[1,0]
    ds_write_b64 v100, v[120:121] offset:18440
    s_waitcnt lgkmcnt(5)
    v_pk_mul_f32 v[40:41], v[10:11], v[82:83] op_sel:[0,0] op_sel_hi:[1,0]
    s_waitcnt lgkmcnt(4)
    v_pk_mul_f32 v[14:15], v[22:23], v[84:85] op_sel:[0,0] op_sel_hi:[1,0]
    s_waitcnt lgkmcnt(3)
    v_pk_mul_f32 v[16:17], v[26:27], v[86:87] op_sel:[0,0] op_sel_hi:[1,0]
    ds_write_b64 v100, v[134:135] offset:18448
    s_waitcnt lgkmcnt(3)
    v_pk_mul_f32 v[30:31], v[46:47], v[88:89] op_sel:[0,0] op_sel_hi:[1,0]
    v_pk_fma_f32 v[34:35], v[12:13], v[76:77], v[34:35] op_sel:[1,1,0] op_sel_hi:[0,1,1] neg_lo:[0,0,0] neg_hi:[1,0,0]
    v_pk_fma_f32 v[38:39], v[8:9], v[78:79], v[38:39] op_sel:[1,1,0] op_sel_hi:[0,1,1] neg_lo:[0,0,0] neg_hi:[1,0,0]
    ds_write_b64 v100, v[132:133] offset:18456
    v_pk_fma_f32 v[36:37], v[44:45], v[80:81], v[36:37] op_sel:[1,1,0] op_sel_hi:[0,1,1] neg_lo:[0,0,0] neg_hi:[1,0,0]
    v_pk_fma_f32 v[40:41], v[10:11], v[82:83], v[40:41] op_sel:[1,1,0] op_sel_hi:[0,1,1] neg_lo:[0,0,0] neg_hi:[1,0,0]
    v_pk_fma_f32 v[14:15], v[22:23], v[84:85], v[14:15] op_sel:[1,1,0] op_sel_hi:[0,1,1] neg_lo:[0,0,0] neg_hi:[1,0,0]
    ds_write_b64 v100, v[136:137] offset:18464
    v_pk_fma_f32 v[16:17], v[26:27], v[86:87], v[16:17] op_sel:[1,1,0] op_sel_hi:[0,1,1] neg_lo:[0,0,0] neg_hi:[1,0,0]
    v_pk_fma_f32 v[30:31], v[46:47], v[88:89], v[30:31] op_sel:[1,1,0] op_sel_hi:[0,1,1] neg_lo:[0,0,0] neg_hi:[1,0,0]
    v_pk_add_f32 v[28:29], v[18:19], v[40:41]
    ds_write_b64 v100, v[128:129] offset:18472
    v_pk_add_f32 v[32:33], v[18:19], v[40:41] neg_lo:[0,1] neg_hi:[0,1]
    v_pk_add_f32 v[24:25], v[34:35], v[14:15]
    v_pk_add_f32 v[20:21], v[34:35], v[14:15] neg_lo:[0,1] neg_hi:[0,1]
    ds_write_b64 v100, v[124:125] offset:18480
    v_pk_add_f32 v[42:43], v[38:39], v[16:17]
    v_pk_add_f32 v[12:13], v[38:39], v[16:17] neg_lo:[0,1] neg_hi:[0,1]
    v_pk_add_f32 v[8:9], v[36:37], v[30:31]
    ds_write_b64 v100, v[146:147] offset:18488
    v_pk_add_f32 v[44:45], v[36:37], v[30:31] neg_lo:[0,1] neg_hi:[0,1]
    v_pk_add_f32 v[10:11], v[28:29], v[42:43]
    ds_read_b64 v[122:123], v6 offset:18432
    v_pk_add_f32 v[22:23], v[28:29], v[42:43] neg_lo:[0,1] neg_hi:[0,1]
    v_pk_add_f32 v[26:27], v[24:25], v[8:9]
    ds_read_b64 v[116:117], v6 offset:18464
    v_pk_add_f32 v[46:47], v[24:25], v[8:9] neg_lo:[0,1] neg_hi:[0,1]
    v_pk_add_f32 v[18:19], v[10:11], v[26:27]
    ds_read_b64 v[112:113], v6 offset:18496
    v_pk_add_f32 v[40:41], v[10:11], v[26:27] neg_lo:[0,1] neg_hi:[0,1]
    v_pk_add_f32 v[34:35], v[22:23], v[46:47] op_sel:[0,1] op_sel_hi:[1,0] neg_lo:[0,1] neg_hi:[0,0]
    ds_read_b64 v[148:149], v6 offset:18528
    v_pk_add_f32 v[14:15], v[22:23], v[46:47] op_sel:[0,1] op_sel_hi:[1,0] neg_lo:[0,0] neg_hi:[0,1]
    v_pk_add_f32 v[38:39], v[20:21], v[20:21] op_sel:[0,1] op_sel_hi:[1,0] neg_lo:[0,1] neg_hi:[0,0]
    ds_read_b64 v[114:115], v6 offset:18560
    v_pk_add_f32 v[16:17], v[44:45], v[44:45] op_sel:[0,1] op_sel_hi:[1,0] neg_lo:[1,1] neg_hi:[1,0]
    v_pk_add_f32 v[36:37], v[32:33], v[12:13] op_sel:[0,1] op_sel_hi:[1,0] neg_lo:[0,1] neg_hi:[0,0]
    ds_read_b64 v[126:127], v6 offset:18592
    v_pk_add_f32 v[30:31], v[32:33], v[12:13] op_sel:[0,1] op_sel_hi:[1,0] neg_lo:[0,0] neg_hi:[0,1]
    v_pk_add_f32 v[28:29], v[38:39], v[16:17]
    ds_read_b64 v[130:131], v6 offset:18624
    v_pk_add_f32 v[24:25], v[38:39], v[16:17] neg_lo:[0,1] neg_hi:[0,1]
    v_pk_fma_f32 v[42:43], v[28:29], s[26:27], v[36:37] neg_lo:[0,0,0] neg_hi:[0,0,0]
    ds_read_b64 v[150:151], v6 offset:18656
    v_pk_fma_f32 v[8:9], v[28:29], s[26:27], v[36:37] neg_lo:[1,0,0] neg_hi:[1,0,0]
    v_pk_fma_f32 v[10:11], v[24:25], s[26:27], v[30:31] op_sel:[1,0,0] op_sel_hi:[0,1,1] neg_lo:[1,0,0] neg_hi:[0,0,0]
    v_pk_fma_f32 v[22:23], v[24:25], s[26:27], v[30:31] op_sel:[1,0,0] op_sel_hi:[0,1,1] neg_lo:[0,0,0] neg_hi:[1,0,0]
    ds_write_b64 v6, v[18:19] offset:0
    s_waitcnt lgkmcnt(7)
    v_pk_mul_f32 v[138:139], v[116:117], v[76:77] op_sel:[0,0] op_sel_hi:[1,0]
    s_waitcnt lgkmcnt(6)
    v_pk_mul_f32 v[142:143], v[112:113], v[78:79] op_sel:[0,0] op_sel_hi:[1,0]
    s_waitcnt lgkmcnt(5)
    v_pk_mul_f32 v[140:141], v[148:149], v[80:81] op_sel:[0,0] op_sel_hi:[1,0]
    ds_write_b64 v6, v[42:43] offset:32
    s_waitcnt lgkmcnt(5)
    v_pk_mul_f32 v[144:145], v[114:115], v[82:83] op_sel:[0,0] op_sel_hi:[1,0]
    s_waitcnt lgkmcnt(4)
    v_pk_mul_f32 v[118:119], v[126:127], v[84:85] op_sel:[0,0] op_sel_hi:[1,0]
    s_waitcnt lgkmcnt(3)
    v_pk_mul_f32 v[120:121], v[130:131], v[86:87] op_sel:[0,0] op_sel_hi:[1,0]
    ds_write_b64 v6, v[34:35] offset:64
    s_waitcnt lgkmcnt(3)
    v_pk_mul_f32 v[134:135], v[150:151], v[88:89] op_sel:[0,0] op_sel_hi:[1,0]
    v_pk_fma_f32 v[138:139], v[116:117], v[76:77], v[138:139] op_sel:[1,1,0] op_sel_hi:[0,1,1] neg_lo:[0,0,0] neg_hi:[1,0,0]
    v_pk_fma_f32 v[142:143], v[112:113], v[78:79], v[142:143] op_sel:[1,1,0] op_sel_hi:[0,1,1] neg_lo:[0,0,0] neg_hi:[1,0,0]
    ds_write_b64 v6, v[10:11] offset:96
    v_pk_fma_f32 v[140:141], v[148:149], v[80:81], v[140:141] op_sel:[1,1,0] op_sel_hi:[0,1,1] neg_lo:[0,0,0] neg_hi:[1,0,0]
    v_pk_fma_f32 v[144:145], v[114:115], v[82:83], v[144:145] op_sel:[1,1,0] op_sel_hi:[0,1,1] neg_lo:[0,0,0] neg_hi:[1,0,0]
    v_pk_fma_f32 v[118:119], v[126:127], v[84:85], v[118:119] op_sel:[1,1,0] op_sel_hi:[0,1,1] neg_lo:[0,0,0] neg_hi:[1,0,0]
    ds_write_b64 v6, v[40:41] offset:128
    v_pk_fma_f32 v[120:121], v[130:131], v[86:87], v[120:121] op_sel:[1,1,0] op_sel_hi:[0,1,1] neg_lo:[0,0,0] neg_hi:[1,0,0]
    v_pk_fma_f32 v[134:135], v[150:151], v[88:89], v[134:135] op_sel:[1,1,0] op_sel_hi:[0,1,1] neg_lo:[0,0,0] neg_hi:[1,0,0]
    v_pk_add_f32 v[132:133], v[122:123], v[144:145]
    ds_write_b64 v6, v[8:9] offset:160
    v_pk_add_f32 v[136:137], v[122:123], v[144:145] neg_lo:[0,1] neg_hi:[0,1]
    v_pk_add_f32 v[128:129], v[138:139], v[118:119]
    v_pk_add_f32 v[124:125], v[138:139], v[118:119] neg_lo:[0,1] neg_hi:[0,1]
    ds_write_b64 v6, v[14:15] offset:192
    v_pk_add_f32 v[146:147], v[142:143], v[120:121]
    v_pk_add_f32 v[116:117], v[142:143], v[120:121] neg_lo:[0,1] neg_hi:[0,1]
    v_pk_add_f32 v[112:113], v[140:141], v[134:135]
    ds_write_b64 v6, v[22:23] offset:224
    v_pk_add_f32 v[148:149], v[140:141], v[134:135] neg_lo:[0,1] neg_hi:[0,1]
    v_pk_add_f32 v[114:115], v[132:133], v[146:147]
    ds_read_b64 v[26:27], v5 offset:0
    v_pk_add_f32 v[126:127], v[132:133], v[146:147] neg_lo:[0,1] neg_hi:[0,1]
    v_pk_add_f32 v[130:131], v[128:129], v[112:113]
    ds_read_b64 v[46:47], v5 offset:288
    v_pk_add_f32 v[150:151], v[128:129], v[112:113] neg_lo:[0,1] neg_hi:[0,1]
    v_pk_add_f32 v[122:123], v[114:115], v[130:131]
    ds_read_b64 v[32:33], v5 offset:576
    v_pk_add_f32 v[144:145], v[114:115], v[130:131] neg_lo:[0,1] neg_hi:[0,1]
    v_pk_add_f32 v[138:139], v[126:127], v[150:151] op_sel:[0,1] op_sel_hi:[1,0] neg_lo:[0,1] neg_hi:[0,0]
    ds_read_b64 v[20:21], v5 offset:864
    v_pk_add_f32 v[118:119], v[126:127], v[150:151] op_sel:[0,1] op_sel_hi:[1,0] neg_lo:[0,0] neg_hi:[0,1]
    v_pk_add_f32 v[142:143], v[124:125], v[124:125] op_sel:[0,1] op_sel_hi:[1,0] neg_lo:[0,1] neg_hi:[0,0]
    ds_read_b64 v[12:13], v5 offset:1152
    v_pk_add_f32 v[120:121], v[148:149], v[148:149] op_sel:[0,1] op_sel_hi:[1,0] neg_lo:[1,1] neg_hi:[1,0]
    v_pk_add_f32 v[140:141], v[136:137], v[116:117] op_sel:[0,1] op_sel_hi:[1,0] neg_lo:[0,1] neg_hi:[0,0]
    ds_read_b64 v[44:45], v5 offset:1440
    v_pk_add_f32 v[134:135], v[136:137], v[116:117] op_sel:[0,1] op_sel_hi:[1,0] neg_lo:[0,0] neg_hi:[0,1]
    v_pk_add_f32 v[132:133], v[142:143], v[120:121]
    ds_read_b64 v[38:39], v5 offset:1728
    v_pk_add_f32 v[128:129], v[142:143], v[120:121] neg_lo:[0,1] neg_hi:[0,1]
    v_pk_fma_f32 v[146:147], v[132:133], s[26:27], v[140:141] neg_lo:[0,0,0] neg_hi:[0,0,0]
    ds_read_b64 v[16:17], v5 offset:2016
    v_pk_fma_f32 v[112:113], v[132:133], s[26:27], v[140:141] neg_lo:[1,0,0] neg_hi:[1,0,0]
    v_pk_fma_f32 v[114:115], v[128:129], s[26:27], v[134:135] op_sel:[1,0,0] op_sel_hi:[0,1,1] neg_lo:[1,0,0] neg_hi:[0,0,0]
    v_pk_fma_f32 v[126:127], v[128:129], s[26:27], v[134:135] op_sel:[1,0,0] op_sel_hi:[0,1,1] neg_lo:[0,0,0] neg_hi:[1,0,0]
    ds_write_b64 v6, v[122:123] offset:18432
    s_waitcnt lgkmcnt(7)
    v_pk_mul_f32 v[36:37], v[46:47], v[62:63] op_sel:[0,0] op_sel_hi:[1,0]
    s_waitcnt lgkmcnt(6)
    v_pk_mul_f32 v[30:31], v[32:33], v[64:65] op_sel:[0,0] op_sel_hi:[1,0]
    s_waitcnt lgkmcnt(5)
    v_pk_mul_f32 v[28:29], v[20:21], v[66:67] op_sel:[0,0] op_sel_hi:[1,0]
    ds_write_b64 v6, v[146:147] offset:18464
    s_waitcnt lgkmcnt(5)
    v_pk_mul_f32 v[24:25], v[12:13], v[68:69] op_sel:[0,0] op_sel_hi:[1,0]
    s_waitcnt lgkmcnt(4)
    v_pk_mul_f32 v[18:19], v[44:45], v[70:71] op_sel:[0,0] op_sel_hi:[1,0]
    s_waitcnt lgkmcnt(3)
    v_pk_mul_f32 v[42:43], v[38:39], v[72:73] op_sel:[0,0] op_sel_hi:[1,0]
    ds_write_b64 v6, v[138:139] offset:18496
    s_waitcnt lgkmcnt(3)
    v_pk_mul_f32 v[34:35], v[16:17], v[74:75] op_sel:[0,0] op_sel_hi:[1,0]
    v_pk_fma_f32 v[36:37], v[46:47], v[62:63], v[36:37] op_sel:[1,1,0] op_sel_hi:[0,1,1] neg_lo:[0,0,0] neg_hi:[1,0,0]
    v_pk_fma_f32 v[30:31], v[32:33], v[64:65], v[30:31] op_sel:[1,1,0] op_sel_hi:[0,1,1] neg_lo:[0,0,0] neg_hi:[1,0,0]
    ds_write_b64 v6, v[114:115] offset:18528
    v_pk_fma_f32 v[28:29], v[20:21], v[66:67], v[28:29] op_sel:[1,1,0] op_sel_hi:[0,1,1] neg_lo:[0,0,0] neg_hi:[1,0,0]
    v_pk_fma_f32 v[24:25], v[12:13], v[68:69], v[24:25] op_sel:[1,1,0] op_sel_hi:[0,1,1] neg_lo:[0,0,0] neg_hi:[1,0,0]
    v_pk_fma_f32 v[18:19], v[44:45], v[70:71], v[18:19] op_sel:[1,1,0] op_sel_hi:[0,1,1] neg_lo:[0,0,0] neg_hi:[1,0,0]
    ds_write_b64 v6, v[144:145] offset:18560
    v_pk_fma_f32 v[42:43], v[38:39], v[72:73], v[42:43] op_sel:[1,1,0] op_sel_hi:[0,1,1] neg_lo:[0,0,0] neg_hi:[1,0,0]
    v_pk_fma_f32 v[34:35], v[16:17], v[74:75], v[34:35] op_sel:[1,1,0] op_sel_hi:[0,1,1] neg_lo:[0,0,0] neg_hi:[1,0,0]
    v_pk_add_f32 v[10:11], v[26:27], v[24:25]
    ds_write_b64 v6, v[112:113] offset:18592
    v_pk_add_f32 v[40:41], v[26:27], v[24:25] neg_lo:[0,1] neg_hi:[0,1]
    v_pk_add_f32 v[8:9], v[36:37], v[18:19]
    v_pk_add_f32 v[14:15], v[36:37], v[18:19] neg_lo:[0,1] neg_hi:[0,1]
    ds_write_b64 v6, v[118:119] offset:18624
    v_pk_add_f32 v[22:23], v[30:31], v[42:43]
    v_pk_add_f32 v[46:47], v[30:31], v[42:43] neg_lo:[0,1] neg_hi:[0,1]
    v_pk_add_f32 v[32:33], v[28:29], v[34:35]
    ds_write_b64 v6, v[126:127] offset:18656
    v_pk_add_f32 v[20:21], v[28:29], v[34:35] neg_lo:[0,1] neg_hi:[0,1]
    v_pk_add_f32 v[12:13], v[10:11], v[22:23]
    ds_read_b64 v[130:131], v5 offset:18432
    v_pk_add_f32 v[44:45], v[10:11], v[22:23] neg_lo:[0,1] neg_hi:[0,1]
    v_pk_add_f32 v[38:39], v[8:9], v[32:33]
    ds_read_b64 v[150:151], v5 offset:18720
    v_pk_add_f32 v[16:17], v[8:9], v[32:33] neg_lo:[0,1] neg_hi:[0,1]
    v_pk_add_f32 v[26:27], v[12:13], v[38:39]
    ds_read_b64 v[136:137], v5 offset:19008
    v_pk_add_f32 v[24:25], v[12:13], v[38:39] neg_lo:[0,1] neg_hi:[0,1]
    v_pk_add_f32 v[36:37], v[44:45], v[16:17] op_sel:[0,1] op_sel_hi:[1,0] neg_lo:[0,1] neg_hi:[0,0]
    ds_read_b64 v[124:125], v5 offset:19296
    v_pk_add_f32 v[18:19], v[44:45], v[16:17] op_sel:[0,1] op_sel_hi:[1,0] neg_lo:[0,0] neg_hi:[0,1]
    v_pk_add_f32 v[30:31], v[14:15], v[14:15] op_sel:[0,1] op_sel_hi:[1,0] neg_lo:[0,1] neg_hi:[0,0]
    ds_read_b64 v[116:117], v5 offset:19584
    v_pk_add_f32 v[42:43], v[20:21], v[20:21] op_sel:[0,1] op_sel_hi:[1,0] neg_lo:[1,1] neg_hi:[1,0]
    v_pk_add_f32 v[28:29], v[40:41], v[46:47] op_sel:[0,1] op_sel_hi:[1,0] neg_lo:[0,1] neg_hi:[0,0]
    ds_read_b64 v[148:149], v5 offset:19872
    v_pk_add_f32 v[34:35], v[40:41], v[46:47] op_sel:[0,1] op_sel_hi:[1,0] neg_lo:[0,0] neg_hi:[0,1]
    v_pk_add_f32 v[10:11], v[30:31], v[42:43]
    ds_read_b64 v[142:143], v5 offset:20160
    v_pk_add_f32 v[8:9], v[30:31], v[42:43] neg_lo:[0,1] neg_hi:[0,1]
    v_pk_fma_f32 v[22:23], v[10:11], s[26:27], v[28:29] neg_lo:[0,0,0] neg_hi:[0,0,0]
    ds_read_b64 v[120:121], v5 offset:20448
    v_pk_fma_f32 v[32:33], v[10:11], s[26:27], v[28:29] neg_lo:[1,0,0] neg_hi:[1,0,0]
    v_pk_fma_f32 v[12:13], v[8:9], s[26:27], v[34:35] op_sel:[1,0,0] op_sel_hi:[0,1,1] neg_lo:[1,0,0] neg_hi:[0,0,0]
    v_pk_fma_f32 v[44:45], v[8:9], s[26:27], v[34:35] op_sel:[1,0,0] op_sel_hi:[0,1,1] neg_lo:[0,0,0] neg_hi:[1,0,0]
    ds_write_b64 v5, v[26:27] offset:0
    s_waitcnt lgkmcnt(7)
    v_pk_mul_f32 v[140:141], v[150:151], v[62:63] op_sel:[0,0] op_sel_hi:[1,0]
    s_waitcnt lgkmcnt(6)
    v_pk_mul_f32 v[134:135], v[136:137], v[64:65] op_sel:[0,0] op_sel_hi:[1,0]
    s_waitcnt lgkmcnt(5)
    v_pk_mul_f32 v[132:133], v[124:125], v[66:67] op_sel:[0,0] op_sel_hi:[1,0]
    ds_write_b64 v5, v[22:23] offset:256
    s_waitcnt lgkmcnt(5)
    v_pk_mul_f32 v[128:129], v[116:117], v[68:69] op_sel:[0,0] op_sel_hi:[1,0]
    s_waitcnt lgkmcnt(4)
    v_pk_mul_f32 v[122:123], v[148:149], v[70:71] op_sel:[0,0] op_sel_hi:[1,0]
    s_waitcnt lgkmcnt(3)
    v_pk_mul_f32 v[146:147], v[142:143], v[72:73] op_sel:[0,0] op_sel_hi:[1,0]
    ds_write_b64 v5, v[36:37] offset:512
    s_waitcnt lgkmcnt(3)
    v_pk_mul_f32 v[138:139], v[120:121], v[74:75] op_sel:[0,0] op_sel_hi:[1,0]
    v_pk_fma_f32 v[140:141], v[150:151], v[62:63], v[140:141] op_sel:[1,1,0] op_sel_hi:[0,1,1] neg_lo:[0,0,0] neg_hi:[1,0,0]
    v_pk_fma_f32 v[134:135], v[136:137], v[64:65], v[134:135] op_sel:[1,1,0] op_sel_hi:[0,1,1] neg_lo:[0,0,0] neg_hi:[1,0,0]
    ds_write_b64 v5, v[12:13] offset:768
    v_pk_fma_f32 v[132:133], v[124:125], v[66:67], v[132:133] op_sel:[1,1,0] op_sel_hi:[0,1,1] neg_lo:[0,0,0] neg_hi:[1,0,0]
    v_pk_fma_f32 v[128:129], v[116:117], v[68:69], v[128:129] op_sel:[1,1,0] op_sel_hi:[0,1,1] neg_lo:[0,0,0] neg_hi:[1,0,0]
    v_pk_fma_f32 v[122:123], v[148:149], v[70:71], v[122:123] op_sel:[1,1,0] op_sel_hi:[0,1,1] neg_lo:[0,0,0] neg_hi:[1,0,0]
    ds_write_b64 v5, v[24:25] offset:1024
    v_pk_fma_f32 v[146:147], v[142:143], v[72:73], v[146:147] op_sel:[1,1,0] op_sel_hi:[0,1,1] neg_lo:[0,0,0] neg_hi:[1,0,0]
    v_pk_fma_f32 v[138:139], v[120:121], v[74:75], v[138:139] op_sel:[1,1,0] op_sel_hi:[0,1,1] neg_lo:[0,0,0] neg_hi:[1,0,0]
    v_pk_add_f32 v[114:115], v[130:131], v[128:129]
    ds_write_b64 v5, v[32:33] offset:1280
    v_pk_add_f32 v[144:145], v[130:131], v[128:129] neg_lo:[0,1] neg_hi:[0,1]
    v_pk_add_f32 v[112:113], v[140:141], v[122:123]
    v_pk_add_f32 v[118:119], v[140:141], v[122:123] neg_lo:[0,1] neg_hi:[0,1]
    ds_write_b64 v5, v[18:19] offset:1536
    v_pk_add_f32 v[126:127], v[134:135], v[146:147]
    v_pk_add_f32 v[150:151], v[134:135], v[146:147] neg_lo:[0,1] neg_hi:[0,1]
    v_pk_add_f32 v[136:137], v[132:133], v[138:139]
    ds_write_b64 v5, v[44:45] offset:1792
    v_pk_add_f32 v[124:125], v[132:133], v[138:139] neg_lo:[0,1] neg_hi:[0,1]
    v_pk_add_f32 v[116:117], v[114:115], v[126:127]
    v_pk_add_f32 v[148:149], v[114:115], v[126:127] neg_lo:[0,1] neg_hi:[0,1]
    v_pk_add_f32 v[142:143], v[112:113], v[136:137]
    v_pk_add_f32 v[120:121], v[112:113], v[136:137] neg_lo:[0,1] neg_hi:[0,1]
    v_pk_add_f32 v[130:131], v[116:117], v[142:143]
    v_pk_add_f32 v[128:129], v[116:117], v[142:143] neg_lo:[0,1] neg_hi:[0,1]
    v_pk_add_f32 v[140:141], v[148:149], v[120:121] op_sel:[0,1] op_sel_hi:[1,0] neg_lo:[0,1] neg_hi:[0,0]
    v_pk_add_f32 v[122:123], v[148:149], v[120:121] op_sel:[0,1] op_sel_hi:[1,0] neg_lo:[0,0] neg_hi:[0,1]
    v_pk_add_f32 v[134:135], v[118:119], v[118:119] op_sel:[0,1] op_sel_hi:[1,0] neg_lo:[0,1] neg_hi:[0,0]
    v_pk_add_f32 v[146:147], v[124:125], v[124:125] op_sel:[0,1] op_sel_hi:[1,0] neg_lo:[1,1] neg_hi:[1,0]
    v_pk_add_f32 v[132:133], v[144:145], v[150:151] op_sel:[0,1] op_sel_hi:[1,0] neg_lo:[0,1] neg_hi:[0,0]
    v_pk_add_f32 v[138:139], v[144:145], v[150:151] op_sel:[0,1] op_sel_hi:[1,0] neg_lo:[0,0] neg_hi:[0,1]
    v_pk_add_f32 v[114:115], v[134:135], v[146:147]
    v_pk_add_f32 v[112:113], v[134:135], v[146:147] neg_lo:[0,1] neg_hi:[0,1]
    v_pk_fma_f32 v[126:127], v[114:115], s[26:27], v[132:133] neg_lo:[0,0,0] neg_hi:[0,0,0]
    v_pk_fma_f32 v[136:137], v[114:115], s[26:27], v[132:133] neg_lo:[1,0,0] neg_hi:[1,0,0]
    v_pk_fma_f32 v[116:117], v[112:113], s[26:27], v[138:139] op_sel:[1,0,0] op_sel_hi:[0,1,1] neg_lo:[1,0,0] neg_hi:[0,0,0]
    v_pk_fma_f32 v[148:149], v[112:113], s[26:27], v[138:139] op_sel:[1,0,0] op_sel_hi:[0,1,1] neg_lo:[0,0,0] neg_hi:[1,0,0]
    ds_write_b64 v5, v[130:131] offset:18432
    ds_write_b64 v5, v[126:127] offset:18688
    ds_write_b64 v5, v[140:141] offset:18944
    ds_write_b64 v5, v[116:117] offset:19200
    ds_write_b64 v5, v[128:129] offset:19456
    ds_write_b64 v5, v[136:137] offset:19712
    ds_write_b64 v5, v[122:123] offset:19968
    ds_write_b64 v5, v[148:149] offset:20224
    s_waitcnt lgkmcnt(0)
    s_barrier
    ds_read_b64 v[38:39], v3 offset:0
    ds_read_b64 v[16:17], v3 offset:2304
    ds_read_b64 v[40:41], v3 offset:4608
    ds_read_b64 v[14:15], v3 offset:6912
    ds_read_b64 v[46:47], v3 offset:9216
    ds_read_b64 v[20:21], v3 offset:11520
    ds_read_b64 v[30:31], v3 offset:13824
    ds_read_b64 v[42:43], v3 offset:16128
    ds_read_b64 v[142:143], v3 offset:18432
    ds_read_b64 v[120:121], v3 offset:20736
    ds_read_b64 v[144:145], v3 offset:23040
    ds_read_b64 v[118:119], v3 offset:25344
    ds_read_b64 v[150:151], v3 offset:27648
    ds_read_b64 v[124:125], v3 offset:29952
    ds_read_b64 v[134:135], v3 offset:32256
    ds_read_b64 v[146:147], v3 offset:34560
    s_waitcnt lgkmcnt(14)
    v_pk_mul_f32 v[28:29], v[16:17], v[48:49] op_sel:[0,0] op_sel_hi:[1,0]
    s_waitcnt lgkmcnt(13)
    v_pk_mul_f32 v[34:35], v[40:41], v[50:51] op_sel:[0,0] op_sel_hi:[1,0]
    s_waitcnt lgkmcnt(12)
    v_pk_mul_f32 v[10:11], v[14:15], v[52:53] op_sel:[0,0] op_sel_hi:[1,0]
    s_waitcnt lgkmcnt(11)
    v_pk_mul_f32 v[8:9], v[46:47], v[54:55] op_sel:[0,0] op_sel_hi:[1,0]
    s_waitcnt lgkmcnt(10)
    v_pk_mul_f32 v[26:27], v[20:21], v[56:57] op_sel:[0,0] op_sel_hi:[1,0]
    s_waitcnt lgkmcnt(9)
    v_pk_mul_f32 v[22:23], v[30:31], v[58:59] op_sel:[0,0] op_sel_hi:[1,0]
    s_waitcnt lgkmcnt(8)
    v_pk_mul_f32 v[36:37], v[42:43], v[60:61] op_sel:[0,0] op_sel_hi:[1,0]
    v_pk_fma_f32 v[28:29], v[16:17], v[48:49], v[28:29] op_sel:[1,1,0] op_sel_hi:[0,1,1] neg_lo:[0,0,0] neg_hi:[1,0,0]
    v_pk_fma_f32 v[34:35], v[40:41], v[50:51], v[34:35] op_sel:[1,1,0] op_sel_hi:[0,1,1] neg_lo:[0,0,0] neg_hi:[1,0,0]
    v_pk_fma_f32 v[10:11], v[14:15], v[52:53], v[10:11] op_sel:[1,1,0] op_sel_hi:[0,1,1] neg_lo:[0,0,0] neg_hi:[1,0,0]
    v_pk_fma_f32 v[8:9], v[46:47], v[54:55], v[8:9] op_sel:[1,1,0] op_sel_hi:[0,1,1] neg_lo:[0,0,0] neg_hi:[1,0,0]
    v_pk_fma_f32 v[26:27], v[20:21], v[56:57], v[26:27] op_sel:[1,1,0] op_sel_hi:[0,1,1] neg_lo:[0,0,0] neg_hi:[1,0,0]
    v_pk_fma_f32 v[22:23], v[30:31], v[58:59], v[22:23] op_sel:[1,1,0] op_sel_hi:[0,1,1] neg_lo:[0,0,0] neg_hi:[1,0,0]
    v_pk_fma_f32 v[36:37], v[42:43], v[60:61], v[36:37] op_sel:[1,1,0] op_sel_hi:[0,1,1] neg_lo:[0,0,0] neg_hi:[1,0,0]
    v_pk_add_f32 v[12:13], v[38:39], v[8:9]
    v_pk_add_f32 v[24:25], v[38:39], v[8:9] neg_lo:[0,1] neg_hi:[0,1]
    v_pk_add_f32 v[32:33], v[28:29], v[26:27]
    v_pk_add_f32 v[18:19], v[28:29], v[26:27] neg_lo:[0,1] neg_hi:[0,1]
    v_pk_add_f32 v[44:45], v[34:35], v[22:23]
    v_pk_add_f32 v[16:17], v[34:35], v[22:23] neg_lo:[0,1] neg_hi:[0,1]
    v_pk_add_f32 v[40:41], v[10:11], v[36:37]
    v_pk_add_f32 v[14:15], v[10:11], v[36:37] neg_lo:[0,1] neg_hi:[0,1]
    v_pk_add_f32 v[46:47], v[12:13], v[44:45]
    v_pk_add_f32 v[20:21], v[12:13], v[44:45] neg_lo:[0,1] neg_hi:[0,1]
    v_pk_add_f32 v[30:31], v[32:33], v[40:41]
    v_pk_add_f32 v[42:43], v[32:33], v[40:41] neg_lo:[0,1] neg_hi:[0,1]
    v_pk_add_f32 v[38:39], v[46:47], v[30:31]
    v_pk_add_f32 v[8:9], v[46:47], v[30:31] neg_lo:[0,1] neg_hi:[0,1]
    v_pk_add_f32 v[28:29], v[20:21], v[42:43] op_sel:[0,1] op_sel_hi:[1,0] neg_lo:[0,1] neg_hi:[0,0]
    v_pk_add_f32 v[26:27], v[20:21], v[42:43] op_sel:[0,1] op_sel_hi:[1,0] neg_lo:[0,0] neg_hi:[0,1]
    v_pk_add_f32 v[34:35], v[18:19], v[18:19] op_sel:[0,1] op_sel_hi:[1,0] neg_lo:[0,1] neg_hi:[0,0]
    v_pk_add_f32 v[22:23], v[14:15], v[14:15] op_sel:[0,1] op_sel_hi:[1,0] neg_lo:[1,1] neg_hi:[1,0]
    v_pk_add_f32 v[10:11], v[24:25], v[16:17] op_sel:[0,1] op_sel_hi:[1,0] neg_lo:[0,1] neg_hi:[0,0]
    v_pk_add_f32 v[36:37], v[24:25], v[16:17] op_sel:[0,1] op_sel_hi:[1,0] neg_lo:[0,0] neg_hi:[0,1]
    v_pk_add_f32 v[12:13], v[34:35], v[22:23]
    v_pk_add_f32 v[32:33], v[34:35], v[22:23] neg_lo:[0,1] neg_hi:[0,1]
    v_pk_fma_f32 v[44:45], v[12:13], s[26:27], v[10:11] neg_lo:[0,0,0] neg_hi:[0,0,0]
    v_pk_fma_f32 v[40:41], v[12:13], s[26:27], v[10:11] neg_lo:[1,0,0] neg_hi:[1,0,0]
    v_pk_fma_f32 v[46:47], v[32:33], s[26:27], v[36:37] op_sel:[1,0,0] op_sel_hi:[0,1,1] neg_lo:[1,0,0] neg_hi:[0,0,0]
    v_pk_fma_f32 v[20:21], v[32:33], s[26:27], v[36:37] op_sel:[1,0,0] op_sel_hi:[0,1,1] neg_lo:[0,0,0] neg_hi:[1,0,0]
    s_waitcnt lgkmcnt(6)
    v_pk_mul_f32 v[132:133], v[120:121], v[48:49] op_sel:[0,0] op_sel_hi:[1,0]
    s_waitcnt lgkmcnt(5)
    v_pk_mul_f32 v[138:139], v[144:145], v[50:51] op_sel:[0,0] op_sel_hi:[1,0]
    s_waitcnt lgkmcnt(4)
    v_pk_mul_f32 v[114:115], v[118:119], v[52:53] op_sel:[0,0] op_sel_hi:[1,0]
    s_waitcnt lgkmcnt(3)
    v_pk_mul_f32 v[112:113], v[150:151], v[54:55] op_sel:[0,0] op_sel_hi:[1,0]
    s_waitcnt lgkmcnt(2)
    v_pk_mul_f32 v[130:131], v[124:125], v[56:57] op_sel:[0,0] op_sel_hi:[1,0]
    s_waitcnt lgkmcnt(1)
    v_pk_mul_f32 v[126:127], v[134:135], v[58:59] op_sel:[0,0] op_sel_hi:[1,0]
    s_waitcnt lgkmcnt(0)
    v_pk_mul_f32 v[140:141], v[146:147], v[60:61] op_sel:[0,0] op_sel_hi:[1,0]
    v_pk_fma_f32 v[132:133], v[120:121], v[48:49], v[132:133] op_sel:[1,1,0] op_sel_hi:[0,1,1] neg_lo:[0,0,0] neg_hi:[1,0,0]
    v_pk_fma_f32 v[138:139], v[144:145], v[50:51], v[138:139] op_sel:[1,1,0] op_sel_hi:[0,1,1] neg_lo:[0,0,0] neg_hi:[1,0,0]
    v_pk_fma_f32 v[114:115], v[118:119], v[52:53], v[114:115] op_sel:[1,1,0] op_sel_hi:[0,1,1] neg_lo:[0,0,0] neg_hi:[1,0,0]
    v_pk_fma_f32 v[112:113], v[150:151], v[54:55], v[112:113] op_sel:[1,1,0] op_sel_hi:[0,1,1] neg_lo:[0,0,0] neg_hi:[1,0,0]
    v_pk_fma_f32 v[130:131], v[124:125], v[56:57], v[130:131] op_sel:[1,1,0] op_sel_hi:[0,1,1] neg_lo:[0,0,0] neg_hi:[1,0,0]
    v_pk_fma_f32 v[126:127], v[134:135], v[58:59], v[126:127] op_sel:[1,1,0] op_sel_hi:[0,1,1] neg_lo:[0,0,0] neg_hi:[1,0,0]
    v_pk_fma_f32 v[140:141], v[146:147], v[60:61], v[140:141] op_sel:[1,1,0] op_sel_hi:[0,1,1] neg_lo:[0,0,0] neg_hi:[1,0,0]
    v_pk_add_f32 v[116:117], v[142:143], v[112:113]
    v_pk_add_f32 v[128:129], v[142:143], v[112:113] neg_lo:[0,1] neg_hi:[0,1]
    v_pk_add_f32 v[136:137], v[132:133], v[130:131]
    v_pk_add_f32 v[122:123], v[132:133], v[130:131] neg_lo:[0,1] neg_hi:[0,1]
    v_pk_add_f32 v[148:149], v[138:139], v[126:127]
    v_pk_add_f32 v[120:121], v[138:139], v[126:127] neg_lo:[0,1] neg_hi:[0,1]
    v_pk_add_f32 v[144:145], v[114:115], v[140:141]
    v_pk_add_f32 v[118:119], v[114:115], v[140:141] neg_lo:[0,1] neg_hi:[0,1]
    v_pk_add_f32 v[150:151], v[116:117], v[148:149]
    v_pk_add_f32 v[124:125], v[116:117], v[148:149] neg_lo:[0,1] neg_hi:[0,1]
    v_pk_add_f32 v[134:135], v[136:137], v[144:145]
    v_pk_add_f32 v[146:147], v[136:137], v[144:145] neg_lo:[0,1] neg_hi:[0,1]
    v_pk_add_f32 v[142:143], v[150:151], v[134:135]
    v_pk_add_f32 v[112:113], v[150:151], v[134:135] neg_lo:[0,1] neg_hi:[0,1]
    v_pk_add_f32 v[132:133], v[124:125], v[146:147] op_sel:[0,1] op_sel_hi:[1,0] neg_lo:[0,1] neg_hi:[0,0]
    v_pk_add_f32 v[130:131], v[124:125], v[146:147] op_sel:[0,1] op_sel_hi:[1,0] neg_lo:[0,0] neg_hi:[0,1]
    v_pk_add_f32 v[138:139], v[122:123], v[122:123] op_sel:[0,1] op_sel_hi:[1,0] neg_lo:[0,1] neg_hi:[0,0]
    v_pk_add_f32 v[126:127], v[118:119], v[118:119] op_sel:[0,1] op_sel_hi:[1,0] neg_lo:[1,1] neg_hi:[1,0]
    v_pk_add_f32 v[114:115], v[128:129], v[120:121] op_sel:[0,1] op_sel_hi:[1,0] neg_lo:[0,1] neg_hi:[0,0]
    v_pk_add_f32 v[140:141], v[128:129], v[120:121] op_sel:[0,1] op_sel_hi:[1,0] neg_lo:[0,0] neg_hi:[0,1]
    v_pk_add_f32 v[116:117], v[138:139], v[126:127]
    v_pk_add_f32 v[136:137], v[138:139], v[126:127] neg_lo:[0,1] neg_hi:[0,1]
    v_pk_fma_f32 v[148:149], v[116:117], s[26:27], v[114:115] neg_lo:[0,0,0] neg_hi:[0,0,0]
    v_pk_fma_f32 v[144:145], v[116:117], s[26:27], v[114:115] neg_lo:[1,0,0] neg_hi:[1,0,0]
    v_pk_fma_f32 v[150:151], v[136:137], s[26:27], v[140:141] op_sel:[1,0,0] op_sel_hi:[0,1,1] neg_lo:[1,0,0] neg_hi:[0,0,0]
    v_pk_fma_f32 v[124:125], v[136:137], s[26:27], v[140:141] op_sel:[1,0,0] op_sel_hi:[0,1,1] neg_lo:[0,0,0] neg_hi:[1,0,0]
    s_mul_i32 s22, s101, 3145728
    s_add_u32 s22, s22, 157286400
    s_lshl_b32 s21, s2, 14
    s_add_u32 s21, s21, s22
    s_cmp_eq_u32 s2, 0
    s_cbranch_scc1 M_fft_c0
    v_cvt_pk_bf16_f32 v38, v38, v39
    v_cvt_pk_bf16_f32 v39, v142, v143
    v_cvt_pk_bf16_f32 v44, v44, v45
    v_cvt_pk_bf16_f32 v45, v148, v149
    v_cvt_pk_bf16_f32 v28, v28, v29
    v_cvt_pk_bf16_f32 v29, v132, v133
    v_cvt_pk_bf16_f32 v46, v46, v47
    v_cvt_pk_bf16_f32 v47, v150, v151
    v_cvt_pk_bf16_f32 v8, v8, v9
    v_cvt_pk_bf16_f32 v9, v112, v113
    v_cvt_pk_bf16_f32 v40, v40, v41
    v_cvt_pk_bf16_f32 v41, v144, v145
    v_cvt_pk_bf16_f32 v26, v26, v27
    v_cvt_pk_bf16_f32 v27, v130, v131
    v_cvt_pk_bf16_f32 v20, v20, v21
    v_cvt_pk_bf16_f32 v21, v124, v125
    s_cmp_eq_u32 s2, 160
    s_cbranch_scc1 M_fft_c1
    buffer_store_dwordx2 v[38:39], v101, s[8:11], s21 offen offset:0 sc1
    buffer_store_dwordx2 v[44:45], v101, s[8:11], s21 offen offset:2048 sc1
    s_add_u32 s21, s21, 4096
    buffer_store_dwordx2 v[28:29], v101, s[8:11], s21 offen offset:0 sc1
    buffer_store_dwordx2 v[46:47], v101, s[8:11], s21 offen offset:2048 sc1
    s_add_u32 s21, s21, 4096
    buffer_store_dwordx2 v[8:9], v101, s[8:11], s21 offen offset:0 sc1
    buffer_store_dwordx2 v[40:41], v101, s[8:11], s21 offen offset:2048 sc1
    s_add_u32 s21, s21, 4096
    buffer_store_dwordx2 v[26:27], v101, s[8:11], s21 offen offset:0 sc1
    buffer_store_dwordx2 v[20:21], v101, s[8:11], s21 offen offset:2048 sc1
    s_add_u32 s21, s21, 4096
    s_branch M_fft_end
M_fft_c0:
    v_cvt_pk_bf16_f32 v38, v38, v142
    v_cvt_pk_bf16_f32 v44, v44, v148
    v_cvt_pk_bf16_f32 v28, v28, v132
    v_cvt_pk_bf16_f32 v46, v46, v150
    v_cvt_pk_bf16_f32 v8, v8, v112
    v_cvt_pk_bf16_f32 v40, v40, v144
    v_cvt_pk_bf16_f32 v26, v26, v130
    v_cvt_pk_bf16_f32 v20, v20, v124
    s_sub_u32 s22, s22, 4
M_fft_c1:
    buffer_store_dword v38, v101, s[8:11], s22 offen offset:4 sc1
    buffer_store_dword v44, v101, s[8:11], s22 offen offset:2052 sc1
    s_add_u32 s22, s22, 4096
    buffer_store_dword v28, v101, s[8:11], s22 offen offset:4 sc1
    buffer_store_dword v46, v101, s[8:11], s22 offen offset:2052 sc1
    s_add_u32 s22, s22, 4096
    buffer_store_dword v8, v101, s[8:11], s22 offen offset:4 sc1
    buffer_store_dword v40, v101, s[8:11], s22 offen offset:2052 sc1
    s_add_u32 s22, s22, 4096
    buffer_store_dword v26, v101, s[8:11], s22 offen offset:4 sc1
    buffer_store_dword v20, v101, s[8:11], s22 offen offset:2052 sc1
    s_add_u32 s22, s22, 4096
M_fft_end:
    s_waitcnt vmcnt(0) lgkmcnt(0)
    s_barrier
    s_cmp_lg_u32 s83, 0
    s_cbranch_scc1 M_gb_35
    s_mov_b32 s23, s85
    s_add_u32 s28, s86, 167841792
    s_lshl_b32 s27, s82, 7
    s_mov_b64 exec, 1
    s_add_u32 s31, s27, s84
    v_mov_b32 v190, s31
    v_mov_b32 v191, 1
    s_cmp_lg_u32 s23, 0
    s_cbranch_scc1 M_ls_36
    buffer_store_byte v191, v190, s[8:11], s28 offen
M_ls_36_r:
    s_cmp_lg_u32 s84, 31
    s_cbranch_scc1 M_gb_33
    s_mov_b64 exec, -1
    v_mbcnt_lo_u32_b32 v189, -1, 0
    s_mov_b64 exec, 0xff
    v_lshl_add_u32 v190, v189, 2, s27
    s_mov_b32 s30, 0
M_gs_37:
    buffer_load_dword v191, v190, s[8:11], s28 offen sc1
    s_add_u32 s30, s30, 1
    s_cmp_ge_u32 s30, 240000
    s_cbranch_scc1 M_fail
    s_waitcnt vmcnt(0)
    v_cmp_ne_u32 vcc, 0x1010101, v191
    s_cbranch_vccnz M_gs_37
    s_mov_b64 exec, 1
    v_mov_b32 v190, s27
    v_mov_b32 v191, 1
    buffer_store_dword v191, v190, s[8:11], s28 offen offset:1024 sc1
M_gb_33:
    s_mov_b64 exec, -1
M_gb_35:
    s_cmp_lg_u32 s83, 0
    s_cbranch_scc1 M_gb_34
    s_add_u32 s28, s86, 167841792
    v_mbcnt_lo_u32_b32 v189, -1, 0
    s_mov_b64 exec, 0x3f
    v_lshlrev_b32 v190, 7, v189
    v_add_u32 v190, 1024, v190
    s_mov_b32 s30, 0
M_gs_38:
    buffer_load_dword v191, v190, s[8:11], s28 offen sc1
    s_add_u32 s30, s30, 1
    s_cmp_ge_u32 s30, 240000
    s_cbranch_scc1 M_fail
    s_waitcnt vmcnt(0)
    v_cmp_ne_u32 vcc, 0x1, v191
    s_cbranch_vccnz M_gs_38
    s_mov_b64 exec, -1
M_gb_34:
    s_barrier
    s_cmp_ge_u32 s89, 64
    s_cbranch_scc1 M_noid
    v_mbcnt_lo_u32_b32 v0, -1, 0
    v_mbcnt_hi_u32_b32 v0, -1, v0
    s_mov_b32 s23, s85
    v_lshlrev_b32 v1, 4, v0
    v_lshrrev_b32 v3, 4, v0
    v_and_b32 v4, 15, v0
    v_lshlrev_b32 v2, 15, v3
    v_lshl_add_u32 v2, v4, 4, v2
    s_mul_i32 s24, s101, 3145728
    s_lshl_b32 s25, s89, 8
    s_add_u32 s24, s24, s25
    s_add_u32 s24, s24, 157286400
    s_add_u32 s25, s24, 0
    buffer_load_dwordx4 v[64:67], v2, s[8:11], s25 offen sc1
    s_add_u32 s25, s24, 16384
    buffer_load_dwordx4 v[68:71], v2, s[8:11], s25 offen sc1
    s_add_u32 s25, s24, 131072
    buffer_load_dwordx4 v[72:75], v2, s[8:11], s25 offen sc1
    s_add_u32 s25, s24, 147456
    buffer_load_dwordx4 v[76:79], v2, s[8:11], s25 offen sc1
    s_add_u32 s25, s24, 262144
    buffer_load_dwordx4 v[80:83], v2, s[8:11], s25 offen sc1
    s_add_u32 s25, s24, 278528
    buffer_load_dwordx4 v[84:87], v2, s[8:11], s25 offen sc1
    s_add_u32 s25, s24, 393216
    buffer_load_dwordx4 v[88:91], v2, s[8:11], s25 offen sc1
    s_add_u32 s25, s24, 409600
    buffer_load_dwordx4 v[92:95], v2, s[8:11], s25 offen sc1
    s_add_u32 s25, s24, 524288
    buffer_load_dwordx4 v[96:99], v2, s[8:11], s25 offen sc1
    s_add_u32 s25, s24, 540672
    buffer_load_dwordx4 v[100:103], v2, s[8:11], s25 offen sc1
    s_add_u32 s25, s24, 655360
    buffer_load_dwordx4 v[104:107], v2, s[8:11], s25 offen sc1
    s_add_u32 s25, s24, 671744
    buffer_load_dwordx4 v[108:111], v2, s[8:11], s25 offen sc1
    s_add_u32 s25, s24, 786432
    buffer_load_dwordx4 v[112:115], v2, s[8:11], s25 offen sc1
    s_add_u32 s25, s24, 802816
    buffer_load_dwordx4 v[116:119], v2, s[8:11], s25 offen sc1
    s_add_u32 s25, s24, 917504
    buffer_load_dwordx4 v[120:123], v2, s[8:11], s25 offen sc1
    s_add_u32 s25, s24, 933888
    buffer_load_dwordx4 v[124:127], v2, s[8:11], s25 offen sc1
    s_mul_i32 s29, s89, 40960
    v_mul_u32_u24 v5, 1280, v4
    v_lshl_add_u32 v5, v3, 4, v5
    v_add_u32 v6, 40960, v1
    s_lshl_b32 s31, s88, 7
    s_add_u32 s30, s29, s31
    s_add_u32 s31, s30, s80
    s_add_u32 s32, s31, 20480
    s_add_u32 s33, s30, 20480
    ds_read_b128 v[44:47], v1 offset:0
    ds_read_b128 v[48:51], v1 offset:20480
    ds_read_b128 v[52:55], v6 offset:0
    ds_read_b128 v[56:59], v6 offset:20480
    s_waitcnt vmcnt(14)
    v_swap_b32 v66, v68
    v_swap_b32 v67, v69
    s_waitcnt lgkmcnt(3)
    s_nop 0
    v_mfma_f32_16x16x32_bf16 v[12:15], v[44:47], v[64:67], 0
    ds_read_b128 v[60:63], v1 offset:1024
    v_mfma_f32_16x16x32_bf16 v[28:31], v[44:47], v[68:71], 0
    s_waitcnt lgkmcnt(3)
    v_mfma_f32_16x16x32_bf16 v[16:19], v[48:51], v[64:67], 0
    ds_read_b128 v[44:47], v1 offset:21504
    v_mfma_f32_16x16x32_bf16 v[32:35], v[48:51], v[68:71], 0
    s_waitcnt lgkmcnt(3)
    v_mfma_f32_16x16x32_bf16 v[20:23], v[52:55], v[64:67], 0
    ds_read_b128 v[48:51], v6 offset:1024
    v_mfma_f32_16x16x32_bf16 v[36:39], v[52:55], v[68:71], 0
    s_waitcnt vmcnt(12)
    v_swap_b32 v74, v76
    v_swap_b32 v75, v77
    s_waitcnt lgkmcnt(3)
    v_mfma_f32_16x16x32_bf16 v[24:27], v[56:59], v[64:67], 0
    ds_read_b128 v[52:55], v6 offset:21504
    v_mfma_f32_16x16x32_bf16 v[40:43], v[56:59], v[68:71], 0
    s_add_u32 s25, s24, 1048576
    buffer_load_dwordx4 v[128:131], v2, s[8:11], s25 offen sc1
    s_add_u32 s25, s24, 1064960
    buffer_load_dwordx4 v[132:135], v2, s[8:11], s25 offen sc1
    s_add_u32 s25, s24, 1179648
    buffer_load_dwordx4 v[136:139], v2, s[8:11], s25 offen sc1
    s_add_u32 s25, s24, 1196032
    buffer_load_dwordx4 v[140:143], v2, s[8:11], s25 offen sc1
    s_add_u32 s25, s24, 1310720
    buffer_load_dwordx4 v[144:147], v2, s[8:11], s25 offen sc1
    s_add_u32 s25, s24, 1327104
    buffer_load_dwordx4 v[148:151], v2, s[8:11], s25 offen sc1
    s_add_u32 s25, s24, 1441792
    buffer_load_dwordx4 v[152:155], v2, s[8:11], s25 offen sc1
    s_add_u32 s25, s24, 1458176
    buffer_load_dwordx4 v[156:159], v2, s[8:11], s25 offen sc1
    s_waitcnt lgkmcnt(3)
    v_mfma_f32_16x16x32_bf16 v[12:15], v[60:63], v[72:75], v[12:15]
    ds_read_b128 v[56:59], v1 offset:2048
    v_mfma_f32_16x16x32_bf16 v[28:31], v[60:63], v[76:79], v[28:31]
    s_waitcnt lgkmcnt(3)
    v_mfma_f32_16x16x32_bf16 v[16:19], v[44:47], v[72:75], v[16:19]
    ds_read_b128 v[60:63], v1 offset:22528
    v_mfma_f32_16x16x32_bf16 v[32:35], v[44:47], v[76:79], v[32:35]
    s_waitcnt lgkmcnt(3)
    v_mfma_f32_16x16x32_bf16 v[20:23], v[48:51], v[72:75], v[20:23]
    ds_read_b128 v[44:47], v6 offset:2048
    v_mfma_f32_16x16x32_bf16 v[36:39], v[48:51], v[76:79], v[36:39]
    s_waitcnt vmcnt(18)
    v_swap_b32 v82, v84
    v_swap_b32 v83, v85
    s_waitcnt lgkmcnt(3)
    v_mfma_f32_16x16x32_bf16 v[24:27], v[52:55], v[72:75], v[24:27]
    ds_read_b128 v[48:51], v6 offset:22528
    v_mfma_f32_16x16x32_bf16 v[40:43], v[52:55], v[76:79], v[40:43]
    s_waitcnt lgkmcnt(3)
    v_mfma_f32_16x16x32_bf16 v[12:15], v[56:59], v[80:83], v[12:15]
    ds_read_b128 v[52:55], v1 offset:3072
    v_mfma_f32_16x16x32_bf16 v[28:31], v[56:59], v[84:87], v[28:31]
    s_waitcnt lgkmcnt(3)
    v_mfma_f32_16x16x32_bf16 v[16:19], v[60:63], v[80:83], v[16:19]
    ds_read_b128 v[56:59], v1 offset:23552
    v_mfma_f32_16x16x32_bf16 v[32:35], v[60:63], v[84:87], v[32:35]
    s_waitcnt lgkmcnt(3)
    v_mfma_f32_16x16x32_bf16 v[20:23], v[44:47], v[80:83], v[20:23]
    ds_read_b128 v[60:63], v6 offset:3072
    v_mfma_f32_16x16x32_bf16 v[36:39], v[44:47], v[84:87], v[36:39]
    s_waitcnt vmcnt(16)
    v_swap_b32 v90, v92
    v_swap_b32 v91, v93
    s_waitcnt lgkmcnt(3)
    v_mfma_f32_16x16x32_bf16 v[24:27], v[48:51], v[80:83], v[24:27]
    ds_read_b128 v[44:47], v6 offset:23552
    v_mfma_f32_16x16x32_bf16 v[40:43], v[48:51], v[84:87], v[40:43]
    s_add_u32 s25, s24, 1572864
    buffer_load_dwordx4 v[160:163], v2, s[8:11], s25 offen sc1
    s_add_u32 s25, s24, 1589248
    buffer_load_dwordx4 v[164:167], v2, s[8:11], s25 offen sc1
    s_add_u32 s25, s24, 1703936
    buffer_load_dwordx4 v[168:171], v2, s[8:11], s25 offen sc1
    s_add_u32 s25, s24, 1720320
    buffer_load_dwordx4 v[172:175], v2, s[8:11], s25 offen sc1
    s_add_u32 s25, s24, 1835008
    buffer_load_dwordx4 v[176:179], v2, s[8:11], s25 offen sc1
    s_add_u32 s25, s24, 1851392
    buffer_load_dwordx4 v[180:183], v2, s[8:11], s25 offen sc1
    s_add_u32 s25, s24, 1966080
    buffer_load_dwordx4 v[64:67], v2, s[8:11], s25 offen sc1
    s_add_u32 s25, s24, 1982464
    buffer_load_dwordx4 v[68:71], v2, s[8:11], s25 offen sc1
    s_waitcnt lgkmcnt(3)
    v_mfma_f32_16x16x32_bf16 v[12:15], v[52:55], v[88:91], v[12:15]
    ds_read_b128 v[48:51], v1 offset:4096
    v_mfma_f32_16x16x32_bf16 v[28:31], v[52:55], v[92:95], v[28:31]
    s_waitcnt lgkmcnt(3)
    v_mfma_f32_16x16x32_bf16 v[16:19], v[56:59], v[88:91], v[16:19]
    ds_read_b128 v[52:55], v1 offset:24576
    v_mfma_f32_16x16x32_bf16 v[32:35], v[56:59], v[92:95], v[32:35]
    s_waitcnt lgkmcnt(3)
    v_mfma_f32_16x16x32_bf16 v[20:23], v[60:63], v[88:91], v[20:23]
    ds_read_b128 v[56:59], v6 offset:4096
    v_mfma_f32_16x16x32_bf16 v[36:39], v[60:63], v[92:95], v[36:39]
    s_waitcnt vmcnt(22)
    v_swap_b32 v98, v100
    v_swap_b32 v99, v101
    s_waitcnt lgkmcnt(3)
    v_mfma_f32_16x16x32_bf16 v[24:27], v[44:47], v[88:91], v[24:27]
    ds_read_b128 v[60:63], v6 offset:24576
    v_mfma_f32_16x16x32_bf16 v[40:43], v[44:47], v[92:95], v[40:43]
    s_waitcnt lgkmcnt(3)
    v_mfma_f32_16x16x32_bf16 v[12:15], v[48:51], v[96:99], v[12:15]
    ds_read_b128 v[44:47], v1 offset:5120
    v_mfma_f32_16x16x32_bf16 v[28:31], v[48:51], v[100:103], v[28:31]
    s_waitcnt lgkmcnt(3)
    v_mfma_f32_16x16x32_bf16 v[16:19], v[52:55], v[96:99], v[16:19]
    ds_read_b128 v[48:51], v1 offset:25600
    v_mfma_f32_16x16x32_bf16 v[32:35], v[52:55], v[100:103], v[32:35]
    s_waitcnt lgkmcnt(3)
    v_mfma_f32_16x16x32_bf16 v[20:23], v[56:59], v[96:99], v[20:23]
    ds_read_b128 v[52:55], v6 offset:5120
    v_mfma_f32_16x16x32_bf16 v[36:39], v[56:59], v[100:103], v[36:39]
    s_waitcnt vmcnt(20)
    v_swap_b32 v106, v108
    v_swap_b32 v107, v109
    s_waitcnt lgkmcnt(3)
    v_mfma_f32_16x16x32_bf16 v[24:27], v[60:63], v[96:99], v[24:27]
    ds_read_b128 v[56:59], v6 offset:25600
    v_mfma_f32_16x16x32_bf16 v[40:43], v[60:63], v[100:103], v[40:43]
    s_add_u32 s25, s24, 2097152
    buffer_load_dwordx4 v[72:75], v2, s[8:11], s25 offen sc1
    s_add_u32 s25, s24, 2113536
    buffer_load_dwordx4 v[76:79], v2, s[8:11], s25 offen sc1
    s_add_u32 s25, s24, 2228224
    buffer_load_dwordx4 v[80:83], v2, s[8:11], s25 offen sc1
    s_add_u32 s25, s24, 2244608
    buffer_load_dwordx4 v[84:87], v2, s[8:11], s25 offen sc1
    s_add_u32 s25, s24, 2359296
    buffer_load_dwordx4 v[88:91], v2, s[8:11], s25 offen sc1
    s_add_u32 s25, s24, 2375680
    buffer_load_dwordx4 v[92:95], v2, s[8:11], s25 offen sc1
    s_add_u32 s25, s24, 2490368
    buffer_load_dwordx4 v[96:99], v2, s[8:11], s25 offen sc1
    s_add_u32 s25, s24, 2506752
    buffer_load_dwordx4 v[100:103], v2, s[8:11], s25 offen sc1
    s_waitcnt lgkmcnt(3)
    v_mfma_f32_16x16x32_bf16 v[12:15], v[44:47], v[104:107], v[12:15]
    ds_read_b128 v[60:63], v1 offset:6144
    v_mfma_f32_16x16x32_bf16 v[28:31], v[44:47], v[108:111], v[28:31]
    s_waitcnt lgkmcnt(3)
    v_mfma_f32_16x16x32_bf16 v[16:19], v[48:51], v[104:107], v[16:19]
    ds_read_b128 v[44:47], v1 offset:26624
    v_mfma_f32_16x16x32_bf16 v[32:35], v[48:51], v[108:111], v[32:35]
    s_waitcnt lgkmcnt(3)
    v_mfma_f32_16x16x32_bf16 v[20:23], v[52:55], v[104:107], v[20:23]
    ds_read_b128 v[48:51], v6 offset:6144
    v_mfma_f32_16x16x32_bf16 v[36:39], v[52:55], v[108:111], v[36:39]
    s_waitcnt vmcnt(26)
    v_swap_b32 v114, v116
    v_swap_b32 v115, v117
    s_waitcnt lgkmcnt(3)
    v_mfma_f32_16x16x32_bf16 v[24:27], v[56:59], v[104:107], v[24:27]
    ds_read_b128 v[52:55], v6 offset:26624
    v_mfma_f32_16x16x32_bf16 v[40:43], v[56:59], v[108:111], v[40:43]
    s_waitcnt lgkmcnt(3)
    v_mfma_f32_16x16x32_bf16 v[12:15], v[60:63], v[112:115], v[12:15]
    ds_read_b128 v[56:59], v1 offset:7168
    v_mfma_f32_16x16x32_bf16 v[28:31], v[60:63], v[116:119], v[28:31]
    s_waitcnt lgkmcnt(3)
    v_mfma_f32_16x16x32_bf16 v[16:19], v[44:47], v[112:115], v[16:19]
    ds_read_b128 v[60:63], v1 offset:27648
    v_mfma_f32_16x16x32_bf16 v[32:35], v[44:47], v[116:119], v[32:35]
    s_waitcnt lgkmcnt(3)
    v_mfma_f32_16x16x32_bf16 v[20:23], v[48:51], v[112:115], v[20:23]
    ds_read_b128 v[44:47], v6 offset:7168
    v_mfma_f32_16x16x32_bf16 v[36:39], v[48:51], v[116:119], v[36:39]
    s_waitcnt vmcnt(24)
    v_swap_b32 v122, v124
    v_swap_b32 v123, v125
    s_waitcnt lgkmcnt(3)
    v_mfma_f32_16x16x32_bf16 v[24:27], v[52:55], v[112:115], v[24:27]
    ds_read_b128 v[48:51], v6 offset:27648
    v_mfma_f32_16x16x32_bf16 v[40:43], v[52:55], v[116:119], v[40:43]
    s_waitcnt lgkmcnt(3)
    v_mfma_f32_16x16x32_bf16 v[12:15], v[56:59], v[120:123], v[12:15]
    ds_read_b128 v[52:55], v1 offset:8192
    v_mfma_f32_16x16x32_bf16 v[28:31], v[56:59], v[124:127], v[28:31]
    s_waitcnt lgkmcnt(3)
    v_mfma_f32_16x16x32_bf16 v[16:19], v[60:63], v[120:123], v[16:19]
    ds_read_b128 v[56:59], v1 offset:28672
    v_mfma_f32_16x16x32_bf16 v[32:35], v[60:63], v[124:127], v[32:35]
    s_waitcnt lgkmcnt(3)
    v_mfma_f32_16x16x32_bf16 v[20:23], v[44:47], v[120:123], v[20:23]
    ds_read_b128 v[60:63], v6 offset:8192
    v_mfma_f32_16x16x32_bf16 v[36:39], v[44:47], v[124:127], v[36:39]
    s_waitcnt vmcnt(22)
    v_swap_b32 v130, v132
    v_swap_b32 v131, v133
    s_waitcnt lgkmcnt(3)
    v_mfma_f32_16x16x32_bf16 v[24:27], v[48:51], v[120:123], v[24:27]
    ds_read_b128 v[44:47], v6 offset:28672
    v_mfma_f32_16x16x32_bf16 v[40:43], v[48:51], v[124:127], v[40:43]
    s_waitcnt lgkmcnt(3)
    v_mfma_f32_16x16x32_bf16 v[12:15], v[52:55], v[128:131], v[12:15]
    ds_read_b128 v[48:51], v1 offset:9216
    v_mfma_f32_16x16x32_bf16 v[28:31], v[52:55], v[132:135], v[28:31]
    s_waitcnt lgkmcnt(3)
    v_mfma_f32_16x16x32_bf16 v[16:19], v[56:59], v[128:131], v[16:19]
    ds_read_b128 v[52:55], v1 offset:29696
    v_mfma_f32_16x16x32_bf16 v[32:35], v[56:59], v[132:135], v[32:35]
    s_waitcnt lgkmcnt(3)
    v_mfma_f32_16x16x32_bf16 v[20:23], v[60:63], v[128:131], v[20:23]
    ds_read_b128 v[56:59], v6 offset:9216
    v_mfma_f32_16x16x32_bf16 v[36:39], v[60:63], v[132:135], v[36:39]
    s_waitcnt vmcnt(20)
    v_swap_b32 v138, v140
    v_swap_b32 v139, v141
    s_waitcnt lgkmcnt(3)
    v_mfma_f32_16x16x32_bf16 v[24:27], v[44:47], v[128:131], v[24:27]
    ds_read_b128 v[60:63], v6 offset:29696
    v_mfma_f32_16x16x32_bf16 v[40:43], v[44:47], v[132:135], v[40:43]
    s_waitcnt lgkmcnt(3)
    v_mfma_f32_16x16x32_bf16 v[12:15], v[48:51], v[136:139], v[12:15]
    ds_read_b128 v[44:47], v1 offset:10240
    v_mfma_f32_16x16x32_bf16 v[28:31], v[48:51], v[140:143], v[28:31]
    s_waitcnt lgkmcnt(3)
    v_mfma_f32_16x16x32_bf16 v[16:19], v[52:55], v[136:139], v[16:19]
    ds_read_b128 v[48:51], v1 offset:30720
    v_mfma_f32_16x16x32_bf16 v[32:35], v[52:55], v[140:143], v[32:35]
    s_waitcnt lgkmcnt(3)
    v_mfma_f32_16x16x32_bf16 v[20:23], v[56:59], v[136:139], v[20:23]
    ds_read_b128 v[52:55], v6 offset:10240
    v_mfma_f32_16x16x32_bf16 v[36:39], v[56:59], v[140:143], v[36:39]
    s_waitcnt vmcnt(18)
    v_swap_b32 v146, v148
    v_swap_b32 v147, v149
    s_waitcnt lgkmcnt(3)
    v_mfma_f32_16x16x32_bf16 v[24:27], v[60:63], v[136:139], v[24:27]
    ds_read_b128 v[56:59], v6 offset:30720
    v_mfma_f32_16x16x32_bf16 v[40:43], v[60:63], v[140:143], v[40:43]
    buffer_load_dwordx4 v[104:107], v5, s[8:11], s31 offen offset:0 sc1
    buffer_load_dwordx4 v[108:111], v5, s[8:11], s31 offen offset:64 sc1
    buffer_load_dwordx4 v[112:115], v5, s[8:11], s32 offen offset:0 sc1
    buffer_load_dwordx4 v[116:119], v5, s[8:11], s32 offen offset:64 sc1
    s_waitcnt lgkmcnt(3)
    v_mfma_f32_16x16x32_bf16 v[12:15], v[44:47], v[144:147], v[12:15]
    ds_read_b128 v[60:63], v1 offset:11264
    v_mfma_f32_16x16x32_bf16 v[28:31], v[44:47], v[148:151], v[28:31]
    s_waitcnt lgkmcnt(3)
    v_mfma_f32_16x16x32_bf16 v[16:19], v[48:51], v[144:147], v[16:19]
    ds_read_b128 v[44:47], v1 offset:31744
    v_mfma_f32_16x16x32_bf16 v[32:35], v[48:51], v[148:151], v[32:35]
    s_waitcnt lgkmcnt(3)
    v_mfma_f32_16x16x32_bf16 v[20:23], v[52:55], v[144:147], v[20:23]
    ds_read_b128 v[48:51], v6 offset:11264
    v_mfma_f32_16x16x32_bf16 v[36:39], v[52:55], v[148:151], v[36:39]
    s_waitcnt vmcnt(20)
    v_swap_b32 v154, v156
    v_swap_b32 v155, v157
    s_waitcnt lgkmcnt(3)
    v_mfma_f32_16x16x32_bf16 v[24:27], v[56:59], v[144:147], v[24:27]
    ds_read_b128 v[52:55], v6 offset:31744
    v_mfma_f32_16x16x32_bf16 v[40:43], v[56:59], v[148:151], v[40:43]
    s_waitcnt lgkmcnt(3)
    v_mfma_f32_16x16x32_bf16 v[12:15], v[60:63], v[152:155], v[12:15]
    ds_read_b128 v[56:59], v1 offset:12288
    v_mfma_f32_16x16x32_bf16 v[28:31], v[60:63], v[156:159], v[28:31]
    s_waitcnt lgkmcnt(3)
    v_mfma_f32_16x16x32_bf16 v[16:19], v[44:47], v[152:155], v[16:19]
    ds_read_b128 v[60:63], v1 offset:32768
    v_mfma_f32_16x16x32_bf16 v[32:35], v[44:47], v[156:159], v[32:35]
    s_waitcnt lgkmcnt(3)
    v_mfma_f32_16x16x32_bf16 v[20:23], v[48:51], v[152:155], v[20:23]
    ds_read_b128 v[44:47], v6 offset:12288
    v_mfma_f32_16x16x32_bf16 v[36:39], v[48:51], v[156:159], v[36:39]
    s_waitcnt vmcnt(18)
    v_swap_b32 v162, v164
    v_swap_b32 v163, v165
    s_waitcnt lgkmcnt(3)
    v_mfma_f32_16x16x32_bf16 v[24:27], v[52:55], v[152:155], v[24:27]
    ds_read_b128 v[48:51], v6 offset:32768
    v_mfma_f32_16x16x32_bf16 v[40:43], v[52:55], v[156:159], v[40:43]
    s_waitcnt lgkmcnt(3)
    v_mfma_f32_16x16x32_bf16 v[12:15], v[56:59], v[160:163], v[12:15]
    ds_read_b128 v[52:55], v1 offset:13312
    v_mfma_f32_16x16x32_bf16 v[28:31], v[56:59], v[164:167], v[28:31]
    s_waitcnt lgkmcnt(3)
    v_mfma_f32_16x16x32_bf16 v[16:19], v[60:63], v[160:163], v[16:19]
    ds_read_b128 v[56:59], v1 offset:33792
    v_mfma_f32_16x16x32_bf16 v[32:35], v[60:63], v[164:167], v[32:35]
    s_waitcnt lgkmcnt(3)
    v_mfma_f32_16x16x32_bf16 v[20:23], v[44:47], v[160:163], v[20:23]
    ds_read_b128 v[60:63], v6 offset:13312
    v_mfma_f32_16x16x32_bf16 v[36:39], v[44:47], v[164:167], v[36:39]
    s_waitcnt vmcnt(16)
    v_swap_b32 v170, v172
    v_swap_b32 v171, v173
    s_waitcnt lgkmcnt(3)
    v_mfma_f32_16x16x32_bf16 v[24:27], v[48:51], v[160:163], v[24:27]
    ds_read_b128 v[44:47], v6 offset:33792
    v_mfma_f32_16x16x32_bf16 v[40:43], v[48:51], v[164:167], v[40:43]
    s_waitcnt lgkmcnt(3)
    v_mfma_f32_16x16x32_bf16 v[12:15], v[52:55], v[168:171], v[12:15]
    ds_read_b128 v[48:51], v1 offset:14336
    v_mfma_f32_16x16x32_bf16 v[28:31], v[52:55], v[172:175], v[28:31]
    s_waitcnt lgkmcnt(3)
    v_mfma_f32_16x16x32_bf16 v[16:19], v[56:59], v[168:171], v[16:19]
    ds_read_b128 v[52:55], v1 offset:34816
    v_mfma_f32_16x16x32_bf16 v[32:35], v[56:59], v[172:175], v[32:35]
    s_waitcnt lgkmcnt(3)
    v_mfma_f32_16x16x32_bf16 v[20:23], v[60:63], v[168:171], v[20:23]
    ds_read_b128 v[56:59], v6 offset:14336
    v_mfma_f32_16x16x32_bf16 v[36:39], v[60:63], v[172:175], v[36:39]
    s_waitcnt vmcnt(14)
    v_swap_b32 v178, v180
    v_swap_b32 v179, v181
    s_waitcnt lgkmcnt(3)
    v_mfma_f32_16x16x32_bf16 v[24:27], v[44:47], v[168:171], v[24:27]
    ds_read_b128 v[60:63], v6 offset:34816
    v_mfma_f32_16x16x32_bf16 v[40:43], v[44:47], v[172:175], v[40:43]
    s_waitcnt lgkmcnt(3)
    v_mfma_f32_16x16x32_bf16 v[12:15], v[48:51], v[176:179], v[12:15]
    ds_read_b128 v[44:47], v1 offset:15360
    v_mfma_f32_16x16x32_bf16 v[28:31], v[48:51], v[180:183], v[28:31]
    s_waitcnt lgkmcnt(3)
    v_mfma_f32_16x16x32_bf16 v[16:19], v[52:55], v[176:179], v[16:19]
    ds_read_b128 v[48:51], v1 offset:35840
    v_mfma_f32_16x16x32_bf16 v[32:35], v[52:55], v[180:183], v[32:35]
    s_waitcnt lgkmcnt(3)
    v_mfma_f32_16x16x32_bf16 v[20:23], v[56:59], v[176:179], v[20:23]
    ds_read_b128 v[52:55], v6 offset:15360
    v_mfma_f32_16x16x32_bf16 v[36:39], v[56:59], v[180:183], v[36:39]
    s_waitcnt vmcnt(12)
    v_swap_b32 v66, v68
    v_swap_b32 v67, v69
    s_waitcnt lgkmcnt(3)
    v_mfma_f32_16x16x32_bf16 v[24:27], v[60:63], v[176:179], v[24:27]
    ds_read_b128 v[56:59], v6 offset:35840
    v_mfma_f32_16x16x32_bf16 v[40:43], v[60:63], v[180:183], v[40:43]
    s_waitcnt lgkmcnt(3)
    v_mfma_f32_16x16x32_bf16 v[12:15], v[44:47], v[64:67], v[12:15]
    ds_read_b128 v[60:63], v1 offset:16384
    v_mfma_f32_16x16x32_bf16 v[28:31], v[44:47], v[68:71], v[28:31]
    s_waitcnt lgkmcnt(3)
    v_mfma_f32_16x16x32_bf16 v[16:19], v[48:51], v[64:67], v[16:19]
    ds_read_b128 v[44:47], v1 offset:36864
    v_mfma_f32_16x16x32_bf16 v[32:35], v[48:51], v[68:71], v[32:35]
    s_waitcnt lgkmcnt(3)
    v_mfma_f32_16x16x32_bf16 v[20:23], v[52:55], v[64:67], v[20:23]
    ds_read_b128 v[48:51], v6 offset:16384
    v_mfma_f32_16x16x32_bf16 v[36:39], v[52:55], v[68:71], v[36:39]
    s_waitcnt vmcnt(10)
    v_swap_b32 v74, v76
    v_swap_b32 v75, v77
    s_waitcnt lgkmcnt(3)
    v_mfma_f32_16x16x32_bf16 v[24:27], v[56:59], v[64:67], v[24:27]
    ds_read_b128 v[52:55], v6 offset:36864
    v_mfma_f32_16x16x32_bf16 v[40:43], v[56:59], v[68:71], v[40:43]
    s_waitcnt lgkmcnt(3)
    v_mfma_f32_16x16x32_bf16 v[12:15], v[60:63], v[72:75], v[12:15]
    ds_read_b128 v[56:59], v1 offset:17408
    v_mfma_f32_16x16x32_bf16 v[28:31], v[60:63], v[76:79], v[28:31]
    s_waitcnt lgkmcnt(3)
    v_mfma_f32_16x16x32_bf16 v[16:19], v[44:47], v[72:75], v[16:19]
    ds_read_b128 v[60:63], v1 offset:37888
    v_mfma_f32_16x16x32_bf16 v[32:35], v[44:47], v[76:79], v[32:35]
    s_waitcnt lgkmcnt(3)
    v_mfma_f32_16x16x32_bf16 v[20:23], v[48:51], v[72:75], v[20:23]
    ds_read_b128 v[44:47], v6 offset:17408
    v_mfma_f32_16x16x32_bf16 v[36:39], v[48:51], v[76:79], v[36:39]
    s_waitcnt vmcnt(8)
    v_swap_b32 v82, v84
    v_swap_b32 v83, v85
    s_waitcnt lgkmcnt(3)
    v_mfma_f32_16x16x32_bf16 v[24:27], v[52:55], v[72:75], v[24:27]
    ds_read_b128 v[48:51], v6 offset:37888
    v_mfma_f32_16x16x32_bf16 v[40:43], v[52:55], v[76:79], v[40:43]
    s_waitcnt lgkmcnt(3)
    v_mfma_f32_16x16x32_bf16 v[12:15], v[56:59], v[80:83], v[12:15]
    ds_read_b128 v[52:55], v1 offset:18432
    v_mfma_f32_16x16x32_bf16 v[28:31], v[56:59], v[84:87], v[28:31]
    s_waitcnt lgkmcnt(3)
    v_mfma_f32_16x16x32_bf16 v[16:19], v[60:63], v[80:83], v[16:19]
    ds_read_b128 v[56:59], v1 offset:38912
    v_mfma_f32_16x16x32_bf16 v[32:35], v[60:63], v[84:87], v[32:35]
    s_waitcnt lgkmcnt(3)
    v_mfma_f32_16x16x32_bf16 v[20:23], v[44:47], v[80:83], v[20:23]
    ds_read_b128 v[60:63], v6 offset:18432
    v_mfma_f32_16x16x32_bf16 v[36:39], v[44:47], v[84:87], v[36:39]
    s_waitcnt vmcnt(6)
    v_swap_b32 v90, v92
    v_swap_b32 v91, v93
    s_waitcnt lgkmcnt(3)
    v_mfma_f32_16x16x32_bf16 v[24:27], v[48:51], v[80:83], v[24:27]
    ds_read_b128 v[44:47], v6 offset:38912
    v_mfma_f32_16x16x32_bf16 v[40:43], v[48:51], v[84:87], v[40:43]
    s_waitcnt lgkmcnt(3)
    v_mfma_f32_16x16x32_bf16 v[12:15], v[52:55], v[88:91], v[12:15]
    ds_read_b128 v[48:51], v1 offset:19456
    v_mfma_f32_16x16x32_bf16 v[28:31], v[52:55], v[92:95], v[28:31]
    s_waitcnt lgkmcnt(3)
    v_mfma_f32_16x16x32_bf16 v[16:19], v[56:59], v[88:91], v[16:19]
    ds_read_b128 v[52:55], v1 offset:39936
    v_mfma_f32_16x16x32_bf16 v[32:35], v[56:59], v[92:95], v[32:35]
    s_waitcnt lgkmcnt(3)
    v_mfma_f32_16x16x32_bf16 v[20:23], v[60:63], v[88:91], v[20:23]
    ds_read_b128 v[56:59], v6 offset:19456
    v_mfma_f32_16x16x32_bf16 v[36:39], v[60:63], v[92:95], v[36:39]
    s_waitcnt vmcnt(4)
    v_swap_b32 v98, v100
    v_swap_b32 v99, v101
    s_waitcnt lgkmcnt(3)
    v_mfma_f32_16x16x32_bf16 v[24:27], v[44:47], v[88:91], v[24:27]
    ds_read_b128 v[60:63], v6 offset:39936
    v_mfma_f32_16x16x32_bf16 v[40:43], v[44:47], v[92:95], v[40:43]
    s_waitcnt lgkmcnt(3)
    v_mfma_f32_16x16x32_bf16 v[12:15], v[48:51], v[96:99], v[12:15]
    v_mfma_f32_16x16x32_bf16 v[28:31], v[48:51], v[100:103], v[28:31]
    s_waitcnt lgkmcnt(2)
    v_mfma_f32_16x16x32_bf16 v[16:19], v[52:55], v[96:99], v[16:19]
    v_mfma_f32_16x16x32_bf16 v[32:35], v[52:55], v[100:103], v[32:35]
    s_waitcnt lgkmcnt(1)
    v_mfma_f32_16x16x32_bf16 v[20:23], v[56:59], v[96:99], v[20:23]
    v_mfma_f32_16x16x32_bf16 v[36:39], v[56:59], v[100:103], v[36:39]
    s_waitcnt lgkmcnt(0)
    v_mfma_f32_16x16x32_bf16 v[24:27], v[60:63], v[96:99], v[24:27]
    v_mfma_f32_16x16x32_bf16 v[40:43], v[60:63], v[100:103], v[40:43]
    s_waitcnt vmcnt(3)
    v_lshlrev_b32 v8, 16, v104
    v_and_b32 v9, 0xffff0000, v104
    v_pk_add_f32 v[12:13], v[12:13], v[8:9]
    v_cvt_pk_bf16_f32 v104, v12, v13
    v_lshlrev_b32 v8, 16, v105
    v_and_b32 v9, 0xffff0000, v105
    v_pk_add_f32 v[14:15], v[14:15], v[8:9]
    v_cvt_pk_bf16_f32 v105, v14, v15
    v_lshlrev_b32 v8, 16, v106
    v_and_b32 v9, 0xffff0000, v106
    v_pk_add_f32 v[16:17], v[16:17], v[8:9]
    v_cvt_pk_bf16_f32 v106, v16, v17
    v_lshlrev_b32 v8, 16, v107
    v_and_b32 v9, 0xffff0000, v107
    v_pk_add_f32 v[18:19], v[18:19], v[8:9]
    v_cvt_pk_bf16_f32 v107, v18, v19
    s_waitcnt vmcnt(2)
    v_lshlrev_b32 v8, 16, v108
    v_and_b32 v9, 0xffff0000, v108
    v_pk_add_f32 v[20:21], v[20:21], v[8:9]
    v_cvt_pk_bf16_f32 v108, v20, v21
    v_lshlrev_b32 v8, 16, v109
    v_and_b32 v9, 0xffff0000, v109
    v_pk_add_f32 v[22:23], v[22:23], v[8:9]
    v_cvt_pk_bf16_f32 v109, v22, v23
    v_lshlrev_b32 v8, 16, v110
    v_and_b32 v9, 0xffff0000, v110
    v_pk_add_f32 v[24:25], v[24:25], v[8:9]
    v_cvt_pk_bf16_f32 v110, v24, v25
    v_lshlrev_b32 v8, 16, v111
    v_and_b32 v9, 0xffff0000, v111
    v_pk_add_f32 v[26:27], v[26:27], v[8:9]
    v_cvt_pk_bf16_f32 v111, v26, v27
    s_waitcnt vmcnt(1)
    v_lshlrev_b32 v8, 16, v112
    v_and_b32 v9, 0xffff0000, v112
    v_pk_add_f32 v[28:29], v[28:29], v[8:9]
    v_cvt_pk_bf16_f32 v112, v28, v29
    v_lshlrev_b32 v8, 16, v113
    v_and_b32 v9, 0xffff0000, v113
    v_pk_add_f32 v[30:31], v[30:31], v[8:9]
    v_cvt_pk_bf16_f32 v113, v30, v31
    v_lshlrev_b32 v8, 16, v114
    v_and_b32 v9, 0xffff0000, v114
    v_pk_add_f32 v[32:33], v[32:33], v[8:9]
    v_cvt_pk_bf16_f32 v114, v32, v33
    v_lshlrev_b32 v8, 16, v115
    v_and_b32 v9, 0xffff0000, v115
    v_pk_add_f32 v[34:35], v[34:35], v[8:9]
    v_cvt_pk_bf16_f32 v115, v34, v35
    s_waitcnt vmcnt(0)
    v_lshlrev_b32 v8, 16, v116
    v_and_b32 v9, 0xffff0000, v116
    v_pk_add_f32 v[36:37], v[36:37], v[8:9]
    v_cvt_pk_bf16_f32 v116, v36, v37
    v_lshlrev_b32 v8, 16, v117
    v_and_b32 v9, 0xffff0000, v117
    v_pk_add_f32 v[38:39], v[38:39], v[8:9]
    v_cvt_pk_bf16_f32 v117, v38, v39
    v_lshlrev_b32 v8, 16, v118
    v_and_b32 v9, 0xffff0000, v118
    v_pk_add_f32 v[40:41], v[40:41], v[8:9]
    v_cvt_pk_bf16_f32 v118, v40, v41
    v_lshlrev_b32 v8, 16, v119
    v_and_b32 v9, 0xffff0000, v119
    v_pk_add_f32 v[42:43], v[42:43], v[8:9]
    v_cvt_pk_bf16_f32 v119, v42, v43
    s_cmp_eq_u32 s101, 1
    s_cbranch_scc1 M_id_out
    v_lshlrev_b32 v12, 16, v104
    v_and_b32 v13, 0xffff0000, v104
    v_lshlrev_b32 v14, 16, v105
    v_and_b32 v15, 0xffff0000, v105
    v_lshlrev_b32 v16, 16, v106
    v_and_b32 v17, 0xffff0000, v106
    v_lshlrev_b32 v18, 16, v107
    v_and_b32 v19, 0xffff0000, v107
    v_lshlrev_b32 v20, 16, v108
    v_and_b32 v21, 0xffff0000, v108
    v_lshlrev_b32 v22, 16, v109
    v_and_b32 v23, 0xffff0000, v109
    v_lshlrev_b32 v24, 16, v110
    v_and_b32 v25, 0xffff0000, v110
    v_lshlrev_b32 v26, 16, v111
    v_and_b32 v27, 0xffff0000, v111
    v_lshlrev_b32 v28, 16, v112
    v_and_b32 v29, 0xffff0000, v112
    v_lshlrev_b32 v30, 16, v113
    v_and_b32 v31, 0xffff0000, v113
    v_lshlrev_b32 v32, 16, v114
    v_and_b32 v33, 0xffff0000, v114
    v_lshlrev_b32 v34, 16, v115
    v_and_b32 v35, 0xffff0000, v115
    v_lshlrev_b32 v36, 16, v116
    v_and_b32 v37, 0xffff0000, v116
    v_lshlrev_b32 v38, 16, v117
    v_and_b32 v39, 0xffff0000, v117
    v_lshlrev_b32 v40, 16, v118
    v_and_b32 v41, 0xffff0000, v118
    v_lshlrev_b32 v42, 16, v119
    v_and_b32 v43, 0xffff0000, v119
    v_pk_add_f32 v[124:125], v[12:13], v[14:15]
    v_pk_add_f32 v[128:129], v[28:29], v[30:31]
    v_pk_add_f32 v[124:125], v[124:125], v[16:17]
    v_pk_add_f32 v[128:129], v[128:129], v[32:33]
    v_pk_add_f32 v[124:125], v[124:125], v[18:19]
    v_pk_add_f32 v[128:129], v[128:129], v[34:35]
    v_pk_add_f32 v[124:125], v[124:125], v[20:21]
    v_pk_add_f32 v[128:129], v[128:129], v[36:37]
    v_pk_add_f32 v[124:125], v[124:125], v[22:23]
    v_pk_add_f32 v[128:129], v[128:129], v[38:39]
    v_pk_add_f32 v[124:125], v[124:125], v[24:25]
    v_pk_add_f32 v[128:129], v[128:129], v[40:41]
    v_pk_add_f32 v[124:125], v[124:125], v[26:27]
    v_pk_add_f32 v[128:129], v[128:129], v[42:43]
    v_add_f32 v124, v124, v125
    v_add_f32 v128, v128, v129
    v_mov_b32 v132, v124
    v_mov_b32 v133, v128
    s_nop 0
    v_permlane16_swap_b32 v124, v132
    v_permlane16_swap_b32 v128, v133
    v_add_f32 v124, v124, v132
    v_add_f32 v128, v128, v133
    v_mov_b32 v132, v124
    v_mov_b32 v133, v128
    s_nop 0
    v_permlane32_swap_b32 v124, v132
    v_permlane32_swap_b32 v128, v133
    v_add_f32 v124, v124, v132
    v_add_f32 v128, v128, v133
    v_mul_f32 v124, 0x3c800000, v124
    v_mov_b64 v[126:127], 0
    v_mul_f32 v128, 0x3c800000, v128
    v_mov_b64 v[130:131], 0
    v_pk_add_f32 v[8:9], v[12:13], v[124:125] op_sel_hi:[1,0] neg_lo:[0,1] neg_hi:[0,1]
    v_pk_add_f32 v[10:11], v[28:29], v[128:129] op_sel_hi:[1,0] neg_lo:[0,1] neg_hi:[0,1]
    v_pk_fma_f32 v[126:127], v[8:9], v[8:9], v[126:127]
    v_pk_fma_f32 v[130:131], v[10:11], v[10:11], v[130:131]
    v_pk_add_f32 v[8:9], v[14:15], v[124:125] op_sel_hi:[1,0] neg_lo:[0,1] neg_hi:[0,1]
    v_pk_add_f32 v[10:11], v[30:31], v[128:129] op_sel_hi:[1,0] neg_lo:[0,1] neg_hi:[0,1]
    v_pk_fma_f32 v[126:127], v[8:9], v[8:9], v[126:127]
    v_pk_fma_f32 v[130:131], v[10:11], v[10:11], v[130:131]
    v_pk_add_f32 v[8:9], v[16:17], v[124:125] op_sel_hi:[1,0] neg_lo:[0,1] neg_hi:[0,1]
    v_pk_add_f32 v[10:11], v[32:33], v[128:129] op_sel_hi:[1,0] neg_lo:[0,1] neg_hi:[0,1]
    v_pk_fma_f32 v[126:127], v[8:9], v[8:9], v[126:127]
    v_pk_fma_f32 v[130:131], v[10:11], v[10:11], v[130:131]
    v_pk_add_f32 v[8:9], v[18:19], v[124:125] op_sel_hi:[1,0] neg_lo:[0,1] neg_hi:[0,1]
    v_pk_add_f32 v[10:11], v[34:35], v[128:129] op_sel_hi:[1,0] neg_lo:[0,1] neg_hi:[0,1]
    v_pk_fma_f32 v[126:127], v[8:9], v[8:9], v[126:127]
    v_pk_fma_f32 v[130:131], v[10:11], v[10:11], v[130:131]
    v_pk_add_f32 v[8:9], v[20:21], v[124:125] op_sel_hi:[1,0] neg_lo:[0,1] neg_hi:[0,1]
    v_pk_add_f32 v[10:11], v[36:37], v[128:129] op_sel_hi:[1,0] neg_lo:[0,1] neg_hi:[0,1]
    v_pk_fma_f32 v[126:127], v[8:9], v[8:9], v[126:127]
    v_pk_fma_f32 v[130:131], v[10:11], v[10:11], v[130:131]
    v_pk_add_f32 v[8:9], v[22:23], v[124:125] op_sel_hi:[1,0] neg_lo:[0,1] neg_hi:[0,1]
    v_pk_add_f32 v[10:11], v[38:39], v[128:129] op_sel_hi:[1,0] neg_lo:[0,1] neg_hi:[0,1]
    v_pk_fma_f32 v[126:127], v[8:9], v[8:9], v[126:127]
    v_pk_fma_f32 v[130:131], v[10:11], v[10:11], v[130:131]
    v_pk_add_f32 v[8:9], v[24:25], v[124:125] op_sel_hi:[1,0] neg_lo:[0,1] neg_hi:[0,1]
    v_pk_add_f32 v[10:11], v[40:41], v[128:129] op_sel_hi:[1,0] neg_lo:[0,1] neg_hi:[0,1]
    v_pk_fma_f32 v[126:127], v[8:9], v[8:9], v[126:127]
    v_pk_fma_f32 v[130:131], v[10:11], v[10:11], v[130:131]
    v_pk_add_f32 v[8:9], v[26:27], v[124:125] op_sel_hi:[1,0] neg_lo:[0,1] neg_hi:[0,1]
    v_pk_add_f32 v[10:11], v[42:43], v[128:129] op_sel_hi:[1,0] neg_lo:[0,1] neg_hi:[0,1]
    v_pk_fma_f32 v[126:127], v[8:9], v[8:9], v[126:127]
    v_pk_fma_f32 v[130:131], v[10:11], v[10:11], v[130:131]
    v_add_f32 v125, v126, v127
    v_add_f32 v129, v130, v131
    v_mov_b32 v132, v125
    v_mov_b32 v133, v129
    s_nop 0
    v_permlane16_swap_b32 v125, v132
    v_permlane16_swap_b32 v129, v133
    v_add_f32 v125, v125, v132
    v_add_f32 v129, v129, v133
    v_mov_b32 v132, v125
    v_mov_b32 v133, v129
    s_nop 0
    v_permlane32_swap_b32 v125, v132
    v_permlane32_swap_b32 v129, v133
    v_add_f32 v125, v125, v132
    v_add_f32 v129, v129, v133
    v_min_u32 v124, -2, v124
    v_min_u32 v125, -2, v125
    v_min_u32 v128, -2, v128
    v_min_u32 v129, -2, v129
    s_lshl_b32 s24, s89, 12
    s_add_u32 s24, s24, 173654016
    s_lshl_b32 s25, s88, 3
    s_add_u32 s25, s25, s24
    v_lshlrev_b32 v7, 7, v4
    v_lshl_add_u32 v2, v3, 5, v7
    s_mov_b64 exec, 0xffff
    s_cmp_lg_u32 s23, 0
    s_cbranch_scc1 M_ls_39
    buffer_store_dwordx2 v[124:125], v7, s[8:11], s25 offen offset:0
    buffer_store_dwordx2 v[128:129], v7, s[8:11], s25 offen offset:2048
M_ls_39_r:
    s_mov_b64 exec, -1
    v_cmp_gt_u32_e64 s[36:37], 3, v3
    v_cmp_gt_u32_e64 s[38:39], 2, v3
    s_mov_b32 s34, 0
M_id_poll:
    buffer_load_dwordx4 v[136:139], v2, s[8:11], s24 offen offset:0 sc1
    buffer_load_dwordx4 v[140:143], v2, s[8:11], s24 offen offset:16 sc1
    buffer_load_dwordx4 v[144:147], v2, s[8:11], s24 offen offset:2048 sc1
    buffer_load_dwordx4 v[148:151], v2, s[8:11], s24 offen offset:2064 sc1
    s_add_u32 s34, s34, 1
    s_cmp_ge_u32 s34, 60000
    s_cbranch_scc1 M_fail
    s_waitcnt vmcnt(3)
    v_cndmask_b32_e64 v136, 0, v136, s[36:37]
    v_cndmask_b32_e64 v137, 0, v137, s[36:37]
    v_cndmask_b32_e64 v138, 0, v138, s[36:37]
    v_cndmask_b32_e64 v139, 0, v139, s[36:37]
    s_waitcnt vmcnt(2)
    v_cndmask_b32_e64 v140, 0, v140, s[38:39]
    v_cndmask_b32_e64 v141, 0, v141, s[38:39]
    v_cndmask_b32_e64 v142, 0, v142, s[38:39]
    v_cndmask_b32_e64 v143, 0, v143, s[38:39]
    s_waitcnt vmcnt(1)
    v_cndmask_b32_e64 v144, 0, v144, s[36:37]
    v_cndmask_b32_e64 v145, 0, v145, s[36:37]
    v_cndmask_b32_e64 v146, 0, v146, s[36:37]
    v_cndmask_b32_e64 v147, 0, v147, s[36:37]
    s_waitcnt vmcnt(0)
    v_cndmask_b32_e64 v148, 0, v148, s[38:39]
    v_cndmask_b32_e64 v149, 0, v149, s[38:39]
    v_cndmask_b32_e64 v150, 0, v150, s[38:39]
    v_cndmask_b32_e64 v151, 0, v151, s[38:39]
    v_max3_u32 v8, v136, v137, v138
    v_max3_u32 v8, v8, v139, v140
    v_max3_u32 v8, v8, v141, v142
    v_max3_u32 v8, v8, v143, v144
    v_max3_u32 v8, v8, v145, v146
    v_max3_u32 v8, v8, v147, v148
    v_max3_u32 v8, v8, v149, v150
    v_max_u32 v8, v8, v151
    v_cmp_eq_u32 vcc, -1, v8
    s_cbranch_vccnz M_id_poll
    v_add_f32 v124, v136, v138
    v_add_f32 v125, v140, v142
    v_add_f32 v124, v124, v125
    v_add_f32 v128, v144, v146
    v_add_f32 v129, v148, v150
    v_add_f32 v128, v128, v129
    v_mov_b32 v132, v124
    v_mov_b32 v133, v128
    s_nop 0
    v_permlane16_swap_b32 v124, v132
    v_permlane16_swap_b32 v128, v133
    v_add_f32 v124, v124, v132
    v_add_f32 v128, v128, v133
    v_mov_b32 v132, v124
    v_mov_b32 v133, v128
    s_nop 0
    v_permlane32_swap_b32 v124, v132
    v_permlane32_swap_b32 v128, v133
    v_add_f32 v124, v124, v132
    v_add_f32 v128, v128, v133
    v_mul_f32 v124, 0x3dcccccd, v124
    v_add_f32 v125, v137, v139
    v_add_f32 v126, v141, v143
    v_add_f32 v125, v125, v126
    v_sub_f32 v8, v136, v124
    v_cndmask_b32_e64 v8, 0, v8, s[36:37]
    v_mul_f32 v9, 0x42800000, v8
    v_fmac_f32 v125, v8, v9
    v_sub_f32 v8, v138, v124
    v_cndmask_b32_e64 v8, 0, v8, s[36:37]
    v_mul_f32 v9, 0x42800000, v8
    v_fmac_f32 v125, v8, v9
    v_sub_f32 v8, v140, v124
    v_cndmask_b32_e64 v8, 0, v8, s[38:39]
    v_mul_f32 v9, 0x42800000, v8
    v_fmac_f32 v125, v8, v9
    v_sub_f32 v8, v142, v124
    v_cndmask_b32_e64 v8, 0, v8, s[38:39]
    v_mul_f32 v9, 0x42800000, v8
    v_fmac_f32 v125, v8, v9
    v_mul_f32 v128, 0x3dcccccd, v128
    v_add_f32 v129, v145, v147
    v_add_f32 v130, v149, v151
    v_add_f32 v129, v129, v130
    v_sub_f32 v8, v144, v128
    v_cndmask_b32_e64 v8, 0, v8, s[36:37]
    v_mul_f32 v9, 0x42800000, v8
    v_fmac_f32 v129, v8, v9
    v_sub_f32 v8, v146, v128
    v_cndmask_b32_e64 v8, 0, v8, s[36:37]
    v_mul_f32 v9, 0x42800000, v8
    v_fmac_f32 v129, v8, v9
    v_sub_f32 v8, v148, v128
    v_cndmask_b32_e64 v8, 0, v8, s[38:39]
    v_mul_f32 v9, 0x42800000, v8
    v_fmac_f32 v129, v8, v9
    v_sub_f32 v8, v150, v128
    v_cndmask_b32_e64 v8, 0, v8, s[38:39]
    v_mul_f32 v9, 0x42800000, v8
    v_fmac_f32 v129, v8, v9
    v_mov_b32 v132, v125
    v_mov_b32 v133, v129
    s_nop 0
    v_permlane16_swap_b32 v125, v132
    v_permlane16_swap_b32 v129, v133
    v_add_f32 v125, v125, v132
    v_add_f32 v129, v129, v133
    v_mov_b32 v132, v125
    v_mov_b32 v133, v129
    s_nop 0
    v_permlane32_swap_b32 v125, v132
    v_permlane32_swap_b32 v129, v133
    v_add_f32 v125, v125, v132
    v_add_f32 v129, v129, v133
    v_mov_b32 v126, 0x3727c5ac
    v_fmac_f32 v126, 0x3acccccd, v125
    v_rsq_f32 v126, v126
    v_mov_b32 v130, 0x3727c5ac
    v_fmac_f32 v130, 0x3acccccd, v129
    v_rsq_f32 v130, v130
    s_lshl_b32 s25, s88, 11
    s_add_u32 s25, s25, s29
    s_add_u32 s25, s25, 32505856
    s_add_u32 s24, s25, 20480
    v_pk_add_f32 v[12:13], v[12:13], v[124:125] op_sel_hi:[1,0] neg_lo:[0,1] neg_hi:[0,1]
    v_pk_add_f32 v[14:15], v[14:15], v[124:125] op_sel_hi:[1,0] neg_lo:[0,1] neg_hi:[0,1]
    v_pk_add_f32 v[16:17], v[16:17], v[124:125] op_sel_hi:[1,0] neg_lo:[0,1] neg_hi:[0,1]
    v_pk_add_f32 v[18:19], v[18:19], v[124:125] op_sel_hi:[1,0] neg_lo:[0,1] neg_hi:[0,1]
    v_pk_add_f32 v[20:21], v[20:21], v[124:125] op_sel_hi:[1,0] neg_lo:[0,1] neg_hi:[0,1]
    v_pk_add_f32 v[22:23], v[22:23], v[124:125] op_sel_hi:[1,0] neg_lo:[0,1] neg_hi:[0,1]
    v_pk_add_f32 v[24:25], v[24:25], v[124:125] op_sel_hi:[1,0] neg_lo:[0,1] neg_hi:[0,1]
    v_pk_add_f32 v[26:27], v[26:27], v[124:125] op_sel_hi:[1,0] neg_lo:[0,1] neg_hi:[0,1]
    v_pk_mul_f32 v[12:13], v[12:13], v[126:127] op_sel_hi:[1,0]
    v_pk_mul_f32 v[14:15], v[14:15], v[126:127] op_sel_hi:[1,0]
    v_pk_mul_f32 v[16:17], v[16:17], v[126:127] op_sel_hi:[1,0]
    v_pk_mul_f32 v[18:19], v[18:19], v[126:127] op_sel_hi:[1,0]
    v_pk_mul_f32 v[20:21], v[20:21], v[126:127] op_sel_hi:[1,0]
    v_pk_mul_f32 v[22:23], v[22:23], v[126:127] op_sel_hi:[1,0]
    v_pk_mul_f32 v[24:25], v[24:25], v[126:127] op_sel_hi:[1,0]
    v_pk_mul_f32 v[26:27], v[26:27], v[126:127] op_sel_hi:[1,0]
    v_cvt_pk_bf16_f32 v12, v12, v13
    v_cvt_pk_bf16_f32 v13, v14, v15
    v_cvt_pk_bf16_f32 v14, v16, v17
    v_cvt_pk_bf16_f32 v15, v18, v19
    v_cvt_pk_bf16_f32 v16, v20, v21
    v_cvt_pk_bf16_f32 v17, v22, v23
    v_cvt_pk_bf16_f32 v18, v24, v25
    v_cvt_pk_bf16_f32 v19, v26, v27
    v_pk_add_f32 v[28:29], v[28:29], v[128:129] op_sel_hi:[1,0] neg_lo:[0,1] neg_hi:[0,1]
    v_pk_add_f32 v[30:31], v[30:31], v[128:129] op_sel_hi:[1,0] neg_lo:[0,1] neg_hi:[0,1]
    v_pk_add_f32 v[32:33], v[32:33], v[128:129] op_sel_hi:[1,0] neg_lo:[0,1] neg_hi:[0,1]
    v_pk_add_f32 v[34:35], v[34:35], v[128:129] op_sel_hi:[1,0] neg_lo:[0,1] neg_hi:[0,1]
    v_pk_add_f32 v[36:37], v[36:37], v[128:129] op_sel_hi:[1,0] neg_lo:[0,1] neg_hi:[0,1]
    v_pk_add_f32 v[38:39], v[38:39], v[128:129] op_sel_hi:[1,0] neg_lo:[0,1] neg_hi:[0,1]
    v_pk_add_f32 v[40:41], v[40:41], v[128:129] op_sel_hi:[1,0] neg_lo:[0,1] neg_hi:[0,1]
    v_pk_add_f32 v[42:43], v[42:43], v[128:129] op_sel_hi:[1,0] neg_lo:[0,1] neg_hi:[0,1]
    v_pk_mul_f32 v[28:29], v[28:29], v[130:131] op_sel_hi:[1,0]
    v_pk_mul_f32 v[30:31], v[30:31], v[130:131] op_sel_hi:[1,0]
    v_pk_mul_f32 v[32:33], v[32:33], v[130:131] op_sel_hi:[1,0]
    v_pk_mul_f32 v[34:35], v[34:35], v[130:131] op_sel_hi:[1,0]
    v_pk_mul_f32 v[36:37], v[36:37], v[130:131] op_sel_hi:[1,0]
    v_pk_mul_f32 v[38:39], v[38:39], v[130:131] op_sel_hi:[1,0]
    v_pk_mul_f32 v[40:41], v[40:41], v[130:131] op_sel_hi:[1,0]
    v_pk_mul_f32 v[42:43], v[42:43], v[130:131] op_sel_hi:[1,0]
    v_cvt_pk_bf16_f32 v28, v28, v29
    v_cvt_pk_bf16_f32 v29, v30, v31
    v_cvt_pk_bf16_f32 v30, v32, v33
    v_cvt_pk_bf16_f32 v31, v34, v35
    v_cvt_pk_bf16_f32 v32, v36, v37
    v_cvt_pk_bf16_f32 v33, v38, v39
    v_cvt_pk_bf16_f32 v34, v40, v41
    v_cvt_pk_bf16_f32 v35, v42, v43
    s_cmp_lg_u32 s82, 0
    s_cbranch_scc1 M_id_nl
    s_add_u32 s34, s25, 76546048
    s_add_u32 s35, s34, 20480
    s_cmp_lg_u32 s23, 0
    s_cbranch_scc1 M_ls_40
    buffer_store_dwordx4 v[12:15], v1, s[8:11], s34 offen offset:0
    buffer_store_dwordx4 v[16:19], v1, s[8:11], s34 offen offset:1024
    buffer_store_dwordx4 v[28:31], v1, s[8:11], s35 offen offset:0
    buffer_store_dwordx4 v[32:35], v1, s[8:11], s35 offen offset:1024
M_ls_40_r:
    s_mul_i32 s34, s89, 10
    s_add_u32 s34, s34, s88
    s_add_u32 s34, s34, 167956480
    v_mov_b32 v8, 1
    s_waitcnt vmcnt(0)
    s_mov_b64 exec, 1
    s_cmp_lg_u32 s23, 0
    s_cbranch_scc1 M_ls_41
    buffer_store_byte v8, v1, s[8:11], s34 offen
M_ls_41_r:
    s_mov_b64 exec, -1
    s_mov_b32 s68, s25
    s_mov_b32 s69, s24
    s_mov_b32 s70, s30
    s_mov_b32 s71, s33
    s_branch M_noid
M_id_nl:
    buffer_store_dwordx4 v[12:15], v1, s[8:11], s25 offen offset:0 sc1
    buffer_store_dwordx4 v[16:19], v1, s[8:11], s25 offen offset:1024 sc1
    buffer_store_dwordx4 v[28:31], v1, s[8:11], s24 offen offset:0 sc1
    buffer_store_dwordx4 v[32:35], v1, s[8:11], s24 offen offset:1024 sc1
M_id_out:
    buffer_store_dwordx4 v[104:107], v5, s[16:19], s30 offen offset:0 sc1
    buffer_store_dwordx4 v[108:111], v5, s[16:19], s30 offen offset:64 sc1
    buffer_store_dwordx4 v[112:115], v5, s[16:19], s33 offen offset:0 sc1
    buffer_store_dwordx4 v[116:119], v5, s[16:19], s33 offen offset:64 sc1
    s_cmp_eq_u32 s101, 1
    s_cbranch_scc1 M_end
    s_lshl_b32 s24, s89, 7
    s_lshl_b32 s25, s88, 2
    s_add_u32 s24, s24, s25
    s_add_u32 s24, s24, 167919616
    v_mov_b32 v8, 1
    s_waitcnt vmcnt(0)
    s_mov_b64 exec, 1
    buffer_store_dword v8, v1, s[8:11], s24 offen sc1
    s_mov_b64 exec, -1
M_noid:
    s_add_u32 s20, s82, 2
    s_mov_b32 s21, s83
    s_mov_b32 s22, s84
    s_mov_b32 s23, s85
    s_cmp_eq_u32 s101, 1
    s_cbranch_scc1 M_end
    s_mov_b32 s101, 1
    v_mbcnt_lo_u32_b32 v0, -1, 0
    v_mbcnt_hi_u32_b32 v0, -1, v0
    v_lshlrev_b32 v0, 4, v0
    s_waitcnt lgkmcnt(0)
    s_barrier
    s_branch M_bulk
M_ls_12:
    s_nop 7
    buffer_store_byte v11, v10, s[8:11], s62 offen sc1
    s_branch M_ls_12_r
M_ls_15:
    s_nop 7
    buffer_store_dwordx4 v[64:67], v4, s[8:11], s48 offen offset:0 sc1
    buffer_store_dwordx4 v[72:75], v4, s[8:11], s27 offen offset:0 sc1
    s_branch M_ls_15_r
M_ls_16:
    s_nop 7
    buffer_store_dwordx4 v[80:83], v4, s[8:11], s48 offen offset:64 sc1
    buffer_store_dwordx4 v[88:91], v4, s[8:11], s27 offen offset:64 sc1
    s_branch M_ls_16_r
M_ls_17:
    s_nop 7
    buffer_store_dwordx4 v[96:99], v4, s[8:11], s48 offen offset:128 sc1
    buffer_store_dwordx4 v[104:107], v4, s[8:11], s27 offen offset:128 sc1
    s_branch M_ls_17_r
M_ls_18:
    s_nop 7
    buffer_store_dwordx4 v[112:115], v4, s[8:11], s48 offen offset:192 sc1
    buffer_store_dwordx4 v[120:123], v4, s[8:11], s27 offen offset:192 sc1
    s_branch M_ls_18_r
M_ls_19:
    s_nop 7
    buffer_store_dwordx4 v[128:131], v4, s[8:11], s48 offen offset:256 sc1
    buffer_store_dwordx4 v[136:139], v4, s[8:11], s27 offen offset:256 sc1
    s_branch M_ls_19_r
M_ls_20:
    s_nop 7
    buffer_store_byte v11, v10, s[8:11], s62 offen sc1
    s_branch M_ls_20_r
M_ls_23:
    s_nop 7
    s_mov_b32 exec_hi, 0
    buffer_store_dwordx2 v[72:73], v12, s[8:11], s63 offen sc1
    s_mov_b32 exec_lo, 0x000f000f
    buffer_store_dwordx2 v[74:75], v12, s[8:11], s64 offen sc1
    s_mov_b64 exec, -1
    s_branch M_ls_23_r
M_ls_24:
    s_nop 7
    buffer_store_byte v11, v10, s[8:11], s62 offen sc1
    s_branch M_ls_24_r
M_ls_36:
    s_nop 7
    buffer_store_byte v191, v190, s[8:11], s28 offen sc1
    s_branch M_ls_36_r
M_ls_39:
    s_nop 7
    buffer_store_dwordx2 v[124:125], v7, s[8:11], s25 offen offset:0 sc1
    buffer_store_dwordx2 v[128:129], v7, s[8:11], s25 offen offset:2048 sc1
    s_branch M_ls_39_r
M_ls_40:
    s_nop 7
    buffer_store_dwordx4 v[12:15], v1, s[8:11], s34 offen offset:0 sc1
    buffer_store_dwordx4 v[16:19], v1, s[8:11], s34 offen offset:1024 sc1
    buffer_store_dwordx4 v[28:31], v1, s[8:11], s35 offen offset:0 sc1
    buffer_store_dwordx4 v[32:35], v1, s[8:11], s35 offen offset:1024 sc1
    s_branch M_ls_40_r
M_ls_41:
    s_nop 7
    buffer_store_byte v8, v1, s[8:11], s34 offen sc1
    s_branch M_ls_41_r
M_fail:
    s_mov_b64 exec, 1
    v_mov_b32 v12, 1
    v_mov_b32 v13, 48
    buffer_atomic_add v12, v13, s[12:15], 0 offen
M_end:
    s_endpgm

.section .rodata,"a"
.p2align 6
.amdhsa_kernel interleave_layers__memory_aug_recurrent_mem_tr__spectral_gfnet__prompt_kernel
  .amdhsa_next_free_vgpr 512
  .amdhsa_next_free_sgpr 102
  .amdhsa_accum_offset 256
  .amdhsa_group_segment_fixed_size 0
  .amdhsa_kernarg_size 104
  .amdhsa_user_sgpr_count 2
  .amdhsa_user_sgpr_kernarg_segment_ptr 1
  .amdhsa_system_sgpr_workgroup_id_x 1
  .amdhsa_float_denorm_mode_32 3
  .amdhsa_float_denorm_mode_16_64 3
.end_amdhsa_kernel
```

```asm
; @launch kernel=interleave_layers__memory_aug_recurrent_mem_tr__spectral_gfnet__prompt_kernel grid=(256,1,1) block=(256,1,1) lds=163840
.amdgcn_target "amdgcn-amd-amdhsa--gfx950"
.text
.globl interleave_layers__memory_aug_recurrent_mem_tr__spectral_gfnet__prompt_kernel
.p2align 8
.type interleave_layers__memory_aug_recurrent_mem_tr__spectral_gfnet__prompt_kernel,@function
interleave_layers__memory_aug_recurrent_mem_tr__spectral_gfnet__prompt_kernel:
    s_cmp_ge_u32 s2, 256
    s_cbranch_scc1 M_end
    s_load_dwordx2 s[16:17], s[0:1], 0
    s_load_dwordx2 s[8:9], s[0:1], 96
    s_load_dwordx2 s[12:13], s[0:1], 88
    s_load_dwordx2 s[72:73], s[0:1], 16
    s_load_dwordx2 s[76:77], s[0:1], 24
    s_load_dwordx2 s[80:81], s[0:1], 32
    s_load_dwordx2 s[84:85], s[0:1], 40
    s_load_dwordx2 s[68:69], s[0:1], 8
    s_getreg_b32 s24, hwreg(HW_REG_XCC_ID)
    s_and_b32 s24, s24, 7
    s_getpc_b64 s[26:27]
M_cpf:
    s_lshr_b32 s28, s2, 3
    s_lshl_b32 s28, s28, 8
    v_add_u32 v13, s28, v0
    v_lshlrev_b32 v13, 6, v13
    v_cmp_gt_u32 vcc, M_end - M_cpf, v13
    s_and_saveexec_b64 s[28:29], vcc
    s_cbranch_execz M_cpfd
    global_load_dword v14, v13, s[26:27]
M_cpfd:
    s_mov_b64 exec, s[28:29]
    v_lshrrev_b32 v12, 6, v0
    v_and_b32 v0, 63, v0
    v_readfirstlane_b32 s21, v12
    v_lshlrev_b32 v0, 4, v0
    s_waitcnt lgkmcnt(0)
    s_and_b32 s9, s9, 0xffff
    s_mov_b32 s10, 268435456
    s_mov_b32 s11, 0x00020000
    s_and_b32 s13, s13, 0xffff
    s_mov_b32 s14, 256
    s_mov_b32 s15, 0x00020000
    s_and_b32 s17, s17, 0xffff
    s_mov_b32 s18, 2621440
    s_mov_b32 s19, 0x00020000
    s_and_b32 s73, s73, 0xffff
    s_mov_b32 s74, 5242880
    s_mov_b32 s75, 0x00020000
    s_and_b32 s77, s77, 0xffff
    s_mov_b32 s78, 5242880
    s_mov_b32 s79, 0x00020000
    s_and_b32 s81, s81, 0xffff
    s_mov_b32 s82, 5242880
    s_mov_b32 s83, 0x00020000
    s_and_b32 s85, s85, 0xffff
    s_mov_b32 s86, 5242880
    s_mov_b32 s87, 0x00020000
    s_and_b32 s69, s69, 0xffff
    s_mov_b32 s70, 10240
    s_mov_b32 s71, 0x00020000
    s_mov_b32 s5, 0
    s_mov_b32 s101, 0
    s_cmp_eq_u32 s21, 0
    s_cbranch_scc1 M_tick
    s_cmp_eq_u32 s21, 3
    s_cbranch_scc1 M_zero
    v_mov_b32 v28, -1
    v_mov_b32 v29, -1
    v_mov_b32 v30, -1
    v_mov_b32 v31, -1
    s_lshl_b32 s26, s2, 1
    s_add_u32 s26, s26, s21
    s_lshl_b32 s26, s26, 12
    s_add_u32 s26, s26, 171962368
    buffer_store_dwordx4 v[28:31], v0, s[8:11], s26 offen offset:0 sc1
    buffer_store_dwordx4 v[28:31], v0, s[8:11], s26 offen offset:1024 sc1
    buffer_store_dwordx4 v[28:31], v0, s[8:11], s26 offen offset:2048 sc1
    buffer_store_dwordx4 v[28:31], v0, s[8:11], s26 offen offset:3072 sc1
    s_branch M_notick
M_zero:
    v_mov_b32 v28, 0
    v_mov_b32 v29, 0
    v_mov_b32 v30, 0
    v_mov_b32 v31, 0
    s_lshl_b32 s26, s2, 9
    s_add_u32 s26, s26, 167837696
    s_mov_b32 exec_hi, 0
    buffer_store_dwordx4 v[28:31], v0, s[8:11], s26 offen sc1
    s_mov_b64 exec, -1
    s_cmp_ge_u32 s2, 10
    s_cbranch_scc1 M_notick
    v_bfe_u32 v6, v0, 4, 3
    v_mul_u32_u24 v6, 1280, v6
    v_lshrrev_b32 v7, 8, v0
    v_lshl_add_u32 v6, v7, 5, v6
    v_bfe_u32 v7, v0, 7, 1
    v_lshl_add_u32 v6, v7, 2, v6
    s_lshl_b32 s26, s2, 7
    buffer_load_dword v32, v6, s[68:71], s26 offen offset:0
    buffer_load_dword v33, v6, s[68:71], s26 offen offset:8
    buffer_load_dword v34, v6, s[68:71], s26 offen offset:16
    buffer_load_dword v35, v6, s[68:71], s26 offen offset:24
    v_and_b32 v7, 0x200, v0
    v_bfe_u32 v12, v0, 6, 1
    v_lshl_or_b32 v7, v12, 8, v7
    v_bfe_u32 v12, v0, 4, 1
    v_lshl_or_b32 v7, v12, 7, v7
    v_bfe_u32 v12, v0, 5, 1
    v_lshl_or_b32 v7, v12, 6, v7
    v_bfe_u32 v12, v0, 8, 1
    v_lshl_or_b32 v7, v12, 5, v7
    v_bfe_u32 v12, v0, 7, 1
    v_lshl_or_b32 v7, v12, 4, v7
    s_lshl_b32 s26, s2, 10
    s_add_u32 s26, s26, 167772160
    s_waitcnt vmcnt(0)
    v_min_u32 v32, -2, v32
    v_min_u32 v33, -2, v33
    v_min_u32 v34, -2, v34
    v_min_u32 v35, -2, v35
    buffer_store_dwordx4 v[32:35], v7, s[8:11], s26 offen sc1
    s_branch M_notick
M_tick:
    s_lshr_b32 s25, 5, s24
    s_and_b32 s25, s25, 1
    s_cmp_lg_u32 s25, 1
    s_cbranch_scc1 M_nocal
    s_bfe_u32 s25, s2, 0x20003
    s_lshl_b32 s26, s25, 13
    s_lshr_b32 s27, s2, 5
    s_lshl_b32 s27, s27, 15
    s_add_u32 s26, s26, s27
    s_lshl_b32 s27, s24, 8
    s_add_u32 s26, s26, s27
    s_add_u32 s26, s26, 171966464
    v_mov_b32 v28, -1
    v_mov_b32 v29, -1
    v_mov_b32 v30, -1
    v_mov_b32 v31, -1
    s_mov_b64 exec, 0xff
    s_mov_b32 s27, -1
    s_waitcnt vmcnt(0)
    s_memtime s[28:29]
    buffer_store_dwordx4 v[28:31], v0, s[8:11], s26 offen sc1
    s_waitcnt vmcnt(0)
    s_memtime s[30:31]
    s_waitcnt lgkmcnt(0)
    s_sub_u32 s28, s30, s28
    s_min_u32 s27, s27, s28
    s_memtime s[28:29]
    buffer_store_dwordx4 v[28:31], v0, s[8:11], s26 offen sc1
    s_waitcnt vmcnt(0)
    s_memtime s[30:31]
    s_waitcnt lgkmcnt(0)
    s_sub_u32 s28, s30, s28
    s_min_u32 s27, s27, s28
    s_memtime s[28:29]
    buffer_store_dwordx4 v[28:31], v0, s[8:11], s26 offen sc1
    s_waitcnt vmcnt(0)
    s_memtime s[30:31]
    s_waitcnt lgkmcnt(0)
    s_sub_u32 s28, s30, s28
    s_min_u32 s27, s27, s28
    s_memtime s[28:29]
    buffer_store_dwordx4 v[28:31], v0, s[8:11], s26 offen sc1
    s_waitcnt vmcnt(0)
    s_memtime s[30:31]
    s_waitcnt lgkmcnt(0)
    s_sub_u32 s28, s30, s28
    s_min_u32 s27, s27, s28
    s_mov_b64 exec, 1
    s_min_u32 s27, s27, 0xffff
    s_sub_u32 s27, 0x10000, s27
    s_lshl_b32 s27, s27, 2
    s_or_b32 s27, s27, s25
    v_mov_b32 v28, s27
    v_mov_b32 v29, 60
    buffer_atomic_umax v28, v29, s[12:15], 0 offen
M_nocal:
    s_mov_b64 exec, 1
    v_mov_b32 v28, 1
    s_lshl_b32 s25, s24, 2
    v_mov_b32 v29, s25
    buffer_atomic_add v28, v29, s[12:15], 0 offen sc0
    s_mov_b64 exec, -1
M_notick:
    s_lshl_b32 s20, s24, 2
    s_lshr_b32 s20, 0x76521403, s20
    s_and_b32 s20, s20, 7
    s_waitcnt vmcnt(0)
    s_cmp_lg_u32 s21, 0
    s_cbranch_scc1 M_notick2
    s_mov_b64 exec, 1
    v_mov_b32 v29, 23296
    ds_write_b32 v29, v28
    s_waitcnt lgkmcnt(0)
    s_mov_b64 exec, -1
M_notick2:
    s_barrier
    s_cmp_lg_u32 s21, 0
    s_cbranch_scc1 M_noarr
    s_mov_b64 exec, 1
    v_mov_b32 v30, 1
    v_mov_b32 v29, 32
    buffer_atomic_add v30, v29, s[12:15], 0 offen
    s_mov_b64 exec, -1
M_noarr:
    v_mov_b32 v29, 23296
    ds_read_b32 v28, v29
    s_waitcnt lgkmcnt(0)
    v_readfirstlane_b32 s25, v28
    s_and_b32 s22, s25, 31
    s_mov_b32 s23, 0
    s_mov_b32 s32, 0
    s_cmp_ge_u32 s20, 3
    s_cbranch_scc1 M_lw_done
M_loadw:
    s_barrier
    s_cmp_lt_u32 s20, 2
    s_cbranch_scc1 M_lw_chain
    s_cmp_lt_u32 s20, 4
    s_cbranch_scc1 M_lw_bulk
    s_lshl_b32 s34, s22, 2
    s_add_u32 s34, s34, s20
    s_sub_u32 s34, s34, 4
    s_mov_b32 s92, s33
    s_mov_b32 s33, s21
    v_lshrrev_b32 v1, 4, v0
    v_lshrrev_b32 v3, 8, v0
    v_and_b32 v4, 15, v1
    v_mov_b32 v5, v0
    v_mul_u32_u24 v6, 1280, v4
    v_lshl_add_u32 v6, v3, 4, v6
    s_mul_i32 s36, s34, 20480
    s_mul_i32 s35, s33, 320
    s_add_u32 s36, s36, s35
    buffer_load_dwordx4 v[8:11], v6, s[16:19], s36 offen offset:0
    buffer_load_dwordx4 v[12:15], v6, s[16:19], s36 offen offset:64
    buffer_load_dwordx4 v[16:19], v6, s[16:19], s36 offen offset:128
    buffer_load_dwordx4 v[20:23], v6, s[16:19], s36 offen offset:192
    buffer_load_dwordx4 v[24:27], v6, s[16:19], s36 offen offset:256
    s_waitcnt vmcnt(4)
    v_lshlrev_b32 v32, 16, v8
    v_and_b32 v33, 0xffff0000, v8
    v_lshlrev_b32 v34, 16, v9
    v_and_b32 v35, 0xffff0000, v9
    v_lshlrev_b32 v36, 16, v10
    v_and_b32 v37, 0xffff0000, v10
    v_lshlrev_b32 v38, 16, v11
    v_and_b32 v39, 0xffff0000, v11
    s_waitcnt vmcnt(3)
    v_lshlrev_b32 v40, 16, v12
    v_and_b32 v41, 0xffff0000, v12
    v_lshlrev_b32 v42, 16, v13
    v_and_b32 v43, 0xffff0000, v13
    v_lshlrev_b32 v44, 16, v14
    v_and_b32 v45, 0xffff0000, v14
    v_lshlrev_b32 v46, 16, v15
    v_and_b32 v47, 0xffff0000, v15
    s_waitcnt vmcnt(2)
    v_lshlrev_b32 v48, 16, v16
    v_and_b32 v49, 0xffff0000, v16
    v_lshlrev_b32 v50, 16, v17
    v_and_b32 v51, 0xffff0000, v17
    v_lshlrev_b32 v52, 16, v18
    v_and_b32 v53, 0xffff0000, v18
    v_lshlrev_b32 v54, 16, v19
    v_and_b32 v55, 0xffff0000, v19
    s_waitcnt vmcnt(1)
    v_lshlrev_b32 v56, 16, v20
    v_and_b32 v57, 0xffff0000, v20
    v_lshlrev_b32 v58, 16, v21
    v_and_b32 v59, 0xffff0000, v21
    v_lshlrev_b32 v60, 16, v22
    v_and_b32 v61, 0xffff0000, v22
    v_lshlrev_b32 v62, 16, v23
    v_and_b32 v63, 0xffff0000, v23
    s_waitcnt vmcnt(0)
    v_lshlrev_b32 v64, 16, v24
    v_and_b32 v65, 0xffff0000, v24
    v_lshlrev_b32 v66, 16, v25
    v_and_b32 v67, 0xffff0000, v25
    v_lshlrev_b32 v68, 16, v26
    v_and_b32 v69, 0xffff0000, v26
    v_lshlrev_b32 v70, 16, v27
    v_and_b32 v71, 0xffff0000, v27
    v_add_f32 v72, v32, v33
    v_add_f32 v72, v72, v34
    v_add_f32 v72, v72, v35
    v_add_f32 v72, v72, v36
    v_add_f32 v72, v72, v37
    v_add_f32 v72, v72, v38
    v_add_f32 v72, v72, v39
    v_add_f32 v72, v72, v40
    v_add_f32 v72, v72, v41
    v_add_f32 v72, v72, v42
    v_add_f32 v72, v72, v43
    v_add_f32 v72, v72, v44
    v_add_f32 v72, v72, v45
    v_add_f32 v72, v72, v46
    v_add_f32 v72, v72, v47
    v_add_f32 v72, v72, v48
    v_add_f32 v72, v72, v49
    v_add_f32 v72, v72, v50
    v_add_f32 v72, v72, v51
    v_add_f32 v72, v72, v52
    v_add_f32 v72, v72, v53
    v_add_f32 v72, v72, v54
    v_add_f32 v72, v72, v55
    v_add_f32 v72, v72, v56
    v_add_f32 v72, v72, v57
    v_add_f32 v72, v72, v58
    v_add_f32 v72, v72, v59
    v_add_f32 v72, v72, v60
    v_add_f32 v72, v72, v61
    v_add_f32 v72, v72, v62
    v_add_f32 v72, v72, v63
    v_add_f32 v72, v72, v64
    v_add_f32 v72, v72, v65
    v_add_f32 v72, v72, v66
    v_add_f32 v72, v72, v67
    v_add_f32 v72, v72, v68
    v_add_f32 v72, v72, v69
    v_add_f32 v72, v72, v70
    v_add_f32 v72, v72, v71
    v_lshlrev_b32 v77, 4, v4
    s_lshl_b32 s35, s33, 2
    v_add_u32 v76, s35, v77
    v_mov_b32 v73, v72
    s_nop 1
    v_permlane16_swap_b32 v72, v73
    v_add_f32 v72, v72, v73
    v_mov_b32 v73, v72
    s_nop 1
    v_permlane32_swap_b32 v72, v73
    v_add_f32 v72, v72, v73
    ds_write_b32 v76, v72 offset:0
    s_waitcnt lgkmcnt(0)
    s_barrier
    ds_read_b128 v[80:83], v77 offset:0
    s_waitcnt lgkmcnt(0)
    v_add_f32 v80, v80, v81
    v_add_f32 v82, v82, v83
    v_add_f32 v72, v80, v82
    v_mul_f32 v72, 0x3acccccd, v72
    v_sub_f32 v32, v32, v72
    v_sub_f32 v33, v33, v72
    v_sub_f32 v34, v34, v72
    v_sub_f32 v35, v35, v72
    v_sub_f32 v36, v36, v72
    v_sub_f32 v37, v37, v72
    v_sub_f32 v38, v38, v72
    v_sub_f32 v39, v39, v72
    v_sub_f32 v40, v40, v72
    v_sub_f32 v41, v41, v72
    v_sub_f32 v42, v42, v72
    v_sub_f32 v43, v43, v72
    v_sub_f32 v44, v44, v72
    v_sub_f32 v45, v45, v72
    v_sub_f32 v46, v46, v72
    v_sub_f32 v47, v47, v72
    v_sub_f32 v48, v48, v72
    v_sub_f32 v49, v49, v72
    v_sub_f32 v50, v50, v72
    v_sub_f32 v51, v51, v72
    v_sub_f32 v52, v52, v72
    v_sub_f32 v53, v53, v72
    v_sub_f32 v54, v54, v72
    v_sub_f32 v55, v55, v72
    v_sub_f32 v56, v56, v72
    v_sub_f32 v57, v57, v72
    v_sub_f32 v58, v58, v72
    v_sub_f32 v59, v59, v72
    v_sub_f32 v60, v60, v72
    v_sub_f32 v61, v61, v72
    v_sub_f32 v62, v62, v72
    v_sub_f32 v63, v63, v72
    v_sub_f32 v64, v64, v72
    v_sub_f32 v65, v65, v72
    v_sub_f32 v66, v66, v72
    v_sub_f32 v67, v67, v72
    v_sub_f32 v68, v68, v72
    v_sub_f32 v69, v69, v72
    v_sub_f32 v70, v70, v72
    v_sub_f32 v71, v71, v72
    v_mul_f32 v74, v32, v32
    v_fmac_f32 v74, v33, v33
    v_fmac_f32 v74, v34, v34
    v_fmac_f32 v74, v35, v35
    v_fmac_f32 v74, v36, v36
    v_fmac_f32 v74, v37, v37
    v_fmac_f32 v74, v38, v38
    v_fmac_f32 v74, v39, v39
    v_fmac_f32 v74, v40, v40
    v_fmac_f32 v74, v41, v41
    v_fmac_f32 v74, v42, v42
    v_fmac_f32 v74, v43, v43
    v_fmac_f32 v74, v44, v44
    v_fmac_f32 v74, v45, v45
    v_fmac_f32 v74, v46, v46
    v_fmac_f32 v74, v47, v47
    v_fmac_f32 v74, v48, v48
    v_fmac_f32 v74, v49, v49
    v_fmac_f32 v74, v50, v50
    v_fmac_f32 v74, v51, v51
    v_fmac_f32 v74, v52, v52
    v_fmac_f32 v74, v53, v53
    v_fmac_f32 v74, v54, v54
    v_fmac_f32 v74, v55, v55
    v_fmac_f32 v74, v56, v56
    v_fmac_f32 v74, v57, v57
    v_fmac_f32 v74, v58, v58
    v_fmac_f32 v74, v59, v59
    v_fmac_f32 v74, v60, v60
    v_fmac_f32 v74, v61, v61
    v_fmac_f32 v74, v62, v62
    v_fmac_f32 v74, v63, v63
    v_fmac_f32 v74, v64, v64
    v_fmac_f32 v74, v65, v65
    v_fmac_f32 v74, v66, v66
    v_fmac_f32 v74, v67, v67
    v_fmac_f32 v74, v68, v68
    v_fmac_f32 v74, v69, v69
    v_fmac_f32 v74, v70, v70
    v_fmac_f32 v74, v71, v71
    v_mov_b32 v73, v74
    s_nop 1
    v_permlane16_swap_b32 v74, v73
    v_add_f32 v74, v74, v73
    v_mov_b32 v73, v74
    s_nop 1
    v_permlane32_swap_b32 v74, v73
    v_add_f32 v74, v74, v73
    ds_write_b32 v76, v74 offset:512
    s_waitcnt lgkmcnt(0)
    s_barrier
    ds_read_b128 v[80:83], v77 offset:512
    s_waitcnt lgkmcnt(0)
    v_add_f32 v80, v80, v81
    v_add_f32 v82, v82, v83
    v_add_f32 v74, v80, v82
    v_mov_b32 v75, 0x3727c5ac
    v_fmac_f32 v75, 0x3acccccd, v74
    v_rsq_f32 v75, v75
    s_nop 0
    v_mul_f32 v32, v32, v75
    v_mul_f32 v33, v33, v75
    v_mul_f32 v34, v34, v75
    v_mul_f32 v35, v35, v75
    v_mul_f32 v36, v36, v75
    v_mul_f32 v37, v37, v75
    v_mul_f32 v38, v38, v75
    v_mul_f32 v39, v39, v75
    v_mul_f32 v40, v40, v75
    v_mul_f32 v41, v41, v75
    v_mul_f32 v42, v42, v75
    v_mul_f32 v43, v43, v75
    v_mul_f32 v44, v44, v75
    v_mul_f32 v45, v45, v75
    v_mul_f32 v46, v46, v75
    v_mul_f32 v47, v47, v75
    v_mul_f32 v48, v48, v75
    v_mul_f32 v49, v49, v75
    v_mul_f32 v50, v50, v75
    v_mul_f32 v51, v51, v75
    v_mul_f32 v52, v52, v75
    v_mul_f32 v53, v53, v75
    v_mul_f32 v54, v54, v75
    v_mul_f32 v55, v55, v75
    v_mul_f32 v56, v56, v75
    v_mul_f32 v57, v57, v75
    v_mul_f32 v58, v58, v75
    v_mul_f32 v59, v59, v75
    v_mul_f32 v60, v60, v75
    v_mul_f32 v61, v61, v75
    v_mul_f32 v62, v62, v75
    v_mul_f32 v63, v63, v75
    v_mul_f32 v64, v64, v75
    v_mul_f32 v65, v65, v75
    v_mul_f32 v66, v66, v75
    v_mul_f32 v67, v67, v75
    v_mul_f32 v68, v68, v75
    v_mul_f32 v69, v69, v75
    v_mul_f32 v70, v70, v75
    v_mul_f32 v71, v71, v75
    v_cvt_pk_bf16_f32 v8, v32, v33
    v_cvt_pk_bf16_f32 v9, v34, v35
    v_cvt_pk_bf16_f32 v10, v36, v37
    v_cvt_pk_bf16_f32 v11, v38, v39
    v_cvt_pk_bf16_f32 v12, v40, v41
    v_cvt_pk_bf16_f32 v13, v42, v43
    v_cvt_pk_bf16_f32 v14, v44, v45
    v_cvt_pk_bf16_f32 v15, v46, v47
    v_cvt_pk_bf16_f32 v16, v48, v49
    v_cvt_pk_bf16_f32 v17, v50, v51
    v_cvt_pk_bf16_f32 v18, v52, v53
    v_cvt_pk_bf16_f32 v19, v54, v55
    v_cvt_pk_bf16_f32 v20, v56, v57
    v_cvt_pk_bf16_f32 v21, v58, v59
    v_cvt_pk_bf16_f32 v22, v60, v61
    v_cvt_pk_bf16_f32 v23, v62, v63
    v_cvt_pk_bf16_f32 v24, v64, v65
    v_cvt_pk_bf16_f32 v25, v66, v67
    v_cvt_pk_bf16_f32 v26, v68, v69
    v_cvt_pk_bf16_f32 v27, v70, v71
    s_mul_i32 s36, s34, 20480
    s_mul_i32 s35, s33, 5120
    s_add_u32 s36, s36, s35
    s_add_u32 s36, s36, 29360128
    s_add_u32 s35, s36, 4096
    buffer_store_dwordx4 v[8:11], v5, s[8:11], s36 offen offset:0 sc1
    buffer_store_dwordx4 v[12:15], v5, s[8:11], s36 offen offset:1024 sc1
    buffer_store_dwordx4 v[16:19], v5, s[8:11], s36 offen offset:2048 sc1
    buffer_store_dwordx4 v[20:23], v5, s[8:11], s36 offen offset:3072 sc1
    buffer_store_dwordx4 v[24:27], v5, s[8:11], s35 offen offset:0 sc1
    s_mov_b32 s33, s92
    s_waitcnt vmcnt(0)
    s_barrier
    s_cmp_lg_u32 s21, 0
    s_cbranch_scc1 M_lw_bulk
    s_lshr_b32 s27, s34, 1
    s_lshl_b32 s27, s27, 7
    s_and_b32 s28, s34, 1
    s_mul_i32 s28, s28, 20
    s_add_u32 s27, s27, s28
    s_add_u32 s27, s27, 167911424
    v_lshrrev_b32 v12, 2, v0
    v_mov_b32 v13, 1
    s_mov_b64 exec, 31
    buffer_store_dword v13, v12, s[8:11], s27 offen sc1
    s_mov_b64 exec, -1
M_lw_bulk:
    v_lshrrev_b32 v12, 8, v0
    v_lshlrev_b32 v12, 16, v12
    v_and_b32 v14, 0xf0, v0
    v_add_u32 v12, v12, v14
    s_lshl_b32 s46, s22, 8
    s_lshl_b32 s27, s21, 13
    v_add_u32 v4, s27, v0
    v_add_u32 v5, 32768, v4
    s_cmp_eq_u32 s20, 2
    s_cbranch_scc1 M_bl_kv
    s_mul_i32 s27, s21, 40960
    v_add_u32 v7, s27, v0
    v_lshrrev_b32 v8, 8, v0
    v_mul_u32_u24 v8, 40960, v8
    s_lshl_b32 s47, s22, 6
    s_add_u32 s47, s47, s21
    s_mul_i32 s47, s47, 2560
    v_and_b32 v14, 0xf0, v0
    v_add_u32 v8, v8, v14
    s_mov_b32 s44, 0x05040100
    s_mov_b32 s45, 0x07060302
    s_add_u32 s27, s47, 0
    buffer_load_dwordx4 v[16:19], v8, s[84:87], s27 offen
    s_add_u32 s27, s47, 1280
    buffer_load_dwordx4 v[20:23], v8, s[84:87], s27 offen
    s_add_u32 s27, s47, 10240
    buffer_load_dwordx4 v[24:27], v8, s[84:87], s27 offen
    s_add_u32 s27, s47, 11520
    buffer_load_dwordx4 v[28:31], v8, s[84:87], s27 offen
    s_add_u32 s27, s47, 20480
    buffer_load_dwordx4 v[32:35], v8, s[84:87], s27 offen
    s_add_u32 s27, s47, 21760
    buffer_load_dwordx4 v[36:39], v8, s[84:87], s27 offen
    s_add_u32 s27, s47, 30720
    buffer_load_dwordx4 v[40:43], v8, s[84:87], s27 offen
    s_add_u32 s27, s47, 32000
    buffer_load_dwordx4 v[44:47], v8, s[84:87], s27 offen
    s_add_u32 s27, s47, 256
    buffer_load_dwordx4 v[48:51], v8, s[84:87], s27 offen
    s_add_u32 s27, s47, 1536
    buffer_load_dwordx4 v[52:55], v8, s[84:87], s27 offen
    s_add_u32 s27, s47, 10496
    buffer_load_dwordx4 v[56:59], v8, s[84:87], s27 offen
    s_add_u32 s27, s47, 11776
    buffer_load_dwordx4 v[60:63], v8, s[84:87], s27 offen
    s_add_u32 s27, s47, 20736
    buffer_load_dwordx4 v[64:67], v8, s[84:87], s27 offen
    s_add_u32 s27, s47, 22016
    buffer_load_dwordx4 v[68:71], v8, s[84:87], s27 offen
    s_add_u32 s27, s47, 30976
    buffer_load_dwordx4 v[72:75], v8, s[84:87], s27 offen
    s_add_u32 s27, s47, 32256
    buffer_load_dwordx4 v[76:79], v8, s[84:87], s27 offen
    v_and_b32 v13, 0x300, v0
    s_lshl_b32 s27, s21, 10
    s_add_u32 s27, s27, 0
    v_add_u32 v13, s27, v13
    v_bfe_u32 v14, v0, 6, 2
    v_lshl_add_u32 v13, v14, 13, v13
    v_bfe_u32 v14, v0, 4, 2
    v_lshl_add_u32 v13, v14, 6, v13
    s_waitcnt vmcnt(14)
    v_perm_b32 v80, v20, v16, s44
    s_waitcnt vmcnt(12)
    v_perm_b32 v81, v28, v24, s44
    s_waitcnt vmcnt(10)
    v_perm_b32 v82, v36, v32, s44
    s_waitcnt vmcnt(8)
    v_perm_b32 v83, v44, v40, s44
    ds_write_b128 v13, v[80:83] offset:0
    v_perm_b32 v84, v20, v16, s45
    v_perm_b32 v85, v28, v24, s45
    v_perm_b32 v86, v36, v32, s45
    v_perm_b32 v87, v44, v40, s45
    ds_write_b128 v13, v[84:87] offset:16
    v_perm_b32 v80, v21, v17, s44
    v_perm_b32 v81, v29, v25, s44
    v_perm_b32 v82, v37, v33, s44
    v_perm_b32 v83, v45, v41, s44
    ds_write_b128 v13, v[80:83] offset:32
    v_perm_b32 v84, v21, v17, s45
    v_perm_b32 v85, v29, v25, s45
    v_perm_b32 v86, v37, v33, s45
    v_perm_b32 v87, v45, v41, s45
    ds_write_b128 v13, v[84:87] offset:48
    v_perm_b32 v80, v22, v18, s44
    v_perm_b32 v81, v30, v26, s44
    v_perm_b32 v82, v38, v34, s44
    v_perm_b32 v83, v46, v42, s44
    ds_write_b128 v13, v[80:83] offset:4096
    v_perm_b32 v84, v22, v18, s45
    v_perm_b32 v85, v30, v26, s45
    v_perm_b32 v86, v38, v34, s45
    v_perm_b32 v87, v46, v42, s45
    ds_write_b128 v13, v[84:87] offset:4112
    v_perm_b32 v80, v23, v19, s44
    v_perm_b32 v81, v31, v27, s44
    v_perm_b32 v82, v39, v35, s44
    v_perm_b32 v83, v47, v43, s44
    ds_write_b128 v13, v[80:83] offset:4128
    v_perm_b32 v84, v23, v19, s45
    v_perm_b32 v85, v31, v27, s45
    v_perm_b32 v86, v39, v35, s45
    v_perm_b32 v87, v47, v43, s45
    ds_write_b128 v13, v[84:87] offset:4144
    s_add_u32 s27, s47, 512
    buffer_load_dwordx4 v[16:19], v8, s[84:87], s27 offen
    s_add_u32 s27, s47, 1792
    buffer_load_dwordx4 v[20:23], v8, s[84:87], s27 offen
    s_add_u32 s27, s47, 10752
    buffer_load_dwordx4 v[24:27], v8, s[84:87], s27 offen
    s_add_u32 s27, s47, 12032
    buffer_load_dwordx4 v[28:31], v8, s[84:87], s27 offen
    s_add_u32 s27, s47, 20992
    buffer_load_dwordx4 v[32:35], v8, s[84:87], s27 offen
    s_add_u32 s27, s47, 22272
    buffer_load_dwordx4 v[36:39], v8, s[84:87], s27 offen
    s_add_u32 s27, s47, 31232
    buffer_load_dwordx4 v[40:43], v8, s[84:87], s27 offen
    s_add_u32 s27, s47, 32512
    buffer_load_dwordx4 v[44:47], v8, s[84:87], s27 offen
    v_and_b32 v13, 0x300, v0
    s_lshl_b32 s27, s21, 10
    s_add_u32 s27, s27, 32768
    v_add_u32 v13, s27, v13
    v_bfe_u32 v14, v0, 6, 2
    v_lshl_add_u32 v13, v14, 13, v13
    v_bfe_u32 v14, v0, 4, 2
    v_lshl_add_u32 v13, v14, 6, v13
    s_waitcnt vmcnt(14)
    v_perm_b32 v80, v52, v48, s44
    s_waitcnt vmcnt(12)
    v_perm_b32 v81, v60, v56, s44
    s_waitcnt vmcnt(10)
    v_perm_b32 v82, v68, v64, s44
    s_waitcnt vmcnt(8)
    v_perm_b32 v83, v76, v72, s44
    ds_write_b128 v13, v[80:83] offset:0
    v_perm_b32 v84, v52, v48, s45
    v_perm_b32 v85, v60, v56, s45
    v_perm_b32 v86, v68, v64, s45
    v_perm_b32 v87, v76, v72, s45
    ds_write_b128 v13, v[84:87] offset:16
    v_perm_b32 v80, v53, v49, s44
    v_perm_b32 v81, v61, v57, s44
    v_perm_b32 v82, v69, v65, s44
    v_perm_b32 v83, v77, v73, s44
    ds_write_b128 v13, v[80:83] offset:32
    v_perm_b32 v84, v53, v49, s45
    v_perm_b32 v85, v61, v57, s45
    v_perm_b32 v86, v69, v65, s45
    v_perm_b32 v87, v77, v73, s45
    ds_write_b128 v13, v[84:87] offset:48
    v_perm_b32 v80, v54, v50, s44
    v_perm_b32 v81, v62, v58, s44
    v_perm_b32 v82, v70, v66, s44
    v_perm_b32 v83, v78, v74, s44
    ds_write_b128 v13, v[80:83] offset:4096
    v_perm_b32 v84, v54, v50, s45
    v_perm_b32 v85, v62, v58, s45
    v_perm_b32 v86, v70, v66, s45
    v_perm_b32 v87, v78, v74, s45
    ds_write_b128 v13, v[84:87] offset:4112
    v_perm_b32 v80, v55, v51, s44
    v_perm_b32 v81, v63, v59, s44
    v_perm_b32 v82, v71, v67, s44
    v_perm_b32 v83, v79, v75, s44
    ds_write_b128 v13, v[80:83] offset:4128
    v_perm_b32 v84, v55, v51, s45
    v_perm_b32 v85, v63, v59, s45
    v_perm_b32 v86, v71, v67, s45
    v_perm_b32 v87, v79, v75, s45
    ds_write_b128 v13, v[84:87] offset:4144
    s_add_u32 s27, s47, 768
    buffer_load_dwordx4 v[48:51], v8, s[84:87], s27 offen
    s_add_u32 s27, s47, 2048
    buffer_load_dwordx4 v[52:55], v8, s[84:87], s27 offen
    s_add_u32 s27, s47, 11008
    buffer_load_dwordx4 v[56:59], v8, s[84:87], s27 offen
    s_add_u32 s27, s47, 12288
    buffer_load_dwordx4 v[60:63], v8, s[84:87], s27 offen
    s_add_u32 s27, s47, 21248
    buffer_load_dwordx4 v[64:67], v8, s[84:87], s27 offen
    s_add_u32 s27, s47, 22528
    buffer_load_dwordx4 v[68:71], v8, s[84:87], s27 offen
    s_add_u32 s27, s47, 31488
    buffer_load_dwordx4 v[72:75], v8, s[84:87], s27 offen
    s_add_u32 s27, s47, 32768
    buffer_load_dwordx4 v[76:79], v8, s[84:87], s27 offen
    v_and_b32 v13, 0x300, v0
    s_lshl_b32 s27, s21, 10
    s_add_u32 s27, s27, 65536
    v_add_u32 v13, s27, v13
    v_bfe_u32 v14, v0, 6, 2
    v_lshl_add_u32 v13, v14, 13, v13
    v_bfe_u32 v14, v0, 4, 2
    v_lshl_add_u32 v13, v14, 6, v13
    s_waitcnt vmcnt(14)
    v_perm_b32 v80, v20, v16, s44
    s_waitcnt vmcnt(12)
    v_perm_b32 v81, v28, v24, s44
    s_waitcnt vmcnt(10)
    v_perm_b32 v82, v36, v32, s44
    s_waitcnt vmcnt(8)
    v_perm_b32 v83, v44, v40, s44
    ds_write_b128 v13, v[80:83] offset:0
    v_perm_b32 v84, v20, v16, s45
    v_perm_b32 v85, v28, v24, s45
    v_perm_b32 v86, v36, v32, s45
    v_perm_b32 v87, v44, v40, s45
    ds_write_b128 v13, v[84:87] offset:16
    v_perm_b32 v80, v21, v17, s44
    v_perm_b32 v81, v29, v25, s44
    v_perm_b32 v82, v37, v33, s44
    v_perm_b32 v83, v45, v41, s44
    ds_write_b128 v13, v[80:83] offset:32
    v_perm_b32 v84, v21, v17, s45
    v_perm_b32 v85, v29, v25, s45
    v_perm_b32 v86, v37, v33, s45
    v_perm_b32 v87, v45, v41, s45
    ds_write_b128 v13, v[84:87] offset:48
    v_perm_b32 v80, v22, v18, s44
    v_perm_b32 v81, v30, v26, s44
    v_perm_b32 v82, v38, v34, s44
    v_perm_b32 v83, v46, v42, s44
    ds_write_b128 v13, v[80:83] offset:4096
    v_perm_b32 v84, v22, v18, s45
    v_perm_b32 v85, v30, v26, s45
    v_perm_b32 v86, v38, v34, s45
    v_perm_b32 v87, v46, v42, s45
    ds_write_b128 v13, v[84:87] offset:4112
    v_perm_b32 v80, v23, v19, s44
    v_perm_b32 v81, v31, v27, s44
    v_perm_b32 v82, v39, v35, s44
    v_perm_b32 v83, v47, v43, s44
    ds_write_b128 v13, v[80:83] offset:4128
    v_perm_b32 v84, v23, v19, s45
    v_perm_b32 v85, v31, v27, s45
    v_perm_b32 v86, v39, v35, s45
    v_perm_b32 v87, v47, v43, s45
    ds_write_b128 v13, v[84:87] offset:4144
    s_add_u32 s27, s47, 1024
    buffer_load_dwordx4 v[16:19], v8, s[84:87], s27 offen
    s_add_u32 s27, s47, 2304
    buffer_load_dwordx4 v[20:23], v8, s[84:87], s27 offen
    s_add_u32 s27, s47, 11264
    buffer_load_dwordx4 v[24:27], v8, s[84:87], s27 offen
    s_add_u32 s27, s47, 12544
    buffer_load_dwordx4 v[28:31], v8, s[84:87], s27 offen
    s_add_u32 s27, s47, 21504
    buffer_load_dwordx4 v[32:35], v8, s[84:87], s27 offen
    s_add_u32 s27, s47, 22784
    buffer_load_dwordx4 v[36:39], v8, s[84:87], s27 offen
    s_add_u32 s27, s47, 31744
    buffer_load_dwordx4 v[40:43], v8, s[84:87], s27 offen
    s_add_u32 s27, s47, 33024
    buffer_load_dwordx4 v[44:47], v8, s[84:87], s27 offen
    v_and_b32 v13, 0x300, v0
    s_lshl_b32 s27, s21, 10
    s_add_u32 s27, s27, 98304
    v_add_u32 v13, s27, v13
    v_bfe_u32 v14, v0, 6, 2
    v_lshl_add_u32 v13, v14, 13, v13
    v_bfe_u32 v14, v0, 4, 2
    v_lshl_add_u32 v13, v14, 6, v13
    s_waitcnt vmcnt(14)
    v_perm_b32 v80, v52, v48, s44
    s_waitcnt vmcnt(12)
    v_perm_b32 v81, v60, v56, s44
    s_waitcnt vmcnt(10)
    v_perm_b32 v82, v68, v64, s44
    s_waitcnt vmcnt(8)
    v_perm_b32 v83, v76, v72, s44
    ds_write_b128 v13, v[80:83] offset:0
    v_perm_b32 v84, v52, v48, s45
    v_perm_b32 v85, v60, v56, s45
    v_perm_b32 v86, v68, v64, s45
    v_perm_b32 v87, v76, v72, s45
    ds_write_b128 v13, v[84:87] offset:16
    v_perm_b32 v80, v53, v49, s44
    v_perm_b32 v81, v61, v57, s44
    v_perm_b32 v82, v69, v65, s44
    v_perm_b32 v83, v77, v73, s44
    ds_write_b128 v13, v[80:83] offset:32
    v_perm_b32 v84, v53, v49, s45
    v_perm_b32 v85, v61, v57, s45
    v_perm_b32 v86, v69, v65, s45
    v_perm_b32 v87, v77, v73, s45
    ds_write_b128 v13, v[84:87] offset:48
    v_perm_b32 v80, v54, v50, s44
    v_perm_b32 v81, v62, v58, s44
    v_perm_b32 v82, v70, v66, s44
    v_perm_b32 v83, v78, v74, s44
    ds_write_b128 v13, v[80:83] offset:4096
    v_perm_b32 v84, v54, v50, s45
    v_perm_b32 v85, v62, v58, s45
    v_perm_b32 v86, v70, v66, s45
    v_perm_b32 v87, v78, v74, s45
    ds_write_b128 v13, v[84:87] offset:4112
    v_perm_b32 v80, v55, v51, s44
    v_perm_b32 v81, v63, v59, s44
    v_perm_b32 v82, v71, v67, s44
    v_perm_b32 v83, v79, v75, s44
    ds_write_b128 v13, v[80:83] offset:4128
    v_perm_b32 v84, v55, v51, s45
    v_perm_b32 v85, v63, v59, s45
    v_perm_b32 v86, v71, v67, s45
    v_perm_b32 v87, v79, v75, s45
    ds_write_b128 v13, v[84:87] offset:4144
    v_and_b32 v13, 0x300, v0
    s_lshl_b32 s27, s21, 10
    s_add_u32 s27, s27, 131072
    v_add_u32 v13, s27, v13
    v_bfe_u32 v14, v0, 6, 2
    v_lshl_add_u32 v13, v14, 13, v13
    v_bfe_u32 v14, v0, 4, 2
    v_lshl_add_u32 v13, v14, 6, v13
    s_waitcnt vmcnt(6)
    v_perm_b32 v80, v20, v16, s44
    s_waitcnt vmcnt(4)
    v_perm_b32 v81, v28, v24, s44
    s_waitcnt vmcnt(2)
    v_perm_b32 v82, v36, v32, s44
    s_waitcnt vmcnt(0)
    v_perm_b32 v83, v44, v40, s44
    ds_write_b128 v13, v[80:83] offset:0
    v_perm_b32 v84, v20, v16, s45
    v_perm_b32 v85, v28, v24, s45
    v_perm_b32 v86, v36, v32, s45
    v_perm_b32 v87, v44, v40, s45
    ds_write_b128 v13, v[84:87] offset:16
    v_perm_b32 v80, v21, v17, s44
    v_perm_b32 v81, v29, v25, s44
    v_perm_b32 v82, v37, v33, s44
    v_perm_b32 v83, v45, v41, s44
    ds_write_b128 v13, v[80:83] offset:32
    v_perm_b32 v84, v21, v17, s45
    v_perm_b32 v85, v29, v25, s45
    v_perm_b32 v86, v37, v33, s45
    v_perm_b32 v87, v45, v41, s45
    ds_write_b128 v13, v[84:87] offset:48
    v_perm_b32 v80, v22, v18, s44
    v_perm_b32 v81, v30, v26, s44
    v_perm_b32 v82, v38, v34, s44
    v_perm_b32 v83, v46, v42, s44
    ds_write_b128 v13, v[80:83] offset:4096
    v_perm_b32 v84, v22, v18, s45
    v_perm_b32 v85, v30, v26, s45
    v_perm_b32 v86, v38, v34, s45
    v_perm_b32 v87, v46, v42, s45
    ds_write_b128 v13, v[84:87] offset:4112
    v_perm_b32 v80, v23, v19, s44
    v_perm_b32 v81, v31, v27, s44
    v_perm_b32 v82, v39, v35, s44
    v_perm_b32 v83, v47, v43, s44
    ds_write_b128 v13, v[80:83] offset:4128
    v_perm_b32 v84, v23, v19, s45
    v_perm_b32 v85, v31, v27, s45
    v_perm_b32 v86, v39, v35, s45
    v_perm_b32 v87, v47, v43, s45
    ds_write_b128 v13, v[84:87] offset:4144
    s_waitcnt lgkmcnt(0)
    s_barrier
    ds_read_b128 a[160:163], v7 offset:0
    ds_read_b128 a[164:167], v7 offset:1024
    ds_read_b128 a[168:171], v7 offset:2048
    ds_read_b128 a[172:175], v7 offset:3072
    ds_read_b128 a[176:179], v7 offset:4096
    ds_read_b128 a[180:183], v7 offset:5120
    ds_read_b128 a[184:187], v7 offset:6144
    ds_read_b128 a[188:191], v7 offset:7168
    ds_read_b128 a[192:195], v7 offset:8192
    ds_read_b128 a[196:199], v7 offset:9216
    ds_read_b128 a[200:203], v7 offset:10240
    ds_read_b128 a[204:207], v7 offset:11264
    ds_read_b128 a[208:211], v7 offset:12288
    ds_read_b128 a[212:215], v7 offset:13312
    ds_read_b128 a[216:219], v7 offset:14336
    ds_read_b128 a[220:223], v7 offset:15360
    ds_read_b128 a[224:227], v7 offset:16384
    ds_read_b128 a[228:231], v7 offset:17408
    ds_read_b128 a[232:235], v7 offset:18432
    ds_read_b128 a[236:239], v7 offset:19456
    ds_read_b128 a[240:243], v7 offset:20480
    ds_read_b128 a[244:247], v7 offset:21504
    ds_read_b128 a[248:251], v7 offset:22528
    ds_read_b128 a[252:255], v7 offset:23552
    ds_read_b128 v[192:195], v7 offset:24576
    ds_read_b128 v[196:199], v7 offset:25600
    ds_read_b128 v[200:203], v7 offset:26624
    ds_read_b128 v[204:207], v7 offset:27648
    ds_read_b128 v[208:211], v7 offset:28672
    ds_read_b128 v[212:215], v7 offset:29696
    ds_read_b128 v[216:219], v7 offset:30720
    ds_read_b128 v[220:223], v7 offset:31744
    ds_read_b128 v[224:227], v7 offset:32768
    ds_read_b128 v[228:231], v7 offset:33792
    ds_read_b128 v[232:235], v7 offset:34816
    ds_read_b128 v[236:239], v7 offset:35840
    ds_read_b128 v[240:243], v7 offset:36864
    ds_read_b128 v[244:247], v7 offset:37888
    ds_read_b128 v[248:251], v7 offset:38912
    ds_read_b128 v[252:255], v7 offset:39936
    s_waitcnt lgkmcnt(0)
    s_barrier
    s_mov_b32 s44, 0x05040100
    s_mov_b32 s45, 0x07060302
    s_add_u32 s26, s21, 0
    s_lshl_b32 s27, s26, 18
    s_add_u32 s27, s27, s46
    buffer_load_dwordx4 v[16:19], v12, s[72:75], s27 offen
    s_add_u32 s27, s27, 8192
    buffer_load_dwordx4 v[20:23], v12, s[72:75], s27 offen
    s_add_u32 s27, s27, 8192
    buffer_load_dwordx4 v[24:27], v12, s[72:75], s27 offen
    s_add_u32 s27, s27, 8192
    buffer_load_dwordx4 v[28:31], v12, s[72:75], s27 offen
    s_add_u32 s27, s27, 8192
    buffer_load_dwordx4 v[32:35], v12, s[72:75], s27 offen
    s_add_u32 s27, s27, 8192
    buffer_load_dwordx4 v[36:39], v12, s[72:75], s27 offen
    s_add_u32 s27, s27, 8192
    buffer_load_dwordx4 v[40:43], v12, s[72:75], s27 offen
    s_add_u32 s27, s27, 8192
    buffer_load_dwordx4 v[44:47], v12, s[72:75], s27 offen
    s_add_u32 s26, s21, 4
    s_lshl_b32 s27, s26, 18
    s_add_u32 s27, s27, s46
    buffer_load_dwordx4 v[48:51], v12, s[72:75], s27 offen
    s_add_u32 s27, s27, 8192
    buffer_load_dwordx4 v[52:55], v12, s[72:75], s27 offen
    s_add_u32 s27, s27, 8192
    buffer_load_dwordx4 v[56:59], v12, s[72:75], s27 offen
    s_add_u32 s27, s27, 8192
    buffer_load_dwordx4 v[60:63], v12, s[72:75], s27 offen
    s_add_u32 s27, s27, 8192
    buffer_load_dwordx4 v[64:67], v12, s[72:75], s27 offen
    s_add_u32 s27, s27, 8192
    buffer_load_dwordx4 v[68:71], v12, s[72:75], s27 offen
    s_add_u32 s27, s27, 8192
    buffer_load_dwordx4 v[72:75], v12, s[72:75], s27 offen
    s_add_u32 s27, s27, 8192
    buffer_load_dwordx4 v[76:79], v12, s[72:75], s27 offen
    s_lshl_b32 s27, s21, 11
    s_add_u32 s27, s27, 0
    v_add_u32 v13, s27, v0
    s_waitcnt vmcnt(14)
    v_perm_b32 v80, v20, v16, s44
    s_waitcnt vmcnt(12)
    v_perm_b32 v81, v28, v24, s44
    s_waitcnt vmcnt(10)
    v_perm_b32 v82, v36, v32, s44
    s_waitcnt vmcnt(8)
    v_perm_b32 v83, v44, v40, s44
    ds_write_b128 v13, v[80:83] offset:0
    v_perm_b32 v84, v20, v16, s45
    v_perm_b32 v85, v28, v24, s45
    v_perm_b32 v86, v36, v32, s45
    v_perm_b32 v87, v44, v40, s45
    ds_write_b128 v13, v[84:87] offset:1024
    v_perm_b32 v80, v21, v17, s44
    v_perm_b32 v81, v29, v25, s44
    v_perm_b32 v82, v37, v33, s44
    v_perm_b32 v83, v45, v41, s44
    ds_write_b128 v13, v[80:83] offset:8192
    v_perm_b32 v84, v21, v17, s45
    v_perm_b32 v85, v29, v25, s45
    v_perm_b32 v86, v37, v33, s45
    v_perm_b32 v87, v45, v41, s45
    ds_write_b128 v13, v[84:87] offset:9216
    v_perm_b32 v80, v22, v18, s44
    v_perm_b32 v81, v30, v26, s44
    v_perm_b32 v82, v38, v34, s44
    v_perm_b32 v83, v46, v42, s44
    ds_write_b128 v13, v[80:83] offset:16384
    v_perm_b32 v84, v22, v18, s45
    v_perm_b32 v85, v30, v26, s45
    v_perm_b32 v86, v38, v34, s45
    v_perm_b32 v87, v46, v42, s45
    ds_write_b128 v13, v[84:87] offset:17408
    v_perm_b32 v80, v23, v19, s44
    v_perm_b32 v81, v31, v27, s44
    v_perm_b32 v82, v39, v35, s44
    v_perm_b32 v83, v47, v43, s44
    ds_write_b128 v13, v[80:83] offset:24576
    v_perm_b32 v84, v23, v19, s45
    v_perm_b32 v85, v31, v27, s45
    v_perm_b32 v86, v39, v35, s45
    v_perm_b32 v87, v47, v43, s45
    ds_write_b128 v13, v[84:87] offset:25600
    s_add_u32 s26, s21, 8
    s_lshl_b32 s27, s26, 18
    s_add_u32 s27, s27, s46
    buffer_load_dwordx4 v[16:19], v12, s[72:75], s27 offen
    s_add_u32 s27, s27, 8192
    buffer_load_dwordx4 v[20:23], v12, s[72:75], s27 offen
    s_add_u32 s27, s27, 8192
    buffer_load_dwordx4 v[24:27], v12, s[72:75], s27 offen
    s_add_u32 s27, s27, 8192
    buffer_load_dwordx4 v[28:31], v12, s[72:75], s27 offen
    s_add_u32 s27, s27, 8192
    buffer_load_dwordx4 v[32:35], v12, s[72:75], s27 offen
    s_add_u32 s27, s27, 8192
    buffer_load_dwordx4 v[36:39], v12, s[72:75], s27 offen
    s_add_u32 s27, s27, 8192
    buffer_load_dwordx4 v[40:43], v12, s[72:75], s27 offen
    s_add_u32 s27, s27, 8192
    buffer_load_dwordx4 v[44:47], v12, s[72:75], s27 offen
    s_waitcnt lgkmcnt(0)
    s_barrier
    ds_read_b128 a[0:3], v4 offset:0
    ds_read_b128 a[80:83], v4 offset:1024
    ds_read_b128 a[4:7], v4 offset:2048
    ds_read_b128 a[84:87], v4 offset:3072
    ds_read_b128 a[8:11], v4 offset:4096
    ds_read_b128 a[88:91], v4 offset:5120
    ds_read_b128 a[12:15], v4 offset:6144
    ds_read_b128 a[92:95], v4 offset:7168
    s_lshl_b32 s27, s21, 11
    s_add_u32 s27, s27, 32768
    v_add_u32 v13, s27, v0
    s_waitcnt vmcnt(14)
    v_perm_b32 v80, v52, v48, s44
    s_waitcnt vmcnt(12)
    v_perm_b32 v81, v60, v56, s44
    s_waitcnt vmcnt(10)
    v_perm_b32 v82, v68, v64, s44
    s_waitcnt vmcnt(8)
    v_perm_b32 v83, v76, v72, s44
    ds_write_b128 v13, v[80:83] offset:0
    v_perm_b32 v84, v52, v48, s45
    v_perm_b32 v85, v60, v56, s45
    v_perm_b32 v86, v68, v64, s45
    v_perm_b32 v87, v76, v72, s45
    ds_write_b128 v13, v[84:87] offset:1024
    v_perm_b32 v80, v53, v49, s44
    v_perm_b32 v81, v61, v57, s44
    v_perm_b32 v82, v69, v65, s44
    v_perm_b32 v83, v77, v73, s44
    ds_write_b128 v13, v[80:83] offset:8192
    v_perm_b32 v84, v53, v49, s45
    v_perm_b32 v85, v61, v57, s45
    v_perm_b32 v86, v69, v65, s45
    v_perm_b32 v87, v77, v73, s45
    ds_write_b128 v13, v[84:87] offset:9216
    v_perm_b32 v80, v54, v50, s44
    v_perm_b32 v81, v62, v58, s44
    v_perm_b32 v82, v70, v66, s44
    v_perm_b32 v83, v78, v74, s44
    ds_write_b128 v13, v[80:83] offset:16384
    v_perm_b32 v84, v54, v50, s45
    v_perm_b32 v85, v62, v58, s45
    v_perm_b32 v86, v70, v66, s45
    v_perm_b32 v87, v78, v74, s45
    ds_write_b128 v13, v[84:87] offset:17408
    v_perm_b32 v80, v55, v51, s44
    v_perm_b32 v81, v63, v59, s44
    v_perm_b32 v82, v71, v67, s44
    v_perm_b32 v83, v79, v75, s44
    ds_write_b128 v13, v[80:83] offset:24576
    v_perm_b32 v84, v55, v51, s45
    v_perm_b32 v85, v63, v59, s45
    v_perm_b32 v86, v71, v67, s45
    v_perm_b32 v87, v79, v75, s45
    ds_write_b128 v13, v[84:87] offset:25600
    s_add_u32 s26, s21, 12
    s_lshl_b32 s27, s26, 18
    s_add_u32 s27, s27, s46
    buffer_load_dwordx4 v[48:51], v12, s[72:75], s27 offen
    s_add_u32 s27, s27, 8192
    buffer_load_dwordx4 v[52:55], v12, s[72:75], s27 offen
    s_add_u32 s27, s27, 8192
    buffer_load_dwordx4 v[56:59], v12, s[72:75], s27 offen
    s_add_u32 s27, s27, 8192
    buffer_load_dwordx4 v[60:63], v12, s[72:75], s27 offen
    s_add_u32 s27, s27, 8192
    buffer_load_dwordx4 v[64:67], v12, s[72:75], s27 offen
    s_add_u32 s27, s27, 8192
    buffer_load_dwordx4 v[68:71], v12, s[72:75], s27 offen
    s_add_u32 s27, s27, 8192
    buffer_load_dwordx4 v[72:75], v12, s[72:75], s27 offen
    s_add_u32 s27, s27, 8192
    buffer_load_dwordx4 v[76:79], v12, s[72:75], s27 offen
    s_waitcnt lgkmcnt(0)
    s_barrier
    ds_read_b128 a[16:19], v5 offset:0
    ds_read_b128 a[96:99], v5 offset:1024
    ds_read_b128 a[20:23], v5 offset:2048
    ds_read_b128 a[100:103], v5 offset:3072
    ds_read_b128 a[24:27], v5 offset:4096
    ds_read_b128 a[104:107], v5 offset:5120
    ds_read_b128 a[28:31], v5 offset:6144
    ds_read_b128 a[108:111], v5 offset:7168
    s_lshl_b32 s27, s21, 11
    s_add_u32 s27, s27, 0
    v_add_u32 v13, s27, v0
    s_waitcnt vmcnt(14)
    v_perm_b32 v80, v20, v16, s44
    s_waitcnt vmcnt(12)
    v_perm_b32 v81, v28, v24, s44
    s_waitcnt vmcnt(10)
    v_perm_b32 v82, v36, v32, s44
    s_waitcnt vmcnt(8)
    v_perm_b32 v83, v44, v40, s44
    ds_write_b128 v13, v[80:83] offset:0
    v_perm_b32 v84, v20, v16, s45
    v_perm_b32 v85, v28, v24, s45
    v_perm_b32 v86, v36, v32, s45
    v_perm_b32 v87, v44, v40, s45
    ds_write_b128 v13, v[84:87] offset:1024
    v_perm_b32 v80, v21, v17, s44
    v_perm_b32 v81, v29, v25, s44
    v_perm_b32 v82, v37, v33, s44
    v_perm_b32 v83, v45, v41, s44
    ds_write_b128 v13, v[80:83] offset:8192
    v_perm_b32 v84, v21, v17, s45
    v_perm_b32 v85, v29, v25, s45
    v_perm_b32 v86, v37, v33, s45
    v_perm_b32 v87, v45, v41, s45
    ds_write_b128 v13, v[84:87] offset:9216
    v_perm_b32 v80, v22, v18, s44
    v_perm_b32 v81, v30, v26, s44
    v_perm_b32 v82, v38, v34, s44
    v_perm_b32 v83, v46, v42, s44
    ds_write_b128 v13, v[80:83] offset:16384
    v_perm_b32 v84, v22, v18, s45
    v_perm_b32 v85, v30, v26, s45
    v_perm_b32 v86, v38, v34, s45
    v_perm_b32 v87, v46, v42, s45
    ds_write_b128 v13, v[84:87] offset:17408
    v_perm_b32 v80, v23, v19, s44
    v_perm_b32 v81, v31, v27, s44
    v_perm_b32 v82, v39, v35, s44
    v_perm_b32 v83, v47, v43, s44
    ds_write_b128 v13, v[80:83] offset:24576
    v_perm_b32 v84, v23, v19, s45
    v_perm_b32 v85, v31, v27, s45
    v_perm_b32 v86, v39, v35, s45
    v_perm_b32 v87, v47, v43, s45
    ds_write_b128 v13, v[84:87] offset:25600
    s_add_u32 s26, s21, 16
    s_lshl_b32 s27, s26, 18
    s_add_u32 s27, s27, s46
    buffer_load_dwordx4 v[16:19], v12, s[72:75], s27 offen
    s_add_u32 s27, s27, 8192
    buffer_load_dwordx4 v[20:23], v12, s[72:75], s27 offen
    s_add_u32 s27, s27, 8192
    buffer_load_dwordx4 v[24:27], v12, s[72:75], s27 offen
    s_add_u32 s27, s27, 8192
    buffer_load_dwordx4 v[28:31], v12, s[72:75], s27 offen
    s_add_u32 s27, s27, 8192
    buffer_load_dwordx4 v[32:35], v12, s[72:75], s27 offen
    s_add_u32 s27, s27, 8192
    buffer_load_dwordx4 v[36:39], v12, s[72:75], s27 offen
    s_add_u32 s27, s27, 8192
    buffer_load_dwordx4 v[40:43], v12, s[72:75], s27 offen
    s_add_u32 s27, s27, 8192
    buffer_load_dwordx4 v[44:47], v12, s[72:75], s27 offen
    s_waitcnt lgkmcnt(0)
    s_barrier
    ds_read_b128 a[32:35], v4 offset:0
    ds_read_b128 a[112:115], v4 offset:1024
    ds_read_b128 a[36:39], v4 offset:2048
    ds_read_b128 a[116:119], v4 offset:3072
    ds_read_b128 a[40:43], v4 offset:4096
    ds_read_b128 a[120:123], v4 offset:5120
    ds_read_b128 a[44:47], v4 offset:6144
    ds_read_b128 a[124:127], v4 offset:7168
    s_lshl_b32 s27, s21, 11
    s_add_u32 s27, s27, 32768
    v_add_u32 v13, s27, v0
    s_waitcnt vmcnt(14)
    v_perm_b32 v80, v52, v48, s44
    s_waitcnt vmcnt(12)
    v_perm_b32 v81, v60, v56, s44
    s_waitcnt vmcnt(10)
    v_perm_b32 v82, v68, v64, s44
    s_waitcnt vmcnt(8)
    v_perm_b32 v83, v76, v72, s44
    ds_write_b128 v13, v[80:83] offset:0
    v_perm_b32 v84, v52, v48, s45
    v_perm_b32 v85, v60, v56, s45
    v_perm_b32 v86, v68, v64, s45
    v_perm_b32 v87, v76, v72, s45
    ds_write_b128 v13, v[84:87] offset:1024
    v_perm_b32 v80, v53, v49, s44
    v_perm_b32 v81, v61, v57, s44
    v_perm_b32 v82, v69, v65, s44
    v_perm_b32 v83, v77, v73, s44
    ds_write_b128 v13, v[80:83] offset:8192
    v_perm_b32 v84, v53, v49, s45
    v_perm_b32 v85, v61, v57, s45
    v_perm_b32 v86, v69, v65, s45
    v_perm_b32 v87, v77, v73, s45
    ds_write_b128 v13, v[84:87] offset:9216
    v_perm_b32 v80, v54, v50, s44
    v_perm_b32 v81, v62, v58, s44
    v_perm_b32 v82, v70, v66, s44
    v_perm_b32 v83, v78, v74, s44
    ds_write_b128 v13, v[80:83] offset:16384
    v_perm_b32 v84, v54, v50, s45
    v_perm_b32 v85, v62, v58, s45
    v_perm_b32 v86, v70, v66, s45
    v_perm_b32 v87, v78, v74, s45
    ds_write_b128 v13, v[84:87] offset:17408
    v_perm_b32 v80, v55, v51, s44
    v_perm_b32 v81, v63, v59, s44
    v_perm_b32 v82, v71, v67, s44
    v_perm_b32 v83, v79, v75, s44
    ds_write_b128 v13, v[80:83] offset:24576
    v_perm_b32 v84, v55, v51, s45
    v_perm_b32 v85, v63, v59, s45
    v_perm_b32 v86, v71, v67, s45
    v_perm_b32 v87, v79, v75, s45
    ds_write_b128 v13, v[84:87] offset:25600
    s_waitcnt lgkmcnt(0)
    s_barrier
    ds_read_b128 a[48:51], v5 offset:0
    ds_read_b128 a[128:131], v5 offset:1024
    ds_read_b128 a[52:55], v5 offset:2048
    ds_read_b128 a[132:135], v5 offset:3072
    ds_read_b128 a[56:59], v5 offset:4096
    ds_read_b128 a[136:139], v5 offset:5120
    ds_read_b128 a[60:63], v5 offset:6144
    ds_read_b128 a[140:143], v5 offset:7168
    s_lshl_b32 s27, s21, 11
    s_add_u32 s27, s27, 0
    v_add_u32 v13, s27, v0
    s_waitcnt vmcnt(6)
    v_perm_b32 v80, v20, v16, s44
    s_waitcnt vmcnt(4)
    v_perm_b32 v81, v28, v24, s44
    s_waitcnt vmcnt(2)
    v_perm_b32 v82, v36, v32, s44
    s_waitcnt vmcnt(0)
    v_perm_b32 v83, v44, v40, s44
    ds_write_b128 v13, v[80:83] offset:0
    v_perm_b32 v84, v20, v16, s45
    v_perm_b32 v85, v28, v24, s45
    v_perm_b32 v86, v36, v32, s45
    v_perm_b32 v87, v44, v40, s45
    ds_write_b128 v13, v[84:87] offset:1024
    v_perm_b32 v80, v21, v17, s44
    v_perm_b32 v81, v29, v25, s44
    v_perm_b32 v82, v37, v33, s44
    v_perm_b32 v83, v45, v41, s44
    ds_write_b128 v13, v[80:83] offset:8192
    v_perm_b32 v84, v21, v17, s45
    v_perm_b32 v85, v29, v25, s45
    v_perm_b32 v86, v37, v33, s45
    v_perm_b32 v87, v45, v41, s45
    ds_write_b128 v13, v[84:87] offset:9216
    v_perm_b32 v80, v22, v18, s44
    v_perm_b32 v81, v30, v26, s44
    v_perm_b32 v82, v38, v34, s44
    v_perm_b32 v83, v46, v42, s44
    ds_write_b128 v13, v[80:83] offset:16384
    v_perm_b32 v84, v22, v18, s45
    v_perm_b32 v85, v30, v26, s45
    v_perm_b32 v86, v38, v34, s45
    v_perm_b32 v87, v46, v42, s45
    ds_write_b128 v13, v[84:87] offset:17408
    v_perm_b32 v80, v23, v19, s44
    v_perm_b32 v81, v31, v27, s44
    v_perm_b32 v82, v39, v35, s44
    v_perm_b32 v83, v47, v43, s44
    ds_write_b128 v13, v[80:83] offset:24576
    v_perm_b32 v84, v23, v19, s45
    v_perm_b32 v85, v31, v27, s45
    v_perm_b32 v86, v39, v35, s45
    v_perm_b32 v87, v47, v43, s45
    ds_write_b128 v13, v[84:87] offset:25600
    s_waitcnt lgkmcnt(0)
    s_barrier
    ds_read_b128 a[64:67], v4 offset:0
    ds_read_b128 a[144:147], v4 offset:1024
    ds_read_b128 a[68:71], v4 offset:2048
    ds_read_b128 a[148:151], v4 offset:3072
    ds_read_b128 a[72:75], v4 offset:4096
    ds_read_b128 a[152:155], v4 offset:5120
    ds_read_b128 a[76:79], v4 offset:6144
    ds_read_b128 a[156:159], v4 offset:7168
    s_waitcnt lgkmcnt(0)
    s_branch M_lw_done
M_bl_kv:
    s_mov_b32 s44, 0x05040100
    s_mov_b32 s45, 0x07060302
    s_add_u32 s26, s21, 0
    s_lshl_b32 s27, s26, 18
    s_add_u32 s27, s27, s46
    buffer_load_dwordx4 v[16:19], v12, s[76:79], s27 offen
    s_add_u32 s27, s27, 8192
    buffer_load_dwordx4 v[20:23], v12, s[76:79], s27 offen
    s_add_u32 s27, s27, 8192
    buffer_load_dwordx4 v[24:27], v12, s[76:79], s27 offen
    s_add_u32 s27, s27, 8192
    buffer_load_dwordx4 v[28:31], v12, s[76:79], s27 offen
    s_add_u32 s27, s27, 8192
    buffer_load_dwordx4 v[32:35], v12, s[76:79], s27 offen
    s_add_u32 s27, s27, 8192
    buffer_load_dwordx4 v[36:39], v12, s[76:79], s27 offen
    s_add_u32 s27, s27, 8192
    buffer_load_dwordx4 v[40:43], v12, s[76:79], s27 offen
    s_add_u32 s27, s27, 8192
    buffer_load_dwordx4 v[44:47], v12, s[76:79], s27 offen
    s_add_u32 s26, s21, 4
    s_lshl_b32 s27, s26, 18
    s_add_u32 s27, s27, s46
    buffer_load_dwordx4 v[48:51], v12, s[76:79], s27 offen
    s_add_u32 s27, s27, 8192
    buffer_load_dwordx4 v[52:55], v12, s[76:79], s27 offen
    s_add_u32 s27, s27, 8192
    buffer_load_dwordx4 v[56:59], v12, s[76:79], s27 offen
    s_add_u32 s27, s27, 8192
    buffer_load_dwordx4 v[60:63], v12, s[76:79], s27 offen
    s_add_u32 s27, s27, 8192
    buffer_load_dwordx4 v[64:67], v12, s[76:79], s27 offen
    s_add_u32 s27, s27, 8192
    buffer_load_dwordx4 v[68:71], v12, s[76:79], s27 offen
    s_add_u32 s27, s27, 8192
    buffer_load_dwordx4 v[72:75], v12, s[76:79], s27 offen
    s_add_u32 s27, s27, 8192
    buffer_load_dwordx4 v[76:79], v12, s[76:79], s27 offen
    s_lshl_b32 s27, s21, 11
    s_add_u32 s27, s27, 0
    v_add_u32 v13, s27, v0
    s_waitcnt vmcnt(14)
    v_perm_b32 v80, v20, v16, s44
    s_waitcnt vmcnt(12)
    v_perm_b32 v81, v28, v24, s44
    s_waitcnt vmcnt(10)
    v_perm_b32 v82, v36, v32, s44
    s_waitcnt vmcnt(8)
    v_perm_b32 v83, v44, v40, s44
    ds_write_b128 v13, v[80:83] offset:0
    v_perm_b32 v84, v20, v16, s45
    v_perm_b32 v85, v28, v24, s45
    v_perm_b32 v86, v36, v32, s45
    v_perm_b32 v87, v44, v40, s45
    ds_write_b128 v13, v[84:87] offset:1024
    v_perm_b32 v80, v21, v17, s44
    v_perm_b32 v81, v29, v25, s44
    v_perm_b32 v82, v37, v33, s44
    v_perm_b32 v83, v45, v41, s44
    ds_write_b128 v13, v[80:83] offset:8192
    v_perm_b32 v84, v21, v17, s45
    v_perm_b32 v85, v29, v25, s45
    v_perm_b32 v86, v37, v33, s45
    v_perm_b32 v87, v45, v41, s45
    ds_write_b128 v13, v[84:87] offset:9216
    v_perm_b32 v80, v22, v18, s44
    v_perm_b32 v81, v30, v26, s44
    v_perm_b32 v82, v38, v34, s44
    v_perm_b32 v83, v46, v42, s44
    ds_write_b128 v13, v[80:83] offset:16384
    v_perm_b32 v84, v22, v18, s45
    v_perm_b32 v85, v30, v26, s45
    v_perm_b32 v86, v38, v34, s45
    v_perm_b32 v87, v46, v42, s45
    ds_write_b128 v13, v[84:87] offset:17408
    v_perm_b32 v80, v23, v19, s44
    v_perm_b32 v81, v31, v27, s44
    v_perm_b32 v82, v39, v35, s44
    v_perm_b32 v83, v47, v43, s44
    ds_write_b128 v13, v[80:83] offset:24576
    v_perm_b32 v84, v23, v19, s45
    v_perm_b32 v85, v31, v27, s45
    v_perm_b32 v86, v39, v35, s45
    v_perm_b32 v87, v47, v43, s45
    ds_write_b128 v13, v[84:87] offset:25600
    s_add_u32 s26, s21, 8
    s_lshl_b32 s27, s26, 18
    s_add_u32 s27, s27, s46
    buffer_load_dwordx4 v[16:19], v12, s[76:79], s27 offen
    s_add_u32 s27, s27, 8192
    buffer_load_dwordx4 v[20:23], v12, s[76:79], s27 offen
    s_add_u32 s27, s27, 8192
    buffer_load_dwordx4 v[24:27], v12, s[76:79], s27 offen
    s_add_u32 s27, s27, 8192
    buffer_load_dwordx4 v[28:31], v12, s[76:79], s27 offen
    s_add_u32 s27, s27, 8192
    buffer_load_dwordx4 v[32:35], v12, s[76:79], s27 offen
    s_add_u32 s27, s27, 8192
    buffer_load_dwordx4 v[36:39], v12, s[76:79], s27 offen
    s_add_u32 s27, s27, 8192
    buffer_load_dwordx4 v[40:43], v12, s[76:79], s27 offen
    s_add_u32 s27, s27, 8192
    buffer_load_dwordx4 v[44:47], v12, s[76:79], s27 offen
    s_waitcnt lgkmcnt(0)
    s_barrier
    ds_read_b128 a[0:3], v4 offset:0
    ds_read_b128 a[80:83], v4 offset:1024
    ds_read_b128 a[4:7], v4 offset:2048
    ds_read_b128 a[84:87], v4 offset:3072
    ds_read_b128 a[8:11], v4 offset:4096
    ds_read_b128 a[88:91], v4 offset:5120
    ds_read_b128 a[12:15], v4 offset:6144
    ds_read_b128 a[92:95], v4 offset:7168
    s_lshl_b32 s27, s21, 11
    s_add_u32 s27, s27, 32768
    v_add_u32 v13, s27, v0
    s_waitcnt vmcnt(14)
    v_perm_b32 v80, v52, v48, s44
    s_waitcnt vmcnt(12)
    v_perm_b32 v81, v60, v56, s44
    s_waitcnt vmcnt(10)
    v_perm_b32 v82, v68, v64, s44
    s_waitcnt vmcnt(8)
    v_perm_b32 v83, v76, v72, s44
    ds_write_b128 v13, v[80:83] offset:0
    v_perm_b32 v84, v52, v48, s45
    v_perm_b32 v85, v60, v56, s45
    v_perm_b32 v86, v68, v64, s45
    v_perm_b32 v87, v76, v72, s45
    ds_write_b128 v13, v[84:87] offset:1024
    v_perm_b32 v80, v53, v49, s44
    v_perm_b32 v81, v61, v57, s44
    v_perm_b32 v82, v69, v65, s44
    v_perm_b32 v83, v77, v73, s44
    ds_write_b128 v13, v[80:83] offset:8192
    v_perm_b32 v84, v53, v49, s45
    v_perm_b32 v85, v61, v57, s45
    v_perm_b32 v86, v69, v65, s45
    v_perm_b32 v87, v77, v73, s45
    ds_write_b128 v13, v[84:87] offset:9216
    v_perm_b32 v80, v54, v50, s44
    v_perm_b32 v81, v62, v58, s44
    v_perm_b32 v82, v70, v66, s44
    v_perm_b32 v83, v78, v74, s44
    ds_write_b128 v13, v[80:83] offset:16384
    v_perm_b32 v84, v54, v50, s45
    v_perm_b32 v85, v62, v58, s45
    v_perm_b32 v86, v70, v66, s45
    v_perm_b32 v87, v78, v74, s45
    ds_write_b128 v13, v[84:87] offset:17408
    v_perm_b32 v80, v55, v51, s44
    v_perm_b32 v81, v63, v59, s44
    v_perm_b32 v82, v71, v67, s44
    v_perm_b32 v83, v79, v75, s44
    ds_write_b128 v13, v[80:83] offset:24576
    v_perm_b32 v84, v55, v51, s45
    v_perm_b32 v85, v63, v59, s45
    v_perm_b32 v86, v71, v67, s45
    v_perm_b32 v87, v79, v75, s45
    ds_write_b128 v13, v[84:87] offset:25600
    s_add_u32 s26, s21, 12
    s_lshl_b32 s27, s26, 18
    s_add_u32 s27, s27, s46
    buffer_load_dwordx4 v[48:51], v12, s[76:79], s27 offen
    s_add_u32 s27, s27, 8192
    buffer_load_dwordx4 v[52:55], v12, s[76:79], s27 offen
    s_add_u32 s27, s27, 8192
    buffer_load_dwordx4 v[56:59], v12, s[76:79], s27 offen
    s_add_u32 s27, s27, 8192
    buffer_load_dwordx4 v[60:63], v12, s[76:79], s27 offen
    s_add_u32 s27, s27, 8192
    buffer_load_dwordx4 v[64:67], v12, s[76:79], s27 offen
    s_add_u32 s27, s27, 8192
    buffer_load_dwordx4 v[68:71], v12, s[76:79], s27 offen
    s_add_u32 s27, s27, 8192
    buffer_load_dwordx4 v[72:75], v12, s[76:79], s27 offen
    s_add_u32 s27, s27, 8192
    buffer_load_dwordx4 v[76:79], v12, s[76:79], s27 offen
    s_waitcnt lgkmcnt(0)
    s_barrier
    ds_read_b128 a[16:19], v5 offset:0
    ds_read_b128 a[96:99], v5 offset:1024
    ds_read_b128 a[20:23], v5 offset:2048
    ds_read_b128 a[100:103], v5 offset:3072
    ds_read_b128 a[24:27], v5 offset:4096
    ds_read_b128 a[104:107], v5 offset:5120
    ds_read_b128 a[28:31], v5 offset:6144
    ds_read_b128 a[108:111], v5 offset:7168
    s_lshl_b32 s27, s21, 11
    s_add_u32 s27, s27, 0
    v_add_u32 v13, s27, v0
    s_waitcnt vmcnt(14)
    v_perm_b32 v80, v20, v16, s44
    s_waitcnt vmcnt(12)
    v_perm_b32 v81, v28, v24, s44
    s_waitcnt vmcnt(10)
    v_perm_b32 v82, v36, v32, s44
    s_waitcnt vmcnt(8)
    v_perm_b32 v83, v44, v40, s44
    ds_write_b128 v13, v[80:83] offset:0
    v_perm_b32 v84, v20, v16, s45
    v_perm_b32 v85, v28, v24, s45
    v_perm_b32 v86, v36, v32, s45
    v_perm_b32 v87, v44, v40, s45
    ds_write_b128 v13, v[84:87] offset:1024
    v_perm_b32 v80, v21, v17, s44
    v_perm_b32 v81, v29, v25, s44
    v_perm_b32 v82, v37, v33, s44
    v_perm_b32 v83, v45, v41, s44
    ds_write_b128 v13, v[80:83] offset:8192
    v_perm_b32 v84, v21, v17, s45
    v_perm_b32 v85, v29, v25, s45
    v_perm_b32 v86, v37, v33, s45
    v_perm_b32 v87, v45, v41, s45
    ds_write_b128 v13, v[84:87] offset:9216
    v_perm_b32 v80, v22, v18, s44
    v_perm_b32 v81, v30, v26, s44
    v_perm_b32 v82, v38, v34, s44
    v_perm_b32 v83, v46, v42, s44
    ds_write_b128 v13, v[80:83] offset:16384
    v_perm_b32 v84, v22, v18, s45
    v_perm_b32 v85, v30, v26, s45
    v_perm_b32 v86, v38, v34, s45
    v_perm_b32 v87, v46, v42, s45
    ds_write_b128 v13, v[84:87] offset:17408
    v_perm_b32 v80, v23, v19, s44
    v_perm_b32 v81, v31, v27, s44
    v_perm_b32 v82, v39, v35, s44
    v_perm_b32 v83, v47, v43, s44
    ds_write_b128 v13, v[80:83] offset:24576
    v_perm_b32 v84, v23, v19, s45
    v_perm_b32 v85, v31, v27, s45
    v_perm_b32 v86, v39, v35, s45
    v_perm_b32 v87, v47, v43, s45
    ds_write_b128 v13, v[84:87] offset:25600
    s_add_u32 s26, s21, 16
    s_lshl_b32 s27, s26, 18
    s_add_u32 s27, s27, s46
    buffer_load_dwordx4 v[16:19], v12, s[76:79], s27 offen
    s_add_u32 s27, s27, 8192
    buffer_load_dwordx4 v[20:23], v12, s[76:79], s27 offen
    s_add_u32 s27, s27, 8192
    buffer_load_dwordx4 v[24:27], v12, s[76:79], s27 offen
    s_add_u32 s27, s27, 8192
    buffer_load_dwordx4 v[28:31], v12, s[76:79], s27 offen
    s_add_u32 s27, s27, 8192
    buffer_load_dwordx4 v[32:35], v12, s[76:79], s27 offen
    s_add_u32 s27, s27, 8192
    buffer_load_dwordx4 v[36:39], v12, s[76:79], s27 offen
    s_add_u32 s27, s27, 8192
    buffer_load_dwordx4 v[40:43], v12, s[76:79], s27 offen
    s_add_u32 s27, s27, 8192
    buffer_load_dwordx4 v[44:47], v12, s[76:79], s27 offen
    s_waitcnt lgkmcnt(0)
    s_barrier
    ds_read_b128 a[32:35], v4 offset:0
    ds_read_b128 a[112:115], v4 offset:1024
    ds_read_b128 a[36:39], v4 offset:2048
    ds_read_b128 a[116:119], v4 offset:3072
    ds_read_b128 a[40:43], v4 offset:4096
    ds_read_b128 a[120:123], v4 offset:5120
    ds_read_b128 a[44:47], v4 offset:6144
    ds_read_b128 a[124:127], v4 offset:7168
    s_lshl_b32 s27, s21, 11
    s_add_u32 s27, s27, 32768
    v_add_u32 v13, s27, v0
    s_waitcnt vmcnt(14)
    v_perm_b32 v80, v52, v48, s44
    s_waitcnt vmcnt(12)
    v_perm_b32 v81, v60, v56, s44
    s_waitcnt vmcnt(10)
    v_perm_b32 v82, v68, v64, s44
    s_waitcnt vmcnt(8)
    v_perm_b32 v83, v76, v72, s44
    ds_write_b128 v13, v[80:83] offset:0
    v_perm_b32 v84, v52, v48, s45
    v_perm_b32 v85, v60, v56, s45
    v_perm_b32 v86, v68, v64, s45
    v_perm_b32 v87, v76, v72, s45
    ds_write_b128 v13, v[84:87] offset:1024
    v_perm_b32 v80, v53, v49, s44
    v_perm_b32 v81, v61, v57, s44
    v_perm_b32 v82, v69, v65, s44
    v_perm_b32 v83, v77, v73, s44
    ds_write_b128 v13, v[80:83] offset:8192
    v_perm_b32 v84, v53, v49, s45
    v_perm_b32 v85, v61, v57, s45
    v_perm_b32 v86, v69, v65, s45
    v_perm_b32 v87, v77, v73, s45
    ds_write_b128 v13, v[84:87] offset:9216
    v_perm_b32 v80, v54, v50, s44
    v_perm_b32 v81, v62, v58, s44
    v_perm_b32 v82, v70, v66, s44
    v_perm_b32 v83, v78, v74, s44
    ds_write_b128 v13, v[80:83] offset:16384
    v_perm_b32 v84, v54, v50, s45
    v_perm_b32 v85, v62, v58, s45
    v_perm_b32 v86, v70, v66, s45
    v_perm_b32 v87, v78, v74, s45
    ds_write_b128 v13, v[84:87] offset:17408
    v_perm_b32 v80, v55, v51, s44
    v_perm_b32 v81, v63, v59, s44
    v_perm_b32 v82, v71, v67, s44
    v_perm_b32 v83, v79, v75, s44
    ds_write_b128 v13, v[80:83] offset:24576
    v_perm_b32 v84, v55, v51, s45
    v_perm_b32 v85, v63, v59, s45
    v_perm_b32 v86, v71, v67, s45
    v_perm_b32 v87, v79, v75, s45
    ds_write_b128 v13, v[84:87] offset:25600
    s_add_u32 s26, s21, 0
    s_lshl_b32 s27, s26, 18
    s_add_u32 s27, s27, s46
    buffer_load_dwordx4 v[48:51], v12, s[80:83], s27 offen
    s_add_u32 s27, s27, 8192
    buffer_load_dwordx4 v[52:55], v12, s[80:83], s27 offen
    s_add_u32 s27, s27, 8192
    buffer_load_dwordx4 v[56:59], v12, s[80:83], s27 offen
    s_add_u32 s27, s27, 8192
    buffer_load_dwordx4 v[60:63], v12, s[80:83], s27 offen
    s_add_u32 s27, s27, 8192
    buffer_load_dwordx4 v[64:67], v12, s[80:83], s27 offen
    s_add_u32 s27, s27, 8192
    buffer_load_dwordx4 v[68:71], v12, s[80:83], s27 offen
    s_add_u32 s27, s27, 8192
    buffer_load_dwordx4 v[72:75], v12, s[80:83], s27 offen
    s_add_u32 s27, s27, 8192
    buffer_load_dwordx4 v[76:79], v12, s[80:83], s27 offen
    s_waitcnt lgkmcnt(0)
    s_barrier
    ds_read_b128 a[48:51], v5 offset:0
    ds_read_b128 a[128:131], v5 offset:1024
    ds_read_b128 a[52:55], v5 offset:2048
    ds_read_b128 a[132:135], v5 offset:3072
    ds_read_b128 a[56:59], v5 offset:4096
    ds_read_b128 a[136:139], v5 offset:5120
    ds_read_b128 a[60:63], v5 offset:6144
    ds_read_b128 a[140:143], v5 offset:7168
    s_lshl_b32 s27, s21, 11
    s_add_u32 s27, s27, 0
    v_add_u32 v13, s27, v0
    s_waitcnt vmcnt(14)
    v_perm_b32 v80, v20, v16, s44
    s_waitcnt vmcnt(12)
    v_perm_b32 v81, v28, v24, s44
    s_waitcnt vmcnt(10)
    v_perm_b32 v82, v36, v32, s44
    s_waitcnt vmcnt(8)
    v_perm_b32 v83, v44, v40, s44
    ds_write_b128 v13, v[80:83] offset:0
    v_perm_b32 v84, v20, v16, s45
    v_perm_b32 v85, v28, v24, s45
    v_perm_b32 v86, v36, v32, s45
    v_perm_b32 v87, v44, v40, s45
    ds_write_b128 v13, v[84:87] offset:1024
    v_perm_b32 v80, v21, v17, s44
    v_perm_b32 v81, v29, v25, s44
    v_perm_b32 v82, v37, v33, s44
    v_perm_b32 v83, v45, v41, s44
    ds_write_b128 v13, v[80:83] offset:8192
    v_perm_b32 v84, v21, v17, s45
    v_perm_b32 v85, v29, v25, s45
    v_perm_b32 v86, v37, v33, s45
    v_perm_b32 v87, v45, v41, s45
    ds_write_b128 v13, v[84:87] offset:9216
    v_perm_b32 v80, v22, v18, s44
    v_perm_b32 v81, v30, v26, s44
    v_perm_b32 v82, v38, v34, s44
    v_perm_b32 v83, v46, v42, s44
    ds_write_b128 v13, v[80:83] offset:16384
    v_perm_b32 v84, v22, v18, s45
    v_perm_b32 v85, v30, v26, s45
    v_perm_b32 v86, v38, v34, s45
    v_perm_b32 v87, v46, v42, s45
    ds_write_b128 v13, v[84:87] offset:17408
    v_perm_b32 v80, v23, v19, s44
    v_perm_b32 v81, v31, v27, s44
    v_perm_b32 v82, v39, v35, s44
    v_perm_b32 v83, v47, v43, s44
    ds_write_b128 v13, v[80:83] offset:24576
    v_perm_b32 v84, v23, v19, s45
    v_perm_b32 v85, v31, v27, s45
    v_perm_b32 v86, v39, v35, s45
    v_perm_b32 v87, v47, v43, s45
    ds_write_b128 v13, v[84:87] offset:25600
    s_add_u32 s26, s21, 4
    s_lshl_b32 s27, s26, 18
    s_add_u32 s27, s27, s46
    buffer_load_dwordx4 v[16:19], v12, s[80:83], s27 offen
    s_add_u32 s27, s27, 8192
    buffer_load_dwordx4 v[20:23], v12, s[80:83], s27 offen
    s_add_u32 s27, s27, 8192
    buffer_load_dwordx4 v[24:27], v12, s[80:83], s27 offen
    s_add_u32 s27, s27, 8192
    buffer_load_dwordx4 v[28:31], v12, s[80:83], s27 offen
    s_add_u32 s27, s27, 8192
    buffer_load_dwordx4 v[32:35], v12, s[80:83], s27 offen
    s_add_u32 s27, s27, 8192
    buffer_load_dwordx4 v[36:39], v12, s[80:83], s27 offen
    s_add_u32 s27, s27, 8192
    buffer_load_dwordx4 v[40:43], v12, s[80:83], s27 offen
    s_add_u32 s27, s27, 8192
    buffer_load_dwordx4 v[44:47], v12, s[80:83], s27 offen
    s_waitcnt lgkmcnt(0)
    s_barrier
    ds_read_b128 a[64:67], v4 offset:0
    ds_read_b128 a[144:147], v4 offset:1024
    ds_read_b128 a[68:71], v4 offset:2048
    ds_read_b128 a[148:151], v4 offset:3072
    ds_read_b128 a[72:75], v4 offset:4096
    ds_read_b128 a[152:155], v4 offset:5120
    ds_read_b128 a[76:79], v4 offset:6144
    ds_read_b128 a[156:159], v4 offset:7168
    s_lshl_b32 s27, s21, 11
    s_add_u32 s27, s27, 32768
    v_add_u32 v13, s27, v0
    s_waitcnt vmcnt(14)
    v_perm_b32 v80, v52, v48, s44
    s_waitcnt vmcnt(12)
    v_perm_b32 v81, v60, v56, s44
    s_waitcnt vmcnt(10)
    v_perm_b32 v82, v68, v64, s44
    s_waitcnt vmcnt(8)
    v_perm_b32 v83, v76, v72, s44
    ds_write_b128 v13, v[80:83] offset:0
    v_perm_b32 v84, v52, v48, s45
    v_perm_b32 v85, v60, v56, s45
    v_perm_b32 v86, v68, v64, s45
    v_perm_b32 v87, v76, v72, s45
    ds_write_b128 v13, v[84:87] offset:1024
    v_perm_b32 v80, v53, v49, s44
    v_perm_b32 v81, v61, v57, s44
    v_perm_b32 v82, v69, v65, s44
    v_perm_b32 v83, v77, v73, s44
    ds_write_b128 v13, v[80:83] offset:8192
    v_perm_b32 v84, v53, v49, s45
    v_perm_b32 v85, v61, v57, s45
    v_perm_b32 v86, v69, v65, s45
    v_perm_b32 v87, v77, v73, s45
    ds_write_b128 v13, v[84:87] offset:9216
    v_perm_b32 v80, v54, v50, s44
    v_perm_b32 v81, v62, v58, s44
    v_perm_b32 v82, v70, v66, s44
    v_perm_b32 v83, v78, v74, s44
    ds_write_b128 v13, v[80:83] offset:16384
    v_perm_b32 v84, v54, v50, s45
    v_perm_b32 v85, v62, v58, s45
    v_perm_b32 v86, v70, v66, s45
    v_perm_b32 v87, v78, v74, s45
    ds_write_b128 v13, v[84:87] offset:17408
    v_perm_b32 v80, v55, v51, s44
    v_perm_b32 v81, v63, v59, s44
    v_perm_b32 v82, v71, v67, s44
    v_perm_b32 v83, v79, v75, s44
    ds_write_b128 v13, v[80:83] offset:24576
    v_perm_b32 v84, v55, v51, s45
    v_perm_b32 v85, v63, v59, s45
    v_perm_b32 v86, v71, v67, s45
    v_perm_b32 v87, v79, v75, s45
    ds_write_b128 v13, v[84:87] offset:25600
    s_add_u32 s26, s21, 8
    s_lshl_b32 s27, s26, 18
    s_add_u32 s27, s27, s46
    buffer_load_dwordx4 v[48:51], v12, s[80:83], s27 offen
    s_add_u32 s27, s27, 8192
    buffer_load_dwordx4 v[52:55], v12, s[80:83], s27 offen
    s_add_u32 s27, s27, 8192
    buffer_load_dwordx4 v[56:59], v12, s[80:83], s27 offen
    s_add_u32 s27, s27, 8192
    buffer_load_dwordx4 v[60:63], v12, s[80:83], s27 offen
    s_add_u32 s27, s27, 8192
    buffer_load_dwordx4 v[64:67], v12, s[80:83], s27 offen
    s_add_u32 s27, s27, 8192
    buffer_load_dwordx4 v[68:71], v12, s[80:83], s27 offen
    s_add_u32 s27, s27, 8192
    buffer_load_dwordx4 v[72:75], v12, s[80:83], s27 offen
    s_add_u32 s27, s27, 8192
    buffer_load_dwordx4 v[76:79], v12, s[80:83], s27 offen
    s_waitcnt lgkmcnt(0)
    s_barrier
    ds_read_b128 a[160:163], v5 offset:0
    ds_read_b128 a[240:243], v5 offset:1024
    ds_read_b128 a[164:167], v5 offset:2048
    ds_read_b128 a[244:247], v5 offset:3072
    ds_read_b128 a[168:171], v5 offset:4096
    ds_read_b128 a[248:251], v5 offset:5120
    ds_read_b128 a[172:175], v5 offset:6144
    ds_read_b128 a[252:255], v5 offset:7168
    s_lshl_b32 s27, s21, 11
    s_add_u32 s27, s27, 0
    v_add_u32 v13, s27, v0
    s_waitcnt vmcnt(14)
    v_perm_b32 v80, v20, v16, s44
    s_waitcnt vmcnt(12)
    v_perm_b32 v81, v28, v24, s44
    s_waitcnt vmcnt(10)
    v_perm_b32 v82, v36, v32, s44
    s_waitcnt vmcnt(8)
    v_perm_b32 v83, v44, v40, s44
    ds_write_b128 v13, v[80:83] offset:0
    v_perm_b32 v84, v20, v16, s45
    v_perm_b32 v85, v28, v24, s45
    v_perm_b32 v86, v36, v32, s45
    v_perm_b32 v87, v44, v40, s45
    ds_write_b128 v13, v[84:87] offset:1024
    v_perm_b32 v80, v21, v17, s44
    v_perm_b32 v81, v29, v25, s44
    v_perm_b32 v82, v37, v33, s44
    v_perm_b32 v83, v45, v41, s44
    ds_write_b128 v13, v[80:83] offset:8192
    v_perm_b32 v84, v21, v17, s45
    v_perm_b32 v85, v29, v25, s45
    v_perm_b32 v86, v37, v33, s45
    v_perm_b32 v87, v45, v41, s45
    ds_write_b128 v13, v[84:87] offset:9216
    v_perm_b32 v80, v22, v18, s44
    v_perm_b32 v81, v30, v26, s44
    v_perm_b32 v82, v38, v34, s44
    v_perm_b32 v83, v46, v42, s44
    ds_write_b128 v13, v[80:83] offset:16384
    v_perm_b32 v84, v22, v18, s45
    v_perm_b32 v85, v30, v26, s45
    v_perm_b32 v86, v38, v34, s45
    v_perm_b32 v87, v46, v42, s45
    ds_write_b128 v13, v[84:87] offset:17408
    v_perm_b32 v80, v23, v19, s44
    v_perm_b32 v81, v31, v27, s44
    v_perm_b32 v82, v39, v35, s44
    v_perm_b32 v83, v47, v43, s44
    ds_write_b128 v13, v[80:83] offset:24576
    v_perm_b32 v84, v23, v19, s45
    v_perm_b32 v85, v31, v27, s45
    v_perm_b32 v86, v39, v35, s45
    v_perm_b32 v87, v47, v43, s45
    ds_write_b128 v13, v[84:87] offset:25600
    s_add_u32 s26, s21, 12
    s_lshl_b32 s27, s26, 18
    s_add_u32 s27, s27, s46
    buffer_load_dwordx4 v[16:19], v12, s[80:83], s27 offen
    s_add_u32 s27, s27, 8192
    buffer_load_dwordx4 v[20:23], v12, s[80:83], s27 offen
    s_add_u32 s27, s27, 8192
    buffer_load_dwordx4 v[24:27], v12, s[80:83], s27 offen
    s_add_u32 s27, s27, 8192
    buffer_load_dwordx4 v[28:31], v12, s[80:83], s27 offen
    s_add_u32 s27, s27, 8192
    buffer_load_dwordx4 v[32:35], v12, s[80:83], s27 offen
    s_add_u32 s27, s27, 8192
    buffer_load_dwordx4 v[36:39], v12, s[80:83], s27 offen
    s_add_u32 s27, s27, 8192
    buffer_load_dwordx4 v[40:43], v12, s[80:83], s27 offen
    s_add_u32 s27, s27, 8192
    buffer_load_dwordx4 v[44:47], v12, s[80:83], s27 offen
    s_waitcnt lgkmcnt(0)
    s_barrier
    ds_read_b128 a[176:179], v4 offset:0
    ds_read_b128 v[192:195], v4 offset:1024
    ds_read_b128 a[180:183], v4 offset:2048
    ds_read_b128 v[196:199], v4 offset:3072
    ds_read_b128 a[184:187], v4 offset:4096
    ds_read_b128 v[200:203], v4 offset:5120
    ds_read_b128 a[188:191], v4 offset:6144
    ds_read_b128 v[204:207], v4 offset:7168
    s_lshl_b32 s27, s21, 11
    s_add_u32 s27, s27, 32768
    v_add_u32 v13, s27, v0
    s_waitcnt vmcnt(14)
    v_perm_b32 v80, v52, v48, s44
    s_waitcnt vmcnt(12)
    v_perm_b32 v81, v60, v56, s44
    s_waitcnt vmcnt(10)
    v_perm_b32 v82, v68, v64, s44
    s_waitcnt vmcnt(8)
    v_perm_b32 v83, v76, v72, s44
    ds_write_b128 v13, v[80:83] offset:0
    v_perm_b32 v84, v52, v48, s45
    v_perm_b32 v85, v60, v56, s45
    v_perm_b32 v86, v68, v64, s45
    v_perm_b32 v87, v76, v72, s45
    ds_write_b128 v13, v[84:87] offset:1024
    v_perm_b32 v80, v53, v49, s44
    v_perm_b32 v81, v61, v57, s44
    v_perm_b32 v82, v69, v65, s44
    v_perm_b32 v83, v77, v73, s44
    ds_write_b128 v13, v[80:83] offset:8192
    v_perm_b32 v84, v53, v49, s45
    v_perm_b32 v85, v61, v57, s45
    v_perm_b32 v86, v69, v65, s45
    v_perm_b32 v87, v77, v73, s45
    ds_write_b128 v13, v[84:87] offset:9216
    v_perm_b32 v80, v54, v50, s44
    v_perm_b32 v81, v62, v58, s44
    v_perm_b32 v82, v70, v66, s44
    v_perm_b32 v83, v78, v74, s44
    ds_write_b128 v13, v[80:83] offset:16384
    v_perm_b32 v84, v54, v50, s45
    v_perm_b32 v85, v62, v58, s45
    v_perm_b32 v86, v70, v66, s45
    v_perm_b32 v87, v78, v74, s45
    ds_write_b128 v13, v[84:87] offset:17408
    v_perm_b32 v80, v55, v51, s44
    v_perm_b32 v81, v63, v59, s44
    v_perm_b32 v82, v71, v67, s44
    v_perm_b32 v83, v79, v75, s44
    ds_write_b128 v13, v[80:83] offset:24576
    v_perm_b32 v84, v55, v51, s45
    v_perm_b32 v85, v63, v59, s45
    v_perm_b32 v86, v71, v67, s45
    v_perm_b32 v87, v79, v75, s45
    ds_write_b128 v13, v[84:87] offset:25600
    s_add_u32 s26, s21, 16
    s_lshl_b32 s27, s26, 18
    s_add_u32 s27, s27, s46
    buffer_load_dwordx4 v[48:51], v12, s[80:83], s27 offen
    s_add_u32 s27, s27, 8192
    buffer_load_dwordx4 v[52:55], v12, s[80:83], s27 offen
    s_add_u32 s27, s27, 8192
    buffer_load_dwordx4 v[56:59], v12, s[80:83], s27 offen
    s_add_u32 s27, s27, 8192
    buffer_load_dwordx4 v[60:63], v12, s[80:83], s27 offen
    s_add_u32 s27, s27, 8192
    buffer_load_dwordx4 v[64:67], v12, s[80:83], s27 offen
    s_add_u32 s27, s27, 8192
    buffer_load_dwordx4 v[68:71], v12, s[80:83], s27 offen
    s_add_u32 s27, s27, 8192
    buffer_load_dwordx4 v[72:75], v12, s[80:83], s27 offen
    s_add_u32 s27, s27, 8192
    buffer_load_dwordx4 v[76:79], v12, s[80:83], s27 offen
    s_waitcnt lgkmcnt(0)
    s_barrier
    ds_read_b128 a[192:195], v5 offset:0
    ds_read_b128 v[208:211], v5 offset:1024
    ds_read_b128 a[196:199], v5 offset:2048
    ds_read_b128 v[212:215], v5 offset:3072
    ds_read_b128 a[200:203], v5 offset:4096
    ds_read_b128 v[216:219], v5 offset:5120
    ds_read_b128 a[204:207], v5 offset:6144
    ds_read_b128 v[220:223], v5 offset:7168
    s_lshl_b32 s27, s21, 11
    s_add_u32 s27, s27, 0
    v_add_u32 v13, s27, v0
    s_waitcnt vmcnt(14)
    v_perm_b32 v80, v20, v16, s44
    s_waitcnt vmcnt(12)
    v_perm_b32 v81, v28, v24, s44
    s_waitcnt vmcnt(10)
    v_perm_b32 v82, v36, v32, s44
    s_waitcnt vmcnt(8)
    v_perm_b32 v83, v44, v40, s44
    ds_write_b128 v13, v[80:83] offset:0
    v_perm_b32 v84, v20, v16, s45
    v_perm_b32 v85, v28, v24, s45
    v_perm_b32 v86, v36, v32, s45
    v_perm_b32 v87, v44, v40, s45
    ds_write_b128 v13, v[84:87] offset:1024
    v_perm_b32 v80, v21, v17, s44
    v_perm_b32 v81, v29, v25, s44
    v_perm_b32 v82, v37, v33, s44
    v_perm_b32 v83, v45, v41, s44
    ds_write_b128 v13, v[80:83] offset:8192
    v_perm_b32 v84, v21, v17, s45
    v_perm_b32 v85, v29, v25, s45
    v_perm_b32 v86, v37, v33, s45
    v_perm_b32 v87, v45, v41, s45
    ds_write_b128 v13, v[84:87] offset:9216
    v_perm_b32 v80, v22, v18, s44
    v_perm_b32 v81, v30, v26, s44
    v_perm_b32 v82, v38, v34, s44
    v_perm_b32 v83, v46, v42, s44
    ds_write_b128 v13, v[80:83] offset:16384
    v_perm_b32 v84, v22, v18, s45
    v_perm_b32 v85, v30, v26, s45
    v_perm_b32 v86, v38, v34, s45
    v_perm_b32 v87, v46, v42, s45
    ds_write_b128 v13, v[84:87] offset:17408
    v_perm_b32 v80, v23, v19, s44
    v_perm_b32 v81, v31, v27, s44
    v_perm_b32 v82, v39, v35, s44
    v_perm_b32 v83, v47, v43, s44
    ds_write_b128 v13, v[80:83] offset:24576
    v_perm_b32 v84, v23, v19, s45
    v_perm_b32 v85, v31, v27, s45
    v_perm_b32 v86, v39, v35, s45
    v_perm_b32 v87, v47, v43, s45
    ds_write_b128 v13, v[84:87] offset:25600
    s_waitcnt lgkmcnt(0)
    s_barrier
    ds_read_b128 a[208:211], v4 offset:0
    ds_read_b128 v[224:227], v4 offset:1024
    ds_read_b128 a[212:215], v4 offset:2048
    ds_read_b128 v[228:231], v4 offset:3072
    ds_read_b128 a[216:219], v4 offset:4096
    ds_read_b128 v[232:235], v4 offset:5120
    ds_read_b128 a[220:223], v4 offset:6144
    ds_read_b128 v[236:239], v4 offset:7168
    s_lshl_b32 s27, s21, 11
    s_add_u32 s27, s27, 32768
    v_add_u32 v13, s27, v0
    s_waitcnt vmcnt(6)
    v_perm_b32 v80, v52, v48, s44
    s_waitcnt vmcnt(4)
    v_perm_b32 v81, v60, v56, s44
    s_waitcnt vmcnt(2)
    v_perm_b32 v82, v68, v64, s44
    s_waitcnt vmcnt(0)
    v_perm_b32 v83, v76, v72, s44
    ds_write_b128 v13, v[80:83] offset:0
    v_perm_b32 v84, v52, v48, s45
    v_perm_b32 v85, v60, v56, s45
    v_perm_b32 v86, v68, v64, s45
    v_perm_b32 v87, v76, v72, s45
    ds_write_b128 v13, v[84:87] offset:1024
    v_perm_b32 v80, v53, v49, s44
    v_perm_b32 v81, v61, v57, s44
    v_perm_b32 v82, v69, v65, s44
    v_perm_b32 v83, v77, v73, s44
    ds_write_b128 v13, v[80:83] offset:8192
    v_perm_b32 v84, v53, v49, s45
    v_perm_b32 v85, v61, v57, s45
    v_perm_b32 v86, v69, v65, s45
    v_perm_b32 v87, v77, v73, s45
    ds_write_b128 v13, v[84:87] offset:9216
    v_perm_b32 v80, v54, v50, s44
    v_perm_b32 v81, v62, v58, s44
    v_perm_b32 v82, v70, v66, s44
    v_perm_b32 v83, v78, v74, s44
    ds_write_b128 v13, v[80:83] offset:16384
    v_perm_b32 v84, v54, v50, s45
    v_perm_b32 v85, v62, v58, s45
    v_perm_b32 v86, v70, v66, s45
    v_perm_b32 v87, v78, v74, s45
    ds_write_b128 v13, v[84:87] offset:17408
    v_perm_b32 v80, v55, v51, s44
    v_perm_b32 v81, v63, v59, s44
    v_perm_b32 v82, v71, v67, s44
    v_perm_b32 v83, v79, v75, s44
    ds_write_b128 v13, v[80:83] offset:24576
    v_perm_b32 v84, v55, v51, s45
    v_perm_b32 v85, v63, v59, s45
    v_perm_b32 v86, v71, v67, s45
    v_perm_b32 v87, v79, v75, s45
    ds_write_b128 v13, v[84:87] offset:25600
    s_waitcnt lgkmcnt(0)
    s_barrier
    ds_read_b128 a[224:227], v5 offset:0
    ds_read_b128 v[240:243], v5 offset:1024
    ds_read_b128 a[228:231], v5 offset:2048
    ds_read_b128 v[244:247], v5 offset:3072
    ds_read_b128 a[232:235], v5 offset:4096
    ds_read_b128 v[248:251], v5 offset:5120
    ds_read_b128 a[236:239], v5 offset:6144
    ds_read_b128 v[252:255], v5 offset:7168
    s_waitcnt lgkmcnt(0)
    s_branch M_lw_done
M_lw_chain:
    v_lshrrev_b32 v12, 8, v0
    v_lshlrev_b32 v12, 16, v12
    v_and_b32 v14, 0xf0, v0
    v_add_u32 v12, v12, v14
    s_lshl_b32 s46, s22, 8
    s_lshl_b32 s27, s21, 13
    s_add_u32 s28, s27, 106496
    v_add_u32 v4, s28, v0
    s_add_u32 s28, s27, 24576
    v_add_u32 v5, s28, v0
    s_lshl_b32 s27, s21, 12
    v_add_u32 v6, s27, v0
    s_mul_i32 s27, s21, 20480
    s_add_u32 s27, s27, 24576
    v_add_u32 v7, s27, v0
    s_mul_i32 s48, s20, 10
    s_and_b32 s27, s21, 1
    s_add_u32 s49, s27, 10
    s_sub_u32 s49, s49, s48
    s_add_u32 s48, s48, s27
    v_lshrrev_b32 v8, 9, v0
    v_lshlrev_b32 v8, 4, v8
    v_bfe_u32 v14, v0, 8, 1
    v_add_u32 v8, v8, v14
    v_mul_u32_u24 v8, 2560, v8
    s_and_b32 s47, s21, 1
    s_lshl_b32 s47, s47, 6
    s_lshr_b32 s27, s21, 1
    s_lshl_b32 s27, s27, 2
    s_add_u32 s47, s47, s27
    s_lshl_b32 s27, s22, 7
    s_add_u32 s47, s47, s27
    s_mul_i32 s47, s47, 1280
    s_mul_i32 s27, s20, 640
    s_add_u32 s47, s47, s27
    v_and_b32 v14, 0xf0, v0
    v_add_u32 v8, v8, v14
    s_mov_b32 s90, 5242880
    s_mov_b32 s91, 0x00020000
    s_mov_b32 s44, 0x05040100
    s_mov_b32 s45, 0x07060302
    s_add_u32 s27, s47, 0
    buffer_load_dwordx4 v[16:19], v8, s[84:87], s27 offen
    s_add_u32 s27, s47, 10240
    buffer_load_dwordx4 v[20:23], v8, s[84:87], s27 offen
    s_add_u32 s27, s47, 1280
    buffer_load_dwordx4 v[24:27], v8, s[84:87], s27 offen
    s_add_u32 s27, s47, 11520
    buffer_load_dwordx4 v[28:31], v8, s[84:87], s27 offen
    s_add_u32 s27, s47, 20480
    buffer_load_dwordx4 v[32:35], v8, s[84:87], s27 offen
    s_add_u32 s27, s47, 30720
    buffer_load_dwordx4 v[36:39], v8, s[84:87], s27 offen
    s_add_u32 s27, s47, 21760
    buffer_load_dwordx4 v[40:43], v8, s[84:87], s27 offen
    s_add_u32 s27, s47, 32000
    buffer_load_dwordx4 v[44:47], v8, s[84:87], s27 offen
    s_add_u32 s27, s47, 256
    buffer_load_dwordx4 v[48:51], v8, s[84:87], s27 offen
    s_add_u32 s27, s47, 10496
    buffer_load_dwordx4 v[52:55], v8, s[84:87], s27 offen
    s_add_u32 s27, s47, 1536
    buffer_load_dwordx4 v[56:59], v8, s[84:87], s27 offen
    s_add_u32 s27, s47, 11776
    buffer_load_dwordx4 v[60:63], v8, s[84:87], s27 offen
    s_add_u32 s27, s47, 20736
    buffer_load_dwordx4 v[64:67], v8, s[84:87], s27 offen
    s_add_u32 s27, s47, 30976
    buffer_load_dwordx4 v[68:71], v8, s[84:87], s27 offen
    s_add_u32 s27, s47, 22016
    buffer_load_dwordx4 v[72:75], v8, s[84:87], s27 offen
    s_add_u32 s27, s47, 32256
    buffer_load_dwordx4 v[76:79], v8, s[84:87], s27 offen
    v_and_b32 v13, 0x300, v0
    s_lshl_b32 s27, s21, 10
    s_add_u32 s27, s27, 24576
    v_add_u32 v13, s27, v13
    v_bfe_u32 v14, v0, 7, 1
    v_mul_u32_u24 v14, 20480, v14
    v_add_u32 v13, v13, v14
    v_bfe_u32 v14, v0, 5, 2
    v_lshl_add_u32 v13, v14, 6, v13
    v_and_b32 v14, 16, v0
    v_add_u32 v13, v13, v14
    s_waitcnt vmcnt(14)
    v_perm_b32 v80, v20, v16, s44
    s_waitcnt vmcnt(12)
    v_perm_b32 v81, v28, v24, s44
    s_waitcnt vmcnt(10)
    v_perm_b32 v82, v36, v32, s44
    s_waitcnt vmcnt(8)
    v_perm_b32 v83, v44, v40, s44
    ds_write_b128 v13, v[80:83] offset:0
    v_perm_b32 v84, v20, v16, s45
    v_perm_b32 v85, v28, v24, s45
    v_perm_b32 v86, v36, v32, s45
    v_perm_b32 v87, v44, v40, s45
    ds_write_b128 v13, v[84:87] offset:4096
    v_perm_b32 v80, v21, v17, s44
    v_perm_b32 v81, v29, v25, s44
    v_perm_b32 v82, v37, v33, s44
    v_perm_b32 v83, v45, v41, s44
    ds_write_b128 v13, v[80:83] offset:32
    v_perm_b32 v84, v21, v17, s45
    v_perm_b32 v85, v29, v25, s45
    v_perm_b32 v86, v37, v33, s45
    v_perm_b32 v87, v45, v41, s45
    ds_write_b128 v13, v[84:87] offset:4128
    v_perm_b32 v80, v22, v18, s44
    v_perm_b32 v81, v30, v26, s44
    v_perm_b32 v82, v38, v34, s44
    v_perm_b32 v83, v46, v42, s44
    ds_write_b128 v13, v[80:83] offset:8192
    v_perm_b32 v84, v22, v18, s45
    v_perm_b32 v85, v30, v26, s45
    v_perm_b32 v86, v38, v34, s45
    v_perm_b32 v87, v46, v42, s45
    ds_write_b128 v13, v[84:87] offset:12288
    v_perm_b32 v80, v23, v19, s44
    v_perm_b32 v81, v31, v27, s44
    v_perm_b32 v82, v39, v35, s44
    v_perm_b32 v83, v47, v43, s44
    ds_write_b128 v13, v[80:83] offset:8224
    v_perm_b32 v84, v23, v19, s45
    v_perm_b32 v85, v31, v27, s45
    v_perm_b32 v86, v39, v35, s45
    v_perm_b32 v87, v47, v43, s45
    ds_write_b128 v13, v[84:87] offset:12320
    s_mov_b32 exec_lo, 0x00ff00ff
    s_mov_b32 exec_hi, 0x00ff00ff
    s_add_u32 s27, s47, 512
    buffer_load_dwordx4 v[16:19], v8, s[84:87], s27 offen
    s_add_u32 s27, s47, 10752
    buffer_load_dwordx4 v[20:23], v8, s[84:87], s27 offen
    s_add_u32 s27, s47, 1792
    buffer_load_dwordx4 v[24:27], v8, s[84:87], s27 offen
    s_add_u32 s27, s47, 12032
    buffer_load_dwordx4 v[28:31], v8, s[84:87], s27 offen
    s_add_u32 s27, s47, 20992
    buffer_load_dwordx4 v[32:35], v8, s[84:87], s27 offen
    s_add_u32 s27, s47, 31232
    buffer_load_dwordx4 v[36:39], v8, s[84:87], s27 offen
    s_add_u32 s27, s47, 22272
    buffer_load_dwordx4 v[40:43], v8, s[84:87], s27 offen
    s_add_u32 s27, s47, 32512
    buffer_load_dwordx4 v[44:47], v8, s[84:87], s27 offen
    s_mov_b64 exec, -1
    v_and_b32 v13, 0x300, v0
    s_lshl_b32 s27, s21, 10
    s_add_u32 s27, s27, 65536
    v_add_u32 v13, s27, v13
    v_bfe_u32 v14, v0, 7, 1
    v_mul_u32_u24 v14, 20480, v14
    v_add_u32 v13, v13, v14
    v_bfe_u32 v14, v0, 5, 2
    v_lshl_add_u32 v13, v14, 6, v13
    v_and_b32 v14, 16, v0
    v_add_u32 v13, v13, v14
    s_waitcnt vmcnt(14)
    v_perm_b32 v80, v52, v48, s44
    s_waitcnt vmcnt(12)
    v_perm_b32 v81, v60, v56, s44
    s_waitcnt vmcnt(10)
    v_perm_b32 v82, v68, v64, s44
    s_waitcnt vmcnt(8)
    v_perm_b32 v83, v76, v72, s44
    ds_write_b128 v13, v[80:83] offset:0
    v_perm_b32 v84, v52, v48, s45
    v_perm_b32 v85, v60, v56, s45
    v_perm_b32 v86, v68, v64, s45
    v_perm_b32 v87, v76, v72, s45
    ds_write_b128 v13, v[84:87] offset:4096
    v_perm_b32 v80, v53, v49, s44
    v_perm_b32 v81, v61, v57, s44
    v_perm_b32 v82, v69, v65, s44
    v_perm_b32 v83, v77, v73, s44
    ds_write_b128 v13, v[80:83] offset:32
    v_perm_b32 v84, v53, v49, s45
    v_perm_b32 v85, v61, v57, s45
    v_perm_b32 v86, v69, v65, s45
    v_perm_b32 v87, v77, v73, s45
    ds_write_b128 v13, v[84:87] offset:4128
    v_perm_b32 v80, v54, v50, s44
    v_perm_b32 v81, v62, v58, s44
    v_perm_b32 v82, v70, v66, s44
    v_perm_b32 v83, v78, v74, s44
    ds_write_b128 v13, v[80:83] offset:8192
    v_perm_b32 v84, v54, v50, s45
    v_perm_b32 v85, v62, v58, s45
    v_perm_b32 v86, v70, v66, s45
    v_perm_b32 v87, v78, v74, s45
    ds_write_b128 v13, v[84:87] offset:12288
    v_perm_b32 v80, v55, v51, s44
    v_perm_b32 v81, v63, v59, s44
    v_perm_b32 v82, v71, v67, s44
    v_perm_b32 v83, v79, v75, s44
    ds_write_b128 v13, v[80:83] offset:8224
    v_perm_b32 v84, v55, v51, s45
    v_perm_b32 v85, v63, v59, s45
    v_perm_b32 v86, v71, v67, s45
    v_perm_b32 v87, v79, v75, s45
    ds_write_b128 v13, v[84:87] offset:12320
    s_cmp_lt_u32 s21, 2
    s_cselect_b32 s26, s48, s48
    s_cselect_b32 s27, 0, 2
    s_cselect_b64 s[88:89], s[76:77], s[76:77]
    s_add_u32 s26, s26, s27
    s_lshl_b32 s27, s26, 18
    s_add_u32 s27, s27, s46
    buffer_load_dwordx4 v[48:51], v12, s[88:91], s27 offen
    s_add_u32 s27, s27, 8192
    buffer_load_dwordx4 v[52:55], v12, s[88:91], s27 offen
    s_add_u32 s27, s27, 8192
    buffer_load_dwordx4 v[56:59], v12, s[88:91], s27 offen
    s_add_u32 s27, s27, 8192
    buffer_load_dwordx4 v[60:63], v12, s[88:91], s27 offen
    s_add_u32 s27, s27, 8192
    buffer_load_dwordx4 v[64:67], v12, s[88:91], s27 offen
    s_add_u32 s27, s27, 8192
    buffer_load_dwordx4 v[68:71], v12, s[88:91], s27 offen
    s_add_u32 s27, s27, 8192
    buffer_load_dwordx4 v[72:75], v12, s[88:91], s27 offen
    s_add_u32 s27, s27, 8192
    buffer_load_dwordx4 v[76:79], v12, s[88:91], s27 offen
    v_and_b32 v13, 0x300, v0
    s_lshl_b32 s27, s21, 10
    s_add_u32 s27, s27, 40960
    v_add_u32 v13, s27, v13
    v_bfe_u32 v14, v0, 5, 2
    v_mul_u32_u24 v14, 20480, v14
    v_add_u32 v13, v13, v14
    v_bfe_u32 v14, v0, 4, 1
    v_lshl_add_u32 v13, v14, 6, v13
    s_mov_b32 exec_lo, 0x00ff00ff
    s_mov_b32 exec_hi, 0x00ff00ff
    s_waitcnt vmcnt(14)
    v_perm_b32 v80, v20, v16, s44
    s_waitcnt vmcnt(12)
    v_perm_b32 v81, v28, v24, s44
    s_waitcnt vmcnt(10)
    v_perm_b32 v82, v36, v32, s44
    s_waitcnt vmcnt(8)
    v_perm_b32 v83, v44, v40, s44
    ds_write_b128 v13, v[80:83] offset:0
    v_perm_b32 v84, v20, v16, s45
    v_perm_b32 v85, v28, v24, s45
    v_perm_b32 v86, v36, v32, s45
    v_perm_b32 v87, v44, v40, s45
    ds_write_b128 v13, v[84:87] offset:16
    v_perm_b32 v80, v21, v17, s44
    v_perm_b32 v81, v29, v25, s44
    v_perm_b32 v82, v37, v33, s44
    v_perm_b32 v83, v45, v41, s44
    ds_write_b128 v13, v[80:83] offset:128
    v_perm_b32 v84, v21, v17, s45
    v_perm_b32 v85, v29, v25, s45
    v_perm_b32 v86, v37, v33, s45
    v_perm_b32 v87, v45, v41, s45
    ds_write_b128 v13, v[84:87] offset:144
    v_perm_b32 v80, v22, v18, s44
    v_perm_b32 v81, v30, v26, s44
    v_perm_b32 v82, v38, v34, s44
    v_perm_b32 v83, v46, v42, s44
    ds_write_b128 v13, v[80:83] offset:32
    v_perm_b32 v84, v22, v18, s45
    v_perm_b32 v85, v30, v26, s45
    v_perm_b32 v86, v38, v34, s45
    v_perm_b32 v87, v46, v42, s45
    ds_write_b128 v13, v[84:87] offset:48
    v_perm_b32 v80, v23, v19, s44
    v_perm_b32 v81, v31, v27, s44
    v_perm_b32 v82, v39, v35, s44
    v_perm_b32 v83, v47, v43, s44
    ds_write_b128 v13, v[80:83] offset:160
    v_perm_b32 v84, v23, v19, s45
    v_perm_b32 v85, v31, v27, s45
    v_perm_b32 v86, v39, v35, s45
    v_perm_b32 v87, v47, v43, s45
    ds_write_b128 v13, v[84:87] offset:176
    s_mov_b64 exec, -1
    s_cmp_lt_u32 s21, 2
    s_cselect_b32 s26, s48, s49
    s_cselect_b32 s27, 6, 4
    s_cselect_b64 s[88:89], s[76:77], s[72:73]
    s_add_u32 s26, s26, s27
    s_lshl_b32 s27, s26, 18
    s_add_u32 s27, s27, s46
    buffer_load_dwordx4 v[16:19], v12, s[88:91], s27 offen
    s_add_u32 s27, s27, 8192
    buffer_load_dwordx4 v[20:23], v12, s[88:91], s27 offen
    s_add_u32 s27, s27, 8192
    buffer_load_dwordx4 v[24:27], v12, s[88:91], s27 offen
    s_add_u32 s27, s27, 8192
    buffer_load_dwordx4 v[28:31], v12, s[88:91], s27 offen
    s_add_u32 s27, s27, 8192
    buffer_load_dwordx4 v[32:35], v12, s[88:91], s27 offen
    s_add_u32 s27, s27, 8192
    buffer_load_dwordx4 v[36:39], v12, s[88:91], s27 offen
    s_add_u32 s27, s27, 8192
    buffer_load_dwordx4 v[40:43], v12, s[88:91], s27 offen
    s_add_u32 s27, s27, 8192
    buffer_load_dwordx4 v[44:47], v12, s[88:91], s27 offen
    s_waitcnt lgkmcnt(0)
    s_barrier
    ds_read_b128 v[160:163], v7 offset:0
    ds_read_b128 v[164:167], v7 offset:1024
    ds_read_b128 v[152:155], v7 offset:2048
    ds_read_b128 v[156:159], v7 offset:3072
    ds_read_b128 v[144:147], v7 offset:4096
    ds_read_b128 v[148:151], v7 offset:5120
    ds_read_b128 v[136:139], v7 offset:6144
    ds_read_b128 v[140:143], v7 offset:7168
    ds_read_b128 v[128:131], v7 offset:8192
    ds_read_b128 v[132:135], v7 offset:9216
    ds_read_b128 v[120:123], v7 offset:10240
    ds_read_b128 v[124:127], v7 offset:11264
    ds_read_b128 v[112:115], v7 offset:12288
    ds_read_b128 v[116:119], v7 offset:13312
    ds_read_b128 v[104:107], v7 offset:14336
    ds_read_b128 v[108:111], v7 offset:15360
    ds_read_b128 v[96:99], v7 offset:16384
    ds_read_b128 v[100:103], v7 offset:17408
    ds_read_b128 v[88:91], v7 offset:18432
    ds_read_b128 v[92:95], v7 offset:19456
    s_lshl_b32 s27, s21, 11
    s_add_u32 s27, s27, 106496
    v_add_u32 v13, s27, v0
    s_waitcnt vmcnt(14)
    v_perm_b32 v80, v52, v48, s44
    s_waitcnt vmcnt(12)
    v_perm_b32 v81, v60, v56, s44
    s_waitcnt vmcnt(10)
    v_perm_b32 v82, v68, v64, s44
    s_waitcnt vmcnt(8)
    v_perm_b32 v83, v76, v72, s44
    ds_write_b128 v13, v[80:83] offset:0
    v_perm_b32 v84, v52, v48, s45
    v_perm_b32 v85, v60, v56, s45
    v_perm_b32 v86, v68, v64, s45
    v_perm_b32 v87, v76, v72, s45
    ds_write_b128 v13, v[84:87] offset:1024
    v_perm_b32 v80, v53, v49, s44
    v_perm_b32 v81, v61, v57, s44
    v_perm_b32 v82, v69, v65, s44
    v_perm_b32 v83, v77, v73, s44
    ds_write_b128 v13, v[80:83] offset:8192
    v_perm_b32 v84, v53, v49, s45
    v_perm_b32 v85, v61, v57, s45
    v_perm_b32 v86, v69, v65, s45
    v_perm_b32 v87, v77, v73, s45
    ds_write_b128 v13, v[84:87] offset:9216
    v_perm_b32 v80, v54, v50, s44
    v_perm_b32 v81, v62, v58, s44
    v_perm_b32 v82, v70, v66, s44
    v_perm_b32 v83, v78, v74, s44
    ds_write_b128 v13, v[80:83] offset:16384
    v_perm_b32 v84, v54, v50, s45
    v_perm_b32 v85, v62, v58, s45
    v_perm_b32 v86, v70, v66, s45
    v_perm_b32 v87, v78, v74, s45
    ds_write_b128 v13, v[84:87] offset:17408
    v_perm_b32 v80, v55, v51, s44
    v_perm_b32 v81, v63, v59, s44
    v_perm_b32 v82, v71, v67, s44
    v_perm_b32 v83, v79, v75, s44
    ds_write_b128 v13, v[80:83] offset:24576
    v_perm_b32 v84, v55, v51, s45
    v_perm_b32 v85, v63, v59, s45
    v_perm_b32 v86, v71, v67, s45
    v_perm_b32 v87, v79, v75, s45
    ds_write_b128 v13, v[84:87] offset:25600
    s_cmp_lt_u32 s21, 2
    s_cselect_b32 s26, s49, s49
    s_cselect_b32 s27, 4, 8
    s_cselect_b64 s[88:89], s[76:77], s[76:77]
    s_add_u32 s26, s26, s27
    s_lshl_b32 s27, s26, 18
    s_add_u32 s27, s27, s46
    buffer_load_dwordx4 v[48:51], v12, s[88:91], s27 offen
    s_add_u32 s27, s27, 8192
    buffer_load_dwordx4 v[52:55], v12, s[88:91], s27 offen
    s_add_u32 s27, s27, 8192
    buffer_load_dwordx4 v[56:59], v12, s[88:91], s27 offen
    s_add_u32 s27, s27, 8192
    buffer_load_dwordx4 v[60:63], v12, s[88:91], s27 offen
    s_add_u32 s27, s27, 8192
    buffer_load_dwordx4 v[64:67], v12, s[88:91], s27 offen
    s_add_u32 s27, s27, 8192
    buffer_load_dwordx4 v[68:71], v12, s[88:91], s27 offen
    s_add_u32 s27, s27, 8192
    buffer_load_dwordx4 v[72:75], v12, s[88:91], s27 offen
    s_add_u32 s27, s27, 8192
    buffer_load_dwordx4 v[76:79], v12, s[88:91], s27 offen
    s_waitcnt lgkmcnt(0)
    s_barrier
    ds_read_b128 a[248:251], v4 offset:0
    ds_read_b128 a[240:243], v4 offset:1024
    ds_read_b128 a[252:255], v4 offset:2048
    ds_read_b128 a[244:247], v4 offset:3072
    ds_read_b128 a[216:219], v4 offset:4096
    ds_read_b128 a[208:211], v4 offset:5120
    ds_read_b128 a[220:223], v4 offset:6144
    ds_read_b128 a[212:215], v4 offset:7168
    s_lshl_b32 s27, s21, 11
    s_add_u32 s27, s27, 24576
    v_add_u32 v13, s27, v0
    s_waitcnt vmcnt(14)
    v_perm_b32 v80, v20, v16, s44
    s_waitcnt vmcnt(12)
    v_perm_b32 v81, v28, v24, s44
    s_waitcnt vmcnt(10)
    v_perm_b32 v82, v36, v32, s44
    s_waitcnt vmcnt(8)
    v_perm_b32 v83, v44, v40, s44
    ds_write_b128 v13, v[80:83] offset:0
    v_perm_b32 v84, v20, v16, s45
    v_perm_b32 v85, v28, v24, s45
    v_perm_b32 v86, v36, v32, s45
    v_perm_b32 v87, v44, v40, s45
    ds_write_b128 v13, v[84:87] offset:1024
    v_perm_b32 v80, v21, v17, s44
    v_perm_b32 v81, v29, v25, s44
    v_perm_b32 v82, v37, v33, s44
    v_perm_b32 v83, v45, v41, s44
    ds_write_b128 v13, v[80:83] offset:8192
    v_perm_b32 v84, v21, v17, s45
    v_perm_b32 v85, v29, v25, s45
    v_perm_b32 v86, v37, v33, s45
    v_perm_b32 v87, v45, v41, s45
    ds_write_b128 v13, v[84:87] offset:9216
    v_perm_b32 v80, v22, v18, s44
    v_perm_b32 v81, v30, v26, s44
    v_perm_b32 v82, v38, v34, s44
    v_perm_b32 v83, v46, v42, s44
    ds_write_b128 v13, v[80:83] offset:16384
    v_perm_b32 v84, v22, v18, s45
    v_perm_b32 v85, v30, v26, s45
    v_perm_b32 v86, v38, v34, s45
    v_perm_b32 v87, v46, v42, s45
    ds_write_b128 v13, v[84:87] offset:17408
    v_perm_b32 v80, v23, v19, s44
    v_perm_b32 v81, v31, v27, s44
    v_perm_b32 v82, v39, v35, s44
    v_perm_b32 v83, v47, v43, s44
    ds_write_b128 v13, v[80:83] offset:24576
    v_perm_b32 v84, v23, v19, s45
    v_perm_b32 v85, v31, v27, s45
    v_perm_b32 v86, v39, v35, s45
    v_perm_b32 v87, v47, v43, s45
    ds_write_b128 v13, v[84:87] offset:25600
    s_cmp_lt_u32 s21, 2
    s_cselect_b32 s26, s49, s49
    s_cselect_b32 s27, 0, 2
    s_cselect_b64 s[88:89], s[80:81], s[80:81]
    s_add_u32 s26, s26, s27
    s_lshl_b32 s27, s26, 18
    s_add_u32 s27, s27, s46
    buffer_load_dwordx4 v[16:19], v12, s[88:91], s27 offen
    s_add_u32 s27, s27, 8192
    buffer_load_dwordx4 v[20:23], v12, s[88:91], s27 offen
    s_add_u32 s27, s27, 8192
    buffer_load_dwordx4 v[24:27], v12, s[88:91], s27 offen
    s_add_u32 s27, s27, 8192
    buffer_load_dwordx4 v[28:31], v12, s[88:91], s27 offen
    s_add_u32 s27, s27, 8192
    buffer_load_dwordx4 v[32:35], v12, s[88:91], s27 offen
    s_add_u32 s27, s27, 8192
    buffer_load_dwordx4 v[36:39], v12, s[88:91], s27 offen
    s_add_u32 s27, s27, 8192
    buffer_load_dwordx4 v[40:43], v12, s[88:91], s27 offen
    s_add_u32 s27, s27, 8192
    buffer_load_dwordx4 v[44:47], v12, s[88:91], s27 offen
    s_waitcnt lgkmcnt(0)
    s_barrier
    ds_read_b128 a[168:171], v5 offset:0
    ds_read_b128 a[160:163], v5 offset:1024
    ds_read_b128 a[172:175], v5 offset:2048
    ds_read_b128 a[164:167], v5 offset:3072
    ds_read_b128 a[120:123], v5 offset:4096
    ds_read_b128 a[112:115], v5 offset:5120
    ds_read_b128 a[124:127], v5 offset:6144
    ds_read_b128 a[116:119], v5 offset:7168
    s_lshl_b32 s27, s21, 11
    s_add_u32 s27, s27, 106496
    v_add_u32 v13, s27, v0
    s_waitcnt vmcnt(14)
    v_perm_b32 v80, v52, v48, s44
    s_waitcnt vmcnt(12)
    v_perm_b32 v81, v60, v56, s44
    s_waitcnt vmcnt(10)
    v_perm_b32 v82, v68, v64, s44
    s_waitcnt vmcnt(8)
    v_perm_b32 v83, v76, v72, s44
    ds_write_b128 v13, v[80:83] offset:0
    v_perm_b32 v84, v52, v48, s45
    v_perm_b32 v85, v60, v56, s45
    v_perm_b32 v86, v68, v64, s45
    v_perm_b32 v87, v76, v72, s45
    ds_write_b128 v13, v[84:87] offset:1024
    v_perm_b32 v80, v53, v49, s44
    v_perm_b32 v81, v61, v57, s44
    v_perm_b32 v82, v69, v65, s44
    v_perm_b32 v83, v77, v73, s44
    ds_write_b128 v13, v[80:83] offset:8192
    v_perm_b32 v84, v53, v49, s45
    v_perm_b32 v85, v61, v57, s45
    v_perm_b32 v86, v69, v65, s45
    v_perm_b32 v87, v77, v73, s45
    ds_write_b128 v13, v[84:87] offset:9216
    v_perm_b32 v80, v54, v50, s44
    v_perm_b32 v81, v62, v58, s44
    v_perm_b32 v82, v70, v66, s44
    v_perm_b32 v83, v78, v74, s44
    ds_write_b128 v13, v[80:83] offset:16384
    v_perm_b32 v84, v54, v50, s45
    v_perm_b32 v85, v62, v58, s45
    v_perm_b32 v86, v70, v66, s45
    v_perm_b32 v87, v78, v74, s45
    ds_write_b128 v13, v[84:87] offset:17408
    v_perm_b32 v80, v55, v51, s44
    v_perm_b32 v81, v63, v59, s44
    v_perm_b32 v82, v71, v67, s44
    v_perm_b32 v83, v79, v75, s44
    ds_write_b128 v13, v[80:83] offset:24576
    v_perm_b32 v84, v55, v51, s45
    v_perm_b32 v85, v63, v59, s45
    v_perm_b32 v86, v71, v67, s45
    v_perm_b32 v87, v79, v75, s45
    ds_write_b128 v13, v[84:87] offset:25600
    s_cmp_lt_u32 s21, 2
    s_cselect_b32 s26, s49, s49
    s_cselect_b32 s27, 4, 6
    s_cselect_b64 s[88:89], s[80:81], s[80:81]
    s_add_u32 s26, s26, s27
    s_lshl_b32 s27, s26, 18
    s_add_u32 s27, s27, s46
    buffer_load_dwordx4 v[48:51], v12, s[88:91], s27 offen
    s_add_u32 s27, s27, 8192
    buffer_load_dwordx4 v[52:55], v12, s[88:91], s27 offen
    s_add_u32 s27, s27, 8192
    buffer_load_dwordx4 v[56:59], v12, s[88:91], s27 offen
    s_add_u32 s27, s27, 8192
    buffer_load_dwordx4 v[60:63], v12, s[88:91], s27 offen
    s_add_u32 s27, s27, 8192
    buffer_load_dwordx4 v[64:67], v12, s[88:91], s27 offen
    s_add_u32 s27, s27, 8192
    buffer_load_dwordx4 v[68:71], v12, s[88:91], s27 offen
    s_add_u32 s27, s27, 8192
    buffer_load_dwordx4 v[72:75], v12, s[88:91], s27 offen
    s_add_u32 s27, s27, 8192
    buffer_load_dwordx4 v[76:79], v12, s[88:91], s27 offen
    s_waitcnt lgkmcnt(0)
    s_barrier
    ds_read_b128 a[72:75], v4 offset:0
    ds_read_b128 a[64:67], v4 offset:1024
    ds_read_b128 a[76:79], v4 offset:2048
    ds_read_b128 a[68:71], v4 offset:3072
    ds_read_b128 a[48:51], v4 offset:4096
    ds_read_b128 a[40:43], v4 offset:5120
    ds_read_b128 a[52:55], v4 offset:6144
    ds_read_b128 a[44:47], v4 offset:7168
    s_lshl_b32 s27, s21, 11
    s_add_u32 s27, s27, 24576
    v_add_u32 v13, s27, v0
    s_waitcnt vmcnt(14)
    v_perm_b32 v80, v20, v16, s44
    s_waitcnt vmcnt(12)
    v_perm_b32 v81, v28, v24, s44
    s_waitcnt vmcnt(10)
    v_perm_b32 v82, v36, v32, s44
    s_waitcnt vmcnt(8)
    v_perm_b32 v83, v44, v40, s44
    ds_write_b128 v13, v[80:83] offset:0
    v_perm_b32 v84, v20, v16, s45
    v_perm_b32 v85, v28, v24, s45
    v_perm_b32 v86, v36, v32, s45
    v_perm_b32 v87, v44, v40, s45
    ds_write_b128 v13, v[84:87] offset:1024
    v_perm_b32 v80, v21, v17, s44
    v_perm_b32 v81, v29, v25, s44
    v_perm_b32 v82, v37, v33, s44
    v_perm_b32 v83, v45, v41, s44
    ds_write_b128 v13, v[80:83] offset:8192
    v_perm_b32 v84, v21, v17, s45
    v_perm_b32 v85, v29, v25, s45
    v_perm_b32 v86, v37, v33, s45
    v_perm_b32 v87, v45, v41, s45
    ds_write_b128 v13, v[84:87] offset:9216
    v_perm_b32 v80, v22, v18, s44
    v_perm_b32 v81, v30, v26, s44
    v_perm_b32 v82, v38, v34, s44
    v_perm_b32 v83, v46, v42, s44
    ds_write_b128 v13, v[80:83] offset:16384
    v_perm_b32 v84, v22, v18, s45
    v_perm_b32 v85, v30, v26, s45
    v_perm_b32 v86, v38, v34, s45
    v_perm_b32 v87, v46, v42, s45
    ds_write_b128 v13, v[84:87] offset:17408
    v_perm_b32 v80, v23, v19, s44
    v_perm_b32 v81, v31, v27, s44
    v_perm_b32 v82, v39, v35, s44
    v_perm_b32 v83, v47, v43, s44
    ds_write_b128 v13, v[80:83] offset:24576
    v_perm_b32 v84, v23, v19, s45
    v_perm_b32 v85, v31, v27, s45
    v_perm_b32 v86, v39, v35, s45
    v_perm_b32 v87, v47, v43, s45
    ds_write_b128 v13, v[84:87] offset:25600
    s_cmp_lt_u32 s21, 2
    s_cselect_b32 s26, s49, s48
    s_cselect_b32 s27, 8, 4
    s_cselect_b64 s[88:89], s[80:81], s[80:81]
    s_add_u32 s26, s26, s27
    s_lshl_b32 s27, s26, 18
    s_add_u32 s27, s27, s46
    buffer_load_dwordx4 v[16:19], v12, s[88:91], s27 offen
    s_add_u32 s27, s27, 8192
    buffer_load_dwordx4 v[20:23], v12, s[88:91], s27 offen
    s_add_u32 s27, s27, 8192
    buffer_load_dwordx4 v[24:27], v12, s[88:91], s27 offen
    s_add_u32 s27, s27, 8192
    buffer_load_dwordx4 v[28:31], v12, s[88:91], s27 offen
    s_add_u32 s27, s27, 8192
    buffer_load_dwordx4 v[32:35], v12, s[88:91], s27 offen
    s_add_u32 s27, s27, 8192
    buffer_load_dwordx4 v[36:39], v12, s[88:91], s27 offen
    s_add_u32 s27, s27, 8192
    buffer_load_dwordx4 v[40:43], v12, s[88:91], s27 offen
    s_add_u32 s27, s27, 8192
    buffer_load_dwordx4 v[44:47], v12, s[88:91], s27 offen
    s_waitcnt lgkmcnt(0)
    s_barrier
    ds_read_b128 a[32:35], v5 offset:0
    ds_read_b128 a[24:27], v5 offset:1024
    ds_read_b128 a[36:39], v5 offset:2048
    ds_read_b128 a[28:31], v5 offset:3072
    ds_read_b128 a[16:19], v5 offset:4096
    ds_read_b128 a[8:11], v5 offset:5120
    ds_read_b128 a[20:23], v5 offset:6144
    ds_read_b128 a[12:15], v5 offset:7168
    s_lshl_b32 s27, s21, 11
    s_add_u32 s27, s27, 106496
    v_add_u32 v13, s27, v0
    s_waitcnt vmcnt(14)
    v_perm_b32 v80, v52, v48, s44
    s_waitcnt vmcnt(12)
    v_perm_b32 v81, v60, v56, s44
    s_waitcnt vmcnt(10)
    v_perm_b32 v82, v68, v64, s44
    s_waitcnt vmcnt(8)
    v_perm_b32 v83, v76, v72, s44
    ds_write_b128 v13, v[80:83] offset:0
    v_perm_b32 v84, v52, v48, s45
    v_perm_b32 v85, v60, v56, s45
    v_perm_b32 v86, v68, v64, s45
    v_perm_b32 v87, v76, v72, s45
    ds_write_b128 v13, v[84:87] offset:1024
    v_perm_b32 v80, v53, v49, s44
    v_perm_b32 v81, v61, v57, s44
    v_perm_b32 v82, v69, v65, s44
    v_perm_b32 v83, v77, v73, s44
    ds_write_b128 v13, v[80:83] offset:8192
    v_perm_b32 v84, v53, v49, s45
    v_perm_b32 v85, v61, v57, s45
    v_perm_b32 v86, v69, v65, s45
    v_perm_b32 v87, v77, v73, s45
    ds_write_b128 v13, v[84:87] offset:9216
    v_perm_b32 v80, v54, v50, s44
    v_perm_b32 v81, v62, v58, s44
    v_perm_b32 v82, v70, v66, s44
    v_perm_b32 v83, v78, v74, s44
    ds_write_b128 v13, v[80:83] offset:16384
    v_perm_b32 v84, v54, v50, s45
    v_perm_b32 v85, v62, v58, s45
    v_perm_b32 v86, v70, v66, s45
    v_perm_b32 v87, v78, v74, s45
    ds_write_b128 v13, v[84:87] offset:17408
    v_perm_b32 v80, v55, v51, s44
    v_perm_b32 v81, v63, v59, s44
    v_perm_b32 v82, v71, v67, s44
    v_perm_b32 v83, v79, v75, s44
    ds_write_b128 v13, v[80:83] offset:24576
    v_perm_b32 v84, v55, v51, s45
    v_perm_b32 v85, v63, v59, s45
    v_perm_b32 v86, v71, v67, s45
    v_perm_b32 v87, v79, v75, s45
    ds_write_b128 v13, v[84:87] offset:25600
    s_cmp_lt_u32 s21, 2
    s_cselect_b32 s26, s48, s48
    s_cselect_b32 s27, 6, 8
    s_cselect_b64 s[88:89], s[80:81], s[80:81]
    s_add_u32 s26, s26, s27
    s_lshl_b32 s27, s26, 18
    s_add_u32 s27, s27, s46
    buffer_load_dwordx4 v[48:51], v12, s[88:91], s27 offen
    s_add_u32 s27, s27, 8192
    buffer_load_dwordx4 v[52:55], v12, s[88:91], s27 offen
    s_add_u32 s27, s27, 8192
    buffer_load_dwordx4 v[56:59], v12, s[88:91], s27 offen
    s_add_u32 s27, s27, 8192
    buffer_load_dwordx4 v[60:63], v12, s[88:91], s27 offen
    s_add_u32 s27, s27, 8192
    buffer_load_dwordx4 v[64:67], v12, s[88:91], s27 offen
    s_add_u32 s27, s27, 8192
    buffer_load_dwordx4 v[68:71], v12, s[88:91], s27 offen
    s_add_u32 s27, s27, 8192
    buffer_load_dwordx4 v[72:75], v12, s[88:91], s27 offen
    s_add_u32 s27, s27, 8192
    buffer_load_dwordx4 v[76:79], v12, s[88:91], s27 offen
    s_waitcnt lgkmcnt(0)
    s_barrier
    ds_read_b128 a[0:3], v4 offset:0
    ds_read_b128 v[248:251], v4 offset:1024
    ds_read_b128 a[4:7], v4 offset:2048
    ds_read_b128 v[252:255], v4 offset:3072
    ds_read_b128 v[240:243], v4 offset:4096
    ds_read_b128 v[232:235], v4 offset:5120
    ds_read_b128 v[244:247], v4 offset:6144
    ds_read_b128 v[236:239], v4 offset:7168
    s_lshl_b32 s27, s21, 11
    s_add_u32 s27, s27, 24576
    v_add_u32 v13, s27, v0
    s_waitcnt vmcnt(14)
    v_perm_b32 v80, v20, v16, s44
    s_waitcnt vmcnt(12)
    v_perm_b32 v81, v28, v24, s44
    s_waitcnt vmcnt(10)
    v_perm_b32 v82, v36, v32, s44
    s_waitcnt vmcnt(8)
    v_perm_b32 v83, v44, v40, s44
    ds_write_b128 v13, v[80:83] offset:0
    v_perm_b32 v84, v20, v16, s45
    v_perm_b32 v85, v28, v24, s45
    v_perm_b32 v86, v36, v32, s45
    v_perm_b32 v87, v44, v40, s45
    ds_write_b128 v13, v[84:87] offset:1024
    v_perm_b32 v80, v21, v17, s44
    v_perm_b32 v81, v29, v25, s44
    v_perm_b32 v82, v37, v33, s44
    v_perm_b32 v83, v45, v41, s44
    ds_write_b128 v13, v[80:83] offset:8192
    v_perm_b32 v84, v21, v17, s45
    v_perm_b32 v85, v29, v25, s45
    v_perm_b32 v86, v37, v33, s45
    v_perm_b32 v87, v45, v41, s45
    ds_write_b128 v13, v[84:87] offset:9216
    v_perm_b32 v80, v22, v18, s44
    v_perm_b32 v81, v30, v26, s44
    v_perm_b32 v82, v38, v34, s44
    v_perm_b32 v83, v46, v42, s44
    ds_write_b128 v13, v[80:83] offset:16384
    v_perm_b32 v84, v22, v18, s45
    v_perm_b32 v85, v30, v26, s45
    v_perm_b32 v86, v38, v34, s45
    v_perm_b32 v87, v46, v42, s45
    ds_write_b128 v13, v[84:87] offset:17408
    v_perm_b32 v80, v23, v19, s44
    v_perm_b32 v81, v31, v27, s44
    v_perm_b32 v82, v39, v35, s44
    v_perm_b32 v83, v47, v43, s44
    ds_write_b128 v13, v[80:83] offset:24576
    v_perm_b32 v84, v23, v19, s45
    v_perm_b32 v85, v31, v27, s45
    v_perm_b32 v86, v39, v35, s45
    v_perm_b32 v87, v47, v43, s45
    ds_write_b128 v13, v[84:87] offset:25600
    s_cmp_lt_u32 s21, 2
    s_cselect_b32 s26, s48, s48
    s_cselect_b32 s27, 0, 0
    s_cselect_b64 s[88:89], s[72:73], s[80:81]
    s_add_u32 s26, s26, s27
    s_lshl_b32 s27, s26, 18
    s_add_u32 s27, s27, s46
    buffer_load_dwordx4 v[16:19], v12, s[88:91], s27 offen
    s_add_u32 s27, s27, 8192
    buffer_load_dwordx4 v[20:23], v12, s[88:91], s27 offen
    s_add_u32 s27, s27, 8192
    buffer_load_dwordx4 v[24:27], v12, s[88:91], s27 offen
    s_add_u32 s27, s27, 8192
    buffer_load_dwordx4 v[28:31], v12, s[88:91], s27 offen
    s_add_u32 s27, s27, 8192
    buffer_load_dwordx4 v[32:35], v12, s[88:91], s27 offen
    s_add_u32 s27, s27, 8192
    buffer_load_dwordx4 v[36:39], v12, s[88:91], s27 offen
    s_add_u32 s27, s27, 8192
    buffer_load_dwordx4 v[40:43], v12, s[88:91], s27 offen
    s_add_u32 s27, s27, 8192
    buffer_load_dwordx4 v[44:47], v12, s[88:91], s27 offen
    s_waitcnt lgkmcnt(0)
    s_barrier
    ds_read_b128 v[224:227], v5 offset:0
    ds_read_b128 v[216:219], v5 offset:1024
    ds_read_b128 v[228:231], v5 offset:2048
    ds_read_b128 v[220:223], v5 offset:3072
    ds_read_b128 v[208:211], v5 offset:4096
    ds_read_b128 v[200:203], v5 offset:5120
    ds_read_b128 v[212:215], v5 offset:6144
    ds_read_b128 v[204:207], v5 offset:7168
    s_lshl_b32 s27, s21, 11
    s_add_u32 s27, s27, 106496
    v_add_u32 v13, s27, v0
    s_waitcnt vmcnt(14)
    v_perm_b32 v80, v52, v48, s44
    s_waitcnt vmcnt(12)
    v_perm_b32 v81, v60, v56, s44
    s_waitcnt vmcnt(10)
    v_perm_b32 v82, v68, v64, s44
    s_waitcnt vmcnt(8)
    v_perm_b32 v83, v76, v72, s44
    ds_write_b128 v13, v[80:83] offset:0
    v_perm_b32 v84, v52, v48, s45
    v_perm_b32 v85, v60, v56, s45
    v_perm_b32 v86, v68, v64, s45
    v_perm_b32 v87, v76, v72, s45
    ds_write_b128 v13, v[84:87] offset:1024
    v_perm_b32 v80, v53, v49, s44
    v_perm_b32 v81, v61, v57, s44
    v_perm_b32 v82, v69, v65, s44
    v_perm_b32 v83, v77, v73, s44
    ds_write_b128 v13, v[80:83] offset:8192
    v_perm_b32 v84, v53, v49, s45
    v_perm_b32 v85, v61, v57, s45
    v_perm_b32 v86, v69, v65, s45
    v_perm_b32 v87, v77, v73, s45
    ds_write_b128 v13, v[84:87] offset:9216
    v_perm_b32 v80, v54, v50, s44
    v_perm_b32 v81, v62, v58, s44
    v_perm_b32 v82, v70, v66, s44
    v_perm_b32 v83, v78, v74, s44
    ds_write_b128 v13, v[80:83] offset:16384
    v_perm_b32 v84, v54, v50, s45
    v_perm_b32 v85, v62, v58, s45
    v_perm_b32 v86, v70, v66, s45
    v_perm_b32 v87, v78, v74, s45
    ds_write_b128 v13, v[84:87] offset:17408
    v_perm_b32 v80, v55, v51, s44
    v_perm_b32 v81, v63, v59, s44
    v_perm_b32 v82, v71, v67, s44
    v_perm_b32 v83, v79, v75, s44
    ds_write_b128 v13, v[80:83] offset:24576
    v_perm_b32 v84, v55, v51, s45
    v_perm_b32 v85, v63, v59, s45
    v_perm_b32 v86, v71, v67, s45
    v_perm_b32 v87, v79, v75, s45
    ds_write_b128 v13, v[84:87] offset:25600
    s_cmp_lt_u32 s21, 2
    s_cselect_b32 s26, s48, s48
    s_cselect_b32 s27, 2, 2
    s_cselect_b64 s[88:89], s[72:73], s[80:81]
    s_add_u32 s26, s26, s27
    s_lshl_b32 s27, s26, 18
    s_add_u32 s27, s27, s46
    buffer_load_dwordx4 v[48:51], v12, s[88:91], s27 offen
    s_add_u32 s27, s27, 8192
    buffer_load_dwordx4 v[52:55], v12, s[88:91], s27 offen
    s_add_u32 s27, s27, 8192
    buffer_load_dwordx4 v[56:59], v12, s[88:91], s27 offen
    s_add_u32 s27, s27, 8192
    buffer_load_dwordx4 v[60:63], v12, s[88:91], s27 offen
    s_add_u32 s27, s27, 8192
    buffer_load_dwordx4 v[64:67], v12, s[88:91], s27 offen
    s_add_u32 s27, s27, 8192
    buffer_load_dwordx4 v[68:71], v12, s[88:91], s27 offen
    s_add_u32 s27, s27, 8192
    buffer_load_dwordx4 v[72:75], v12, s[88:91], s27 offen
    s_add_u32 s27, s27, 8192
    buffer_load_dwordx4 v[76:79], v12, s[88:91], s27 offen
    s_waitcnt lgkmcnt(0)
    s_barrier
    ds_read_b128 v[192:195], v4 offset:0
    ds_read_b128 v[184:187], v4 offset:1024
    ds_read_b128 v[196:199], v4 offset:2048
    ds_read_b128 v[188:191], v4 offset:3072
    ds_read_b128 v[176:179], v4 offset:4096
    ds_read_b128 v[168:171], v4 offset:5120
    ds_read_b128 v[180:183], v4 offset:6144
    ds_read_b128 v[172:175], v4 offset:7168
    s_waitcnt lgkmcnt(0)
    s_barrier
    s_and_b32 s28, s21, 1
    s_lshl_b32 s28, s28, 10
    s_mov_b32 s29, 2048
    s_mov_b32 s30, 4096
    s_cmp_lt_u32 s21, 2
    s_cselect_b32 s29, 24576, s29
    s_cselect_b32 s30, 34816, s30
    s_add_u32 s29, s29, s28
    v_add_u32 v13, s29, v0
    s_add_u32 s29, s29, s30
    s_waitcnt vmcnt(14)
    v_perm_b32 v80, v20, v16, s44
    s_waitcnt vmcnt(12)
    v_perm_b32 v81, v28, v24, s44
    s_waitcnt vmcnt(10)
    v_perm_b32 v82, v36, v32, s44
    s_waitcnt vmcnt(8)
    v_perm_b32 v83, v44, v40, s44
    ds_write_b128 v13, v[80:83]
    v_add_u32 v14, s29, v0
    s_add_u32 s29, s29, s30
    v_perm_b32 v84, v21, v17, s44
    v_perm_b32 v85, v29, v25, s44
    v_perm_b32 v86, v37, v33, s44
    v_perm_b32 v87, v45, v41, s44
    ds_write_b128 v14, v[84:87]
    v_add_u32 v13, s29, v0
    s_add_u32 s29, s29, s30
    v_perm_b32 v80, v22, v18, s44
    v_perm_b32 v81, v30, v26, s44
    v_perm_b32 v82, v38, v34, s44
    v_perm_b32 v83, v46, v42, s44
    ds_write_b128 v13, v[80:83]
    v_add_u32 v14, s29, v0
    s_add_u32 s29, s29, s30
    v_perm_b32 v84, v23, v19, s44
    v_perm_b32 v85, v31, v27, s44
    v_perm_b32 v86, v39, v35, s44
    v_perm_b32 v87, v47, v43, s44
    ds_write_b128 v14, v[84:87]
    s_mov_b32 s29, 28672
    s_mov_b32 s30, 34816
    s_cmp_lt_u32 s21, 2
    s_cselect_b32 s29, 26624, s29
    s_cselect_b32 s30, 34816, s30
    s_add_u32 s29, s29, s28
    v_add_u32 v13, s29, v0
    s_add_u32 s29, s29, s30
    v_perm_b32 v80, v20, v16, s45
    v_perm_b32 v81, v28, v24, s45
    v_perm_b32 v82, v36, v32, s45
    v_perm_b32 v83, v44, v40, s45
    ds_write_b128 v13, v[80:83]
    v_add_u32 v14, s29, v0
    s_add_u32 s29, s29, s30
    v_perm_b32 v84, v21, v17, s45
    v_perm_b32 v85, v29, v25, s45
    v_perm_b32 v86, v37, v33, s45
    v_perm_b32 v87, v45, v41, s45
    ds_write_b128 v14, v[84:87]
    v_add_u32 v13, s29, v0
    s_add_u32 s29, s29, s30
    v_perm_b32 v80, v22, v18, s45
    v_perm_b32 v81, v30, v26, s45
    v_perm_b32 v82, v38, v34, s45
    v_perm_b32 v83, v46, v42, s45
    ds_write_b128 v13, v[80:83]
    v_add_u32 v14, s29, v0
    s_add_u32 s29, s29, s30
    v_perm_b32 v84, v23, v19, s45
    v_perm_b32 v85, v31, v27, s45
    v_perm_b32 v86, v39, v35, s45
    v_perm_b32 v87, v47, v43, s45
    ds_write_b128 v14, v[84:87]
    s_cmp_lt_u32 s21, 2
    s_cselect_b32 s26, s48, s48
    s_cselect_b32 s27, 4, 4
    s_cselect_b64 s[88:89], s[72:73], s[76:77]
    s_add_u32 s26, s26, s27
    s_lshl_b32 s27, s26, 18
    s_add_u32 s27, s27, s46
    buffer_load_dwordx4 v[16:19], v12, s[88:91], s27 offen
    s_add_u32 s27, s27, 8192
    buffer_load_dwordx4 v[20:23], v12, s[88:91], s27 offen
    s_add_u32 s27, s27, 8192
    buffer_load_dwordx4 v[24:27], v12, s[88:91], s27 offen
    s_add_u32 s27, s27, 8192
    buffer_load_dwordx4 v[28:31], v12, s[88:91], s27 offen
    s_add_u32 s27, s27, 8192
    buffer_load_dwordx4 v[32:35], v12, s[88:91], s27 offen
    s_add_u32 s27, s27, 8192
    buffer_load_dwordx4 v[36:39], v12, s[88:91], s27 offen
    s_add_u32 s27, s27, 8192
    buffer_load_dwordx4 v[40:43], v12, s[88:91], s27 offen
    s_add_u32 s27, s27, 8192
    buffer_load_dwordx4 v[44:47], v12, s[88:91], s27 offen
    s_waitcnt lgkmcnt(0)
    s_barrier
    ds_read_b128 a[232:235], v6 offset:2048
    ds_read_b128 a[236:239], v6 offset:3072
    s_waitcnt lgkmcnt(0)
    s_barrier
    s_and_b32 s28, s21, 1
    s_lshl_b32 s28, s28, 10
    s_mov_b32 s29, 32768
    s_mov_b32 s30, 34816
    s_cmp_lt_u32 s21, 2
    s_cselect_b32 s29, 0, s29
    s_cselect_b32 s30, 4096, s30
    s_add_u32 s29, s29, s28
    v_add_u32 v13, s29, v0
    s_add_u32 s29, s29, s30
    s_waitcnt vmcnt(14)
    v_perm_b32 v80, v52, v48, s44
    s_waitcnt vmcnt(12)
    v_perm_b32 v81, v60, v56, s44
    s_waitcnt vmcnt(10)
    v_perm_b32 v82, v68, v64, s44
    s_waitcnt vmcnt(8)
    v_perm_b32 v83, v76, v72, s44
    ds_write_b128 v13, v[80:83]
    v_add_u32 v14, s29, v0
    s_add_u32 s29, s29, s30
    v_perm_b32 v84, v53, v49, s44
    v_perm_b32 v85, v61, v57, s44
    v_perm_b32 v86, v69, v65, s44
    v_perm_b32 v87, v77, v73, s44
    ds_write_b128 v14, v[84:87]
    v_add_u32 v13, s29, v0
    s_add_u32 s29, s29, s30
    v_perm_b32 v80, v54, v50, s44
    v_perm_b32 v81, v62, v58, s44
    v_perm_b32 v82, v70, v66, s44
    v_perm_b32 v83, v78, v74, s44
    ds_write_b128 v13, v[80:83]
    v_add_u32 v14, s29, v0
    s_add_u32 s29, s29, s30
    v_perm_b32 v84, v55, v51, s44
    v_perm_b32 v85, v63, v59, s44
    v_perm_b32 v86, v71, v67, s44
    v_perm_b32 v87, v79, v75, s44
    ds_write_b128 v14, v[84:87]
    s_mov_b32 s29, 2048
    s_mov_b32 s30, 4096
    s_cmp_lt_u32 s21, 2
    s_cselect_b32 s29, 30720, s29
    s_cselect_b32 s30, 34816, s30
    s_add_u32 s29, s29, s28
    v_add_u32 v13, s29, v0
    s_add_u32 s29, s29, s30
    v_perm_b32 v80, v52, v48, s45
    v_perm_b32 v81, v60, v56, s45
    v_perm_b32 v82, v68, v64, s45
    v_perm_b32 v83, v76, v72, s45
    ds_write_b128 v13, v[80:83]
    v_add_u32 v14, s29, v0
    s_add_u32 s29, s29, s30
    v_perm_b32 v84, v53, v49, s45
    v_perm_b32 v85, v61, v57, s45
    v_perm_b32 v86, v69, v65, s45
    v_perm_b32 v87, v77, v73, s45
    ds_write_b128 v14, v[84:87]
    v_add_u32 v13, s29, v0
    s_add_u32 s29, s29, s30
    v_perm_b32 v80, v54, v50, s45
    v_perm_b32 v81, v62, v58, s45
    v_perm_b32 v82, v70, v66, s45
    v_perm_b32 v83, v78, v74, s45
    ds_write_b128 v13, v[80:83]
    v_add_u32 v14, s29, v0
    s_add_u32 s29, s29, s30
    v_perm_b32 v84, v55, v51, s45
    v_perm_b32 v85, v63, v59, s45
    v_perm_b32 v86, v71, v67, s45
    v_perm_b32 v87, v79, v75, s45
    ds_write_b128 v14, v[84:87]
    s_cmp_lt_u32 s21, 2
    s_cselect_b32 s26, s48, s48
    s_cselect_b32 s27, 6, 8
    s_cselect_b64 s[88:89], s[72:73], s[72:73]
    s_add_u32 s26, s26, s27
    s_lshl_b32 s27, s26, 18
    s_add_u32 s27, s27, s46
    buffer_load_dwordx4 v[48:51], v12, s[88:91], s27 offen
    s_add_u32 s27, s27, 8192
    buffer_load_dwordx4 v[52:55], v12, s[88:91], s27 offen
    s_add_u32 s27, s27, 8192
    buffer_load_dwordx4 v[56:59], v12, s[88:91], s27 offen
    s_add_u32 s27, s27, 8192
    buffer_load_dwordx4 v[60:63], v12, s[88:91], s27 offen
    s_add_u32 s27, s27, 8192
    buffer_load_dwordx4 v[64:67], v12, s[88:91], s27 offen
    s_add_u32 s27, s27, 8192
    buffer_load_dwordx4 v[68:71], v12, s[88:91], s27 offen
    s_add_u32 s27, s27, 8192
    buffer_load_dwordx4 v[72:75], v12, s[88:91], s27 offen
    s_add_u32 s27, s27, 8192
    buffer_load_dwordx4 v[76:79], v12, s[88:91], s27 offen
    s_waitcnt lgkmcnt(0)
    s_barrier
    ds_read_b128 a[224:227], v6 offset:0
    ds_read_b128 a[228:231], v6 offset:1024
    ds_read_b128 a[200:203], v6 offset:2048
    ds_read_b128 a[204:207], v6 offset:3072
    s_waitcnt lgkmcnt(0)
    s_barrier
    s_and_b32 s28, s21, 1
    s_lshl_b32 s28, s28, 10
    s_mov_b32 s29, 2048
    s_mov_b32 s30, 4096
    s_cmp_lt_u32 s21, 2
    s_cselect_b32 s29, 34816, s29
    s_cselect_b32 s30, 34816, s30
    s_add_u32 s29, s29, s28
    v_add_u32 v13, s29, v0
    s_add_u32 s29, s29, s30
    s_waitcnt vmcnt(14)
    v_perm_b32 v80, v20, v16, s44
    s_waitcnt vmcnt(12)
    v_perm_b32 v81, v28, v24, s44
    s_waitcnt vmcnt(10)
    v_perm_b32 v82, v36, v32, s44
    s_waitcnt vmcnt(8)
    v_perm_b32 v83, v44, v40, s44
    ds_write_b128 v13, v[80:83]
    v_add_u32 v14, s29, v0
    s_add_u32 s29, s29, s30
    v_perm_b32 v84, v21, v17, s44
    v_perm_b32 v85, v29, v25, s44
    v_perm_b32 v86, v37, v33, s44
    v_perm_b32 v87, v45, v41, s44
    ds_write_b128 v14, v[84:87]
    v_add_u32 v13, s29, v0
    s_add_u32 s29, s29, s30
    v_perm_b32 v80, v22, v18, s44
    v_perm_b32 v81, v30, v26, s44
    v_perm_b32 v82, v38, v34, s44
    v_perm_b32 v83, v46, v42, s44
    ds_write_b128 v13, v[80:83]
    v_add_u32 v14, s29, v0
    s_add_u32 s29, s29, s30
    v_perm_b32 v84, v23, v19, s44
    v_perm_b32 v85, v31, v27, s44
    v_perm_b32 v86, v39, v35, s44
    v_perm_b32 v87, v47, v43, s44
    ds_write_b128 v14, v[84:87]
    s_mov_b32 s29, 36864
    s_mov_b32 s30, 34816
    s_cmp_lt_u32 s21, 2
    s_cselect_b32 s29, 0, s29
    s_cselect_b32 s30, 4096, s30
    s_add_u32 s29, s29, s28
    v_add_u32 v13, s29, v0
    s_add_u32 s29, s29, s30
    v_perm_b32 v80, v20, v16, s45
    v_perm_b32 v81, v28, v24, s45
    v_perm_b32 v82, v36, v32, s45
    v_perm_b32 v83, v44, v40, s45
    ds_write_b128 v13, v[80:83]
    v_add_u32 v14, s29, v0
    s_add_u32 s29, s29, s30
    v_perm_b32 v84, v21, v17, s45
    v_perm_b32 v85, v29, v25, s45
    v_perm_b32 v86, v37, v33, s45
    v_perm_b32 v87, v45, v41, s45
    ds_write_b128 v14, v[84:87]
    v_add_u32 v13, s29, v0
    s_add_u32 s29, s29, s30
    v_perm_b32 v80, v22, v18, s45
    v_perm_b32 v81, v30, v26, s45
    v_perm_b32 v82, v38, v34, s45
    v_perm_b32 v83, v46, v42, s45
    ds_write_b128 v13, v[80:83]
    v_add_u32 v14, s29, v0
    s_add_u32 s29, s29, s30
    v_perm_b32 v84, v23, v19, s45
    v_perm_b32 v85, v31, v27, s45
    v_perm_b32 v86, v39, v35, s45
    v_perm_b32 v87, v47, v43, s45
    ds_write_b128 v14, v[84:87]
    s_cmp_lt_u32 s21, 2
    s_cselect_b32 s26, s48, s49
    s_cselect_b32 s27, 8, 0
    s_cselect_b64 s[88:89], s[76:77], s[72:73]
    s_add_u32 s26, s26, s27
    s_lshl_b32 s27, s26, 18
    s_add_u32 s27, s27, s46
    buffer_load_dwordx4 v[16:19], v12, s[88:91], s27 offen
    s_add_u32 s27, s27, 8192
    buffer_load_dwordx4 v[20:23], v12, s[88:91], s27 offen
    s_add_u32 s27, s27, 8192
    buffer_load_dwordx4 v[24:27], v12, s[88:91], s27 offen
    s_add_u32 s27, s27, 8192
    buffer_load_dwordx4 v[28:31], v12, s[88:91], s27 offen
    s_add_u32 s27, s27, 8192
    buffer_load_dwordx4 v[32:35], v12, s[88:91], s27 offen
    s_add_u32 s27, s27, 8192
    buffer_load_dwordx4 v[36:39], v12, s[88:91], s27 offen
    s_add_u32 s27, s27, 8192
    buffer_load_dwordx4 v[40:43], v12, s[88:91], s27 offen
    s_add_u32 s27, s27, 8192
    buffer_load_dwordx4 v[44:47], v12, s[88:91], s27 offen
    s_waitcnt lgkmcnt(0)
    s_barrier
    ds_read_b128 a[192:195], v6 offset:0
    ds_read_b128 a[196:199], v6 offset:1024
    ds_read_b128 a[184:187], v6 offset:2048
    ds_read_b128 a[188:191], v6 offset:3072
    s_waitcnt lgkmcnt(0)
    s_barrier
    s_and_b32 s28, s21, 1
    s_lshl_b32 s28, s28, 10
    s_mov_b32 s29, 40960
    s_mov_b32 s30, 34816
    s_cmp_lt_u32 s21, 2
    s_cselect_b32 s29, 0, s29
    s_cselect_b32 s30, 4096, s30
    s_add_u32 s29, s29, s28
    v_add_u32 v13, s29, v0
    s_add_u32 s29, s29, s30
    s_waitcnt vmcnt(14)
    v_perm_b32 v80, v52, v48, s44
    s_waitcnt vmcnt(12)
    v_perm_b32 v81, v60, v56, s44
    s_waitcnt vmcnt(10)
    v_perm_b32 v82, v68, v64, s44
    s_waitcnt vmcnt(8)
    v_perm_b32 v83, v76, v72, s44
    ds_write_b128 v13, v[80:83]
    v_add_u32 v14, s29, v0
    s_add_u32 s29, s29, s30
    v_perm_b32 v84, v53, v49, s44
    v_perm_b32 v85, v61, v57, s44
    v_perm_b32 v86, v69, v65, s44
    v_perm_b32 v87, v77, v73, s44
    ds_write_b128 v14, v[84:87]
    v_add_u32 v13, s29, v0
    s_add_u32 s29, s29, s30
    v_perm_b32 v80, v54, v50, s44
    v_perm_b32 v81, v62, v58, s44
    v_perm_b32 v82, v70, v66, s44
    v_perm_b32 v83, v78, v74, s44
    ds_write_b128 v13, v[80:83]
    v_add_u32 v14, s29, v0
    s_add_u32 s29, s29, s30
    v_perm_b32 v84, v55, v51, s44
    v_perm_b32 v85, v63, v59, s44
    v_perm_b32 v86, v71, v67, s44
    v_perm_b32 v87, v79, v75, s44
    ds_write_b128 v14, v[84:87]
    s_mov_b32 s29, 2048
    s_mov_b32 s30, 4096
    s_cmp_lt_u32 s21, 2
    s_cselect_b32 s29, 38912, s29
    s_cselect_b32 s30, 34816, s30
    s_add_u32 s29, s29, s28
    v_add_u32 v13, s29, v0
    s_add_u32 s29, s29, s30
    v_perm_b32 v80, v52, v48, s45
    v_perm_b32 v81, v60, v56, s45
    v_perm_b32 v82, v68, v64, s45
    v_perm_b32 v83, v76, v72, s45
    ds_write_b128 v13, v[80:83]
    v_add_u32 v14, s29, v0
    s_add_u32 s29, s29, s30
    v_perm_b32 v84, v53, v49, s45
    v_perm_b32 v85, v61, v57, s45
    v_perm_b32 v86, v69, v65, s45
    v_perm_b32 v87, v77, v73, s45
    ds_write_b128 v14, v[84:87]
    v_add_u32 v13, s29, v0
    s_add_u32 s29, s29, s30
    v_perm_b32 v80, v54, v50, s45
    v_perm_b32 v81, v62, v58, s45
    v_perm_b32 v82, v70, v66, s45
    v_perm_b32 v83, v78, v74, s45
    ds_write_b128 v13, v[80:83]
    v_add_u32 v14, s29, v0
    s_add_u32 s29, s29, s30
    v_perm_b32 v84, v55, v51, s45
    v_perm_b32 v85, v63, v59, s45
    v_perm_b32 v86, v71, v67, s45
    v_perm_b32 v87, v79, v75, s45
    ds_write_b128 v14, v[84:87]
    s_cmp_lt_u32 s21, 2
    s_cselect_b32 s26, s49, s49
    s_cselect_b32 s27, 2, 6
    s_cselect_b64 s[88:89], s[72:73], s[72:73]
    s_add_u32 s26, s26, s27
    s_lshl_b32 s27, s26, 18
    s_add_u32 s27, s27, s46
    buffer_load_dwordx4 v[48:51], v12, s[88:91], s27 offen
    s_add_u32 s27, s27, 8192
    buffer_load_dwordx4 v[52:55], v12, s[88:91], s27 offen
    s_add_u32 s27, s27, 8192
    buffer_load_dwordx4 v[56:59], v12, s[88:91], s27 offen
    s_add_u32 s27, s27, 8192
    buffer_load_dwordx4 v[60:63], v12, s[88:91], s27 offen
    s_add_u32 s27, s27, 8192
    buffer_load_dwordx4 v[64:67], v12, s[88:91], s27 offen
    s_add_u32 s27, s27, 8192
    buffer_load_dwordx4 v[68:71], v12, s[88:91], s27 offen
    s_add_u32 s27, s27, 8192
    buffer_load_dwordx4 v[72:75], v12, s[88:91], s27 offen
    s_add_u32 s27, s27, 8192
    buffer_load_dwordx4 v[76:79], v12, s[88:91], s27 offen
    s_waitcnt lgkmcnt(0)
    s_barrier
    ds_read_b128 a[176:179], v6 offset:0
    ds_read_b128 a[180:183], v6 offset:1024
    ds_read_b128 a[152:155], v6 offset:2048
    ds_read_b128 a[156:159], v6 offset:3072
    s_waitcnt lgkmcnt(0)
    s_barrier
    s_and_b32 s28, s21, 1
    s_lshl_b32 s28, s28, 10
    s_mov_b32 s29, 2048
    s_mov_b32 s30, 4096
    s_cmp_lt_u32 s21, 2
    s_cselect_b32 s29, 43008, s29
    s_cselect_b32 s30, 34816, s30
    s_add_u32 s29, s29, s28
    v_add_u32 v13, s29, v0
    s_add_u32 s29, s29, s30
    s_waitcnt vmcnt(14)
    v_perm_b32 v80, v20, v16, s44
    s_waitcnt vmcnt(12)
    v_perm_b32 v81, v28, v24, s44
    s_waitcnt vmcnt(10)
    v_perm_b32 v82, v36, v32, s44
    s_waitcnt vmcnt(8)
    v_perm_b32 v83, v44, v40, s44
    ds_write_b128 v13, v[80:83]
    v_add_u32 v14, s29, v0
    s_add_u32 s29, s29, s30
    v_perm_b32 v84, v21, v17, s44
    v_perm_b32 v85, v29, v25, s44
    v_perm_b32 v86, v37, v33, s44
    v_perm_b32 v87, v45, v41, s44
    ds_write_b128 v14, v[84:87]
    v_add_u32 v13, s29, v0
    s_add_u32 s29, s29, s30
    v_perm_b32 v80, v22, v18, s44
    v_perm_b32 v81, v30, v26, s44
    v_perm_b32 v82, v38, v34, s44
    v_perm_b32 v83, v46, v42, s44
    ds_write_b128 v13, v[80:83]
    v_add_u32 v14, s29, v0
    s_add_u32 s29, s29, s30
    v_perm_b32 v84, v23, v19, s44
    v_perm_b32 v85, v31, v27, s44
    v_perm_b32 v86, v39, v35, s44
    v_perm_b32 v87, v47, v43, s44
    ds_write_b128 v14, v[84:87]
    s_mov_b32 s29, 45056
    s_mov_b32 s30, 34816
    s_cmp_lt_u32 s21, 2
    s_cselect_b32 s29, 0, s29
    s_cselect_b32 s30, 4096, s30
    s_add_u32 s29, s29, s28
    v_add_u32 v13, s29, v0
    s_add_u32 s29, s29, s30
    v_perm_b32 v80, v20, v16, s45
    v_perm_b32 v81, v28, v24, s45
    v_perm_b32 v82, v36, v32, s45
    v_perm_b32 v83, v44, v40, s45
    ds_write_b128 v13, v[80:83]
    v_add_u32 v14, s29, v0
    s_add_u32 s29, s29, s30
    v_perm_b32 v84, v21, v17, s45
    v_perm_b32 v85, v29, v25, s45
    v_perm_b32 v86, v37, v33, s45
    v_perm_b32 v87, v45, v41, s45
    ds_write_b128 v14, v[84:87]
    v_add_u32 v13, s29, v0
    s_add_u32 s29, s29, s30
    v_perm_b32 v80, v22, v18, s45
    v_perm_b32 v81, v30, v26, s45
    v_perm_b32 v82, v38, v34, s45
    v_perm_b32 v83, v46, v42, s45
    ds_write_b128 v13, v[80:83]
    v_add_u32 v14, s29, v0
    s_add_u32 s29, s29, s30
    v_perm_b32 v84, v23, v19, s45
    v_perm_b32 v85, v31, v27, s45
    v_perm_b32 v86, v39, v35, s45
    v_perm_b32 v87, v47, v43, s45
    ds_write_b128 v14, v[84:87]
    s_cmp_lt_u32 s21, 2
    s_cselect_b32 s26, s49, s49
    s_cselect_b32 s27, 8, 0
    s_cselect_b64 s[88:89], s[72:73], s[76:77]
    s_add_u32 s26, s26, s27
    s_lshl_b32 s27, s26, 18
    s_add_u32 s27, s27, s46
    buffer_load_dwordx4 v[16:19], v12, s[88:91], s27 offen
    s_add_u32 s27, s27, 8192
    buffer_load_dwordx4 v[20:23], v12, s[88:91], s27 offen
    s_add_u32 s27, s27, 8192
    buffer_load_dwordx4 v[24:27], v12, s[88:91], s27 offen
    s_add_u32 s27, s27, 8192
    buffer_load_dwordx4 v[28:31], v12, s[88:91], s27 offen
    s_add_u32 s27, s27, 8192
    buffer_load_dwordx4 v[32:35], v12, s[88:91], s27 offen
    s_add_u32 s27, s27, 8192
    buffer_load_dwordx4 v[36:39], v12, s[88:91], s27 offen
    s_add_u32 s27, s27, 8192
    buffer_load_dwordx4 v[40:43], v12, s[88:91], s27 offen
    s_add_u32 s27, s27, 8192
    buffer_load_dwordx4 v[44:47], v12, s[88:91], s27 offen
    s_waitcnt lgkmcnt(0)
    s_barrier
    ds_read_b128 a[144:147], v6 offset:0
    ds_read_b128 a[148:151], v6 offset:1024
    ds_read_b128 a[136:139], v6 offset:2048
    ds_read_b128 a[140:143], v6 offset:3072
    s_waitcnt lgkmcnt(0)
    s_barrier
    s_and_b32 s28, s21, 1
    s_lshl_b32 s28, s28, 10
    s_mov_b32 s29, 49152
    s_mov_b32 s30, 34816
    s_cmp_lt_u32 s21, 2
    s_cselect_b32 s29, 0, s29
    s_cselect_b32 s30, 4096, s30
    s_add_u32 s29, s29, s28
    v_add_u32 v13, s29, v0
    s_add_u32 s29, s29, s30
    s_waitcnt vmcnt(14)
    v_perm_b32 v80, v52, v48, s44
    s_waitcnt vmcnt(12)
    v_perm_b32 v81, v60, v56, s44
    s_waitcnt vmcnt(10)
    v_perm_b32 v82, v68, v64, s44
    s_waitcnt vmcnt(8)
    v_perm_b32 v83, v76, v72, s44
    ds_write_b128 v13, v[80:83]
    v_add_u32 v14, s29, v0
    s_add_u32 s29, s29, s30
    v_perm_b32 v84, v53, v49, s44
    v_perm_b32 v85, v61, v57, s44
    v_perm_b32 v86, v69, v65, s44
    v_perm_b32 v87, v77, v73, s44
    ds_write_b128 v14, v[84:87]
    v_add_u32 v13, s29, v0
    s_add_u32 s29, s29, s30
    v_perm_b32 v80, v54, v50, s44
    v_perm_b32 v81, v62, v58, s44
    v_perm_b32 v82, v70, v66, s44
    v_perm_b32 v83, v78, v74, s44
    ds_write_b128 v13, v[80:83]
    v_add_u32 v14, s29, v0
    s_add_u32 s29, s29, s30
    v_perm_b32 v84, v55, v51, s44
    v_perm_b32 v85, v63, v59, s44
    v_perm_b32 v86, v71, v67, s44
    v_perm_b32 v87, v79, v75, s44
    ds_write_b128 v14, v[84:87]
    s_mov_b32 s29, 2048
    s_mov_b32 s30, 4096
    s_cmp_lt_u32 s21, 2
    s_cselect_b32 s29, 47104, s29
    s_cselect_b32 s30, 34816, s30
    s_add_u32 s29, s29, s28
    v_add_u32 v13, s29, v0
    s_add_u32 s29, s29, s30
    v_perm_b32 v80, v52, v48, s45
    v_perm_b32 v81, v60, v56, s45
    v_perm_b32 v82, v68, v64, s45
    v_perm_b32 v83, v76, v72, s45
    ds_write_b128 v13, v[80:83]
    v_add_u32 v14, s29, v0
    s_add_u32 s29, s29, s30
    v_perm_b32 v84, v53, v49, s45
    v_perm_b32 v85, v61, v57, s45
    v_perm_b32 v86, v69, v65, s45
    v_perm_b32 v87, v77, v73, s45
    ds_write_b128 v14, v[84:87]
    v_add_u32 v13, s29, v0
    s_add_u32 s29, s29, s30
    v_perm_b32 v80, v54, v50, s45
    v_perm_b32 v81, v62, v58, s45
    v_perm_b32 v82, v70, v66, s45
    v_perm_b32 v83, v78, v74, s45
    ds_write_b128 v13, v[80:83]
    v_add_u32 v14, s29, v0
    s_add_u32 s29, s29, s30
    v_perm_b32 v84, v55, v51, s45
    v_perm_b32 v85, v63, v59, s45
    v_perm_b32 v86, v71, v67, s45
    v_perm_b32 v87, v79, v75, s45
    ds_write_b128 v14, v[84:87]
    s_cmp_lt_u32 s21, 2
    s_cselect_b32 s26, s49, s49
    s_cselect_b32 s27, 2, 6
    s_cselect_b64 s[88:89], s[76:77], s[76:77]
    s_add_u32 s26, s26, s27
    s_lshl_b32 s27, s26, 18
    s_add_u32 s27, s27, s46
    buffer_load_dwordx4 v[48:51], v12, s[88:91], s27 offen
    s_add_u32 s27, s27, 8192
    buffer_load_dwordx4 v[52:55], v12, s[88:91], s27 offen
    s_add_u32 s27, s27, 8192
    buffer_load_dwordx4 v[56:59], v12, s[88:91], s27 offen
    s_add_u32 s27, s27, 8192
    buffer_load_dwordx4 v[60:63], v12, s[88:91], s27 offen
    s_add_u32 s27, s27, 8192
    buffer_load_dwordx4 v[64:67], v12, s[88:91], s27 offen
    s_add_u32 s27, s27, 8192
    buffer_load_dwordx4 v[68:71], v12, s[88:91], s27 offen
    s_add_u32 s27, s27, 8192
    buffer_load_dwordx4 v[72:75], v12, s[88:91], s27 offen
    s_add_u32 s27, s27, 8192
    buffer_load_dwordx4 v[76:79], v12, s[88:91], s27 offen
    s_waitcnt lgkmcnt(0)
    s_barrier
    ds_read_b128 a[128:131], v6 offset:0
    ds_read_b128 a[132:135], v6 offset:1024
    ds_read_b128 a[104:107], v6 offset:2048
    ds_read_b128 a[108:111], v6 offset:3072
    s_waitcnt lgkmcnt(0)
    s_barrier
    s_and_b32 s28, s21, 1
    s_lshl_b32 s28, s28, 10
    s_mov_b32 s29, 2048
    s_mov_b32 s30, 4096
    s_cmp_lt_u32 s21, 2
    s_cselect_b32 s29, 51200, s29
    s_cselect_b32 s30, 34816, s30
    s_add_u32 s29, s29, s28
    v_add_u32 v13, s29, v0
    s_add_u32 s29, s29, s30
    s_waitcnt vmcnt(14)
    v_perm_b32 v80, v20, v16, s44
    s_waitcnt vmcnt(12)
    v_perm_b32 v81, v28, v24, s44
    s_waitcnt vmcnt(10)
    v_perm_b32 v82, v36, v32, s44
    s_waitcnt vmcnt(8)
    v_perm_b32 v83, v44, v40, s44
    ds_write_b128 v13, v[80:83]
    v_add_u32 v14, s29, v0
    s_add_u32 s29, s29, s30
    v_perm_b32 v84, v21, v17, s44
    v_perm_b32 v85, v29, v25, s44
    v_perm_b32 v86, v37, v33, s44
    v_perm_b32 v87, v45, v41, s44
    ds_write_b128 v14, v[84:87]
    v_add_u32 v13, s29, v0
    s_add_u32 s29, s29, s30
    v_perm_b32 v80, v22, v18, s44
    v_perm_b32 v81, v30, v26, s44
    v_perm_b32 v82, v38, v34, s44
    v_perm_b32 v83, v46, v42, s44
    ds_write_b128 v13, v[80:83]
    v_add_u32 v14, s29, v0
    s_add_u32 s29, s29, s30
    v_perm_b32 v84, v23, v19, s44
    v_perm_b32 v85, v31, v27, s44
    v_perm_b32 v86, v39, v35, s44
    v_perm_b32 v87, v47, v43, s44
    ds_write_b128 v14, v[84:87]
    s_mov_b32 s29, 53248
    s_mov_b32 s30, 34816
    s_cmp_lt_u32 s21, 2
    s_cselect_b32 s29, 0, s29
    s_cselect_b32 s30, 4096, s30
    s_add_u32 s29, s29, s28
    v_add_u32 v13, s29, v0
    s_add_u32 s29, s29, s30
    v_perm_b32 v80, v20, v16, s45
    v_perm_b32 v81, v28, v24, s45
    v_perm_b32 v82, v36, v32, s45
    v_perm_b32 v83, v44, v40, s45
    ds_write_b128 v13, v[80:83]
    v_add_u32 v14, s29, v0
    s_add_u32 s29, s29, s30
    v_perm_b32 v84, v21, v17, s45
    v_perm_b32 v85, v29, v25, s45
    v_perm_b32 v86, v37, v33, s45
    v_perm_b32 v87, v45, v41, s45
    ds_write_b128 v14, v[84:87]
    v_add_u32 v13, s29, v0
    s_add_u32 s29, s29, s30
    v_perm_b32 v80, v22, v18, s45
    v_perm_b32 v81, v30, v26, s45
    v_perm_b32 v82, v38, v34, s45
    v_perm_b32 v83, v46, v42, s45
    ds_write_b128 v13, v[80:83]
    v_add_u32 v14, s29, v0
    s_add_u32 s29, s29, s30
    v_perm_b32 v84, v23, v19, s45
    v_perm_b32 v85, v31, v27, s45
    v_perm_b32 v86, v39, v35, s45
    v_perm_b32 v87, v47, v43, s45
    ds_write_b128 v14, v[84:87]
    s_waitcnt lgkmcnt(0)
    s_barrier
    ds_read_b128 a[96:99], v6 offset:0
    ds_read_b128 a[100:103], v6 offset:1024
    ds_read_b128 a[88:91], v6 offset:2048
    ds_read_b128 a[92:95], v6 offset:3072
    s_waitcnt lgkmcnt(0)
    s_barrier
    s_and_b32 s28, s21, 1
    s_lshl_b32 s28, s28, 10
    s_mov_b32 s29, 57344
    s_mov_b32 s30, 34816
    s_cmp_lt_u32 s21, 2
    s_cselect_b32 s29, 0, s29
    s_cselect_b32 s30, 4096, s30
    s_add_u32 s29, s29, s28
    v_add_u32 v13, s29, v0
    s_add_u32 s29, s29, s30
    s_waitcnt vmcnt(6)
    v_perm_b32 v80, v52, v48, s44
    s_waitcnt vmcnt(4)
    v_perm_b32 v81, v60, v56, s44
    s_waitcnt vmcnt(2)
    v_perm_b32 v82, v68, v64, s44
    s_waitcnt vmcnt(0)
    v_perm_b32 v83, v76, v72, s44
    ds_write_b128 v13, v[80:83]
    v_add_u32 v14, s29, v0
    s_add_u32 s29, s29, s30
    v_perm_b32 v84, v53, v49, s44
    v_perm_b32 v85, v61, v57, s44
    v_perm_b32 v86, v69, v65, s44
    v_perm_b32 v87, v77, v73, s44
    ds_write_b128 v14, v[84:87]
    v_add_u32 v13, s29, v0
    s_add_u32 s29, s29, s30
    v_perm_b32 v80, v54, v50, s44
    v_perm_b32 v81, v62, v58, s44
    v_perm_b32 v82, v70, v66, s44
    v_perm_b32 v83, v78, v74, s44
    ds_write_b128 v13, v[80:83]
    v_add_u32 v14, s29, v0
    s_add_u32 s29, s29, s30
    v_perm_b32 v84, v55, v51, s44
    v_perm_b32 v85, v63, v59, s44
    v_perm_b32 v86, v71, v67, s44
    v_perm_b32 v87, v79, v75, s44
    ds_write_b128 v14, v[84:87]
    s_mov_b32 s29, 2048
    s_mov_b32 s30, 4096
    s_cmp_lt_u32 s21, 2
    s_cselect_b32 s29, 55296, s29
    s_cselect_b32 s30, 34816, s30
    s_add_u32 s29, s29, s28
    v_add_u32 v13, s29, v0
    s_add_u32 s29, s29, s30
    v_perm_b32 v80, v52, v48, s45
    v_perm_b32 v81, v60, v56, s45
    v_perm_b32 v82, v68, v64, s45
    v_perm_b32 v83, v76, v72, s45
    ds_write_b128 v13, v[80:83]
    v_add_u32 v14, s29, v0
    s_add_u32 s29, s29, s30
    v_perm_b32 v84, v53, v49, s45
    v_perm_b32 v85, v61, v57, s45
    v_perm_b32 v86, v69, v65, s45
    v_perm_b32 v87, v77, v73, s45
    ds_write_b128 v14, v[84:87]
    v_add_u32 v13, s29, v0
    s_add_u32 s29, s29, s30
    v_perm_b32 v80, v54, v50, s45
    v_perm_b32 v81, v62, v58, s45
    v_perm_b32 v82, v70, v66, s45
    v_perm_b32 v83, v78, v74, s45
    ds_write_b128 v13, v[80:83]
    v_add_u32 v14, s29, v0
    s_add_u32 s29, s29, s30
    v_perm_b32 v84, v55, v51, s45
    v_perm_b32 v85, v63, v59, s45
    v_perm_b32 v86, v71, v67, s45
    v_perm_b32 v87, v79, v75, s45
    ds_write_b128 v14, v[84:87]
    s_waitcnt lgkmcnt(0)
    s_barrier
    ds_read_b128 a[80:83], v6 offset:0
    ds_read_b128 a[84:87], v6 offset:1024
    ds_read_b128 a[56:59], v6 offset:2048
    ds_read_b128 a[60:63], v6 offset:3072
    s_waitcnt lgkmcnt(0)
M_lw_done:
    s_cmp_lg_u32 s32, 0
    s_cbranch_scc1 M_role_ok
    s_mov_b32 s32, 1
    s_mov_b32 s30, 0
    v_bfe_u32 v12, v0, 4, 4
    v_lshlrev_b32 v12, 2, v12
M_modepoll:
    buffer_load_dword v13, v12, s[12:15], 0 offen sc1
    s_waitcnt vmcnt(0)
    v_readlane_b32 s31, v13, 8
    s_cmp_eq_u32 s31, 256
    s_cbranch_scc1 M_modegot
    s_sleep 2
    s_add_u32 s30, s30, 1
    s_cmp_lt_u32 s30, 60000
    s_cbranch_scc1 M_modepoll
    s_branch M_fail
M_modegot:
    s_cmp_eq_u32 s30, 0
    s_cbranch_scc1 M_moderd
    buffer_load_dword v13, v12, s[12:15], 0 offen sc1
    s_waitcnt vmcnt(0)
M_moderd:
    v_readlane_b32 s33, v13, 15
    s_nop 0
    s_and_b32 s33, s33, 3
    s_lshl_b32 s33, s33, 13
    s_xor_b32 s33, s33, 16384
    v_cmp_ne_u32 vcc, 32, v13
    s_and_b32 s31, vcc_lo, 0xff
    s_cmp_lg_u32 s31, 0
    s_cbranch_scc1 M_slowm
    s_cmp_ge_u32 s20, 3
    s_cbranch_scc1 M_loadw
    s_branch M_role_ok
M_slowm:
    s_mov_b32 s23, 1
    s_mov_b32 s31, s25
    v_readlane_b32 s30, v13, 0
    s_cmp_gt_u32 s24, 0
    s_cselect_b32 s30, s30, 0
    s_add_u32 s31, s31, s30
    v_readlane_b32 s30, v13, 1
    s_cmp_gt_u32 s24, 1
    s_cselect_b32 s30, s30, 0
    s_add_u32 s31, s31, s30
    v_readlane_b32 s30, v13, 2
    s_cmp_gt_u32 s24, 2
    s_cselect_b32 s30, s30, 0
    s_add_u32 s31, s31, s30
    v_readlane_b32 s30, v13, 3
    s_cmp_gt_u32 s24, 3
    s_cselect_b32 s30, s30, 0
    s_add_u32 s31, s31, s30
    v_readlane_b32 s30, v13, 4
    s_cmp_gt_u32 s24, 4
    s_cselect_b32 s30, s30, 0
    s_add_u32 s31, s31, s30
    v_readlane_b32 s30, v13, 5
    s_cmp_gt_u32 s24, 5
    s_cselect_b32 s30, s30, 0
    s_add_u32 s31, s31, s30
    v_readlane_b32 s30, v13, 6
    s_cmp_gt_u32 s24, 6
    s_cselect_b32 s30, s30, 0
    s_add_u32 s31, s31, s30
    s_lshr_b32 s20, s31, 5
    s_and_b32 s22, s31, 31
    s_and_b32 s20, s20, 7
    s_and_b32 s22, s22, 31
    s_branch M_loadw
M_role_ok:
    s_mov_b32 s25, s33
    s_cmp_ge_u32 s20, 2
    s_cbranch_scc1 M_bulk
    v_lshrrev_b32 v36, 8, v0
    v_bfe_u32 v37, v0, 4, 4
    v_bfe_u32 v38, v0, 4, 3
    v_bfe_u32 v39, v0, 7, 1
    s_mov_b32 s36, 0x00ff00ff
    s_mov_b32 s37, 0x00ff00ff
    s_not_b64 s[18:19], s[36:37]
    v_mov_b32 v1, 0x4444
    v_mov_b32 v40, 0xeeee
    v_cndmask_b32_e64 v1, v1, v40, s[18:19]
    v_and_b32 v40, 1, v36
    v_lshlrev_b32 v40, 2, v40
    v_lshrrev_b32 v41, 1, v36
    v_add_u32 v40, v40, v41
    v_mul_u32_u24 v40, 288, v40
    v_lshl_add_u32 v40, v37, 2, v40
    s_lshl_b32 s27, s21, 6
    v_add_u32 v2, s27, v40
    v_mul_u32_u24 v40, 288, v38
    v_lshl_add_u32 v3, v36, 4, v40
    s_lshr_b32 s27, s21, 1
    s_lshl_b32 s27, s27, 10
    s_and_b32 s28, s21, 1
    s_lshl_b32 s28, s28, 3
    s_add_u32 s27, s27, s28
    s_add_u32 s27, s27, 13312
    v_and_b32 v40, 0x37f, v0
    v_add_u32 v4, s27, v40
    s_mul_i32 s27, s21, 34816
    s_add_u32 s27, s27, 24576
    v_add_u32 v5, s27, v0
    v_and_b32 v6, 0x200, v0
    v_bfe_u32 v40, v0, 6, 1
    v_lshl_or_b32 v6, v40, 8, v6
    v_bfe_u32 v40, v0, 4, 1
    v_lshl_or_b32 v6, v40, 7, v6
    v_bfe_u32 v40, v0, 5, 1
    v_lshl_or_b32 v6, v40, 6, v6
    v_bfe_u32 v40, v0, 8, 1
    v_lshl_or_b32 v6, v40, 5, v6
    v_bfe_u32 v40, v0, 7, 1
    v_lshl_or_b32 v6, v40, 4, v6
    s_lshl_b32 s27, s21, 13
    s_lshl_b32 s28, s22, 5
    s_add_u32 s27, s27, s28
    s_add_u32 s27, s27, 135168
    v_lshrrev_b32 v40, 7, v0
    v_lshlrev_b32 v40, 10, v40
    v_lshl_add_u32 v40, v38, 2, v40
    v_add_u32 v7, s27, v40
    v_lshrrev_b32 v40, 7, v0
    v_mul_u32_u24 v40, 4224, v40
    v_lshl_add_u32 v8, v38, 4, v40
    v_lshlrev_b32 v9, 3, v0
    s_mul_i32 s34, s20, 671744
    s_add_u32 s34, s34, 172228608
    s_lshl_b32 s35, s21, 10
    s_mul_i32 s27, s22, 4224
    s_add_u32 s35, s35, s27
    s_and_b32 s27, s22, 1
    s_bfe_u32 s28, s22, 0x10001
    s_bfe_u32 s29, s22, 0x10002
    s_lshl_b32 s30, s27, 2
    s_lshl_b32 s31, s28, 1
    s_or_b32 s30, s30, s31
    s_or_b32 s30, s30, s29
    s_and_b32 s31, s22, 0x18
    s_or_b32 s30, s30, s31
    s_lshl_b32 s33, s30, 7
    s_lshl_b32 s32, s22, 7
    s_cmp_eq_u32 s21, 0
    s_cbranch_scc1 M_c_r0
    s_lshl_b32 s32, s22, 10
    s_add_u32 s32, s32, 135168
    s_lshl_b32 s33, s27, 4
    s_lshl_b32 s28, s28, 8
    s_or_b32 s33, s33, s28
    s_lshl_b32 s29, s29, 7
    s_or_b32 s33, s33, s29
    s_bfe_u32 s28, s22, 0x10003
    s_lshl_b32 s28, s28, 5
    s_or_b32 s33, s33, s28
    s_bfe_u32 s28, s22, 0x10004
    s_lshl_b32 s28, s28, 9
    s_or_b32 s33, s33, s28
    s_add_u32 s33, s33, 4096
M_c_r0:
    s_mul_i32 s41, s20, 20480
    s_add_u32 s41, s41, 173605504
    s_lshl_b32 s46, s20, 17
    s_add_u32 s46, s46, 171966464
    s_add_u32 s46, s46, s25
    s_xor_b32 s47, s46, 0x20000
    s_mov_b32 s38, 0x00ff00ff
    s_mov_b32 s39, 0
    s_mov_b32 s62, 0x00030003
    s_mov_b32 s63, 0x00030003
    s_mov_b32 s40, 0x3e0293ee
    s_movk_i32 s45, 0x3f80
    s_mov_b32 s68, 0x33800000
    s_mov_b32 s69, 0x18000000
    s_lshl_b32 s51, s22, 7
    s_add_u32 s52, s51, 167862272
    s_lshl_b32 s51, s22, 8
    s_add_u32 s51, s51, 167854080
    s_mov_b32 s24, 0x3f803f80
    s_mov_b32 s25, 0x3f803f80
    s_mov_b32 s16, 0x3f003f00
    s_mov_b32 s17, 0x3f003f00
    s_lshl_b32 s53, s22, 13
    s_add_u32 s53, s53, 218103808
    s_lshl_b32 s27, s20, 12
    s_add_u32 s53, s53, s27
    s_lshl_b32 s27, s20, 2
    s_add_u32 s52, s52, s27
    s_cmp_eq_u32 s20, 0
    s_cselect_b64 s[66:67], -1, 0
    s_mov_b32 s44, 0
    s_mov_b32 s54, 0
    s_mov_b32 s71, 0
    s_mov_b32 s4, 0x10000000
    s_mov_b32 s60, 0x10000000
    s_mov_b32 s64, 0x10000000
    s_mov_b32 s65, 0x10000000
    v_mov_b32 v40, 23296
    v_mov_b64 v[10:11], 0
    ds_write_b64 v40, v[10:11]
    s_waitcnt vmcnt(0) lgkmcnt(0)
    s_barrier
    s_cmp_lg_u32 s23, 0
    s_cbranch_scc1 M_c_slow
    s_cmp_eq_u32 s21, 1
    s_cbranch_scc1 M_c0_1_layer
    s_cmp_eq_u32 s21, 2
    s_cbranch_scc1 M_c0_2_layer
    s_cmp_eq_u32 s21, 3
    s_cbranch_scc1 M_c0_3_layer
M_c0_0_layer:
    s_lshr_b32 s27, s44, 6
    s_mul_i32 s50, s27, 33554432
    s_lshl_b32 s27, s22, 13
    s_add_u32 s50, s50, s27
    s_add_u32 s50, s50, 37748736
    s_barrier
    s_mov_b32 s26, 0x10010000
    s_mov_b32 s3, s26
    s_mul_i32 s27, s20, 5120
    s_add_u32 s48, s27, 167772160
    s_sub_u32 s49, 167777280, s27
    s_and_b32 s55, s44, 3
    s_mul_i32 s55, s55, 167936
    s_add_u32 s55, s55, s34
    s_add_u32 s58, s55, s35
    s_and_b32 s57, s44, 63
    s_add_u32 s43, s55, s32
    s_add_u32 s61, s43, 33792
    s_add_u32 s100, s43, 67584
    s_add_u32 s101, s43, 101376
    s_add_u32 s42, s44, 2
    s_or_b32 s28, s44, 63
    s_add_u32 s28, s28, 1
    s_min_u32 s42, s42, s28
    ds_read_b128 v[56:59], v5 offset:0
    ds_read_b128 v[60:63], v5 offset:1024
    ds_read_b128 v[64:67], v5 offset:2048
    ds_read_b128 v[68:71], v5 offset:3072
    v_mov_b64 v[12:13], 0
    v_mov_b64 v[14:15], 0
    v_mov_b64 v[16:17], 0
    v_mov_b64 v[18:19], 0
    v_mov_b64 v[20:21], 0
    v_mov_b64 v[22:23], 0
    v_mov_b64 v[24:25], 0
    v_mov_b64 v[26:27], 0
    v_mov_b64 v[28:29], 0
    v_mov_b64 v[30:31], 0
    v_mov_b64 v[32:33], 0
    v_mov_b64 v[34:35], 0
    s_mov_b32 s70, 0
    s_waitcnt lgkmcnt(0)
M_c0_0_top:
    s_nop 0
    s_barrier
    ds_read_b128 v[36:39], v6 offset:13312
    ds_read_b128 v[40:43], v6 offset:14336
    s_mov_b32 m0, 8192
    s_nop 0
    buffer_load_dwordx4 v0, s[8:11], s49 offen offset:0 sc1 lds
    buffer_load_dwordx4 v0, s[8:11], s49 offen offset:1024 sc1 lds
M_c0_0_lr_r:
    s_waitcnt lgkmcnt(1)
    v_smfmac_f32_16x16x64_bf16 v[20:23], v[36:39], v[56:63], v1
    ds_read_b128 v[56:59], v5 offset:4096
    v_smfmac_f32_16x16x64_bf16 v[24:27], v[36:39], v[64:71], v1
    ds_read_b128 v[60:63], v5 offset:5120
    v_smfmac_f32_16x16x64_bf16 v[28:31], v[36:39], a[248:255], v1
    ds_read_b128 v[64:67], v5 offset:6144
    v_smfmac_f32_16x16x64_bf16 v[32:35], v[36:39], a[240:247], v1
    ds_read_b128 v[68:71], v5 offset:7168
    v_smfmac_f32_16x16x64_bf16 v[12:15], v[36:39], a[232:239], v1
    ds_read_b128 v[44:47], v6 offset:15360
    s_waitcnt lgkmcnt(3)
    v_smfmac_f32_16x16x64_bf16 v[16:19], v[36:39], v[56:63], v1
    ds_read_b128 v[56:59], v5 offset:8192
    v_smfmac_f32_16x16x64_bf16 v[20:23], v[40:43], a[224:231], v1
    ds_read_b128 v[60:63], v5 offset:9216
    s_waitcnt lgkmcnt(3)
    v_smfmac_f32_16x16x64_bf16 v[24:27], v[40:43], v[64:71], v1
    ds_read_b128 v[64:67], v5 offset:10240
    v_smfmac_f32_16x16x64_bf16 v[28:31], v[40:43], a[216:223], v1
    ds_read_b128 v[68:71], v5 offset:11264
    v_smfmac_f32_16x16x64_bf16 v[32:35], v[40:43], a[208:215], v1
    ds_read_b128 v[48:51], v6 offset:16384
    s_waitcnt lgkmcnt(3)
    v_smfmac_f32_16x16x64_bf16 v[12:15], v[40:43], v[56:63], v1
    ds_read_b128 v[56:59], v5 offset:12288
    v_smfmac_f32_16x16x64_bf16 v[16:19], v[40:43], a[200:207], v1
    ds_read_b128 v[60:63], v5 offset:13312
    s_waitcnt lgkmcnt(3)
    v_smfmac_f32_16x16x64_bf16 v[20:23], v[44:47], v[64:71], v1
    ds_read_b128 v[64:67], v5 offset:14336
    v_smfmac_f32_16x16x64_bf16 v[24:27], v[44:47], a[192:199], v1
    ds_read_b128 v[68:71], v5 offset:15360
    v_smfmac_f32_16x16x64_bf16 v[28:31], v[44:47], a[184:191], v1
    ds_read_b128 v[52:55], v6 offset:17408
    s_waitcnt lgkmcnt(3)
    v_smfmac_f32_16x16x64_bf16 v[32:35], v[44:47], v[56:63], v1
    ds_read_b128 v[56:59], v5 offset:16384
    v_smfmac_f32_16x16x64_bf16 v[20:23], v[48:51], a[176:183], v1
    ds_read_b128 v[60:63], v5 offset:17408
    s_waitcnt lgkmcnt(3)
    v_max3_u32 v10, v36, v40, v44
    v_smfmac_f32_16x16x64_bf16 v[24:27], v[48:51], v[64:71], v1
    ds_read_b128 v[64:67], v5 offset:18432
    s_waitcnt lgkmcnt(3)
    v_max3_u32 v10, v10, v48, v52
    v_smfmac_f32_16x16x64_bf16 v[28:31], v[48:51], a[168:175], v1
    ds_read_b128 v[68:71], v5 offset:19456
    v_cmp_eq_u32 vcc, -1, v10
    v_smfmac_f32_16x16x64_bf16 v[32:35], v[48:51], a[160:167], v1
    s_cbranch_vccnz M_c0_0_lr
    s_waitcnt vmcnt(0)
    s_barrier
    ds_read_b128 v[36:39], v6 offset:8192
    ds_read_b128 v[40:43], v6 offset:9216
    s_waitcnt lgkmcnt(4)
    v_smfmac_f32_16x16x64_bf16 v[20:23], v[52:55], v[56:63], v1
    ds_read_b128 v[44:47], v6 offset:10240
    ds_read_b128 v[48:51], v6 offset:11264
    v_smfmac_f32_16x16x64_bf16 v[24:27], v[52:55], a[152:159], v1
    ds_read_b32 v11, v6 offset:12288
    ds_read_b128 v[56:59], v5 offset:20480
    s_waitcnt lgkmcnt(6)
    v_smfmac_f32_16x16x64_bf16 v[28:31], v[52:55], v[64:71], v1
    ds_read_b128 v[60:63], v5 offset:21504
    s_waitcnt lgkmcnt(4)
    v_max3_u32 v10, v36, v40, v44
    v_smfmac_f32_16x16x64_bf16 v[32:35], v[52:55], a[144:151], v1
    s_waitcnt lgkmcnt(2)
    v_max3_u32 v10, v10, v48, v11
    v_cmp_eq_u32 vcc, -1, v10
    s_cbranch_vccnz M_c0_0_rr
M_c0_0_rr_r:
    ds_read_b128 v[64:67], v5 offset:22528
    ds_read_b128 v[68:71], v5 offset:23552
    ds_read_b128 v[52:55], v6 offset:12288
    buffer_store_dwordx4 v[76:79], v0, s[8:11], s4 offen offset:0 sc1
    s_mov_b32 s4, 0x10000000
    s_mov_b64 exec, 0x3ff
    buffer_store_dwordx4 v[72:75], v0, s[8:11], s60 offen sc1
    s_mov_b64 exec, -1
    s_mov_b32 s60, 0x10000000
    v_smfmac_f32_16x16x64_bf16 v[20:23], v[36:39], a[136:143], v1
    s_waitcnt lgkmcnt(3)
    v_smfmac_f32_16x16x64_bf16 v[24:27], v[36:39], v[56:63], v1
    ds_read_b128 v[56:59], v5 offset:24576
    v_smfmac_f32_16x16x64_bf16 v[20:23], v[40:43], a[128:135], v1
    ds_read_b128 v[60:63], v5 offset:25600
    s_waitcnt lgkmcnt(3)
    v_smfmac_f32_16x16x64_bf16 v[24:27], v[40:43], v[64:71], v1
    ds_read_b128 v[64:67], v5 offset:26624
    v_smfmac_f32_16x16x64_bf16 v[20:23], v[44:47], a[120:127], v1
    ds_read_b128 v[68:71], v5 offset:27648
    v_smfmac_f32_16x16x64_bf16 v[24:27], v[44:47], a[112:119], v1
    s_waitcnt lgkmcnt(2)
    v_smfmac_f32_16x16x64_bf16 v[20:23], v[48:51], v[56:63], v1
    ds_read_b128 v[56:59], v5 offset:28672
    v_smfmac_f32_16x16x64_bf16 v[24:27], v[48:51], a[104:111], v1
    ds_read_b128 v[60:63], v5 offset:29696
    s_waitcnt lgkmcnt(2)
    v_smfmac_f32_16x16x64_bf16 v[20:23], v[52:55], v[64:71], v1
    ds_read_b128 v[64:67], v5 offset:30720
    v_smfmac_f32_16x16x64_bf16 v[24:27], v[52:55], a[96:103], v1
    ds_read_b128 v[68:71], v5 offset:31744
    v_smfmac_f32_16x16x64_bf16 v[28:31], v[36:39], a[88:95], v1
    s_cmp_eq_u32 s57, 0
    s_cbranch_scc1 M_c0_0_first
M_c0_0_first_r:
    s_waitcnt lgkmcnt(2)
    v_smfmac_f32_16x16x64_bf16 v[32:35], v[36:39], v[56:63], v1
    ds_read_b128 v[56:59], v5 offset:32768
    v_permlane32_swap_b32 v20, v21
    v_smfmac_f32_16x16x64_bf16 v[28:31], v[40:43], a[80:87], v1
    ds_read_b128 v[60:63], v5 offset:33792
    s_waitcnt lgkmcnt(2)
    v_permlane32_swap_b32 v22, v23
    v_smfmac_f32_16x16x64_bf16 v[32:35], v[40:43], v[64:71], v1
    ds_read_b128 v[64:67], v0 offset:2048
    v_permlane32_swap_b32 v24, v25
    v_smfmac_f32_16x16x64_bf16 v[28:31], v[44:47], a[72:79], v1
    ds_read_b128 v[68:71], v0 offset:3072
    v_permlane32_swap_b32 v26, v27
    v_smfmac_f32_16x16x64_bf16 v[32:35], v[44:47], a[64:71], v1
    s_waitcnt lgkmcnt(2)
    v_add_f32 v20, v20, v21
    v_add_f32 v22, v22, v23
    v_smfmac_f32_16x16x64_bf16 v[28:31], v[48:51], v[56:63], v1
    ds_read_b128 v[56:59], v0 offset:0
    v_add_f32 v24, v24, v25
    v_add_f32 v26, v26, v27
    v_smfmac_f32_16x16x64_bf16 v[32:35], v[48:51], a[56:63], v1
    ds_read_b128 v[60:63], v0 offset:1024
    v_mul_f32 v20, s40, v20
    v_mul_f32 v24, s40, v24
    v_smfmac_f32_16x16x64_bf16 v[28:31], v[52:55], a[48:55], v1
    v_mul_f32 v22, s40, v22
    v_mul_f32 v26, s40, v26
    v_smfmac_f32_16x16x64_bf16 v[32:35], v[52:55], a[40:47], v1
    v_cvt_pk_bf16_f32 v20, v20, v24
    v_cvt_pk_bf16_f32 v21, v22, v26
    v_smfmac_f32_16x16x64_bf16 v[12:15], v[36:39], a[32:39], v1
    ds_write_b32 v2, v20 offset:18432
    v_smfmac_f32_16x16x64_bf16 v[16:19], v[36:39], a[24:31], v1
    ds_write_b32 v2, v21 offset:19008
    v_permlane32_swap_b32 v28, v29
    v_smfmac_f32_16x16x64_bf16 v[12:15], v[40:43], a[16:23], v1
    ds_read_b128 v[36:39], v6 offset:15360
    v_permlane32_swap_b32 v30, v31
    v_smfmac_f32_16x16x64_bf16 v[16:19], v[40:43], a[8:15], v1
    ds_read_b128 v[40:43], v6 offset:16384
    v_permlane32_swap_b32 v32, v33
    v_smfmac_f32_16x16x64_bf16 v[12:15], v[44:47], a[0:7], v1
    s_waitcnt lgkmcnt(2)
    s_barrier
    v_permlane32_swap_b32 v34, v35
    v_smfmac_f32_16x16x64_bf16 v[16:19], v[44:47], v[248:255], v1
    ds_read_b128 v[20:23], v3 offset:18432
    v_add_f32 v28, v28, v29
    v_add_f32 v30, v30, v31
    v_smfmac_f32_16x16x64_bf16 v[12:15], v[48:51], v[240:247], v1
    ds_read_b128 v[24:27], v3 offset:18496
    v_add_f32 v32, v32, v33
    v_add_f32 v34, v34, v35
    v_smfmac_f32_16x16x64_bf16 v[16:19], v[48:51], v[232:239], v1
    ds_read_b128 v[72:75], v3 offset:18560
    v_cvt_pk_bf16_f32 v28, v28, v32
    v_cvt_pk_bf16_f32 v29, v30, v34
    v_smfmac_f32_16x16x64_bf16 v[12:15], v[52:55], v[224:231], v1
    ds_write_b32 v2, v28 offset:20736
    ds_read_b128 v[44:47], v3 offset:18624
    v_smfmac_f32_16x16x64_bf16 v[16:19], v[52:55], v[216:223], v1
    ds_write_b32 v2, v29 offset:21312
    s_waitcnt lgkmcnt(7)
    v_smfmac_f32_16x16x64_bf16 v[12:15], v[36:39], v[208:215], v1
    ds_read_b128 v[48:51], v6 offset:17408
    v_mov_b64 v[10:11], s[16:17]
    v_smfmac_f32_16x16x64_bf16 v[16:19], v[36:39], v[200:207], v1
    s_waitcnt lgkmcnt(6)
    v_mfma_f32_16x16x32_bf16 v[28:31], v[56:59], v[20:23], 0
    ds_read_b128 v[56:59], v0 offset:4096
    s_waitcnt lgkmcnt(6)
    v_mfma_f32_16x16x32_bf16 v[28:31], v[60:63], v[24:27], v[28:31]
    ds_read_b128 v[60:63], v0 offset:5120
    s_waitcnt lgkmcnt(3)
    s_barrier
    v_mfma_f32_16x16x32_bf16 v[28:31], v[64:67], v[72:75], v[28:31]
    ds_read_b128 v[64:67], v0 offset:6144
    v_mfma_f32_16x16x32_bf16 v[28:31], v[68:71], v[44:47], v[28:31]
    ds_read_b128 v[68:71], v0 offset:7168
    v_smfmac_f32_16x16x64_bf16 v[12:15], v[40:43], v[192:199], v1
    ds_read_b128 v[36:39], v3 offset:20736
    v_smfmac_f32_16x16x64_bf16 v[16:19], v[40:43], v[184:191], v1
    ds_read_b128 v[52:55], v3 offset:20800
    s_waitcnt lgkmcnt(4)
    v_mfma_f32_16x16x32_bf16 v[32:35], v[56:59], v[20:23], 0
    s_nop 0
    v_exp_f32 v28, v28
    ds_read_b128 v[56:59], v3 offset:20864
    v_mfma_f32_16x16x32_bf16 v[32:35], v[60:63], v[24:27], v[32:35]
    s_waitcnt lgkmcnt(3)
    v_exp_f32 v29, v29
    ds_read_b128 v[60:63], v3 offset:20928
    v_mfma_f32_16x16x32_bf16 v[32:35], v[64:67], v[72:75], v[32:35]
    v_exp_f32 v30, v30
    v_mfma_f32_16x16x32_bf16 v[32:35], v[68:71], v[44:47], v[32:35]
    s_waitcnt lgkmcnt(3)
    v_exp_f32 v31, v31
    v_mfma_f32_16x16x32_bf16 v[40:43], v[36:39], v[20:23], 0
    s_waitcnt lgkmcnt(2)
    v_cvt_pk_bf16_f32 v28, v28, v29
    v_cvt_pk_bf16_f32 v29, v30, v31
    v_mfma_f32_16x16x32_bf16 v[40:43], v[52:55], v[24:27], v[40:43]
    s_waitcnt lgkmcnt(1)
    v_mov_b64 v[64:65], s[24:25]
    v_mov_b64 v[66:67], s[24:25]
    v_mfma_f32_16x16x32_bf16 v[40:43], v[56:59], v[72:75], v[40:43]
    s_waitcnt lgkmcnt(0)
    v_exp_f32 v32, v32
    v_mfma_f32_16x16x32_bf16 v[40:43], v[60:63], v[44:47], v[40:43]
    v_exp_f32 v33, v33
    v_smfmac_f32_16x16x64_bf16 v[12:15], v[48:51], v[176:183], v1
    v_exp_f32 v34, v34
    v_smfmac_f32_16x16x64_bf16 v[16:19], v[48:51], v[168:175], v1
    v_exp_f32 v35, v35
    v_cvt_pk_bf16_f32 v30, v32, v33
    v_cvt_pk_bf16_f32 v31, v34, v35
    s_nop 0
    v_exp_f32 v40, v40
    v_mfma_f32_16x16x32_bf16 v[72:75], v[64:67], v[28:31], 0
    v_exp_f32 v41, v41
    v_mfma_f32_16x16x32_bf16 v[20:23], v[80:83], v[28:31], 0
    v_exp_f32 v42, v42
    v_mfma_f32_16x16x32_bf16 v[24:27], v[84:87], v[28:31], 0
    v_exp_f32 v43, v43
    v_cvt_pk_bf16_f32 v40, v40, v41
    v_cvt_pk_bf16_f32 v41, v42, v43
    v_cvt_pk_bf16_f32 v12, v12, v13
    v_cvt_pk_bf16_f32 v13, v14, v15
    v_mfma_f32_16x16x16_bf16 v[72:75], v[10:11], v[40:41], v[72:75]
    v_cvt_pk_bf16_f32 v14, v16, v17
    v_cvt_pk_bf16_f32 v15, v18, v19
M_c0_0_fin:
    v_mfma_f32_16x16x16_bf16 v[20:23], v[12:13], v[40:41], v[20:23]
    s_cmp_eq_u32 s57, 63
    v_cndmask_b32_e64 v76, v12, v36, s[66:67]
    v_cndmask_b32_e64 v77, v13, v37, s[66:67]
    v_mfma_f32_16x16x16_bf16 v[24:27], v[14:15], v[40:41], v[24:27]
    v_cndmask_b32_e64 v78, v14, v38, s[66:67]
    v_cndmask_b32_e64 v79, v15, v39, s[66:67]
    s_cbranch_scc1 M_c0_0_last
    v_rcp_f32 v74, v72
    v_subrev_u32 v73, s68, v72
    v_cmp_lt_u32 vcc, s69, v73
    v_mov_b64 v[44:45], 0
    v_mov_b64 v[46:47], 0
    v_cndmask_b32_e64 v20, v20, v24, s[18:19]
    v_cndmask_b32_e64 v21, v21, v25, s[18:19]
    v_cndmask_b32_e64 v22, v22, v26, s[18:19]
    v_cndmask_b32_e64 v23, v23, v27, s[18:19]
    v_pk_mul_f32 v[20:21], v[20:21], v[74:75] op_sel_hi:[1,0]
    v_pk_mul_f32 v[22:23], v[22:23], v[74:75] op_sel_hi:[1,0]
    v_cvt_pk_bf16_f32 v20, v20, v21
    v_cvt_pk_bf16_f32 v21, v22, v23
    ds_write_b64 v0, v[20:21] offset:13312
    s_cbranch_vccnz M_c0_0_zbad
M_c0_0_zok:
    s_cmp_lt_u32 s54, s42
    s_cbranch_scc1 M_c0_0_first2
M_c0_0_first2_r:
    buffer_load_dwordx4 v[80:83], v0, s[8:11], s3 offen offset:0 sc1
    buffer_load_dwordx4 v[84:87], v0, s[8:11], s3 offen offset:1024 sc1
    s_waitcnt lgkmcnt(0)
    s_barrier
    ds_read_b128 v[32:35], v0 offset:13312
    ds_read_b128 v[52:55], v0 offset:14336
    s_mov_b32 m0, 0
    s_nop 0
    buffer_load_dwordx4 v0, s[8:11], s26 offen offset:0 sc1 lds
    buffer_load_dwordx4 v0, s[8:11], s26 offen offset:1024 sc1 lds
    v_mov_b64 v[68:69], 0
    v_mov_b64 v[70:71], 0
    v_mov_b64 v[64:65], 0
    v_mov_b64 v[66:67], 0
    v_mov_b64 v[60:61], 0
    v_mov_b64 v[62:63], 0
    v_mov_b64 v[56:57], 0
    v_mov_b64 v[58:59], 0
    s_waitcnt lgkmcnt(1)
    s_nop 0
    v_smfmac_f32_16x16x64_bf16 v[56:59], v[32:35], v[160:167], v1
    v_smfmac_f32_16x16x64_bf16 v[60:63], v[32:35], v[144:151], v1
    s_waitcnt lgkmcnt(0)
    v_smfmac_f32_16x16x64_bf16 v[56:59], v[52:55], v[152:159], v1
    v_smfmac_f32_16x16x64_bf16 v[60:63], v[52:55], v[136:143], v1
    v_smfmac_f32_16x16x64_bf16 v[64:67], v[32:35], v[128:135], v1
    v_smfmac_f32_16x16x64_bf16 v[68:71], v[32:35], v[112:119], v1
    v_permlane32_swap_b32 v56, v57
    v_smfmac_f32_16x16x64_bf16 v[64:67], v[52:55], v[120:127], v1
    v_permlane32_swap_b32 v58, v59
    v_smfmac_f32_16x16x64_bf16 v[68:71], v[52:55], v[104:111], v1
    v_add_f32 v56, v56, v57
    v_add_f32 v58, v58, v59
    v_smfmac_f32_16x16x64_bf16 v[44:47], v[32:35], v[96:103], v1
    v_permlane32_swap_b32 v60, v61
    v_smfmac_f32_16x16x64_bf16 v[44:47], v[52:55], v[88:95], v1
    v_permlane32_swap_b32 v62, v63
    v_add_f32 v60, v60, v61
    v_add_f32 v62, v62, v63
    v_cvt_pk_bf16_f32 v36, v56, v60
    v_cvt_pk_bf16_f32 v38, v58, v62
    v_permlane32_swap_b32 v64, v65
    v_permlane32_swap_b32 v66, v67
    v_add_f32 v64, v64, v65
    v_add_f32 v66, v66, v67
    v_permlane32_swap_b32 v68, v69
    v_permlane32_swap_b32 v70, v71
    v_add_f32 v68, v68, v69
    v_add_f32 v70, v70, v71
    v_cvt_pk_bf16_f32 v37, v64, v68
    v_cvt_pk_bf16_f32 v39, v66, v70
    buffer_store_dwordx4 v[36:39], v0, s[8:11], s58 offen
    v_permlane32_swap_b32 v44, v45
    v_permlane32_swap_b32 v46, v47
    v_add_f32 v44, v44, v45
    v_add_f32 v46, v46, v47
    v_cvt_pk_bf16_f32 v44, v44, v46
    buffer_store_dword v44, v7, s[8:11], s55 offen
    v_and_b32 v32, 16, v0
    v_bfe_u32 v33, v0, 5, 2
    v_lshlrev_b32_e64 v32, v32, s45
    v_cmp_eq_u32_e64 s[64:65], 0, v33
    v_cmp_eq_u32_e64 vcc, 1, v33
    s_add_u32 s27, s44, 1
    s_and_b32 s27, s27, 3
    v_cndmask_b32_e64 v72, 0, v32, s[64:65]
    v_cndmask_b32_e64 v73, 0, v32, vcc
    v_cmp_eq_u32_e64 s[64:65], 2, v33
    v_cmp_eq_u32_e64 vcc, 3, v33
    s_mul_i32 s48, s27, 5120
    s_add_u32 s48, s48, s41
    v_cndmask_b32_e64 v74, 0, v32, s[64:65]
    v_cndmask_b32_e64 v75, 0, v32, vcc
    s_lshl_b32 s27, s27, 15
    s_add_u32 s49, s27, s47
    v_bfe_u32 v11, v0, 4, 3
    v_lshlrev_b32 v11, 3, v11
    v_lshrrev_b32 v32, 8, v0
    v_lshl_add_u32 v11, v32, 6, v11
    s_add_u32 s56, s27, s46
    s_add_u32 s56, s56, s33
    s_add_u32 s58, s48, s33
    s_nop 15
    s_nop 15
    buffer_load_dwordx4 v[12:15], v8, s[8:11], s43 offen sc1
    buffer_load_dwordx4 v[16:19], v8, s[8:11], s61 offen sc1
    buffer_load_dwordx4 v[20:23], v8, s[8:11], s100 offen sc1
    buffer_load_dwordx4 v[24:27], v8, s[8:11], s101 offen sc1
    s_nop 15
    s_nop 11
    buffer_load_dwordx4 v[40:43], v8, s[8:11], s43 offen sc1
    buffer_load_dwordx4 v[44:47], v8, s[8:11], s61 offen sc1
    buffer_load_dwordx4 v[48:51], v8, s[8:11], s100 offen sc1
    buffer_load_dwordx4 v[52:55], v8, s[8:11], s101 offen sc1
    s_nop 7
    s_waitcnt vmcnt(7)
    v_mfma_f32_16x16x32_bf16 v[28:31], v[72:75], v[12:15], 0
    s_waitcnt vmcnt(6)
    v_mfma_f32_16x16x32_bf16 v[28:31], v[72:75], v[16:19], v[28:31]
    s_waitcnt vmcnt(5)
    v_mfma_f32_16x16x32_bf16 v[28:31], v[72:75], v[20:23], v[28:31]
    s_waitcnt vmcnt(4)
    v_mfma_f32_16x16x32_bf16 v[28:31], v[72:75], v[24:27], v[28:31]
    v_max3_u32 v32, v12, v16, v20
    v_max_u32 v32, v32, v24
    v_cmp_eq_u32 vcc, -1, v32
    s_cbranch_vccnz M_c0_0_wq1
    v_mov_b32 v5, v5
    v_mov_b32 v5, v5
    v_mov_b32 v5, v5
    v_mov_b32 v5, v5
    v_add_f32_dpp v28, v28, v28 row_ror:8 row_mask:0xf bank_mask:0xf
    v_add_f32_dpp v29, v29, v29 row_ror:8 row_mask:0xf bank_mask:0xf
    v_add_f32_dpp v30, v30, v30 row_ror:8 row_mask:0xf bank_mask:0xf
    v_add_f32_dpp v31, v31, v31 row_ror:8 row_mask:0xf bank_mask:0xf
    v_cmp_u_f32 vcc, v28, v28
    v_cvt_pk_bf16_f32 v28, v28, v29
    v_cvt_pk_bf16_f32 v29, v30, v31
    s_cbranch_vccnz M_c0_0_wrb_e0
    s_mov_b64 exec, s[38:39]
    buffer_store_dwordx2 v[28:29], v11, s[8:11], s58 offen
M_c0_0_wrb_d:
    s_barrier
    buffer_store_dwordx2 v[28:29], v11, s[8:11], s56 offen sc1
M_c0_0_wrb_g:
    s_mov_b64 exec, -1
    s_waitcnt vmcnt(2)
    ds_read_b128 v[56:59], v5 offset:0
    ds_read_b128 v[60:63], v5 offset:1024
    ds_read_b128 v[64:67], v5 offset:2048
    ds_read_b128 v[68:71], v5 offset:3072
    v_mov_b64 v[12:13], 0
    v_mov_b64 v[14:15], 0
    v_mov_b64 v[16:17], 0
    v_mov_b64 v[18:19], 0
    v_mov_b64 v[20:21], 0
    v_mov_b64 v[22:23], 0
    v_mov_b64 v[24:25], 0
    v_mov_b64 v[26:27], 0
    v_mov_b64 v[28:29], 0
    v_mov_b64 v[30:31], 0
    v_mov_b64 v[32:33], 0
    v_mov_b64 v[34:35], 0
    ds_read_b64 v[36:37], v0 offset:23296
    s_waitcnt lgkmcnt(0)
    v_min_u32 v36, v36, v37
    s_nop 0
    v_readfirstlane_b32 s28, v36
    s_nop 0
    s_max_u32 s54, s54, s28
    s_and_b32 s26, s44, 63
    s_add_u32 s26, s26, 2
    s_min_u32 s26, s26, 63
    s_lshl_b32 s26, s26, 18
    s_add_u32 s26, s26, s50
    s_add_u32 s3, s26, 16777216
    s_lshl_b32 s4, s44, 18
    s_add_u32 s4, s4, s53
    v_mov_b64 v[72:73], -1
    v_mov_b64 v[74:75], -1
    s_add_u32 s28, s44, 3
    s_and_b32 s29, s28, 3
    s_mul_i32 s31, s22, 160
    s_mul_i32 s28, s29, 167936
    s_add_u32 s28, s28, s34
    s_add_u32 s64, s28, s35
    s_mul_i32 s65, s29, 5120
    s_add_u32 s65, s65, s41
    s_add_u32 s65, s65, s31
    s_lshl_b32 s60, s29, 15
    s_add_u32 s60, s60, s47
    s_add_u32 s60, s60, s31
    s_add_u32 s44, s44, 1
    s_and_b32 s55, s44, 3
    s_mul_i32 s55, s55, 167936
    s_add_u32 s55, s55, s34
    s_add_u32 s58, s55, s35
    s_and_b32 s57, s44, 63
    s_add_u32 s43, s55, s32
    s_add_u32 s61, s43, 33792
    s_add_u32 s100, s43, 67584
    s_add_u32 s101, s43, 101376
    s_add_u32 s42, s44, 2
    s_or_b32 s28, s44, 63
    s_add_u32 s28, s28, 1
    s_min_u32 s42, s42, s28
    s_nop 15
    s_nop 15
    s_nop 1
    buffer_store_dwordx4 v[72:75], v0, s[8:11], s64 offen offset:0
    buffer_store_dwordx4 v[72:75], v0, s[8:11], s64 offen offset:1024
    s_mov_b64 exec, 0x3ff
    buffer_store_dwordx4 v[72:75], v0, s[8:11], s65 offen
    s_mov_b64 exec, -1
    s_mov_b32 s65, 0x10000000
    s_mov_b32 s64, 0x10000000
    s_mov_b32 s70, 0
    s_branch M_c0_0_top
M_c0_0_restart:
    s_waitcnt vmcnt(0) lgkmcnt(0)
    s_nop 7
    s_barrier
    ds_read_b128 v[56:59], v5 offset:0
    ds_read_b128 v[60:63], v5 offset:1024
    ds_read_b128 v[64:67], v5 offset:2048
    ds_read_b128 v[68:71], v5 offset:3072
    v_mov_b64 v[12:13], 0
    v_mov_b64 v[14:15], 0
    v_mov_b64 v[16:17], 0
    v_mov_b64 v[18:19], 0
    v_mov_b64 v[20:21], 0
    v_mov_b64 v[22:23], 0
    v_mov_b64 v[24:25], 0
    v_mov_b64 v[26:27], 0
    v_mov_b64 v[28:29], 0
    v_mov_b64 v[30:31], 0
    v_mov_b64 v[32:33], 0
    v_mov_b64 v[34:35], 0
    s_waitcnt vmcnt(0) lgkmcnt(0)
    s_branch M_c0_0_top
M_c0_0_zbad:
    s_cmp_eq_u32 s70, 2
    s_cbranch_scc1 M_c0_0_zok
    v_cmp_u_f32 vcc, v72, v72
    s_cbranch_vccz M_c0_0_exact
    s_cmp_eq_u32 s70, 1
    s_cbranch_scc1 M_c0_0_exact
M_c0_0_vfy0:
    s_mov_b32 s70, 1
    s_mov_b32 s30, 0
    s_waitcnt vmcnt(0) lgkmcnt(0)
    s_nop 7
M_c0_0_vfy:
    v_mov_b32 v10, 0
    s_add_u32 s59, s48, 4096
    buffer_load_dwordx4 v[36:39], v0, s[8:11], s48 offen offset:0 sc1
    buffer_load_dwordx4 v[40:43], v0, s[8:11], s48 offen offset:1024 sc1
    buffer_load_dwordx4 v[44:47], v0, s[8:11], s48 offen offset:2048 sc1
    buffer_load_dwordx4 v[48:51], v0, s[8:11], s48 offen offset:3072 sc1
    buffer_load_dwordx4 v[52:55], v0, s[8:11], s59 offen offset:0 sc1
    s_waitcnt vmcnt(4)
    v_max3_u32 v10, v10, v36, v37
    v_max3_u32 v10, v10, v38, v39
    s_waitcnt vmcnt(3)
    v_max3_u32 v10, v10, v40, v41
    v_max3_u32 v10, v10, v42, v43
    s_waitcnt vmcnt(2)
    v_max3_u32 v10, v10, v44, v45
    v_max3_u32 v10, v10, v46, v47
    s_waitcnt vmcnt(1)
    v_max3_u32 v10, v10, v48, v49
    v_max3_u32 v10, v10, v50, v51
    s_waitcnt vmcnt(0)
    v_max3_u32 v10, v10, v52, v53
    v_max3_u32 v10, v10, v54, v55
    s_add_u32 s59, s49, 4096
    buffer_load_dwordx4 v[36:39], v0, s[8:11], s49 offen offset:0 sc1
    buffer_load_dwordx4 v[40:43], v0, s[8:11], s49 offen offset:1024 sc1
    buffer_load_dwordx4 v[44:47], v0, s[8:11], s49 offen offset:2048 sc1
    buffer_load_dwordx4 v[48:51], v0, s[8:11], s49 offen offset:3072 sc1
    buffer_load_dwordx4 v[52:55], v0, s[8:11], s59 offen offset:0 sc1
    s_waitcnt vmcnt(4)
    v_max3_u32 v10, v10, v36, v37
    v_max3_u32 v10, v10, v38, v39
    s_waitcnt vmcnt(3)
    v_max3_u32 v10, v10, v40, v41
    v_max3_u32 v10, v10, v42, v43
    s_waitcnt vmcnt(2)
    v_max3_u32 v10, v10, v44, v45
    v_max3_u32 v10, v10, v46, v47
    s_waitcnt vmcnt(1)
    v_max3_u32 v10, v10, v48, v49
    v_max3_u32 v10, v10, v50, v51
    s_waitcnt vmcnt(0)
    v_max3_u32 v10, v10, v52, v53
    v_max3_u32 v10, v10, v54, v55
    v_cmp_eq_u32 vcc, -1, v10
    s_cbranch_vccz M_c0_0_restart
    s_add_u32 s30, s30, 1
    s_cmp_ge_u32 s30, 60000
    s_cbranch_scc1 M_fail
    s_branch M_c0_0_vfy
M_c0_0_exact:
    s_nop 7
    s_mov_b32 s70, 2
    s_waitcnt lgkmcnt(0)
    ds_read_b128 v[20:23], v3 offset:18432
    ds_read_b128 v[24:27], v3 offset:18496
    ds_read_b128 v[72:75], v3 offset:18560
    ds_read_b128 v[44:47], v3 offset:18624
    ds_read_b128 v[56:59], v0 offset:0
    s_waitcnt lgkmcnt(0)
    v_mfma_f32_16x16x32_bf16 v[28:31], v[56:59], v[20:23], 0
    s_nop 3
    ds_read_b128 v[60:63], v0 offset:1024
    s_waitcnt lgkmcnt(0)
    v_mfma_f32_16x16x32_bf16 v[28:31], v[60:63], v[24:27], v[28:31]
    s_nop 3
    ds_read_b128 v[56:59], v0 offset:2048
    s_waitcnt lgkmcnt(0)
    v_mfma_f32_16x16x32_bf16 v[28:31], v[56:59], v[72:75], v[28:31]
    s_nop 3
    ds_read_b128 v[60:63], v0 offset:3072
    s_waitcnt lgkmcnt(0)
    v_mfma_f32_16x16x32_bf16 v[28:31], v[60:63], v[44:47], v[28:31]
    s_nop 3
    ds_read_b128 v[56:59], v0 offset:4096
    s_waitcnt lgkmcnt(0)
    v_mfma_f32_16x16x32_bf16 v[32:35], v[56:59], v[20:23], 0
    s_nop 3
    ds_read_b128 v[60:63], v0 offset:5120
    s_waitcnt lgkmcnt(0)
    v_mfma_f32_16x16x32_bf16 v[32:35], v[60:63], v[24:27], v[32:35]
    s_nop 3
    ds_read_b128 v[56:59], v0 offset:6144
    s_waitcnt lgkmcnt(0)
    v_mfma_f32_16x16x32_bf16 v[32:35], v[56:59], v[72:75], v[32:35]
    s_nop 3
    ds_read_b128 v[60:63], v0 offset:7168
    s_waitcnt lgkmcnt(0)
    v_mfma_f32_16x16x32_bf16 v[32:35], v[60:63], v[44:47], v[32:35]
    s_nop 3
    ds_read_b128 v[56:59], v3 offset:20736
    s_waitcnt lgkmcnt(0)
    v_mfma_f32_16x16x32_bf16 v[40:43], v[56:59], v[20:23], 0
    s_nop 3
    ds_read_b128 v[60:63], v3 offset:20800
    s_waitcnt lgkmcnt(0)
    v_mfma_f32_16x16x32_bf16 v[40:43], v[60:63], v[24:27], v[40:43]
    s_nop 3
    ds_read_b128 v[56:59], v3 offset:20864
    s_waitcnt lgkmcnt(0)
    v_mfma_f32_16x16x32_bf16 v[40:43], v[56:59], v[72:75], v[40:43]
    s_nop 3
    ds_read_b128 v[60:63], v3 offset:20928
    s_waitcnt lgkmcnt(0)
    v_mfma_f32_16x16x32_bf16 v[40:43], v[60:63], v[44:47], v[40:43]
    s_nop 3
    v_max3_f32 v68, v28, v29, v30
    v_max3_f32 v68, v68, v31, v32
    v_max3_f32 v68, v68, v33, v34
    s_nop 0
    v_max3_f32 v68, v68, v35, v40
    v_max3_f32 v68, v68, v41, v42
    v_max_f32 v68, v68, v43
    v_mov_b32 v69, v68
    s_nop 1
    v_permlane16_swap_b32 v68, v69
    v_max_f32 v68, v68, v69
    v_mov_b32 v69, v68
    s_nop 1
    v_permlane32_swap_b32 v68, v69
    v_max_f32 v68, v68, v69
    v_sub_f32 v28, v28, v68
    v_exp_f32 v28, v28
    v_sub_f32 v29, v29, v68
    v_exp_f32 v29, v29
    v_sub_f32 v30, v30, v68
    v_exp_f32 v30, v30
    v_sub_f32 v31, v31, v68
    v_exp_f32 v31, v31
    v_sub_f32 v32, v32, v68
    v_exp_f32 v32, v32
    v_sub_f32 v33, v33, v68
    v_exp_f32 v33, v33
    v_sub_f32 v34, v34, v68
    v_exp_f32 v34, v34
    v_sub_f32 v35, v35, v68
    v_exp_f32 v35, v35
    v_sub_f32 v40, v40, v68
    v_exp_f32 v40, v40
    v_sub_f32 v41, v41, v68
    v_exp_f32 v41, v41
    v_sub_f32 v42, v42, v68
    v_exp_f32 v42, v42
    v_sub_f32 v43, v43, v68
    v_exp_f32 v43, v43
    v_cvt_pk_bf16_f32 v28, v28, v29
    v_cvt_pk_bf16_f32 v29, v30, v31
    v_cvt_pk_bf16_f32 v30, v32, v33
    v_cvt_pk_bf16_f32 v31, v34, v35
    v_cvt_pk_bf16_f32 v40, v40, v41
    v_cvt_pk_bf16_f32 v41, v42, v43
    v_mfma_f32_16x16x32_bf16 v[20:23], v[80:83], v[28:31], 0
    v_mfma_f32_16x16x32_bf16 v[24:27], v[84:87], v[28:31], 0
    v_mfma_f32_16x16x32_bf16 v[72:75], v[64:67], v[28:31], 0
    ds_read_b128 v[36:39], v3 offset:20736
    s_waitcnt lgkmcnt(0)
    s_nop 7
    v_mfma_f32_16x16x16_bf16 v[72:75], v[10:11], v[40:41], v[72:75]
    s_nop 7
    s_branch M_c0_0_fin
M_c0_0_last:
    s_cmp_lg_u32 s70, 0
    s_cbranch_scc1 M_c0_0_last2
    v_cmp_u_f32 vcc, v32, v32
    s_cbranch_vccnz M_c0_0_vfy0
M_c0_0_last2:
    s_lshl_b32 s4, s44, 18
    s_add_u32 s4, s4, s53
    buffer_store_dwordx4 v[76:79], v0, s[8:11], s4 offen offset:0 sc1
    s_mov_b32 s4, 0x10000000
    s_waitcnt vmcnt(0) lgkmcnt(0)
    s_barrier
    s_nop 7
    v_mov_b64 v[72:73], -1
    v_mov_b64 v[74:75], -1
    s_add_u32 s28, s44, 3
    s_and_b32 s29, s28, 3
    s_mul_i32 s31, s22, 160
    s_mul_i32 s28, s29, 167936
    s_add_u32 s28, s28, s34
    s_add_u32 s64, s28, s35
    s_mul_i32 s65, s29, 5120
    s_add_u32 s65, s65, s41
    s_add_u32 s65, s65, s31
    s_lshl_b32 s60, s29, 15
    s_add_u32 s60, s60, s47
    s_add_u32 s60, s60, s31
    buffer_store_dwordx4 v[72:75], v0, s[8:11], s64 offen offset:0
    buffer_store_dwordx4 v[72:75], v0, s[8:11], s64 offen offset:1024
    s_mov_b64 exec, 0x3ff
    buffer_store_dwordx4 v[72:75], v0, s[8:11], s65 offen
    s_mov_b64 exec, -1
    s_mov_b32 s65, 0x10000000
    s_mov_b32 s64, 0x10000000
    s_mov_b64 exec, 0x3ff
    buffer_store_dwordx4 v[72:75], v0, s[8:11], s60 offen sc1
    s_mov_b64 exec, -1
    s_mov_b32 s60, 0x10000000
    s_waitcnt vmcnt(0)
    s_add_u32 s44, s44, 1
    s_cmp_eq_u32 s44, 128
    s_cbranch_scc1 M_end
    s_branch M_c0_0_layer
M_c0_0_lr:
    s_mov_b32 s30, 0
M_c0_0_lr_l:
    s_waitcnt lgkmcnt(0)
    ds_read_b128 v[36:39], v6 offset:13312
    ds_read_b128 v[40:43], v6 offset:14336
    ds_read_b128 v[44:47], v6 offset:15360
    ds_read_b128 v[48:51], v6 offset:16384
    ds_read_b128 v[52:55], v6 offset:17408
    s_waitcnt lgkmcnt(2)
    v_max3_u32 v10, v36, v40, v44
    s_waitcnt lgkmcnt(0)
    v_max3_u32 v10, v10, v48, v52
    v_cmp_eq_u32 vcc, -1, v10
    s_cbranch_vccz M_c0_0_lr_d
    s_add_u32 s30, s30, 1
    s_cmp_ge_u32 s30, 480000
    s_cbranch_scc1 M_fail
    s_branch M_c0_0_lr_l
M_c0_0_lr_d:
    ds_read_b128 v[56:59], v5 offset:0
    ds_read_b128 v[60:63], v5 offset:1024
    ds_read_b128 v[64:67], v5 offset:2048
    ds_read_b128 v[68:71], v5 offset:3072
    v_mov_b64 v[12:13], 0
    v_mov_b64 v[14:15], 0
    v_mov_b64 v[16:17], 0
    v_mov_b64 v[18:19], 0
    v_mov_b64 v[20:21], 0
    v_mov_b64 v[22:23], 0
    v_mov_b64 v[24:25], 0
    v_mov_b64 v[26:27], 0
    v_mov_b64 v[28:29], 0
    v_mov_b64 v[30:31], 0
    v_mov_b64 v[32:33], 0
    v_mov_b64 v[34:35], 0
    s_waitcnt lgkmcnt(0)
    s_branch M_c0_0_lr_r
M_c0_0_rr:
    s_mov_b32 s30, 0
M_c0_0_rr_l:
    s_waitcnt lgkmcnt(0)
    s_and_b32 s27, s30, 1
    s_cbranch_scc1 M_c0_0_rr_n
    s_waitcnt vmcnt(2)
    s_mov_b32 m0, 8192
    s_nop 0
    buffer_load_dwordx4 v0, s[8:11], s49 offen offset:0 sc1 lds
    buffer_load_dwordx4 v0, s[8:11], s49 offen offset:1024 sc1 lds
M_c0_0_rr_n:
    ds_read_b128 v[36:39], v6 offset:8192
    ds_read_b128 v[40:43], v6 offset:9216
    ds_read_b128 v[44:47], v6 offset:10240
    ds_read_b128 v[48:51], v6 offset:11264
    ds_read_b32 v11, v6 offset:12288
    s_waitcnt lgkmcnt(2)
    v_max3_u32 v10, v36, v40, v44
    s_waitcnt lgkmcnt(0)
    v_max3_u32 v10, v10, v48, v11
    v_cmp_eq_u32 vcc, -1, v10
    s_cbranch_vccz M_c0_0_rr_d
    s_add_u32 s30, s30, 1
    s_cmp_ge_u32 s30, 480000
    s_cbranch_scc1 M_fail
    s_branch M_c0_0_rr_l
M_c0_0_rr_d:
    s_branch M_c0_0_rr_r
M_c0_0_first:
    s_mul_i32 s27, s21, 167936
    s_add_u32 s27, s27, s34
    s_mul_i32 s28, s22, 4224
    s_add_u32 s28, s28, s27
    s_mov_b32 exec_hi, 0
    buffer_load_dword v10, v9, s[8:11], s28 offen sc1
    s_lshl_b32 s28, s22, 10
    s_add_u32 s28, s28, s27
    s_add_u32 s28, s28, 135168
    s_mov_b64 exec, 0xff
    buffer_load_dword v10, v9, s[8:11], s28 offen sc1
    s_mul_i32 s27, s21, 5120
    s_add_u32 s27, s27, s41
    s_mul_i32 s28, s22, 160
    s_add_u32 s28, s28, s27
    s_mov_b64 exec, 3
    buffer_load_dword v10, v9, s[8:11], s28 offen sc1
    s_mov_b64 exec, -1
    s_barrier
    s_and_b32 s26, s44, 63
    s_lshl_b32 s26, s26, 18
    s_add_u32 s26, s26, s50
    s_add_u32 s3, s26, 16777216
    s_mov_b32 m0, 0
    s_nop 0
    buffer_load_dwordx4 v0, s[8:11], s26 offen offset:0 sc1 lds
    buffer_load_dwordx4 v0, s[8:11], s26 offen offset:1024 sc1 lds
    buffer_load_dwordx4 v[80:83], v0, s[8:11], s3 offen offset:0 sc1
    buffer_load_dwordx4 v[84:87], v0, s[8:11], s3 offen offset:1024 sc1
    s_and_b32 s26, s44, 63
    s_add_u32 s26, s26, 1
    s_min_u32 s26, s26, 63
    s_lshl_b32 s26, s26, 18
    s_add_u32 s26, s26, s50
    s_add_u32 s3, s26, 16777216
    s_waitcnt vmcnt(0) lgkmcnt(0)
    s_barrier
    s_branch M_c0_0_first_r
M_c0_0_first2:
    ds_read_b64 v[10:11], v0 offset:23296
    s_waitcnt lgkmcnt(0)
    v_min_u32 v10, v10, v11
    s_nop 0
    v_readfirstlane_b32 s28, v10
    s_nop 0
    s_max_u32 s54, s54, s28
    s_add_u32 s27, s44, 2
    s_or_b32 s28, s44, 63
    s_add_u32 s28, s28, 1
    s_min_u32 s27, s27, s28
    s_cmp_lt_u32 s54, s27
    s_cbranch_scc1 M_c0_0_p2
M_c0_0_p2_r:
    s_branch M_c0_0_first2_r
M_c0_0_wq1:
    buffer_load_dwordx4 v[12:15], v8, s[8:11], s43 offen sc1
    buffer_load_dwordx4 v[16:19], v8, s[8:11], s61 offen sc1
    buffer_load_dwordx4 v[20:23], v8, s[8:11], s100 offen sc1
    buffer_load_dwordx4 v[24:27], v8, s[8:11], s101 offen sc1
    s_waitcnt vmcnt(7)
    v_mfma_f32_16x16x32_bf16 v[28:31], v[72:75], v[40:43], 0
    s_waitcnt vmcnt(6)
    v_mfma_f32_16x16x32_bf16 v[28:31], v[72:75], v[44:47], v[28:31]
    s_waitcnt vmcnt(5)
    v_mfma_f32_16x16x32_bf16 v[28:31], v[72:75], v[48:51], v[28:31]
    s_waitcnt vmcnt(4)
    v_mfma_f32_16x16x32_bf16 v[28:31], v[72:75], v[52:55], v[28:31]
    v_max3_u32 v32, v40, v44, v48
    v_max_u32 v32, v32, v52
    v_cmp_eq_u32 vcc, -1, v32
    s_cbranch_vccnz M_c0_0_wqx
    v_mov_b32 v5, v5
    v_mov_b32 v5, v5
    v_mov_b32 v5, v5
    v_mov_b32 v5, v5
    v_add_f32_dpp v28, v28, v28 row_ror:8 row_mask:0xf bank_mask:0xf
    v_add_f32_dpp v29, v29, v29 row_ror:8 row_mask:0xf bank_mask:0xf
    v_add_f32_dpp v30, v30, v30 row_ror:8 row_mask:0xf bank_mask:0xf
    v_add_f32_dpp v31, v31, v31 row_ror:8 row_mask:0xf bank_mask:0xf
    v_cmp_u_f32 vcc, v28, v28
    v_cvt_pk_bf16_f32 v28, v28, v29
    v_cvt_pk_bf16_f32 v29, v30, v31
    s_cbranch_vccnz M_c0_0_wqe1
    s_mov_b64 exec, s[38:39]
    buffer_store_dwordx2 v[28:29], v11, s[8:11], s58 offen
    s_barrier
    buffer_store_dwordx2 v[28:29], v11, s[8:11], s56 offen sc1
    s_branch M_c0_0_wrb_g
M_c0_0_wqx:
    s_branch M_c0_0_wrb_i1
M_c0_0_wqe1:
    s_waitcnt vmcnt(0)
    buffer_load_dwordx4 v[12:15], v8, s[8:11], s43 offen sc1
    buffer_load_dwordx4 v[16:19], v8, s[8:11], s61 offen sc1
    buffer_load_dwordx4 v[20:23], v8, s[8:11], s100 offen sc1
    buffer_load_dwordx4 v[24:27], v8, s[8:11], s101 offen sc1
    s_branch M_c0_0_wrb_e1
M_c0_0_wrb_l:
    s_waitcnt vmcnt(4)
    v_mfma_f32_16x16x32_bf16 v[28:31], v[72:75], v[12:15], 0
    v_mfma_f32_16x16x32_bf16 v[28:31], v[72:75], v[16:19], v[28:31]
    v_mfma_f32_16x16x32_bf16 v[28:31], v[72:75], v[20:23], v[28:31]
    v_mfma_f32_16x16x32_bf16 v[28:31], v[72:75], v[24:27], v[28:31]
    v_max3_u32 v32, v12, v16, v20
    v_max_u32 v32, v32, v24
    v_cmp_eq_u32 vcc, -1, v32
    s_cbranch_vccz M_c0_0_wrb_x0
M_c0_0_wrb_i0:
    buffer_load_dwordx4 v[12:15], v8, s[8:11], s43 offen sc1
    buffer_load_dwordx4 v[16:19], v8, s[8:11], s61 offen sc1
    buffer_load_dwordx4 v[20:23], v8, s[8:11], s100 offen sc1
    buffer_load_dwordx4 v[24:27], v8, s[8:11], s101 offen sc1
    s_waitcnt vmcnt(4)
    v_mfma_f32_16x16x32_bf16 v[28:31], v[72:75], v[40:43], 0
    v_mfma_f32_16x16x32_bf16 v[28:31], v[72:75], v[44:47], v[28:31]
    v_mfma_f32_16x16x32_bf16 v[28:31], v[72:75], v[48:51], v[28:31]
    v_mfma_f32_16x16x32_bf16 v[28:31], v[72:75], v[52:55], v[28:31]
    v_max3_u32 v32, v40, v44, v48
    v_max_u32 v32, v32, v52
    v_cmp_eq_u32 vcc, -1, v32
    s_cbranch_vccz M_c0_0_wrb_x1
M_c0_0_wrb_i1:
    buffer_load_dwordx4 v[40:43], v8, s[8:11], s43 offen sc1
    buffer_load_dwordx4 v[44:47], v8, s[8:11], s61 offen sc1
    buffer_load_dwordx4 v[48:51], v8, s[8:11], s100 offen sc1
    buffer_load_dwordx4 v[52:55], v8, s[8:11], s101 offen sc1
    s_add_u32 s71, s71, 1
    s_cmp_lt_u32 s71, 240000
    s_cbranch_scc1 M_c0_0_wrb_l
    s_branch M_fail
M_c0_0_wrb_x0:
    s_nop 3
    v_add_f32_dpp v28, v28, v28 row_ror:8 row_mask:0xf bank_mask:0xf
    v_add_f32_dpp v29, v29, v29 row_ror:8 row_mask:0xf bank_mask:0xf
    v_add_f32_dpp v30, v30, v30 row_ror:8 row_mask:0xf bank_mask:0xf
    v_add_f32_dpp v31, v31, v31 row_ror:8 row_mask:0xf bank_mask:0xf
    v_cmp_u_f32 vcc, v28, v28
    v_cvt_pk_bf16_f32 v28, v28, v29
    v_cvt_pk_bf16_f32 v29, v30, v31
    s_cbranch_vccz M_c0_0_wrb_n
M_c0_0_wrb_e0:
    v_max3_u32 v32, v12, v13, v14
    v_max3_u32 v32, v32, v15, v16
    v_max3_u32 v32, v32, v17, v18
    v_max3_u32 v32, v32, v19, v20
    v_max3_u32 v32, v32, v21, v22
    v_max3_u32 v32, v32, v23, v24
    v_max3_u32 v32, v32, v25, v26
    v_max_u32 v32, v32, v27
    v_cmp_eq_u32 vcc, -1, v32
    s_cbranch_vccnz M_c0_0_wrb_i0
    v_min_u32 v28, -2, v28
    v_min_u32 v29, -2, v29
    s_branch M_c0_0_wrb_n
M_c0_0_wrb_x1:
    s_nop 3
    v_add_f32_dpp v28, v28, v28 row_ror:8 row_mask:0xf bank_mask:0xf
    v_add_f32_dpp v29, v29, v29 row_ror:8 row_mask:0xf bank_mask:0xf
    v_add_f32_dpp v30, v30, v30 row_ror:8 row_mask:0xf bank_mask:0xf
    v_add_f32_dpp v31, v31, v31 row_ror:8 row_mask:0xf bank_mask:0xf
    v_cmp_u_f32 vcc, v28, v28
    v_cvt_pk_bf16_f32 v28, v28, v29
    v_cvt_pk_bf16_f32 v29, v30, v31
    s_cbranch_vccz M_c0_0_wrb_n
M_c0_0_wrb_e1:
    v_max3_u32 v32, v40, v41, v42
    v_max3_u32 v32, v32, v43, v44
    v_max3_u32 v32, v32, v45, v46
    v_max3_u32 v32, v32, v47, v48
    v_max3_u32 v32, v32, v49, v50
    v_max3_u32 v32, v32, v51, v52
    v_max3_u32 v32, v32, v53, v54
    v_max_u32 v32, v32, v55
    v_cmp_eq_u32 vcc, -1, v32
    s_cbranch_vccnz M_c0_0_wrb_i1
    v_min_u32 v28, -2, v28
    v_min_u32 v29, -2, v29
M_c0_0_wrb_n:
    s_mov_b64 exec, s[38:39]
    buffer_store_dwordx2 v[28:29], v11, s[8:11], s58 offen
    s_branch M_c0_0_wrb_d
M_c0_0_p2:
    s_mov_b32 s30, 0
M_c0_0_p2_l:
    s_waitcnt lgkmcnt(0)
    s_mov_b64 exec, 3
    buffer_load_dword v10, v9, s[8:11], s51 offen sc1
    s_waitcnt vmcnt(0)
    s_mov_b64 exec, -1
    v_readlane_b32 s54, v10, 0
    v_readlane_b32 s28, v10, 1
    s_nop 3
    s_min_u32 s54, s54, s28
    s_cmp_ge_u32 s54, s27
    s_cbranch_scc1 M_c0_0_p2_r
    s_sleep 2
    s_add_u32 s30, s30, 1
    s_cmp_ge_u32 s30, 240000
    s_cbranch_scc1 M_fail
    s_branch M_c0_0_p2_l
M_c0_1_layer:
    s_lshr_b32 s27, s44, 6
    s_mul_i32 s50, s27, 33554432
    s_lshl_b32 s27, s22, 13
    s_add_u32 s50, s50, s27
    s_add_u32 s50, s50, 37748736
    s_barrier
    s_mov_b32 s26, 0x10010000
    s_mov_b32 s3, s26
    s_mul_i32 s27, s20, 5120
    s_add_u32 s48, s27, 167772160
    s_sub_u32 s49, 167777280, s27
    s_and_b32 s55, s44, 3
    s_mul_i32 s55, s55, 167936
    s_add_u32 s55, s55, s34
    s_add_u32 s58, s55, s35
    s_and_b32 s57, s44, 63
    s_add_u32 s43, s55, s32
    s_sub_u32 s27, s57, 1
    s_max_i32 s27, s27, 0
    s_lshl_b64 s[100:101], 1, s27
    s_lshl_b32 s27, s27, 7
    s_sub_u32 s61, s52, s27
    s_add_u32 s42, s44, 2
    s_or_b32 s28, s44, 63
    s_add_u32 s28, s28, 1
    s_min_u32 s42, s42, s28
    ds_read_b128 v[56:59], v5 offset:0
    ds_read_b128 v[60:63], v5 offset:1024
    ds_read_b128 v[64:67], v5 offset:2048
    ds_read_b128 v[68:71], v5 offset:3072
    v_mov_b64 v[12:13], 0
    v_mov_b64 v[14:15], 0
    v_mov_b64 v[16:17], 0
    v_mov_b64 v[18:19], 0
    v_mov_b64 v[20:21], 0
    v_mov_b64 v[22:23], 0
    v_mov_b64 v[24:25], 0
    v_mov_b64 v[26:27], 0
    v_mov_b64 v[28:29], 0
    v_mov_b64 v[30:31], 0
    v_mov_b64 v[32:33], 0
    v_mov_b64 v[34:35], 0
    s_mov_b32 s70, 0
    s_waitcnt lgkmcnt(0)
M_c0_1_top:
    s_nop 0
    s_barrier
    ds_read_b128 v[36:39], v6 offset:13312
    ds_read_b128 v[40:43], v6 offset:14336
    s_mov_b32 m0, 8192
    s_nop 0
    buffer_load_dwordx4 v0, s[8:11], s49 offen offset:2048 sc1 lds
M_c0_1_lr_r:
    s_waitcnt lgkmcnt(1)
    v_smfmac_f32_16x16x64_bf16 v[20:23], v[36:39], v[56:63], v1
    ds_read_b128 v[56:59], v5 offset:4096
    v_smfmac_f32_16x16x64_bf16 v[24:27], v[36:39], v[64:71], v1
    ds_read_b128 v[60:63], v5 offset:5120
    v_smfmac_f32_16x16x64_bf16 v[28:31], v[36:39], a[248:255], v1
    ds_read_b128 v[64:67], v5 offset:6144
    v_smfmac_f32_16x16x64_bf16 v[32:35], v[36:39], a[240:247], v1
    ds_read_b128 v[68:71], v5 offset:7168
    v_smfmac_f32_16x16x64_bf16 v[12:15], v[36:39], a[232:239], v1
    ds_read_b128 v[44:47], v6 offset:15360
    s_waitcnt lgkmcnt(3)
    v_smfmac_f32_16x16x64_bf16 v[16:19], v[36:39], v[56:63], v1
    ds_read_b128 v[56:59], v5 offset:8192
    v_smfmac_f32_16x16x64_bf16 v[20:23], v[40:43], a[224:231], v1
    ds_read_b128 v[60:63], v5 offset:9216
    s_waitcnt lgkmcnt(3)
    v_smfmac_f32_16x16x64_bf16 v[24:27], v[40:43], v[64:71], v1
    ds_read_b128 v[64:67], v5 offset:10240
    v_smfmac_f32_16x16x64_bf16 v[28:31], v[40:43], a[216:223], v1
    ds_read_b128 v[68:71], v5 offset:11264
    v_smfmac_f32_16x16x64_bf16 v[32:35], v[40:43], a[208:215], v1
    ds_read_b128 v[48:51], v6 offset:16384
    s_waitcnt lgkmcnt(3)
    v_smfmac_f32_16x16x64_bf16 v[12:15], v[40:43], v[56:63], v1
    ds_read_b128 v[56:59], v5 offset:12288
    v_smfmac_f32_16x16x64_bf16 v[16:19], v[40:43], a[200:207], v1
    ds_read_b128 v[60:63], v5 offset:13312
    s_waitcnt lgkmcnt(3)
    v_smfmac_f32_16x16x64_bf16 v[20:23], v[44:47], v[64:71], v1
    ds_read_b128 v[64:67], v5 offset:14336
    v_smfmac_f32_16x16x64_bf16 v[24:27], v[44:47], a[192:199], v1
    ds_read_b128 v[68:71], v5 offset:15360
    v_smfmac_f32_16x16x64_bf16 v[28:31], v[44:47], a[184:191], v1
    ds_read_b128 v[52:55], v6 offset:17408
    s_waitcnt lgkmcnt(3)
    v_smfmac_f32_16x16x64_bf16 v[32:35], v[44:47], v[56:63], v1
    ds_read_b128 v[56:59], v5 offset:16384
    v_smfmac_f32_16x16x64_bf16 v[20:23], v[48:51], a[176:183], v1
    ds_read_b128 v[60:63], v5 offset:17408
    s_waitcnt lgkmcnt(3)
    v_max3_u32 v10, v36, v40, v44
    v_smfmac_f32_16x16x64_bf16 v[24:27], v[48:51], v[64:71], v1
    ds_read_b128 v[64:67], v5 offset:18432
    s_waitcnt lgkmcnt(3)
    v_max3_u32 v10, v10, v48, v52
    v_smfmac_f32_16x16x64_bf16 v[28:31], v[48:51], a[168:175], v1
    ds_read_b128 v[68:71], v5 offset:19456
    v_cmp_eq_u32 vcc, -1, v10
    v_smfmac_f32_16x16x64_bf16 v[32:35], v[48:51], a[160:167], v1
    s_cbranch_vccnz M_c0_1_lr
    s_waitcnt vmcnt(0)
    s_barrier
    ds_read_b128 v[36:39], v6 offset:8192
    ds_read_b128 v[40:43], v6 offset:9216
    s_waitcnt lgkmcnt(4)
    v_smfmac_f32_16x16x64_bf16 v[20:23], v[52:55], v[56:63], v1
    ds_read_b128 v[44:47], v6 offset:10240
    ds_read_b128 v[48:51], v6 offset:11264
    v_smfmac_f32_16x16x64_bf16 v[24:27], v[52:55], a[152:159], v1
    ds_read_b32 v11, v6 offset:12288
    ds_read_b128 v[56:59], v5 offset:20480
    s_waitcnt lgkmcnt(6)
    v_smfmac_f32_16x16x64_bf16 v[28:31], v[52:55], v[64:71], v1
    ds_read_b128 v[60:63], v5 offset:21504
    s_waitcnt lgkmcnt(4)
    v_max3_u32 v10, v36, v40, v44
    v_smfmac_f32_16x16x64_bf16 v[32:35], v[52:55], a[144:151], v1
    s_waitcnt lgkmcnt(2)
    v_max3_u32 v10, v10, v48, v11
    v_cmp_eq_u32 vcc, -1, v10
    s_cbranch_vccnz M_c0_1_rr
M_c0_1_rr_r:
    s_mov_b32 m0, 23296
    ds_read_b128 v[64:67], v5 offset:22528
    ds_read_b128 v[68:71], v5 offset:23552
    ds_read_b128 v[52:55], v6 offset:12288
    buffer_store_dwordx4 v[76:79], v0, s[8:11], s4 offen offset:1024 sc1
    s_mov_b32 s4, 0x10000000
    s_mov_b64 exec, 3
    buffer_load_dword v9, s[8:11], s51 offen sc1 lds
    s_mov_b64 exec, s[100:101]
    buffer_store_dword v9, v9, s[8:11], s61 offen sc1
    s_mov_b64 exec, -1
    v_smfmac_f32_16x16x64_bf16 v[20:23], v[36:39], a[136:143], v1
    s_waitcnt lgkmcnt(3)
    v_smfmac_f32_16x16x64_bf16 v[24:27], v[36:39], v[56:63], v1
    ds_read_b128 v[56:59], v5 offset:24576
    v_smfmac_f32_16x16x64_bf16 v[20:23], v[40:43], a[128:135], v1
    ds_read_b128 v[60:63], v5 offset:25600
    s_waitcnt lgkmcnt(3)
    v_smfmac_f32_16x16x64_bf16 v[24:27], v[40:43], v[64:71], v1
    ds_read_b128 v[64:67], v5 offset:26624
    v_smfmac_f32_16x16x64_bf16 v[20:23], v[44:47], a[120:127], v1
    ds_read_b128 v[68:71], v5 offset:27648
    v_smfmac_f32_16x16x64_bf16 v[24:27], v[44:47], a[112:119], v1
    s_waitcnt lgkmcnt(2)
    v_smfmac_f32_16x16x64_bf16 v[20:23], v[48:51], v[56:63], v1
    ds_read_b128 v[56:59], v5 offset:28672
    v_smfmac_f32_16x16x64_bf16 v[24:27], v[48:51], a[104:111], v1
    ds_read_b128 v[60:63], v5 offset:29696
    s_waitcnt lgkmcnt(2)
    v_smfmac_f32_16x16x64_bf16 v[20:23], v[52:55], v[64:71], v1
    ds_read_b128 v[64:67], v5 offset:30720
    v_smfmac_f32_16x16x64_bf16 v[24:27], v[52:55], a[96:103], v1
    ds_read_b128 v[68:71], v5 offset:31744
    v_smfmac_f32_16x16x64_bf16 v[28:31], v[36:39], a[88:95], v1
    s_cmp_eq_u32 s57, 0
    s_cbranch_scc1 M_c0_1_first
M_c0_1_first_r:
    s_waitcnt lgkmcnt(2)
    v_smfmac_f32_16x16x64_bf16 v[32:35], v[36:39], v[56:63], v1
    ds_read_b128 v[56:59], v5 offset:32768
    v_permlane32_swap_b32 v20, v21
    v_smfmac_f32_16x16x64_bf16 v[28:31], v[40:43], a[80:87], v1
    ds_read_b128 v[60:63], v5 offset:33792
    s_waitcnt lgkmcnt(2)
    v_permlane32_swap_b32 v22, v23
    v_smfmac_f32_16x16x64_bf16 v[32:35], v[40:43], v[64:71], v1
    ds_read_b128 v[64:67], v0 offset:2048
    v_permlane32_swap_b32 v24, v25
    v_smfmac_f32_16x16x64_bf16 v[28:31], v[44:47], a[72:79], v1
    ds_read_b128 v[68:71], v0 offset:3072
    v_permlane32_swap_b32 v26, v27
    v_smfmac_f32_16x16x64_bf16 v[32:35], v[44:47], a[64:71], v1
    s_waitcnt lgkmcnt(2)
    v_add_f32 v20, v20, v21
    v_add_f32 v22, v22, v23
    v_smfmac_f32_16x16x64_bf16 v[28:31], v[48:51], v[56:63], v1
    ds_read_b128 v[56:59], v0 offset:0
    v_add_f32 v24, v24, v25
    v_add_f32 v26, v26, v27
    v_smfmac_f32_16x16x64_bf16 v[32:35], v[48:51], a[56:63], v1
    ds_read_b128 v[60:63], v0 offset:1024
    v_mul_f32 v20, s40, v20
    v_mul_f32 v24, s40, v24
    v_smfmac_f32_16x16x64_bf16 v[28:31], v[52:55], a[48:55], v1
    v_mul_f32 v22, s40, v22
    v_mul_f32 v26, s40, v26
    v_smfmac_f32_16x16x64_bf16 v[32:35], v[52:55], a[40:47], v1
    v_cvt_pk_bf16_f32 v20, v20, v24
    v_cvt_pk_bf16_f32 v21, v22, v26
    v_smfmac_f32_16x16x64_bf16 v[12:15], v[36:39], a[32:39], v1
    ds_write_b32 v2, v20 offset:18432
    v_smfmac_f32_16x16x64_bf16 v[16:19], v[36:39], a[24:31], v1
    ds_write_b32 v2, v21 offset:19008
    v_permlane32_swap_b32 v28, v29
    v_smfmac_f32_16x16x64_bf16 v[12:15], v[40:43], a[16:23], v1
    ds_read_b128 v[36:39], v6 offset:15360
    v_permlane32_swap_b32 v30, v31
    v_smfmac_f32_16x16x64_bf16 v[16:19], v[40:43], a[8:15], v1
    ds_read_b128 v[40:43], v6 offset:16384
    v_permlane32_swap_b32 v32, v33
    v_smfmac_f32_16x16x64_bf16 v[12:15], v[44:47], a[0:7], v1
    s_waitcnt lgkmcnt(2)
    s_barrier
    v_permlane32_swap_b32 v34, v35
    v_smfmac_f32_16x16x64_bf16 v[16:19], v[44:47], v[248:255], v1
    ds_read_b128 v[20:23], v3 offset:18432
    v_add_f32 v28, v28, v29
    v_add_f32 v30, v30, v31
    v_smfmac_f32_16x16x64_bf16 v[12:15], v[48:51], v[240:247], v1
    ds_read_b128 v[24:27], v3 offset:18496
    v_add_f32 v32, v32, v33
    v_add_f32 v34, v34, v35
    v_smfmac_f32_16x16x64_bf16 v[16:19], v[48:51], v[232:239], v1
    ds_read_b128 v[72:75], v3 offset:18560
    v_cvt_pk_bf16_f32 v28, v28, v32
    v_cvt_pk_bf16_f32 v29, v30, v34
    v_smfmac_f32_16x16x64_bf16 v[12:15], v[52:55], v[224:231], v1
    ds_write_b32 v2, v28 offset:20736
    ds_read_b128 v[44:47], v3 offset:18624
    v_smfmac_f32_16x16x64_bf16 v[16:19], v[52:55], v[216:223], v1
    ds_write_b32 v2, v29 offset:21312
    s_waitcnt lgkmcnt(7)
    v_smfmac_f32_16x16x64_bf16 v[12:15], v[36:39], v[208:215], v1
    ds_read_b128 v[48:51], v6 offset:17408
    v_mov_b64 v[10:11], s[16:17]
    v_smfmac_f32_16x16x64_bf16 v[16:19], v[36:39], v[200:207], v1
    s_waitcnt lgkmcnt(6)
    v_mfma_f32_16x16x32_bf16 v[28:31], v[56:59], v[20:23], 0
    ds_read_b128 v[56:59], v0 offset:4096
    s_waitcnt lgkmcnt(6)
    v_mfma_f32_16x16x32_bf16 v[28:31], v[60:63], v[24:27], v[28:31]
    ds_read_b128 v[60:63], v0 offset:5120
    s_waitcnt lgkmcnt(3)
    s_barrier
    v_mfma_f32_16x16x32_bf16 v[28:31], v[64:67], v[72:75], v[28:31]
    ds_read_b128 v[64:67], v0 offset:6144
    v_mfma_f32_16x16x32_bf16 v[28:31], v[68:71], v[44:47], v[28:31]
    ds_read_b128 v[68:71], v0 offset:7168
    v_smfmac_f32_16x16x64_bf16 v[12:15], v[40:43], v[192:199], v1
    ds_read_b128 v[36:39], v3 offset:20736
    v_smfmac_f32_16x16x64_bf16 v[16:19], v[40:43], v[184:191], v1
    ds_read_b128 v[52:55], v3 offset:20800
    s_waitcnt lgkmcnt(4)
    v_mfma_f32_16x16x32_bf16 v[32:35], v[56:59], v[20:23], 0
    s_nop 0
    v_exp_f32 v28, v28
    ds_read_b128 v[56:59], v3 offset:20864
    v_mfma_f32_16x16x32_bf16 v[32:35], v[60:63], v[24:27], v[32:35]
    s_waitcnt lgkmcnt(3)
    v_exp_f32 v29, v29
    ds_read_b128 v[60:63], v3 offset:20928
    v_mfma_f32_16x16x32_bf16 v[32:35], v[64:67], v[72:75], v[32:35]
    v_exp_f32 v30, v30
    v_mfma_f32_16x16x32_bf16 v[32:35], v[68:71], v[44:47], v[32:35]
    s_waitcnt lgkmcnt(3)
    v_exp_f32 v31, v31
    v_mfma_f32_16x16x32_bf16 v[40:43], v[36:39], v[20:23], 0
    s_waitcnt lgkmcnt(2)
    v_cvt_pk_bf16_f32 v28, v28, v29
    v_cvt_pk_bf16_f32 v29, v30, v31
    v_mfma_f32_16x16x32_bf16 v[40:43], v[52:55], v[24:27], v[40:43]
    s_waitcnt lgkmcnt(1)
    v_mov_b64 v[64:65], s[24:25]
    v_mov_b64 v[66:67], s[24:25]
    v_mfma_f32_16x16x32_bf16 v[40:43], v[56:59], v[72:75], v[40:43]
    s_waitcnt lgkmcnt(0)
    v_exp_f32 v32, v32
    v_mfma_f32_16x16x32_bf16 v[40:43], v[60:63], v[44:47], v[40:43]
    v_exp_f32 v33, v33
    v_smfmac_f32_16x16x64_bf16 v[12:15], v[48:51], v[176:183], v1
    v_exp_f32 v34, v34
    v_smfmac_f32_16x16x64_bf16 v[16:19], v[48:51], v[168:175], v1
    v_exp_f32 v35, v35
    v_cvt_pk_bf16_f32 v30, v32, v33
    v_cvt_pk_bf16_f32 v31, v34, v35
    s_nop 0
    v_exp_f32 v40, v40
    v_mfma_f32_16x16x32_bf16 v[72:75], v[64:67], v[28:31], 0
    v_exp_f32 v41, v41
    v_mfma_f32_16x16x32_bf16 v[20:23], v[80:83], v[28:31], 0
    v_exp_f32 v42, v42
    v_mfma_f32_16x16x32_bf16 v[24:27], v[84:87], v[28:31], 0
    v_exp_f32 v43, v43
    v_cvt_pk_bf16_f32 v40, v40, v41
    v_cvt_pk_bf16_f32 v41, v42, v43
    v_cvt_pk_bf16_f32 v12, v12, v13
    v_cvt_pk_bf16_f32 v13, v14, v15
    v_mfma_f32_16x16x16_bf16 v[72:75], v[10:11], v[40:41], v[72:75]
    v_cvt_pk_bf16_f32 v14, v16, v17
    v_cvt_pk_bf16_f32 v15, v18, v19
M_c0_1_fin:
    v_mfma_f32_16x16x16_bf16 v[20:23], v[12:13], v[40:41], v[20:23]
    s_cmp_eq_u32 s57, 63
    v_cndmask_b32_e64 v76, v12, v52, s[66:67]
    v_cndmask_b32_e64 v77, v13, v53, s[66:67]
    v_mfma_f32_16x16x16_bf16 v[24:27], v[14:15], v[40:41], v[24:27]
    v_cndmask_b32_e64 v78, v14, v54, s[66:67]
    v_cndmask_b32_e64 v79, v15, v55, s[66:67]
    s_cbranch_scc1 M_c0_1_last
    v_rcp_f32 v74, v72
    v_subrev_u32 v73, s68, v72
    v_cmp_lt_u32 vcc, s69, v73
    v_mov_b64 v[44:45], 0
    v_mov_b64 v[46:47], 0
    v_cndmask_b32_e64 v20, v20, v24, s[18:19]
    v_cndmask_b32_e64 v21, v21, v25, s[18:19]
    v_cndmask_b32_e64 v22, v22, v26, s[18:19]
    v_cndmask_b32_e64 v23, v23, v27, s[18:19]
    v_pk_mul_f32 v[20:21], v[20:21], v[74:75] op_sel_hi:[1,0]
    v_pk_mul_f32 v[22:23], v[22:23], v[74:75] op_sel_hi:[1,0]
    v_cvt_pk_bf16_f32 v20, v20, v21
    v_cvt_pk_bf16_f32 v21, v22, v23
    ds_write_b64 v0, v[20:21] offset:13320
    s_cbranch_vccnz M_c0_1_zbad
M_c0_1_zok:
    s_cmp_lt_u32 s54, s42
    s_cbranch_scc1 M_c0_1_first2
M_c0_1_first2_r:
    buffer_load_dwordx4 v[80:83], v0, s[8:11], s3 offen offset:0 sc1
    buffer_load_dwordx4 v[84:87], v0, s[8:11], s3 offen offset:1024 sc1
    s_waitcnt lgkmcnt(0)
    s_barrier
    ds_read_b128 v[32:35], v0 offset:13312
    ds_read_b128 v[52:55], v0 offset:14336
    s_mov_b32 m0, 2048
    s_nop 0
    buffer_load_dwordx4 v0, s[8:11], s26 offen offset:0 sc1 lds
    buffer_load_dwordx4 v0, s[8:11], s26 offen offset:1024 sc1 lds
    v_mov_b64 v[68:69], 0
    v_mov_b64 v[70:71], 0
    v_mov_b64 v[64:65], 0
    v_mov_b64 v[66:67], 0
    v_mov_b64 v[60:61], 0
    v_mov_b64 v[62:63], 0
    v_mov_b64 v[56:57], 0
    v_mov_b64 v[58:59], 0
    s_waitcnt lgkmcnt(1)
    s_nop 0
    v_smfmac_f32_16x16x64_bf16 v[56:59], v[32:35], v[160:167], v1
    v_smfmac_f32_16x16x64_bf16 v[60:63], v[32:35], v[144:151], v1
    s_waitcnt lgkmcnt(0)
    v_smfmac_f32_16x16x64_bf16 v[56:59], v[52:55], v[152:159], v1
    v_smfmac_f32_16x16x64_bf16 v[60:63], v[52:55], v[136:143], v1
    v_smfmac_f32_16x16x64_bf16 v[64:67], v[32:35], v[128:135], v1
    v_smfmac_f32_16x16x64_bf16 v[68:71], v[32:35], v[112:119], v1
    v_permlane32_swap_b32 v56, v57
    v_smfmac_f32_16x16x64_bf16 v[64:67], v[52:55], v[120:127], v1
    v_permlane32_swap_b32 v58, v59
    v_smfmac_f32_16x16x64_bf16 v[68:71], v[52:55], v[104:111], v1
    v_add_f32 v56, v56, v57
    v_add_f32 v58, v58, v59
    v_smfmac_f32_16x16x64_bf16 v[44:47], v[32:35], v[96:103], v1
    v_permlane32_swap_b32 v60, v61
    v_smfmac_f32_16x16x64_bf16 v[44:47], v[52:55], v[88:95], v1
    v_permlane32_swap_b32 v62, v63
    v_add_f32 v60, v60, v61
    v_add_f32 v62, v62, v63
    v_cvt_pk_bf16_f32 v36, v56, v60
    v_cvt_pk_bf16_f32 v38, v58, v62
    v_permlane32_swap_b32 v64, v65
    v_permlane32_swap_b32 v66, v67
    v_add_f32 v64, v64, v65
    v_add_f32 v66, v66, v67
    v_permlane32_swap_b32 v68, v69
    v_permlane32_swap_b32 v70, v71
    v_add_f32 v68, v68, v69
    v_add_f32 v70, v70, v71
    v_cvt_pk_bf16_f32 v37, v64, v68
    v_cvt_pk_bf16_f32 v39, v66, v70
    buffer_store_dwordx4 v[36:39], v0, s[8:11], s58 offen
    v_permlane32_swap_b32 v44, v45
    v_permlane32_swap_b32 v46, v47
    v_add_f32 v44, v44, v45
    v_add_f32 v46, v46, v47
    v_cvt_pk_bf16_f32 v44, v44, v46
    buffer_store_dword v44, v7, s[8:11], s55 offen
    v_bfe_u32 v34, v0, 4, 1
    v_bfe_u32 v33, v0, 7, 1
    v_lshl_add_u32 v33, v33, 1, v34
    v_bfe_u32 v32, v0, 6, 1
    v_lshlrev_b32 v32, 4, v32
    v_lshlrev_b32_e64 v32, v32, s45
    v_cmp_eq_u32_e64 s[64:65], 0, v33
    v_cmp_eq_u32_e64 vcc, 1, v33
    s_add_u32 s27, s44, 1
    s_and_b32 s27, s27, 3
    v_cndmask_b32_e64 v72, 0, v32, s[64:65]
    v_cndmask_b32_e64 v73, 0, v32, vcc
    v_cmp_eq_u32_e64 s[64:65], 2, v33
    v_cmp_eq_u32_e64 vcc, 3, v33
    s_mul_i32 s48, s27, 5120
    s_add_u32 s48, s48, s41
    v_cndmask_b32_e64 v74, 0, v32, s[64:65]
    v_cndmask_b32_e64 v75, 0, v32, vcc
    s_lshl_b32 s27, s27, 15
    s_add_u32 s49, s27, s47
    v_bfe_u32 v32, v0, 8, 1
    v_lshlrev_b32 v11, 6, v32
    v_lshl_add_u32 v11, v34, 3, v11
    v_lshrrev_b32 v33, 9, v0
    v_lshl_add_u32 v11, v33, 2, v11
    s_add_u32 s56, s27, s46
    s_add_u32 s56, s56, s33
    s_add_u32 s58, s48, s33
    s_nop 15
    s_nop 15
    buffer_load_dwordx4 v[12:15], v0, s[8:11], s43 offen sc1
    s_nop 15
    s_nop 15
    s_nop 9
    buffer_load_dwordx4 v[16:19], v0, s[8:11], s43 offen sc1
    s_nop 7
    s_waitcnt vmcnt(1)
    v_mfma_f32_16x16x32_bf16 v[28:31], v[72:75], v[12:15], 0
    v_cmp_eq_u32 vcc, -1, v12
    s_cbranch_vccnz M_c0_1_wq1
    v_mov_b32 v5, v5
    v_mov_b32 v5, v5
    v_mov_b32 v5, v5
    v_mov_b32 v5, v5
    v_mov_b32 v5, v5
    v_mov_b32 v5, v5
    v_add_f32_dpp v28, v28, v28 row_ror:8 row_mask:0xf bank_mask:0xf
    v_add_f32_dpp v29, v29, v29 row_ror:8 row_mask:0xf bank_mask:0xf
    s_nop 0
    v_add_f32_dpp v28, v28, v28 row_ror:4 row_mask:0xf bank_mask:0xf
    v_add_f32_dpp v29, v29, v29 row_ror:4 row_mask:0xf bank_mask:0xf
    s_nop 0
    v_add_f32_dpp v28, v28, v28 row_ror:2 row_mask:0xf bank_mask:0xf
    v_add_f32_dpp v29, v29, v29 row_ror:2 row_mask:0xf bank_mask:0xf
    v_cmp_u_f32 vcc, v28, v28
    v_cvt_pk_bf16_f32 v28, v28, v29
    s_cbranch_vccnz M_c0_1_wrb_e0
    s_mov_b64 exec, s[62:63]
    buffer_store_dword v28, v11, s[8:11], s58 offen
M_c0_1_wrb_d:
    s_barrier
    buffer_store_dword v28, v11, s[8:11], s56 offen sc1
M_c0_1_wrb_g:
    s_mov_b64 exec, -1
    s_waitcnt vmcnt(2)
    ds_read_b128 v[56:59], v5 offset:0
    ds_read_b128 v[60:63], v5 offset:1024
    ds_read_b128 v[64:67], v5 offset:2048
    ds_read_b128 v[68:71], v5 offset:3072
    v_mov_b64 v[12:13], 0
    v_mov_b64 v[14:15], 0
    v_mov_b64 v[16:17], 0
    v_mov_b64 v[18:19], 0
    v_mov_b64 v[20:21], 0
    v_mov_b64 v[22:23], 0
    v_mov_b64 v[24:25], 0
    v_mov_b64 v[26:27], 0
    v_mov_b64 v[28:29], 0
    v_mov_b64 v[30:31], 0
    v_mov_b64 v[32:33], 0
    v_mov_b64 v[34:35], 0
    ds_read_b64 v[36:37], v0 offset:23296
    s_waitcnt lgkmcnt(0)
    v_min_u32 v36, v36, v37
    s_nop 0
    v_readfirstlane_b32 s28, v36
    s_nop 0
    s_max_u32 s54, s54, s28
    s_and_b32 s26, s44, 63
    s_add_u32 s26, s26, 2
    s_min_u32 s26, s26, 63
    s_lshl_b32 s26, s26, 18
    s_add_u32 s26, s26, s50
    s_add_u32 s26, s26, 2048
    s_add_u32 s3, s26, 16777216
    s_lshl_b32 s4, s44, 18
    s_add_u32 s4, s4, s53
    v_mov_b64 v[72:73], -1
    v_mov_b64 v[74:75], -1
    s_add_u32 s28, s44, 3
    s_and_b32 s29, s28, 3
    s_mul_i32 s31, s22, 160
    s_mul_i32 s28, s29, 167936
    s_add_u32 s28, s28, s34
    s_add_u32 s64, s28, s35
    s_lshl_b32 s65, s22, 10
    s_add_u32 s65, s65, s28
    s_add_u32 s65, s65, 135168
    s_add_u32 s44, s44, 1
    s_and_b32 s55, s44, 3
    s_mul_i32 s55, s55, 167936
    s_add_u32 s55, s55, s34
    s_add_u32 s58, s55, s35
    s_and_b32 s57, s44, 63
    s_add_u32 s43, s55, s32
    s_sub_u32 s27, s57, 1
    s_max_i32 s27, s27, 0
    s_lshl_b64 s[100:101], 1, s27
    s_lshl_b32 s27, s27, 7
    s_sub_u32 s61, s52, s27
    s_add_u32 s42, s44, 2
    s_or_b32 s28, s44, 63
    s_add_u32 s28, s28, 1
    s_min_u32 s42, s42, s28
    s_nop 15
    s_nop 15
    s_nop 1
    buffer_store_dwordx4 v[72:75], v0, s[8:11], s64 offen offset:1024
    buffer_store_dwordx4 v[72:75], v0, s[8:11], s64 offen offset:2048
    buffer_store_dwordx4 v[72:75], v0, s[8:11], s65 offen
    s_mov_b32 s65, 0x10000000
    s_mov_b32 s64, 0x10000000
    s_mov_b32 s70, 0
    s_branch M_c0_1_top
M_c0_1_restart:
    s_waitcnt vmcnt(0) lgkmcnt(0)
    s_nop 7
    s_barrier
    ds_read_b128 v[56:59], v5 offset:0
    ds_read_b128 v[60:63], v5 offset:1024
    ds_read_b128 v[64:67], v5 offset:2048
    ds_read_b128 v[68:71], v5 offset:3072
    v_mov_b64 v[12:13], 0
    v_mov_b64 v[14:15], 0
    v_mov_b64 v[16:17], 0
    v_mov_b64 v[18:19], 0
    v_mov_b64 v[20:21], 0
    v_mov_b64 v[22:23], 0
    v_mov_b64 v[24:25], 0
    v_mov_b64 v[26:27], 0
    v_mov_b64 v[28:29], 0
    v_mov_b64 v[30:31], 0
    v_mov_b64 v[32:33], 0
    v_mov_b64 v[34:35], 0
    s_waitcnt vmcnt(0) lgkmcnt(0)
    s_branch M_c0_1_top
M_c0_1_zbad:
    s_cmp_eq_u32 s70, 2
    s_cbranch_scc1 M_c0_1_zok
    v_cmp_u_f32 vcc, v72, v72
    s_cbranch_vccz M_c0_1_exact
    s_cmp_eq_u32 s70, 1
    s_cbranch_scc1 M_c0_1_exact
M_c0_1_vfy0:
    s_mov_b32 s70, 1
    s_mov_b32 s30, 0
    s_waitcnt vmcnt(0) lgkmcnt(0)
    s_nop 7
M_c0_1_vfy:
    v_mov_b32 v10, 0
    s_add_u32 s59, s48, 4096
    buffer_load_dwordx4 v[36:39], v0, s[8:11], s48 offen offset:0 sc1
    buffer_load_dwordx4 v[40:43], v0, s[8:11], s48 offen offset:1024 sc1
    buffer_load_dwordx4 v[44:47], v0, s[8:11], s48 offen offset:2048 sc1
    buffer_load_dwordx4 v[48:51], v0, s[8:11], s48 offen offset:3072 sc1
    buffer_load_dwordx4 v[52:55], v0, s[8:11], s59 offen offset:0 sc1
    s_waitcnt vmcnt(4)
    v_max3_u32 v10, v10, v36, v37
    v_max3_u32 v10, v10, v38, v39
    s_waitcnt vmcnt(3)
    v_max3_u32 v10, v10, v40, v41
    v_max3_u32 v10, v10, v42, v43
    s_waitcnt vmcnt(2)
    v_max3_u32 v10, v10, v44, v45
    v_max3_u32 v10, v10, v46, v47
    s_waitcnt vmcnt(1)
    v_max3_u32 v10, v10, v48, v49
    v_max3_u32 v10, v10, v50, v51
    s_waitcnt vmcnt(0)
    v_max3_u32 v10, v10, v52, v53
    v_max3_u32 v10, v10, v54, v55
    s_add_u32 s59, s49, 4096
    buffer_load_dwordx4 v[36:39], v0, s[8:11], s49 offen offset:0 sc1
    buffer_load_dwordx4 v[40:43], v0, s[8:11], s49 offen offset:1024 sc1
    buffer_load_dwordx4 v[44:47], v0, s[8:11], s49 offen offset:2048 sc1
    buffer_load_dwordx4 v[48:51], v0, s[8:11], s49 offen offset:3072 sc1
    buffer_load_dwordx4 v[52:55], v0, s[8:11], s59 offen offset:0 sc1
    s_waitcnt vmcnt(4)
    v_max3_u32 v10, v10, v36, v37
    v_max3_u32 v10, v10, v38, v39
    s_waitcnt vmcnt(3)
    v_max3_u32 v10, v10, v40, v41
    v_max3_u32 v10, v10, v42, v43
    s_waitcnt vmcnt(2)
    v_max3_u32 v10, v10, v44, v45
    v_max3_u32 v10, v10, v46, v47
    s_waitcnt vmcnt(1)
    v_max3_u32 v10, v10, v48, v49
    v_max3_u32 v10, v10, v50, v51
    s_waitcnt vmcnt(0)
    v_max3_u32 v10, v10, v52, v53
    v_max3_u32 v10, v10, v54, v55
    v_cmp_eq_u32 vcc, -1, v10
    s_cbranch_vccz M_c0_1_restart
    s_add_u32 s30, s30, 1
    s_cmp_ge_u32 s30, 60000
    s_cbranch_scc1 M_fail
    s_branch M_c0_1_vfy
M_c0_1_exact:
    s_nop 7
    s_mov_b32 s70, 2
    s_waitcnt lgkmcnt(0)
    ds_read_b128 v[20:23], v3 offset:18432
    ds_read_b128 v[24:27], v3 offset:18496
    ds_read_b128 v[72:75], v3 offset:18560
    ds_read_b128 v[44:47], v3 offset:18624
    ds_read_b128 v[56:59], v0 offset:0
    s_waitcnt lgkmcnt(0)
    v_mfma_f32_16x16x32_bf16 v[28:31], v[56:59], v[20:23], 0
    s_nop 3
    ds_read_b128 v[60:63], v0 offset:1024
    s_waitcnt lgkmcnt(0)
    v_mfma_f32_16x16x32_bf16 v[28:31], v[60:63], v[24:27], v[28:31]
    s_nop 3
    ds_read_b128 v[56:59], v0 offset:2048
    s_waitcnt lgkmcnt(0)
    v_mfma_f32_16x16x32_bf16 v[28:31], v[56:59], v[72:75], v[28:31]
    s_nop 3
    ds_read_b128 v[60:63], v0 offset:3072
    s_waitcnt lgkmcnt(0)
    v_mfma_f32_16x16x32_bf16 v[28:31], v[60:63], v[44:47], v[28:31]
    s_nop 3
    ds_read_b128 v[56:59], v0 offset:4096
    s_waitcnt lgkmcnt(0)
    v_mfma_f32_16x16x32_bf16 v[32:35], v[56:59], v[20:23], 0
    s_nop 3
    ds_read_b128 v[60:63], v0 offset:5120
    s_waitcnt lgkmcnt(0)
    v_mfma_f32_16x16x32_bf16 v[32:35], v[60:63], v[24:27], v[32:35]
    s_nop 3
    ds_read_b128 v[56:59], v0 offset:6144
    s_waitcnt lgkmcnt(0)
    v_mfma_f32_16x16x32_bf16 v[32:35], v[56:59], v[72:75], v[32:35]
    s_nop 3
    ds_read_b128 v[60:63], v0 offset:7168
    s_waitcnt lgkmcnt(0)
    v_mfma_f32_16x16x32_bf16 v[32:35], v[60:63], v[44:47], v[32:35]
    s_nop 3
    ds_read_b128 v[56:59], v3 offset:20736
    s_waitcnt lgkmcnt(0)
    v_mfma_f32_16x16x32_bf16 v[40:43], v[56:59], v[20:23], 0
    s_nop 3
    ds_read_b128 v[60:63], v3 offset:20800
    s_waitcnt lgkmcnt(0)
    v_mfma_f32_16x16x32_bf16 v[40:43], v[60:63], v[24:27], v[40:43]
    s_nop 3
    ds_read_b128 v[56:59], v3 offset:20864
    s_waitcnt lgkmcnt(0)
    v_mfma_f32_16x16x32_bf16 v[40:43], v[56:59], v[72:75], v[40:43]
    s_nop 3
    ds_read_b128 v[60:63], v3 offset:20928
    s_waitcnt lgkmcnt(0)
    v_mfma_f32_16x16x32_bf16 v[40:43], v[60:63], v[44:47], v[40:43]
    s_nop 3
    v_max3_f32 v68, v28, v29, v30
    v_max3_f32 v68, v68, v31, v32
    v_max3_f32 v68, v68, v33, v34
    s_nop 0
    v_max3_f32 v68, v68, v35, v40
    v_max3_f32 v68, v68, v41, v42
    v_max_f32 v68, v68, v43
    v_mov_b32 v69, v68
    s_nop 1
    v_permlane16_swap_b32 v68, v69
    v_max_f32 v68, v68, v69
    v_mov_b32 v69, v68
    s_nop 1
    v_permlane32_swap_b32 v68, v69
    v_max_f32 v68, v68, v69
    v_sub_f32 v28, v28, v68
    v_exp_f32 v28, v28
    v_sub_f32 v29, v29, v68
    v_exp_f32 v29, v29
    v_sub_f32 v30, v30, v68
    v_exp_f32 v30, v30
    v_sub_f32 v31, v31, v68
    v_exp_f32 v31, v31
    v_sub_f32 v32, v32, v68
    v_exp_f32 v32, v32
    v_sub_f32 v33, v33, v68
    v_exp_f32 v33, v33
    v_sub_f32 v34, v34, v68
    v_exp_f32 v34, v34
    v_sub_f32 v35, v35, v68
    v_exp_f32 v35, v35
    v_sub_f32 v40, v40, v68
    v_exp_f32 v40, v40
    v_sub_f32 v41, v41, v68
    v_exp_f32 v41, v41
    v_sub_f32 v42, v42, v68
    v_exp_f32 v42, v42
    v_sub_f32 v43, v43, v68
    v_exp_f32 v43, v43
    v_cvt_pk_bf16_f32 v28, v28, v29
    v_cvt_pk_bf16_f32 v29, v30, v31
    v_cvt_pk_bf16_f32 v30, v32, v33
    v_cvt_pk_bf16_f32 v31, v34, v35
    v_cvt_pk_bf16_f32 v40, v40, v41
    v_cvt_pk_bf16_f32 v41, v42, v43
    v_mfma_f32_16x16x32_bf16 v[20:23], v[80:83], v[28:31], 0
    v_mfma_f32_16x16x32_bf16 v[24:27], v[84:87], v[28:31], 0
    v_mfma_f32_16x16x32_bf16 v[72:75], v[64:67], v[28:31], 0
    ds_read_b128 v[52:55], v3 offset:20800
    s_waitcnt lgkmcnt(0)
    s_nop 7
    v_mfma_f32_16x16x16_bf16 v[72:75], v[10:11], v[40:41], v[72:75]
    s_nop 7
    s_branch M_c0_1_fin
M_c0_1_last:
    s_cmp_lg_u32 s70, 0
    s_cbranch_scc1 M_c0_1_last2
    v_cmp_u_f32 vcc, v32, v32
    s_cbranch_vccnz M_c0_1_vfy0
M_c0_1_last2:
    s_lshl_b32 s4, s44, 18
    s_add_u32 s4, s4, s53
    buffer_store_dwordx4 v[76:79], v0, s[8:11], s4 offen offset:1024 sc1
    s_mov_b32 s4, 0x10000000
    s_waitcnt vmcnt(0) lgkmcnt(0)
    s_barrier
    v_mov_b32 v11, 8192
    s_mov_b64 exec, 1
    buffer_store_dword v11, v0, s[8:11], s52 offen sc1
    s_mov_b64 exec, -1
    s_add_u32 s52, s52, 4096
    s_nop 7
    v_mov_b64 v[72:73], -1
    v_mov_b64 v[74:75], -1
    s_add_u32 s28, s44, 3
    s_and_b32 s29, s28, 3
    s_mul_i32 s31, s22, 160
    s_mul_i32 s28, s29, 167936
    s_add_u32 s28, s28, s34
    s_add_u32 s64, s28, s35
    s_lshl_b32 s65, s22, 10
    s_add_u32 s65, s65, s28
    s_add_u32 s65, s65, 135168
    buffer_store_dwordx4 v[72:75], v0, s[8:11], s64 offen offset:1024
    buffer_store_dwordx4 v[72:75], v0, s[8:11], s64 offen offset:2048
    buffer_store_dwordx4 v[72:75], v0, s[8:11], s65 offen
    s_mov_b32 s65, 0x10000000
    s_mov_b32 s64, 0x10000000
    s_waitcnt vmcnt(0)
    s_add_u32 s44, s44, 1
    s_cmp_eq_u32 s44, 128
    s_cbranch_scc1 M_end
    s_branch M_c0_1_layer
M_c0_1_lr:
    s_mov_b32 s30, 0
M_c0_1_lr_l:
    s_waitcnt lgkmcnt(0)
    ds_read_b128 v[36:39], v6 offset:13312
    ds_read_b128 v[40:43], v6 offset:14336
    ds_read_b128 v[44:47], v6 offset:15360
    ds_read_b128 v[48:51], v6 offset:16384
    ds_read_b128 v[52:55], v6 offset:17408
    s_waitcnt lgkmcnt(2)
    v_max3_u32 v10, v36, v40, v44
    s_waitcnt lgkmcnt(0)
    v_max3_u32 v10, v10, v48, v52
    v_cmp_eq_u32 vcc, -1, v10
    s_cbranch_vccz M_c0_1_lr_d
    s_add_u32 s30, s30, 1
    s_cmp_ge_u32 s30, 480000
    s_cbranch_scc1 M_fail
    s_branch M_c0_1_lr_l
M_c0_1_lr_d:
    ds_read_b128 v[56:59], v5 offset:0
    ds_read_b128 v[60:63], v5 offset:1024
    ds_read_b128 v[64:67], v5 offset:2048
    ds_read_b128 v[68:71], v5 offset:3072
    v_mov_b64 v[12:13], 0
    v_mov_b64 v[14:15], 0
    v_mov_b64 v[16:17], 0
    v_mov_b64 v[18:19], 0
    v_mov_b64 v[20:21], 0
    v_mov_b64 v[22:23], 0
    v_mov_b64 v[24:25], 0
    v_mov_b64 v[26:27], 0
    v_mov_b64 v[28:29], 0
    v_mov_b64 v[30:31], 0
    v_mov_b64 v[32:33], 0
    v_mov_b64 v[34:35], 0
    s_waitcnt lgkmcnt(0)
    s_branch M_c0_1_lr_r
M_c0_1_rr:
    s_mov_b32 s30, 0
M_c0_1_rr_l:
    s_waitcnt lgkmcnt(0)
    s_and_b32 s27, s30, 1
    s_cbranch_scc1 M_c0_1_rr_n
    s_waitcnt vmcnt(1)
    s_mov_b32 m0, 8192
    s_nop 0
    buffer_load_dwordx4 v0, s[8:11], s49 offen offset:2048 sc1 lds
M_c0_1_rr_n:
    ds_read_b128 v[36:39], v6 offset:8192
    ds_read_b128 v[40:43], v6 offset:9216
    ds_read_b128 v[44:47], v6 offset:10240
    ds_read_b128 v[48:51], v6 offset:11264
    ds_read_b32 v11, v6 offset:12288
    s_waitcnt lgkmcnt(2)
    v_max3_u32 v10, v36, v40, v44
    s_waitcnt lgkmcnt(0)
    v_max3_u32 v10, v10, v48, v11
    v_cmp_eq_u32 vcc, -1, v10
    s_cbranch_vccz M_c0_1_rr_d
    s_add_u32 s30, s30, 1
    s_cmp_ge_u32 s30, 480000
    s_cbranch_scc1 M_fail
    s_branch M_c0_1_rr_l
M_c0_1_rr_d:
    s_branch M_c0_1_rr_r
M_c0_1_first:
    s_mul_i32 s27, s21, 167936
    s_add_u32 s27, s27, s34
    s_mul_i32 s28, s22, 4224
    s_add_u32 s28, s28, s27
    s_mov_b32 exec_hi, 0
    buffer_load_dword v10, v9, s[8:11], s28 offen sc1
    s_lshl_b32 s28, s22, 10
    s_add_u32 s28, s28, s27
    s_add_u32 s28, s28, 135168
    s_mov_b64 exec, 0xff
    buffer_load_dword v10, v9, s[8:11], s28 offen sc1
    s_mul_i32 s27, s21, 5120
    s_add_u32 s27, s27, s41
    s_mul_i32 s28, s22, 160
    s_add_u32 s28, s28, s27
    s_mov_b64 exec, 3
    buffer_load_dword v10, v9, s[8:11], s28 offen sc1
    s_mov_b64 exec, -1
    s_barrier
    s_and_b32 s26, s44, 63
    s_lshl_b32 s26, s26, 18
    s_add_u32 s26, s26, s50
    s_add_u32 s26, s26, 2048
    s_add_u32 s3, s26, 16777216
    s_mov_b32 m0, 2048
    s_nop 0
    buffer_load_dwordx4 v0, s[8:11], s26 offen offset:0 sc1 lds
    buffer_load_dwordx4 v0, s[8:11], s26 offen offset:1024 sc1 lds
    buffer_load_dwordx4 v[80:83], v0, s[8:11], s3 offen offset:0 sc1
    buffer_load_dwordx4 v[84:87], v0, s[8:11], s3 offen offset:1024 sc1
    s_and_b32 s26, s44, 63
    s_add_u32 s26, s26, 1
    s_min_u32 s26, s26, 63
    s_lshl_b32 s26, s26, 18
    s_add_u32 s26, s26, s50
    s_add_u32 s26, s26, 2048
    s_add_u32 s3, s26, 16777216
    s_waitcnt vmcnt(0) lgkmcnt(0)
    s_barrier
    s_branch M_c0_1_first_r
M_c0_1_first2:
    ds_read_b64 v[10:11], v0 offset:23296
    s_waitcnt lgkmcnt(0)
    v_min_u32 v10, v10, v11
    s_nop 0
    v_readfirstlane_b32 s28, v10
    s_nop 0
    s_max_u32 s54, s54, s28
    s_add_u32 s27, s44, 2
    s_or_b32 s28, s44, 63
    s_add_u32 s28, s28, 1
    s_min_u32 s27, s27, s28
    s_cmp_lt_u32 s54, s27
    s_cbranch_scc1 M_c0_1_p2
M_c0_1_p2_r:
    s_branch M_c0_1_first2_r
M_c0_1_wq1:
    buffer_load_dwordx4 v[12:15], v0, s[8:11], s43 offen sc1
    s_waitcnt vmcnt(1)
    v_mfma_f32_16x16x32_bf16 v[28:31], v[72:75], v[16:19], 0
    v_cmp_eq_u32 vcc, -1, v16
    s_cbranch_vccnz M_c0_1_wqx
    v_mov_b32 v5, v5
    v_mov_b32 v5, v5
    v_mov_b32 v5, v5
    v_mov_b32 v5, v5
    v_mov_b32 v5, v5
    v_mov_b32 v5, v5
    v_add_f32_dpp v28, v28, v28 row_ror:8 row_mask:0xf bank_mask:0xf
    v_add_f32_dpp v29, v29, v29 row_ror:8 row_mask:0xf bank_mask:0xf
    s_nop 0
    v_add_f32_dpp v28, v28, v28 row_ror:4 row_mask:0xf bank_mask:0xf
    v_add_f32_dpp v29, v29, v29 row_ror:4 row_mask:0xf bank_mask:0xf
    s_nop 0
    v_add_f32_dpp v28, v28, v28 row_ror:2 row_mask:0xf bank_mask:0xf
    v_add_f32_dpp v29, v29, v29 row_ror:2 row_mask:0xf bank_mask:0xf
    v_cmp_u_f32 vcc, v28, v28
    v_cvt_pk_bf16_f32 v28, v28, v29
    s_cbranch_vccnz M_c0_1_wqe1
    s_mov_b64 exec, s[62:63]
    buffer_store_dword v28, v11, s[8:11], s58 offen
    s_barrier
    buffer_store_dword v28, v11, s[8:11], s56 offen sc1
    s_branch M_c0_1_wrb_g
M_c0_1_wqx:
    s_branch M_c0_1_wrb_i1
M_c0_1_wqe1:
    s_waitcnt vmcnt(0)
    buffer_load_dwordx4 v[12:15], v0, s[8:11], s43 offen sc1
    s_branch M_c0_1_wrb_e1
M_c0_1_wrb_l:
    s_waitcnt vmcnt(1)
    v_mfma_f32_16x16x32_bf16 v[28:31], v[72:75], v[12:15], 0
    v_cmp_eq_u32 vcc, -1, v12
    s_cbranch_vccz M_c0_1_wrb_x0
M_c0_1_wrb_i0:
    buffer_load_dwordx4 v[12:15], v0, s[8:11], s43 offen sc1
    s_waitcnt vmcnt(1)
    v_mfma_f32_16x16x32_bf16 v[28:31], v[72:75], v[16:19], 0
    v_cmp_eq_u32 vcc, -1, v16
    s_cbranch_vccz M_c0_1_wrb_x1
M_c0_1_wrb_i1:
    buffer_load_dwordx4 v[16:19], v0, s[8:11], s43 offen sc1
    s_add_u32 s71, s71, 1
    s_cmp_lt_u32 s71, 240000
    s_cbranch_scc1 M_c0_1_wrb_l
    s_branch M_fail
M_c0_1_wrb_x0:
    s_nop 5
    v_add_f32_dpp v28, v28, v28 row_ror:8 row_mask:0xf bank_mask:0xf
    v_add_f32_dpp v29, v29, v29 row_ror:8 row_mask:0xf bank_mask:0xf
    s_nop 0
    v_add_f32_dpp v28, v28, v28 row_ror:4 row_mask:0xf bank_mask:0xf
    v_add_f32_dpp v29, v29, v29 row_ror:4 row_mask:0xf bank_mask:0xf
    s_nop 0
    v_add_f32_dpp v28, v28, v28 row_ror:2 row_mask:0xf bank_mask:0xf
    v_add_f32_dpp v29, v29, v29 row_ror:2 row_mask:0xf bank_mask:0xf
    v_cmp_u_f32 vcc, v28, v28
    v_cvt_pk_bf16_f32 v28, v28, v29
    s_cbranch_vccz M_c0_1_wrb_n
M_c0_1_wrb_e0:
    v_max3_u32 v32, v12, v13, v14
    v_max_u32 v32, v32, v15
    v_cmp_eq_u32 vcc, -1, v32
    s_cbranch_vccnz M_c0_1_wrb_i0
    v_min_u32 v28, -2, v28
    v_min_u32 v29, -2, v29
    s_branch M_c0_1_wrb_n
M_c0_1_wrb_x1:
    s_nop 5
    v_add_f32_dpp v28, v28, v28 row_ror:8 row_mask:0xf bank_mask:0xf
    v_add_f32_dpp v29, v29, v29 row_ror:8 row_mask:0xf bank_mask:0xf
    s_nop 0
    v_add_f32_dpp v28, v28, v28 row_ror:4 row_mask:0xf bank_mask:0xf
    v_add_f32_dpp v29, v29, v29 row_ror:4 row_mask:0xf bank_mask:0xf
    s_nop 0
    v_add_f32_dpp v28, v28, v28 row_ror:2 row_mask:0xf bank_mask:0xf
    v_add_f32_dpp v29, v29, v29 row_ror:2 row_mask:0xf bank_mask:0xf
    v_cmp_u_f32 vcc, v28, v28
    v_cvt_pk_bf16_f32 v28, v28, v29
    s_cbranch_vccz M_c0_1_wrb_n
M_c0_1_wrb_e1:
    v_max3_u32 v32, v16, v17, v18
    v_max_u32 v32, v32, v19
    v_cmp_eq_u32 vcc, -1, v32
    s_cbranch_vccnz M_c0_1_wrb_i1
    v_min_u32 v28, -2, v28
    v_min_u32 v29, -2, v29
M_c0_1_wrb_n:
    s_mov_b64 exec, s[62:63]
    buffer_store_dword v28, v11, s[8:11], s58 offen
    s_branch M_c0_1_wrb_d
M_c0_1_p2:
    s_mov_b32 s30, 0
M_c0_1_p2_l:
    s_waitcnt lgkmcnt(0)
    s_mov_b64 exec, 3
    buffer_load_dword v10, v9, s[8:11], s51 offen sc1
    s_waitcnt vmcnt(0)
    s_mov_b64 exec, -1
    v_readlane_b32 s54, v10, 0
    v_readlane_b32 s28, v10, 1
    s_nop 3
    s_min_u32 s54, s54, s28
    s_cmp_ge_u32 s54, s27
    s_cbranch_scc1 M_c0_1_p2_r
    s_sleep 2
    s_add_u32 s30, s30, 1
    s_cmp_ge_u32 s30, 240000
    s_cbranch_scc1 M_fail
    s_branch M_c0_1_p2_l
M_c0_2_layer:
    s_lshr_b32 s27, s44, 6
    s_mul_i32 s50, s27, 33554432
    s_lshl_b32 s27, s22, 13
    s_add_u32 s50, s50, s27
    s_add_u32 s50, s50, 37748736
    s_barrier
    s_mov_b32 s26, 0x10010000
    s_mov_b32 s3, s26
    s_mul_i32 s27, s20, 5120
    s_add_u32 s48, s27, 167772160
    s_sub_u32 s49, 167777280, s27
    s_mov_b32 m0, 13312
    s_nop 0
    buffer_load_dwordx4 v0, s[8:11], s48 offen offset:0 sc1 lds
    buffer_load_dwordx4 v0, s[8:11], s48 offen offset:1024 sc1 lds
    buffer_load_dwordx4 v0, s[8:11], s48 offen offset:2048 sc1 lds
    s_and_b32 s55, s44, 3
    s_mul_i32 s55, s55, 167936
    s_add_u32 s55, s55, s34
    s_add_u32 s58, s55, s35
    s_and_b32 s57, s44, 63
    s_add_u32 s42, s44, 2
    s_or_b32 s28, s44, 63
    s_add_u32 s28, s28, 1
    s_min_u32 s42, s42, s28
    s_sub_u32 s61, s3, 4096
    s_cmp_ge_u32 s54, s42
    s_cselect_b32 s61, s61, 0x10000000
    ds_read_b128 v[56:59], v5 offset:0
    ds_read_b128 v[60:63], v5 offset:1024
    ds_read_b128 v[64:67], v5 offset:2048
    ds_read_b128 v[68:71], v5 offset:3072
    v_mov_b64 v[12:13], 0
    v_mov_b64 v[14:15], 0
    v_mov_b64 v[16:17], 0
    v_mov_b64 v[18:19], 0
    v_mov_b64 v[20:21], 0
    v_mov_b64 v[22:23], 0
    v_mov_b64 v[24:25], 0
    v_mov_b64 v[26:27], 0
    v_mov_b64 v[28:29], 0
    v_mov_b64 v[30:31], 0
    v_mov_b64 v[32:33], 0
    v_mov_b64 v[34:35], 0
    s_mov_b32 s70, 0
    s_waitcnt vmcnt(0) lgkmcnt(0)
M_c0_2_top:
    s_waitcnt vmcnt(6)
    s_barrier
    ds_read_b128 v[36:39], v6 offset:13312
    ds_read_b128 v[40:43], v6 offset:14336
    s_mov_b32 m0, 8192
    s_nop 0
    buffer_load_dwordx4 v0, s[8:11], s49 offen offset:3072 sc1 lds
M_c0_2_lr_r:
    s_waitcnt lgkmcnt(1)
    v_smfmac_f32_16x16x64_bf16 v[20:23], v[36:39], v[56:63], v1
    ds_read_b128 v[56:59], v5 offset:4096
    v_smfmac_f32_16x16x64_bf16 v[24:27], v[36:39], v[64:71], v1
    ds_read_b128 v[60:63], v5 offset:5120
    v_smfmac_f32_16x16x64_bf16 v[28:31], v[36:39], a[248:255], v1
    ds_read_b128 v[64:67], v5 offset:6144
    v_smfmac_f32_16x16x64_bf16 v[32:35], v[36:39], a[240:247], v1
    ds_read_b128 v[68:71], v5 offset:7168
    v_smfmac_f32_16x16x64_bf16 v[12:15], v[36:39], a[232:239], v1
    ds_read_b128 v[44:47], v6 offset:15360
    s_waitcnt lgkmcnt(3)
    v_smfmac_f32_16x16x64_bf16 v[16:19], v[36:39], v[56:63], v1
    ds_read_b128 v[56:59], v5 offset:8192
    v_smfmac_f32_16x16x64_bf16 v[20:23], v[40:43], a[224:231], v1
    ds_read_b128 v[60:63], v5 offset:9216
    s_waitcnt lgkmcnt(3)
    v_smfmac_f32_16x16x64_bf16 v[24:27], v[40:43], v[64:71], v1
    ds_read_b128 v[64:67], v5 offset:10240
    v_smfmac_f32_16x16x64_bf16 v[28:31], v[40:43], a[216:223], v1
    ds_read_b128 v[68:71], v5 offset:11264
    v_smfmac_f32_16x16x64_bf16 v[32:35], v[40:43], a[208:215], v1
    ds_read_b128 v[48:51], v6 offset:16384
    s_waitcnt lgkmcnt(3)
    v_smfmac_f32_16x16x64_bf16 v[12:15], v[40:43], v[56:63], v1
    ds_read_b128 v[56:59], v5 offset:12288
    v_smfmac_f32_16x16x64_bf16 v[16:19], v[40:43], a[200:207], v1
    ds_read_b128 v[60:63], v5 offset:13312
    s_waitcnt lgkmcnt(3)
    v_smfmac_f32_16x16x64_bf16 v[20:23], v[44:47], v[64:71], v1
    ds_read_b128 v[64:67], v5 offset:14336
    v_smfmac_f32_16x16x64_bf16 v[24:27], v[44:47], a[192:199], v1
    ds_read_b128 v[68:71], v5 offset:15360
    v_smfmac_f32_16x16x64_bf16 v[28:31], v[44:47], a[184:191], v1
    ds_read_b128 v[52:55], v6 offset:17408
    s_waitcnt lgkmcnt(3)
    v_smfmac_f32_16x16x64_bf16 v[32:35], v[44:47], v[56:63], v1
    ds_read_b128 v[56:59], v5 offset:16384
    v_smfmac_f32_16x16x64_bf16 v[20:23], v[48:51], a[176:183], v1
    ds_read_b128 v[60:63], v5 offset:17408
    s_waitcnt lgkmcnt(3)
    v_max3_u32 v10, v36, v40, v44
    v_smfmac_f32_16x16x64_bf16 v[24:27], v[48:51], v[64:71], v1
    ds_read_b128 v[64:67], v5 offset:18432
    s_waitcnt lgkmcnt(3)
    v_max3_u32 v10, v10, v48, v52
    v_smfmac_f32_16x16x64_bf16 v[28:31], v[48:51], a[168:175], v1
    ds_read_b128 v[68:71], v5 offset:19456
    v_cmp_eq_u32 vcc, -1, v10
    v_smfmac_f32_16x16x64_bf16 v[32:35], v[48:51], a[160:167], v1
    s_cbranch_vccnz M_c0_2_lr
    s_waitcnt vmcnt(0)
    s_barrier
    ds_read_b128 v[36:39], v6 offset:8192
    ds_read_b128 v[40:43], v6 offset:9216
    s_waitcnt lgkmcnt(4)
    v_smfmac_f32_16x16x64_bf16 v[20:23], v[52:55], v[56:63], v1
    ds_read_b128 v[44:47], v6 offset:10240
    ds_read_b128 v[48:51], v6 offset:11264
    v_smfmac_f32_16x16x64_bf16 v[24:27], v[52:55], a[152:159], v1
    ds_read_b32 v11, v6 offset:12288
    ds_read_b128 v[56:59], v5 offset:20480
    s_waitcnt lgkmcnt(6)
    v_smfmac_f32_16x16x64_bf16 v[28:31], v[52:55], v[64:71], v1
    ds_read_b128 v[60:63], v5 offset:21504
    s_waitcnt lgkmcnt(4)
    v_max3_u32 v10, v36, v40, v44
    v_smfmac_f32_16x16x64_bf16 v[32:35], v[52:55], a[144:151], v1
    s_waitcnt lgkmcnt(2)
    v_max3_u32 v10, v10, v48, v11
    v_cmp_eq_u32 vcc, -1, v10
    s_cbranch_vccnz M_c0_2_rr
M_c0_2_rr_r:
    s_mov_b32 m0, 23040
    ds_read_b128 v[64:67], v5 offset:22528
    ds_read_b128 v[68:71], v5 offset:23552
    ds_read_b128 v[52:55], v6 offset:12288
    buffer_store_dwordx4 v[76:79], v0, s[8:11], s4 offen offset:2048 sc1
    s_mov_b32 s4, 0x10000000
    buffer_load_dword v9, s[8:11], s61 offen sc1 lds
    v_smfmac_f32_16x16x64_bf16 v[20:23], v[36:39], a[136:143], v1
    s_waitcnt lgkmcnt(3)
    v_smfmac_f32_16x16x64_bf16 v[24:27], v[36:39], v[56:63], v1
    ds_read_b128 v[56:59], v5 offset:24576
    v_smfmac_f32_16x16x64_bf16 v[20:23], v[40:43], a[128:135], v1
    ds_read_b128 v[60:63], v5 offset:25600
    s_waitcnt lgkmcnt(3)
    v_smfmac_f32_16x16x64_bf16 v[24:27], v[40:43], v[64:71], v1
    ds_read_b128 v[64:67], v5 offset:26624
    v_smfmac_f32_16x16x64_bf16 v[20:23], v[44:47], a[120:127], v1
    ds_read_b128 v[68:71], v5 offset:27648
    v_smfmac_f32_16x16x64_bf16 v[24:27], v[44:47], a[112:119], v1
    s_waitcnt lgkmcnt(2)
    v_smfmac_f32_16x16x64_bf16 v[20:23], v[48:51], v[56:63], v1
    ds_read_b128 v[56:59], v5 offset:28672
    v_smfmac_f32_16x16x64_bf16 v[24:27], v[48:51], a[104:111], v1
    ds_read_b128 v[60:63], v5 offset:29696
    s_waitcnt lgkmcnt(2)
    v_smfmac_f32_16x16x64_bf16 v[20:23], v[52:55], v[64:71], v1
    ds_read_b128 v[64:67], v5 offset:30720
    v_smfmac_f32_16x16x64_bf16 v[24:27], v[52:55], a[96:103], v1
    ds_read_b128 v[68:71], v5 offset:31744
    v_smfmac_f32_16x16x64_bf16 v[28:31], v[36:39], a[88:95], v1
    s_cmp_eq_u32 s57, 0
    s_cbranch_scc1 M_c0_2_first
M_c0_2_first_r:
    s_waitcnt lgkmcnt(2)
    v_smfmac_f32_16x16x64_bf16 v[32:35], v[36:39], v[56:63], v1
    ds_read_b128 v[56:59], v5 offset:32768
    v_permlane32_swap_b32 v20, v21
    v_smfmac_f32_16x16x64_bf16 v[28:31], v[40:43], a[80:87], v1
    ds_read_b128 v[60:63], v5 offset:33792
    s_waitcnt lgkmcnt(2)
    v_permlane32_swap_b32 v22, v23
    v_smfmac_f32_16x16x64_bf16 v[32:35], v[40:43], v[64:71], v1
    ds_read_b128 v[64:67], v0 offset:2048
    v_permlane32_swap_b32 v24, v25
    v_smfmac_f32_16x16x64_bf16 v[28:31], v[44:47], a[72:79], v1
    ds_read_b128 v[68:71], v0 offset:3072
    v_permlane32_swap_b32 v26, v27
    v_smfmac_f32_16x16x64_bf16 v[32:35], v[44:47], a[64:71], v1
    s_waitcnt lgkmcnt(2)
    v_add_f32 v20, v20, v21
    v_add_f32 v22, v22, v23
    v_smfmac_f32_16x16x64_bf16 v[28:31], v[48:51], v[56:63], v1
    ds_read_b128 v[56:59], v0 offset:0
    v_add_f32 v24, v24, v25
    v_add_f32 v26, v26, v27
    v_smfmac_f32_16x16x64_bf16 v[32:35], v[48:51], a[56:63], v1
    ds_read_b128 v[60:63], v0 offset:1024
    v_mul_f32 v20, s40, v20
    v_mul_f32 v24, s40, v24
    v_smfmac_f32_16x16x64_bf16 v[28:31], v[52:55], a[48:55], v1
    v_mul_f32 v22, s40, v22
    v_mul_f32 v26, s40, v26
    v_smfmac_f32_16x16x64_bf16 v[32:35], v[52:55], a[40:47], v1
    v_cvt_pk_bf16_f32 v20, v20, v24
    v_cvt_pk_bf16_f32 v21, v22, v26
    v_smfmac_f32_16x16x64_bf16 v[12:15], v[36:39], a[32:39], v1
    ds_write_b32 v2, v20 offset:18432
    v_smfmac_f32_16x16x64_bf16 v[16:19], v[36:39], a[24:31], v1
    ds_write_b32 v2, v21 offset:19008
    v_permlane32_swap_b32 v28, v29
    v_smfmac_f32_16x16x64_bf16 v[12:15], v[40:43], a[16:23], v1
    ds_read_b128 v[36:39], v6 offset:15360
    v_permlane32_swap_b32 v30, v31
    v_smfmac_f32_16x16x64_bf16 v[16:19], v[40:43], a[8:15], v1
    ds_read_b128 v[40:43], v6 offset:16384
    v_permlane32_swap_b32 v32, v33
    v_smfmac_f32_16x16x64_bf16 v[12:15], v[44:47], a[0:7], v1
    s_waitcnt lgkmcnt(2)
    s_barrier
    v_permlane32_swap_b32 v34, v35
    v_smfmac_f32_16x16x64_bf16 v[16:19], v[44:47], v[248:255], v1
    ds_read_b128 v[20:23], v3 offset:18432
    v_add_f32 v28, v28, v29
    v_add_f32 v30, v30, v31
    v_smfmac_f32_16x16x64_bf16 v[12:15], v[48:51], v[240:247], v1
    ds_read_b128 v[24:27], v3 offset:18496
    v_add_f32 v32, v32, v33
    v_add_f32 v34, v34, v35
    v_smfmac_f32_16x16x64_bf16 v[16:19], v[48:51], v[232:239], v1
    ds_read_b128 v[72:75], v3 offset:18560
    v_cvt_pk_bf16_f32 v28, v28, v32
    v_cvt_pk_bf16_f32 v29, v30, v34
    v_smfmac_f32_16x16x64_bf16 v[12:15], v[52:55], v[224:231], v1
    ds_write_b32 v2, v28 offset:20736
    ds_read_b128 v[44:47], v3 offset:18624
    v_smfmac_f32_16x16x64_bf16 v[16:19], v[52:55], v[216:223], v1
    ds_write_b32 v2, v29 offset:21312
    s_waitcnt lgkmcnt(7)
    v_smfmac_f32_16x16x64_bf16 v[12:15], v[36:39], v[208:215], v1
    ds_read_b128 v[48:51], v6 offset:17408
    v_mov_b64 v[10:11], s[16:17]
    v_smfmac_f32_16x16x64_bf16 v[16:19], v[36:39], v[200:207], v1
    s_waitcnt lgkmcnt(6)
    v_mfma_f32_16x16x32_bf16 v[28:31], v[56:59], v[20:23], 0
    ds_read_b128 v[56:59], v0 offset:4096
    s_waitcnt lgkmcnt(6)
    v_mfma_f32_16x16x32_bf16 v[28:31], v[60:63], v[24:27], v[28:31]
    ds_read_b128 v[60:63], v0 offset:5120
    s_waitcnt lgkmcnt(3)
    s_barrier
    v_mfma_f32_16x16x32_bf16 v[28:31], v[64:67], v[72:75], v[28:31]
    ds_read_b128 v[64:67], v0 offset:6144
    v_mfma_f32_16x16x32_bf16 v[28:31], v[68:71], v[44:47], v[28:31]
    ds_read_b128 v[68:71], v0 offset:7168
    v_smfmac_f32_16x16x64_bf16 v[12:15], v[40:43], v[192:199], v1
    ds_read_b128 v[36:39], v3 offset:20736
    v_smfmac_f32_16x16x64_bf16 v[16:19], v[40:43], v[184:191], v1
    ds_read_b128 v[52:55], v3 offset:20800
    s_waitcnt lgkmcnt(4)
    v_mfma_f32_16x16x32_bf16 v[32:35], v[56:59], v[20:23], 0
    s_nop 0
    v_exp_f32 v28, v28
    ds_read_b128 v[56:59], v3 offset:20864
    v_mfma_f32_16x16x32_bf16 v[32:35], v[60:63], v[24:27], v[32:35]
    s_waitcnt lgkmcnt(3)
    v_exp_f32 v29, v29
    ds_read_b128 v[60:63], v3 offset:20928
    v_mfma_f32_16x16x32_bf16 v[32:35], v[64:67], v[72:75], v[32:35]
    v_exp_f32 v30, v30
    v_mfma_f32_16x16x32_bf16 v[32:35], v[68:71], v[44:47], v[32:35]
    s_waitcnt lgkmcnt(3)
    v_exp_f32 v31, v31
    v_mfma_f32_16x16x32_bf16 v[40:43], v[36:39], v[20:23], 0
    s_waitcnt lgkmcnt(2)
    v_cvt_pk_bf16_f32 v28, v28, v29
    v_cvt_pk_bf16_f32 v29, v30, v31
    v_mfma_f32_16x16x32_bf16 v[40:43], v[52:55], v[24:27], v[40:43]
    s_waitcnt lgkmcnt(1)
    v_mov_b64 v[64:65], s[24:25]
    v_mov_b64 v[66:67], s[24:25]
    v_mfma_f32_16x16x32_bf16 v[40:43], v[56:59], v[72:75], v[40:43]
    s_waitcnt lgkmcnt(0)
    v_exp_f32 v32, v32
    v_mfma_f32_16x16x32_bf16 v[40:43], v[60:63], v[44:47], v[40:43]
    v_exp_f32 v33, v33
    v_smfmac_f32_16x16x64_bf16 v[12:15], v[48:51], v[176:183], v1
    v_exp_f32 v34, v34
    v_smfmac_f32_16x16x64_bf16 v[16:19], v[48:51], v[168:175], v1
    v_exp_f32 v35, v35
    v_cvt_pk_bf16_f32 v30, v32, v33
    v_cvt_pk_bf16_f32 v31, v34, v35
    s_nop 0
    v_exp_f32 v40, v40
    v_mfma_f32_16x16x32_bf16 v[72:75], v[64:67], v[28:31], 0
    v_exp_f32 v41, v41
    v_mfma_f32_16x16x32_bf16 v[20:23], v[80:83], v[28:31], 0
    v_exp_f32 v42, v42
    v_mfma_f32_16x16x32_bf16 v[24:27], v[84:87], v[28:31], 0
    v_exp_f32 v43, v43
    v_cvt_pk_bf16_f32 v40, v40, v41
    v_cvt_pk_bf16_f32 v41, v42, v43
    v_cvt_pk_bf16_f32 v12, v12, v13
    v_cvt_pk_bf16_f32 v13, v14, v15
    v_mfma_f32_16x16x16_bf16 v[72:75], v[10:11], v[40:41], v[72:75]
    v_cvt_pk_bf16_f32 v14, v16, v17
    v_cvt_pk_bf16_f32 v15, v18, v19
M_c0_2_fin:
    v_mfma_f32_16x16x16_bf16 v[20:23], v[12:13], v[40:41], v[20:23]
    s_cmp_eq_u32 s57, 63
    v_cndmask_b32_e64 v76, v12, v56, s[66:67]
    v_cndmask_b32_e64 v77, v13, v57, s[66:67]
    v_mfma_f32_16x16x16_bf16 v[24:27], v[14:15], v[40:41], v[24:27]
    v_cndmask_b32_e64 v78, v14, v58, s[66:67]
    v_cndmask_b32_e64 v79, v15, v59, s[66:67]
    s_cbranch_scc1 M_c0_2_last
    v_rcp_f32 v74, v72
    v_subrev_u32 v73, s68, v72
    v_cmp_lt_u32 vcc, s69, v73
    v_mov_b64 v[44:45], 0
    v_mov_b64 v[46:47], 0
    v_cndmask_b32_e64 v20, v20, v24, s[18:19]
    v_cndmask_b32_e64 v21, v21, v25, s[18:19]
    v_cndmask_b32_e64 v22, v22, v26, s[18:19]
    v_cndmask_b32_e64 v23, v23, v27, s[18:19]
    v_pk_mul_f32 v[20:21], v[20:21], v[74:75] op_sel_hi:[1,0]
    v_pk_mul_f32 v[22:23], v[22:23], v[74:75] op_sel_hi:[1,0]
    v_cvt_pk_bf16_f32 v20, v20, v21
    v_cvt_pk_bf16_f32 v21, v22, v23
    ds_write_b64 v0, v[20:21] offset:14336
    s_cbranch_vccnz M_c0_2_zbad
M_c0_2_zok:
    s_cmp_lt_u32 s54, s42
    s_cbranch_scc1 M_c0_2_first2
M_c0_2_first2_r:
    buffer_load_dwordx4 v[80:83], v0, s[8:11], s3 offen offset:0 sc1
    buffer_load_dwordx4 v[84:87], v0, s[8:11], s3 offen offset:1024 sc1
    s_waitcnt lgkmcnt(0)
    s_barrier
    ds_read_b128 v[32:35], v0 offset:13312
    ds_read_b128 v[52:55], v0 offset:14336
    s_mov_b32 m0, 4096
    s_nop 0
    buffer_load_dwordx4 v0, s[8:11], s26 offen offset:0 sc1 lds
    buffer_load_dwordx4 v0, s[8:11], s26 offen offset:1024 sc1 lds
    v_mov_b64 v[68:69], 0
    v_mov_b64 v[70:71], 0
    v_mov_b64 v[64:65], 0
    v_mov_b64 v[66:67], 0
    v_mov_b64 v[60:61], 0
    v_mov_b64 v[62:63], 0
    v_mov_b64 v[56:57], 0
    v_mov_b64 v[58:59], 0
    s_waitcnt lgkmcnt(1)
    s_nop 0
    v_smfmac_f32_16x16x64_bf16 v[56:59], v[32:35], v[160:167], v1
    v_smfmac_f32_16x16x64_bf16 v[60:63], v[32:35], v[144:151], v1
    s_waitcnt lgkmcnt(0)
    v_smfmac_f32_16x16x64_bf16 v[56:59], v[52:55], v[152:159], v1
    v_smfmac_f32_16x16x64_bf16 v[60:63], v[52:55], v[136:143], v1
    v_smfmac_f32_16x16x64_bf16 v[64:67], v[32:35], v[128:135], v1
    v_smfmac_f32_16x16x64_bf16 v[68:71], v[32:35], v[112:119], v1
    v_permlane32_swap_b32 v56, v57
    v_smfmac_f32_16x16x64_bf16 v[64:67], v[52:55], v[120:127], v1
    v_permlane32_swap_b32 v58, v59
    v_smfmac_f32_16x16x64_bf16 v[68:71], v[52:55], v[104:111], v1
    v_add_f32 v56, v56, v57
    v_add_f32 v58, v58, v59
    v_smfmac_f32_16x16x64_bf16 v[44:47], v[32:35], v[96:103], v1
    v_permlane32_swap_b32 v60, v61
    v_smfmac_f32_16x16x64_bf16 v[44:47], v[52:55], v[88:95], v1
    v_permlane32_swap_b32 v62, v63
    v_add_f32 v60, v60, v61
    v_add_f32 v62, v62, v63
    v_cvt_pk_bf16_f32 v36, v56, v60
    v_cvt_pk_bf16_f32 v38, v58, v62
    v_permlane32_swap_b32 v64, v65
    v_permlane32_swap_b32 v66, v67
    v_add_f32 v64, v64, v65
    v_add_f32 v66, v66, v67
    v_permlane32_swap_b32 v68, v69
    v_permlane32_swap_b32 v70, v71
    v_add_f32 v68, v68, v69
    v_add_f32 v70, v70, v71
    v_cvt_pk_bf16_f32 v37, v64, v68
    v_cvt_pk_bf16_f32 v39, v66, v70
    buffer_store_dwordx4 v[36:39], v0, s[8:11], s58 offen
    v_permlane32_swap_b32 v44, v45
    v_permlane32_swap_b32 v46, v47
    v_add_f32 v44, v44, v45
    v_add_f32 v46, v46, v47
    v_cvt_pk_bf16_f32 v44, v44, v46
    buffer_store_dword v44, v7, s[8:11], s55 offen
    s_add_u32 s27, s44, 1
    s_and_b32 s27, s27, 3
    s_mul_i32 s48, s27, 5120
    s_add_u32 s48, s48, s41
    s_lshl_b32 s27, s27, 15
    s_add_u32 s49, s27, s47
    ds_read_b128 v[56:59], v5 offset:0
    ds_read_b128 v[60:63], v5 offset:1024
    ds_read_b128 v[64:67], v5 offset:2048
    ds_read_b128 v[68:71], v5 offset:3072
    v_mov_b64 v[12:13], 0
    v_mov_b64 v[14:15], 0
    v_mov_b64 v[16:17], 0
    v_mov_b64 v[18:19], 0
    v_mov_b64 v[20:21], 0
    v_mov_b64 v[22:23], 0
    v_mov_b64 v[24:25], 0
    v_mov_b64 v[26:27], 0
    v_mov_b64 v[28:29], 0
    v_mov_b64 v[30:31], 0
    v_mov_b64 v[32:33], 0
    v_mov_b64 v[34:35], 0
    ds_read_b64 v[10:11], v0 offset:23296
    s_waitcnt lgkmcnt(0)
    v_min_u32 v10, v10, v11
    s_nop 0
    v_readfirstlane_b32 s28, v10
    s_nop 0
    s_max_u32 s54, s54, s28
    s_barrier
    s_and_b32 s26, s44, 63
    s_add_u32 s26, s26, 2
    s_min_u32 s26, s26, 63
    s_lshl_b32 s26, s26, 18
    s_add_u32 s26, s26, s50
    s_add_u32 s26, s26, 4096
    s_add_u32 s3, s26, 16777216
    s_lshl_b32 s4, s44, 18
    s_add_u32 s4, s4, s53
    s_add_u32 s44, s44, 1
    s_and_b32 s55, s44, 3
    s_mul_i32 s55, s55, 167936
    s_add_u32 s55, s55, s34
    s_add_u32 s58, s55, s35
    s_and_b32 s57, s44, 63
    s_add_u32 s42, s44, 2
    s_or_b32 s28, s44, 63
    s_add_u32 s28, s28, 1
    s_min_u32 s42, s42, s28
    s_sub_u32 s61, s3, 4096
    s_cmp_ge_u32 s54, s42
    s_cselect_b32 s61, s61, 0x10000000
    s_nop 15
    s_nop 15
    s_nop 5
    s_mov_b32 m0, 13312
    s_nop 0
    buffer_load_dwordx4 v0, s[8:11], s48 offen offset:0 sc1 lds
    buffer_load_dwordx4 v0, s[8:11], s48 offen offset:1024 sc1 lds
    buffer_load_dwordx4 v0, s[8:11], s48 offen offset:2048 sc1 lds
    s_nop 13
    s_mov_b32 m0, 13312
    s_nop 0
    buffer_load_dwordx4 v0, s[8:11], s48 offen offset:0 sc1 lds
    buffer_load_dwordx4 v0, s[8:11], s48 offen offset:1024 sc1 lds
    buffer_load_dwordx4 v0, s[8:11], s48 offen offset:2048 sc1 lds
    s_nop 13
    s_mov_b32 m0, 13312
    s_nop 0
    buffer_load_dwordx4 v0, s[8:11], s48 offen offset:0 sc1 lds
    buffer_load_dwordx4 v0, s[8:11], s48 offen offset:1024 sc1 lds
    buffer_load_dwordx4 v0, s[8:11], s48 offen offset:2048 sc1 lds
    s_mov_b32 s70, 0
    s_branch M_c0_2_top
M_c0_2_restart:
    s_waitcnt vmcnt(0) lgkmcnt(0)
    s_nop 7
    s_barrier
    s_mov_b32 m0, 13312
    s_nop 0
    buffer_load_dwordx4 v0, s[8:11], s48 offen offset:0 sc1 lds
    buffer_load_dwordx4 v0, s[8:11], s48 offen offset:1024 sc1 lds
    buffer_load_dwordx4 v0, s[8:11], s48 offen offset:2048 sc1 lds
    ds_read_b128 v[56:59], v5 offset:0
    ds_read_b128 v[60:63], v5 offset:1024
    ds_read_b128 v[64:67], v5 offset:2048
    ds_read_b128 v[68:71], v5 offset:3072
    v_mov_b64 v[12:13], 0
    v_mov_b64 v[14:15], 0
    v_mov_b64 v[16:17], 0
    v_mov_b64 v[18:19], 0
    v_mov_b64 v[20:21], 0
    v_mov_b64 v[22:23], 0
    v_mov_b64 v[24:25], 0
    v_mov_b64 v[26:27], 0
    v_mov_b64 v[28:29], 0
    v_mov_b64 v[30:31], 0
    v_mov_b64 v[32:33], 0
    v_mov_b64 v[34:35], 0
    s_waitcnt vmcnt(0) lgkmcnt(0)
    s_branch M_c0_2_top
M_c0_2_zbad:
    s_cmp_eq_u32 s70, 2
    s_cbranch_scc1 M_c0_2_zok
    v_cmp_u_f32 vcc, v72, v72
    s_cbranch_vccz M_c0_2_exact
    s_cmp_eq_u32 s70, 1
    s_cbranch_scc1 M_c0_2_exact
M_c0_2_vfy0:
    s_mov_b32 s70, 1
    s_mov_b32 s30, 0
    s_waitcnt vmcnt(0) lgkmcnt(0)
    s_nop 7
M_c0_2_vfy:
    v_mov_b32 v10, 0
    s_add_u32 s59, s48, 4096
    buffer_load_dwordx4 v[36:39], v0, s[8:11], s48 offen offset:0 sc1
    buffer_load_dwordx4 v[40:43], v0, s[8:11], s48 offen offset:1024 sc1
    buffer_load_dwordx4 v[44:47], v0, s[8:11], s48 offen offset:2048 sc1
    buffer_load_dwordx4 v[48:51], v0, s[8:11], s48 offen offset:3072 sc1
    buffer_load_dwordx4 v[52:55], v0, s[8:11], s59 offen offset:0 sc1
    s_waitcnt vmcnt(4)
    v_max3_u32 v10, v10, v36, v37
    v_max3_u32 v10, v10, v38, v39
    s_waitcnt vmcnt(3)
    v_max3_u32 v10, v10, v40, v41
    v_max3_u32 v10, v10, v42, v43
    s_waitcnt vmcnt(2)
    v_max3_u32 v10, v10, v44, v45
    v_max3_u32 v10, v10, v46, v47
    s_waitcnt vmcnt(1)
    v_max3_u32 v10, v10, v48, v49
    v_max3_u32 v10, v10, v50, v51
    s_waitcnt vmcnt(0)
    v_max3_u32 v10, v10, v52, v53
    v_max3_u32 v10, v10, v54, v55
    s_add_u32 s59, s49, 4096
    buffer_load_dwordx4 v[36:39], v0, s[8:11], s49 offen offset:0 sc1
    buffer_load_dwordx4 v[40:43], v0, s[8:11], s49 offen offset:1024 sc1
    buffer_load_dwordx4 v[44:47], v0, s[8:11], s49 offen offset:2048 sc1
    buffer_load_dwordx4 v[48:51], v0, s[8:11], s49 offen offset:3072 sc1
    buffer_load_dwordx4 v[52:55], v0, s[8:11], s59 offen offset:0 sc1
    s_waitcnt vmcnt(4)
    v_max3_u32 v10, v10, v36, v37
    v_max3_u32 v10, v10, v38, v39
    s_waitcnt vmcnt(3)
    v_max3_u32 v10, v10, v40, v41
    v_max3_u32 v10, v10, v42, v43
    s_waitcnt vmcnt(2)
    v_max3_u32 v10, v10, v44, v45
    v_max3_u32 v10, v10, v46, v47
    s_waitcnt vmcnt(1)
    v_max3_u32 v10, v10, v48, v49
    v_max3_u32 v10, v10, v50, v51
    s_waitcnt vmcnt(0)
    v_max3_u32 v10, v10, v52, v53
    v_max3_u32 v10, v10, v54, v55
    v_cmp_eq_u32 vcc, -1, v10
    s_cbranch_vccz M_c0_2_restart
    s_add_u32 s30, s30, 1
    s_cmp_ge_u32 s30, 60000
    s_cbranch_scc1 M_fail
    s_branch M_c0_2_vfy
M_c0_2_exact:
    s_nop 7
    s_mov_b32 s70, 2
    s_waitcnt lgkmcnt(0)
    ds_read_b128 v[20:23], v3 offset:18432
    ds_read_b128 v[24:27], v3 offset:18496
    ds_read_b128 v[72:75], v3 offset:18560
    ds_read_b128 v[44:47], v3 offset:18624
    ds_read_b128 v[56:59], v0 offset:0
    s_waitcnt lgkmcnt(0)
    v_mfma_f32_16x16x32_bf16 v[28:31], v[56:59], v[20:23], 0
    s_nop 3
    ds_read_b128 v[60:63], v0 offset:1024
    s_waitcnt lgkmcnt(0)
    v_mfma_f32_16x16x32_bf16 v[28:31], v[60:63], v[24:27], v[28:31]
    s_nop 3
    ds_read_b128 v[56:59], v0 offset:2048
    s_waitcnt lgkmcnt(0)
    v_mfma_f32_16x16x32_bf16 v[28:31], v[56:59], v[72:75], v[28:31]
    s_nop 3
    ds_read_b128 v[60:63], v0 offset:3072
    s_waitcnt lgkmcnt(0)
    v_mfma_f32_16x16x32_bf16 v[28:31], v[60:63], v[44:47], v[28:31]
    s_nop 3
    ds_read_b128 v[56:59], v0 offset:4096
    s_waitcnt lgkmcnt(0)
    v_mfma_f32_16x16x32_bf16 v[32:35], v[56:59], v[20:23], 0
    s_nop 3
    ds_read_b128 v[60:63], v0 offset:5120
    s_waitcnt lgkmcnt(0)
    v_mfma_f32_16x16x32_bf16 v[32:35], v[60:63], v[24:27], v[32:35]
    s_nop 3
    ds_read_b128 v[56:59], v0 offset:6144
    s_waitcnt lgkmcnt(0)
    v_mfma_f32_16x16x32_bf16 v[32:35], v[56:59], v[72:75], v[32:35]
    s_nop 3
    ds_read_b128 v[60:63], v0 offset:7168
    s_waitcnt lgkmcnt(0)
    v_mfma_f32_16x16x32_bf16 v[32:35], v[60:63], v[44:47], v[32:35]
    s_nop 3
    ds_read_b128 v[56:59], v3 offset:20736
    s_waitcnt lgkmcnt(0)
    v_mfma_f32_16x16x32_bf16 v[40:43], v[56:59], v[20:23], 0
    s_nop 3
    ds_read_b128 v[60:63], v3 offset:20800
    s_waitcnt lgkmcnt(0)
    v_mfma_f32_16x16x32_bf16 v[40:43], v[60:63], v[24:27], v[40:43]
    s_nop 3
    ds_read_b128 v[56:59], v3 offset:20864
    s_waitcnt lgkmcnt(0)
    v_mfma_f32_16x16x32_bf16 v[40:43], v[56:59], v[72:75], v[40:43]
    s_nop 3
    ds_read_b128 v[60:63], v3 offset:20928
    s_waitcnt lgkmcnt(0)
    v_mfma_f32_16x16x32_bf16 v[40:43], v[60:63], v[44:47], v[40:43]
    s_nop 3
    v_max3_f32 v68, v28, v29, v30
    v_max3_f32 v68, v68, v31, v32
    v_max3_f32 v68, v68, v33, v34
    s_nop 0
    v_max3_f32 v68, v68, v35, v40
    v_max3_f32 v68, v68, v41, v42
    v_max_f32 v68, v68, v43
    v_mov_b32 v69, v68
    s_nop 1
    v_permlane16_swap_b32 v68, v69
    v_max_f32 v68, v68, v69
    v_mov_b32 v69, v68
    s_nop 1
    v_permlane32_swap_b32 v68, v69
    v_max_f32 v68, v68, v69
    v_sub_f32 v28, v28, v68
    v_exp_f32 v28, v28
    v_sub_f32 v29, v29, v68
    v_exp_f32 v29, v29
    v_sub_f32 v30, v30, v68
    v_exp_f32 v30, v30
    v_sub_f32 v31, v31, v68
    v_exp_f32 v31, v31
    v_sub_f32 v32, v32, v68
    v_exp_f32 v32, v32
    v_sub_f32 v33, v33, v68
    v_exp_f32 v33, v33
    v_sub_f32 v34, v34, v68
    v_exp_f32 v34, v34
    v_sub_f32 v35, v35, v68
    v_exp_f32 v35, v35
    v_sub_f32 v40, v40, v68
    v_exp_f32 v40, v40
    v_sub_f32 v41, v41, v68
    v_exp_f32 v41, v41
    v_sub_f32 v42, v42, v68
    v_exp_f32 v42, v42
    v_sub_f32 v43, v43, v68
    v_exp_f32 v43, v43
    v_cvt_pk_bf16_f32 v28, v28, v29
    v_cvt_pk_bf16_f32 v29, v30, v31
    v_cvt_pk_bf16_f32 v30, v32, v33
    v_cvt_pk_bf16_f32 v31, v34, v35
    v_cvt_pk_bf16_f32 v40, v40, v41
    v_cvt_pk_bf16_f32 v41, v42, v43
    v_mfma_f32_16x16x32_bf16 v[20:23], v[80:83], v[28:31], 0
    v_mfma_f32_16x16x32_bf16 v[24:27], v[84:87], v[28:31], 0
    v_mfma_f32_16x16x32_bf16 v[72:75], v[64:67], v[28:31], 0
    ds_read_b128 v[56:59], v3 offset:20864
    s_waitcnt lgkmcnt(0)
    s_nop 7
    v_mfma_f32_16x16x16_bf16 v[72:75], v[10:11], v[40:41], v[72:75]
    s_nop 7
    s_branch M_c0_2_fin
M_c0_2_last:
    s_cmp_lg_u32 s70, 0
    s_cbranch_scc1 M_c0_2_last2
    v_cmp_u_f32 vcc, v32, v32
    s_cbranch_vccnz M_c0_2_vfy0
M_c0_2_last2:
    s_lshl_b32 s4, s44, 18
    s_add_u32 s4, s4, s53
    buffer_store_dwordx4 v[76:79], v0, s[8:11], s4 offen offset:2048 sc1
    s_mov_b32 s4, 0x10000000
    s_waitcnt vmcnt(0) lgkmcnt(0)
    s_barrier
    s_nop 7
    v_mov_b64 v[72:73], -1
    v_mov_b64 v[74:75], -1
    s_add_u32 s28, s44, 3
    s_and_b32 s29, s28, 3
    s_mul_i32 s31, s22, 160
    s_waitcnt vmcnt(0)
    s_add_u32 s44, s44, 1
    s_cmp_eq_u32 s44, 128
    s_cbranch_scc1 M_end
    s_branch M_c0_2_layer
M_c0_2_lr:
    s_mov_b32 s30, 0
M_c0_2_lr_l:
    s_waitcnt lgkmcnt(0)
    s_and_b32 s27, s30, 1
    s_cbranch_scc0 M_c0_2_lr_n
    s_waitcnt vmcnt(3)
    s_mov_b32 m0, 13312
    s_nop 0
    buffer_load_dwordx4 v0, s[8:11], s48 offen offset:0 sc1 lds
    buffer_load_dwordx4 v0, s[8:11], s48 offen offset:1024 sc1 lds
    buffer_load_dwordx4 v0, s[8:11], s48 offen offset:2048 sc1 lds
M_c0_2_lr_n:
    ds_read_b128 v[36:39], v6 offset:13312
    ds_read_b128 v[40:43], v6 offset:14336
    ds_read_b128 v[44:47], v6 offset:15360
    ds_read_b128 v[48:51], v6 offset:16384
    ds_read_b128 v[52:55], v6 offset:17408
    s_waitcnt lgkmcnt(2)
    v_max3_u32 v10, v36, v40, v44
    s_waitcnt lgkmcnt(0)
    v_max3_u32 v10, v10, v48, v52
    v_cmp_eq_u32 vcc, -1, v10
    s_cbranch_vccz M_c0_2_lr_d
    s_add_u32 s30, s30, 1
    s_cmp_ge_u32 s30, 480000
    s_cbranch_scc1 M_fail
    s_branch M_c0_2_lr_l
M_c0_2_lr_d:
    ds_read_b128 v[56:59], v5 offset:0
    ds_read_b128 v[60:63], v5 offset:1024
    ds_read_b128 v[64:67], v5 offset:2048
    ds_read_b128 v[68:71], v5 offset:3072
    v_mov_b64 v[12:13], 0
    v_mov_b64 v[14:15], 0
    v_mov_b64 v[16:17], 0
    v_mov_b64 v[18:19], 0
    v_mov_b64 v[20:21], 0
    v_mov_b64 v[22:23], 0
    v_mov_b64 v[24:25], 0
    v_mov_b64 v[26:27], 0
    v_mov_b64 v[28:29], 0
    v_mov_b64 v[30:31], 0
    v_mov_b64 v[32:33], 0
    v_mov_b64 v[34:35], 0
    s_waitcnt lgkmcnt(0)
    s_branch M_c0_2_lr_r
M_c0_2_rr:
    s_mov_b32 s30, 0
M_c0_2_rr_l:
    s_waitcnt lgkmcnt(0)
    s_and_b32 s27, s30, 1
    s_cbranch_scc1 M_c0_2_rr_n
    s_waitcnt vmcnt(1)
    s_mov_b32 m0, 8192
    s_nop 0
    buffer_load_dwordx4 v0, s[8:11], s49 offen offset:3072 sc1 lds
M_c0_2_rr_n:
    ds_read_b128 v[36:39], v6 offset:8192
    ds_read_b128 v[40:43], v6 offset:9216
    ds_read_b128 v[44:47], v6 offset:10240
    ds_read_b128 v[48:51], v6 offset:11264
    ds_read_b32 v11, v6 offset:12288
    s_waitcnt lgkmcnt(2)
    v_max3_u32 v10, v36, v40, v44
    s_waitcnt lgkmcnt(0)
    v_max3_u32 v10, v10, v48, v11
    v_cmp_eq_u32 vcc, -1, v10
    s_cbranch_vccz M_c0_2_rr_d
    s_add_u32 s30, s30, 1
    s_cmp_ge_u32 s30, 480000
    s_cbranch_scc1 M_fail
    s_branch M_c0_2_rr_l
M_c0_2_rr_d:
    s_branch M_c0_2_rr_r
M_c0_2_first:
    s_mul_i32 s27, s21, 167936
    s_add_u32 s27, s27, s34
    s_mul_i32 s28, s22, 4224
    s_add_u32 s28, s28, s27
    s_mov_b32 exec_hi, 0
    buffer_load_dword v10, v9, s[8:11], s28 offen sc1
    s_lshl_b32 s28, s22, 10
    s_add_u32 s28, s28, s27
    s_add_u32 s28, s28, 135168
    s_mov_b64 exec, 0xff
    buffer_load_dword v10, v9, s[8:11], s28 offen sc1
    s_mul_i32 s27, s21, 5120
    s_add_u32 s27, s27, s41
    s_mul_i32 s28, s22, 160
    s_add_u32 s28, s28, s27
    s_mov_b64 exec, 3
    buffer_load_dword v10, v9, s[8:11], s28 offen sc1
    s_mov_b64 exec, -1
    s_barrier
    s_and_b32 s26, s44, 63
    s_lshl_b32 s26, s26, 18
    s_add_u32 s26, s26, s50
    s_add_u32 s26, s26, 4096
    s_add_u32 s3, s26, 16777216
    s_mov_b32 m0, 4096
    s_nop 0
    buffer_load_dwordx4 v0, s[8:11], s26 offen offset:0 sc1 lds
    buffer_load_dwordx4 v0, s[8:11], s26 offen offset:1024 sc1 lds
    buffer_load_dwordx4 v[80:83], v0, s[8:11], s3 offen offset:0 sc1
    buffer_load_dwordx4 v[84:87], v0, s[8:11], s3 offen offset:1024 sc1
    s_and_b32 s26, s44, 63
    s_add_u32 s26, s26, 1
    s_min_u32 s26, s26, 63
    s_lshl_b32 s26, s26, 18
    s_add_u32 s26, s26, s50
    s_add_u32 s26, s26, 4096
    s_add_u32 s3, s26, 16777216
    s_waitcnt vmcnt(0) lgkmcnt(0)
    s_barrier
    s_branch M_c0_2_first_r
M_c0_2_first2:
    ds_read_b64 v[10:11], v0 offset:23296
    s_waitcnt lgkmcnt(0)
    v_min_u32 v10, v10, v11
    s_nop 0
    v_readfirstlane_b32 s28, v10
    s_nop 0
    s_max_u32 s54, s54, s28
    s_add_u32 s27, s44, 2
    s_or_b32 s28, s44, 63
    s_add_u32 s28, s28, 1
    s_min_u32 s27, s27, s28
    s_cmp_lt_u32 s54, s27
    s_cbranch_scc1 M_c0_2_p2
M_c0_2_p2_r:
    s_branch M_c0_2_first2_r
M_c0_2_p2:
    s_mov_b32 s30, 0
M_c0_2_p2_l:
    s_waitcnt lgkmcnt(0)
    s_mov_b64 exec, 3
    buffer_load_dword v10, v9, s[8:11], s51 offen sc1
    s_waitcnt vmcnt(0)
    s_mov_b64 exec, -1
    v_readlane_b32 s54, v10, 0
    v_readlane_b32 s28, v10, 1
    s_nop 3
    s_min_u32 s54, s54, s28
    s_cmp_ge_u32 s54, s27
    s_cbranch_scc1 M_c0_2_p2_r
    s_sleep 2
    s_add_u32 s30, s30, 1
    s_cmp_ge_u32 s30, 240000
    s_cbranch_scc1 M_fail
    s_branch M_c0_2_p2_l
M_c0_3_layer:
    s_lshr_b32 s27, s44, 6
    s_mul_i32 s50, s27, 33554432
    s_lshl_b32 s27, s22, 13
    s_add_u32 s50, s50, s27
    s_add_u32 s50, s50, 37748736
    s_barrier
    s_mov_b32 s26, 0x10010000
    s_mov_b32 s3, s26
    s_mul_i32 s27, s20, 5120
    s_add_u32 s48, s27, 167772160
    s_sub_u32 s49, 167777280, s27
    s_mov_b32 m0, 13312
    s_nop 0
    buffer_load_dwordx4 v0, s[8:11], s48 offen offset:3072 sc1 lds
    s_mov_b32 m0, 17408
    s_add_u32 s59, s48, 4096
    buffer_load_dwordx4 v0, s[8:11], s59 offen offset:0 sc1 lds
    s_and_b32 s55, s44, 3
    s_mul_i32 s55, s55, 167936
    s_add_u32 s55, s55, s34
    s_add_u32 s58, s55, s35
    s_and_b32 s57, s44, 63
    s_add_u32 s42, s44, 2
    s_or_b32 s28, s44, 63
    s_add_u32 s28, s28, 1
    s_min_u32 s42, s42, s28
    s_sub_u32 s61, s26, 6144
    s_cmp_ge_u32 s54, s42
    s_cselect_b32 s61, s61, 0x10000000
    ds_read_b128 v[56:59], v5 offset:0
    ds_read_b128 v[60:63], v5 offset:1024
    ds_read_b128 v[64:67], v5 offset:2048
    ds_read_b128 v[68:71], v5 offset:3072
    v_mov_b64 v[12:13], 0
    v_mov_b64 v[14:15], 0
    v_mov_b64 v[16:17], 0
    v_mov_b64 v[18:19], 0
    v_mov_b64 v[20:21], 0
    v_mov_b64 v[22:23], 0
    v_mov_b64 v[24:25], 0
    v_mov_b64 v[26:27], 0
    v_mov_b64 v[28:29], 0
    v_mov_b64 v[30:31], 0
    v_mov_b64 v[32:33], 0
    v_mov_b64 v[34:35], 0
    s_mov_b32 s70, 0
    s_waitcnt vmcnt(0) lgkmcnt(0)
M_c0_3_top:
    s_waitcnt vmcnt(4)
    s_barrier
    ds_read_b128 v[36:39], v6 offset:13312
    ds_read_b128 v[40:43], v6 offset:14336
    s_mov_b32 m0, 12288
    s_add_u32 s59, s49, 4096
    buffer_load_dwordx4 v0, s[8:11], s59 offen offset:0 sc1 lds
M_c0_3_lr_r:
    s_waitcnt lgkmcnt(1)
    v_smfmac_f32_16x16x64_bf16 v[20:23], v[36:39], v[56:63], v1
    ds_read_b128 v[56:59], v5 offset:4096
    v_smfmac_f32_16x16x64_bf16 v[24:27], v[36:39], v[64:71], v1
    ds_read_b128 v[60:63], v5 offset:5120
    v_smfmac_f32_16x16x64_bf16 v[28:31], v[36:39], a[248:255], v1
    ds_read_b128 v[64:67], v5 offset:6144
    v_smfmac_f32_16x16x64_bf16 v[32:35], v[36:39], a[240:247], v1
    ds_read_b128 v[68:71], v5 offset:7168
    v_smfmac_f32_16x16x64_bf16 v[12:15], v[36:39], a[232:239], v1
    ds_read_b128 v[44:47], v6 offset:15360
    s_waitcnt lgkmcnt(3)
    v_smfmac_f32_16x16x64_bf16 v[16:19], v[36:39], v[56:63], v1
    ds_read_b128 v[56:59], v5 offset:8192
    v_smfmac_f32_16x16x64_bf16 v[20:23], v[40:43], a[224:231], v1
    ds_read_b128 v[60:63], v5 offset:9216
    s_waitcnt lgkmcnt(3)
    v_smfmac_f32_16x16x64_bf16 v[24:27], v[40:43], v[64:71], v1
    ds_read_b128 v[64:67], v5 offset:10240
    v_smfmac_f32_16x16x64_bf16 v[28:31], v[40:43], a[216:223], v1
    ds_read_b128 v[68:71], v5 offset:11264
    v_smfmac_f32_16x16x64_bf16 v[32:35], v[40:43], a[208:215], v1
    ds_read_b128 v[48:51], v6 offset:16384
    s_waitcnt lgkmcnt(3)
    v_smfmac_f32_16x16x64_bf16 v[12:15], v[40:43], v[56:63], v1
    ds_read_b128 v[56:59], v5 offset:12288
    v_smfmac_f32_16x16x64_bf16 v[16:19], v[40:43], a[200:207], v1
    ds_read_b128 v[60:63], v5 offset:13312
    s_waitcnt lgkmcnt(3)
    v_smfmac_f32_16x16x64_bf16 v[20:23], v[44:47], v[64:71], v1
    ds_read_b128 v[64:67], v5 offset:14336
    v_smfmac_f32_16x16x64_bf16 v[24:27], v[44:47], a[192:199], v1
    ds_read_b128 v[68:71], v5 offset:15360
    v_smfmac_f32_16x16x64_bf16 v[28:31], v[44:47], a[184:191], v1
    ds_read_b128 v[52:55], v6 offset:17408
    s_waitcnt lgkmcnt(3)
    v_smfmac_f32_16x16x64_bf16 v[32:35], v[44:47], v[56:63], v1
    ds_read_b128 v[56:59], v5 offset:16384
    v_smfmac_f32_16x16x64_bf16 v[20:23], v[48:51], a[176:183], v1
    ds_read_b128 v[60:63], v5 offset:17408
    s_waitcnt lgkmcnt(3)
    v_max3_u32 v10, v36, v40, v44
    v_smfmac_f32_16x16x64_bf16 v[24:27], v[48:51], v[64:71], v1
    ds_read_b128 v[64:67], v5 offset:18432
    s_waitcnt lgkmcnt(3)
    v_max3_u32 v10, v10, v48, v52
    v_smfmac_f32_16x16x64_bf16 v[28:31], v[48:51], a[168:175], v1
    ds_read_b128 v[68:71], v5 offset:19456
    v_cmp_eq_u32 vcc, -1, v10
    v_smfmac_f32_16x16x64_bf16 v[32:35], v[48:51], a[160:167], v1
    s_cbranch_vccnz M_c0_3_lr
    s_waitcnt vmcnt(0)
    s_barrier
    ds_read_b128 v[36:39], v6 offset:8192
    ds_read_b128 v[40:43], v6 offset:9216
    s_waitcnt lgkmcnt(4)
    v_smfmac_f32_16x16x64_bf16 v[20:23], v[52:55], v[56:63], v1
    ds_read_b128 v[44:47], v6 offset:10240
    ds_read_b128 v[48:51], v6 offset:11264
    v_smfmac_f32_16x16x64_bf16 v[24:27], v[52:55], a[152:159], v1
    ds_read_b32 v11, v6 offset:12288
    ds_read_b128 v[56:59], v5 offset:20480
    s_waitcnt lgkmcnt(6)
    v_smfmac_f32_16x16x64_bf16 v[28:31], v[52:55], v[64:71], v1
    ds_read_b128 v[60:63], v5 offset:21504
    s_waitcnt lgkmcnt(4)
    v_max3_u32 v10, v36, v40, v44
    v_smfmac_f32_16x16x64_bf16 v[32:35], v[52:55], a[144:151], v1
    s_waitcnt lgkmcnt(2)
    v_max3_u32 v10, v10, v48, v11
    v_cmp_eq_u32 vcc, -1, v10
    s_cbranch_vccnz M_c0_3_rr
M_c0_3_rr_r:
    s_mov_b32 m0, 23040
    ds_read_b128 v[64:67], v5 offset:22528
    ds_read_b128 v[68:71], v5 offset:23552
    ds_read_b128 v[52:55], v6 offset:12288
    buffer_store_dwordx4 v[76:79], v0, s[8:11], s4 offen offset:3072 sc1
    s_mov_b32 s4, 0x10000000
    buffer_load_dword v9, s[8:11], s61 offen sc1 lds
    v_smfmac_f32_16x16x64_bf16 v[20:23], v[36:39], a[136:143], v1
    s_waitcnt lgkmcnt(3)
    v_smfmac_f32_16x16x64_bf16 v[24:27], v[36:39], v[56:63], v1
    ds_read_b128 v[56:59], v5 offset:24576
    v_smfmac_f32_16x16x64_bf16 v[20:23], v[40:43], a[128:135], v1
    ds_read_b128 v[60:63], v5 offset:25600
    s_waitcnt lgkmcnt(3)
    v_smfmac_f32_16x16x64_bf16 v[24:27], v[40:43], v[64:71], v1
    ds_read_b128 v[64:67], v5 offset:26624
    v_smfmac_f32_16x16x64_bf16 v[20:23], v[44:47], a[120:127], v1
    ds_read_b128 v[68:71], v5 offset:27648
    v_smfmac_f32_16x16x64_bf16 v[24:27], v[44:47], a[112:119], v1
    s_waitcnt lgkmcnt(2)
    v_smfmac_f32_16x16x64_bf16 v[20:23], v[48:51], v[56:63], v1
    ds_read_b128 v[56:59], v5 offset:28672
    v_smfmac_f32_16x16x64_bf16 v[24:27], v[48:51], a[104:111], v1
    ds_read_b128 v[60:63], v5 offset:29696
    s_waitcnt lgkmcnt(2)
    v_smfmac_f32_16x16x64_bf16 v[20:23], v[52:55], v[64:71], v1
    ds_read_b128 v[64:67], v5 offset:30720
    v_smfmac_f32_16x16x64_bf16 v[24:27], v[52:55], a[96:103], v1
    ds_read_b128 v[68:71], v5 offset:31744
    v_smfmac_f32_16x16x64_bf16 v[28:31], v[36:39], a[88:95], v1
    s_cmp_eq_u32 s57, 0
    s_cbranch_scc1 M_c0_3_first
M_c0_3_first_r:
    s_waitcnt lgkmcnt(2)
    v_smfmac_f32_16x16x64_bf16 v[32:35], v[36:39], v[56:63], v1
    ds_read_b128 v[56:59], v5 offset:32768
    v_permlane32_swap_b32 v20, v21
    v_smfmac_f32_16x16x64_bf16 v[28:31], v[40:43], a[80:87], v1
    ds_read_b128 v[60:63], v5 offset:33792
    s_waitcnt lgkmcnt(2)
    v_permlane32_swap_b32 v22, v23
    v_smfmac_f32_16x16x64_bf16 v[32:35], v[40:43], v[64:71], v1
    ds_read_b128 v[64:67], v0 offset:2048
    v_permlane32_swap_b32 v24, v25
    v_smfmac_f32_16x16x64_bf16 v[28:31], v[44:47], a[72:79], v1
    ds_read_b128 v[68:71], v0 offset:3072
    v_permlane32_swap_b32 v26, v27
    v_smfmac_f32_16x16x64_bf16 v[32:35], v[44:47], a[64:71], v1
    s_waitcnt lgkmcnt(2)
    v_add_f32 v20, v20, v21
    v_add_f32 v22, v22, v23
    v_smfmac_f32_16x16x64_bf16 v[28:31], v[48:51], v[56:63], v1
    ds_read_b128 v[56:59], v0 offset:0
    v_add_f32 v24, v24, v25
    v_add_f32 v26, v26, v27
    v_smfmac_f32_16x16x64_bf16 v[32:35], v[48:51], a[56:63], v1
    ds_read_b128 v[60:63], v0 offset:1024
    v_mul_f32 v20, s40, v20
    v_mul_f32 v24, s40, v24
    v_smfmac_f32_16x16x64_bf16 v[28:31], v[52:55], a[48:55], v1
    v_mul_f32 v22, s40, v22
    v_mul_f32 v26, s40, v26
    v_smfmac_f32_16x16x64_bf16 v[32:35], v[52:55], a[40:47], v1
    v_cvt_pk_bf16_f32 v20, v20, v24
    v_cvt_pk_bf16_f32 v21, v22, v26
    v_smfmac_f32_16x16x64_bf16 v[12:15], v[36:39], a[32:39], v1
    ds_write_b32 v2, v20 offset:18432
    v_smfmac_f32_16x16x64_bf16 v[16:19], v[36:39], a[24:31], v1
    ds_write_b32 v2, v21 offset:19008
    v_permlane32_swap_b32 v28, v29
    v_smfmac_f32_16x16x64_bf16 v[12:15], v[40:43], a[16:23], v1
    ds_read_b128 v[36:39], v6 offset:15360
    v_permlane32_swap_b32 v30, v31
    v_smfmac_f32_16x16x64_bf16 v[16:19], v[40:43], a[8:15], v1
    ds_read_b128 v[40:43], v6 offset:16384
    v_permlane32_swap_b32 v32, v33
    v_smfmac_f32_16x16x64_bf16 v[12:15], v[44:47], a[0:7], v1
    s_waitcnt lgkmcnt(2)
    s_barrier
    v_permlane32_swap_b32 v34, v35
    v_smfmac_f32_16x16x64_bf16 v[16:19], v[44:47], v[248:255], v1
    ds_read_b128 v[20:23], v3 offset:18432
    v_add_f32 v28, v28, v29
    v_add_f32 v30, v30, v31
    v_smfmac_f32_16x16x64_bf16 v[12:15], v[48:51], v[240:247], v1
    ds_read_b128 v[24:27], v3 offset:18496
    v_add_f32 v32, v32, v33
    v_add_f32 v34, v34, v35
    v_smfmac_f32_16x16x64_bf16 v[16:19], v[48:51], v[232:239], v1
    ds_read_b128 v[72:75], v3 offset:18560
    v_cvt_pk_bf16_f32 v28, v28, v32
    v_cvt_pk_bf16_f32 v29, v30, v34
    v_smfmac_f32_16x16x64_bf16 v[12:15], v[52:55], v[224:231], v1
    ds_write_b32 v2, v28 offset:20736
    ds_read_b128 v[44:47], v3 offset:18624
    v_smfmac_f32_16x16x64_bf16 v[16:19], v[52:55], v[216:223], v1
    ds_write_b32 v2, v29 offset:21312
    s_waitcnt lgkmcnt(7)
    v_smfmac_f32_16x16x64_bf16 v[12:15], v[36:39], v[208:215], v1
    ds_read_b128 v[48:51], v6 offset:17408
    v_mov_b64 v[10:11], s[16:17]
    v_smfmac_f32_16x16x64_bf16 v[16:19], v[36:39], v[200:207], v1
    s_waitcnt lgkmcnt(6)
    v_mfma_f32_16x16x32_bf16 v[28:31], v[56:59], v[20:23], 0
    ds_read_b128 v[56:59], v0 offset:4096
    s_waitcnt lgkmcnt(6)
    v_mfma_f32_16x16x32_bf16 v[28:31], v[60:63], v[24:27], v[28:31]
    ds_read_b128 v[60:63], v0 offset:5120
    s_waitcnt lgkmcnt(3)
    s_barrier
    v_mfma_f32_16x16x32_bf16 v[28:31], v[64:67], v[72:75], v[28:31]
    ds_read_b128 v[64:67], v0 offset:6144
    v_mfma_f32_16x16x32_bf16 v[28:31], v[68:71], v[44:47], v[28:31]
    ds_read_b128 v[68:71], v0 offset:7168
    v_smfmac_f32_16x16x64_bf16 v[12:15], v[40:43], v[192:199], v1
    ds_read_b128 v[36:39], v3 offset:20736
    v_smfmac_f32_16x16x64_bf16 v[16:19], v[40:43], v[184:191], v1
    ds_read_b128 v[52:55], v3 offset:20800
    s_waitcnt lgkmcnt(4)
    v_mfma_f32_16x16x32_bf16 v[32:35], v[56:59], v[20:23], 0
    s_nop 0
    v_exp_f32 v28, v28
    ds_read_b128 v[56:59], v3 offset:20864
    v_mfma_f32_16x16x32_bf16 v[32:35], v[60:63], v[24:27], v[32:35]
    s_waitcnt lgkmcnt(3)
    v_exp_f32 v29, v29
    ds_read_b128 v[60:63], v3 offset:20928
    v_mfma_f32_16x16x32_bf16 v[32:35], v[64:67], v[72:75], v[32:35]
    v_exp_f32 v30, v30
    v_mfma_f32_16x16x32_bf16 v[32:35], v[68:71], v[44:47], v[32:35]
    s_waitcnt lgkmcnt(3)
    v_exp_f32 v31, v31
    v_mfma_f32_16x16x32_bf16 v[40:43], v[36:39], v[20:23], 0
    s_waitcnt lgkmcnt(2)
    v_cvt_pk_bf16_f32 v28, v28, v29
    v_cvt_pk_bf16_f32 v29, v30, v31
    v_mfma_f32_16x16x32_bf16 v[40:43], v[52:55], v[24:27], v[40:43]
    s_waitcnt lgkmcnt(1)
    v_mov_b64 v[64:65], s[24:25]
    v_mov_b64 v[66:67], s[24:25]
    v_mfma_f32_16x16x32_bf16 v[40:43], v[56:59], v[72:75], v[40:43]
    s_waitcnt lgkmcnt(0)
    v_exp_f32 v32, v32
    v_mfma_f32_16x16x32_bf16 v[40:43], v[60:63], v[44:47], v[40:43]
    v_exp_f32 v33, v33
    v_smfmac_f32_16x16x64_bf16 v[12:15], v[48:51], v[176:183], v1
    v_exp_f32 v34, v34
    v_smfmac_f32_16x16x64_bf16 v[16:19], v[48:51], v[168:175], v1
    v_exp_f32 v35, v35
    v_cvt_pk_bf16_f32 v30, v32, v33
    v_cvt_pk_bf16_f32 v31, v34, v35
    s_nop 0
    v_exp_f32 v40, v40
    v_mfma_f32_16x16x32_bf16 v[72:75], v[64:67], v[28:31], 0
    v_exp_f32 v41, v41
    v_mfma_f32_16x16x32_bf16 v[20:23], v[80:83], v[28:31], 0
    v_exp_f32 v42, v42
    v_mfma_f32_16x16x32_bf16 v[24:27], v[84:87], v[28:31], 0
    v_exp_f32 v43, v43
    v_cvt_pk_bf16_f32 v40, v40, v41
    v_cvt_pk_bf16_f32 v41, v42, v43
    v_cvt_pk_bf16_f32 v12, v12, v13
    v_cvt_pk_bf16_f32 v13, v14, v15
    v_mfma_f32_16x16x16_bf16 v[72:75], v[10:11], v[40:41], v[72:75]
    v_cvt_pk_bf16_f32 v14, v16, v17
    v_cvt_pk_bf16_f32 v15, v18, v19
M_c0_3_fin:
    v_mfma_f32_16x16x16_bf16 v[20:23], v[12:13], v[40:41], v[20:23]
    s_cmp_eq_u32 s57, 63
    v_cndmask_b32_e64 v76, v12, v60, s[66:67]
    v_cndmask_b32_e64 v77, v13, v61, s[66:67]
    v_mfma_f32_16x16x16_bf16 v[24:27], v[14:15], v[40:41], v[24:27]
    v_cndmask_b32_e64 v78, v14, v62, s[66:67]
    v_cndmask_b32_e64 v79, v15, v63, s[66:67]
    s_cbranch_scc1 M_c0_3_last
    v_rcp_f32 v74, v72
    v_subrev_u32 v73, s68, v72
    v_cmp_lt_u32 vcc, s69, v73
    v_mov_b64 v[44:45], 0
    v_mov_b64 v[46:47], 0
    v_cndmask_b32_e64 v20, v20, v24, s[18:19]
    v_cndmask_b32_e64 v21, v21, v25, s[18:19]
    v_cndmask_b32_e64 v22, v22, v26, s[18:19]
    v_cndmask_b32_e64 v23, v23, v27, s[18:19]
    v_pk_mul_f32 v[20:21], v[20:21], v[74:75] op_sel_hi:[1,0]
    v_pk_mul_f32 v[22:23], v[22:23], v[74:75] op_sel_hi:[1,0]
    v_cvt_pk_bf16_f32 v20, v20, v21
    v_cvt_pk_bf16_f32 v21, v22, v23
    ds_write_b64 v0, v[20:21] offset:14344
    s_cbranch_vccnz M_c0_3_zbad
M_c0_3_zok:
    s_cmp_lt_u32 s54, s42
    s_cbranch_scc1 M_c0_3_first2
M_c0_3_first2_r:
    buffer_load_dwordx4 v[80:83], v0, s[8:11], s3 offen offset:0 sc1
    buffer_load_dwordx4 v[84:87], v0, s[8:11], s3 offen offset:1024 sc1
    s_waitcnt lgkmcnt(0)
    s_barrier
    ds_read_b128 v[32:35], v0 offset:13312
    ds_read_b128 v[52:55], v0 offset:14336
    s_mov_b32 m0, 6144
    s_nop 0
    buffer_load_dwordx4 v0, s[8:11], s26 offen offset:0 sc1 lds
    buffer_load_dwordx4 v0, s[8:11], s26 offen offset:1024 sc1 lds
    v_mov_b64 v[68:69], 0
    v_mov_b64 v[70:71], 0
    v_mov_b64 v[64:65], 0
    v_mov_b64 v[66:67], 0
    v_mov_b64 v[60:61], 0
    v_mov_b64 v[62:63], 0
    v_mov_b64 v[56:57], 0
    v_mov_b64 v[58:59], 0
    s_waitcnt lgkmcnt(1)
    s_nop 0
    v_smfmac_f32_16x16x64_bf16 v[56:59], v[32:35], v[160:167], v1
    v_smfmac_f32_16x16x64_bf16 v[60:63], v[32:35], v[144:151], v1
    s_waitcnt lgkmcnt(0)
    v_smfmac_f32_16x16x64_bf16 v[56:59], v[52:55], v[152:159], v1
    v_smfmac_f32_16x16x64_bf16 v[60:63], v[52:55], v[136:143], v1
    v_smfmac_f32_16x16x64_bf16 v[64:67], v[32:35], v[128:135], v1
    v_smfmac_f32_16x16x64_bf16 v[68:71], v[32:35], v[112:119], v1
    v_permlane32_swap_b32 v56, v57
    v_smfmac_f32_16x16x64_bf16 v[64:67], v[52:55], v[120:127], v1
    v_permlane32_swap_b32 v58, v59
    v_smfmac_f32_16x16x64_bf16 v[68:71], v[52:55], v[104:111], v1
    v_add_f32 v56, v56, v57
    v_add_f32 v58, v58, v59
    v_smfmac_f32_16x16x64_bf16 v[44:47], v[32:35], v[96:103], v1
    v_permlane32_swap_b32 v60, v61
    v_smfmac_f32_16x16x64_bf16 v[44:47], v[52:55], v[88:95], v1
    v_permlane32_swap_b32 v62, v63
    v_add_f32 v60, v60, v61
    v_add_f32 v62, v62, v63
    v_cvt_pk_bf16_f32 v36, v56, v60
    v_cvt_pk_bf16_f32 v38, v58, v62
    v_permlane32_swap_b32 v64, v65
    v_permlane32_swap_b32 v66, v67
    v_add_f32 v64, v64, v65
    v_add_f32 v66, v66, v67
    v_permlane32_swap_b32 v68, v69
    v_permlane32_swap_b32 v70, v71
    v_add_f32 v68, v68, v69
    v_add_f32 v70, v70, v71
    v_cvt_pk_bf16_f32 v37, v64, v68
    v_cvt_pk_bf16_f32 v39, v66, v70
    buffer_store_dwordx4 v[36:39], v0, s[8:11], s58 offen
    v_permlane32_swap_b32 v44, v45
    v_permlane32_swap_b32 v46, v47
    v_add_f32 v44, v44, v45
    v_add_f32 v46, v46, v47
    v_cvt_pk_bf16_f32 v44, v44, v46
    buffer_store_dword v44, v7, s[8:11], s55 offen
    s_add_u32 s27, s44, 1
    s_and_b32 s27, s27, 3
    s_mul_i32 s48, s27, 5120
    s_add_u32 s48, s48, s41
    s_lshl_b32 s27, s27, 15
    s_add_u32 s49, s27, s47
    ds_read_b128 v[56:59], v5 offset:0
    ds_read_b128 v[60:63], v5 offset:1024
    ds_read_b128 v[64:67], v5 offset:2048
    ds_read_b128 v[68:71], v5 offset:3072
    v_mov_b64 v[12:13], 0
    v_mov_b64 v[14:15], 0
    v_mov_b64 v[16:17], 0
    v_mov_b64 v[18:19], 0
    v_mov_b64 v[20:21], 0
    v_mov_b64 v[22:23], 0
    v_mov_b64 v[24:25], 0
    v_mov_b64 v[26:27], 0
    v_mov_b64 v[28:29], 0
    v_mov_b64 v[30:31], 0
    v_mov_b64 v[32:33], 0
    v_mov_b64 v[34:35], 0
    ds_read_b64 v[10:11], v0 offset:23296
    s_waitcnt lgkmcnt(0)
    v_min_u32 v10, v10, v11
    s_nop 0
    v_readfirstlane_b32 s28, v10
    s_nop 0
    s_max_u32 s54, s54, s28
    s_barrier
    s_and_b32 s26, s44, 63
    s_add_u32 s26, s26, 2
    s_min_u32 s26, s26, 63
    s_lshl_b32 s26, s26, 18
    s_add_u32 s26, s26, s50
    s_add_u32 s26, s26, 6144
    s_add_u32 s3, s26, 16777216
    s_lshl_b32 s4, s44, 18
    s_add_u32 s4, s4, s53
    s_add_u32 s44, s44, 1
    s_and_b32 s55, s44, 3
    s_mul_i32 s55, s55, 167936
    s_add_u32 s55, s55, s34
    s_add_u32 s58, s55, s35
    s_and_b32 s57, s44, 63
    s_add_u32 s42, s44, 2
    s_or_b32 s28, s44, 63
    s_add_u32 s28, s28, 1
    s_min_u32 s42, s42, s28
    s_sub_u32 s61, s26, 6144
    s_cmp_ge_u32 s54, s42
    s_cselect_b32 s61, s61, 0x10000000
    s_nop 15
    s_nop 15
    s_nop 5
    s_mov_b32 m0, 13312
    s_nop 0
    buffer_load_dwordx4 v0, s[8:11], s48 offen offset:3072 sc1 lds
    s_mov_b32 m0, 17408
    s_add_u32 s59, s48, 4096
    buffer_load_dwordx4 v0, s[8:11], s59 offen offset:0 sc1 lds
    s_nop 13
    s_mov_b32 m0, 13312
    s_nop 0
    buffer_load_dwordx4 v0, s[8:11], s48 offen offset:3072 sc1 lds
    s_mov_b32 m0, 17408
    s_add_u32 s59, s48, 4096
    buffer_load_dwordx4 v0, s[8:11], s59 offen offset:0 sc1 lds
    s_nop 13
    s_mov_b32 m0, 13312
    s_nop 0
    buffer_load_dwordx4 v0, s[8:11], s48 offen offset:3072 sc1 lds
    s_mov_b32 m0, 17408
    s_add_u32 s59, s48, 4096
    buffer_load_dwordx4 v0, s[8:11], s59 offen offset:0 sc1 lds
    s_mov_b32 s70, 0
    s_branch M_c0_3_top
M_c0_3_restart:
    s_waitcnt vmcnt(0) lgkmcnt(0)
    s_nop 7
    s_barrier
    s_mov_b32 m0, 13312
    s_nop 0
    buffer_load_dwordx4 v0, s[8:11], s48 offen offset:3072 sc1 lds
    s_mov_b32 m0, 17408
    s_add_u32 s59, s48, 4096
    buffer_load_dwordx4 v0, s[8:11], s59 offen offset:0 sc1 lds
    ds_read_b128 v[56:59], v5 offset:0
    ds_read_b128 v[60:63], v5 offset:1024
    ds_read_b128 v[64:67], v5 offset:2048
    ds_read_b128 v[68:71], v5 offset:3072
    v_mov_b64 v[12:13], 0
    v_mov_b64 v[14:15], 0
    v_mov_b64 v[16:17], 0
    v_mov_b64 v[18:19], 0
    v_mov_b64 v[20:21], 0
    v_mov_b64 v[22:23], 0
    v_mov_b64 v[24:25], 0
    v_mov_b64 v[26:27], 0
    v_mov_b64 v[28:29], 0
    v_mov_b64 v[30:31], 0
    v_mov_b64 v[32:33], 0
    v_mov_b64 v[34:35], 0
    s_waitcnt vmcnt(0) lgkmcnt(0)
    s_branch M_c0_3_top
M_c0_3_zbad:
    s_cmp_eq_u32 s70, 2
    s_cbranch_scc1 M_c0_3_zok
    v_cmp_u_f32 vcc, v72, v72
    s_cbranch_vccz M_c0_3_exact
    s_cmp_eq_u32 s70, 1
    s_cbranch_scc1 M_c0_3_exact
M_c0_3_vfy0:
    s_mov_b32 s70, 1
    s_mov_b32 s30, 0
    s_waitcnt vmcnt(0) lgkmcnt(0)
    s_nop 7
M_c0_3_vfy:
    v_mov_b32 v10, 0
    s_add_u32 s59, s48, 4096
    buffer_load_dwordx4 v[36:39], v0, s[8:11], s48 offen offset:0 sc1
    buffer_load_dwordx4 v[40:43], v0, s[8:11], s48 offen offset:1024 sc1
    buffer_load_dwordx4 v[44:47], v0, s[8:11], s48 offen offset:2048 sc1
    buffer_load_dwordx4 v[48:51], v0, s[8:11], s48 offen offset:3072 sc1
    buffer_load_dwordx4 v[52:55], v0, s[8:11], s59 offen offset:0 sc1
    s_waitcnt vmcnt(4)
    v_max3_u32 v10, v10, v36, v37
    v_max3_u32 v10, v10, v38, v39
    s_waitcnt vmcnt(3)
    v_max3_u32 v10, v10, v40, v41
    v_max3_u32 v10, v10, v42, v43
    s_waitcnt vmcnt(2)
    v_max3_u32 v10, v10, v44, v45
    v_max3_u32 v10, v10, v46, v47
    s_waitcnt vmcnt(1)
    v_max3_u32 v10, v10, v48, v49
    v_max3_u32 v10, v10, v50, v51
    s_waitcnt vmcnt(0)
    v_max3_u32 v10, v10, v52, v53
    v_max3_u32 v10, v10, v54, v55
    s_add_u32 s59, s49, 4096
    buffer_load_dwordx4 v[36:39], v0, s[8:11], s49 offen offset:0 sc1
    buffer_load_dwordx4 v[40:43], v0, s[8:11], s49 offen offset:1024 sc1
    buffer_load_dwordx4 v[44:47], v0, s[8:11], s49 offen offset:2048 sc1
    buffer_load_dwordx4 v[48:51], v0, s[8:11], s49 offen offset:3072 sc1
    buffer_load_dwordx4 v[52:55], v0, s[8:11], s59 offen offset:0 sc1
    s_waitcnt vmcnt(4)
    v_max3_u32 v10, v10, v36, v37
    v_max3_u32 v10, v10, v38, v39
    s_waitcnt vmcnt(3)
    v_max3_u32 v10, v10, v40, v41
    v_max3_u32 v10, v10, v42, v43
    s_waitcnt vmcnt(2)
    v_max3_u32 v10, v10, v44, v45
    v_max3_u32 v10, v10, v46, v47
    s_waitcnt vmcnt(1)
    v_max3_u32 v10, v10, v48, v49
    v_max3_u32 v10, v10, v50, v51
    s_waitcnt vmcnt(0)
    v_max3_u32 v10, v10, v52, v53
    v_max3_u32 v10, v10, v54, v55
    v_cmp_eq_u32 vcc, -1, v10
    s_cbranch_vccz M_c0_3_restart
    s_add_u32 s30, s30, 1
    s_cmp_ge_u32 s30, 60000
    s_cbranch_scc1 M_fail
    s_branch M_c0_3_vfy
M_c0_3_exact:
    s_nop 7
    s_mov_b32 s70, 2
    s_waitcnt lgkmcnt(0)
    ds_read_b128 v[20:23], v3 offset:18432
    ds_read_b128 v[24:27], v3 offset:18496
    ds_read_b128 v[72:75], v3 offset:18560
    ds_read_b128 v[44:47], v3 offset:18624
    ds_read_b128 v[56:59], v0 offset:0
    s_waitcnt lgkmcnt(0)
    v_mfma_f32_16x16x32_bf16 v[28:31], v[56:59], v[20:23], 0
    s_nop 3
    ds_read_b128 v[60:63], v0 offset:1024
    s_waitcnt lgkmcnt(0)
    v_mfma_f32_16x16x32_bf16 v[28:31], v[60:63], v[24:27], v[28:31]
    s_nop 3
    ds_read_b128 v[56:59], v0 offset:2048
    s_waitcnt lgkmcnt(0)
    v_mfma_f32_16x16x32_bf16 v[28:31], v[56:59], v[72:75], v[28:31]
    s_nop 3
    ds_read_b128 v[60:63], v0 offset:3072
    s_waitcnt lgkmcnt(0)
    v_mfma_f32_16x16x32_bf16 v[28:31], v[60:63], v[44:47], v[28:31]
    s_nop 3
    ds_read_b128 v[56:59], v0 offset:4096
    s_waitcnt lgkmcnt(0)
    v_mfma_f32_16x16x32_bf16 v[32:35], v[56:59], v[20:23], 0
    s_nop 3
    ds_read_b128 v[60:63], v0 offset:5120
    s_waitcnt lgkmcnt(0)
    v_mfma_f32_16x16x32_bf16 v[32:35], v[60:63], v[24:27], v[32:35]
    s_nop 3
    ds_read_b128 v[56:59], v0 offset:6144
    s_waitcnt lgkmcnt(0)
    v_mfma_f32_16x16x32_bf16 v[32:35], v[56:59], v[72:75], v[32:35]
    s_nop 3
    ds_read_b128 v[60:63], v0 offset:7168
    s_waitcnt lgkmcnt(0)
    v_mfma_f32_16x16x32_bf16 v[32:35], v[60:63], v[44:47], v[32:35]
    s_nop 3
    ds_read_b128 v[56:59], v3 offset:20736
    s_waitcnt lgkmcnt(0)
    v_mfma_f32_16x16x32_bf16 v[40:43], v[56:59], v[20:23], 0
    s_nop 3
    ds_read_b128 v[60:63], v3 offset:20800
    s_waitcnt lgkmcnt(0)
    v_mfma_f32_16x16x32_bf16 v[40:43], v[60:63], v[24:27], v[40:43]
    s_nop 3
    ds_read_b128 v[56:59], v3 offset:20864
    s_waitcnt lgkmcnt(0)
    v_mfma_f32_16x16x32_bf16 v[40:43], v[56:59], v[72:75], v[40:43]
    s_nop 3
    ds_read_b128 v[60:63], v3 offset:20928
    s_waitcnt lgkmcnt(0)
    v_mfma_f32_16x16x32_bf16 v[40:43], v[60:63], v[44:47], v[40:43]
    s_nop 3
    v_max3_f32 v68, v28, v29, v30
    v_max3_f32 v68, v68, v31, v32
    v_max3_f32 v68, v68, v33, v34
    s_nop 0
    v_max3_f32 v68, v68, v35, v40
    v_max3_f32 v68, v68, v41, v42
    v_max_f32 v68, v68, v43
    v_mov_b32 v69, v68
    s_nop 1
    v_permlane16_swap_b32 v68, v69
    v_max_f32 v68, v68, v69
    v_mov_b32 v69, v68
    s_nop 1
    v_permlane32_swap_b32 v68, v69
    v_max_f32 v68, v68, v69
    v_sub_f32 v28, v28, v68
    v_exp_f32 v28, v28
    v_sub_f32 v29, v29, v68
    v_exp_f32 v29, v29
    v_sub_f32 v30, v30, v68
    v_exp_f32 v30, v30
    v_sub_f32 v31, v31, v68
    v_exp_f32 v31, v31
    v_sub_f32 v32, v32, v68
    v_exp_f32 v32, v32
    v_sub_f32 v33, v33, v68
    v_exp_f32 v33, v33
    v_sub_f32 v34, v34, v68
    v_exp_f32 v34, v34
    v_sub_f32 v35, v35, v68
    v_exp_f32 v35, v35
    v_sub_f32 v40, v40, v68
    v_exp_f32 v40, v40
    v_sub_f32 v41, v41, v68
    v_exp_f32 v41, v41
    v_sub_f32 v42, v42, v68
    v_exp_f32 v42, v42
    v_sub_f32 v43, v43, v68
    v_exp_f32 v43, v43
    v_cvt_pk_bf16_f32 v28, v28, v29
    v_cvt_pk_bf16_f32 v29, v30, v31
    v_cvt_pk_bf16_f32 v30, v32, v33
    v_cvt_pk_bf16_f32 v31, v34, v35
    v_cvt_pk_bf16_f32 v40, v40, v41
    v_cvt_pk_bf16_f32 v41, v42, v43
    v_mfma_f32_16x16x32_bf16 v[20:23], v[80:83], v[28:31], 0
    v_mfma_f32_16x16x32_bf16 v[24:27], v[84:87], v[28:31], 0
    v_mfma_f32_16x16x32_bf16 v[72:75], v[64:67], v[28:31], 0
    ds_read_b128 v[60:63], v3 offset:20928
    s_waitcnt lgkmcnt(0)
    s_nop 7
    v_mfma_f32_16x16x16_bf16 v[72:75], v[10:11], v[40:41], v[72:75]
    s_nop 7
    s_branch M_c0_3_fin
M_c0_3_last:
    s_cmp_lg_u32 s70, 0
    s_cbranch_scc1 M_c0_3_last2
    v_cmp_u_f32 vcc, v32, v32
    s_cbranch_vccnz M_c0_3_vfy0
M_c0_3_last2:
    s_lshl_b32 s4, s44, 18
    s_add_u32 s4, s4, s53
    buffer_store_dwordx4 v[76:79], v0, s[8:11], s4 offen offset:3072 sc1
    s_mov_b32 s4, 0x10000000
    s_waitcnt vmcnt(0) lgkmcnt(0)
    s_barrier
    s_nop 7
    v_mov_b64 v[72:73], -1
    v_mov_b64 v[74:75], -1
    s_add_u32 s28, s44, 3
    s_and_b32 s29, s28, 3
    s_mul_i32 s31, s22, 160
    s_waitcnt vmcnt(0)
    s_add_u32 s44, s44, 1
    s_cmp_eq_u32 s44, 128
    s_cbranch_scc1 M_end
    s_branch M_c0_3_layer
M_c0_3_lr:
    s_mov_b32 s30, 0
M_c0_3_lr_l:
    s_waitcnt lgkmcnt(0)
    s_and_b32 s27, s30, 1
    s_cbranch_scc0 M_c0_3_lr_n
    s_waitcnt vmcnt(2)
    s_mov_b32 m0, 13312
    s_nop 0
    buffer_load_dwordx4 v0, s[8:11], s48 offen offset:3072 sc1 lds
    s_mov_b32 m0, 17408
    s_add_u32 s59, s48, 4096
    buffer_load_dwordx4 v0, s[8:11], s59 offen offset:0 sc1 lds
M_c0_3_lr_n:
    ds_read_b128 v[36:39], v6 offset:13312
    ds_read_b128 v[40:43], v6 offset:14336
    ds_read_b128 v[44:47], v6 offset:15360
    ds_read_b128 v[48:51], v6 offset:16384
    ds_read_b128 v[52:55], v6 offset:17408
    s_waitcnt lgkmcnt(2)
    v_max3_u32 v10, v36, v40, v44
    s_waitcnt lgkmcnt(0)
    v_max3_u32 v10, v10, v48, v52
    v_cmp_eq_u32 vcc, -1, v10
    s_cbranch_vccz M_c0_3_lr_d
    s_add_u32 s30, s30, 1
    s_cmp_ge_u32 s30, 480000
    s_cbranch_scc1 M_fail
    s_branch M_c0_3_lr_l
M_c0_3_lr_d:
    ds_read_b128 v[56:59], v5 offset:0
    ds_read_b128 v[60:63], v5 offset:1024
    ds_read_b128 v[64:67], v5 offset:2048
    ds_read_b128 v[68:71], v5 offset:3072
    v_mov_b64 v[12:13], 0
    v_mov_b64 v[14:15], 0
    v_mov_b64 v[16:17], 0
    v_mov_b64 v[18:19], 0
    v_mov_b64 v[20:21], 0
    v_mov_b64 v[22:23], 0
    v_mov_b64 v[24:25], 0
    v_mov_b64 v[26:27], 0
    v_mov_b64 v[28:29], 0
    v_mov_b64 v[30:31], 0
    v_mov_b64 v[32:33], 0
    v_mov_b64 v[34:35], 0
    s_waitcnt lgkmcnt(0)
    s_branch M_c0_3_lr_r
M_c0_3_rr:
    s_mov_b32 s30, 0
M_c0_3_rr_l:
    s_waitcnt lgkmcnt(0)
    s_and_b32 s27, s30, 1
    s_cbranch_scc1 M_c0_3_rr_n
    s_waitcnt vmcnt(1)
    s_mov_b32 m0, 12288
    s_add_u32 s59, s49, 4096
    buffer_load_dwordx4 v0, s[8:11], s59 offen offset:0 sc1 lds
M_c0_3_rr_n:
    ds_read_b128 v[36:39], v6 offset:8192
    ds_read_b128 v[40:43], v6 offset:9216
    ds_read_b128 v[44:47], v6 offset:10240
    ds_read_b128 v[48:51], v6 offset:11264
    ds_read_b32 v11, v6 offset:12288
    s_waitcnt lgkmcnt(2)
    v_max3_u32 v10, v36, v40, v44
    s_waitcnt lgkmcnt(0)
    v_max3_u32 v10, v10, v48, v11
    v_cmp_eq_u32 vcc, -1, v10
    s_cbranch_vccz M_c0_3_rr_d
    s_add_u32 s30, s30, 1
    s_cmp_ge_u32 s30, 480000
    s_cbranch_scc1 M_fail
    s_branch M_c0_3_rr_l
M_c0_3_rr_d:
    s_branch M_c0_3_rr_r
M_c0_3_first:
    s_mul_i32 s27, s21, 167936
    s_add_u32 s27, s27, s34
    s_mul_i32 s28, s22, 4224
    s_add_u32 s28, s28, s27
    s_mov_b32 exec_hi, 0
    buffer_load_dword v10, v9, s[8:11], s28 offen sc1
    s_lshl_b32 s28, s22, 10
    s_add_u32 s28, s28, s27
    s_add_u32 s28, s28, 135168
    s_mov_b64 exec, 0xff
    buffer_load_dword v10, v9, s[8:11], s28 offen sc1
    s_mul_i32 s27, s21, 5120
    s_add_u32 s27, s27, s41
    s_mul_i32 s28, s22, 160
    s_add_u32 s28, s28, s27
    s_mov_b64 exec, 3
    buffer_load_dword v10, v9, s[8:11], s28 offen sc1
    s_mov_b64 exec, -1
    s_add_u32 s27, s44, 1
    s_or_b32 s28, s44, 63
    s_add_u32 s28, s28, 1
    s_min_u32 s27, s27, s28
    s_cmp_lt_u32 s54, s27
    s_cbranch_scc1 M_c0_3_p1
M_c0_3_p1_r:
    s_barrier
    s_and_b32 s26, s44, 63
    s_lshl_b32 s26, s26, 18
    s_add_u32 s26, s26, s50
    s_add_u32 s26, s26, 6144
    s_add_u32 s3, s26, 16777216
    s_mov_b32 m0, 6144
    s_nop 0
    buffer_load_dwordx4 v0, s[8:11], s26 offen offset:0 sc1 lds
    buffer_load_dwordx4 v0, s[8:11], s26 offen offset:1024 sc1 lds
    buffer_load_dwordx4 v[80:83], v0, s[8:11], s3 offen offset:0 sc1
    buffer_load_dwordx4 v[84:87], v0, s[8:11], s3 offen offset:1024 sc1
    s_and_b32 s26, s44, 63
    s_add_u32 s26, s26, 1
    s_min_u32 s26, s26, 63
    s_lshl_b32 s26, s26, 18
    s_add_u32 s26, s26, s50
    s_add_u32 s26, s26, 6144
    s_add_u32 s3, s26, 16777216
    s_waitcnt vmcnt(0) lgkmcnt(0)
    s_barrier
    s_branch M_c0_3_first_r
M_c0_3_first2:
    ds_read_b64 v[10:11], v0 offset:23296
    s_waitcnt lgkmcnt(0)
    v_min_u32 v10, v10, v11
    s_nop 0
    v_readfirstlane_b32 s28, v10
    s_nop 0
    s_max_u32 s54, s54, s28
    s_add_u32 s27, s44, 2
    s_or_b32 s28, s44, 63
    s_add_u32 s28, s28, 1
    s_min_u32 s27, s27, s28
    s_cmp_lt_u32 s54, s27
    s_cbranch_scc1 M_c0_3_p2
M_c0_3_p2_r:
    s_branch M_c0_3_first2_r
M_c0_3_p1:
    s_mov_b32 s30, 0
M_c0_3_p1_l:
    s_waitcnt lgkmcnt(0)
    s_mov_b64 exec, 3
    buffer_load_dword v10, v9, s[8:11], s51 offen sc1
    s_waitcnt vmcnt(0)
    s_mov_b64 exec, -1
    v_readlane_b32 s54, v10, 0
    v_readlane_b32 s28, v10, 1
    s_nop 3
    s_min_u32 s54, s54, s28
    s_cmp_ge_u32 s54, s27
    s_cbranch_scc1 M_c0_3_p1_r
    s_sleep 2
    s_add_u32 s30, s30, 1
    s_cmp_ge_u32 s30, 240000
    s_cbranch_scc1 M_fail
    s_branch M_c0_3_p1_l
M_c0_3_p2:
    s_mov_b32 s30, 0
M_c0_3_p2_l:
    s_waitcnt lgkmcnt(0)
    s_mov_b64 exec, 3
    buffer_load_dword v10, v9, s[8:11], s51 offen sc1
    s_waitcnt vmcnt(0)
    s_mov_b64 exec, -1
    v_readlane_b32 s54, v10, 0
    v_readlane_b32 s28, v10, 1
    s_nop 3
    s_min_u32 s54, s54, s28
    s_cmp_ge_u32 s54, s27
    s_cbranch_scc1 M_c0_3_p2_r
    s_sleep 2
    s_add_u32 s30, s30, 1
    s_cmp_ge_u32 s30, 240000
    s_cbranch_scc1 M_fail
    s_branch M_c0_3_p2_l
M_c_slow:
    s_cmp_eq_u32 s21, 1
    s_cbranch_scc1 M_c1_1_layer
    s_cmp_eq_u32 s21, 2
    s_cbranch_scc1 M_c1_2_layer
    s_cmp_eq_u32 s21, 3
    s_cbranch_scc1 M_c1_3_layer
M_c1_0_layer:
    s_lshr_b32 s27, s44, 6
    s_mul_i32 s50, s27, 33554432
    s_lshl_b32 s27, s22, 13
    s_add_u32 s50, s50, s27
    s_add_u32 s50, s50, 37748736
    s_barrier
    s_mov_b32 s26, 0x10010000
    s_mov_b32 s3, s26
    s_mul_i32 s27, s20, 5120
    s_add_u32 s48, s27, 167772160
    s_sub_u32 s49, 167777280, s27
    s_and_b32 s55, s44, 3
    s_mul_i32 s55, s55, 167936
    s_add_u32 s55, s55, s34
    s_add_u32 s58, s55, s35
    s_and_b32 s57, s44, 63
    s_add_u32 s43, s55, s32
    s_add_u32 s61, s43, 33792
    s_add_u32 s100, s43, 67584
    s_add_u32 s101, s43, 101376
    s_add_u32 s42, s44, 2
    s_or_b32 s28, s44, 63
    s_add_u32 s28, s28, 1
    s_min_u32 s42, s42, s28
    ds_read_b128 v[56:59], v5 offset:0
    ds_read_b128 v[60:63], v5 offset:1024
    ds_read_b128 v[64:67], v5 offset:2048
    ds_read_b128 v[68:71], v5 offset:3072
    v_mov_b64 v[12:13], 0
    v_mov_b64 v[14:15], 0
    v_mov_b64 v[16:17], 0
    v_mov_b64 v[18:19], 0
    v_mov_b64 v[20:21], 0
    v_mov_b64 v[22:23], 0
    v_mov_b64 v[24:25], 0
    v_mov_b64 v[26:27], 0
    v_mov_b64 v[28:29], 0
    v_mov_b64 v[30:31], 0
    v_mov_b64 v[32:33], 0
    v_mov_b64 v[34:35], 0
    s_mov_b32 s70, 0
    s_waitcnt lgkmcnt(0)
M_c1_0_top:
    s_nop 0
    s_barrier
    ds_read_b128 v[36:39], v6 offset:13312
    ds_read_b128 v[40:43], v6 offset:14336
    s_mov_b32 m0, 8192
    s_nop 0
    buffer_load_dwordx4 v0, s[8:11], s49 offen offset:0 sc1 lds
    buffer_load_dwordx4 v0, s[8:11], s49 offen offset:1024 sc1 lds
M_c1_0_lr_r:
    s_waitcnt lgkmcnt(1)
    v_smfmac_f32_16x16x64_bf16 v[20:23], v[36:39], v[56:63], v1
    ds_read_b128 v[56:59], v5 offset:4096
    v_smfmac_f32_16x16x64_bf16 v[24:27], v[36:39], v[64:71], v1
    ds_read_b128 v[60:63], v5 offset:5120
    v_smfmac_f32_16x16x64_bf16 v[28:31], v[36:39], a[248:255], v1
    ds_read_b128 v[64:67], v5 offset:6144
    v_smfmac_f32_16x16x64_bf16 v[32:35], v[36:39], a[240:247], v1
    ds_read_b128 v[68:71], v5 offset:7168
    v_smfmac_f32_16x16x64_bf16 v[12:15], v[36:39], a[232:239], v1
    ds_read_b128 v[44:47], v6 offset:15360
    s_waitcnt lgkmcnt(3)
    v_smfmac_f32_16x16x64_bf16 v[16:19], v[36:39], v[56:63], v1
    ds_read_b128 v[56:59], v5 offset:8192
    v_smfmac_f32_16x16x64_bf16 v[20:23], v[40:43], a[224:231], v1
    ds_read_b128 v[60:63], v5 offset:9216
    s_waitcnt lgkmcnt(3)
    v_smfmac_f32_16x16x64_bf16 v[24:27], v[40:43], v[64:71], v1
    ds_read_b128 v[64:67], v5 offset:10240
    v_smfmac_f32_16x16x64_bf16 v[28:31], v[40:43], a[216:223], v1
    ds_read_b128 v[68:71], v5 offset:11264
    v_smfmac_f32_16x16x64_bf16 v[32:35], v[40:43], a[208:215], v1
    ds_read_b128 v[48:51], v6 offset:16384
    s_waitcnt lgkmcnt(3)
    v_smfmac_f32_16x16x64_bf16 v[12:15], v[40:43], v[56:63], v1
    ds_read_b128 v[56:59], v5 offset:12288
    v_smfmac_f32_16x16x64_bf16 v[16:19], v[40:43], a[200:207], v1
    ds_read_b128 v[60:63], v5 offset:13312
    s_waitcnt lgkmcnt(3)
    v_smfmac_f32_16x16x64_bf16 v[20:23], v[44:47], v[64:71], v1
    ds_read_b128 v[64:67], v5 offset:14336
    v_smfmac_f32_16x16x64_bf16 v[24:27], v[44:47], a[192:199], v1
    ds_read_b128 v[68:71], v5 offset:15360
    v_smfmac_f32_16x16x64_bf16 v[28:31], v[44:47], a[184:191], v1
    ds_read_b128 v[52:55], v6 offset:17408
    s_waitcnt lgkmcnt(3)
    v_smfmac_f32_16x16x64_bf16 v[32:35], v[44:47], v[56:63], v1
    ds_read_b128 v[56:59], v5 offset:16384
    v_smfmac_f32_16x16x64_bf16 v[20:23], v[48:51], a[176:183], v1
    ds_read_b128 v[60:63], v5 offset:17408
    s_waitcnt lgkmcnt(3)
    v_max3_u32 v10, v36, v40, v44
    v_smfmac_f32_16x16x64_bf16 v[24:27], v[48:51], v[64:71], v1
    ds_read_b128 v[64:67], v5 offset:18432
    s_waitcnt lgkmcnt(3)
    v_max3_u32 v10, v10, v48, v52
    v_smfmac_f32_16x16x64_bf16 v[28:31], v[48:51], a[168:175], v1
    ds_read_b128 v[68:71], v5 offset:19456
    v_cmp_eq_u32 vcc, -1, v10
    v_smfmac_f32_16x16x64_bf16 v[32:35], v[48:51], a[160:167], v1
    s_cbranch_vccnz M_c1_0_lr
    s_waitcnt vmcnt(0)
    s_barrier
    ds_read_b128 v[36:39], v6 offset:8192
    ds_read_b128 v[40:43], v6 offset:9216
    s_waitcnt lgkmcnt(4)
    v_smfmac_f32_16x16x64_bf16 v[20:23], v[52:55], v[56:63], v1
    ds_read_b128 v[44:47], v6 offset:10240
    ds_read_b128 v[48:51], v6 offset:11264
    v_smfmac_f32_16x16x64_bf16 v[24:27], v[52:55], a[152:159], v1
    ds_read_b32 v11, v6 offset:12288
    ds_read_b128 v[56:59], v5 offset:20480
    s_waitcnt lgkmcnt(6)
    v_smfmac_f32_16x16x64_bf16 v[28:31], v[52:55], v[64:71], v1
    ds_read_b128 v[60:63], v5 offset:21504
    s_waitcnt lgkmcnt(4)
    v_max3_u32 v10, v36, v40, v44
    v_smfmac_f32_16x16x64_bf16 v[32:35], v[52:55], a[144:151], v1
    s_waitcnt lgkmcnt(2)
    v_max3_u32 v10, v10, v48, v11
    v_cmp_eq_u32 vcc, -1, v10
    s_cbranch_vccnz M_c1_0_rr
M_c1_0_rr_r:
    ds_read_b128 v[64:67], v5 offset:22528
    ds_read_b128 v[68:71], v5 offset:23552
    ds_read_b128 v[52:55], v6 offset:12288
    buffer_store_dwordx4 v[76:79], v0, s[8:11], s4 offen offset:0 sc1
    s_mov_b32 s4, 0x10000000
    s_mov_b64 exec, 0x3ff
    buffer_store_dwordx4 v[72:75], v0, s[8:11], s60 offen sc1
    s_mov_b64 exec, -1
    s_mov_b32 s60, 0x10000000
    v_smfmac_f32_16x16x64_bf16 v[20:23], v[36:39], a[136:143], v1
    s_waitcnt lgkmcnt(3)
    v_smfmac_f32_16x16x64_bf16 v[24:27], v[36:39], v[56:63], v1
    ds_read_b128 v[56:59], v5 offset:24576
    v_smfmac_f32_16x16x64_bf16 v[20:23], v[40:43], a[128:135], v1
    ds_read_b128 v[60:63], v5 offset:25600
    s_waitcnt lgkmcnt(3)
    v_smfmac_f32_16x16x64_bf16 v[24:27], v[40:43], v[64:71], v1
    ds_read_b128 v[64:67], v5 offset:26624
    v_smfmac_f32_16x16x64_bf16 v[20:23], v[44:47], a[120:127], v1
    ds_read_b128 v[68:71], v5 offset:27648
    v_smfmac_f32_16x16x64_bf16 v[24:27], v[44:47], a[112:119], v1
    s_waitcnt lgkmcnt(2)
    v_smfmac_f32_16x16x64_bf16 v[20:23], v[48:51], v[56:63], v1
    ds_read_b128 v[56:59], v5 offset:28672
    v_smfmac_f32_16x16x64_bf16 v[24:27], v[48:51], a[104:111], v1
    ds_read_b128 v[60:63], v5 offset:29696
    s_waitcnt lgkmcnt(2)
    v_smfmac_f32_16x16x64_bf16 v[20:23], v[52:55], v[64:71], v1
    ds_read_b128 v[64:67], v5 offset:30720
    v_smfmac_f32_16x16x64_bf16 v[24:27], v[52:55], a[96:103], v1
    ds_read_b128 v[68:71], v5 offset:31744
    v_smfmac_f32_16x16x64_bf16 v[28:31], v[36:39], a[88:95], v1
    s_cmp_eq_u32 s57, 0
    s_cbranch_scc1 M_c1_0_first
M_c1_0_first_r:
    s_waitcnt lgkmcnt(2)
    v_smfmac_f32_16x16x64_bf16 v[32:35], v[36:39], v[56:63], v1
    ds_read_b128 v[56:59], v5 offset:32768
    v_permlane32_swap_b32 v20, v21
    v_smfmac_f32_16x16x64_bf16 v[28:31], v[40:43], a[80:87], v1
    ds_read_b128 v[60:63], v5 offset:33792
    s_waitcnt lgkmcnt(2)
    v_permlane32_swap_b32 v22, v23
    v_smfmac_f32_16x16x64_bf16 v[32:35], v[40:43], v[64:71], v1
    ds_read_b128 v[64:67], v0 offset:2048
    v_permlane32_swap_b32 v24, v25
    v_smfmac_f32_16x16x64_bf16 v[28:31], v[44:47], a[72:79], v1
    ds_read_b128 v[68:71], v0 offset:3072
    v_permlane32_swap_b32 v26, v27
    v_smfmac_f32_16x16x64_bf16 v[32:35], v[44:47], a[64:71], v1
    s_waitcnt lgkmcnt(2)
    v_add_f32 v20, v20, v21
    v_add_f32 v22, v22, v23
    v_smfmac_f32_16x16x64_bf16 v[28:31], v[48:51], v[56:63], v1
    ds_read_b128 v[56:59], v0 offset:0
    v_add_f32 v24, v24, v25
    v_add_f32 v26, v26, v27
    v_smfmac_f32_16x16x64_bf16 v[32:35], v[48:51], a[56:63], v1
    ds_read_b128 v[60:63], v0 offset:1024
    v_mul_f32 v20, s40, v20
    v_mul_f32 v24, s40, v24
    v_smfmac_f32_16x16x64_bf16 v[28:31], v[52:55], a[48:55], v1
    v_mul_f32 v22, s40, v22
    v_mul_f32 v26, s40, v26
    v_smfmac_f32_16x16x64_bf16 v[32:35], v[52:55], a[40:47], v1
    v_cvt_pk_bf16_f32 v20, v20, v24
    v_cvt_pk_bf16_f32 v21, v22, v26
    v_smfmac_f32_16x16x64_bf16 v[12:15], v[36:39], a[32:39], v1
    ds_write_b32 v2, v20 offset:18432
    v_smfmac_f32_16x16x64_bf16 v[16:19], v[36:39], a[24:31], v1
    ds_write_b32 v2, v21 offset:19008
    v_permlane32_swap_b32 v28, v29
    v_smfmac_f32_16x16x64_bf16 v[12:15], v[40:43], a[16:23], v1
    ds_read_b128 v[36:39], v6 offset:15360
    v_permlane32_swap_b32 v30, v31
    v_smfmac_f32_16x16x64_bf16 v[16:19], v[40:43], a[8:15], v1
    ds_read_b128 v[40:43], v6 offset:16384
    v_permlane32_swap_b32 v32, v33
    v_smfmac_f32_16x16x64_bf16 v[12:15], v[44:47], a[0:7], v1
    s_waitcnt lgkmcnt(2)
    s_barrier
    v_permlane32_swap_b32 v34, v35
    v_smfmac_f32_16x16x64_bf16 v[16:19], v[44:47], v[248:255], v1
    ds_read_b128 v[20:23], v3 offset:18432
    v_add_f32 v28, v28, v29
    v_add_f32 v30, v30, v31
    v_smfmac_f32_16x16x64_bf16 v[12:15], v[48:51], v[240:247], v1
    ds_read_b128 v[24:27], v3 offset:18496
    v_add_f32 v32, v32, v33
    v_add_f32 v34, v34, v35
    v_smfmac_f32_16x16x64_bf16 v[16:19], v[48:51], v[232:239], v1
    ds_read_b128 v[72:75], v3 offset:18560
    v_cvt_pk_bf16_f32 v28, v28, v32
    v_cvt_pk_bf16_f32 v29, v30, v34
    v_smfmac_f32_16x16x64_bf16 v[12:15], v[52:55], v[224:231], v1
    ds_write_b32 v2, v28 offset:20736
    ds_read_b128 v[44:47], v3 offset:18624
    v_smfmac_f32_16x16x64_bf16 v[16:19], v[52:55], v[216:223], v1
    ds_write_b32 v2, v29 offset:21312
    s_waitcnt lgkmcnt(7)
    v_smfmac_f32_16x16x64_bf16 v[12:15], v[36:39], v[208:215], v1
    ds_read_b128 v[48:51], v6 offset:17408
    v_mov_b64 v[10:11], s[16:17]
    v_smfmac_f32_16x16x64_bf16 v[16:19], v[36:39], v[200:207], v1
    s_waitcnt lgkmcnt(6)
    v_mfma_f32_16x16x32_bf16 v[28:31], v[56:59], v[20:23], 0
    ds_read_b128 v[56:59], v0 offset:4096
    s_waitcnt lgkmcnt(6)
    v_mfma_f32_16x16x32_bf16 v[28:31], v[60:63], v[24:27], v[28:31]
    ds_read_b128 v[60:63], v0 offset:5120
    s_waitcnt lgkmcnt(3)
    s_barrier
    v_mfma_f32_16x16x32_bf16 v[28:31], v[64:67], v[72:75], v[28:31]
    ds_read_b128 v[64:67], v0 offset:6144
    v_mfma_f32_16x16x32_bf16 v[28:31], v[68:71], v[44:47], v[28:31]
    ds_read_b128 v[68:71], v0 offset:7168
    v_smfmac_f32_16x16x64_bf16 v[12:15], v[40:43], v[192:199], v1
    ds_read_b128 v[36:39], v3 offset:20736
    v_smfmac_f32_16x16x64_bf16 v[16:19], v[40:43], v[184:191], v1
    ds_read_b128 v[52:55], v3 offset:20800
    s_waitcnt lgkmcnt(4)
    v_mfma_f32_16x16x32_bf16 v[32:35], v[56:59], v[20:23], 0
    s_nop 0
    v_exp_f32 v28, v28
    ds_read_b128 v[56:59], v3 offset:20864
    v_mfma_f32_16x16x32_bf16 v[32:35], v[60:63], v[24:27], v[32:35]
    s_waitcnt lgkmcnt(3)
    v_exp_f32 v29, v29
    ds_read_b128 v[60:63], v3 offset:20928
    v_mfma_f32_16x16x32_bf16 v[32:35], v[64:67], v[72:75], v[32:35]
    v_exp_f32 v30, v30
    v_mfma_f32_16x16x32_bf16 v[32:35], v[68:71], v[44:47], v[32:35]
    s_waitcnt lgkmcnt(3)
    v_exp_f32 v31, v31
    v_mfma_f32_16x16x32_bf16 v[40:43], v[36:39], v[20:23], 0
    s_waitcnt lgkmcnt(2)
    v_cvt_pk_bf16_f32 v28, v28, v29
    v_cvt_pk_bf16_f32 v29, v30, v31
    v_mfma_f32_16x16x32_bf16 v[40:43], v[52:55], v[24:27], v[40:43]
    s_waitcnt lgkmcnt(1)
    v_mov_b64 v[64:65], s[24:25]
    v_mov_b64 v[66:67], s[24:25]
    v_mfma_f32_16x16x32_bf16 v[40:43], v[56:59], v[72:75], v[40:43]
    s_waitcnt lgkmcnt(0)
    v_exp_f32 v32, v32
    v_mfma_f32_16x16x32_bf16 v[40:43], v[60:63], v[44:47], v[40:43]
    v_exp_f32 v33, v33
    v_smfmac_f32_16x16x64_bf16 v[12:15], v[48:51], v[176:183], v1
    v_exp_f32 v34, v34
    v_smfmac_f32_16x16x64_bf16 v[16:19], v[48:51], v[168:175], v1
    v_exp_f32 v35, v35
    v_cvt_pk_bf16_f32 v30, v32, v33
    v_cvt_pk_bf16_f32 v31, v34, v35
    s_nop 0
    v_exp_f32 v40, v40
    v_mfma_f32_16x16x32_bf16 v[72:75], v[64:67], v[28:31], 0
    v_exp_f32 v41, v41
    v_mfma_f32_16x16x32_bf16 v[20:23], v[80:83], v[28:31], 0
    v_exp_f32 v42, v42
    v_mfma_f32_16x16x32_bf16 v[24:27], v[84:87], v[28:31], 0
    v_exp_f32 v43, v43
    v_cvt_pk_bf16_f32 v40, v40, v41
    v_cvt_pk_bf16_f32 v41, v42, v43
    v_cvt_pk_bf16_f32 v12, v12, v13
    v_cvt_pk_bf16_f32 v13, v14, v15
    v_mfma_f32_16x16x16_bf16 v[72:75], v[10:11], v[40:41], v[72:75]
    v_cvt_pk_bf16_f32 v14, v16, v17
    v_cvt_pk_bf16_f32 v15, v18, v19
M_c1_0_fin:
    v_mfma_f32_16x16x16_bf16 v[20:23], v[12:13], v[40:41], v[20:23]
    s_cmp_eq_u32 s57, 63
    v_cndmask_b32_e64 v76, v12, v36, s[66:67]
    v_cndmask_b32_e64 v77, v13, v37, s[66:67]
    v_mfma_f32_16x16x16_bf16 v[24:27], v[14:15], v[40:41], v[24:27]
    v_cndmask_b32_e64 v78, v14, v38, s[66:67]
    v_cndmask_b32_e64 v79, v15, v39, s[66:67]
    s_cbranch_scc1 M_c1_0_last
    v_rcp_f32 v74, v72
    v_subrev_u32 v73, s68, v72
    v_cmp_lt_u32 vcc, s69, v73
    v_mov_b64 v[44:45], 0
    v_mov_b64 v[46:47], 0
    v_cndmask_b32_e64 v20, v20, v24, s[18:19]
    v_cndmask_b32_e64 v21, v21, v25, s[18:19]
    v_cndmask_b32_e64 v22, v22, v26, s[18:19]
    v_cndmask_b32_e64 v23, v23, v27, s[18:19]
    v_pk_mul_f32 v[20:21], v[20:21], v[74:75] op_sel_hi:[1,0]
    v_pk_mul_f32 v[22:23], v[22:23], v[74:75] op_sel_hi:[1,0]
    v_cvt_pk_bf16_f32 v20, v20, v21
    v_cvt_pk_bf16_f32 v21, v22, v23
    ds_write_b64 v0, v[20:21] offset:13312
    s_cbranch_vccnz M_c1_0_zbad
M_c1_0_zok:
    s_cmp_lt_u32 s54, s42
    s_cbranch_scc1 M_c1_0_first2
M_c1_0_first2_r:
    buffer_load_dwordx4 v[80:83], v0, s[8:11], s3 offen offset:0 sc1
    buffer_load_dwordx4 v[84:87], v0, s[8:11], s3 offen offset:1024 sc1
    s_waitcnt lgkmcnt(0)
    s_barrier
    ds_read_b128 v[32:35], v0 offset:13312
    ds_read_b128 v[52:55], v0 offset:14336
    s_mov_b32 m0, 0
    s_nop 0
    buffer_load_dwordx4 v0, s[8:11], s26 offen offset:0 sc1 lds
    buffer_load_dwordx4 v0, s[8:11], s26 offen offset:1024 sc1 lds
    v_mov_b64 v[68:69], 0
    v_mov_b64 v[70:71], 0
    v_mov_b64 v[64:65], 0
    v_mov_b64 v[66:67], 0
    v_mov_b64 v[60:61], 0
    v_mov_b64 v[62:63], 0
    v_mov_b64 v[56:57], 0
    v_mov_b64 v[58:59], 0
    s_waitcnt lgkmcnt(1)
    s_nop 0
    v_smfmac_f32_16x16x64_bf16 v[56:59], v[32:35], v[160:167], v1
    v_smfmac_f32_16x16x64_bf16 v[60:63], v[32:35], v[144:151], v1
    s_waitcnt lgkmcnt(0)
    v_smfmac_f32_16x16x64_bf16 v[56:59], v[52:55], v[152:159], v1
    v_smfmac_f32_16x16x64_bf16 v[60:63], v[52:55], v[136:143], v1
    v_smfmac_f32_16x16x64_bf16 v[64:67], v[32:35], v[128:135], v1
    v_smfmac_f32_16x16x64_bf16 v[68:71], v[32:35], v[112:119], v1
    v_permlane32_swap_b32 v56, v57
    v_smfmac_f32_16x16x64_bf16 v[64:67], v[52:55], v[120:127], v1
    v_permlane32_swap_b32 v58, v59
    v_smfmac_f32_16x16x64_bf16 v[68:71], v[52:55], v[104:111], v1
    v_add_f32 v56, v56, v57
    v_add_f32 v58, v58, v59
    v_smfmac_f32_16x16x64_bf16 v[44:47], v[32:35], v[96:103], v1
    v_permlane32_swap_b32 v60, v61
    v_smfmac_f32_16x16x64_bf16 v[44:47], v[52:55], v[88:95], v1
    v_permlane32_swap_b32 v62, v63
    v_add_f32 v60, v60, v61
    v_add_f32 v62, v62, v63
    v_cvt_pk_bf16_f32 v36, v56, v60
    v_cvt_pk_bf16_f32 v38, v58, v62
    v_permlane32_swap_b32 v64, v65
    v_permlane32_swap_b32 v66, v67
    v_add_f32 v64, v64, v65
    v_add_f32 v66, v66, v67
    v_permlane32_swap_b32 v68, v69
    v_permlane32_swap_b32 v70, v71
    v_add_f32 v68, v68, v69
    v_add_f32 v70, v70, v71
    v_cvt_pk_bf16_f32 v37, v64, v68
    v_cvt_pk_bf16_f32 v39, v66, v70
    buffer_store_dwordx4 v[36:39], v0, s[8:11], s58 offen sc1
    v_permlane32_swap_b32 v44, v45
    v_permlane32_swap_b32 v46, v47
    v_add_f32 v44, v44, v45
    v_add_f32 v46, v46, v47
    v_cvt_pk_bf16_f32 v44, v44, v46
    buffer_store_dword v44, v7, s[8:11], s55 offen sc1
    v_and_b32 v32, 16, v0
    v_bfe_u32 v33, v0, 5, 2
    v_lshlrev_b32_e64 v32, v32, s45
    v_cmp_eq_u32_e64 s[64:65], 0, v33
    v_cmp_eq_u32_e64 vcc, 1, v33
    s_add_u32 s27, s44, 1
    s_and_b32 s27, s27, 3
    v_cndmask_b32_e64 v72, 0, v32, s[64:65]
    v_cndmask_b32_e64 v73, 0, v32, vcc
    v_cmp_eq_u32_e64 s[64:65], 2, v33
    v_cmp_eq_u32_e64 vcc, 3, v33
    s_mul_i32 s48, s27, 5120
    s_add_u32 s48, s48, s41
    v_cndmask_b32_e64 v74, 0, v32, s[64:65]
    v_cndmask_b32_e64 v75, 0, v32, vcc
    s_lshl_b32 s27, s27, 15
    s_add_u32 s49, s27, s47
    v_bfe_u32 v11, v0, 4, 3
    v_lshlrev_b32 v11, 3, v11
    v_lshrrev_b32 v32, 8, v0
    v_lshl_add_u32 v11, v32, 6, v11
    s_add_u32 s56, s27, s46
    s_add_u32 s56, s56, s33
    s_add_u32 s58, s48, s33
    s_nop 15
    s_nop 15
    buffer_load_dwordx4 v[12:15], v8, s[8:11], s43 offen sc1
    buffer_load_dwordx4 v[16:19], v8, s[8:11], s61 offen sc1
    buffer_load_dwordx4 v[20:23], v8, s[8:11], s100 offen sc1
    buffer_load_dwordx4 v[24:27], v8, s[8:11], s101 offen sc1
    s_nop 15
    s_nop 11
    buffer_load_dwordx4 v[40:43], v8, s[8:11], s43 offen sc1
    buffer_load_dwordx4 v[44:47], v8, s[8:11], s61 offen sc1
    buffer_load_dwordx4 v[48:51], v8, s[8:11], s100 offen sc1
    buffer_load_dwordx4 v[52:55], v8, s[8:11], s101 offen sc1
    s_nop 7
    s_waitcnt vmcnt(7)
    v_mfma_f32_16x16x32_bf16 v[28:31], v[72:75], v[12:15], 0
    s_waitcnt vmcnt(6)
    v_mfma_f32_16x16x32_bf16 v[28:31], v[72:75], v[16:19], v[28:31]
    s_waitcnt vmcnt(5)
    v_mfma_f32_16x16x32_bf16 v[28:31], v[72:75], v[20:23], v[28:31]
    s_waitcnt vmcnt(4)
    v_mfma_f32_16x16x32_bf16 v[28:31], v[72:75], v[24:27], v[28:31]
    v_max3_u32 v32, v12, v16, v20
    v_max_u32 v32, v32, v24
    v_cmp_eq_u32 vcc, -1, v32
    s_cbranch_vccnz M_c1_0_wq1
    v_mov_b32 v5, v5
    v_mov_b32 v5, v5
    v_mov_b32 v5, v5
    v_mov_b32 v5, v5
    v_add_f32_dpp v28, v28, v28 row_ror:8 row_mask:0xf bank_mask:0xf
    v_add_f32_dpp v29, v29, v29 row_ror:8 row_mask:0xf bank_mask:0xf
    v_add_f32_dpp v30, v30, v30 row_ror:8 row_mask:0xf bank_mask:0xf
    v_add_f32_dpp v31, v31, v31 row_ror:8 row_mask:0xf bank_mask:0xf
    v_cmp_u_f32 vcc, v28, v28
    v_cvt_pk_bf16_f32 v28, v28, v29
    v_cvt_pk_bf16_f32 v29, v30, v31
    s_cbranch_vccnz M_c1_0_wrb_e0
    s_mov_b64 exec, s[38:39]
    buffer_store_dwordx2 v[28:29], v11, s[8:11], s58 offen sc1
M_c1_0_wrb_d:
    s_barrier
    buffer_store_dwordx2 v[28:29], v11, s[8:11], s56 offen sc1
M_c1_0_wrb_g:
    s_mov_b64 exec, -1
    s_waitcnt vmcnt(2)
    ds_read_b128 v[56:59], v5 offset:0
    ds_read_b128 v[60:63], v5 offset:1024
    ds_read_b128 v[64:67], v5 offset:2048
    ds_read_b128 v[68:71], v5 offset:3072
    v_mov_b64 v[12:13], 0
    v_mov_b64 v[14:15], 0
    v_mov_b64 v[16:17], 0
    v_mov_b64 v[18:19], 0
    v_mov_b64 v[20:21], 0
    v_mov_b64 v[22:23], 0
    v_mov_b64 v[24:25], 0
    v_mov_b64 v[26:27], 0
    v_mov_b64 v[28:29], 0
    v_mov_b64 v[30:31], 0
    v_mov_b64 v[32:33], 0
    v_mov_b64 v[34:35], 0
    ds_read_b64 v[36:37], v0 offset:23296
    s_waitcnt lgkmcnt(0)
    v_min_u32 v36, v36, v37
    s_nop 0
    v_readfirstlane_b32 s28, v36
    s_nop 0
    s_max_u32 s54, s54, s28
    s_and_b32 s26, s44, 63
    s_add_u32 s26, s26, 2
    s_min_u32 s26, s26, 63
    s_lshl_b32 s26, s26, 18
    s_add_u32 s26, s26, s50
    s_add_u32 s3, s26, 16777216
    s_lshl_b32 s4, s44, 18
    s_add_u32 s4, s4, s53
    v_mov_b64 v[72:73], -1
    v_mov_b64 v[74:75], -1
    s_add_u32 s28, s44, 3
    s_and_b32 s29, s28, 3
    s_mul_i32 s31, s22, 160
    s_mul_i32 s28, s29, 167936
    s_add_u32 s28, s28, s34
    s_add_u32 s64, s28, s35
    s_mul_i32 s65, s29, 5120
    s_add_u32 s65, s65, s41
    s_add_u32 s65, s65, s31
    s_lshl_b32 s60, s29, 15
    s_add_u32 s60, s60, s47
    s_add_u32 s60, s60, s31
    s_add_u32 s44, s44, 1
    s_and_b32 s55, s44, 3
    s_mul_i32 s55, s55, 167936
    s_add_u32 s55, s55, s34
    s_add_u32 s58, s55, s35
    s_and_b32 s57, s44, 63
    s_add_u32 s43, s55, s32
    s_add_u32 s61, s43, 33792
    s_add_u32 s100, s43, 67584
    s_add_u32 s101, s43, 101376
    s_add_u32 s42, s44, 2
    s_or_b32 s28, s44, 63
    s_add_u32 s28, s28, 1
    s_min_u32 s42, s42, s28
    s_nop 15
    s_nop 15
    s_nop 1
    buffer_store_dwordx4 v[72:75], v0, s[8:11], s64 offen offset:0 sc1
    buffer_store_dwordx4 v[72:75], v0, s[8:11], s64 offen offset:1024 sc1
    s_mov_b64 exec, 0x3ff
    buffer_store_dwordx4 v[72:75], v0, s[8:11], s65 offen sc1
    s_mov_b64 exec, -1
    s_mov_b32 s65, 0x10000000
    s_mov_b32 s64, 0x10000000
    s_mov_b32 s70, 0
    s_branch M_c1_0_top
M_c1_0_restart:
    s_waitcnt vmcnt(0) lgkmcnt(0)
    s_nop 7
    s_barrier
    ds_read_b128 v[56:59], v5 offset:0
    ds_read_b128 v[60:63], v5 offset:1024
    ds_read_b128 v[64:67], v5 offset:2048
    ds_read_b128 v[68:71], v5 offset:3072
    v_mov_b64 v[12:13], 0
    v_mov_b64 v[14:15], 0
    v_mov_b64 v[16:17], 0
    v_mov_b64 v[18:19], 0
    v_mov_b64 v[20:21], 0
    v_mov_b64 v[22:23], 0
    v_mov_b64 v[24:25], 0
    v_mov_b64 v[26:27], 0
    v_mov_b64 v[28:29], 0
    v_mov_b64 v[30:31], 0
    v_mov_b64 v[32:33], 0
    v_mov_b64 v[34:35], 0
    s_waitcnt vmcnt(0) lgkmcnt(0)
    s_branch M_c1_0_top
M_c1_0_zbad:
    s_cmp_eq_u32 s70, 2
    s_cbranch_scc1 M_c1_0_zok
    v_cmp_u_f32 vcc, v72, v72
    s_cbranch_vccz M_c1_0_exact
    s_cmp_eq_u32 s70, 1
    s_cbranch_scc1 M_c1_0_exact
M_c1_0_vfy0:
    s_mov_b32 s70, 1
    s_mov_b32 s30, 0
    s_waitcnt vmcnt(0) lgkmcnt(0)
    s_nop 7
M_c1_0_vfy:
    v_mov_b32 v10, 0
    s_add_u32 s59, s48, 4096
    buffer_load_dwordx4 v[36:39], v0, s[8:11], s48 offen offset:0 sc1
    buffer_load_dwordx4 v[40:43], v0, s[8:11], s48 offen offset:1024 sc1
    buffer_load_dwordx4 v[44:47], v0, s[8:11], s48 offen offset:2048 sc1
    buffer_load_dwordx4 v[48:51], v0, s[8:11], s48 offen offset:3072 sc1
    buffer_load_dwordx4 v[52:55], v0, s[8:11], s59 offen offset:0 sc1
    s_waitcnt vmcnt(4)
    v_max3_u32 v10, v10, v36, v37
    v_max3_u32 v10, v10, v38, v39
    s_waitcnt vmcnt(3)
    v_max3_u32 v10, v10, v40, v41
    v_max3_u32 v10, v10, v42, v43
    s_waitcnt vmcnt(2)
    v_max3_u32 v10, v10, v44, v45
    v_max3_u32 v10, v10, v46, v47
    s_waitcnt vmcnt(1)
    v_max3_u32 v10, v10, v48, v49
    v_max3_u32 v10, v10, v50, v51
    s_waitcnt vmcnt(0)
    v_max3_u32 v10, v10, v52, v53
    v_max3_u32 v10, v10, v54, v55
    s_add_u32 s59, s49, 4096
    buffer_load_dwordx4 v[36:39], v0, s[8:11], s49 offen offset:0 sc1
    buffer_load_dwordx4 v[40:43], v0, s[8:11], s49 offen offset:1024 sc1
    buffer_load_dwordx4 v[44:47], v0, s[8:11], s49 offen offset:2048 sc1
    buffer_load_dwordx4 v[48:51], v0, s[8:11], s49 offen offset:3072 sc1
    buffer_load_dwordx4 v[52:55], v0, s[8:11], s59 offen offset:0 sc1
    s_waitcnt vmcnt(4)
    v_max3_u32 v10, v10, v36, v37
    v_max3_u32 v10, v10, v38, v39
    s_waitcnt vmcnt(3)
    v_max3_u32 v10, v10, v40, v41
    v_max3_u32 v10, v10, v42, v43
    s_waitcnt vmcnt(2)
    v_max3_u32 v10, v10, v44, v45
    v_max3_u32 v10, v10, v46, v47
    s_waitcnt vmcnt(1)
    v_max3_u32 v10, v10, v48, v49
    v_max3_u32 v10, v10, v50, v51
    s_waitcnt vmcnt(0)
    v_max3_u32 v10, v10, v52, v53
    v_max3_u32 v10, v10, v54, v55
    v_cmp_eq_u32 vcc, -1, v10
    s_cbranch_vccz M_c1_0_restart
    s_add_u32 s30, s30, 1
    s_cmp_ge_u32 s30, 60000
    s_cbranch_scc1 M_fail
    s_branch M_c1_0_vfy
M_c1_0_exact:
    s_nop 7
    s_mov_b32 s70, 2
    s_waitcnt lgkmcnt(0)
    ds_read_b128 v[20:23], v3 offset:18432
    ds_read_b128 v[24:27], v3 offset:18496
    ds_read_b128 v[72:75], v3 offset:18560
    ds_read_b128 v[44:47], v3 offset:18624
    ds_read_b128 v[56:59], v0 offset:0
    s_waitcnt lgkmcnt(0)
    v_mfma_f32_16x16x32_bf16 v[28:31], v[56:59], v[20:23], 0
    s_nop 3
    ds_read_b128 v[60:63], v0 offset:1024
    s_waitcnt lgkmcnt(0)
    v_mfma_f32_16x16x32_bf16 v[28:31], v[60:63], v[24:27], v[28:31]
    s_nop 3
    ds_read_b128 v[56:59], v0 offset:2048
    s_waitcnt lgkmcnt(0)
    v_mfma_f32_16x16x32_bf16 v[28:31], v[56:59], v[72:75], v[28:31]
    s_nop 3
    ds_read_b128 v[60:63], v0 offset:3072
    s_waitcnt lgkmcnt(0)
    v_mfma_f32_16x16x32_bf16 v[28:31], v[60:63], v[44:47], v[28:31]
    s_nop 3
    ds_read_b128 v[56:59], v0 offset:4096
    s_waitcnt lgkmcnt(0)
    v_mfma_f32_16x16x32_bf16 v[32:35], v[56:59], v[20:23], 0
    s_nop 3
    ds_read_b128 v[60:63], v0 offset:5120
    s_waitcnt lgkmcnt(0)
    v_mfma_f32_16x16x32_bf16 v[32:35], v[60:63], v[24:27], v[32:35]
    s_nop 3
    ds_read_b128 v[56:59], v0 offset:6144
    s_waitcnt lgkmcnt(0)
    v_mfma_f32_16x16x32_bf16 v[32:35], v[56:59], v[72:75], v[32:35]
    s_nop 3
    ds_read_b128 v[60:63], v0 offset:7168
    s_waitcnt lgkmcnt(0)
    v_mfma_f32_16x16x32_bf16 v[32:35], v[60:63], v[44:47], v[32:35]
    s_nop 3
    ds_read_b128 v[56:59], v3 offset:20736
    s_waitcnt lgkmcnt(0)
    v_mfma_f32_16x16x32_bf16 v[40:43], v[56:59], v[20:23], 0
    s_nop 3
    ds_read_b128 v[60:63], v3 offset:20800
    s_waitcnt lgkmcnt(0)
    v_mfma_f32_16x16x32_bf16 v[40:43], v[60:63], v[24:27], v[40:43]
    s_nop 3
    ds_read_b128 v[56:59], v3 offset:20864
    s_waitcnt lgkmcnt(0)
    v_mfma_f32_16x16x32_bf16 v[40:43], v[56:59], v[72:75], v[40:43]
    s_nop 3
    ds_read_b128 v[60:63], v3 offset:20928
    s_waitcnt lgkmcnt(0)
    v_mfma_f32_16x16x32_bf16 v[40:43], v[60:63], v[44:47], v[40:43]
    s_nop 3
    v_max3_f32 v68, v28, v29, v30
    v_max3_f32 v68, v68, v31, v32
    v_max3_f32 v68, v68, v33, v34
    s_nop 0
    v_max3_f32 v68, v68, v35, v40
    v_max3_f32 v68, v68, v41, v42
    v_max_f32 v68, v68, v43
    v_mov_b32 v69, v68
    s_nop 1
    v_permlane16_swap_b32 v68, v69
    v_max_f32 v68, v68, v69
    v_mov_b32 v69, v68
    s_nop 1
    v_permlane32_swap_b32 v68, v69
    v_max_f32 v68, v68, v69
    v_sub_f32 v28, v28, v68
    v_exp_f32 v28, v28
    v_sub_f32 v29, v29, v68
    v_exp_f32 v29, v29
    v_sub_f32 v30, v30, v68
    v_exp_f32 v30, v30
    v_sub_f32 v31, v31, v68
    v_exp_f32 v31, v31
    v_sub_f32 v32, v32, v68
    v_exp_f32 v32, v32
    v_sub_f32 v33, v33, v68
    v_exp_f32 v33, v33
    v_sub_f32 v34, v34, v68
    v_exp_f32 v34, v34
    v_sub_f32 v35, v35, v68
    v_exp_f32 v35, v35
    v_sub_f32 v40, v40, v68
    v_exp_f32 v40, v40
    v_sub_f32 v41, v41, v68
    v_exp_f32 v41, v41
    v_sub_f32 v42, v42, v68
    v_exp_f32 v42, v42
    v_sub_f32 v43, v43, v68
    v_exp_f32 v43, v43
    v_cvt_pk_bf16_f32 v28, v28, v29
    v_cvt_pk_bf16_f32 v29, v30, v31
    v_cvt_pk_bf16_f32 v30, v32, v33
    v_cvt_pk_bf16_f32 v31, v34, v35
    v_cvt_pk_bf16_f32 v40, v40, v41
    v_cvt_pk_bf16_f32 v41, v42, v43
    v_mfma_f32_16x16x32_bf16 v[20:23], v[80:83], v[28:31], 0
    v_mfma_f32_16x16x32_bf16 v[24:27], v[84:87], v[28:31], 0
    v_mfma_f32_16x16x32_bf16 v[72:75], v[64:67], v[28:31], 0
    ds_read_b128 v[36:39], v3 offset:20736
    s_waitcnt lgkmcnt(0)
    s_nop 7
    v_mfma_f32_16x16x16_bf16 v[72:75], v[10:11], v[40:41], v[72:75]
    s_nop 7
    s_branch M_c1_0_fin
M_c1_0_last:
    s_cmp_lg_u32 s70, 0
    s_cbranch_scc1 M_c1_0_last2
    v_cmp_u_f32 vcc, v32, v32
    s_cbranch_vccnz M_c1_0_vfy0
M_c1_0_last2:
    s_lshl_b32 s4, s44, 18
    s_add_u32 s4, s4, s53
    buffer_store_dwordx4 v[76:79], v0, s[8:11], s4 offen offset:0 sc1
    s_mov_b32 s4, 0x10000000
    s_waitcnt vmcnt(0) lgkmcnt(0)
    s_barrier
    s_nop 7
    v_mov_b64 v[72:73], -1
    v_mov_b64 v[74:75], -1
    s_add_u32 s28, s44, 3
    s_and_b32 s29, s28, 3
    s_mul_i32 s31, s22, 160
    s_mul_i32 s28, s29, 167936
    s_add_u32 s28, s28, s34
    s_add_u32 s64, s28, s35
    s_mul_i32 s65, s29, 5120
    s_add_u32 s65, s65, s41
    s_add_u32 s65, s65, s31
    s_lshl_b32 s60, s29, 15
    s_add_u32 s60, s60, s47
    s_add_u32 s60, s60, s31
    buffer_store_dwordx4 v[72:75], v0, s[8:11], s64 offen offset:0 sc1
    buffer_store_dwordx4 v[72:75], v0, s[8:11], s64 offen offset:1024 sc1
    s_mov_b64 exec, 0x3ff
    buffer_store_dwordx4 v[72:75], v0, s[8:11], s65 offen sc1
    s_mov_b64 exec, -1
    s_mov_b32 s65, 0x10000000
    s_mov_b32 s64, 0x10000000
    s_mov_b64 exec, 0x3ff
    buffer_store_dwordx4 v[72:75], v0, s[8:11], s60 offen sc1
    s_mov_b64 exec, -1
    s_mov_b32 s60, 0x10000000
    s_waitcnt vmcnt(0)
    s_add_u32 s44, s44, 1
    s_cmp_eq_u32 s44, 128
    s_cbranch_scc1 M_end
    s_branch M_c1_0_layer
M_c1_0_lr:
    s_mov_b32 s30, 0
M_c1_0_lr_l:
    s_waitcnt lgkmcnt(0)
    ds_read_b128 v[36:39], v6 offset:13312
    ds_read_b128 v[40:43], v6 offset:14336
    ds_read_b128 v[44:47], v6 offset:15360
    ds_read_b128 v[48:51], v6 offset:16384
    ds_read_b128 v[52:55], v6 offset:17408
    s_waitcnt lgkmcnt(2)
    v_max3_u32 v10, v36, v40, v44
    s_waitcnt lgkmcnt(0)
    v_max3_u32 v10, v10, v48, v52
    v_cmp_eq_u32 vcc, -1, v10
    s_cbranch_vccz M_c1_0_lr_d
    s_add_u32 s30, s30, 1
    s_cmp_ge_u32 s30, 480000
    s_cbranch_scc1 M_fail
    s_branch M_c1_0_lr_l
M_c1_0_lr_d:
    ds_read_b128 v[56:59], v5 offset:0
    ds_read_b128 v[60:63], v5 offset:1024
    ds_read_b128 v[64:67], v5 offset:2048
    ds_read_b128 v[68:71], v5 offset:3072
    v_mov_b64 v[12:13], 0
    v_mov_b64 v[14:15], 0
    v_mov_b64 v[16:17], 0
    v_mov_b64 v[18:19], 0
    v_mov_b64 v[20:21], 0
    v_mov_b64 v[22:23], 0
    v_mov_b64 v[24:25], 0
    v_mov_b64 v[26:27], 0
    v_mov_b64 v[28:29], 0
    v_mov_b64 v[30:31], 0
    v_mov_b64 v[32:33], 0
    v_mov_b64 v[34:35], 0
    s_waitcnt lgkmcnt(0)
    s_branch M_c1_0_lr_r
M_c1_0_rr:
    s_mov_b32 s30, 0
M_c1_0_rr_l:
    s_waitcnt lgkmcnt(0)
    s_and_b32 s27, s30, 1
    s_cbranch_scc1 M_c1_0_rr_n
    s_waitcnt vmcnt(2)
    s_mov_b32 m0, 8192
    s_nop 0
    buffer_load_dwordx4 v0, s[8:11], s49 offen offset:0 sc1 lds
    buffer_load_dwordx4 v0, s[8:11], s49 offen offset:1024 sc1 lds
M_c1_0_rr_n:
    ds_read_b128 v[36:39], v6 offset:8192
    ds_read_b128 v[40:43], v6 offset:9216
    ds_read_b128 v[44:47], v6 offset:10240
    ds_read_b128 v[48:51], v6 offset:11264
    ds_read_b32 v11, v6 offset:12288
    s_waitcnt lgkmcnt(2)
    v_max3_u32 v10, v36, v40, v44
    s_waitcnt lgkmcnt(0)
    v_max3_u32 v10, v10, v48, v11
    v_cmp_eq_u32 vcc, -1, v10
    s_cbranch_vccz M_c1_0_rr_d
    s_add_u32 s30, s30, 1
    s_cmp_ge_u32 s30, 480000
    s_cbranch_scc1 M_fail
    s_branch M_c1_0_rr_l
M_c1_0_rr_d:
    s_branch M_c1_0_rr_r
M_c1_0_first:
    s_mul_i32 s27, s21, 167936
    s_add_u32 s27, s27, s34
    s_mul_i32 s28, s22, 4224
    s_add_u32 s28, s28, s27
    s_mov_b32 exec_hi, 0
    buffer_load_dword v10, v9, s[8:11], s28 offen sc1
    s_lshl_b32 s28, s22, 10
    s_add_u32 s28, s28, s27
    s_add_u32 s28, s28, 135168
    s_mov_b64 exec, 0xff
    buffer_load_dword v10, v9, s[8:11], s28 offen sc1
    s_mul_i32 s27, s21, 5120
    s_add_u32 s27, s27, s41
    s_mul_i32 s28, s22, 160
    s_add_u32 s28, s28, s27
    s_mov_b64 exec, 3
    buffer_load_dword v10, v9, s[8:11], s28 offen sc1
    s_mov_b64 exec, -1
    s_barrier
    s_and_b32 s26, s44, 63
    s_lshl_b32 s26, s26, 18
    s_add_u32 s26, s26, s50
    s_add_u32 s3, s26, 16777216
    s_mov_b32 m0, 0
    s_nop 0
    buffer_load_dwordx4 v0, s[8:11], s26 offen offset:0 sc1 lds
    buffer_load_dwordx4 v0, s[8:11], s26 offen offset:1024 sc1 lds
    buffer_load_dwordx4 v[80:83], v0, s[8:11], s3 offen offset:0 sc1
    buffer_load_dwordx4 v[84:87], v0, s[8:11], s3 offen offset:1024 sc1
    s_and_b32 s26, s44, 63
    s_add_u32 s26, s26, 1
    s_min_u32 s26, s26, 63
    s_lshl_b32 s26, s26, 18
    s_add_u32 s26, s26, s50
    s_add_u32 s3, s26, 16777216
    s_waitcnt vmcnt(0) lgkmcnt(0)
    s_barrier
    s_branch M_c1_0_first_r
M_c1_0_first2:
    ds_read_b64 v[10:11], v0 offset:23296
    s_waitcnt lgkmcnt(0)
    v_min_u32 v10, v10, v11
    s_nop 0
    v_readfirstlane_b32 s28, v10
    s_nop 0
    s_max_u32 s54, s54, s28
    s_add_u32 s27, s44, 2
    s_or_b32 s28, s44, 63
    s_add_u32 s28, s28, 1
    s_min_u32 s27, s27, s28
    s_cmp_lt_u32 s54, s27
    s_cbranch_scc1 M_c1_0_p2
M_c1_0_p2_r:
    s_branch M_c1_0_first2_r
M_c1_0_wq1:
    buffer_load_dwordx4 v[12:15], v8, s[8:11], s43 offen sc1
    buffer_load_dwordx4 v[16:19], v8, s[8:11], s61 offen sc1
    buffer_load_dwordx4 v[20:23], v8, s[8:11], s100 offen sc1
    buffer_load_dwordx4 v[24:27], v8, s[8:11], s101 offen sc1
    s_waitcnt vmcnt(7)
    v_mfma_f32_16x16x32_bf16 v[28:31], v[72:75], v[40:43], 0
    s_waitcnt vmcnt(6)
    v_mfma_f32_16x16x32_bf16 v[28:31], v[72:75], v[44:47], v[28:31]
    s_waitcnt vmcnt(5)
    v_mfma_f32_16x16x32_bf16 v[28:31], v[72:75], v[48:51], v[28:31]
    s_waitcnt vmcnt(4)
    v_mfma_f32_16x16x32_bf16 v[28:31], v[72:75], v[52:55], v[28:31]
    v_max3_u32 v32, v40, v44, v48
    v_max_u32 v32, v32, v52
    v_cmp_eq_u32 vcc, -1, v32
    s_cbranch_vccnz M_c1_0_wqx
    v_mov_b32 v5, v5
    v_mov_b32 v5, v5
    v_mov_b32 v5, v5
    v_mov_b32 v5, v5
    v_add_f32_dpp v28, v28, v28 row_ror:8 row_mask:0xf bank_mask:0xf
    v_add_f32_dpp v29, v29, v29 row_ror:8 row_mask:0xf bank_mask:0xf
    v_add_f32_dpp v30, v30, v30 row_ror:8 row_mask:0xf bank_mask:0xf
    v_add_f32_dpp v31, v31, v31 row_ror:8 row_mask:0xf bank_mask:0xf
    v_cmp_u_f32 vcc, v28, v28
    v_cvt_pk_bf16_f32 v28, v28, v29
    v_cvt_pk_bf16_f32 v29, v30, v31
    s_cbranch_vccnz M_c1_0_wqe1
    s_mov_b64 exec, s[38:39]
    buffer_store_dwordx2 v[28:29], v11, s[8:11], s58 offen sc1
    s_barrier
    buffer_store_dwordx2 v[28:29], v11, s[8:11], s56 offen sc1
    s_branch M_c1_0_wrb_g
M_c1_0_wqx:
    s_branch M_c1_0_wrb_i1
M_c1_0_wqe1:
    s_waitcnt vmcnt(0)
    buffer_load_dwordx4 v[12:15], v8, s[8:11], s43 offen sc1
    buffer_load_dwordx4 v[16:19], v8, s[8:11], s61 offen sc1
    buffer_load_dwordx4 v[20:23], v8, s[8:11], s100 offen sc1
    buffer_load_dwordx4 v[24:27], v8, s[8:11], s101 offen sc1
    s_branch M_c1_0_wrb_e1
M_c1_0_wrb_l:
    s_waitcnt vmcnt(4)
    v_mfma_f32_16x16x32_bf16 v[28:31], v[72:75], v[12:15], 0
    v_mfma_f32_16x16x32_bf16 v[28:31], v[72:75], v[16:19], v[28:31]
    v_mfma_f32_16x16x32_bf16 v[28:31], v[72:75], v[20:23], v[28:31]
    v_mfma_f32_16x16x32_bf16 v[28:31], v[72:75], v[24:27], v[28:31]
    v_max3_u32 v32, v12, v16, v20
    v_max_u32 v32, v32, v24
    v_cmp_eq_u32 vcc, -1, v32
    s_cbranch_vccz M_c1_0_wrb_x0
M_c1_0_wrb_i0:
    buffer_load_dwordx4 v[12:15], v8, s[8:11], s43 offen sc1
    buffer_load_dwordx4 v[16:19], v8, s[8:11], s61 offen sc1
    buffer_load_dwordx4 v[20:23], v8, s[8:11], s100 offen sc1
    buffer_load_dwordx4 v[24:27], v8, s[8:11], s101 offen sc1
    s_waitcnt vmcnt(4)
    v_mfma_f32_16x16x32_bf16 v[28:31], v[72:75], v[40:43], 0
    v_mfma_f32_16x16x32_bf16 v[28:31], v[72:75], v[44:47], v[28:31]
    v_mfma_f32_16x16x32_bf16 v[28:31], v[72:75], v[48:51], v[28:31]
    v_mfma_f32_16x16x32_bf16 v[28:31], v[72:75], v[52:55], v[28:31]
    v_max3_u32 v32, v40, v44, v48
    v_max_u32 v32, v32, v52
    v_cmp_eq_u32 vcc, -1, v32
    s_cbranch_vccz M_c1_0_wrb_x1
M_c1_0_wrb_i1:
    buffer_load_dwordx4 v[40:43], v8, s[8:11], s43 offen sc1
    buffer_load_dwordx4 v[44:47], v8, s[8:11], s61 offen sc1
    buffer_load_dwordx4 v[48:51], v8, s[8:11], s100 offen sc1
    buffer_load_dwordx4 v[52:55], v8, s[8:11], s101 offen sc1
    s_add_u32 s71, s71, 1
    s_cmp_lt_u32 s71, 240000
    s_cbranch_scc1 M_c1_0_wrb_l
    s_branch M_fail
M_c1_0_wrb_x0:
    s_nop 3
    v_add_f32_dpp v28, v28, v28 row_ror:8 row_mask:0xf bank_mask:0xf
    v_add_f32_dpp v29, v29, v29 row_ror:8 row_mask:0xf bank_mask:0xf
    v_add_f32_dpp v30, v30, v30 row_ror:8 row_mask:0xf bank_mask:0xf
    v_add_f32_dpp v31, v31, v31 row_ror:8 row_mask:0xf bank_mask:0xf
    v_cmp_u_f32 vcc, v28, v28
    v_cvt_pk_bf16_f32 v28, v28, v29
    v_cvt_pk_bf16_f32 v29, v30, v31
    s_cbranch_vccz M_c1_0_wrb_n
M_c1_0_wrb_e0:
    v_max3_u32 v32, v12, v13, v14
    v_max3_u32 v32, v32, v15, v16
    v_max3_u32 v32, v32, v17, v18
    v_max3_u32 v32, v32, v19, v20
    v_max3_u32 v32, v32, v21, v22
    v_max3_u32 v32, v32, v23, v24
    v_max3_u32 v32, v32, v25, v26
    v_max_u32 v32, v32, v27
    v_cmp_eq_u32 vcc, -1, v32
    s_cbranch_vccnz M_c1_0_wrb_i0
    v_min_u32 v28, -2, v28
    v_min_u32 v29, -2, v29
    s_branch M_c1_0_wrb_n
M_c1_0_wrb_x1:
    s_nop 3
    v_add_f32_dpp v28, v28, v28 row_ror:8 row_mask:0xf bank_mask:0xf
    v_add_f32_dpp v29, v29, v29 row_ror:8 row_mask:0xf bank_mask:0xf
    v_add_f32_dpp v30, v30, v30 row_ror:8 row_mask:0xf bank_mask:0xf
    v_add_f32_dpp v31, v31, v31 row_ror:8 row_mask:0xf bank_mask:0xf
    v_cmp_u_f32 vcc, v28, v28
    v_cvt_pk_bf16_f32 v28, v28, v29
    v_cvt_pk_bf16_f32 v29, v30, v31
    s_cbranch_vccz M_c1_0_wrb_n
M_c1_0_wrb_e1:
    v_max3_u32 v32, v40, v41, v42
    v_max3_u32 v32, v32, v43, v44
    v_max3_u32 v32, v32, v45, v46
    v_max3_u32 v32, v32, v47, v48
    v_max3_u32 v32, v32, v49, v50
    v_max3_u32 v32, v32, v51, v52
    v_max3_u32 v32, v32, v53, v54
    v_max_u32 v32, v32, v55
    v_cmp_eq_u32 vcc, -1, v32
    s_cbranch_vccnz M_c1_0_wrb_i1
    v_min_u32 v28, -2, v28
    v_min_u32 v29, -2, v29
M_c1_0_wrb_n:
    s_mov_b64 exec, s[38:39]
    buffer_store_dwordx2 v[28:29], v11, s[8:11], s58 offen sc1
    s_branch M_c1_0_wrb_d
M_c1_0_p2:
    s_mov_b32 s30, 0
M_c1_0_p2_l:
    s_waitcnt lgkmcnt(0)
    s_mov_b64 exec, 3
    buffer_load_dword v10, v9, s[8:11], s51 offen sc1
    s_waitcnt vmcnt(0)
    s_mov_b64 exec, -1
    v_readlane_b32 s54, v10, 0
    v_readlane_b32 s28, v10, 1
    s_nop 3
    s_min_u32 s54, s54, s28
    s_cmp_ge_u32 s54, s27
    s_cbranch_scc1 M_c1_0_p2_r
    s_sleep 2
    s_add_u32 s30, s30, 1
    s_cmp_ge_u32 s30, 240000
    s_cbranch_scc1 M_fail
    s_branch M_c1_0_p2_l
M_c1_1_layer:
    s_lshr_b32 s27, s44, 6
    s_mul_i32 s50, s27, 33554432
    s_lshl_b32 s27, s22, 13
    s_add_u32 s50, s50, s27
    s_add_u32 s50, s50, 37748736
    s_barrier
    s_mov_b32 s26, 0x10010000
    s_mov_b32 s3, s26
    s_mul_i32 s27, s20, 5120
    s_add_u32 s48, s27, 167772160
    s_sub_u32 s49, 167777280, s27
    s_and_b32 s55, s44, 3
    s_mul_i32 s55, s55, 167936
    s_add_u32 s55, s55, s34
    s_add_u32 s58, s55, s35
    s_and_b32 s57, s44, 63
    s_add_u32 s43, s55, s32
    s_sub_u32 s27, s57, 1
    s_max_i32 s27, s27, 0
    s_lshl_b64 s[100:101], 1, s27
    s_lshl_b32 s27, s27, 7
    s_sub_u32 s61, s52, s27
    s_add_u32 s42, s44, 2
    s_or_b32 s28, s44, 63
    s_add_u32 s28, s28, 1
    s_min_u32 s42, s42, s28
    ds_read_b128 v[56:59], v5 offset:0
    ds_read_b128 v[60:63], v5 offset:1024
    ds_read_b128 v[64:67], v5 offset:2048
    ds_read_b128 v[68:71], v5 offset:3072
    v_mov_b64 v[12:13], 0
    v_mov_b64 v[14:15], 0
    v_mov_b64 v[16:17], 0
    v_mov_b64 v[18:19], 0
    v_mov_b64 v[20:21], 0
    v_mov_b64 v[22:23], 0
    v_mov_b64 v[24:25], 0
    v_mov_b64 v[26:27], 0
    v_mov_b64 v[28:29], 0
    v_mov_b64 v[30:31], 0
    v_mov_b64 v[32:33], 0
    v_mov_b64 v[34:35], 0
    s_mov_b32 s70, 0
    s_waitcnt lgkmcnt(0)
M_c1_1_top:
    s_nop 0
    s_barrier
    ds_read_b128 v[36:39], v6 offset:13312
    ds_read_b128 v[40:43], v6 offset:14336
    s_mov_b32 m0, 8192
    s_nop 0
    buffer_load_dwordx4 v0, s[8:11], s49 offen offset:2048 sc1 lds
M_c1_1_lr_r:
    s_waitcnt lgkmcnt(1)
    v_smfmac_f32_16x16x64_bf16 v[20:23], v[36:39], v[56:63], v1
    ds_read_b128 v[56:59], v5 offset:4096
    v_smfmac_f32_16x16x64_bf16 v[24:27], v[36:39], v[64:71], v1
    ds_read_b128 v[60:63], v5 offset:5120
    v_smfmac_f32_16x16x64_bf16 v[28:31], v[36:39], a[248:255], v1
    ds_read_b128 v[64:67], v5 offset:6144
    v_smfmac_f32_16x16x64_bf16 v[32:35], v[36:39], a[240:247], v1
    ds_read_b128 v[68:71], v5 offset:7168
    v_smfmac_f32_16x16x64_bf16 v[12:15], v[36:39], a[232:239], v1
    ds_read_b128 v[44:47], v6 offset:15360
    s_waitcnt lgkmcnt(3)
    v_smfmac_f32_16x16x64_bf16 v[16:19], v[36:39], v[56:63], v1
    ds_read_b128 v[56:59], v5 offset:8192
    v_smfmac_f32_16x16x64_bf16 v[20:23], v[40:43], a[224:231], v1
    ds_read_b128 v[60:63], v5 offset:9216
    s_waitcnt lgkmcnt(3)
    v_smfmac_f32_16x16x64_bf16 v[24:27], v[40:43], v[64:71], v1
    ds_read_b128 v[64:67], v5 offset:10240
    v_smfmac_f32_16x16x64_bf16 v[28:31], v[40:43], a[216:223], v1
    ds_read_b128 v[68:71], v5 offset:11264
    v_smfmac_f32_16x16x64_bf16 v[32:35], v[40:43], a[208:215], v1
    ds_read_b128 v[48:51], v6 offset:16384
    s_waitcnt lgkmcnt(3)
    v_smfmac_f32_16x16x64_bf16 v[12:15], v[40:43], v[56:63], v1
    ds_read_b128 v[56:59], v5 offset:12288
    v_smfmac_f32_16x16x64_bf16 v[16:19], v[40:43], a[200:207], v1
    ds_read_b128 v[60:63], v5 offset:13312
    s_waitcnt lgkmcnt(3)
    v_smfmac_f32_16x16x64_bf16 v[20:23], v[44:47], v[64:71], v1
    ds_read_b128 v[64:67], v5 offset:14336
    v_smfmac_f32_16x16x64_bf16 v[24:27], v[44:47], a[192:199], v1
    ds_read_b128 v[68:71], v5 offset:15360
    v_smfmac_f32_16x16x64_bf16 v[28:31], v[44:47], a[184:191], v1
    ds_read_b128 v[52:55], v6 offset:17408
    s_waitcnt lgkmcnt(3)
    v_smfmac_f32_16x16x64_bf16 v[32:35], v[44:47], v[56:63], v1
    ds_read_b128 v[56:59], v5 offset:16384
    v_smfmac_f32_16x16x64_bf16 v[20:23], v[48:51], a[176:183], v1
    ds_read_b128 v[60:63], v5 offset:17408
    s_waitcnt lgkmcnt(3)
    v_max3_u32 v10, v36, v40, v44
    v_smfmac_f32_16x16x64_bf16 v[24:27], v[48:51], v[64:71], v1
    ds_read_b128 v[64:67], v5 offset:18432
    s_waitcnt lgkmcnt(3)
    v_max3_u32 v10, v10, v48, v52
    v_smfmac_f32_16x16x64_bf16 v[28:31], v[48:51], a[168:175], v1
    ds_read_b128 v[68:71], v5 offset:19456
    v_cmp_eq_u32 vcc, -1, v10
    v_smfmac_f32_16x16x64_bf16 v[32:35], v[48:51], a[160:167], v1
    s_cbranch_vccnz M_c1_1_lr
    s_waitcnt vmcnt(0)
    s_barrier
    ds_read_b128 v[36:39], v6 offset:8192
    ds_read_b128 v[40:43], v6 offset:9216
    s_waitcnt lgkmcnt(4)
    v_smfmac_f32_16x16x64_bf16 v[20:23], v[52:55], v[56:63], v1
    ds_read_b128 v[44:47], v6 offset:10240
    ds_read_b128 v[48:51], v6 offset:11264
    v_smfmac_f32_16x16x64_bf16 v[24:27], v[52:55], a[152:159], v1
    ds_read_b32 v11, v6 offset:12288
    ds_read_b128 v[56:59], v5 offset:20480
    s_waitcnt lgkmcnt(6)
    v_smfmac_f32_16x16x64_bf16 v[28:31], v[52:55], v[64:71], v1
    ds_read_b128 v[60:63], v5 offset:21504
    s_waitcnt lgkmcnt(4)
    v_max3_u32 v10, v36, v40, v44
    v_smfmac_f32_16x16x64_bf16 v[32:35], v[52:55], a[144:151], v1
    s_waitcnt lgkmcnt(2)
    v_max3_u32 v10, v10, v48, v11
    v_cmp_eq_u32 vcc, -1, v10
    s_cbranch_vccnz M_c1_1_rr
M_c1_1_rr_r:
    s_mov_b32 m0, 23296
    ds_read_b128 v[64:67], v5 offset:22528
    ds_read_b128 v[68:71], v5 offset:23552
    ds_read_b128 v[52:55], v6 offset:12288
    buffer_store_dwordx4 v[76:79], v0, s[8:11], s4 offen offset:1024 sc1
    s_mov_b32 s4, 0x10000000
    s_mov_b64 exec, 3
    buffer_load_dword v9, s[8:11], s51 offen sc1 lds
    s_mov_b64 exec, s[100:101]
    buffer_store_dword v9, v9, s[8:11], s61 offen sc1
    s_mov_b64 exec, -1
    v_smfmac_f32_16x16x64_bf16 v[20:23], v[36:39], a[136:143], v1
    s_waitcnt lgkmcnt(3)
    v_smfmac_f32_16x16x64_bf16 v[24:27], v[36:39], v[56:63], v1
    ds_read_b128 v[56:59], v5 offset:24576
    v_smfmac_f32_16x16x64_bf16 v[20:23], v[40:43], a[128:135], v1
    ds_read_b128 v[60:63], v5 offset:25600
    s_waitcnt lgkmcnt(3)
    v_smfmac_f32_16x16x64_bf16 v[24:27], v[40:43], v[64:71], v1
    ds_read_b128 v[64:67], v5 offset:26624
    v_smfmac_f32_16x16x64_bf16 v[20:23], v[44:47], a[120:127], v1
    ds_read_b128 v[68:71], v5 offset:27648
    v_smfmac_f32_16x16x64_bf16 v[24:27], v[44:47], a[112:119], v1
    s_waitcnt lgkmcnt(2)
    v_smfmac_f32_16x16x64_bf16 v[20:23], v[48:51], v[56:63], v1
    ds_read_b128 v[56:59], v5 offset:28672
    v_smfmac_f32_16x16x64_bf16 v[24:27], v[48:51], a[104:111], v1
    ds_read_b128 v[60:63], v5 offset:29696
    s_waitcnt lgkmcnt(2)
    v_smfmac_f32_16x16x64_bf16 v[20:23], v[52:55], v[64:71], v1
    ds_read_b128 v[64:67], v5 offset:30720
    v_smfmac_f32_16x16x64_bf16 v[24:27], v[52:55], a[96:103], v1
    ds_read_b128 v[68:71], v5 offset:31744
    v_smfmac_f32_16x16x64_bf16 v[28:31], v[36:39], a[88:95], v1
    s_cmp_eq_u32 s57, 0
    s_cbranch_scc1 M_c1_1_first
M_c1_1_first_r:
    s_waitcnt lgkmcnt(2)
    v_smfmac_f32_16x16x64_bf16 v[32:35], v[36:39], v[56:63], v1
    ds_read_b128 v[56:59], v5 offset:32768
    v_permlane32_swap_b32 v20, v21
    v_smfmac_f32_16x16x64_bf16 v[28:31], v[40:43], a[80:87], v1
    ds_read_b128 v[60:63], v5 offset:33792
    s_waitcnt lgkmcnt(2)
    v_permlane32_swap_b32 v22, v23
    v_smfmac_f32_16x16x64_bf16 v[32:35], v[40:43], v[64:71], v1
    ds_read_b128 v[64:67], v0 offset:2048
    v_permlane32_swap_b32 v24, v25
    v_smfmac_f32_16x16x64_bf16 v[28:31], v[44:47], a[72:79], v1
    ds_read_b128 v[68:71], v0 offset:3072
    v_permlane32_swap_b32 v26, v27
    v_smfmac_f32_16x16x64_bf16 v[32:35], v[44:47], a[64:71], v1
    s_waitcnt lgkmcnt(2)
    v_add_f32 v20, v20, v21
    v_add_f32 v22, v22, v23
    v_smfmac_f32_16x16x64_bf16 v[28:31], v[48:51], v[56:63], v1
    ds_read_b128 v[56:59], v0 offset:0
    v_add_f32 v24, v24, v25
    v_add_f32 v26, v26, v27
    v_smfmac_f32_16x16x64_bf16 v[32:35], v[48:51], a[56:63], v1
    ds_read_b128 v[60:63], v0 offset:1024
    v_mul_f32 v20, s40, v20
    v_mul_f32 v24, s40, v24
    v_smfmac_f32_16x16x64_bf16 v[28:31], v[52:55], a[48:55], v1
    v_mul_f32 v22, s40, v22
    v_mul_f32 v26, s40, v26
    v_smfmac_f32_16x16x64_bf16 v[32:35], v[52:55], a[40:47], v1
    v_cvt_pk_bf16_f32 v20, v20, v24
    v_cvt_pk_bf16_f32 v21, v22, v26
    v_smfmac_f32_16x16x64_bf16 v[12:15], v[36:39], a[32:39], v1
    ds_write_b32 v2, v20 offset:18432
    v_smfmac_f32_16x16x64_bf16 v[16:19], v[36:39], a[24:31], v1
    ds_write_b32 v2, v21 offset:19008
    v_permlane32_swap_b32 v28, v29
    v_smfmac_f32_16x16x64_bf16 v[12:15], v[40:43], a[16:23], v1
    ds_read_b128 v[36:39], v6 offset:15360
    v_permlane32_swap_b32 v30, v31
    v_smfmac_f32_16x16x64_bf16 v[16:19], v[40:43], a[8:15], v1
    ds_read_b128 v[40:43], v6 offset:16384
    v_permlane32_swap_b32 v32, v33
    v_smfmac_f32_16x16x64_bf16 v[12:15], v[44:47], a[0:7], v1
    s_waitcnt lgkmcnt(2)
    s_barrier
    v_permlane32_swap_b32 v34, v35
    v_smfmac_f32_16x16x64_bf16 v[16:19], v[44:47], v[248:255], v1
    ds_read_b128 v[20:23], v3 offset:18432
    v_add_f32 v28, v28, v29
    v_add_f32 v30, v30, v31
    v_smfmac_f32_16x16x64_bf16 v[12:15], v[48:51], v[240:247], v1
    ds_read_b128 v[24:27], v3 offset:18496
    v_add_f32 v32, v32, v33
    v_add_f32 v34, v34, v35
    v_smfmac_f32_16x16x64_bf16 v[16:19], v[48:51], v[232:239], v1
    ds_read_b128 v[72:75], v3 offset:18560
    v_cvt_pk_bf16_f32 v28, v28, v32
    v_cvt_pk_bf16_f32 v29, v30, v34
    v_smfmac_f32_16x16x64_bf16 v[12:15], v[52:55], v[224:231], v1
    ds_write_b32 v2, v28 offset:20736
    ds_read_b128 v[44:47], v3 offset:18624
    v_smfmac_f32_16x16x64_bf16 v[16:19], v[52:55], v[216:223], v1
    ds_write_b32 v2, v29 offset:21312
    s_waitcnt lgkmcnt(7)
    v_smfmac_f32_16x16x64_bf16 v[12:15], v[36:39], v[208:215], v1
    ds_read_b128 v[48:51], v6 offset:17408
    v_mov_b64 v[10:11], s[16:17]
    v_smfmac_f32_16x16x64_bf16 v[16:19], v[36:39], v[200:207], v1
    s_waitcnt lgkmcnt(6)
    v_mfma_f32_16x16x32_bf16 v[28:31], v[56:59], v[20:23], 0
    ds_read_b128 v[56:59], v0 offset:4096
    s_waitcnt lgkmcnt(6)
    v_mfma_f32_16x16x32_bf16 v[28:31], v[60:63], v[24:27], v[28:31]
    ds_read_b128 v[60:63], v0 offset:5120
    s_waitcnt lgkmcnt(3)
    s_barrier
    v_mfma_f32_16x16x32_bf16 v[28:31], v[64:67], v[72:75], v[28:31]
    ds_read_b128 v[64:67], v0 offset:6144
    v_mfma_f32_16x16x32_bf16 v[28:31], v[68:71], v[44:47], v[28:31]
    ds_read_b128 v[68:71], v0 offset:7168
    v_smfmac_f32_16x16x64_bf16 v[12:15], v[40:43], v[192:199], v1
    ds_read_b128 v[36:39], v3 offset:20736
    v_smfmac_f32_16x16x64_bf16 v[16:19], v[40:43], v[184:191], v1
    ds_read_b128 v[52:55], v3 offset:20800
    s_waitcnt lgkmcnt(4)
    v_mfma_f32_16x16x32_bf16 v[32:35], v[56:59], v[20:23], 0
    s_nop 0
    v_exp_f32 v28, v28
    ds_read_b128 v[56:59], v3 offset:20864
    v_mfma_f32_16x16x32_bf16 v[32:35], v[60:63], v[24:27], v[32:35]
    s_waitcnt lgkmcnt(3)
    v_exp_f32 v29, v29
    ds_read_b128 v[60:63], v3 offset:20928
    v_mfma_f32_16x16x32_bf16 v[32:35], v[64:67], v[72:75], v[32:35]
    v_exp_f32 v30, v30
    v_mfma_f32_16x16x32_bf16 v[32:35], v[68:71], v[44:47], v[32:35]
    s_waitcnt lgkmcnt(3)
    v_exp_f32 v31, v31
    v_mfma_f32_16x16x32_bf16 v[40:43], v[36:39], v[20:23], 0
    s_waitcnt lgkmcnt(2)
    v_cvt_pk_bf16_f32 v28, v28, v29
    v_cvt_pk_bf16_f32 v29, v30, v31
    v_mfma_f32_16x16x32_bf16 v[40:43], v[52:55], v[24:27], v[40:43]
    s_waitcnt lgkmcnt(1)
    v_mov_b64 v[64:65], s[24:25]
    v_mov_b64 v[66:67], s[24:25]
    v_mfma_f32_16x16x32_bf16 v[40:43], v[56:59], v[72:75], v[40:43]
    s_waitcnt lgkmcnt(0)
    v_exp_f32 v32, v32
    v_mfma_f32_16x16x32_bf16 v[40:43], v[60:63], v[44:47], v[40:43]
    v_exp_f32 v33, v33
    v_smfmac_f32_16x16x64_bf16 v[12:15], v[48:51], v[176:183], v1
    v_exp_f32 v34, v34
    v_smfmac_f32_16x16x64_bf16 v[16:19], v[48:51], v[168:175], v1
    v_exp_f32 v35, v35
    v_cvt_pk_bf16_f32 v30, v32, v33
    v_cvt_pk_bf16_f32 v31, v34, v35
    s_nop 0
    v_exp_f32 v40, v40
    v_mfma_f32_16x16x32_bf16 v[72:75], v[64:67], v[28:31], 0
    v_exp_f32 v41, v41
    v_mfma_f32_16x16x32_bf16 v[20:23], v[80:83], v[28:31], 0
    v_exp_f32 v42, v42
    v_mfma_f32_16x16x32_bf16 v[24:27], v[84:87], v[28:31], 0
    v_exp_f32 v43, v43
    v_cvt_pk_bf16_f32 v40, v40, v41
    v_cvt_pk_bf16_f32 v41, v42, v43
    v_cvt_pk_bf16_f32 v12, v12, v13
    v_cvt_pk_bf16_f32 v13, v14, v15
    v_mfma_f32_16x16x16_bf16 v[72:75], v[10:11], v[40:41], v[72:75]
    v_cvt_pk_bf16_f32 v14, v16, v17
    v_cvt_pk_bf16_f32 v15, v18, v19
M_c1_1_fin:
    v_mfma_f32_16x16x16_bf16 v[20:23], v[12:13], v[40:41], v[20:23]
    s_cmp_eq_u32 s57, 63
    v_cndmask_b32_e64 v76, v12, v52, s[66:67]
    v_cndmask_b32_e64 v77, v13, v53, s[66:67]
    v_mfma_f32_16x16x16_bf16 v[24:27], v[14:15], v[40:41], v[24:27]
    v_cndmask_b32_e64 v78, v14, v54, s[66:67]
    v_cndmask_b32_e64 v79, v15, v55, s[66:67]
    s_cbranch_scc1 M_c1_1_last
    v_rcp_f32 v74, v72
    v_subrev_u32 v73, s68, v72
    v_cmp_lt_u32 vcc, s69, v73
    v_mov_b64 v[44:45], 0
    v_mov_b64 v[46:47], 0
    v_cndmask_b32_e64 v20, v20, v24, s[18:19]
    v_cndmask_b32_e64 v21, v21, v25, s[18:19]
    v_cndmask_b32_e64 v22, v22, v26, s[18:19]
    v_cndmask_b32_e64 v23, v23, v27, s[18:19]
    v_pk_mul_f32 v[20:21], v[20:21], v[74:75] op_sel_hi:[1,0]
    v_pk_mul_f32 v[22:23], v[22:23], v[74:75] op_sel_hi:[1,0]
    v_cvt_pk_bf16_f32 v20, v20, v21
    v_cvt_pk_bf16_f32 v21, v22, v23
    ds_write_b64 v0, v[20:21] offset:13320
    s_cbranch_vccnz M_c1_1_zbad
M_c1_1_zok:
    s_cmp_lt_u32 s54, s42
    s_cbranch_scc1 M_c1_1_first2
M_c1_1_first2_r:
    buffer_load_dwordx4 v[80:83], v0, s[8:11], s3 offen offset:0 sc1
    buffer_load_dwordx4 v[84:87], v0, s[8:11], s3 offen offset:1024 sc1
    s_waitcnt lgkmcnt(0)
    s_barrier
    ds_read_b128 v[32:35], v0 offset:13312
    ds_read_b128 v[52:55], v0 offset:14336
    s_mov_b32 m0, 2048
    s_nop 0
    buffer_load_dwordx4 v0, s[8:11], s26 offen offset:0 sc1 lds
    buffer_load_dwordx4 v0, s[8:11], s26 offen offset:1024 sc1 lds
    v_mov_b64 v[68:69], 0
    v_mov_b64 v[70:71], 0
    v_mov_b64 v[64:65], 0
    v_mov_b64 v[66:67], 0
    v_mov_b64 v[60:61], 0
    v_mov_b64 v[62:63], 0
    v_mov_b64 v[56:57], 0
    v_mov_b64 v[58:59], 0
    s_waitcnt lgkmcnt(1)
    s_nop 0
    v_smfmac_f32_16x16x64_bf16 v[56:59], v[32:35], v[160:167], v1
    v_smfmac_f32_16x16x64_bf16 v[60:63], v[32:35], v[144:151], v1
    s_waitcnt lgkmcnt(0)
    v_smfmac_f32_16x16x64_bf16 v[56:59], v[52:55], v[152:159], v1
    v_smfmac_f32_16x16x64_bf16 v[60:63], v[52:55], v[136:143], v1
    v_smfmac_f32_16x16x64_bf16 v[64:67], v[32:35], v[128:135], v1
    v_smfmac_f32_16x16x64_bf16 v[68:71], v[32:35], v[112:119], v1
    v_permlane32_swap_b32 v56, v57
    v_smfmac_f32_16x16x64_bf16 v[64:67], v[52:55], v[120:127], v1
    v_permlane32_swap_b32 v58, v59
    v_smfmac_f32_16x16x64_bf16 v[68:71], v[52:55], v[104:111], v1
    v_add_f32 v56, v56, v57
    v_add_f32 v58, v58, v59
    v_smfmac_f32_16x16x64_bf16 v[44:47], v[32:35], v[96:103], v1
    v_permlane32_swap_b32 v60, v61
    v_smfmac_f32_16x16x64_bf16 v[44:47], v[52:55], v[88:95], v1
    v_permlane32_swap_b32 v62, v63
    v_add_f32 v60, v60, v61
    v_add_f32 v62, v62, v63
    v_cvt_pk_bf16_f32 v36, v56, v60
    v_cvt_pk_bf16_f32 v38, v58, v62
    v_permlane32_swap_b32 v64, v65
    v_permlane32_swap_b32 v66, v67
    v_add_f32 v64, v64, v65
    v_add_f32 v66, v66, v67
    v_permlane32_swap_b32 v68, v69
    v_permlane32_swap_b32 v70, v71
    v_add_f32 v68, v68, v69
    v_add_f32 v70, v70, v71
    v_cvt_pk_bf16_f32 v37, v64, v68
    v_cvt_pk_bf16_f32 v39, v66, v70
    buffer_store_dwordx4 v[36:39], v0, s[8:11], s58 offen sc1
    v_permlane32_swap_b32 v44, v45
    v_permlane32_swap_b32 v46, v47
    v_add_f32 v44, v44, v45
    v_add_f32 v46, v46, v47
    v_cvt_pk_bf16_f32 v44, v44, v46
    buffer_store_dword v44, v7, s[8:11], s55 offen sc1
    v_bfe_u32 v34, v0, 4, 1
    v_bfe_u32 v33, v0, 7, 1
    v_lshl_add_u32 v33, v33, 1, v34
    v_bfe_u32 v32, v0, 6, 1
    v_lshlrev_b32 v32, 4, v32
    v_lshlrev_b32_e64 v32, v32, s45
    v_cmp_eq_u32_e64 s[64:65], 0, v33
    v_cmp_eq_u32_e64 vcc, 1, v33
    s_add_u32 s27, s44, 1
    s_and_b32 s27, s27, 3
    v_cndmask_b32_e64 v72, 0, v32, s[64:65]
    v_cndmask_b32_e64 v73, 0, v32, vcc
    v_cmp_eq_u32_e64 s[64:65], 2, v33
    v_cmp_eq_u32_e64 vcc, 3, v33
    s_mul_i32 s48, s27, 5120
    s_add_u32 s48, s48, s41
    v_cndmask_b32_e64 v74, 0, v32, s[64:65]
    v_cndmask_b32_e64 v75, 0, v32, vcc
    s_lshl_b32 s27, s27, 15
    s_add_u32 s49, s27, s47
    v_bfe_u32 v32, v0, 8, 1
    v_lshlrev_b32 v11, 6, v32
    v_lshl_add_u32 v11, v34, 3, v11
    v_lshrrev_b32 v33, 9, v0
    v_lshl_add_u32 v11, v33, 2, v11
    s_add_u32 s56, s27, s46
    s_add_u32 s56, s56, s33
    s_add_u32 s58, s48, s33
    s_nop 15
    s_nop 15
    buffer_load_dwordx4 v[12:15], v0, s[8:11], s43 offen sc1
    s_nop 15
    s_nop 15
    s_nop 9
    buffer_load_dwordx4 v[16:19], v0, s[8:11], s43 offen sc1
    s_nop 7
    s_waitcnt vmcnt(1)
    v_mfma_f32_16x16x32_bf16 v[28:31], v[72:75], v[12:15], 0
    v_cmp_eq_u32 vcc, -1, v12
    s_cbranch_vccnz M_c1_1_wq1
    v_mov_b32 v5, v5
    v_mov_b32 v5, v5
    v_mov_b32 v5, v5
    v_mov_b32 v5, v5
    v_mov_b32 v5, v5
    v_mov_b32 v5, v5
    v_add_f32_dpp v28, v28, v28 row_ror:8 row_mask:0xf bank_mask:0xf
    v_add_f32_dpp v29, v29, v29 row_ror:8 row_mask:0xf bank_mask:0xf
    s_nop 0
    v_add_f32_dpp v28, v28, v28 row_ror:4 row_mask:0xf bank_mask:0xf
    v_add_f32_dpp v29, v29, v29 row_ror:4 row_mask:0xf bank_mask:0xf
    s_nop 0
    v_add_f32_dpp v28, v28, v28 row_ror:2 row_mask:0xf bank_mask:0xf
    v_add_f32_dpp v29, v29, v29 row_ror:2 row_mask:0xf bank_mask:0xf
    v_cmp_u_f32 vcc, v28, v28
    v_cvt_pk_bf16_f32 v28, v28, v29
    s_cbranch_vccnz M_c1_1_wrb_e0
    s_mov_b64 exec, s[62:63]
    buffer_store_dword v28, v11, s[8:11], s58 offen sc1
M_c1_1_wrb_d:
    s_barrier
    buffer_store_dword v28, v11, s[8:11], s56 offen sc1
M_c1_1_wrb_g:
    s_mov_b64 exec, -1
    s_waitcnt vmcnt(2)
    ds_read_b128 v[56:59], v5 offset:0
    ds_read_b128 v[60:63], v5 offset:1024
    ds_read_b128 v[64:67], v5 offset:2048
    ds_read_b128 v[68:71], v5 offset:3072
    v_mov_b64 v[12:13], 0
    v_mov_b64 v[14:15], 0
    v_mov_b64 v[16:17], 0
    v_mov_b64 v[18:19], 0
    v_mov_b64 v[20:21], 0
    v_mov_b64 v[22:23], 0
    v_mov_b64 v[24:25], 0
    v_mov_b64 v[26:27], 0
    v_mov_b64 v[28:29], 0
    v_mov_b64 v[30:31], 0
    v_mov_b64 v[32:33], 0
    v_mov_b64 v[34:35], 0
    ds_read_b64 v[36:37], v0 offset:23296
    s_waitcnt lgkmcnt(0)
    v_min_u32 v36, v36, v37
    s_nop 0
    v_readfirstlane_b32 s28, v36
    s_nop 0
    s_max_u32 s54, s54, s28
    s_and_b32 s26, s44, 63
    s_add_u32 s26, s26, 2
    s_min_u32 s26, s26, 63
    s_lshl_b32 s26, s26, 18
    s_add_u32 s26, s26, s50
    s_add_u32 s26, s26, 2048
    s_add_u32 s3, s26, 16777216
    s_lshl_b32 s4, s44, 18
    s_add_u32 s4, s4, s53
    v_mov_b64 v[72:73], -1
    v_mov_b64 v[74:75], -1
    s_add_u32 s28, s44, 3
    s_and_b32 s29, s28, 3
    s_mul_i32 s31, s22, 160
    s_mul_i32 s28, s29, 167936
    s_add_u32 s28, s28, s34
    s_add_u32 s64, s28, s35
    s_lshl_b32 s65, s22, 10
    s_add_u32 s65, s65, s28
    s_add_u32 s65, s65, 135168
    s_add_u32 s44, s44, 1
    s_and_b32 s55, s44, 3
    s_mul_i32 s55, s55, 167936
    s_add_u32 s55, s55, s34
    s_add_u32 s58, s55, s35
    s_and_b32 s57, s44, 63
    s_add_u32 s43, s55, s32
    s_sub_u32 s27, s57, 1
    s_max_i32 s27, s27, 0
    s_lshl_b64 s[100:101], 1, s27
    s_lshl_b32 s27, s27, 7
    s_sub_u32 s61, s52, s27
    s_add_u32 s42, s44, 2
    s_or_b32 s28, s44, 63
    s_add_u32 s28, s28, 1
    s_min_u32 s42, s42, s28
    s_nop 15
    s_nop 15
    s_nop 1
    buffer_store_dwordx4 v[72:75], v0, s[8:11], s64 offen offset:1024 sc1
    buffer_store_dwordx4 v[72:75], v0, s[8:11], s64 offen offset:2048 sc1
    buffer_store_dwordx4 v[72:75], v0, s[8:11], s65 offen sc1
    s_mov_b32 s65, 0x10000000
    s_mov_b32 s64, 0x10000000
    s_mov_b32 s70, 0
    s_branch M_c1_1_top
M_c1_1_restart:
    s_waitcnt vmcnt(0) lgkmcnt(0)
    s_nop 7
    s_barrier
    ds_read_b128 v[56:59], v5 offset:0
    ds_read_b128 v[60:63], v5 offset:1024
    ds_read_b128 v[64:67], v5 offset:2048
    ds_read_b128 v[68:71], v5 offset:3072
    v_mov_b64 v[12:13], 0
    v_mov_b64 v[14:15], 0
    v_mov_b64 v[16:17], 0
    v_mov_b64 v[18:19], 0
    v_mov_b64 v[20:21], 0
    v_mov_b64 v[22:23], 0
    v_mov_b64 v[24:25], 0
    v_mov_b64 v[26:27], 0
    v_mov_b64 v[28:29], 0
    v_mov_b64 v[30:31], 0
    v_mov_b64 v[32:33], 0
    v_mov_b64 v[34:35], 0
    s_waitcnt vmcnt(0) lgkmcnt(0)
    s_branch M_c1_1_top
M_c1_1_zbad:
    s_cmp_eq_u32 s70, 2
    s_cbranch_scc1 M_c1_1_zok
    v_cmp_u_f32 vcc, v72, v72
    s_cbranch_vccz M_c1_1_exact
    s_cmp_eq_u32 s70, 1
    s_cbranch_scc1 M_c1_1_exact
M_c1_1_vfy0:
    s_mov_b32 s70, 1
    s_mov_b32 s30, 0
    s_waitcnt vmcnt(0) lgkmcnt(0)
    s_nop 7
M_c1_1_vfy:
    v_mov_b32 v10, 0
    s_add_u32 s59, s48, 4096
    buffer_load_dwordx4 v[36:39], v0, s[8:11], s48 offen offset:0 sc1
    buffer_load_dwordx4 v[40:43], v0, s[8:11], s48 offen offset:1024 sc1
    buffer_load_dwordx4 v[44:47], v0, s[8:11], s48 offen offset:2048 sc1
    buffer_load_dwordx4 v[48:51], v0, s[8:11], s48 offen offset:3072 sc1
    buffer_load_dwordx4 v[52:55], v0, s[8:11], s59 offen offset:0 sc1
    s_waitcnt vmcnt(4)
    v_max3_u32 v10, v10, v36, v37
    v_max3_u32 v10, v10, v38, v39
    s_waitcnt vmcnt(3)
    v_max3_u32 v10, v10, v40, v41
    v_max3_u32 v10, v10, v42, v43
    s_waitcnt vmcnt(2)
    v_max3_u32 v10, v10, v44, v45
    v_max3_u32 v10, v10, v46, v47
    s_waitcnt vmcnt(1)
    v_max3_u32 v10, v10, v48, v49
    v_max3_u32 v10, v10, v50, v51
    s_waitcnt vmcnt(0)
    v_max3_u32 v10, v10, v52, v53
    v_max3_u32 v10, v10, v54, v55
    s_add_u32 s59, s49, 4096
    buffer_load_dwordx4 v[36:39], v0, s[8:11], s49 offen offset:0 sc1
    buffer_load_dwordx4 v[40:43], v0, s[8:11], s49 offen offset:1024 sc1
    buffer_load_dwordx4 v[44:47], v0, s[8:11], s49 offen offset:2048 sc1
    buffer_load_dwordx4 v[48:51], v0, s[8:11], s49 offen offset:3072 sc1
    buffer_load_dwordx4 v[52:55], v0, s[8:11], s59 offen offset:0 sc1
    s_waitcnt vmcnt(4)
    v_max3_u32 v10, v10, v36, v37
    v_max3_u32 v10, v10, v38, v39
    s_waitcnt vmcnt(3)
    v_max3_u32 v10, v10, v40, v41
    v_max3_u32 v10, v10, v42, v43
    s_waitcnt vmcnt(2)
    v_max3_u32 v10, v10, v44, v45
    v_max3_u32 v10, v10, v46, v47
    s_waitcnt vmcnt(1)
    v_max3_u32 v10, v10, v48, v49
    v_max3_u32 v10, v10, v50, v51
    s_waitcnt vmcnt(0)
    v_max3_u32 v10, v10, v52, v53
    v_max3_u32 v10, v10, v54, v55
    v_cmp_eq_u32 vcc, -1, v10
    s_cbranch_vccz M_c1_1_restart
    s_add_u32 s30, s30, 1
    s_cmp_ge_u32 s30, 60000
    s_cbranch_scc1 M_fail
    s_branch M_c1_1_vfy
M_c1_1_exact:
    s_nop 7
    s_mov_b32 s70, 2
    s_waitcnt lgkmcnt(0)
    ds_read_b128 v[20:23], v3 offset:18432
    ds_read_b128 v[24:27], v3 offset:18496
    ds_read_b128 v[72:75], v3 offset:18560
    ds_read_b128 v[44:47], v3 offset:18624
    ds_read_b128 v[56:59], v0 offset:0
    s_waitcnt lgkmcnt(0)
    v_mfma_f32_16x16x32_bf16 v[28:31], v[56:59], v[20:23], 0
    s_nop 3
    ds_read_b128 v[60:63], v0 offset:1024
    s_waitcnt lgkmcnt(0)
    v_mfma_f32_16x16x32_bf16 v[28:31], v[60:63], v[24:27], v[28:31]
    s_nop 3
    ds_read_b128 v[56:59], v0 offset:2048
    s_waitcnt lgkmcnt(0)
    v_mfma_f32_16x16x32_bf16 v[28:31], v[56:59], v[72:75], v[28:31]
    s_nop 3
    ds_read_b128 v[60:63], v0 offset:3072
    s_waitcnt lgkmcnt(0)
    v_mfma_f32_16x16x32_bf16 v[28:31], v[60:63], v[44:47], v[28:31]
    s_nop 3
    ds_read_b128 v[56:59], v0 offset:4096
    s_waitcnt lgkmcnt(0)
    v_mfma_f32_16x16x32_bf16 v[32:35], v[56:59], v[20:23], 0
    s_nop 3
    ds_read_b128 v[60:63], v0 offset:5120
    s_waitcnt lgkmcnt(0)
    v_mfma_f32_16x16x32_bf16 v[32:35], v[60:63], v[24:27], v[32:35]
    s_nop 3
    ds_read_b128 v[56:59], v0 offset:6144
    s_waitcnt lgkmcnt(0)
    v_mfma_f32_16x16x32_bf16 v[32:35], v[56:59], v[72:75], v[32:35]
    s_nop 3
    ds_read_b128 v[60:63], v0 offset:7168
    s_waitcnt lgkmcnt(0)
    v_mfma_f32_16x16x32_bf16 v[32:35], v[60:63], v[44:47], v[32:35]
    s_nop 3
    ds_read_b128 v[56:59], v3 offset:20736
    s_waitcnt lgkmcnt(0)
    v_mfma_f32_16x16x32_bf16 v[40:43], v[56:59], v[20:23], 0
    s_nop 3
    ds_read_b128 v[60:63], v3 offset:20800
    s_waitcnt lgkmcnt(0)
    v_mfma_f32_16x16x32_bf16 v[40:43], v[60:63], v[24:27], v[40:43]
    s_nop 3
    ds_read_b128 v[56:59], v3 offset:20864
    s_waitcnt lgkmcnt(0)
    v_mfma_f32_16x16x32_bf16 v[40:43], v[56:59], v[72:75], v[40:43]
    s_nop 3
    ds_read_b128 v[60:63], v3 offset:20928
    s_waitcnt lgkmcnt(0)
    v_mfma_f32_16x16x32_bf16 v[40:43], v[60:63], v[44:47], v[40:43]
    s_nop 3
    v_max3_f32 v68, v28, v29, v30
    v_max3_f32 v68, v68, v31, v32
    v_max3_f32 v68, v68, v33, v34
    s_nop 0
    v_max3_f32 v68, v68, v35, v40
    v_max3_f32 v68, v68, v41, v42
    v_max_f32 v68, v68, v43
    v_mov_b32 v69, v68
    s_nop 1
    v_permlane16_swap_b32 v68, v69
    v_max_f32 v68, v68, v69
    v_mov_b32 v69, v68
    s_nop 1
    v_permlane32_swap_b32 v68, v69
    v_max_f32 v68, v68, v69
    v_sub_f32 v28, v28, v68
    v_exp_f32 v28, v28
    v_sub_f32 v29, v29, v68
    v_exp_f32 v29, v29
    v_sub_f32 v30, v30, v68
    v_exp_f32 v30, v30
    v_sub_f32 v31, v31, v68
    v_exp_f32 v31, v31
    v_sub_f32 v32, v32, v68
    v_exp_f32 v32, v32
    v_sub_f32 v33, v33, v68
    v_exp_f32 v33, v33
    v_sub_f32 v34, v34, v68
    v_exp_f32 v34, v34
    v_sub_f32 v35, v35, v68
    v_exp_f32 v35, v35
    v_sub_f32 v40, v40, v68
    v_exp_f32 v40, v40
    v_sub_f32 v41, v41, v68
    v_exp_f32 v41, v41
    v_sub_f32 v42, v42, v68
    v_exp_f32 v42, v42
    v_sub_f32 v43, v43, v68
    v_exp_f32 v43, v43
    v_cvt_pk_bf16_f32 v28, v28, v29
    v_cvt_pk_bf16_f32 v29, v30, v31
    v_cvt_pk_bf16_f32 v30, v32, v33
    v_cvt_pk_bf16_f32 v31, v34, v35
    v_cvt_pk_bf16_f32 v40, v40, v41
    v_cvt_pk_bf16_f32 v41, v42, v43
    v_mfma_f32_16x16x32_bf16 v[20:23], v[80:83], v[28:31], 0
    v_mfma_f32_16x16x32_bf16 v[24:27], v[84:87], v[28:31], 0
    v_mfma_f32_16x16x32_bf16 v[72:75], v[64:67], v[28:31], 0
    ds_read_b128 v[52:55], v3 offset:20800
    s_waitcnt lgkmcnt(0)
    s_nop 7
    v_mfma_f32_16x16x16_bf16 v[72:75], v[10:11], v[40:41], v[72:75]
    s_nop 7
    s_branch M_c1_1_fin
M_c1_1_last:
    s_cmp_lg_u32 s70, 0
    s_cbranch_scc1 M_c1_1_last2
    v_cmp_u_f32 vcc, v32, v32
    s_cbranch_vccnz M_c1_1_vfy0
M_c1_1_last2:
    s_lshl_b32 s4, s44, 18
    s_add_u32 s4, s4, s53
    buffer_store_dwordx4 v[76:79], v0, s[8:11], s4 offen offset:1024 sc1
    s_mov_b32 s4, 0x10000000
    s_waitcnt vmcnt(0) lgkmcnt(0)
    s_barrier
    v_mov_b32 v11, 8192
    s_mov_b64 exec, 1
    buffer_store_dword v11, v0, s[8:11], s52 offen sc1
    s_mov_b64 exec, -1
    s_add_u32 s52, s52, 4096
    s_nop 7
    v_mov_b64 v[72:73], -1
    v_mov_b64 v[74:75], -1
    s_add_u32 s28, s44, 3
    s_and_b32 s29, s28, 3
    s_mul_i32 s31, s22, 160
    s_mul_i32 s28, s29, 167936
    s_add_u32 s28, s28, s34
    s_add_u32 s64, s28, s35
    s_lshl_b32 s65, s22, 10
    s_add_u32 s65, s65, s28
    s_add_u32 s65, s65, 135168
    buffer_store_dwordx4 v[72:75], v0, s[8:11], s64 offen offset:1024 sc1
    buffer_store_dwordx4 v[72:75], v0, s[8:11], s64 offen offset:2048 sc1
    buffer_store_dwordx4 v[72:75], v0, s[8:11], s65 offen sc1
    s_mov_b32 s65, 0x10000000
    s_mov_b32 s64, 0x10000000
    s_waitcnt vmcnt(0)
    s_add_u32 s44, s44, 1
    s_cmp_eq_u32 s44, 128
    s_cbranch_scc1 M_end
    s_branch M_c1_1_layer
M_c1_1_lr:
    s_mov_b32 s30, 0
M_c1_1_lr_l:
    s_waitcnt lgkmcnt(0)
    ds_read_b128 v[36:39], v6 offset:13312
    ds_read_b128 v[40:43], v6 offset:14336
    ds_read_b128 v[44:47], v6 offset:15360
    ds_read_b128 v[48:51], v6 offset:16384
    ds_read_b128 v[52:55], v6 offset:17408
    s_waitcnt lgkmcnt(2)
    v_max3_u32 v10, v36, v40, v44
    s_waitcnt lgkmcnt(0)
    v_max3_u32 v10, v10, v48, v52
    v_cmp_eq_u32 vcc, -1, v10
    s_cbranch_vccz M_c1_1_lr_d
    s_add_u32 s30, s30, 1
    s_cmp_ge_u32 s30, 480000
    s_cbranch_scc1 M_fail
    s_branch M_c1_1_lr_l
M_c1_1_lr_d:
    ds_read_b128 v[56:59], v5 offset:0
    ds_read_b128 v[60:63], v5 offset:1024
    ds_read_b128 v[64:67], v5 offset:2048
    ds_read_b128 v[68:71], v5 offset:3072
    v_mov_b64 v[12:13], 0
    v_mov_b64 v[14:15], 0
    v_mov_b64 v[16:17], 0
    v_mov_b64 v[18:19], 0
    v_mov_b64 v[20:21], 0
    v_mov_b64 v[22:23], 0
    v_mov_b64 v[24:25], 0
    v_mov_b64 v[26:27], 0
    v_mov_b64 v[28:29], 0
    v_mov_b64 v[30:31], 0
    v_mov_b64 v[32:33], 0
    v_mov_b64 v[34:35], 0
    s_waitcnt lgkmcnt(0)
    s_branch M_c1_1_lr_r
M_c1_1_rr:
    s_mov_b32 s30, 0
M_c1_1_rr_l:
    s_waitcnt lgkmcnt(0)
    s_and_b32 s27, s30, 1
    s_cbranch_scc1 M_c1_1_rr_n
    s_waitcnt vmcnt(1)
    s_mov_b32 m0, 8192
    s_nop 0
    buffer_load_dwordx4 v0, s[8:11], s49 offen offset:2048 sc1 lds
M_c1_1_rr_n:
    ds_read_b128 v[36:39], v6 offset:8192
    ds_read_b128 v[40:43], v6 offset:9216
    ds_read_b128 v[44:47], v6 offset:10240
    ds_read_b128 v[48:51], v6 offset:11264
    ds_read_b32 v11, v6 offset:12288
    s_waitcnt lgkmcnt(2)
    v_max3_u32 v10, v36, v40, v44
    s_waitcnt lgkmcnt(0)
    v_max3_u32 v10, v10, v48, v11
    v_cmp_eq_u32 vcc, -1, v10
    s_cbranch_vccz M_c1_1_rr_d
    s_add_u32 s30, s30, 1
    s_cmp_ge_u32 s30, 480000
    s_cbranch_scc1 M_fail
    s_branch M_c1_1_rr_l
M_c1_1_rr_d:
    s_branch M_c1_1_rr_r
M_c1_1_first:
    s_mul_i32 s27, s21, 167936
    s_add_u32 s27, s27, s34
    s_mul_i32 s28, s22, 4224
    s_add_u32 s28, s28, s27
    s_mov_b32 exec_hi, 0
    buffer_load_dword v10, v9, s[8:11], s28 offen sc1
    s_lshl_b32 s28, s22, 10
    s_add_u32 s28, s28, s27
    s_add_u32 s28, s28, 135168
    s_mov_b64 exec, 0xff
    buffer_load_dword v10, v9, s[8:11], s28 offen sc1
    s_mul_i32 s27, s21, 5120
    s_add_u32 s27, s27, s41
    s_mul_i32 s28, s22, 160
    s_add_u32 s28, s28, s27
    s_mov_b64 exec, 3
    buffer_load_dword v10, v9, s[8:11], s28 offen sc1
    s_mov_b64 exec, -1
    s_barrier
    s_and_b32 s26, s44, 63
    s_lshl_b32 s26, s26, 18
    s_add_u32 s26, s26, s50
    s_add_u32 s26, s26, 2048
    s_add_u32 s3, s26, 16777216
    s_mov_b32 m0, 2048
    s_nop 0
    buffer_load_dwordx4 v0, s[8:11], s26 offen offset:0 sc1 lds
    buffer_load_dwordx4 v0, s[8:11], s26 offen offset:1024 sc1 lds
    buffer_load_dwordx4 v[80:83], v0, s[8:11], s3 offen offset:0 sc1
    buffer_load_dwordx4 v[84:87], v0, s[8:11], s3 offen offset:1024 sc1
    s_and_b32 s26, s44, 63
    s_add_u32 s26, s26, 1
    s_min_u32 s26, s26, 63
    s_lshl_b32 s26, s26, 18
    s_add_u32 s26, s26, s50
    s_add_u32 s26, s26, 2048
    s_add_u32 s3, s26, 16777216
    s_waitcnt vmcnt(0) lgkmcnt(0)
    s_barrier
    s_branch M_c1_1_first_r
M_c1_1_first2:
    ds_read_b64 v[10:11], v0 offset:23296
    s_waitcnt lgkmcnt(0)
    v_min_u32 v10, v10, v11
    s_nop 0
    v_readfirstlane_b32 s28, v10
    s_nop 0
    s_max_u32 s54, s54, s28
    s_add_u32 s27, s44, 2
    s_or_b32 s28, s44, 63
    s_add_u32 s28, s28, 1
    s_min_u32 s27, s27, s28
    s_cmp_lt_u32 s54, s27
    s_cbranch_scc1 M_c1_1_p2
M_c1_1_p2_r:
    s_branch M_c1_1_first2_r
M_c1_1_wq1:
    buffer_load_dwordx4 v[12:15], v0, s[8:11], s43 offen sc1
    s_waitcnt vmcnt(1)
    v_mfma_f32_16x16x32_bf16 v[28:31], v[72:75], v[16:19], 0
    v_cmp_eq_u32 vcc, -1, v16
    s_cbranch_vccnz M_c1_1_wqx
    v_mov_b32 v5, v5
    v_mov_b32 v5, v5
    v_mov_b32 v5, v5
    v_mov_b32 v5, v5
    v_mov_b32 v5, v5
    v_mov_b32 v5, v5
    v_add_f32_dpp v28, v28, v28 row_ror:8 row_mask:0xf bank_mask:0xf
    v_add_f32_dpp v29, v29, v29 row_ror:8 row_mask:0xf bank_mask:0xf
    s_nop 0
    v_add_f32_dpp v28, v28, v28 row_ror:4 row_mask:0xf bank_mask:0xf
    v_add_f32_dpp v29, v29, v29 row_ror:4 row_mask:0xf bank_mask:0xf
    s_nop 0
    v_add_f32_dpp v28, v28, v28 row_ror:2 row_mask:0xf bank_mask:0xf
    v_add_f32_dpp v29, v29, v29 row_ror:2 row_mask:0xf bank_mask:0xf
    v_cmp_u_f32 vcc, v28, v28
    v_cvt_pk_bf16_f32 v28, v28, v29
    s_cbranch_vccnz M_c1_1_wqe1
    s_mov_b64 exec, s[62:63]
    buffer_store_dword v28, v11, s[8:11], s58 offen sc1
    s_barrier
    buffer_store_dword v28, v11, s[8:11], s56 offen sc1
    s_branch M_c1_1_wrb_g
M_c1_1_wqx:
    s_branch M_c1_1_wrb_i1
M_c1_1_wqe1:
    s_waitcnt vmcnt(0)
    buffer_load_dwordx4 v[12:15], v0, s[8:11], s43 offen sc1
    s_branch M_c1_1_wrb_e1
M_c1_1_wrb_l:
    s_waitcnt vmcnt(1)
    v_mfma_f32_16x16x32_bf16 v[28:31], v[72:75], v[12:15], 0
    v_cmp_eq_u32 vcc, -1, v12
    s_cbranch_vccz M_c1_1_wrb_x0
M_c1_1_wrb_i0:
    buffer_load_dwordx4 v[12:15], v0, s[8:11], s43 offen sc1
    s_waitcnt vmcnt(1)
    v_mfma_f32_16x16x32_bf16 v[28:31], v[72:75], v[16:19], 0
    v_cmp_eq_u32 vcc, -1, v16
    s_cbranch_vccz M_c1_1_wrb_x1
M_c1_1_wrb_i1:
    buffer_load_dwordx4 v[16:19], v0, s[8:11], s43 offen sc1
    s_add_u32 s71, s71, 1
    s_cmp_lt_u32 s71, 240000
    s_cbranch_scc1 M_c1_1_wrb_l
    s_branch M_fail
M_c1_1_wrb_x0:
    s_nop 5
    v_add_f32_dpp v28, v28, v28 row_ror:8 row_mask:0xf bank_mask:0xf
    v_add_f32_dpp v29, v29, v29 row_ror:8 row_mask:0xf bank_mask:0xf
    s_nop 0
    v_add_f32_dpp v28, v28, v28 row_ror:4 row_mask:0xf bank_mask:0xf
    v_add_f32_dpp v29, v29, v29 row_ror:4 row_mask:0xf bank_mask:0xf
    s_nop 0
    v_add_f32_dpp v28, v28, v28 row_ror:2 row_mask:0xf bank_mask:0xf
    v_add_f32_dpp v29, v29, v29 row_ror:2 row_mask:0xf bank_mask:0xf
    v_cmp_u_f32 vcc, v28, v28
    v_cvt_pk_bf16_f32 v28, v28, v29
    s_cbranch_vccz M_c1_1_wrb_n
M_c1_1_wrb_e0:
    v_max3_u32 v32, v12, v13, v14
    v_max_u32 v32, v32, v15
    v_cmp_eq_u32 vcc, -1, v32
    s_cbranch_vccnz M_c1_1_wrb_i0
    v_min_u32 v28, -2, v28
    v_min_u32 v29, -2, v29
    s_branch M_c1_1_wrb_n
M_c1_1_wrb_x1:
    s_nop 5
    v_add_f32_dpp v28, v28, v28 row_ror:8 row_mask:0xf bank_mask:0xf
    v_add_f32_dpp v29, v29, v29 row_ror:8 row_mask:0xf bank_mask:0xf
    s_nop 0
    v_add_f32_dpp v28, v28, v28 row_ror:4 row_mask:0xf bank_mask:0xf
    v_add_f32_dpp v29, v29, v29 row_ror:4 row_mask:0xf bank_mask:0xf
    s_nop 0
    v_add_f32_dpp v28, v28, v28 row_ror:2 row_mask:0xf bank_mask:0xf
    v_add_f32_dpp v29, v29, v29 row_ror:2 row_mask:0xf bank_mask:0xf
    v_cmp_u_f32 vcc, v28, v28
    v_cvt_pk_bf16_f32 v28, v28, v29
    s_cbranch_vccz M_c1_1_wrb_n
M_c1_1_wrb_e1:
    v_max3_u32 v32, v16, v17, v18
    v_max_u32 v32, v32, v19
    v_cmp_eq_u32 vcc, -1, v32
    s_cbranch_vccnz M_c1_1_wrb_i1
    v_min_u32 v28, -2, v28
    v_min_u32 v29, -2, v29
M_c1_1_wrb_n:
    s_mov_b64 exec, s[62:63]
    buffer_store_dword v28, v11, s[8:11], s58 offen sc1
    s_branch M_c1_1_wrb_d
M_c1_1_p2:
    s_mov_b32 s30, 0
M_c1_1_p2_l:
    s_waitcnt lgkmcnt(0)
    s_mov_b64 exec, 3
    buffer_load_dword v10, v9, s[8:11], s51 offen sc1
    s_waitcnt vmcnt(0)
    s_mov_b64 exec, -1
    v_readlane_b32 s54, v10, 0
    v_readlane_b32 s28, v10, 1
    s_nop 3
    s_min_u32 s54, s54, s28
    s_cmp_ge_u32 s54, s27
    s_cbranch_scc1 M_c1_1_p2_r
    s_sleep 2
    s_add_u32 s30, s30, 1
    s_cmp_ge_u32 s30, 240000
    s_cbranch_scc1 M_fail
    s_branch M_c1_1_p2_l
M_c1_2_layer:
    s_lshr_b32 s27, s44, 6
    s_mul_i32 s50, s27, 33554432
    s_lshl_b32 s27, s22, 13
    s_add_u32 s50, s50, s27
    s_add_u32 s50, s50, 37748736
    s_barrier
    s_mov_b32 s26, 0x10010000
    s_mov_b32 s3, s26
    s_mul_i32 s27, s20, 5120
    s_add_u32 s48, s27, 167772160
    s_sub_u32 s49, 167777280, s27
    s_mov_b32 m0, 13312
    s_nop 0
    buffer_load_dwordx4 v0, s[8:11], s48 offen offset:0 sc1 lds
    buffer_load_dwordx4 v0, s[8:11], s48 offen offset:1024 sc1 lds
    buffer_load_dwordx4 v0, s[8:11], s48 offen offset:2048 sc1 lds
    s_and_b32 s55, s44, 3
    s_mul_i32 s55, s55, 167936
    s_add_u32 s55, s55, s34
    s_add_u32 s58, s55, s35
    s_and_b32 s57, s44, 63
    s_add_u32 s42, s44, 2
    s_or_b32 s28, s44, 63
    s_add_u32 s28, s28, 1
    s_min_u32 s42, s42, s28
    s_sub_u32 s61, s3, 4096
    s_cmp_ge_u32 s54, s42
    s_cselect_b32 s61, s61, 0x10000000
    ds_read_b128 v[56:59], v5 offset:0
    ds_read_b128 v[60:63], v5 offset:1024
    ds_read_b128 v[64:67], v5 offset:2048
    ds_read_b128 v[68:71], v5 offset:3072
    v_mov_b64 v[12:13], 0
    v_mov_b64 v[14:15], 0
    v_mov_b64 v[16:17], 0
    v_mov_b64 v[18:19], 0
    v_mov_b64 v[20:21], 0
    v_mov_b64 v[22:23], 0
    v_mov_b64 v[24:25], 0
    v_mov_b64 v[26:27], 0
    v_mov_b64 v[28:29], 0
    v_mov_b64 v[30:31], 0
    v_mov_b64 v[32:33], 0
    v_mov_b64 v[34:35], 0
    s_mov_b32 s70, 0
    s_waitcnt vmcnt(0) lgkmcnt(0)
M_c1_2_top:
    s_waitcnt vmcnt(6)
    s_barrier
    ds_read_b128 v[36:39], v6 offset:13312
    ds_read_b128 v[40:43], v6 offset:14336
    s_mov_b32 m0, 8192
    s_nop 0
    buffer_load_dwordx4 v0, s[8:11], s49 offen offset:3072 sc1 lds
M_c1_2_lr_r:
    s_waitcnt lgkmcnt(1)
    v_smfmac_f32_16x16x64_bf16 v[20:23], v[36:39], v[56:63], v1
    ds_read_b128 v[56:59], v5 offset:4096
    v_smfmac_f32_16x16x64_bf16 v[24:27], v[36:39], v[64:71], v1
    ds_read_b128 v[60:63], v5 offset:5120
    v_smfmac_f32_16x16x64_bf16 v[28:31], v[36:39], a[248:255], v1
    ds_read_b128 v[64:67], v5 offset:6144
    v_smfmac_f32_16x16x64_bf16 v[32:35], v[36:39], a[240:247], v1
    ds_read_b128 v[68:71], v5 offset:7168
    v_smfmac_f32_16x16x64_bf16 v[12:15], v[36:39], a[232:239], v1
    ds_read_b128 v[44:47], v6 offset:15360
    s_waitcnt lgkmcnt(3)
    v_smfmac_f32_16x16x64_bf16 v[16:19], v[36:39], v[56:63], v1
    ds_read_b128 v[56:59], v5 offset:8192
    v_smfmac_f32_16x16x64_bf16 v[20:23], v[40:43], a[224:231], v1
    ds_read_b128 v[60:63], v5 offset:9216
    s_waitcnt lgkmcnt(3)
    v_smfmac_f32_16x16x64_bf16 v[24:27], v[40:43], v[64:71], v1
    ds_read_b128 v[64:67], v5 offset:10240
    v_smfmac_f32_16x16x64_bf16 v[28:31], v[40:43], a[216:223], v1
    ds_read_b128 v[68:71], v5 offset:11264
    v_smfmac_f32_16x16x64_bf16 v[32:35], v[40:43], a[208:215], v1
    ds_read_b128 v[48:51], v6 offset:16384
    s_waitcnt lgkmcnt(3)
    v_smfmac_f32_16x16x64_bf16 v[12:15], v[40:43], v[56:63], v1
    ds_read_b128 v[56:59], v5 offset:12288
    v_smfmac_f32_16x16x64_bf16 v[16:19], v[40:43], a[200:207], v1
    ds_read_b128 v[60:63], v5 offset:13312
    s_waitcnt lgkmcnt(3)
    v_smfmac_f32_16x16x64_bf16 v[20:23], v[44:47], v[64:71], v1
    ds_read_b128 v[64:67], v5 offset:14336
    v_smfmac_f32_16x16x64_bf16 v[24:27], v[44:47], a[192:199], v1
    ds_read_b128 v[68:71], v5 offset:15360
    v_smfmac_f32_16x16x64_bf16 v[28:31], v[44:47], a[184:191], v1
    ds_read_b128 v[52:55], v6 offset:17408
    s_waitcnt lgkmcnt(3)
    v_smfmac_f32_16x16x64_bf16 v[32:35], v[44:47], v[56:63], v1
    ds_read_b128 v[56:59], v5 offset:16384
    v_smfmac_f32_16x16x64_bf16 v[20:23], v[48:51], a[176:183], v1
    ds_read_b128 v[60:63], v5 offset:17408
    s_waitcnt lgkmcnt(3)
    v_max3_u32 v10, v36, v40, v44
    v_smfmac_f32_16x16x64_bf16 v[24:27], v[48:51], v[64:71], v1
    ds_read_b128 v[64:67], v5 offset:18432
    s_waitcnt lgkmcnt(3)
    v_max3_u32 v10, v10, v48, v52
    v_smfmac_f32_16x16x64_bf16 v[28:31], v[48:51], a[168:175], v1
    ds_read_b128 v[68:71], v5 offset:19456
    v_cmp_eq_u32 vcc, -1, v10
    v_smfmac_f32_16x16x64_bf16 v[32:35], v[48:51], a[160:167], v1
    s_cbranch_vccnz M_c1_2_lr
    s_waitcnt vmcnt(0)
    s_barrier
    ds_read_b128 v[36:39], v6 offset:8192
    ds_read_b128 v[40:43], v6 offset:9216
    s_waitcnt lgkmcnt(4)
    v_smfmac_f32_16x16x64_bf16 v[20:23], v[52:55], v[56:63], v1
    ds_read_b128 v[44:47], v6 offset:10240
    ds_read_b128 v[48:51], v6 offset:11264
    v_smfmac_f32_16x16x64_bf16 v[24:27], v[52:55], a[152:159], v1
    ds_read_b32 v11, v6 offset:12288
    ds_read_b128 v[56:59], v5 offset:20480
    s_waitcnt lgkmcnt(6)
    v_smfmac_f32_16x16x64_bf16 v[28:31], v[52:55], v[64:71], v1
    ds_read_b128 v[60:63], v5 offset:21504
    s_waitcnt lgkmcnt(4)
    v_max3_u32 v10, v36, v40, v44
    v_smfmac_f32_16x16x64_bf16 v[32:35], v[52:55], a[144:151], v1
    s_waitcnt lgkmcnt(2)
    v_max3_u32 v10, v10, v48, v11
    v_cmp_eq_u32 vcc, -1, v10
    s_cbranch_vccnz M_c1_2_rr
M_c1_2_rr_r:
    s_mov_b32 m0, 23040
    ds_read_b128 v[64:67], v5 offset:22528
    ds_read_b128 v[68:71], v5 offset:23552
    ds_read_b128 v[52:55], v6 offset:12288
    buffer_store_dwordx4 v[76:79], v0, s[8:11], s4 offen offset:2048 sc1
    s_mov_b32 s4, 0x10000000
    buffer_load_dword v9, s[8:11], s61 offen sc1 lds
    v_smfmac_f32_16x16x64_bf16 v[20:23], v[36:39], a[136:143], v1
    s_waitcnt lgkmcnt(3)
    v_smfmac_f32_16x16x64_bf16 v[24:27], v[36:39], v[56:63], v1
    ds_read_b128 v[56:59], v5 offset:24576
    v_smfmac_f32_16x16x64_bf16 v[20:23], v[40:43], a[128:135], v1
    ds_read_b128 v[60:63], v5 offset:25600
    s_waitcnt lgkmcnt(3)
    v_smfmac_f32_16x16x64_bf16 v[24:27], v[40:43], v[64:71], v1
    ds_read_b128 v[64:67], v5 offset:26624
    v_smfmac_f32_16x16x64_bf16 v[20:23], v[44:47], a[120:127], v1
    ds_read_b128 v[68:71], v5 offset:27648
    v_smfmac_f32_16x16x64_bf16 v[24:27], v[44:47], a[112:119], v1
    s_waitcnt lgkmcnt(2)
    v_smfmac_f32_16x16x64_bf16 v[20:23], v[48:51], v[56:63], v1
    ds_read_b128 v[56:59], v5 offset:28672
    v_smfmac_f32_16x16x64_bf16 v[24:27], v[48:51], a[104:111], v1
    ds_read_b128 v[60:63], v5 offset:29696
    s_waitcnt lgkmcnt(2)
    v_smfmac_f32_16x16x64_bf16 v[20:23], v[52:55], v[64:71], v1
    ds_read_b128 v[64:67], v5 offset:30720
    v_smfmac_f32_16x16x64_bf16 v[24:27], v[52:55], a[96:103], v1
    ds_read_b128 v[68:71], v5 offset:31744
    v_smfmac_f32_16x16x64_bf16 v[28:31], v[36:39], a[88:95], v1
    s_cmp_eq_u32 s57, 0
    s_cbranch_scc1 M_c1_2_first
M_c1_2_first_r:
    s_waitcnt lgkmcnt(2)
    v_smfmac_f32_16x16x64_bf16 v[32:35], v[36:39], v[56:63], v1
    ds_read_b128 v[56:59], v5 offset:32768
    v_permlane32_swap_b32 v20, v21
    v_smfmac_f32_16x16x64_bf16 v[28:31], v[40:43], a[80:87], v1
    ds_read_b128 v[60:63], v5 offset:33792
    s_waitcnt lgkmcnt(2)
    v_permlane32_swap_b32 v22, v23
    v_smfmac_f32_16x16x64_bf16 v[32:35], v[40:43], v[64:71], v1
    ds_read_b128 v[64:67], v0 offset:2048
    v_permlane32_swap_b32 v24, v25
    v_smfmac_f32_16x16x64_bf16 v[28:31], v[44:47], a[72:79], v1
    ds_read_b128 v[68:71], v0 offset:3072
    v_permlane32_swap_b32 v26, v27
    v_smfmac_f32_16x16x64_bf16 v[32:35], v[44:47], a[64:71], v1
    s_waitcnt lgkmcnt(2)
    v_add_f32 v20, v20, v21
    v_add_f32 v22, v22, v23
    v_smfmac_f32_16x16x64_bf16 v[28:31], v[48:51], v[56:63], v1
    ds_read_b128 v[56:59], v0 offset:0
    v_add_f32 v24, v24, v25
    v_add_f32 v26, v26, v27
    v_smfmac_f32_16x16x64_bf16 v[32:35], v[48:51], a[56:63], v1
    ds_read_b128 v[60:63], v0 offset:1024
    v_mul_f32 v20, s40, v20
    v_mul_f32 v24, s40, v24
    v_smfmac_f32_16x16x64_bf16 v[28:31], v[52:55], a[48:55], v1
    v_mul_f32 v22, s40, v22
    v_mul_f32 v26, s40, v26
    v_smfmac_f32_16x16x64_bf16 v[32:35], v[52:55], a[40:47], v1
    v_cvt_pk_bf16_f32 v20, v20, v24
    v_cvt_pk_bf16_f32 v21, v22, v26
    v_smfmac_f32_16x16x64_bf16 v[12:15], v[36:39], a[32:39], v1
    ds_write_b32 v2, v20 offset:18432
    v_smfmac_f32_16x16x64_bf16 v[16:19], v[36:39], a[24:31], v1
    ds_write_b32 v2, v21 offset:19008
    v_permlane32_swap_b32 v28, v29
    v_smfmac_f32_16x16x64_bf16 v[12:15], v[40:43], a[16:23], v1
    ds_read_b128 v[36:39], v6 offset:15360
    v_permlane32_swap_b32 v30, v31
    v_smfmac_f32_16x16x64_bf16 v[16:19], v[40:43], a[8:15], v1
    ds_read_b128 v[40:43], v6 offset:16384
    v_permlane32_swap_b32 v32, v33
    v_smfmac_f32_16x16x64_bf16 v[12:15], v[44:47], a[0:7], v1
    s_waitcnt lgkmcnt(2)
    s_barrier
    v_permlane32_swap_b32 v34, v35
    v_smfmac_f32_16x16x64_bf16 v[16:19], v[44:47], v[248:255], v1
    ds_read_b128 v[20:23], v3 offset:18432
    v_add_f32 v28, v28, v29
    v_add_f32 v30, v30, v31
    v_smfmac_f32_16x16x64_bf16 v[12:15], v[48:51], v[240:247], v1
    ds_read_b128 v[24:27], v3 offset:18496
    v_add_f32 v32, v32, v33
    v_add_f32 v34, v34, v35
    v_smfmac_f32_16x16x64_bf16 v[16:19], v[48:51], v[232:239], v1
    ds_read_b128 v[72:75], v3 offset:18560
    v_cvt_pk_bf16_f32 v28, v28, v32
    v_cvt_pk_bf16_f32 v29, v30, v34
    v_smfmac_f32_16x16x64_bf16 v[12:15], v[52:55], v[224:231], v1
    ds_write_b32 v2, v28 offset:20736
    ds_read_b128 v[44:47], v3 offset:18624
    v_smfmac_f32_16x16x64_bf16 v[16:19], v[52:55], v[216:223], v1
    ds_write_b32 v2, v29 offset:21312
    s_waitcnt lgkmcnt(7)
    v_smfmac_f32_16x16x64_bf16 v[12:15], v[36:39], v[208:215], v1
    ds_read_b128 v[48:51], v6 offset:17408
    v_mov_b64 v[10:11], s[16:17]
    v_smfmac_f32_16x16x64_bf16 v[16:19], v[36:39], v[200:207], v1
    s_waitcnt lgkmcnt(6)
    v_mfma_f32_16x16x32_bf16 v[28:31], v[56:59], v[20:23], 0
    ds_read_b128 v[56:59], v0 offset:4096
    s_waitcnt lgkmcnt(6)
    v_mfma_f32_16x16x32_bf16 v[28:31], v[60:63], v[24:27], v[28:31]
    ds_read_b128 v[60:63], v0 offset:5120
    s_waitcnt lgkmcnt(3)
    s_barrier
    v_mfma_f32_16x16x32_bf16 v[28:31], v[64:67], v[72:75], v[28:31]
    ds_read_b128 v[64:67], v0 offset:6144
    v_mfma_f32_16x16x32_bf16 v[28:31], v[68:71], v[44:47], v[28:31]
    ds_read_b128 v[68:71], v0 offset:7168
    v_smfmac_f32_16x16x64_bf16 v[12:15], v[40:43], v[192:199], v1
    ds_read_b128 v[36:39], v3 offset:20736
    v_smfmac_f32_16x16x64_bf16 v[16:19], v[40:43], v[184:191], v1
    ds_read_b128 v[52:55], v3 offset:20800
    s_waitcnt lgkmcnt(4)
    v_mfma_f32_16x16x32_bf16 v[32:35], v[56:59], v[20:23], 0
    s_nop 0
    v_exp_f32 v28, v28
    ds_read_b128 v[56:59], v3 offset:20864
    v_mfma_f32_16x16x32_bf16 v[32:35], v[60:63], v[24:27], v[32:35]
    s_waitcnt lgkmcnt(3)
    v_exp_f32 v29, v29
    ds_read_b128 v[60:63], v3 offset:20928
    v_mfma_f32_16x16x32_bf16 v[32:35], v[64:67], v[72:75], v[32:35]
    v_exp_f32 v30, v30
    v_mfma_f32_16x16x32_bf16 v[32:35], v[68:71], v[44:47], v[32:35]
    s_waitcnt lgkmcnt(3)
    v_exp_f32 v31, v31
    v_mfma_f32_16x16x32_bf16 v[40:43], v[36:39], v[20:23], 0
    s_waitcnt lgkmcnt(2)
    v_cvt_pk_bf16_f32 v28, v28, v29
    v_cvt_pk_bf16_f32 v29, v30, v31
    v_mfma_f32_16x16x32_bf16 v[40:43], v[52:55], v[24:27], v[40:43]
    s_waitcnt lgkmcnt(1)
    v_mov_b64 v[64:65], s[24:25]
    v_mov_b64 v[66:67], s[24:25]
    v_mfma_f32_16x16x32_bf16 v[40:43], v[56:59], v[72:75], v[40:43]
    s_waitcnt lgkmcnt(0)
    v_exp_f32 v32, v32
    v_mfma_f32_16x16x32_bf16 v[40:43], v[60:63], v[44:47], v[40:43]
    v_exp_f32 v33, v33
    v_smfmac_f32_16x16x64_bf16 v[12:15], v[48:51], v[176:183], v1
    v_exp_f32 v34, v34
    v_smfmac_f32_16x16x64_bf16 v[16:19], v[48:51], v[168:175], v1
    v_exp_f32 v35, v35
    v_cvt_pk_bf16_f32 v30, v32, v33
    v_cvt_pk_bf16_f32 v31, v34, v35
    s_nop 0
    v_exp_f32 v40, v40
    v_mfma_f32_16x16x32_bf16 v[72:75], v[64:67], v[28:31], 0
    v_exp_f32 v41, v41
    v_mfma_f32_16x16x32_bf16 v[20:23], v[80:83], v[28:31], 0
    v_exp_f32 v42, v42
    v_mfma_f32_16x16x32_bf16 v[24:27], v[84:87], v[28:31], 0
    v_exp_f32 v43, v43
    v_cvt_pk_bf16_f32 v40, v40, v41
    v_cvt_pk_bf16_f32 v41, v42, v43
    v_cvt_pk_bf16_f32 v12, v12, v13
    v_cvt_pk_bf16_f32 v13, v14, v15
    v_mfma_f32_16x16x16_bf16 v[72:75], v[10:11], v[40:41], v[72:75]
    v_cvt_pk_bf16_f32 v14, v16, v17
    v_cvt_pk_bf16_f32 v15, v18, v19
M_c1_2_fin:
    v_mfma_f32_16x16x16_bf16 v[20:23], v[12:13], v[40:41], v[20:23]
    s_cmp_eq_u32 s57, 63
    v_cndmask_b32_e64 v76, v12, v56, s[66:67]
    v_cndmask_b32_e64 v77, v13, v57, s[66:67]
    v_mfma_f32_16x16x16_bf16 v[24:27], v[14:15], v[40:41], v[24:27]
    v_cndmask_b32_e64 v78, v14, v58, s[66:67]
    v_cndmask_b32_e64 v79, v15, v59, s[66:67]
    s_cbranch_scc1 M_c1_2_last
    v_rcp_f32 v74, v72
    v_subrev_u32 v73, s68, v72
    v_cmp_lt_u32 vcc, s69, v73
    v_mov_b64 v[44:45], 0
    v_mov_b64 v[46:47], 0
    v_cndmask_b32_e64 v20, v20, v24, s[18:19]
    v_cndmask_b32_e64 v21, v21, v25, s[18:19]
    v_cndmask_b32_e64 v22, v22, v26, s[18:19]
    v_cndmask_b32_e64 v23, v23, v27, s[18:19]
    v_pk_mul_f32 v[20:21], v[20:21], v[74:75] op_sel_hi:[1,0]
    v_pk_mul_f32 v[22:23], v[22:23], v[74:75] op_sel_hi:[1,0]
    v_cvt_pk_bf16_f32 v20, v20, v21
    v_cvt_pk_bf16_f32 v21, v22, v23
    ds_write_b64 v0, v[20:21] offset:14336
    s_cbranch_vccnz M_c1_2_zbad
M_c1_2_zok:
    s_cmp_lt_u32 s54, s42
    s_cbranch_scc1 M_c1_2_first2
M_c1_2_first2_r:
    buffer_load_dwordx4 v[80:83], v0, s[8:11], s3 offen offset:0 sc1
    buffer_load_dwordx4 v[84:87], v0, s[8:11], s3 offen offset:1024 sc1
    s_waitcnt lgkmcnt(0)
    s_barrier
    ds_read_b128 v[32:35], v0 offset:13312
    ds_read_b128 v[52:55], v0 offset:14336
    s_mov_b32 m0, 4096
    s_nop 0
    buffer_load_dwordx4 v0, s[8:11], s26 offen offset:0 sc1 lds
    buffer_load_dwordx4 v0, s[8:11], s26 offen offset:1024 sc1 lds
    v_mov_b64 v[68:69], 0
    v_mov_b64 v[70:71], 0
    v_mov_b64 v[64:65], 0
    v_mov_b64 v[66:67], 0
    v_mov_b64 v[60:61], 0
    v_mov_b64 v[62:63], 0
    v_mov_b64 v[56:57], 0
    v_mov_b64 v[58:59], 0
    s_waitcnt lgkmcnt(1)
    s_nop 0
    v_smfmac_f32_16x16x64_bf16 v[56:59], v[32:35], v[160:167], v1
    v_smfmac_f32_16x16x64_bf16 v[60:63], v[32:35], v[144:151], v1
    s_waitcnt lgkmcnt(0)
    v_smfmac_f32_16x16x64_bf16 v[56:59], v[52:55], v[152:159], v1
    v_smfmac_f32_16x16x64_bf16 v[60:63], v[52:55], v[136:143], v1
    v_smfmac_f32_16x16x64_bf16 v[64:67], v[32:35], v[128:135], v1
    v_smfmac_f32_16x16x64_bf16 v[68:71], v[32:35], v[112:119], v1
    v_permlane32_swap_b32 v56, v57
    v_smfmac_f32_16x16x64_bf16 v[64:67], v[52:55], v[120:127], v1
    v_permlane32_swap_b32 v58, v59
    v_smfmac_f32_16x16x64_bf16 v[68:71], v[52:55], v[104:111], v1
    v_add_f32 v56, v56, v57
    v_add_f32 v58, v58, v59
    v_smfmac_f32_16x16x64_bf16 v[44:47], v[32:35], v[96:103], v1
    v_permlane32_swap_b32 v60, v61
    v_smfmac_f32_16x16x64_bf16 v[44:47], v[52:55], v[88:95], v1
    v_permlane32_swap_b32 v62, v63
    v_add_f32 v60, v60, v61
    v_add_f32 v62, v62, v63
    v_cvt_pk_bf16_f32 v36, v56, v60
    v_cvt_pk_bf16_f32 v38, v58, v62
    v_permlane32_swap_b32 v64, v65
    v_permlane32_swap_b32 v66, v67
    v_add_f32 v64, v64, v65
    v_add_f32 v66, v66, v67
    v_permlane32_swap_b32 v68, v69
    v_permlane32_swap_b32 v70, v71
    v_add_f32 v68, v68, v69
    v_add_f32 v70, v70, v71
    v_cvt_pk_bf16_f32 v37, v64, v68
    v_cvt_pk_bf16_f32 v39, v66, v70
    buffer_store_dwordx4 v[36:39], v0, s[8:11], s58 offen sc1
    v_permlane32_swap_b32 v44, v45
    v_permlane32_swap_b32 v46, v47
    v_add_f32 v44, v44, v45
    v_add_f32 v46, v46, v47
    v_cvt_pk_bf16_f32 v44, v44, v46
    buffer_store_dword v44, v7, s[8:11], s55 offen sc1
    s_add_u32 s27, s44, 1
    s_and_b32 s27, s27, 3
    s_mul_i32 s48, s27, 5120
    s_add_u32 s48, s48, s41
    s_lshl_b32 s27, s27, 15
    s_add_u32 s49, s27, s47
    ds_read_b128 v[56:59], v5 offset:0
    ds_read_b128 v[60:63], v5 offset:1024
    ds_read_b128 v[64:67], v5 offset:2048
    ds_read_b128 v[68:71], v5 offset:3072
    v_mov_b64 v[12:13], 0
    v_mov_b64 v[14:15], 0
    v_mov_b64 v[16:17], 0
    v_mov_b64 v[18:19], 0
    v_mov_b64 v[20:21], 0
    v_mov_b64 v[22:23], 0
    v_mov_b64 v[24:25], 0
    v_mov_b64 v[26:27], 0
    v_mov_b64 v[28:29], 0
    v_mov_b64 v[30:31], 0
    v_mov_b64 v[32:33], 0
    v_mov_b64 v[34:35], 0
    ds_read_b64 v[10:11], v0 offset:23296
    s_waitcnt lgkmcnt(0)
    v_min_u32 v10, v10, v11
    s_nop 0
    v_readfirstlane_b32 s28, v10
    s_nop 0
    s_max_u32 s54, s54, s28
    s_barrier
    s_and_b32 s26, s44, 63
    s_add_u32 s26, s26, 2
    s_min_u32 s26, s26, 63
    s_lshl_b32 s26, s26, 18
    s_add_u32 s26, s26, s50
    s_add_u32 s26, s26, 4096
    s_add_u32 s3, s26, 16777216
    s_lshl_b32 s4, s44, 18
    s_add_u32 s4, s4, s53
    s_add_u32 s44, s44, 1
    s_and_b32 s55, s44, 3
    s_mul_i32 s55, s55, 167936
    s_add_u32 s55, s55, s34
    s_add_u32 s58, s55, s35
    s_and_b32 s57, s44, 63
    s_add_u32 s42, s44, 2
    s_or_b32 s28, s44, 63
    s_add_u32 s28, s28, 1
    s_min_u32 s42, s42, s28
    s_sub_u32 s61, s3, 4096
    s_cmp_ge_u32 s54, s42
    s_cselect_b32 s61, s61, 0x10000000
    s_nop 15
    s_nop 15
    s_nop 5
    s_mov_b32 m0, 13312
    s_nop 0
    buffer_load_dwordx4 v0, s[8:11], s48 offen offset:0 sc1 lds
    buffer_load_dwordx4 v0, s[8:11], s48 offen offset:1024 sc1 lds
    buffer_load_dwordx4 v0, s[8:11], s48 offen offset:2048 sc1 lds
    s_nop 13
    s_mov_b32 m0, 13312
    s_nop 0
    buffer_load_dwordx4 v0, s[8:11], s48 offen offset:0 sc1 lds
    buffer_load_dwordx4 v0, s[8:11], s48 offen offset:1024 sc1 lds
    buffer_load_dwordx4 v0, s[8:11], s48 offen offset:2048 sc1 lds
    s_nop 13
    s_mov_b32 m0, 13312
    s_nop 0
    buffer_load_dwordx4 v0, s[8:11], s48 offen offset:0 sc1 lds
    buffer_load_dwordx4 v0, s[8:11], s48 offen offset:1024 sc1 lds
    buffer_load_dwordx4 v0, s[8:11], s48 offen offset:2048 sc1 lds
    s_mov_b32 s70, 0
    s_branch M_c1_2_top
M_c1_2_restart:
    s_waitcnt vmcnt(0) lgkmcnt(0)
    s_nop 7
    s_barrier
    s_mov_b32 m0, 13312
    s_nop 0
    buffer_load_dwordx4 v0, s[8:11], s48 offen offset:0 sc1 lds
    buffer_load_dwordx4 v0, s[8:11], s48 offen offset:1024 sc1 lds
    buffer_load_dwordx4 v0, s[8:11], s48 offen offset:2048 sc1 lds
    ds_read_b128 v[56:59], v5 offset:0
    ds_read_b128 v[60:63], v5 offset:1024
    ds_read_b128 v[64:67], v5 offset:2048
    ds_read_b128 v[68:71], v5 offset:3072
    v_mov_b64 v[12:13], 0
    v_mov_b64 v[14:15], 0
    v_mov_b64 v[16:17], 0
    v_mov_b64 v[18:19], 0
    v_mov_b64 v[20:21], 0
    v_mov_b64 v[22:23], 0
    v_mov_b64 v[24:25], 0
    v_mov_b64 v[26:27], 0
    v_mov_b64 v[28:29], 0
    v_mov_b64 v[30:31], 0
    v_mov_b64 v[32:33], 0
    v_mov_b64 v[34:35], 0
    s_waitcnt vmcnt(0) lgkmcnt(0)
    s_branch M_c1_2_top
M_c1_2_zbad:
    s_cmp_eq_u32 s70, 2
    s_cbranch_scc1 M_c1_2_zok
    v_cmp_u_f32 vcc, v72, v72
    s_cbranch_vccz M_c1_2_exact
    s_cmp_eq_u32 s70, 1
    s_cbranch_scc1 M_c1_2_exact
M_c1_2_vfy0:
    s_mov_b32 s70, 1
    s_mov_b32 s30, 0
    s_waitcnt vmcnt(0) lgkmcnt(0)
    s_nop 7
M_c1_2_vfy:
    v_mov_b32 v10, 0
    s_add_u32 s59, s48, 4096
    buffer_load_dwordx4 v[36:39], v0, s[8:11], s48 offen offset:0 sc1
    buffer_load_dwordx4 v[40:43], v0, s[8:11], s48 offen offset:1024 sc1
    buffer_load_dwordx4 v[44:47], v0, s[8:11], s48 offen offset:2048 sc1
    buffer_load_dwordx4 v[48:51], v0, s[8:11], s48 offen offset:3072 sc1
    buffer_load_dwordx4 v[52:55], v0, s[8:11], s59 offen offset:0 sc1
    s_waitcnt vmcnt(4)
    v_max3_u32 v10, v10, v36, v37
    v_max3_u32 v10, v10, v38, v39
    s_waitcnt vmcnt(3)
    v_max3_u32 v10, v10, v40, v41
    v_max3_u32 v10, v10, v42, v43
    s_waitcnt vmcnt(2)
    v_max3_u32 v10, v10, v44, v45
    v_max3_u32 v10, v10, v46, v47
    s_waitcnt vmcnt(1)
    v_max3_u32 v10, v10, v48, v49
    v_max3_u32 v10, v10, v50, v51
    s_waitcnt vmcnt(0)
    v_max3_u32 v10, v10, v52, v53
    v_max3_u32 v10, v10, v54, v55
    s_add_u32 s59, s49, 4096
    buffer_load_dwordx4 v[36:39], v0, s[8:11], s49 offen offset:0 sc1
    buffer_load_dwordx4 v[40:43], v0, s[8:11], s49 offen offset:1024 sc1
    buffer_load_dwordx4 v[44:47], v0, s[8:11], s49 offen offset:2048 sc1
    buffer_load_dwordx4 v[48:51], v0, s[8:11], s49 offen offset:3072 sc1
    buffer_load_dwordx4 v[52:55], v0, s[8:11], s59 offen offset:0 sc1
    s_waitcnt vmcnt(4)
    v_max3_u32 v10, v10, v36, v37
    v_max3_u32 v10, v10, v38, v39
    s_waitcnt vmcnt(3)
    v_max3_u32 v10, v10, v40, v41
    v_max3_u32 v10, v10, v42, v43
    s_waitcnt vmcnt(2)
    v_max3_u32 v10, v10, v44, v45
    v_max3_u32 v10, v10, v46, v47
    s_waitcnt vmcnt(1)
    v_max3_u32 v10, v10, v48, v49
    v_max3_u32 v10, v10, v50, v51
    s_waitcnt vmcnt(0)
    v_max3_u32 v10, v10, v52, v53
    v_max3_u32 v10, v10, v54, v55
    v_cmp_eq_u32 vcc, -1, v10
    s_cbranch_vccz M_c1_2_restart
    s_add_u32 s30, s30, 1
    s_cmp_ge_u32 s30, 60000
    s_cbranch_scc1 M_fail
    s_branch M_c1_2_vfy
M_c1_2_exact:
    s_nop 7
    s_mov_b32 s70, 2
    s_waitcnt lgkmcnt(0)
    ds_read_b128 v[20:23], v3 offset:18432
    ds_read_b128 v[24:27], v3 offset:18496
    ds_read_b128 v[72:75], v3 offset:18560
    ds_read_b128 v[44:47], v3 offset:18624
    ds_read_b128 v[56:59], v0 offset:0
    s_waitcnt lgkmcnt(0)
    v_mfma_f32_16x16x32_bf16 v[28:31], v[56:59], v[20:23], 0
    s_nop 3
    ds_read_b128 v[60:63], v0 offset:1024
    s_waitcnt lgkmcnt(0)
    v_mfma_f32_16x16x32_bf16 v[28:31], v[60:63], v[24:27], v[28:31]
    s_nop 3
    ds_read_b128 v[56:59], v0 offset:2048
    s_waitcnt lgkmcnt(0)
    v_mfma_f32_16x16x32_bf16 v[28:31], v[56:59], v[72:75], v[28:31]
    s_nop 3
    ds_read_b128 v[60:63], v0 offset:3072
    s_waitcnt lgkmcnt(0)
    v_mfma_f32_16x16x32_bf16 v[28:31], v[60:63], v[44:47], v[28:31]
    s_nop 3
    ds_read_b128 v[56:59], v0 offset:4096
    s_waitcnt lgkmcnt(0)
    v_mfma_f32_16x16x32_bf16 v[32:35], v[56:59], v[20:23], 0
    s_nop 3
    ds_read_b128 v[60:63], v0 offset:5120
    s_waitcnt lgkmcnt(0)
    v_mfma_f32_16x16x32_bf16 v[32:35], v[60:63], v[24:27], v[32:35]
    s_nop 3
    ds_read_b128 v[56:59], v0 offset:6144
    s_waitcnt lgkmcnt(0)
    v_mfma_f32_16x16x32_bf16 v[32:35], v[56:59], v[72:75], v[32:35]
    s_nop 3
    ds_read_b128 v[60:63], v0 offset:7168
    s_waitcnt lgkmcnt(0)
    v_mfma_f32_16x16x32_bf16 v[32:35], v[60:63], v[44:47], v[32:35]
    s_nop 3
    ds_read_b128 v[56:59], v3 offset:20736
    s_waitcnt lgkmcnt(0)
    v_mfma_f32_16x16x32_bf16 v[40:43], v[56:59], v[20:23], 0
    s_nop 3
    ds_read_b128 v[60:63], v3 offset:20800
    s_waitcnt lgkmcnt(0)
    v_mfma_f32_16x16x32_bf16 v[40:43], v[60:63], v[24:27], v[40:43]
    s_nop 3
    ds_read_b128 v[56:59], v3 offset:20864
    s_waitcnt lgkmcnt(0)
    v_mfma_f32_16x16x32_bf16 v[40:43], v[56:59], v[72:75], v[40:43]
    s_nop 3
    ds_read_b128 v[60:63], v3 offset:20928
    s_waitcnt lgkmcnt(0)
    v_mfma_f32_16x16x32_bf16 v[40:43], v[60:63], v[44:47], v[40:43]
    s_nop 3
    v_max3_f32 v68, v28, v29, v30
    v_max3_f32 v68, v68, v31, v32
    v_max3_f32 v68, v68, v33, v34
    s_nop 0
    v_max3_f32 v68, v68, v35, v40
    v_max3_f32 v68, v68, v41, v42
    v_max_f32 v68, v68, v43
    v_mov_b32 v69, v68
    s_nop 1
    v_permlane16_swap_b32 v68, v69
    v_max_f32 v68, v68, v69
    v_mov_b32 v69, v68
    s_nop 1
    v_permlane32_swap_b32 v68, v69
    v_max_f32 v68, v68, v69
    v_sub_f32 v28, v28, v68
    v_exp_f32 v28, v28
    v_sub_f32 v29, v29, v68
    v_exp_f32 v29, v29
    v_sub_f32 v30, v30, v68
    v_exp_f32 v30, v30
    v_sub_f32 v31, v31, v68
    v_exp_f32 v31, v31
    v_sub_f32 v32, v32, v68
    v_exp_f32 v32, v32
    v_sub_f32 v33, v33, v68
    v_exp_f32 v33, v33
    v_sub_f32 v34, v34, v68
    v_exp_f32 v34, v34
    v_sub_f32 v35, v35, v68
    v_exp_f32 v35, v35
    v_sub_f32 v40, v40, v68
    v_exp_f32 v40, v40
    v_sub_f32 v41, v41, v68
    v_exp_f32 v41, v41
    v_sub_f32 v42, v42, v68
    v_exp_f32 v42, v42
    v_sub_f32 v43, v43, v68
    v_exp_f32 v43, v43
    v_cvt_pk_bf16_f32 v28, v28, v29
    v_cvt_pk_bf16_f32 v29, v30, v31
    v_cvt_pk_bf16_f32 v30, v32, v33
    v_cvt_pk_bf16_f32 v31, v34, v35
    v_cvt_pk_bf16_f32 v40, v40, v41
    v_cvt_pk_bf16_f32 v41, v42, v43
    v_mfma_f32_16x16x32_bf16 v[20:23], v[80:83], v[28:31], 0
    v_mfma_f32_16x16x32_bf16 v[24:27], v[84:87], v[28:31], 0
    v_mfma_f32_16x16x32_bf16 v[72:75], v[64:67], v[28:31], 0
    ds_read_b128 v[56:59], v3 offset:20864
    s_waitcnt lgkmcnt(0)
    s_nop 7
    v_mfma_f32_16x16x16_bf16 v[72:75], v[10:11], v[40:41], v[72:75]
    s_nop 7
    s_branch M_c1_2_fin
M_c1_2_last:
    s_cmp_lg_u32 s70, 0
    s_cbranch_scc1 M_c1_2_last2
    v_cmp_u_f32 vcc, v32, v32
    s_cbranch_vccnz M_c1_2_vfy0
M_c1_2_last2:
    s_lshl_b32 s4, s44, 18
    s_add_u32 s4, s4, s53
    buffer_store_dwordx4 v[76:79], v0, s[8:11], s4 offen offset:2048 sc1
    s_mov_b32 s4, 0x10000000
    s_waitcnt vmcnt(0) lgkmcnt(0)
    s_barrier
    s_nop 7
    v_mov_b64 v[72:73], -1
    v_mov_b64 v[74:75], -1
    s_add_u32 s28, s44, 3
    s_and_b32 s29, s28, 3
    s_mul_i32 s31, s22, 160
    s_waitcnt vmcnt(0)
    s_add_u32 s44, s44, 1
    s_cmp_eq_u32 s44, 128
    s_cbranch_scc1 M_end
    s_branch M_c1_2_layer
M_c1_2_lr:
    s_mov_b32 s30, 0
M_c1_2_lr_l:
    s_waitcnt lgkmcnt(0)
    s_and_b32 s27, s30, 1
    s_cbranch_scc0 M_c1_2_lr_n
    s_waitcnt vmcnt(3)
    s_mov_b32 m0, 13312
    s_nop 0
    buffer_load_dwordx4 v0, s[8:11], s48 offen offset:0 sc1 lds
    buffer_load_dwordx4 v0, s[8:11], s48 offen offset:1024 sc1 lds
    buffer_load_dwordx4 v0, s[8:11], s48 offen offset:2048 sc1 lds
M_c1_2_lr_n:
    ds_read_b128 v[36:39], v6 offset:13312
    ds_read_b128 v[40:43], v6 offset:14336
    ds_read_b128 v[44:47], v6 offset:15360
    ds_read_b128 v[48:51], v6 offset:16384
    ds_read_b128 v[52:55], v6 offset:17408
    s_waitcnt lgkmcnt(2)
    v_max3_u32 v10, v36, v40, v44
    s_waitcnt lgkmcnt(0)
    v_max3_u32 v10, v10, v48, v52
    v_cmp_eq_u32 vcc, -1, v10
    s_cbranch_vccz M_c1_2_lr_d
    s_add_u32 s30, s30, 1
    s_cmp_ge_u32 s30, 480000
    s_cbranch_scc1 M_fail
    s_branch M_c1_2_lr_l
M_c1_2_lr_d:
    ds_read_b128 v[56:59], v5 offset:0
    ds_read_b128 v[60:63], v5 offset:1024
    ds_read_b128 v[64:67], v5 offset:2048
    ds_read_b128 v[68:71], v5 offset:3072
    v_mov_b64 v[12:13], 0
    v_mov_b64 v[14:15], 0
    v_mov_b64 v[16:17], 0
    v_mov_b64 v[18:19], 0
    v_mov_b64 v[20:21], 0
    v_mov_b64 v[22:23], 0
    v_mov_b64 v[24:25], 0
    v_mov_b64 v[26:27], 0
    v_mov_b64 v[28:29], 0
    v_mov_b64 v[30:31], 0
    v_mov_b64 v[32:33], 0
    v_mov_b64 v[34:35], 0
    s_waitcnt lgkmcnt(0)
    s_branch M_c1_2_lr_r
M_c1_2_rr:
    s_mov_b32 s30, 0
M_c1_2_rr_l:
    s_waitcnt lgkmcnt(0)
    s_and_b32 s27, s30, 1
    s_cbranch_scc1 M_c1_2_rr_n
    s_waitcnt vmcnt(1)
    s_mov_b32 m0, 8192
    s_nop 0
    buffer_load_dwordx4 v0, s[8:11], s49 offen offset:3072 sc1 lds
M_c1_2_rr_n:
    ds_read_b128 v[36:39], v6 offset:8192
    ds_read_b128 v[40:43], v6 offset:9216
    ds_read_b128 v[44:47], v6 offset:10240
    ds_read_b128 v[48:51], v6 offset:11264
    ds_read_b32 v11, v6 offset:12288
    s_waitcnt lgkmcnt(2)
    v_max3_u32 v10, v36, v40, v44
    s_waitcnt lgkmcnt(0)
    v_max3_u32 v10, v10, v48, v11
    v_cmp_eq_u32 vcc, -1, v10
    s_cbranch_vccz M_c1_2_rr_d
    s_add_u32 s30, s30, 1
    s_cmp_ge_u32 s30, 480000
    s_cbranch_scc1 M_fail
    s_branch M_c1_2_rr_l
M_c1_2_rr_d:
    s_branch M_c1_2_rr_r
M_c1_2_first:
    s_mul_i32 s27, s21, 167936
    s_add_u32 s27, s27, s34
    s_mul_i32 s28, s22, 4224
    s_add_u32 s28, s28, s27
    s_mov_b32 exec_hi, 0
    buffer_load_dword v10, v9, s[8:11], s28 offen sc1
    s_lshl_b32 s28, s22, 10
    s_add_u32 s28, s28, s27
    s_add_u32 s28, s28, 135168
    s_mov_b64 exec, 0xff
    buffer_load_dword v10, v9, s[8:11], s28 offen sc1
    s_mul_i32 s27, s21, 5120
    s_add_u32 s27, s27, s41
    s_mul_i32 s28, s22, 160
    s_add_u32 s28, s28, s27
    s_mov_b64 exec, 3
    buffer_load_dword v10, v9, s[8:11], s28 offen sc1
    s_mov_b64 exec, -1
    s_barrier
    s_and_b32 s26, s44, 63
    s_lshl_b32 s26, s26, 18
    s_add_u32 s26, s26, s50
    s_add_u32 s26, s26, 4096
    s_add_u32 s3, s26, 16777216
    s_mov_b32 m0, 4096
    s_nop 0
    buffer_load_dwordx4 v0, s[8:11], s26 offen offset:0 sc1 lds
    buffer_load_dwordx4 v0, s[8:11], s26 offen offset:1024 sc1 lds
    buffer_load_dwordx4 v[80:83], v0, s[8:11], s3 offen offset:0 sc1
    buffer_load_dwordx4 v[84:87], v0, s[8:11], s3 offen offset:1024 sc1
    s_and_b32 s26, s44, 63
    s_add_u32 s26, s26, 1
    s_min_u32 s26, s26, 63
    s_lshl_b32 s26, s26, 18
    s_add_u32 s26, s26, s50
    s_add_u32 s26, s26, 4096
    s_add_u32 s3, s26, 16777216
    s_waitcnt vmcnt(0) lgkmcnt(0)
    s_barrier
    s_branch M_c1_2_first_r
M_c1_2_first2:
    ds_read_b64 v[10:11], v0 offset:23296
    s_waitcnt lgkmcnt(0)
    v_min_u32 v10, v10, v11
    s_nop 0
    v_readfirstlane_b32 s28, v10
    s_nop 0
    s_max_u32 s54, s54, s28
    s_add_u32 s27, s44, 2
    s_or_b32 s28, s44, 63
    s_add_u32 s28, s28, 1
    s_min_u32 s27, s27, s28
    s_cmp_lt_u32 s54, s27
    s_cbranch_scc1 M_c1_2_p2
M_c1_2_p2_r:
    s_branch M_c1_2_first2_r
M_c1_2_p2:
    s_mov_b32 s30, 0
M_c1_2_p2_l:
    s_waitcnt lgkmcnt(0)
    s_mov_b64 exec, 3
    buffer_load_dword v10, v9, s[8:11], s51 offen sc1
    s_waitcnt vmcnt(0)
    s_mov_b64 exec, -1
    v_readlane_b32 s54, v10, 0
    v_readlane_b32 s28, v10, 1
    s_nop 3
    s_min_u32 s54, s54, s28
    s_cmp_ge_u32 s54, s27
    s_cbranch_scc1 M_c1_2_p2_r
    s_sleep 2
    s_add_u32 s30, s30, 1
    s_cmp_ge_u32 s30, 240000
    s_cbranch_scc1 M_fail
    s_branch M_c1_2_p2_l
M_c1_3_layer:
    s_lshr_b32 s27, s44, 6
    s_mul_i32 s50, s27, 33554432
    s_lshl_b32 s27, s22, 13
    s_add_u32 s50, s50, s27
    s_add_u32 s50, s50, 37748736
    s_barrier
    s_mov_b32 s26, 0x10010000
    s_mov_b32 s3, s26
    s_mul_i32 s27, s20, 5120
    s_add_u32 s48, s27, 167772160
    s_sub_u32 s49, 167777280, s27
    s_mov_b32 m0, 13312
    s_nop 0
    buffer_load_dwordx4 v0, s[8:11], s48 offen offset:3072 sc1 lds
    s_mov_b32 m0, 17408
    s_add_u32 s59, s48, 4096
    buffer_load_dwordx4 v0, s[8:11], s59 offen offset:0 sc1 lds
    s_and_b32 s55, s44, 3
    s_mul_i32 s55, s55, 167936
    s_add_u32 s55, s55, s34
    s_add_u32 s58, s55, s35
    s_and_b32 s57, s44, 63
    s_add_u32 s42, s44, 2
    s_or_b32 s28, s44, 63
    s_add_u32 s28, s28, 1
    s_min_u32 s42, s42, s28
    s_sub_u32 s61, s26, 6144
    s_cmp_ge_u32 s54, s42
    s_cselect_b32 s61, s61, 0x10000000
    ds_read_b128 v[56:59], v5 offset:0
    ds_read_b128 v[60:63], v5 offset:1024
    ds_read_b128 v[64:67], v5 offset:2048
    ds_read_b128 v[68:71], v5 offset:3072
    v_mov_b64 v[12:13], 0
    v_mov_b64 v[14:15], 0
    v_mov_b64 v[16:17], 0
    v_mov_b64 v[18:19], 0
    v_mov_b64 v[20:21], 0
    v_mov_b64 v[22:23], 0
    v_mov_b64 v[24:25], 0
    v_mov_b64 v[26:27], 0
    v_mov_b64 v[28:29], 0
    v_mov_b64 v[30:31], 0
    v_mov_b64 v[32:33], 0
    v_mov_b64 v[34:35], 0
    s_mov_b32 s70, 0
    s_waitcnt vmcnt(0) lgkmcnt(0)
M_c1_3_top:
    s_waitcnt vmcnt(4)
    s_barrier
    ds_read_b128 v[36:39], v6 offset:13312
    ds_read_b128 v[40:43], v6 offset:14336
    s_mov_b32 m0, 12288
    s_add_u32 s59, s49, 4096
    buffer_load_dwordx4 v0, s[8:11], s59 offen offset:0 sc1 lds
M_c1_3_lr_r:
    s_waitcnt lgkmcnt(1)
    v_smfmac_f32_16x16x64_bf16 v[20:23], v[36:39], v[56:63], v1
    ds_read_b128 v[56:59], v5 offset:4096
    v_smfmac_f32_16x16x64_bf16 v[24:27], v[36:39], v[64:71], v1
    ds_read_b128 v[60:63], v5 offset:5120
    v_smfmac_f32_16x16x64_bf16 v[28:31], v[36:39], a[248:255], v1
    ds_read_b128 v[64:67], v5 offset:6144
    v_smfmac_f32_16x16x64_bf16 v[32:35], v[36:39], a[240:247], v1
    ds_read_b128 v[68:71], v5 offset:7168
    v_smfmac_f32_16x16x64_bf16 v[12:15], v[36:39], a[232:239], v1
    ds_read_b128 v[44:47], v6 offset:15360
    s_waitcnt lgkmcnt(3)
    v_smfmac_f32_16x16x64_bf16 v[16:19], v[36:39], v[56:63], v1
    ds_read_b128 v[56:59], v5 offset:8192
    v_smfmac_f32_16x16x64_bf16 v[20:23], v[40:43], a[224:231], v1
    ds_read_b128 v[60:63], v5 offset:9216
    s_waitcnt lgkmcnt(3)
    v_smfmac_f32_16x16x64_bf16 v[24:27], v[40:43], v[64:71], v1
    ds_read_b128 v[64:67], v5 offset:10240
    v_smfmac_f32_16x16x64_bf16 v[28:31], v[40:43], a[216:223], v1
    ds_read_b128 v[68:71], v5 offset:11264
    v_smfmac_f32_16x16x64_bf16 v[32:35], v[40:43], a[208:215], v1
    ds_read_b128 v[48:51], v6 offset:16384
    s_waitcnt lgkmcnt(3)
    v_smfmac_f32_16x16x64_bf16 v[12:15], v[40:43], v[56:63], v1
    ds_read_b128 v[56:59], v5 offset:12288
    v_smfmac_f32_16x16x64_bf16 v[16:19], v[40:43], a[200:207], v1
    ds_read_b128 v[60:63], v5 offset:13312
    s_waitcnt lgkmcnt(3)
    v_smfmac_f32_16x16x64_bf16 v[20:23], v[44:47], v[64:71], v1
    ds_read_b128 v[64:67], v5 offset:14336
    v_smfmac_f32_16x16x64_bf16 v[24:27], v[44:47], a[192:199], v1
    ds_read_b128 v[68:71], v5 offset:15360
    v_smfmac_f32_16x16x64_bf16 v[28:31], v[44:47], a[184:191], v1
    ds_read_b128 v[52:55], v6 offset:17408
    s_waitcnt lgkmcnt(3)
    v_smfmac_f32_16x16x64_bf16 v[32:35], v[44:47], v[56:63], v1
    ds_read_b128 v[56:59], v5 offset:16384
    v_smfmac_f32_16x16x64_bf16 v[20:23], v[48:51], a[176:183], v1
    ds_read_b128 v[60:63], v5 offset:17408
    s_waitcnt lgkmcnt(3)
    v_max3_u32 v10, v36, v40, v44
    v_smfmac_f32_16x16x64_bf16 v[24:27], v[48:51], v[64:71], v1
    ds_read_b128 v[64:67], v5 offset:18432
    s_waitcnt lgkmcnt(3)
    v_max3_u32 v10, v10, v48, v52
    v_smfmac_f32_16x16x64_bf16 v[28:31], v[48:51], a[168:175], v1
    ds_read_b128 v[68:71], v5 offset:19456
    v_cmp_eq_u32 vcc, -1, v10
    v_smfmac_f32_16x16x64_bf16 v[32:35], v[48:51], a[160:167], v1
    s_cbranch_vccnz M_c1_3_lr
    s_waitcnt vmcnt(0)
    s_barrier
    ds_read_b128 v[36:39], v6 offset:8192
    ds_read_b128 v[40:43], v6 offset:9216
    s_waitcnt lgkmcnt(4)
    v_smfmac_f32_16x16x64_bf16 v[20:23], v[52:55], v[56:63], v1
    ds_read_b128 v[44:47], v6 offset:10240
    ds_read_b128 v[48:51], v6 offset:11264
    v_smfmac_f32_16x16x64_bf16 v[24:27], v[52:55], a[152:159], v1
    ds_read_b32 v11, v6 offset:12288
    ds_read_b128 v[56:59], v5 offset:20480
    s_waitcnt lgkmcnt(6)
    v_smfmac_f32_16x16x64_bf16 v[28:31], v[52:55], v[64:71], v1
    ds_read_b128 v[60:63], v5 offset:21504
    s_waitcnt lgkmcnt(4)
    v_max3_u32 v10, v36, v40, v44
    v_smfmac_f32_16x16x64_bf16 v[32:35], v[52:55], a[144:151], v1
    s_waitcnt lgkmcnt(2)
    v_max3_u32 v10, v10, v48, v11
    v_cmp_eq_u32 vcc, -1, v10
    s_cbranch_vccnz M_c1_3_rr
M_c1_3_rr_r:
    s_mov_b32 m0, 23040
    ds_read_b128 v[64:67], v5 offset:22528
    ds_read_b128 v[68:71], v5 offset:23552
    ds_read_b128 v[52:55], v6 offset:12288
    buffer_store_dwordx4 v[76:79], v0, s[8:11], s4 offen offset:3072 sc1
    s_mov_b32 s4, 0x10000000
    buffer_load_dword v9, s[8:11], s61 offen sc1 lds
    v_smfmac_f32_16x16x64_bf16 v[20:23], v[36:39], a[136:143], v1
    s_waitcnt lgkmcnt(3)
    v_smfmac_f32_16x16x64_bf16 v[24:27], v[36:39], v[56:63], v1
    ds_read_b128 v[56:59], v5 offset:24576
    v_smfmac_f32_16x16x64_bf16 v[20:23], v[40:43], a[128:135], v1
    ds_read_b128 v[60:63], v5 offset:25600
    s_waitcnt lgkmcnt(3)
    v_smfmac_f32_16x16x64_bf16 v[24:27], v[40:43], v[64:71], v1
    ds_read_b128 v[64:67], v5 offset:26624
    v_smfmac_f32_16x16x64_bf16 v[20:23], v[44:47], a[120:127], v1
    ds_read_b128 v[68:71], v5 offset:27648
    v_smfmac_f32_16x16x64_bf16 v[24:27], v[44:47], a[112:119], v1
    s_waitcnt lgkmcnt(2)
    v_smfmac_f32_16x16x64_bf16 v[20:23], v[48:51], v[56:63], v1
    ds_read_b128 v[56:59], v5 offset:28672
    v_smfmac_f32_16x16x64_bf16 v[24:27], v[48:51], a[104:111], v1
    ds_read_b128 v[60:63], v5 offset:29696
    s_waitcnt lgkmcnt(2)
    v_smfmac_f32_16x16x64_bf16 v[20:23], v[52:55], v[64:71], v1
    ds_read_b128 v[64:67], v5 offset:30720
    v_smfmac_f32_16x16x64_bf16 v[24:27], v[52:55], a[96:103], v1
    ds_read_b128 v[68:71], v5 offset:31744
    v_smfmac_f32_16x16x64_bf16 v[28:31], v[36:39], a[88:95], v1
    s_cmp_eq_u32 s57, 0
    s_cbranch_scc1 M_c1_3_first
M_c1_3_first_r:
    s_waitcnt lgkmcnt(2)
    v_smfmac_f32_16x16x64_bf16 v[32:35], v[36:39], v[56:63], v1
    ds_read_b128 v[56:59], v5 offset:32768
    v_permlane32_swap_b32 v20, v21
    v_smfmac_f32_16x16x64_bf16 v[28:31], v[40:43], a[80:87], v1
    ds_read_b128 v[60:63], v5 offset:33792
    s_waitcnt lgkmcnt(2)
    v_permlane32_swap_b32 v22, v23
    v_smfmac_f32_16x16x64_bf16 v[32:35], v[40:43], v[64:71], v1
    ds_read_b128 v[64:67], v0 offset:2048
    v_permlane32_swap_b32 v24, v25
    v_smfmac_f32_16x16x64_bf16 v[28:31], v[44:47], a[72:79], v1
    ds_read_b128 v[68:71], v0 offset:3072
    v_permlane32_swap_b32 v26, v27
    v_smfmac_f32_16x16x64_bf16 v[32:35], v[44:47], a[64:71], v1
    s_waitcnt lgkmcnt(2)
    v_add_f32 v20, v20, v21
    v_add_f32 v22, v22, v23
    v_smfmac_f32_16x16x64_bf16 v[28:31], v[48:51], v[56:63], v1
    ds_read_b128 v[56:59], v0 offset:0
    v_add_f32 v24, v24, v25
    v_add_f32 v26, v26, v27
    v_smfmac_f32_16x16x64_bf16 v[32:35], v[48:51], a[56:63], v1
    ds_read_b128 v[60:63], v0 offset:1024
    v_mul_f32 v20, s40, v20
    v_mul_f32 v24, s40, v24
    v_smfmac_f32_16x16x64_bf16 v[28:31], v[52:55], a[48:55], v1
    v_mul_f32 v22, s40, v22
    v_mul_f32 v26, s40, v26
    v_smfmac_f32_16x16x64_bf16 v[32:35], v[52:55], a[40:47], v1
    v_cvt_pk_bf16_f32 v20, v20, v24
    v_cvt_pk_bf16_f32 v21, v22, v26
    v_smfmac_f32_16x16x64_bf16 v[12:15], v[36:39], a[32:39], v1
    ds_write_b32 v2, v20 offset:18432
    v_smfmac_f32_16x16x64_bf16 v[16:19], v[36:39], a[24:31], v1
    ds_write_b32 v2, v21 offset:19008
    v_permlane32_swap_b32 v28, v29
    v_smfmac_f32_16x16x64_bf16 v[12:15], v[40:43], a[16:23], v1
    ds_read_b128 v[36:39], v6 offset:15360
    v_permlane32_swap_b32 v30, v31
    v_smfmac_f32_16x16x64_bf16 v[16:19], v[40:43], a[8:15], v1
    ds_read_b128 v[40:43], v6 offset:16384
    v_permlane32_swap_b32 v32, v33
    v_smfmac_f32_16x16x64_bf16 v[12:15], v[44:47], a[0:7], v1
    s_waitcnt lgkmcnt(2)
    s_barrier
    v_permlane32_swap_b32 v34, v35
    v_smfmac_f32_16x16x64_bf16 v[16:19], v[44:47], v[248:255], v1
    ds_read_b128 v[20:23], v3 offset:18432
    v_add_f32 v28, v28, v29
    v_add_f32 v30, v30, v31
    v_smfmac_f32_16x16x64_bf16 v[12:15], v[48:51], v[240:247], v1
    ds_read_b128 v[24:27], v3 offset:18496
    v_add_f32 v32, v32, v33
    v_add_f32 v34, v34, v35
    v_smfmac_f32_16x16x64_bf16 v[16:19], v[48:51], v[232:239], v1
    ds_read_b128 v[72:75], v3 offset:18560
    v_cvt_pk_bf16_f32 v28, v28, v32
    v_cvt_pk_bf16_f32 v29, v30, v34
    v_smfmac_f32_16x16x64_bf16 v[12:15], v[52:55], v[224:231], v1
    ds_write_b32 v2, v28 offset:20736
    ds_read_b128 v[44:47], v3 offset:18624
    v_smfmac_f32_16x16x64_bf16 v[16:19], v[52:55], v[216:223], v1
    ds_write_b32 v2, v29 offset:21312
    s_waitcnt lgkmcnt(7)
    v_smfmac_f32_16x16x64_bf16 v[12:15], v[36:39], v[208:215], v1
    ds_read_b128 v[48:51], v6 offset:17408
    v_mov_b64 v[10:11], s[16:17]
    v_smfmac_f32_16x16x64_bf16 v[16:19], v[36:39], v[200:207], v1
    s_waitcnt lgkmcnt(6)
    v_mfma_f32_16x16x32_bf16 v[28:31], v[56:59], v[20:23], 0
    ds_read_b128 v[56:59], v0 offset:4096
    s_waitcnt lgkmcnt(6)
    v_mfma_f32_16x16x32_bf16 v[28:31], v[60:63], v[24:27], v[28:31]
    ds_read_b128 v[60:63], v0 offset:5120
    s_waitcnt lgkmcnt(3)
    s_barrier
    v_mfma_f32_16x16x32_bf16 v[28:31], v[64:67], v[72:75], v[28:31]
    ds_read_b128 v[64:67], v0 offset:6144
    v_mfma_f32_16x16x32_bf16 v[28:31], v[68:71], v[44:47], v[28:31]
    ds_read_b128 v[68:71], v0 offset:7168
    v_smfmac_f32_16x16x64_bf16 v[12:15], v[40:43], v[192:199], v1
    ds_read_b128 v[36:39], v3 offset:20736
    v_smfmac_f32_16x16x64_bf16 v[16:19], v[40:43], v[184:191], v1
    ds_read_b128 v[52:55], v3 offset:20800
    s_waitcnt lgkmcnt(4)
    v_mfma_f32_16x16x32_bf16 v[32:35], v[56:59], v[20:23], 0
    s_nop 0
    v_exp_f32 v28, v28
    ds_read_b128 v[56:59], v3 offset:20864
    v_mfma_f32_16x16x32_bf16 v[32:35], v[60:63], v[24:27], v[32:35]
    s_waitcnt lgkmcnt(3)
    v_exp_f32 v29, v29
    ds_read_b128 v[60:63], v3 offset:20928
    v_mfma_f32_16x16x32_bf16 v[32:35], v[64:67], v[72:75], v[32:35]
    v_exp_f32 v30, v30
    v_mfma_f32_16x16x32_bf16 v[32:35], v[68:71], v[44:47], v[32:35]
    s_waitcnt lgkmcnt(3)
    v_exp_f32 v31, v31
    v_mfma_f32_16x16x32_bf16 v[40:43], v[36:39], v[20:23], 0
    s_waitcnt lgkmcnt(2)
    v_cvt_pk_bf16_f32 v28, v28, v29
    v_cvt_pk_bf16_f32 v29, v30, v31
    v_mfma_f32_16x16x32_bf16 v[40:43], v[52:55], v[24:27], v[40:43]
    s_waitcnt lgkmcnt(1)
    v_mov_b64 v[64:65], s[24:25]
    v_mov_b64 v[66:67], s[24:25]
    v_mfma_f32_16x16x32_bf16 v[40:43], v[56:59], v[72:75], v[40:43]
    s_waitcnt lgkmcnt(0)
    v_exp_f32 v32, v32
    v_mfma_f32_16x16x32_bf16 v[40:43], v[60:63], v[44:47], v[40:43]
    v_exp_f32 v33, v33
    v_smfmac_f32_16x16x64_bf16 v[12:15], v[48:51], v[176:183], v1
    v_exp_f32 v34, v34
    v_smfmac_f32_16x16x64_bf16 v[16:19], v[48:51], v[168:175], v1
    v_exp_f32 v35, v35
    v_cvt_pk_bf16_f32 v30, v32, v33
    v_cvt_pk_bf16_f32 v31, v34, v35
    s_nop 0
    v_exp_f32 v40, v40
    v_mfma_f32_16x16x32_bf16 v[72:75], v[64:67], v[28:31], 0
    v_exp_f32 v41, v41
    v_mfma_f32_16x16x32_bf16 v[20:23], v[80:83], v[28:31], 0
    v_exp_f32 v42, v42
    v_mfma_f32_16x16x32_bf16 v[24:27], v[84:87], v[28:31], 0
    v_exp_f32 v43, v43
    v_cvt_pk_bf16_f32 v40, v40, v41
    v_cvt_pk_bf16_f32 v41, v42, v43
    v_cvt_pk_bf16_f32 v12, v12, v13
    v_cvt_pk_bf16_f32 v13, v14, v15
    v_mfma_f32_16x16x16_bf16 v[72:75], v[10:11], v[40:41], v[72:75]
    v_cvt_pk_bf16_f32 v14, v16, v17
    v_cvt_pk_bf16_f32 v15, v18, v19
M_c1_3_fin:
    v_mfma_f32_16x16x16_bf16 v[20:23], v[12:13], v[40:41], v[20:23]
    s_cmp_eq_u32 s57, 63
    v_cndmask_b32_e64 v76, v12, v60, s[66:67]
    v_cndmask_b32_e64 v77, v13, v61, s[66:67]
    v_mfma_f32_16x16x16_bf16 v[24:27], v[14:15], v[40:41], v[24:27]
    v_cndmask_b32_e64 v78, v14, v62, s[66:67]
    v_cndmask_b32_e64 v79, v15, v63, s[66:67]
    s_cbranch_scc1 M_c1_3_last
    v_rcp_f32 v74, v72
    v_subrev_u32 v73, s68, v72
    v_cmp_lt_u32 vcc, s69, v73
    v_mov_b64 v[44:45], 0
    v_mov_b64 v[46:47], 0
    v_cndmask_b32_e64 v20, v20, v24, s[18:19]
    v_cndmask_b32_e64 v21, v21, v25, s[18:19]
    v_cndmask_b32_e64 v22, v22, v26, s[18:19]
    v_cndmask_b32_e64 v23, v23, v27, s[18:19]
    v_pk_mul_f32 v[20:21], v[20:21], v[74:75] op_sel_hi:[1,0]
    v_pk_mul_f32 v[22:23], v[22:23], v[74:75] op_sel_hi:[1,0]
    v_cvt_pk_bf16_f32 v20, v20, v21
    v_cvt_pk_bf16_f32 v21, v22, v23
    ds_write_b64 v0, v[20:21] offset:14344
    s_cbranch_vccnz M_c1_3_zbad
M_c1_3_zok:
    s_cmp_lt_u32 s54, s42
    s_cbranch_scc1 M_c1_3_first2
M_c1_3_first2_r:
    buffer_load_dwordx4 v[80:83], v0, s[8:11], s3 offen offset:0 sc1
    buffer_load_dwordx4 v[84:87], v0, s[8:11], s3 offen offset:1024 sc1
    s_waitcnt lgkmcnt(0)
    s_barrier
    ds_read_b128 v[32:35], v0 offset:13312
    ds_read_b128 v[52:55], v0 offset:14336
    s_mov_b32 m0, 6144
    s_nop 0
    buffer_load_dwordx4 v0, s[8:11], s26 offen offset:0 sc1 lds
    buffer_load_dwordx4 v0, s[8:11], s26 offen offset:1024 sc1 lds
    v_mov_b64 v[68:69], 0
    v_mov_b64 v[70:71], 0
    v_mov_b64 v[64:65], 0
    v_mov_b64 v[66:67], 0
    v_mov_b64 v[60:61], 0
    v_mov_b64 v[62:63], 0
    v_mov_b64 v[56:57], 0
    v_mov_b64 v[58:59], 0
    s_waitcnt lgkmcnt(1)
    s_nop 0
    v_smfmac_f32_16x16x64_bf16 v[56:59], v[32:35], v[160:167], v1
    v_smfmac_f32_16x16x64_bf16 v[60:63], v[32:35], v[144:151], v1
    s_waitcnt lgkmcnt(0)
    v_smfmac_f32_16x16x64_bf16 v[56:59], v[52:55], v[152:159], v1
    v_smfmac_f32_16x16x64_bf16 v[60:63], v[52:55], v[136:143], v1
    v_smfmac_f32_16x16x64_bf16 v[64:67], v[32:35], v[128:135], v1
    v_smfmac_f32_16x16x64_bf16 v[68:71], v[32:35], v[112:119], v1
    v_permlane32_swap_b32 v56, v57
    v_smfmac_f32_16x16x64_bf16 v[64:67], v[52:55], v[120:127], v1
    v_permlane32_swap_b32 v58, v59
    v_smfmac_f32_16x16x64_bf16 v[68:71], v[52:55], v[104:111], v1
    v_add_f32 v56, v56, v57
    v_add_f32 v58, v58, v59
    v_smfmac_f32_16x16x64_bf16 v[44:47], v[32:35], v[96:103], v1
    v_permlane32_swap_b32 v60, v61
    v_smfmac_f32_16x16x64_bf16 v[44:47], v[52:55], v[88:95], v1
    v_permlane32_swap_b32 v62, v63
    v_add_f32 v60, v60, v61
    v_add_f32 v62, v62, v63
    v_cvt_pk_bf16_f32 v36, v56, v60
    v_cvt_pk_bf16_f32 v38, v58, v62
    v_permlane32_swap_b32 v64, v65
    v_permlane32_swap_b32 v66, v67
    v_add_f32 v64, v64, v65
    v_add_f32 v66, v66, v67
    v_permlane32_swap_b32 v68, v69
    v_permlane32_swap_b32 v70, v71
    v_add_f32 v68, v68, v69
    v_add_f32 v70, v70, v71
    v_cvt_pk_bf16_f32 v37, v64, v68
    v_cvt_pk_bf16_f32 v39, v66, v70
    buffer_store_dwordx4 v[36:39], v0, s[8:11], s58 offen sc1
    v_permlane32_swap_b32 v44, v45
    v_permlane32_swap_b32 v46, v47
    v_add_f32 v44, v44, v45
    v_add_f32 v46, v46, v47
    v_cvt_pk_bf16_f32 v44, v44, v46
    buffer_store_dword v44, v7, s[8:11], s55 offen sc1
    s_add_u32 s27, s44, 1
    s_and_b32 s27, s27, 3
    s_mul_i32 s48, s27, 5120
    s_add_u32 s48, s48, s41
    s_lshl_b32 s27, s27, 15
    s_add_u32 s49, s27, s47
    ds_read_b128 v[56:59], v5 offset:0
    ds_read_b128 v[60:63], v5 offset:1024
    ds_read_b128 v[64:67], v5 offset:2048
    ds_read_b128 v[68:71], v5 offset:3072
    v_mov_b64 v[12:13], 0
    v_mov_b64 v[14:15], 0
    v_mov_b64 v[16:17], 0
    v_mov_b64 v[18:19], 0
    v_mov_b64 v[20:21], 0
    v_mov_b64 v[22:23], 0
    v_mov_b64 v[24:25], 0
    v_mov_b64 v[26:27], 0
    v_mov_b64 v[28:29], 0
    v_mov_b64 v[30:31], 0
    v_mov_b64 v[32:33], 0
    v_mov_b64 v[34:35], 0
    ds_read_b64 v[10:11], v0 offset:23296
    s_waitcnt lgkmcnt(0)
    v_min_u32 v10, v10, v11
    s_nop 0
    v_readfirstlane_b32 s28, v10
    s_nop 0
    s_max_u32 s54, s54, s28
    s_barrier
    s_and_b32 s26, s44, 63
    s_add_u32 s26, s26, 2
    s_min_u32 s26, s26, 63
    s_lshl_b32 s26, s26, 18
    s_add_u32 s26, s26, s50
    s_add_u32 s26, s26, 6144
    s_add_u32 s3, s26, 16777216
    s_lshl_b32 s4, s44, 18
    s_add_u32 s4, s4, s53
    s_add_u32 s44, s44, 1
    s_and_b32 s55, s44, 3
    s_mul_i32 s55, s55, 167936
    s_add_u32 s55, s55, s34
    s_add_u32 s58, s55, s35
    s_and_b32 s57, s44, 63
    s_add_u32 s42, s44, 2
    s_or_b32 s28, s44, 63
    s_add_u32 s28, s28, 1
    s_min_u32 s42, s42, s28
    s_sub_u32 s61, s26, 6144
    s_cmp_ge_u32 s54, s42
    s_cselect_b32 s61, s61, 0x10000000
    s_nop 15
    s_nop 15
    s_nop 5
    s_mov_b32 m0, 13312
    s_nop 0
    buffer_load_dwordx4 v0, s[8:11], s48 offen offset:3072 sc1 lds
    s_mov_b32 m0, 17408
    s_add_u32 s59, s48, 4096
    buffer_load_dwordx4 v0, s[8:11], s59 offen offset:0 sc1 lds
    s_nop 13
    s_mov_b32 m0, 13312
    s_nop 0
    buffer_load_dwordx4 v0, s[8:11], s48 offen offset:3072 sc1 lds
    s_mov_b32 m0, 17408
    s_add_u32 s59, s48, 4096
    buffer_load_dwordx4 v0, s[8:11], s59 offen offset:0 sc1 lds
    s_nop 13
    s_mov_b32 m0, 13312
    s_nop 0
    buffer_load_dwordx4 v0, s[8:11], s48 offen offset:3072 sc1 lds
    s_mov_b32 m0, 17408
    s_add_u32 s59, s48, 4096
    buffer_load_dwordx4 v0, s[8:11], s59 offen offset:0 sc1 lds
    s_mov_b32 s70, 0
    s_branch M_c1_3_top
M_c1_3_restart:
    s_waitcnt vmcnt(0) lgkmcnt(0)
    s_nop 7
    s_barrier
    s_mov_b32 m0, 13312
    s_nop 0
    buffer_load_dwordx4 v0, s[8:11], s48 offen offset:3072 sc1 lds
    s_mov_b32 m0, 17408
    s_add_u32 s59, s48, 4096
    buffer_load_dwordx4 v0, s[8:11], s59 offen offset:0 sc1 lds
    ds_read_b128 v[56:59], v5 offset:0
    ds_read_b128 v[60:63], v5 offset:1024
    ds_read_b128 v[64:67], v5 offset:2048
    ds_read_b128 v[68:71], v5 offset:3072
    v_mov_b64 v[12:13], 0
    v_mov_b64 v[14:15], 0
    v_mov_b64 v[16:17], 0
    v_mov_b64 v[18:19], 0
    v_mov_b64 v[20:21], 0
    v_mov_b64 v[22:23], 0
    v_mov_b64 v[24:25], 0
    v_mov_b64 v[26:27], 0
    v_mov_b64 v[28:29], 0
    v_mov_b64 v[30:31], 0
    v_mov_b64 v[32:33], 0
    v_mov_b64 v[34:35], 0
    s_waitcnt vmcnt(0) lgkmcnt(0)
    s_branch M_c1_3_top
M_c1_3_zbad:
    s_cmp_eq_u32 s70, 2
    s_cbranch_scc1 M_c1_3_zok
    v_cmp_u_f32 vcc, v72, v72
    s_cbranch_vccz M_c1_3_exact
    s_cmp_eq_u32 s70, 1
    s_cbranch_scc1 M_c1_3_exact
M_c1_3_vfy0:
    s_mov_b32 s70, 1
    s_mov_b32 s30, 0
    s_waitcnt vmcnt(0) lgkmcnt(0)
    s_nop 7
M_c1_3_vfy:
    v_mov_b32 v10, 0
    s_add_u32 s59, s48, 4096
    buffer_load_dwordx4 v[36:39], v0, s[8:11], s48 offen offset:0 sc1
    buffer_load_dwordx4 v[40:43], v0, s[8:11], s48 offen offset:1024 sc1
    buffer_load_dwordx4 v[44:47], v0, s[8:11], s48 offen offset:2048 sc1
    buffer_load_dwordx4 v[48:51], v0, s[8:11], s48 offen offset:3072 sc1
    buffer_load_dwordx4 v[52:55], v0, s[8:11], s59 offen offset:0 sc1
    s_waitcnt vmcnt(4)
    v_max3_u32 v10, v10, v36, v37
    v_max3_u32 v10, v10, v38, v39
    s_waitcnt vmcnt(3)
    v_max3_u32 v10, v10, v40, v41
    v_max3_u32 v10, v10, v42, v43
    s_waitcnt vmcnt(2)
    v_max3_u32 v10, v10, v44, v45
    v_max3_u32 v10, v10, v46, v47
    s_waitcnt vmcnt(1)
    v_max3_u32 v10, v10, v48, v49
    v_max3_u32 v10, v10, v50, v51
    s_waitcnt vmcnt(0)
    v_max3_u32 v10, v10, v52, v53
    v_max3_u32 v10, v10, v54, v55
    s_add_u32 s59, s49, 4096
    buffer_load_dwordx4 v[36:39], v0, s[8:11], s49 offen offset:0 sc1
    buffer_load_dwordx4 v[40:43], v0, s[8:11], s49 offen offset:1024 sc1
    buffer_load_dwordx4 v[44:47], v0, s[8:11], s49 offen offset:2048 sc1
    buffer_load_dwordx4 v[48:51], v0, s[8:11], s49 offen offset:3072 sc1
    buffer_load_dwordx4 v[52:55], v0, s[8:11], s59 offen offset:0 sc1
    s_waitcnt vmcnt(4)
    v_max3_u32 v10, v10, v36, v37
    v_max3_u32 v10, v10, v38, v39
    s_waitcnt vmcnt(3)
    v_max3_u32 v10, v10, v40, v41
    v_max3_u32 v10, v10, v42, v43
    s_waitcnt vmcnt(2)
    v_max3_u32 v10, v10, v44, v45
    v_max3_u32 v10, v10, v46, v47
    s_waitcnt vmcnt(1)
    v_max3_u32 v10, v10, v48, v49
    v_max3_u32 v10, v10, v50, v51
    s_waitcnt vmcnt(0)
    v_max3_u32 v10, v10, v52, v53
    v_max3_u32 v10, v10, v54, v55
    v_cmp_eq_u32 vcc, -1, v10
    s_cbranch_vccz M_c1_3_restart
    s_add_u32 s30, s30, 1
    s_cmp_ge_u32 s30, 60000
    s_cbranch_scc1 M_fail
    s_branch M_c1_3_vfy
M_c1_3_exact:
    s_nop 7
    s_mov_b32 s70, 2
    s_waitcnt lgkmcnt(0)
    ds_read_b128 v[20:23], v3 offset:18432
    ds_read_b128 v[24:27], v3 offset:18496
    ds_read_b128 v[72:75], v3 offset:18560
    ds_read_b128 v[44:47], v3 offset:18624
    ds_read_b128 v[56:59], v0 offset:0
    s_waitcnt lgkmcnt(0)
    v_mfma_f32_16x16x32_bf16 v[28:31], v[56:59], v[20:23], 0
    s_nop 3
    ds_read_b128 v[60:63], v0 offset:1024
    s_waitcnt lgkmcnt(0)
    v_mfma_f32_16x16x32_bf16 v[28:31], v[60:63], v[24:27], v[28:31]
    s_nop 3
    ds_read_b128 v[56:59], v0 offset:2048
    s_waitcnt lgkmcnt(0)
    v_mfma_f32_16x16x32_bf16 v[28:31], v[56:59], v[72:75], v[28:31]
    s_nop 3
    ds_read_b128 v[60:63], v0 offset:3072
    s_waitcnt lgkmcnt(0)
    v_mfma_f32_16x16x32_bf16 v[28:31], v[60:63], v[44:47], v[28:31]
    s_nop 3
    ds_read_b128 v[56:59], v0 offset:4096
    s_waitcnt lgkmcnt(0)
    v_mfma_f32_16x16x32_bf16 v[32:35], v[56:59], v[20:23], 0
    s_nop 3
    ds_read_b128 v[60:63], v0 offset:5120
    s_waitcnt lgkmcnt(0)
    v_mfma_f32_16x16x32_bf16 v[32:35], v[60:63], v[24:27], v[32:35]
    s_nop 3
    ds_read_b128 v[56:59], v0 offset:6144
    s_waitcnt lgkmcnt(0)
    v_mfma_f32_16x16x32_bf16 v[32:35], v[56:59], v[72:75], v[32:35]
    s_nop 3
    ds_read_b128 v[60:63], v0 offset:7168
    s_waitcnt lgkmcnt(0)
    v_mfma_f32_16x16x32_bf16 v[32:35], v[60:63], v[44:47], v[32:35]
    s_nop 3
    ds_read_b128 v[56:59], v3 offset:20736
    s_waitcnt lgkmcnt(0)
    v_mfma_f32_16x16x32_bf16 v[40:43], v[56:59], v[20:23], 0
    s_nop 3
    ds_read_b128 v[60:63], v3 offset:20800
    s_waitcnt lgkmcnt(0)
    v_mfma_f32_16x16x32_bf16 v[40:43], v[60:63], v[24:27], v[40:43]
    s_nop 3
    ds_read_b128 v[56:59], v3 offset:20864
    s_waitcnt lgkmcnt(0)
    v_mfma_f32_16x16x32_bf16 v[40:43], v[56:59], v[72:75], v[40:43]
    s_nop 3
    ds_read_b128 v[60:63], v3 offset:20928
    s_waitcnt lgkmcnt(0)
    v_mfma_f32_16x16x32_bf16 v[40:43], v[60:63], v[44:47], v[40:43]
    s_nop 3
    v_max3_f32 v68, v28, v29, v30
    v_max3_f32 v68, v68, v31, v32
    v_max3_f32 v68, v68, v33, v34
    s_nop 0
    v_max3_f32 v68, v68, v35, v40
    v_max3_f32 v68, v68, v41, v42
    v_max_f32 v68, v68, v43
    v_mov_b32 v69, v68
    s_nop 1
    v_permlane16_swap_b32 v68, v69
    v_max_f32 v68, v68, v69
    v_mov_b32 v69, v68
    s_nop 1
    v_permlane32_swap_b32 v68, v69
    v_max_f32 v68, v68, v69
    v_sub_f32 v28, v28, v68
    v_exp_f32 v28, v28
    v_sub_f32 v29, v29, v68
    v_exp_f32 v29, v29
    v_sub_f32 v30, v30, v68
    v_exp_f32 v30, v30
    v_sub_f32 v31, v31, v68
    v_exp_f32 v31, v31
    v_sub_f32 v32, v32, v68
    v_exp_f32 v32, v32
    v_sub_f32 v33, v33, v68
    v_exp_f32 v33, v33
    v_sub_f32 v34, v34, v68
    v_exp_f32 v34, v34
    v_sub_f32 v35, v35, v68
    v_exp_f32 v35, v35
    v_sub_f32 v40, v40, v68
    v_exp_f32 v40, v40
    v_sub_f32 v41, v41, v68
    v_exp_f32 v41, v41
    v_sub_f32 v42, v42, v68
    v_exp_f32 v42, v42
    v_sub_f32 v43, v43, v68
    v_exp_f32 v43, v43
    v_cvt_pk_bf16_f32 v28, v28, v29
    v_cvt_pk_bf16_f32 v29, v30, v31
    v_cvt_pk_bf16_f32 v30, v32, v33
    v_cvt_pk_bf16_f32 v31, v34, v35
    v_cvt_pk_bf16_f32 v40, v40, v41
    v_cvt_pk_bf16_f32 v41, v42, v43
    v_mfma_f32_16x16x32_bf16 v[20:23], v[80:83], v[28:31], 0
    v_mfma_f32_16x16x32_bf16 v[24:27], v[84:87], v[28:31], 0
    v_mfma_f32_16x16x32_bf16 v[72:75], v[64:67], v[28:31], 0
    ds_read_b128 v[60:63], v3 offset:20928
    s_waitcnt lgkmcnt(0)
    s_nop 7
    v_mfma_f32_16x16x16_bf16 v[72:75], v[10:11], v[40:41], v[72:75]
    s_nop 7
    s_branch M_c1_3_fin
M_c1_3_last:
    s_cmp_lg_u32 s70, 0
    s_cbranch_scc1 M_c1_3_last2
    v_cmp_u_f32 vcc, v32, v32
    s_cbranch_vccnz M_c1_3_vfy0
M_c1_3_last2:
    s_lshl_b32 s4, s44, 18
    s_add_u32 s4, s4, s53
    buffer_store_dwordx4 v[76:79], v0, s[8:11], s4 offen offset:3072 sc1
    s_mov_b32 s4, 0x10000000
    s_waitcnt vmcnt(0) lgkmcnt(0)
    s_barrier
    s_nop 7
    v_mov_b64 v[72:73], -1
    v_mov_b64 v[74:75], -1
    s_add_u32 s28, s44, 3
    s_and_b32 s29, s28, 3
    s_mul_i32 s31, s22, 160
    s_waitcnt vmcnt(0)
    s_add_u32 s44, s44, 1
    s_cmp_eq_u32 s44, 128
    s_cbranch_scc1 M_end
    s_branch M_c1_3_layer
M_c1_3_lr:
    s_mov_b32 s30, 0
M_c1_3_lr_l:
    s_waitcnt lgkmcnt(0)
    s_and_b32 s27, s30, 1
    s_cbranch_scc0 M_c1_3_lr_n
    s_waitcnt vmcnt(2)
    s_mov_b32 m0, 13312
    s_nop 0
    buffer_load_dwordx4 v0, s[8:11], s48 offen offset:3072 sc1 lds
    s_mov_b32 m0, 17408
    s_add_u32 s59, s48, 4096
    buffer_load_dwordx4 v0, s[8:11], s59 offen offset:0 sc1 lds
M_c1_3_lr_n:
    ds_read_b128 v[36:39], v6 offset:13312
    ds_read_b128 v[40:43], v6 offset:14336
    ds_read_b128 v[44:47], v6 offset:15360
    ds_read_b128 v[48:51], v6 offset:16384
    ds_read_b128 v[52:55], v6 offset:17408
    s_waitcnt lgkmcnt(2)
    v_max3_u32 v10, v36, v40, v44
    s_waitcnt lgkmcnt(0)
    v_max3_u32 v10, v10, v48, v52
    v_cmp_eq_u32 vcc, -1, v10
    s_cbranch_vccz M_c1_3_lr_d
    s_add_u32 s30, s30, 1
    s_cmp_ge_u32 s30, 480000
    s_cbranch_scc1 M_fail
    s_branch M_c1_3_lr_l
M_c1_3_lr_d:
    ds_read_b128 v[56:59], v5 offset:0
    ds_read_b128 v[60:63], v5 offset:1024
    ds_read_b128 v[64:67], v5 offset:2048
    ds_read_b128 v[68:71], v5 offset:3072
    v_mov_b64 v[12:13], 0
    v_mov_b64 v[14:15], 0
    v_mov_b64 v[16:17], 0
    v_mov_b64 v[18:19], 0
    v_mov_b64 v[20:21], 0
    v_mov_b64 v[22:23], 0
    v_mov_b64 v[24:25], 0
    v_mov_b64 v[26:27], 0
    v_mov_b64 v[28:29], 0
    v_mov_b64 v[30:31], 0
    v_mov_b64 v[32:33], 0
    v_mov_b64 v[34:35], 0
    s_waitcnt lgkmcnt(0)
    s_branch M_c1_3_lr_r
M_c1_3_rr:
    s_mov_b32 s30, 0
M_c1_3_rr_l:
    s_waitcnt lgkmcnt(0)
    s_and_b32 s27, s30, 1
    s_cbranch_scc1 M_c1_3_rr_n
    s_waitcnt vmcnt(1)
    s_mov_b32 m0, 12288
    s_add_u32 s59, s49, 4096
    buffer_load_dwordx4 v0, s[8:11], s59 offen offset:0 sc1 lds
M_c1_3_rr_n:
    ds_read_b128 v[36:39], v6 offset:8192
    ds_read_b128 v[40:43], v6 offset:9216
    ds_read_b128 v[44:47], v6 offset:10240
    ds_read_b128 v[48:51], v6 offset:11264
    ds_read_b32 v11, v6 offset:12288
    s_waitcnt lgkmcnt(2)
    v_max3_u32 v10, v36, v40, v44
    s_waitcnt lgkmcnt(0)
    v_max3_u32 v10, v10, v48, v11
    v_cmp_eq_u32 vcc, -1, v10
    s_cbranch_vccz M_c1_3_rr_d
    s_add_u32 s30, s30, 1
    s_cmp_ge_u32 s30, 480000
    s_cbranch_scc1 M_fail
    s_branch M_c1_3_rr_l
M_c1_3_rr_d:
    s_branch M_c1_3_rr_r
M_c1_3_first:
    s_mul_i32 s27, s21, 167936
    s_add_u32 s27, s27, s34
    s_mul_i32 s28, s22, 4224
    s_add_u32 s28, s28, s27
    s_mov_b32 exec_hi, 0
    buffer_load_dword v10, v9, s[8:11], s28 offen sc1
    s_lshl_b32 s28, s22, 10
    s_add_u32 s28, s28, s27
    s_add_u32 s28, s28, 135168
    s_mov_b64 exec, 0xff
    buffer_load_dword v10, v9, s[8:11], s28 offen sc1
    s_mul_i32 s27, s21, 5120
    s_add_u32 s27, s27, s41
    s_mul_i32 s28, s22, 160
    s_add_u32 s28, s28, s27
    s_mov_b64 exec, 3
    buffer_load_dword v10, v9, s[8:11], s28 offen sc1
    s_mov_b64 exec, -1
    s_add_u32 s27, s44, 1
    s_or_b32 s28, s44, 63
    s_add_u32 s28, s28, 1
    s_min_u32 s27, s27, s28
    s_cmp_lt_u32 s54, s27
    s_cbranch_scc1 M_c1_3_p1
M_c1_3_p1_r:
    s_barrier
    s_and_b32 s26, s44, 63
    s_lshl_b32 s26, s26, 18
    s_add_u32 s26, s26, s50
    s_add_u32 s26, s26, 6144
    s_add_u32 s3, s26, 16777216
    s_mov_b32 m0, 6144
    s_nop 0
    buffer_load_dwordx4 v0, s[8:11], s26 offen offset:0 sc1 lds
    buffer_load_dwordx4 v0, s[8:11], s26 offen offset:1024 sc1 lds
    buffer_load_dwordx4 v[80:83], v0, s[8:11], s3 offen offset:0 sc1
    buffer_load_dwordx4 v[84:87], v0, s[8:11], s3 offen offset:1024 sc1
    s_and_b32 s26, s44, 63
    s_add_u32 s26, s26, 1
    s_min_u32 s26, s26, 63
    s_lshl_b32 s26, s26, 18
    s_add_u32 s26, s26, s50
    s_add_u32 s26, s26, 6144
    s_add_u32 s3, s26, 16777216
    s_waitcnt vmcnt(0) lgkmcnt(0)
    s_barrier
    s_branch M_c1_3_first_r
M_c1_3_first2:
    ds_read_b64 v[10:11], v0 offset:23296
    s_waitcnt lgkmcnt(0)
    v_min_u32 v10, v10, v11
    s_nop 0
    v_readfirstlane_b32 s28, v10
    s_nop 0
    s_max_u32 s54, s54, s28
    s_add_u32 s27, s44, 2
    s_or_b32 s28, s44, 63
    s_add_u32 s28, s28, 1
    s_min_u32 s27, s27, s28
    s_cmp_lt_u32 s54, s27
    s_cbranch_scc1 M_c1_3_p2
M_c1_3_p2_r:
    s_branch M_c1_3_first2_r
M_c1_3_p1:
    s_mov_b32 s30, 0
M_c1_3_p1_l:
    s_waitcnt lgkmcnt(0)
    s_mov_b64 exec, 3
    buffer_load_dword v10, v9, s[8:11], s51 offen sc1
    s_waitcnt vmcnt(0)
    s_mov_b64 exec, -1
    v_readlane_b32 s54, v10, 0
    v_readlane_b32 s28, v10, 1
    s_nop 3
    s_min_u32 s54, s54, s28
    s_cmp_ge_u32 s54, s27
    s_cbranch_scc1 M_c1_3_p1_r
    s_sleep 2
    s_add_u32 s30, s30, 1
    s_cmp_ge_u32 s30, 240000
    s_cbranch_scc1 M_fail
    s_branch M_c1_3_p1_l
M_c1_3_p2:
    s_mov_b32 s30, 0
M_c1_3_p2_l:
    s_waitcnt lgkmcnt(0)
    s_mov_b64 exec, 3
    buffer_load_dword v10, v9, s[8:11], s51 offen sc1
    s_waitcnt vmcnt(0)
    s_mov_b64 exec, -1
    v_readlane_b32 s54, v10, 0
    v_readlane_b32 s28, v10, 1
    s_nop 3
    s_min_u32 s54, s54, s28
    s_cmp_ge_u32 s54, s27
    s_cbranch_scc1 M_c1_3_p2_r
    s_sleep 2
    s_add_u32 s30, s30, 1
    s_cmp_ge_u32 s30, 240000
    s_cbranch_scc1 M_fail
    s_branch M_c1_3_p2_l
M_bulk:
    s_waitcnt vmcnt(0)
    s_barrier
    s_mul_i32 s42, s21, 10240
    s_mul_i32 s47, s101, 3145728
    s_add_u32 s47, s47, s42
    s_add_u32 s47, s47, 29360128
    s_mul_i32 s50, s101, 33554432
    s_lshl_b32 s27, s22, 13
    s_add_u32 s50, s50, s27
    s_add_u32 s50, s50, 37748736
    s_lshl_b32 s43, s101, 6
    s_sub_u32 s82, s20, 2
    s_mov_b32 s83, s21
    s_mov_b32 s84, s22
    s_mov_b32 s85, s23
    s_lshl_b32 s87, s82, 5
    s_add_u32 s87, s87, s22
    s_mul_i32 s86, s101, 8192
    s_mul_i32 s80, s101, 8388608
    s_add_u32 s80, s80, 134217728
    s_load_dwordx2 s[98:99], s[0:1], 80
    s_cmp_eq_u32 s87, 160
    s_cselect_b32 s81, 191, s87
    s_cmp_eq_u32 s87, 191
    s_cselect_b32 s81, 160, s81
    s_waitcnt lgkmcnt(0)
    s_mul_i32 s27, s22, 26
    s_lshr_b32 s27, s27, 8
    s_mul_i32 s28, s27, 10
    s_sub_u32 s88, s22, s28
    s_mul_i32 s28, s20, 3
    s_sub_u32 s28, s28, 8
    s_cmp_lt_u32 s20, 3
    s_cselect_b32 s28, 0, s28
    s_cselect_b32 s29, 1, 3
    s_add_u32 s28, s28, s27
    s_lshl_b32 s89, s28, 2
    s_add_u32 s89, s89, s21
    s_cmp_lt_u32 s27, s29
    s_cselect_b32 s89, s89, 64
    s_cmp_ge_u32 s20, 3
    s_cbranch_scc1 M_qao
    s_lshl_b32 s28, s21, 11
    s_add_u32 s52, s50, s28
    s_add_u32 s52, s52, 16777216
    s_lshl_b32 s28, s21, 10
    s_add_u32 s50, s50, s28
    s_lshl_b32 s51, s22, 8
    s_add_u32 s51, s51, 167854080
    v_lshlrev_b32 v3, 3, v0
    s_mov_b32 s44, 0
    s_mov_b32 s45, 0
    s_mul_i32 s53, s101, 76546048
    s_cmp_lg_u32 s101, 0
    s_cbranch_scc1 M_kv_l1
    s_cmp_lg_u32 s21, 0
    s_cbranch_scc1 M_kx_1
    v_lshlrev_b32 v190, 3, v0
    s_mov_b64 exec, 15
    s_mov_b32 s30, 0
    s_lshl_b32 s27, s101, 13
    s_add_u32 s27, s27, 167911424
M_kx_2:
    buffer_load_dwordx4 v[176:179], v190, s[8:11], s27 offen sc1
    buffer_load_dwordx4 v[180:183], v190, s[8:11], s27 offen offset:16 sc1
    buffer_load_dwordx2 v[184:185], v190, s[8:11], s27 offen offset:32 sc1
    s_add_u32 s30, s30, 1
    s_cmp_ge_u32 s30, 60000
    s_cbranch_scc1 M_fail
    s_waitcnt vmcnt(0)
    v_min3_u32 v176, v176, v177, v178
    v_min3_u32 v176, v176, v179, v180
    v_min3_u32 v176, v176, v181, v182
    v_min3_u32 v176, v176, v183, v184
    v_min_u32 v176, v176, v185
    v_cmp_eq_u32 vcc, 0, v176
    s_cbranch_vccz M_kx_2d
    s_sleep 4
    s_branch M_kx_2
M_kx_2d:
    s_mov_b64 exec, -1
M_kx_1:
    s_barrier
M_kx_3:
    s_branch M_kv_l2
M_kv_l1:
    s_mov_b32 s54, 167956480
    s_cmp_lg_u32 s21, 0
    s_cbranch_scc1 M_kl_4
    s_mov_b64 exec, 0x3ff
    s_mov_b32 s30, 0
    v_lshrrev_b32 v190, 2, v0
M_kl_5:
    buffer_load_dword v191, v190, s[8:11], s54 offen sc1
    s_add_u32 s30, s30, 1
    s_cmp_ge_u32 s30, 60000
    s_cbranch_scc1 M_fail
    s_waitcnt vmcnt(0)
    v_cmp_ne_u32 vcc, 0x01010101, v191
    s_cbranch_vccz M_kl_5d
    s_sleep 1
    s_branch M_kl_5
M_kl_5d:
    s_mov_b64 exec, -1
M_kl_4:
    s_barrier
M_kv_l2:
    s_min_u32 s27, s44, 63
    s_mul_i32 s27, s27, 40960
    s_add_u32 s27, s27, s47
    s_cmp_lt_u32 s44, 4
    s_cselect_b32 s28, s53, 0
    s_add_u32 s27, s27, s28
    s_add_u32 s28, s45, s42
    s_mov_b32 m0, s28
    s_nop 0
    buffer_load_dwordx4 v0, s[8:11], s27 offen offset:0 sc1 lds
    buffer_load_dwordx4 v0, s[8:11], s27 offen offset:1024 sc1 lds
    buffer_load_dwordx4 v0, s[8:11], s27 offen offset:2048 sc1 lds
    buffer_load_dwordx4 v0, s[8:11], s27 offen offset:3072 sc1 lds
    s_add_u32 s27, s27, 4096
    s_add_u32 s28, s28, 4096
    s_mov_b32 m0, s28
    s_nop 0
    buffer_load_dwordx4 v0, s[8:11], s27 offen offset:0 sc1 lds
    buffer_load_dwordx4 v0, s[8:11], s27 offen offset:1024 sc1 lds
    buffer_load_dwordx4 v0, s[8:11], s27 offen offset:2048 sc1 lds
    buffer_load_dwordx4 v0, s[8:11], s27 offen offset:3072 sc1 lds
    s_add_u32 s27, s27, 4096
    s_add_u32 s28, s28, 4096
    s_mov_b32 m0, s28
    s_nop 0
    buffer_load_dwordx4 v0, s[8:11], s27 offen offset:0 sc1 lds
    buffer_load_dwordx4 v0, s[8:11], s27 offen offset:1024 sc1 lds
    s_lshl_b32 s55, s89, 7
    s_lshl_b32 s27, s88, 2
    s_add_u32 s55, s55, s27
    s_add_u32 s55, s55, 167919616
    s_cmp_lt_u32 s89, 64
    s_cselect_b32 s27, s101, 0
    s_cmp_lg_u32 s27, 0
    s_cselect_b32 s55, s55, 0x10000000
    s_cbranch_scc1 M_kv_d1
    s_waitcnt vmcnt(0)
    s_barrier
    s_branch M_kv_d2
M_kv_d1:
    s_waitcnt vmcnt(0)
    s_barrier
    v_bfe_u32 v5, v0, 4, 4
    v_mul_u32_u24 v5, 1280, v5
    v_lshrrev_b32 v6, 8, v0
    v_lshl_add_u32 v5, v6, 4, v5
    buffer_store_dwordx4 v[12:15], v0, s[8:11], s68 offen offset:0 sc1
    buffer_store_dwordx4 v[104:107], v5, s[16:19], s70 offen offset:0 sc1
    buffer_store_dwordx4 v[16:19], v0, s[8:11], s68 offen offset:1024 sc1
    buffer_store_dwordx4 v[108:111], v5, s[16:19], s70 offen offset:64 sc1
    buffer_store_dwordx4 v[28:31], v0, s[8:11], s69 offen offset:0 sc1
    buffer_store_dwordx4 v[112:115], v5, s[16:19], s71 offen offset:0 sc1
    buffer_store_dwordx4 v[32:35], v0, s[8:11], s69 offen offset:1024 sc1
    buffer_store_dwordx4 v[116:119], v5, s[16:19], s71 offen offset:64 sc1
M_kv_d2:
    v_mov_b32 v6, 1
    v_mov_b32 v1, v0
    ds_read_b128 v[56:59], v1 offset:0
    ds_read_b128 v[60:63], v1 offset:1024
    ds_read_b128 v[64:67], v1 offset:2048
    ds_read_b128 v[68:71], v1 offset:3072
M_kv_top:
    s_add_u32 s27, s44, s43
    v_mov_b32 v2, s27
    s_sub_u32 s45, 40960, s45
    s_add_u32 s44, s44, 1
    v_add_u32 v4, s45, v0
    ds_read_b128 v[72:75], v1 offset:4096
    s_waitcnt lgkmcnt(4)
    v_mfma_f32_16x16x32_bf16 v[8:11], a[0:3], v[56:59], 0
    v_mfma_f32_16x16x32_bf16 v[24:27], v[56:59], a[160:163], 0
    v_mfma_f32_16x16x32_bf16 v[12:15], a[80:83], v[56:59], 0
    v_mfma_f32_16x16x32_bf16 v[28:31], v[56:59], a[240:243], 0
    ds_read_b128 v[56:59], v1 offset:5120
    s_waitcnt lgkmcnt(4)
    v_mfma_f32_16x16x32_bf16 v[8:11], a[4:7], v[60:63], v[8:11]
    v_mfma_f32_16x16x32_bf16 v[24:27], v[60:63], a[164:167], v[24:27]
    v_mfma_f32_16x16x32_bf16 v[12:15], a[84:87], v[60:63], v[12:15]
    v_mfma_f32_16x16x32_bf16 v[28:31], v[60:63], a[244:247], v[28:31]
    s_min_u32 s27, s44, 63
    s_mul_i32 s27, s27, 40960
    s_add_u32 s27, s27, s47
    s_cmp_lt_u32 s44, 4
    s_cselect_b32 s28, s53, 0
    s_add_u32 s27, s27, s28
    s_add_u32 s28, s45, s42
    s_mov_b32 m0, s28
    s_nop 0
    buffer_load_dwordx4 v0, s[8:11], s27 offen offset:0 sc1 lds
    buffer_load_dwordx4 v0, s[8:11], s27 offen offset:1024 sc1 lds
    ds_read_b128 v[60:63], v1 offset:6144
    s_waitcnt lgkmcnt(4)
    v_mfma_f32_16x16x32_bf16 v[8:11], a[8:11], v[64:67], v[8:11]
    v_mfma_f32_16x16x32_bf16 v[24:27], v[64:67], a[168:171], v[24:27]
    v_mfma_f32_16x16x32_bf16 v[12:15], a[88:91], v[64:67], v[12:15]
    v_mfma_f32_16x16x32_bf16 v[28:31], v[64:67], a[248:251], v[28:31]
    ds_read_b128 v[64:67], v1 offset:7168
    s_waitcnt lgkmcnt(4)
    v_mfma_f32_16x16x32_bf16 v[8:11], a[12:15], v[68:71], v[8:11]
    v_mfma_f32_16x16x32_bf16 v[24:27], v[68:71], a[172:175], v[24:27]
    v_mfma_f32_16x16x32_bf16 v[12:15], a[92:95], v[68:71], v[12:15]
    v_mfma_f32_16x16x32_bf16 v[28:31], v[68:71], a[252:255], v[28:31]
    ds_read_b128 v[68:71], v1 offset:8192
    s_waitcnt lgkmcnt(4)
    v_mfma_f32_16x16x32_bf16 v[8:11], a[16:19], v[72:75], v[8:11]
    v_mfma_f32_16x16x32_bf16 v[24:27], v[72:75], a[176:179], v[24:27]
    v_mfma_f32_16x16x32_bf16 v[12:15], a[96:99], v[72:75], v[12:15]
    v_mfma_f32_16x16x32_bf16 v[28:31], v[72:75], v[192:195], v[28:31]
    ds_read_b128 v[72:75], v1 offset:9216
    s_waitcnt lgkmcnt(4)
    v_mfma_f32_16x16x32_bf16 v[8:11], a[20:23], v[56:59], v[8:11]
    v_mfma_f32_16x16x32_bf16 v[24:27], v[56:59], a[180:183], v[24:27]
    v_mfma_f32_16x16x32_bf16 v[12:15], a[100:103], v[56:59], v[12:15]
    v_mfma_f32_16x16x32_bf16 v[28:31], v[56:59], v[196:199], v[28:31]
    buffer_load_dwordx4 v0, s[8:11], s27 offen offset:2048 sc1 lds
    buffer_load_dwordx4 v0, s[8:11], s27 offen offset:3072 sc1 lds
    ds_read_b128 v[56:59], v1 offset:10240
    s_waitcnt lgkmcnt(4)
    v_mfma_f32_16x16x32_bf16 v[8:11], a[24:27], v[60:63], v[8:11]
    v_mfma_f32_16x16x32_bf16 v[24:27], v[60:63], a[184:187], v[24:27]
    v_mfma_f32_16x16x32_bf16 v[12:15], a[104:107], v[60:63], v[12:15]
    v_mfma_f32_16x16x32_bf16 v[28:31], v[60:63], v[200:203], v[28:31]
    ds_read_b128 v[60:63], v1 offset:11264
    s_waitcnt lgkmcnt(4)
    v_mfma_f32_16x16x32_bf16 v[8:11], a[28:31], v[64:67], v[8:11]
    v_mfma_f32_16x16x32_bf16 v[24:27], v[64:67], a[188:191], v[24:27]
    v_mfma_f32_16x16x32_bf16 v[12:15], a[108:111], v[64:67], v[12:15]
    v_mfma_f32_16x16x32_bf16 v[28:31], v[64:67], v[204:207], v[28:31]
    ds_read_b128 v[64:67], v1 offset:12288
    s_waitcnt lgkmcnt(4)
    v_mfma_f32_16x16x32_bf16 v[8:11], a[32:35], v[68:71], v[8:11]
    v_mfma_f32_16x16x32_bf16 v[24:27], v[68:71], a[192:195], v[24:27]
    v_mfma_f32_16x16x32_bf16 v[12:15], a[112:115], v[68:71], v[12:15]
    v_mfma_f32_16x16x32_bf16 v[28:31], v[68:71], v[208:211], v[28:31]
    ds_read_b128 v[68:71], v1 offset:13312
    s_waitcnt lgkmcnt(4)
    v_mfma_f32_16x16x32_bf16 v[8:11], a[36:39], v[72:75], v[8:11]
    v_mfma_f32_16x16x32_bf16 v[24:27], v[72:75], a[196:199], v[24:27]
    v_mfma_f32_16x16x32_bf16 v[12:15], a[116:119], v[72:75], v[12:15]
    v_mfma_f32_16x16x32_bf16 v[28:31], v[72:75], v[212:215], v[28:31]
    s_waitcnt vmcnt(4)
    s_barrier
    s_cmp_lg_u32 s21, 0
    s_cbranch_scc1 M_kv_f0
    s_mov_b64 exec, 3
    buffer_store_dword v2, v3, s[8:11], s51 offen sc1
    s_mov_b64 exec, -1
M_kv_f0:
    s_mov_b64 exec, 1
    buffer_store_dword v6, v0, s[8:11], s55 offen sc1
    s_mov_b64 exec, -1
    s_mov_b32 s55, 0x10000000
    s_add_u32 s27, s27, 4096
    s_add_u32 s28, s28, 4096
    s_mov_b32 m0, s28
    s_nop 0
    buffer_load_dwordx4 v0, s[8:11], s27 offen offset:0 sc1 lds
    buffer_load_dwordx4 v0, s[8:11], s27 offen offset:1024 sc1 lds
    ds_read_b128 v[72:75], v1 offset:14336
    s_waitcnt lgkmcnt(4)
    v_mfma_f32_16x16x32_bf16 v[8:11], a[40:43], v[56:59], v[8:11]
    v_mfma_f32_16x16x32_bf16 v[24:27], v[56:59], a[200:203], v[24:27]
    v_mfma_f32_16x16x32_bf16 v[12:15], a[120:123], v[56:59], v[12:15]
    v_mfma_f32_16x16x32_bf16 v[28:31], v[56:59], v[216:219], v[28:31]
    ds_read_b128 v[56:59], v1 offset:15360
    s_waitcnt lgkmcnt(4)
    v_mfma_f32_16x16x32_bf16 v[8:11], a[44:47], v[60:63], v[8:11]
    v_mfma_f32_16x16x32_bf16 v[24:27], v[60:63], a[204:207], v[24:27]
    v_mfma_f32_16x16x32_bf16 v[12:15], a[124:127], v[60:63], v[12:15]
    v_mfma_f32_16x16x32_bf16 v[28:31], v[60:63], v[220:223], v[28:31]
    ds_read_b128 v[60:63], v1 offset:16384
    s_waitcnt lgkmcnt(4)
    v_mfma_f32_16x16x32_bf16 v[8:11], a[48:51], v[64:67], v[8:11]
    v_mfma_f32_16x16x32_bf16 v[24:27], v[64:67], a[208:211], v[24:27]
    v_mfma_f32_16x16x32_bf16 v[12:15], a[128:131], v[64:67], v[12:15]
    v_mfma_f32_16x16x32_bf16 v[28:31], v[64:67], v[224:227], v[28:31]
    ds_read_b128 v[64:67], v1 offset:17408
    s_waitcnt lgkmcnt(4)
    v_mfma_f32_16x16x32_bf16 v[8:11], a[52:55], v[68:71], v[8:11]
    v_mfma_f32_16x16x32_bf16 v[24:27], v[68:71], a[212:215], v[24:27]
    v_mfma_f32_16x16x32_bf16 v[12:15], a[132:135], v[68:71], v[12:15]
    v_mfma_f32_16x16x32_bf16 v[28:31], v[68:71], v[228:231], v[28:31]
    buffer_load_dwordx4 v0, s[8:11], s27 offen offset:2048 sc1 lds
    buffer_load_dwordx4 v0, s[8:11], s27 offen offset:3072 sc1 lds
    ds_read_b128 v[68:71], v1 offset:18432
    s_waitcnt lgkmcnt(4)
    v_mfma_f32_16x16x32_bf16 v[8:11], a[56:59], v[72:75], v[8:11]
    v_mfma_f32_16x16x32_bf16 v[24:27], v[72:75], a[216:219], v[24:27]
    v_mfma_f32_16x16x32_bf16 v[12:15], a[136:139], v[72:75], v[12:15]
    v_mfma_f32_16x16x32_bf16 v[28:31], v[72:75], v[232:235], v[28:31]
    ds_read_b128 v[72:75], v1 offset:19456
    s_waitcnt lgkmcnt(4)
    v_mfma_f32_16x16x32_bf16 v[8:11], a[60:63], v[56:59], v[8:11]
    v_mfma_f32_16x16x32_bf16 v[24:27], v[56:59], a[220:223], v[24:27]
    v_mfma_f32_16x16x32_bf16 v[12:15], a[140:143], v[56:59], v[12:15]
    v_mfma_f32_16x16x32_bf16 v[28:31], v[56:59], v[236:239], v[28:31]
    ds_read_b128 v[56:59], v1 offset:20480
    s_waitcnt lgkmcnt(4)
    v_mfma_f32_16x16x32_bf16 v[8:11], a[64:67], v[60:63], v[8:11]
    v_mfma_f32_16x16x32_bf16 v[24:27], v[60:63], a[224:227], v[24:27]
    v_mfma_f32_16x16x32_bf16 v[12:15], a[144:147], v[60:63], v[12:15]
    v_mfma_f32_16x16x32_bf16 v[28:31], v[60:63], v[240:243], v[28:31]
    ds_read_b128 v[60:63], v1 offset:21504
    s_waitcnt lgkmcnt(4)
    v_mfma_f32_16x16x32_bf16 v[8:11], a[68:71], v[64:67], v[8:11]
    v_mfma_f32_16x16x32_bf16 v[24:27], v[64:67], a[228:231], v[24:27]
    v_mfma_f32_16x16x32_bf16 v[12:15], a[148:151], v[64:67], v[12:15]
    v_mfma_f32_16x16x32_bf16 v[28:31], v[64:67], v[244:247], v[28:31]
    s_add_u32 s27, s27, 4096
    s_add_u32 s28, s28, 4096
    s_mov_b32 m0, s28
    s_nop 0
    buffer_load_dwordx4 v0, s[8:11], s27 offen offset:0 sc1 lds
    buffer_load_dwordx4 v0, s[8:11], s27 offen offset:1024 sc1 lds
    ds_read_b128 v[64:67], v1 offset:22528
    s_waitcnt lgkmcnt(4)
    v_mfma_f32_16x16x32_bf16 v[8:11], a[72:75], v[68:71], v[8:11]
    v_mfma_f32_16x16x32_bf16 v[24:27], v[68:71], a[232:235], v[24:27]
    v_mfma_f32_16x16x32_bf16 v[12:15], a[152:155], v[68:71], v[12:15]
    v_mfma_f32_16x16x32_bf16 v[28:31], v[68:71], v[248:251], v[28:31]
    ds_read_b128 v[68:71], v1 offset:23552
    s_waitcnt lgkmcnt(4)
    v_mfma_f32_16x16x32_bf16 v[8:11], a[76:79], v[72:75], v[8:11]
    v_mfma_f32_16x16x32_bf16 v[24:27], v[72:75], a[236:239], v[24:27]
    v_mfma_f32_16x16x32_bf16 v[12:15], a[156:159], v[72:75], v[12:15]
    v_mfma_f32_16x16x32_bf16 v[28:31], v[72:75], v[252:255], v[28:31]
    ds_read_b128 v[72:75], v1 offset:24576
    s_waitcnt lgkmcnt(4)
    v_mfma_f32_16x16x32_bf16 v[16:19], a[0:3], v[56:59], 0
    v_mfma_f32_16x16x32_bf16 v[32:35], v[56:59], a[160:163], 0
    v_mfma_f32_16x16x32_bf16 v[20:23], a[80:83], v[56:59], 0
    v_mfma_f32_16x16x32_bf16 v[36:39], v[56:59], a[240:243], 0
    ds_read_b128 v[56:59], v1 offset:25600
    s_waitcnt lgkmcnt(4)
    v_mfma_f32_16x16x32_bf16 v[16:19], a[4:7], v[60:63], v[16:19]
    v_mfma_f32_16x16x32_bf16 v[32:35], v[60:63], a[164:167], v[32:35]
    v_mfma_f32_16x16x32_bf16 v[20:23], a[84:87], v[60:63], v[20:23]
    v_mfma_f32_16x16x32_bf16 v[36:39], v[60:63], a[244:247], v[36:39]
    ds_read_b128 v[60:63], v1 offset:26624
    s_waitcnt lgkmcnt(4)
    v_mfma_f32_16x16x32_bf16 v[16:19], a[8:11], v[64:67], v[16:19]
    v_cvt_pk_bf16_f32 v40, v8, v12
    v_mfma_f32_16x16x32_bf16 v[32:35], v[64:67], a[168:171], v[32:35]
    v_mfma_f32_16x16x32_bf16 v[20:23], a[88:91], v[64:67], v[20:23]
    v_cvt_pk_bf16_f32 v41, v9, v13
    v_mfma_f32_16x16x32_bf16 v[36:39], v[64:67], a[248:251], v[36:39]
    ds_read_b128 v[64:67], v1 offset:27648
    s_waitcnt lgkmcnt(4)
    v_mfma_f32_16x16x32_bf16 v[16:19], a[12:15], v[68:71], v[16:19]
    v_cvt_pk_bf16_f32 v42, v10, v14
    v_mfma_f32_16x16x32_bf16 v[32:35], v[68:71], a[172:175], v[32:35]
    v_mfma_f32_16x16x32_bf16 v[20:23], a[92:95], v[68:71], v[20:23]
    v_cvt_pk_bf16_f32 v43, v11, v15
    v_mfma_f32_16x16x32_bf16 v[36:39], v[68:71], a[252:255], v[36:39]
    ds_read_b128 v[68:71], v1 offset:28672
    s_waitcnt lgkmcnt(4)
    v_mfma_f32_16x16x32_bf16 v[16:19], a[16:19], v[72:75], v[16:19]
    v_cvt_pk_bf16_f32 v48, v24, v25
    v_mfma_f32_16x16x32_bf16 v[32:35], v[72:75], a[176:179], v[32:35]
    v_mfma_f32_16x16x32_bf16 v[20:23], a[96:99], v[72:75], v[20:23]
    v_cvt_pk_bf16_f32 v49, v26, v27
    v_mfma_f32_16x16x32_bf16 v[36:39], v[72:75], v[192:195], v[36:39]
    ds_read_b128 v[72:75], v1 offset:29696
    s_waitcnt lgkmcnt(4)
    v_mfma_f32_16x16x32_bf16 v[16:19], a[20:23], v[56:59], v[16:19]
    v_cvt_pk_bf16_f32 v52, v28, v29
    v_mfma_f32_16x16x32_bf16 v[32:35], v[56:59], a[180:183], v[32:35]
    v_mfma_f32_16x16x32_bf16 v[20:23], a[100:103], v[56:59], v[20:23]
    v_cvt_pk_bf16_f32 v53, v30, v31
    v_mfma_f32_16x16x32_bf16 v[36:39], v[56:59], v[196:199], v[36:39]
    ds_read_b128 v[56:59], v1 offset:30720
    s_waitcnt lgkmcnt(4)
    v_mfma_f32_16x16x32_bf16 v[16:19], a[24:27], v[60:63], v[16:19]
    v_mfma_f32_16x16x32_bf16 v[32:35], v[60:63], a[184:187], v[32:35]
    v_mfma_f32_16x16x32_bf16 v[20:23], a[104:107], v[60:63], v[20:23]
    v_mfma_f32_16x16x32_bf16 v[36:39], v[60:63], v[200:203], v[36:39]
    ds_read_b128 v[60:63], v1 offset:31744
    s_waitcnt lgkmcnt(4)
    v_mfma_f32_16x16x32_bf16 v[16:19], a[28:31], v[64:67], v[16:19]
    v_mfma_f32_16x16x32_bf16 v[32:35], v[64:67], a[188:191], v[32:35]
    v_mfma_f32_16x16x32_bf16 v[20:23], a[108:111], v[64:67], v[20:23]
    v_mfma_f32_16x16x32_bf16 v[36:39], v[64:67], v[204:207], v[36:39]
    ds_read_b128 v[64:67], v1 offset:32768
    s_waitcnt lgkmcnt(4)
    v_mfma_f32_16x16x32_bf16 v[16:19], a[32:35], v[68:71], v[16:19]
    v_mfma_f32_16x16x32_bf16 v[32:35], v[68:71], a[192:195], v[32:35]
    v_mfma_f32_16x16x32_bf16 v[20:23], a[112:115], v[68:71], v[20:23]
    v_mfma_f32_16x16x32_bf16 v[36:39], v[68:71], v[208:211], v[36:39]
    ds_read_b128 v[68:71], v1 offset:33792
    s_waitcnt lgkmcnt(4)
    v_mfma_f32_16x16x32_bf16 v[16:19], a[36:39], v[72:75], v[16:19]
    v_mfma_f32_16x16x32_bf16 v[32:35], v[72:75], a[196:199], v[32:35]
    v_mfma_f32_16x16x32_bf16 v[20:23], a[116:119], v[72:75], v[20:23]
    v_mfma_f32_16x16x32_bf16 v[36:39], v[72:75], v[212:215], v[36:39]
    ds_read_b128 v[72:75], v1 offset:34816
    s_waitcnt lgkmcnt(4)
    v_mfma_f32_16x16x32_bf16 v[16:19], a[40:43], v[56:59], v[16:19]
    v_mfma_f32_16x16x32_bf16 v[32:35], v[56:59], a[200:203], v[32:35]
    v_mfma_f32_16x16x32_bf16 v[20:23], a[120:123], v[56:59], v[20:23]
    v_mfma_f32_16x16x32_bf16 v[36:39], v[56:59], v[216:219], v[36:39]
    ds_read_b128 v[56:59], v1 offset:35840
    s_waitcnt lgkmcnt(4)
    v_mfma_f32_16x16x32_bf16 v[16:19], a[44:47], v[60:63], v[16:19]
    v_mfma_f32_16x16x32_bf16 v[32:35], v[60:63], a[204:207], v[32:35]
    v_mfma_f32_16x16x32_bf16 v[20:23], a[124:127], v[60:63], v[20:23]
    v_mfma_f32_16x16x32_bf16 v[36:39], v[60:63], v[220:223], v[36:39]
    ds_read_b128 v[60:63], v1 offset:36864
    s_waitcnt lgkmcnt(4)
    v_mfma_f32_16x16x32_bf16 v[16:19], a[48:51], v[64:67], v[16:19]
    v_mfma_f32_16x16x32_bf16 v[32:35], v[64:67], a[208:211], v[32:35]
    v_mfma_f32_16x16x32_bf16 v[20:23], a[128:131], v[64:67], v[20:23]
    v_mfma_f32_16x16x32_bf16 v[36:39], v[64:67], v[224:227], v[36:39]
    ds_read_b128 v[64:67], v1 offset:37888
    s_waitcnt lgkmcnt(4)
    v_mfma_f32_16x16x32_bf16 v[16:19], a[52:55], v[68:71], v[16:19]
    v_mfma_f32_16x16x32_bf16 v[32:35], v[68:71], a[212:215], v[32:35]
    v_mfma_f32_16x16x32_bf16 v[20:23], a[132:135], v[68:71], v[20:23]
    v_mfma_f32_16x16x32_bf16 v[36:39], v[68:71], v[228:231], v[36:39]
    ds_read_b128 v[68:71], v1 offset:38912
    s_waitcnt lgkmcnt(4)
    v_mfma_f32_16x16x32_bf16 v[16:19], a[56:59], v[72:75], v[16:19]
    v_mfma_f32_16x16x32_bf16 v[32:35], v[72:75], a[216:219], v[32:35]
    v_mfma_f32_16x16x32_bf16 v[20:23], a[136:139], v[72:75], v[20:23]
    v_mfma_f32_16x16x32_bf16 v[36:39], v[72:75], v[232:235], v[36:39]
    ds_read_b128 v[72:75], v1 offset:39936
    s_waitcnt lgkmcnt(4)
    v_mfma_f32_16x16x32_bf16 v[16:19], a[60:63], v[56:59], v[16:19]
    v_mfma_f32_16x16x32_bf16 v[32:35], v[56:59], a[220:223], v[32:35]
    v_mfma_f32_16x16x32_bf16 v[20:23], a[140:143], v[56:59], v[20:23]
    v_mfma_f32_16x16x32_bf16 v[36:39], v[56:59], v[236:239], v[36:39]
    s_waitcnt vmcnt(0)
    s_barrier
    ds_read_b128 v[56:59], v4 offset:0
    s_waitcnt lgkmcnt(4)
    v_mfma_f32_16x16x32_bf16 v[16:19], a[64:67], v[60:63], v[16:19]
    v_mfma_f32_16x16x32_bf16 v[32:35], v[60:63], a[224:227], v[32:35]
    v_mfma_f32_16x16x32_bf16 v[20:23], a[144:147], v[60:63], v[20:23]
    v_mfma_f32_16x16x32_bf16 v[36:39], v[60:63], v[240:243], v[36:39]
    ds_read_b128 v[60:63], v4 offset:1024
    s_waitcnt lgkmcnt(4)
    v_mfma_f32_16x16x32_bf16 v[16:19], a[68:71], v[64:67], v[16:19]
    v_mfma_f32_16x16x32_bf16 v[32:35], v[64:67], a[228:231], v[32:35]
    v_mfma_f32_16x16x32_bf16 v[20:23], a[148:151], v[64:67], v[20:23]
    v_mfma_f32_16x16x32_bf16 v[36:39], v[64:67], v[244:247], v[36:39]
    ds_read_b128 v[64:67], v4 offset:2048
    s_waitcnt lgkmcnt(4)
    v_mfma_f32_16x16x32_bf16 v[16:19], a[72:75], v[68:71], v[16:19]
    v_mfma_f32_16x16x32_bf16 v[32:35], v[68:71], a[232:235], v[32:35]
    v_mfma_f32_16x16x32_bf16 v[20:23], a[152:155], v[68:71], v[20:23]
    v_mfma_f32_16x16x32_bf16 v[36:39], v[68:71], v[248:251], v[36:39]
    ds_read_b128 v[68:71], v4 offset:3072
    s_waitcnt lgkmcnt(4)
    v_mfma_f32_16x16x32_bf16 v[16:19], a[76:79], v[72:75], v[16:19]
    v_mfma_f32_16x16x32_bf16 v[32:35], v[72:75], a[236:239], v[32:35]
    v_mfma_f32_16x16x32_bf16 v[20:23], a[156:159], v[72:75], v[20:23]
    v_mfma_f32_16x16x32_bf16 v[36:39], v[72:75], v[252:255], v[36:39]
    s_add_u32 s27, s50, 4096
    v_mov_b32 v1, v4
    buffer_store_dwordx4 v[40:43], v0, s[8:11], s50 offen sc1
    s_nop 3
    v_cvt_pk_bf16_f32 v44, v16, v20
    v_cvt_pk_bf16_f32 v45, v17, v21
    v_cvt_pk_bf16_f32 v46, v18, v22
    v_cvt_pk_bf16_f32 v47, v19, v23
    v_cvt_pk_bf16_f32 v50, v32, v33
    v_cvt_pk_bf16_f32 v51, v34, v35
    v_cvt_pk_bf16_f32 v54, v36, v37
    v_cvt_pk_bf16_f32 v55, v38, v39
    buffer_store_dwordx4 v[44:47], v0, s[8:11], s27 offen sc1
    buffer_store_dwordx4 v[48:51], v0, s[8:11], s52 offen offset:0 sc1
    buffer_store_dwordx4 v[52:55], v0, s[8:11], s52 offen offset:1024 sc1
    s_add_u32 s50, s50, 262144
    s_add_u32 s52, s52, 262144
    s_barrier
    s_cmp_lg_u32 s44, 3
    s_cbranch_scc1 M_kv_np
    s_cmp_lg_u32 s21, 0
    s_cbranch_scc1 M_kx_6
    v_lshlrev_b32 v190, 3, v0
    s_mov_b64 exec, -1
    s_mov_b32 s30, 0
    s_lshl_b32 s27, s101, 13
    s_add_u32 s27, s27, 167911424
M_kx_7:
    buffer_load_dwordx4 v[176:179], v190, s[8:11], s27 offen sc1
    buffer_load_dwordx4 v[180:183], v190, s[8:11], s27 offen offset:16 sc1
    buffer_load_dwordx2 v[184:185], v190, s[8:11], s27 offen offset:32 sc1
    s_add_u32 s30, s30, 1
    s_cmp_ge_u32 s30, 60000
    s_cbranch_scc1 M_fail
    s_waitcnt vmcnt(0)
    v_min3_u32 v176, v176, v177, v178
    v_min3_u32 v176, v176, v179, v180
    v_min3_u32 v176, v176, v181, v182
    v_min3_u32 v176, v176, v183, v184
    v_min_u32 v176, v176, v185
    v_cmp_eq_u32 vcc, 0, v176
    s_cbranch_vccz M_kx_7d
    s_sleep 4
    s_branch M_kx_7
M_kx_7d:
    s_mov_b64 exec, -1
M_kx_6:
    s_barrier
M_kx_8:
M_kv_np:
    s_cmp_lt_u32 s44, 64
    s_cbranch_scc1 M_kv_top
    s_add_u32 s27, s44, s43
    v_mov_b32 v2, s27
    s_waitcnt vmcnt(0) lgkmcnt(0)
    s_barrier
    s_cmp_lg_u32 s21, 0
    s_cbranch_scc1 M_kv_f2
    s_mov_b64 exec, 3
    buffer_store_dword v2, v3, s[8:11], s51 offen sc1
    s_mov_b64 exec, -1
M_kv_f2:
    s_branch M_bphase
M_qao:
    s_cmp_lg_u32 s101, 0
    s_cbranch_scc1 M_q_ft
    v_lshrrev_b32 v1, 4, v0
    v_lshrrev_b32 v3, 8, v0
    v_and_b32 v4, 15, v1
    v_mov_b32 v5, v0
    s_min_u32 s36, s22, 19
    s_mul_i32 s36, s36, 40
    s_mul_i32 s27, s21, 10
    s_add_u32 s36, s36, s27
    s_add_u32 s35, s36, 10
    s_add_u32 s27, s42, 122880
    v_add_u32 v2, s27, v0
M_q_ftl:
    s_mul_hi_u32 s37, s36, 0xccccccd
    s_mul_i32 s38, s37, 20
    s_sub_u32 s38, s36, s38
    s_lshl_b32 s37, s37, 4
    s_lshl_b32 s38, s38, 5
    v_lshlrev_b32 v7, 3, v3
    v_add_u32 v7, s38, v7
    s_mov_b32 s39, 0x666667
    s_movk_i32 s40, 640
    v_add_u32 v6, s37, v4
    v_cmp_lt_u32 vcc, 320, v6
    v_subrev_u32 v8, 320, v6
    s_nop 1
    v_cndmask_b32 v8, v6, v8, vcc
    v_mov_b32 v9, 0
    v_mov_b32 v10, 0x3e800000
    v_cndmask_b32 v9, v9, v10, vcc
    v_add_u32 v11, 0, v7
    v_mul_u32_u24 v11, v11, v8
    v_mul_hi_u32 v12, v11, s39
    v_mul_lo_u32 v12, v12, s40
    v_sub_u32 v11, v11, v12
    v_cvt_f32_u32 v11, v11
    v_mov_b32 v12, v9
    v_fmac_f32 v12, 0x3acccccd, v11
    v_cos_f32 v16, v12
    v_add_u32 v11, 1, v7
    v_mul_u32_u24 v11, v11, v8
    v_mul_hi_u32 v12, v11, s39
    v_mul_lo_u32 v12, v12, s40
    v_sub_u32 v11, v11, v12
    v_cvt_f32_u32 v11, v11
    v_mov_b32 v12, v9
    v_fmac_f32 v12, 0x3acccccd, v11
    v_cos_f32 v17, v12
    v_add_u32 v11, 2, v7
    v_mul_u32_u24 v11, v11, v8
    v_mul_hi_u32 v12, v11, s39
    v_mul_lo_u32 v12, v12, s40
    v_sub_u32 v11, v11, v12
    v_cvt_f32_u32 v11, v11
    v_mov_b32 v12, v9
    v_fmac_f32 v12, 0x3acccccd, v11
    v_cos_f32 v18, v12
    v_add_u32 v11, 3, v7
    v_mul_u32_u24 v11, v11, v8
    v_mul_hi_u32 v12, v11, s39
    v_mul_lo_u32 v12, v12, s40
    v_sub_u32 v11, v11, v12
    v_cvt_f32_u32 v11, v11
    v_mov_b32 v12, v9
    v_fmac_f32 v12, 0x3acccccd, v11
    v_cos_f32 v19, v12
    v_add_u32 v11, 4, v7
    v_mul_u32_u24 v11, v11, v8
    v_mul_hi_u32 v12, v11, s39
    v_mul_lo_u32 v12, v12, s40
    v_sub_u32 v11, v11, v12
    v_cvt_f32_u32 v11, v11
    v_mov_b32 v12, v9
    v_fmac_f32 v12, 0x3acccccd, v11
    v_cos_f32 v20, v12
    v_add_u32 v11, 5, v7
    v_mul_u32_u24 v11, v11, v8
    v_mul_hi_u32 v12, v11, s39
    v_mul_lo_u32 v12, v12, s40
    v_sub_u32 v11, v11, v12
    v_cvt_f32_u32 v11, v11
    v_mov_b32 v12, v9
    v_fmac_f32 v12, 0x3acccccd, v11
    v_cos_f32 v21, v12
    v_add_u32 v11, 6, v7
    v_mul_u32_u24 v11, v11, v8
    v_mul_hi_u32 v12, v11, s39
    v_mul_lo_u32 v12, v12, s40
    v_sub_u32 v11, v11, v12
    v_cvt_f32_u32 v11, v11
    v_mov_b32 v12, v9
    v_fmac_f32 v12, 0x3acccccd, v11
    v_cos_f32 v22, v12
    v_add_u32 v11, 7, v7
    v_mul_u32_u24 v11, v11, v8
    v_mul_hi_u32 v12, v11, s39
    v_mul_lo_u32 v12, v12, s40
    v_sub_u32 v11, v11, v12
    v_cvt_f32_u32 v11, v11
    v_mov_b32 v12, v9
    v_fmac_f32 v12, 0x3acccccd, v11
    v_cos_f32 v23, v12
    s_nop 0
    v_cvt_pk_f16_f32 v24, v16, v17
    v_cvt_pk_f16_f32 v25, v18, v19
    v_cvt_pk_f16_f32 v26, v20, v21
    v_cvt_pk_f16_f32 v27, v22, v23
    ds_write_b128 v2, v[24:27]
    v_add_u32 v2, 1024, v2
    s_add_u32 s36, s36, 1
    s_cmp_lt_u32 s36, s35
    s_cbranch_scc1 M_q_ftl
    s_waitcnt lgkmcnt(0)
M_q_ft:
    v_lshrrev_b32 v1, 8, v0
    v_bfe_u32 v2, v0, 4, 4
    v_add_u32 v3, 81920, v0
    v_add_u32 v14, 122880, v0
    s_mul_i32 s28, s21, 320
    v_mul_u32_u24 v10, 40960, v2
    v_lshl_add_u32 v10, v1, 4, v10
    s_mul_i32 s27, s22, 1280
    s_add_u32 s29, s27, s28
    v_add_u32 v4, s29, v10
    v_mul_u32_u24 v10, 1280, v1
    s_mul_i32 s27, s22, 40960
    s_add_u32 s27, s27, s28
    v_add_u32 v10, s27, v10
    v_lshl_add_u32 v5, v2, 4, v10
    v_lshrrev_b32 v11, 2, v2
    v_mul_u32_u24 v15, 5120, v11
    v_add_u32 v10, v10, v15
    v_and_b32 v15, 0x30, v0
    v_add_u32 v6, v10, v15
    v_and_b32 v10, 1, v1
    v_lshlrev_b32 v10, 3, v10
    v_add_u32 v8, s29, v10
    v_lshl_add_u32 v7, v2, 4, v8
    v_add_u32 v8, v8, v15
    v_lshl_add_u32 v10, v11, 10, v10
    v_lshl_add_u32 v10, v15, 4, v10
    s_mul_i32 s27, s21, 5120
    s_and_b32 s28, s22, 15
    s_lshl_b32 s28, s28, 4
    s_add_u32 s27, s27, s28
    s_lshr_b32 s28, s22, 4
    s_mul_i32 s28, s28, 20480
    s_add_u32 s27, s27, s28
    v_add_u32 v12, s27, v10
    v_lshlrev_b32 v10, 13, v2
    v_lshl_add_u32 v10, v1, 4, v10
    s_lshl_b32 s27, s22, 18
    s_lshl_b32 s28, s21, 6
    s_add_u32 s27, s27, s28
    v_add_u32 v13, s27, v10
    s_and_b32 s58, s21, 1
    s_lshr_b32 s59, s21, 1
    v_lshlrev_b32 v10, 2, v1
    v_sub_u32 v10, v2, v10
    s_lshl_b32 s27, s58, 4
    v_add_u32 v9, s27, v10
    v_and_b32 v10, 16, v0
    s_movk_i32 s27, 0x3f80
    v_lshlrev_b32_e64 v10, v10, s27
    v_bfe_u32 v11, v0, 5, 2
    v_cmp_eq_u32 vcc, 0, v11
    s_nop 1
    v_cndmask_b32 v16, 0, v10, vcc
    v_cmp_eq_u32 vcc, 1, v11
    s_nop 1
    v_cndmask_b32 v17, 0, v10, vcc
    v_cmp_eq_u32 vcc, 2, v11
    s_nop 1
    v_cndmask_b32 v18, 0, v10, vcc
    v_cmp_eq_u32 vcc, 3, v11
    s_nop 1
    v_cndmask_b32 v19, 0, v10, vcc
    s_mov_b32 s40, 0x3e0293ee
    s_mov_b32 s41, s40
    s_sub_u32 s44, s20, 4
    s_min_u32 s44, s44, 4
    s_mov_b32 s45, 0
    s_load_dwordx2 s[72:73], s[0:1], 64
    s_load_dwordx2 s[76:77], s[0:1], 72
    s_mul_i32 s94, s44, 12
    s_add_u32 s94, s94, s22
    s_sub_u32 s94, s94, 20
    s_lshl_b32 s95, s94, 7
    s_add_u32 s95, s95, 167948288
    s_lshl_b32 s94, s94, 2
    s_add_u32 s94, s94, s21
    s_cmp_lg_u32 s101, 0
    s_cselect_b32 s94, 5000, s94
    s_waitcnt lgkmcnt(0)
    s_and_b32 s73, s73, 0xffff
    s_mov_b32 s74, 1314816
    s_mov_b32 s75, 0x00020000
    s_and_b32 s77, s77, 0xffff
    s_mov_b32 s78, 1314816
    s_mov_b32 s79, 0x00020000
    s_mul_i32 s48, s44, 2621440
    s_add_u32 s48, s48, 117440512
    s_mov_b32 s49, 0
    s_lshl_b32 s51, s44, 12
    s_lshl_b32 s27, s101, 11
    s_add_u32 s51, s51, s27
    s_add_u32 s51, s51, 167870464
    s_lshl_b32 s52, s22, 7
    s_lshl_b32 s27, s101, 12
    s_add_u32 s52, s52, s27
    s_add_u32 s52, s52, 167862272
    s_lshl_b32 s53, s22, 13
    s_add_u32 s53, s53, 218103808
    s_mul_i32 s54, s101, 8388608
    s_add_u32 s54, s54, 134217728
    s_lshl_b32 s60, s22, 8
    s_add_u32 s60, s60, 167854080
    s_mul_i32 s63, s44, 65536
    s_add_u32 s63, s63, 104857600
    s_add_u32 s64, s63, 4096
    s_cmp_lg_u32 s21, 0
    s_cbranch_scc1 M_qx_9
    v_lshlrev_b32 v190, 3, v0
    s_mov_b64 exec, -1
    s_mov_b32 s30, 0
    s_lshl_b32 s27, s101, 13
    s_add_u32 s27, s27, 167911424
M_qx_10:
    buffer_load_dwordx4 v[176:179], v190, s[8:11], s27 offen sc1
    buffer_load_dwordx4 v[180:183], v190, s[8:11], s27 offen offset:16 sc1
    buffer_load_dwordx2 v[184:185], v190, s[8:11], s27 offen offset:32 sc1
    s_add_u32 s30, s30, 1
    s_cmp_ge_u32 s30, 60000
    s_cbranch_scc1 M_fail
    s_waitcnt vmcnt(0)
    v_min3_u32 v176, v176, v177, v178
    v_min3_u32 v176, v176, v179, v180
    v_min3_u32 v176, v176, v181, v182
    v_min3_u32 v176, v176, v183, v184
    v_min_u32 v176, v176, v185
    v_cmp_eq_u32 vcc, 0, v176
    s_cbranch_vccz M_qx_10d
    s_sleep 32
    s_branch M_qx_10
M_qx_10d:
    s_mov_b64 exec, -1
M_qx_9:
    s_barrier
M_qx_11:
    s_min_u32 s27, s44, 63
    s_mul_i32 s27, s27, 40960
    s_add_u32 s27, s27, s47
    s_add_u32 s28, 0, s42
    s_mov_b32 m0, s28
    s_nop 0
    buffer_load_dwordx4 v0, s[8:11], s27 offen offset:0 sc1 lds
    buffer_load_dwordx4 v0, s[8:11], s27 offen offset:1024 sc1 lds
    buffer_load_dwordx4 v0, s[8:11], s27 offen offset:2048 sc1 lds
    buffer_load_dwordx4 v0, s[8:11], s27 offen offset:3072 sc1 lds
    s_add_u32 s27, s27, 4096
    s_add_u32 s28, s28, 4096
    s_mov_b32 m0, s28
    s_nop 0
    buffer_load_dwordx4 v0, s[8:11], s27 offen offset:0 sc1 lds
    buffer_load_dwordx4 v0, s[8:11], s27 offen offset:1024 sc1 lds
    buffer_load_dwordx4 v0, s[8:11], s27 offen offset:2048 sc1 lds
    buffer_load_dwordx4 v0, s[8:11], s27 offen offset:3072 sc1 lds
    s_add_u32 s27, s27, 4096
    s_add_u32 s28, s28, 4096
    s_mov_b32 m0, s28
    s_nop 0
    buffer_load_dwordx4 v0, s[8:11], s27 offen offset:0 sc1 lds
    buffer_load_dwordx4 v0, s[8:11], s27 offen offset:1024 sc1 lds
    s_add_u32 s46, s44, 5
    s_min_u32 s27, s46, 63
    s_mul_i32 s27, s27, 40960
    s_add_u32 s27, s27, s47
    s_add_u32 s28, 40960, s42
    s_mov_b32 m0, s28
    s_nop 0
    buffer_load_dwordx4 v0, s[8:11], s27 offen offset:0 sc1 lds
    buffer_load_dwordx4 v0, s[8:11], s27 offen offset:1024 sc1 lds
    buffer_load_dwordx4 v0, s[8:11], s27 offen offset:2048 sc1 lds
    buffer_load_dwordx4 v0, s[8:11], s27 offen offset:3072 sc1 lds
    s_add_u32 s27, s27, 4096
    s_add_u32 s28, s28, 4096
    s_mov_b32 m0, s28
    s_nop 0
    buffer_load_dwordx4 v0, s[8:11], s27 offen offset:0 sc1 lds
    buffer_load_dwordx4 v0, s[8:11], s27 offen offset:1024 sc1 lds
    buffer_load_dwordx4 v0, s[8:11], s27 offen offset:2048 sc1 lds
    buffer_load_dwordx4 v0, s[8:11], s27 offen offset:3072 sc1 lds
    s_add_u32 s27, s27, 4096
    s_add_u32 s28, s28, 4096
    s_mov_b32 m0, s28
    s_nop 0
    buffer_load_dwordx4 v0, s[8:11], s27 offen offset:0 sc1 lds
    buffer_load_dwordx4 v0, s[8:11], s27 offen offset:1024 sc1 lds
    s_waitcnt vmcnt(0)
    s_barrier
    s_mov_b32 s65, 0
    s_mov_b32 s66, s44
    s_mov_b32 s62, 0x10000000
    s_mov_b32 s67, 0x10000000
    s_mov_b32 s68, 0x10000000
M_q_front:
    s_add_u32 s56, s66, s43
    s_mov_b32 s30, 0
M_q_kf:
    s_cmp_gt_u32 s65, s56
    s_cbranch_scc1 M_q_kg
    v_lshlrev_b32 v10, 3, v0
    s_mov_b64 exec, 3
    buffer_load_dword v15, v10, s[8:11], s60 offen sc1
    s_mov_b64 exec, -1
    s_waitcnt vmcnt(0)
    v_readlane_b32 s65, v15, 0
    v_readlane_b32 s27, v15, 1
    s_nop 3
    s_min_u32 s65, s65, s27
    s_sleep 1
    s_add_u32 s30, s30, 1
    s_cmp_lt_u32 s30, 60000
    s_cbranch_scc1 M_q_kf
    s_branch M_fail
M_q_kg:
    s_nop 1
    s_lshl_b32 s27, s66, 18
    s_add_u32 s27, s27, s50
    s_add_u32 s28, s27, 4096
    buffer_load_dwordx4 v[72:75], v0, s[8:11], s27 offen offset:0 sc1
    buffer_load_dwordx4 v[76:79], v0, s[8:11], s27 offen offset:1024 sc1
    buffer_load_dwordx4 v[80:83], v0, s[8:11], s27 offen offset:2048 sc1
    buffer_load_dwordx4 v[84:87], v0, s[8:11], s27 offen offset:3072 sc1
    buffer_load_dwordx4 v[88:91], v0, s[8:11], s28 offen offset:0 sc1
    buffer_load_dwordx4 v[92:95], v0, s[8:11], s28 offen offset:1024 sc1
    buffer_load_dwordx4 v[96:99], v0, s[8:11], s28 offen offset:2048 sc1
    buffer_load_dwordx4 v[100:103], v0, s[8:11], s28 offen offset:3072 sc1
    s_lshl_b32 s28, s59, 12
    s_add_u32 s27, s27, s28
    s_add_u32 s27, s27, 16777216
    buffer_load_dwordx4 v[104:107], v0, s[8:11], s27 offen offset:0 sc1
    buffer_load_dwordx4 v[108:111], v0, s[8:11], s27 offen offset:1024 sc1
    buffer_load_dwordx4 v[112:115], v0, s[8:11], s27 offen offset:2048 sc1
    buffer_load_dwordx4 v[116:119], v0, s[8:11], s27 offen offset:3072 sc1
    s_mul_i32 s27, s66, 40960
    buffer_load_dwordx2 v[184:185], v7, s[16:19], s27 offen sc1
    buffer_load_dwordx2 v[186:187], v8, s[16:19], s27 offen offset:256 sc1
    v_lshlrev_b32 v10, 3, v0
    s_mov_b64 exec, 3
    buffer_load_dword v15, v10, s[8:11], s60 offen sc1
    s_mov_b64 exec, -1
    v_add_u32 v11, s45, v0
    s_sub_u32 s45, 40960, s45
    ds_read_b128 v[40:43], v11 offset:0
    ds_read_b128 v[44:47], v11 offset:1024
    ds_read_b128 v[48:51], v11 offset:2048
    ds_read_b128 v[52:55], v11 offset:3072
    ds_read_b128 v[56:59], v11 offset:4096
    ds_read_b128 v[60:63], v11 offset:5120
    s_waitcnt lgkmcnt(5)
    v_mfma_f32_16x16x32_bf16 v[24:27], a[0:3], v[40:43], 0
    v_mfma_f32_16x16x32_bf16 v[28:31], a[80:83], v[40:43], 0
    ds_read_b128 v[40:43], v11 offset:6144
    s_waitcnt lgkmcnt(5)
    v_mfma_f32_16x16x32_bf16 v[24:27], a[4:7], v[44:47], v[24:27]
    v_mfma_f32_16x16x32_bf16 v[28:31], a[84:87], v[44:47], v[28:31]
    ds_read_b128 v[44:47], v11 offset:7168
    s_waitcnt lgkmcnt(5)
    v_mfma_f32_16x16x32_bf16 v[24:27], a[8:11], v[48:51], v[24:27]
    v_mfma_f32_16x16x32_bf16 v[28:31], a[88:91], v[48:51], v[28:31]
    ds_read_b128 v[48:51], v11 offset:8192
    s_waitcnt lgkmcnt(5)
    v_mfma_f32_16x16x32_bf16 v[24:27], a[12:15], v[52:55], v[24:27]
    v_mfma_f32_16x16x32_bf16 v[28:31], a[92:95], v[52:55], v[28:31]
    ds_read_b128 v[52:55], v11 offset:9216
    s_waitcnt lgkmcnt(5)
    v_mfma_f32_16x16x32_bf16 v[24:27], a[16:19], v[56:59], v[24:27]
    v_mfma_f32_16x16x32_bf16 v[28:31], a[96:99], v[56:59], v[28:31]
    ds_read_b128 v[56:59], v11 offset:10240
    s_waitcnt lgkmcnt(5)
    v_mfma_f32_16x16x32_bf16 v[24:27], a[20:23], v[60:63], v[24:27]
    v_mfma_f32_16x16x32_bf16 v[28:31], a[100:103], v[60:63], v[28:31]
    ds_read_b128 v[60:63], v11 offset:11264
    s_waitcnt lgkmcnt(5)
    v_mfma_f32_16x16x32_bf16 v[24:27], a[24:27], v[40:43], v[24:27]
    v_mfma_f32_16x16x32_bf16 v[28:31], a[104:107], v[40:43], v[28:31]
    ds_read_b128 v[40:43], v11 offset:12288
    s_waitcnt lgkmcnt(5)
    v_mfma_f32_16x16x32_bf16 v[24:27], a[28:31], v[44:47], v[24:27]
    v_mfma_f32_16x16x32_bf16 v[28:31], a[108:111], v[44:47], v[28:31]
    ds_read_b128 v[44:47], v11 offset:13312
    s_waitcnt lgkmcnt(5)
    v_mfma_f32_16x16x32_bf16 v[24:27], a[32:35], v[48:51], v[24:27]
    v_mfma_f32_16x16x32_bf16 v[28:31], a[112:115], v[48:51], v[28:31]
    ds_read_b128 v[48:51], v11 offset:14336
    s_waitcnt lgkmcnt(5)
    v_mfma_f32_16x16x32_bf16 v[24:27], a[36:39], v[52:55], v[24:27]
    v_mfma_f32_16x16x32_bf16 v[28:31], a[116:119], v[52:55], v[28:31]
    ds_read_b128 v[52:55], v11 offset:15360
    s_waitcnt lgkmcnt(5)
    v_mfma_f32_16x16x32_bf16 v[24:27], a[40:43], v[56:59], v[24:27]
    v_mfma_f32_16x16x32_bf16 v[28:31], a[120:123], v[56:59], v[28:31]
    ds_read_b128 v[56:59], v11 offset:16384
    s_waitcnt lgkmcnt(5)
    v_mfma_f32_16x16x32_bf16 v[24:27], a[44:47], v[60:63], v[24:27]
    v_mfma_f32_16x16x32_bf16 v[28:31], a[124:127], v[60:63], v[28:31]
    ds_read_b128 v[60:63], v11 offset:17408
    s_waitcnt lgkmcnt(5)
    v_mfma_f32_16x16x32_bf16 v[24:27], a[48:51], v[40:43], v[24:27]
    v_mfma_f32_16x16x32_bf16 v[28:31], a[128:131], v[40:43], v[28:31]
    ds_read_b128 v[40:43], v11 offset:18432
    s_waitcnt lgkmcnt(5)
    v_mfma_f32_16x16x32_bf16 v[24:27], a[52:55], v[44:47], v[24:27]
    v_mfma_f32_16x16x32_bf16 v[28:31], a[132:135], v[44:47], v[28:31]
    ds_read_b128 v[44:47], v11 offset:19456
    s_waitcnt lgkmcnt(5)
    v_mfma_f32_16x16x32_bf16 v[24:27], a[56:59], v[48:51], v[24:27]
    v_mfma_f32_16x16x32_bf16 v[28:31], a[136:139], v[48:51], v[28:31]
    ds_read_b128 v[48:51], v11 offset:20480
    s_waitcnt lgkmcnt(5)
    v_mfma_f32_16x16x32_bf16 v[24:27], a[60:63], v[52:55], v[24:27]
    v_mfma_f32_16x16x32_bf16 v[28:31], a[140:143], v[52:55], v[28:31]
    ds_read_b128 v[52:55], v11 offset:21504
    s_waitcnt lgkmcnt(5)
    v_mfma_f32_16x16x32_bf16 v[24:27], a[64:67], v[56:59], v[24:27]
    v_mfma_f32_16x16x32_bf16 v[28:31], a[144:147], v[56:59], v[28:31]
    ds_read_b128 v[56:59], v11 offset:22528
    s_waitcnt lgkmcnt(5)
    v_mfma_f32_16x16x32_bf16 v[24:27], a[68:71], v[60:63], v[24:27]
    v_mfma_f32_16x16x32_bf16 v[28:31], a[148:151], v[60:63], v[28:31]
    ds_read_b128 v[60:63], v11 offset:23552
    s_waitcnt lgkmcnt(5)
    v_mfma_f32_16x16x32_bf16 v[24:27], a[72:75], v[40:43], v[24:27]
    v_mfma_f32_16x16x32_bf16 v[28:31], a[152:155], v[40:43], v[28:31]
    ds_read_b128 v[40:43], v11 offset:24576
    s_waitcnt lgkmcnt(5)
    v_mfma_f32_16x16x32_bf16 v[24:27], a[76:79], v[44:47], v[24:27]
    v_mfma_f32_16x16x32_bf16 v[28:31], a[156:159], v[44:47], v[28:31]
    ds_read_b128 v[44:47], v11 offset:25600
    s_waitcnt lgkmcnt(5)
    v_mfma_f32_16x16x32_bf16 v[32:35], a[0:3], v[48:51], 0
    v_mfma_f32_16x16x32_bf16 v[36:39], a[80:83], v[48:51], 0
    ds_read_b128 v[48:51], v11 offset:26624
    s_waitcnt lgkmcnt(5)
    v_mfma_f32_16x16x32_bf16 v[32:35], a[4:7], v[52:55], v[32:35]
    v_mfma_f32_16x16x32_bf16 v[36:39], a[84:87], v[52:55], v[36:39]
    ds_read_b128 v[52:55], v11 offset:27648
    s_waitcnt lgkmcnt(5)
    v_mfma_f32_16x16x32_bf16 v[32:35], a[8:11], v[56:59], v[32:35]
    v_mfma_f32_16x16x32_bf16 v[36:39], a[88:91], v[56:59], v[36:39]
    ds_read_b128 v[56:59], v11 offset:28672
    s_waitcnt lgkmcnt(5)
    v_mfma_f32_16x16x32_bf16 v[32:35], a[12:15], v[60:63], v[32:35]
    v_mfma_f32_16x16x32_bf16 v[36:39], a[92:95], v[60:63], v[36:39]
    ds_read_b128 v[60:63], v11 offset:29696
    s_waitcnt lgkmcnt(5)
    v_mfma_f32_16x16x32_bf16 v[32:35], a[16:19], v[40:43], v[32:35]
    v_mfma_f32_16x16x32_bf16 v[36:39], a[96:99], v[40:43], v[36:39]
    ds_read_b128 v[40:43], v11 offset:30720
    s_waitcnt lgkmcnt(5)
    v_mfma_f32_16x16x32_bf16 v[32:35], a[20:23], v[44:47], v[32:35]
    v_mfma_f32_16x16x32_bf16 v[36:39], a[100:103], v[44:47], v[36:39]
    ds_read_b128 v[44:47], v11 offset:31744
    s_waitcnt lgkmcnt(5)
    v_mfma_f32_16x16x32_bf16 v[32:35], a[24:27], v[48:51], v[32:35]
    v_mfma_f32_16x16x32_bf16 v[36:39], a[104:107], v[48:51], v[36:39]
    ds_read_b128 v[48:51], v11 offset:32768
    s_waitcnt lgkmcnt(5)
    v_mfma_f32_16x16x32_bf16 v[32:35], a[28:31], v[52:55], v[32:35]
    v_mfma_f32_16x16x32_bf16 v[36:39], a[108:111], v[52:55], v[36:39]
    ds_read_b128 v[52:55], v11 offset:33792
    s_waitcnt lgkmcnt(5)
    v_mfma_f32_16x16x32_bf16 v[32:35], a[32:35], v[56:59], v[32:35]
    v_mfma_f32_16x16x32_bf16 v[36:39], a[112:115], v[56:59], v[36:39]
    ds_read_b128 v[56:59], v11 offset:34816
    s_waitcnt lgkmcnt(5)
    v_mfma_f32_16x16x32_bf16 v[32:35], a[36:39], v[60:63], v[32:35]
    v_mfma_f32_16x16x32_bf16 v[36:39], a[116:119], v[60:63], v[36:39]
    ds_read_b128 v[60:63], v11 offset:35840
    s_waitcnt lgkmcnt(5)
    v_mfma_f32_16x16x32_bf16 v[32:35], a[40:43], v[40:43], v[32:35]
    v_mfma_f32_16x16x32_bf16 v[36:39], a[120:123], v[40:43], v[36:39]
    ds_read_b128 v[40:43], v11 offset:36864
    s_waitcnt lgkmcnt(5)
    v_mfma_f32_16x16x32_bf16 v[32:35], a[44:47], v[44:47], v[32:35]
    v_mfma_f32_16x16x32_bf16 v[36:39], a[124:127], v[44:47], v[36:39]
    ds_read_b128 v[44:47], v11 offset:37888
    s_waitcnt lgkmcnt(5)
    v_mfma_f32_16x16x32_bf16 v[32:35], a[48:51], v[48:51], v[32:35]
    v_mfma_f32_16x16x32_bf16 v[36:39], a[128:131], v[48:51], v[36:39]
    ds_read_b128 v[48:51], v11 offset:38912
    s_waitcnt lgkmcnt(5)
    v_mfma_f32_16x16x32_bf16 v[32:35], a[52:55], v[52:55], v[32:35]
    v_mfma_f32_16x16x32_bf16 v[36:39], a[132:135], v[52:55], v[36:39]
    ds_read_b128 v[52:55], v11 offset:39936
    s_waitcnt lgkmcnt(5)
    v_mfma_f32_16x16x32_bf16 v[32:35], a[56:59], v[56:59], v[32:35]
    v_mfma_f32_16x16x32_bf16 v[36:39], a[136:139], v[56:59], v[36:39]
    s_waitcnt lgkmcnt(4)
    v_mfma_f32_16x16x32_bf16 v[32:35], a[60:63], v[60:63], v[32:35]
    v_mfma_f32_16x16x32_bf16 v[36:39], a[140:143], v[60:63], v[36:39]
    s_waitcnt lgkmcnt(3)
    v_mfma_f32_16x16x32_bf16 v[32:35], a[64:67], v[40:43], v[32:35]
    v_mfma_f32_16x16x32_bf16 v[36:39], a[144:147], v[40:43], v[36:39]
    s_waitcnt lgkmcnt(2)
    v_mfma_f32_16x16x32_bf16 v[32:35], a[68:71], v[44:47], v[32:35]
    v_mfma_f32_16x16x32_bf16 v[36:39], a[148:151], v[44:47], v[36:39]
    s_waitcnt lgkmcnt(1)
    v_mfma_f32_16x16x32_bf16 v[32:35], a[72:75], v[48:51], v[32:35]
    v_mfma_f32_16x16x32_bf16 v[36:39], a[152:155], v[48:51], v[36:39]
    s_waitcnt lgkmcnt(0)
    v_mfma_f32_16x16x32_bf16 v[32:35], a[76:79], v[52:55], v[32:35]
    v_mfma_f32_16x16x32_bf16 v[36:39], a[156:159], v[52:55], v[36:39]
    v_pk_mul_f32 v[24:25], v[24:25], s[40:41]
    v_pk_mul_f32 v[26:27], v[26:27], s[40:41]
    v_pk_mul_f32 v[28:29], v[28:29], s[40:41]
    v_pk_mul_f32 v[30:31], v[30:31], s[40:41]
    s_nop 2
    v_pk_mul_f32 v[32:33], v[32:33], s[40:41]
    v_pk_mul_f32 v[34:35], v[34:35], s[40:41]
    v_pk_mul_f32 v[36:37], v[36:37], s[40:41]
    v_pk_mul_f32 v[38:39], v[38:39], s[40:41]
    s_lshl_b32 s27, s21, 10
    v_add_u32 v10, s27, v3
    v_cvt_pk_bf16_f32 v40, v24, v28
    v_cvt_pk_bf16_f32 v41, v25, v29
    v_cvt_pk_bf16_f32 v42, v26, v30
    v_cvt_pk_bf16_f32 v43, v27, v31
    ds_write_b128 v10, v[40:43] offset:0
    v_cvt_pk_bf16_f32 v44, v32, v36
    v_cvt_pk_bf16_f32 v45, v33, v37
    v_cvt_pk_bf16_f32 v46, v34, v38
    v_cvt_pk_bf16_f32 v47, v35, v39
    ds_write_b128 v10, v[44:47] offset:4096
    s_lshl_b32 s27, s58, 12
    v_add_u32 v10, s27, v3
    s_waitcnt vmcnt(15) lgkmcnt(0)
    s_barrier
    ds_read_b128 v[160:163], v10 offset:0
    ds_read_b128 v[164:167], v10 offset:1024
    ds_read_b128 v[168:171], v10 offset:2048
    ds_read_b128 v[172:175], v10 offset:3072
    s_waitcnt vmcnt(0)
    s_cmp_lg_u32 s21, 0
    s_cbranch_scc1 M_q_fa
    s_mov_b64 exec, 1
    v_mov_b32 v10, s22
    v_mov_b32 v11, 1
    s_cmp_lg_u32 s23, 0
    s_cbranch_scc1 M_ls_12
    buffer_store_byte v11, v10, s[8:11], s62 offen
M_ls_12_r:
    s_mov_b64 exec, -1
M_q_fa:
    v_mov_b32 v11, 0xf149f2ca
    v_cmp_gt_i32 vcc, 0, v9
    s_nop 1
    v_cndmask_b32 v120, 0, v11, vcc
    v_cmp_gt_i32 vcc, 1, v9
    s_nop 1
    v_cndmask_b32 v121, 0, v11, vcc
    v_cmp_gt_i32 vcc, 2, v9
    s_nop 1
    v_cndmask_b32 v122, 0, v11, vcc
    v_cmp_gt_i32 vcc, 3, v9
    s_nop 1
    v_cndmask_b32 v123, 0, v11, vcc
    v_cmp_gt_i32 vcc, 16, v9
    s_nop 1
    v_cndmask_b32 v124, 0, v11, vcc
    v_cmp_gt_i32 vcc, 17, v9
    s_nop 1
    v_cndmask_b32 v125, 0, v11, vcc
    v_cmp_gt_i32 vcc, 18, v9
    s_nop 1
    v_cndmask_b32 v126, 0, v11, vcc
    v_cmp_gt_i32 vcc, 19, v9
    s_nop 1
    v_cndmask_b32 v127, 0, v11, vcc
    s_waitcnt lgkmcnt(3)
    v_mfma_f32_16x16x32_bf16 v[120:123], v[72:75], v[160:163], v[120:123]
    v_mfma_f32_16x16x32_bf16 v[124:127], v[88:91], v[160:163], v[124:127]
    s_waitcnt lgkmcnt(2)
    v_mfma_f32_16x16x32_bf16 v[120:123], v[76:79], v[164:167], v[120:123]
    v_mfma_f32_16x16x32_bf16 v[124:127], v[92:95], v[164:167], v[124:127]
    s_waitcnt lgkmcnt(1)
    v_mfma_f32_16x16x32_bf16 v[120:123], v[80:83], v[168:171], v[120:123]
    v_mfma_f32_16x16x32_bf16 v[124:127], v[96:99], v[168:171], v[124:127]
    s_waitcnt lgkmcnt(0)
    v_mfma_f32_16x16x32_bf16 v[120:123], v[84:87], v[172:175], v[120:123]
    v_mfma_f32_16x16x32_bf16 v[124:127], v[100:103], v[172:175], v[124:127]
    v_readlane_b32 s65, v15, 0
    v_readlane_b32 s27, v15, 1
    s_nop 3
    s_min_u32 s65, s65, s27
    v_max3_f32 v176, v120, v121, v122
    v_max3_f32 v176, v176, v123, v124
    v_max3_f32 v176, v176, v125, v126
    v_max_f32 v176, v176, v127
    v_mov_b32 v178, v176
    s_nop 1
    v_permlane16_swap_b32 v176, v178
    v_max_f32 v176, v176, v178
    v_mov_b32 v178, v176
    s_nop 1
    v_permlane32_swap_b32 v176, v178
    v_max_f32 v176, v176, v178
    v_sub_f32 v120, v120, v176
    v_sub_f32 v121, v121, v176
    v_sub_f32 v122, v122, v176
    v_sub_f32 v123, v123, v176
    v_sub_f32 v124, v124, v176
    v_sub_f32 v125, v125, v176
    v_sub_f32 v126, v126, v176
    v_sub_f32 v127, v127, v176
    v_exp_f32 v120, v120
    v_exp_f32 v121, v121
    v_exp_f32 v122, v122
    v_exp_f32 v123, v123
    v_exp_f32 v124, v124
    v_exp_f32 v125, v125
    v_exp_f32 v126, v126
    v_exp_f32 v127, v127
    v_cvt_pk_bf16_f32 v128, v120, v121
    v_cvt_pk_bf16_f32 v129, v122, v123
    v_cvt_pk_bf16_f32 v130, v124, v125
    v_cvt_pk_bf16_f32 v131, v126, v127
    v_add_f32 v177, v120, v121
    v_add_f32 v177, v177, v122
    v_add_f32 v177, v177, v123
    v_add_f32 v177, v177, v124
    v_add_f32 v177, v177, v125
    v_add_f32 v177, v177, v126
    v_add_f32 v177, v177, v127
    v_mfma_f32_16x16x32_bf16 v[144:147], v[104:107], v[128:131], 0
    v_mfma_f32_16x16x32_bf16 v[148:151], v[108:111], v[128:131], 0
    v_mfma_f32_16x16x32_bf16 v[152:155], v[112:115], v[128:131], 0
    v_mfma_f32_16x16x32_bf16 v[156:159], v[116:119], v[128:131], 0
    v_mov_b32 v178, v177
    s_nop 1
    v_permlane16_swap_b32 v177, v178
    v_add_f32 v177, v177, v178
    v_mov_b32 v178, v177
    s_nop 1
    v_permlane32_swap_b32 v177, v178
    v_add_f32 v177, v177, v178
    s_cmp_lg_u32 s66, s44
    s_cbranch_scc1 M_q_back2
M_q_top:
    s_add_u32 s56, s44, s43
    s_lshl_b32 s57, s44, 7
    s_mul_i32 s55, s44, 40960
    s_lshl_b32 s26, s56, 18
    s_add_u32 s26, s26, s53
    s_lshl_b32 s28, s59, 11
    s_add_u32 s29, s26, s28
    s_add_u32 s29, s29, 4096
    s_lshl_b32 s27, s58, 12
    s_add_u32 s27, s27, s28
    v_add_u32 v10, s27, v3
    s_cmp_lg_u32 s21, 0
    s_cbranch_scc1 M_cf_13
    s_mov_b64 exec, 0x3
    s_mov_b32 s30, 0
    v_lshrrev_b32 v190, 2, v0
M_cf_14:
    buffer_load_dword v191, v190, s[8:11], s52 offen sc1
    s_add_u32 s30, s30, 1
    s_cmp_ge_u32 s30, 60000
    s_cbranch_scc1 M_fail
    s_waitcnt vmcnt(0)
    v_cmp_ge_u32 vcc, s57, v191
    s_cbranch_vccz M_cf_14d
    s_sleep 1
    s_branch M_cf_14
M_cf_14d:
    s_mov_b64 exec, -1
M_cf_13:
    s_barrier
    buffer_load_dwordx4 v[24:27], v0, s[8:11], s26 offen offset:0 sc1
    buffer_load_dwordx4 v[28:31], v0, s[8:11], s26 offen offset:1024 sc1
    buffer_load_dwordx4 v[32:35], v0, s[8:11], s26 offen offset:2048 sc1
    buffer_load_dwordx4 v[36:39], v0, s[8:11], s26 offen offset:3072 sc1
    buffer_load_dwordx4 v[40:43], v0, s[8:11], s29 offen offset:0 sc1
    buffer_load_dwordx4 v[44:47], v0, s[8:11], s29 offen offset:1024 sc1
    s_waitcnt vmcnt(5)
    v_mfma_f32_16x16x32_bf16 v[48:51], v[24:27], v[160:163], 0
    s_waitcnt vmcnt(4)
    v_mfma_f32_16x16x32_bf16 v[48:51], v[28:31], v[164:167], v[48:51]
    s_waitcnt vmcnt(3)
    v_mfma_f32_16x16x32_bf16 v[48:51], v[32:35], v[168:171], v[48:51]
    s_waitcnt vmcnt(2)
    v_mfma_f32_16x16x32_bf16 v[48:51], v[36:39], v[172:175], v[48:51]
    s_nop 7
    v_max3_f32 v179, v176, v48, v49
    v_max3_f32 v179, v179, v50, v51
    v_mov_b32 v178, v179
    s_nop 1
    v_permlane16_swap_b32 v179, v178
    v_max_f32 v179, v179, v178
    v_sub_f32 v180, v176, v179
    v_sub_f32 v48, v48, v179
    v_sub_f32 v49, v49, v179
    v_sub_f32 v50, v50, v179
    v_sub_f32 v51, v51, v179
    v_exp_f32 v180, v180
    v_exp_f32 v48, v48
    v_exp_f32 v49, v49
    v_exp_f32 v50, v50
    v_exp_f32 v51, v51
    v_add_f32 v179, v48, v49
    v_add_f32 v176, v50, v51
    v_add_f32 v179, v179, v176
    v_mov_b32 v178, v179
    s_nop 1
    v_permlane16_swap_b32 v179, v178
    v_add_f32 v179, v179, v178
    v_fmac_f32 v179, v180, v177
    v_rcp_f32 v179, v179
    s_nop 0
    v_mul_f32 v180, v180, v179
    v_mul_f32 v48, v48, v179
    v_mul_f32 v49, v49, v179
    v_mul_f32 v50, v50, v179
    v_mul_f32 v51, v51, v179
    v_cvt_pk_bf16_f32 v48, v48, v49
    v_cvt_pk_bf16_f32 v49, v50, v51
    v_pk_mul_f32 v[144:145], v[144:145], v[180:181] op_sel_hi:[1,0]
    v_pk_mul_f32 v[146:147], v[146:147], v[180:181] op_sel_hi:[1,0]
    v_pk_mul_f32 v[148:149], v[148:149], v[180:181] op_sel_hi:[1,0]
    v_pk_mul_f32 v[150:151], v[150:151], v[180:181] op_sel_hi:[1,0]
    v_pk_mul_f32 v[152:153], v[152:153], v[180:181] op_sel_hi:[1,0]
    v_pk_mul_f32 v[154:155], v[154:155], v[180:181] op_sel_hi:[1,0]
    v_pk_mul_f32 v[156:157], v[156:157], v[180:181] op_sel_hi:[1,0]
    v_pk_mul_f32 v[158:159], v[158:159], v[180:181] op_sel_hi:[1,0]
    s_waitcnt vmcnt(1)
    v_mfma_f32_16x16x16_bf16 v[144:147], v[40:41], v[48:49], v[144:147]
    v_mfma_f32_16x16x16_bf16 v[148:151], v[42:43], v[48:49], v[148:151]
    s_waitcnt vmcnt(0)
    v_mfma_f32_16x16x16_bf16 v[152:155], v[44:45], v[48:49], v[152:155]
    v_mfma_f32_16x16x16_bf16 v[156:159], v[46:47], v[48:49], v[156:159]
    s_nop 4
    v_cvt_pk_bf16_f32 v56, v144, v148
    v_cvt_pk_bf16_f32 v57, v145, v149
    v_cvt_pk_bf16_f32 v58, v146, v150
    v_cvt_pk_bf16_f32 v59, v147, v151
    ds_write_b128 v10, v[56:59] offset:8192
    v_cvt_pk_bf16_f32 v60, v152, v156
    v_cvt_pk_bf16_f32 v61, v153, v157
    v_cvt_pk_bf16_f32 v62, v154, v158
    v_cvt_pk_bf16_f32 v63, v155, v159
    ds_write_b128 v10, v[60:63] offset:9216
    s_waitcnt lgkmcnt(0)
    s_barrier
    ds_read_b128 v[24:27], v3 offset:8192
    ds_read_b128 v[40:43], v3 offset:12288
    ds_read_b128 v[28:31], v3 offset:9216
    ds_read_b128 v[44:47], v3 offset:13312
    ds_read_b128 v[32:35], v3 offset:10240
    ds_read_b128 v[48:51], v3 offset:14336
    ds_read_b128 v[36:39], v3 offset:11264
    ds_read_b128 v[52:55], v3 offset:15360
    s_add_u32 s28, s68, 131072
    buffer_store_dwordx4 v[104:107], v13, s[8:11], s68 offen sc1
    buffer_store_dwordx4 v[108:111], v13, s[8:11], s28 offen sc1
    s_mov_b32 exec_hi, 0
    buffer_store_dwordx2 v[20:21], v7, s[8:11], s67 offen sc1
    s_mov_b32 exec_lo, 0x000f000f
    buffer_store_dwordx2 v[22:23], v7, s[8:11], s67 offen offset:256 sc1
    s_mov_b64 exec, -1
    v_mov_b64 v[20:21], v[184:185]
    v_mov_b64 v[22:23], v[186:187]
    s_add_u32 s46, s44, 10
    s_cmp_ge_u32 s46, 64
    s_cbranch_scc1 M_q_tb
    s_sub_u32 s29, 40960, s45
    s_min_u32 s27, s46, 63
    s_mul_i32 s27, s27, 40960
    s_add_u32 s27, s27, s47
    s_add_u32 s28, s29, s42
    s_mov_b32 m0, s28
    s_nop 0
    buffer_load_dwordx4 v0, s[8:11], s27 offen offset:0 sc1 lds
    buffer_load_dwordx4 v0, s[8:11], s27 offen offset:1024 sc1 lds
    buffer_load_dwordx4 v0, s[8:11], s27 offen offset:2048 sc1 lds
    buffer_load_dwordx4 v0, s[8:11], s27 offen offset:3072 sc1 lds
    s_add_u32 s27, s27, 4096
    s_add_u32 s28, s28, 4096
    s_mov_b32 m0, s28
    s_nop 0
    buffer_load_dwordx4 v0, s[8:11], s27 offen offset:0 sc1 lds
    buffer_load_dwordx4 v0, s[8:11], s27 offen offset:1024 sc1 lds
    buffer_load_dwordx4 v0, s[8:11], s27 offen offset:2048 sc1 lds
    buffer_load_dwordx4 v0, s[8:11], s27 offen offset:3072 sc1 lds
    s_add_u32 s27, s27, 4096
    s_add_u32 s28, s28, 4096
    s_mov_b32 m0, s28
    s_nop 0
    buffer_load_dwordx4 v0, s[8:11], s27 offen offset:0 sc1 lds
    buffer_load_dwordx4 v0, s[8:11], s27 offen offset:1024 sc1 lds
M_q_nx:
    s_mov_b32 s62, s51
    s_add_u32 s27, s48, 655360
    s_waitcnt lgkmcnt(7)
    v_mfma_f32_16x16x32_bf16 v[64:67], a[160:163], v[24:27], 0
    v_mfma_f32_16x16x32_bf16 v[68:71], a[176:179], v[24:27], 0
    s_waitcnt lgkmcnt(6)
    v_mfma_f32_16x16x32_bf16 v[72:75], a[160:163], v[40:43], 0
    v_mfma_f32_16x16x32_bf16 v[76:79], a[176:179], v[40:43], 0
    s_waitcnt lgkmcnt(5)
    v_mfma_f32_16x16x32_bf16 v[64:67], a[164:167], v[28:31], v[64:67]
    v_mfma_f32_16x16x32_bf16 v[68:71], a[180:183], v[28:31], v[68:71]
    s_waitcnt lgkmcnt(4)
    v_mfma_f32_16x16x32_bf16 v[72:75], a[164:167], v[44:47], v[72:75]
    v_mfma_f32_16x16x32_bf16 v[76:79], a[180:183], v[44:47], v[76:79]
    s_waitcnt lgkmcnt(3)
    v_mfma_f32_16x16x32_bf16 v[64:67], a[168:171], v[32:35], v[64:67]
    v_mfma_f32_16x16x32_bf16 v[68:71], a[184:187], v[32:35], v[68:71]
    s_waitcnt lgkmcnt(2)
    v_mfma_f32_16x16x32_bf16 v[72:75], a[168:171], v[48:51], v[72:75]
    v_mfma_f32_16x16x32_bf16 v[76:79], a[184:187], v[48:51], v[76:79]
    s_waitcnt lgkmcnt(1)
    v_mfma_f32_16x16x32_bf16 v[64:67], a[172:175], v[36:39], v[64:67]
    v_mfma_f32_16x16x32_bf16 v[68:71], a[188:191], v[36:39], v[68:71]
    s_waitcnt lgkmcnt(0)
    v_mfma_f32_16x16x32_bf16 v[72:75], a[172:175], v[52:55], v[72:75]
    v_mfma_f32_16x16x32_bf16 v[76:79], a[188:191], v[52:55], v[76:79]
    v_mfma_f32_16x16x32_bf16 v[80:83], a[192:195], v[24:27], 0
    v_mfma_f32_16x16x32_bf16 v[84:87], a[208:211], v[24:27], 0
    v_mfma_f32_16x16x32_bf16 v[88:91], a[192:195], v[40:43], 0
    v_mfma_f32_16x16x32_bf16 v[92:95], a[208:211], v[40:43], 0
    v_mfma_f32_16x16x32_bf16 v[80:83], a[196:199], v[28:31], v[80:83]
    v_cvt_pk_bf16_f32 v64, v64, v65
    v_cvt_pk_bf16_f32 v65, v66, v67
    v_mfma_f32_16x16x32_bf16 v[84:87], a[212:215], v[28:31], v[84:87]
    v_cvt_pk_bf16_f32 v66, v68, v69
    v_cvt_pk_bf16_f32 v67, v70, v71
    v_mfma_f32_16x16x32_bf16 v[88:91], a[196:199], v[44:47], v[88:91]
    v_cvt_pk_bf16_f32 v72, v72, v73
    v_cvt_pk_bf16_f32 v73, v74, v75
    v_mfma_f32_16x16x32_bf16 v[92:95], a[212:215], v[44:47], v[92:95]
    v_cvt_pk_bf16_f32 v74, v76, v77
    v_cvt_pk_bf16_f32 v75, v78, v79
    s_cmp_lg_u32 s23, 0
    s_cbranch_scc1 M_ls_15
    buffer_store_dwordx4 v[64:67], v4, s[8:11], s48 offen offset:0
    buffer_store_dwordx4 v[72:75], v4, s[8:11], s27 offen offset:0
M_ls_15_r:
    v_mfma_f32_16x16x32_bf16 v[80:83], a[200:203], v[32:35], v[80:83]
    v_mfma_f32_16x16x32_bf16 v[84:87], a[216:219], v[32:35], v[84:87]
    v_mfma_f32_16x16x32_bf16 v[88:91], a[200:203], v[48:51], v[88:91]
    v_mfma_f32_16x16x32_bf16 v[92:95], a[216:219], v[48:51], v[92:95]
    v_mfma_f32_16x16x32_bf16 v[80:83], a[204:207], v[36:39], v[80:83]
    v_mfma_f32_16x16x32_bf16 v[84:87], a[220:223], v[36:39], v[84:87]
    v_mfma_f32_16x16x32_bf16 v[88:91], a[204:207], v[52:55], v[88:91]
    v_mfma_f32_16x16x32_bf16 v[92:95], a[220:223], v[52:55], v[92:95]
    v_mfma_f32_16x16x32_bf16 v[96:99], a[224:227], v[24:27], 0
    v_mfma_f32_16x16x32_bf16 v[100:103], a[240:243], v[24:27], 0
    v_mfma_f32_16x16x32_bf16 v[104:107], a[224:227], v[40:43], 0
    v_mfma_f32_16x16x32_bf16 v[108:111], a[240:243], v[40:43], 0
    v_mfma_f32_16x16x32_bf16 v[96:99], a[228:231], v[28:31], v[96:99]
    v_cvt_pk_bf16_f32 v80, v80, v81
    v_cvt_pk_bf16_f32 v81, v82, v83
    v_mfma_f32_16x16x32_bf16 v[100:103], a[244:247], v[28:31], v[100:103]
    v_cvt_pk_bf16_f32 v82, v84, v85
    v_cvt_pk_bf16_f32 v83, v86, v87
    v_mfma_f32_16x16x32_bf16 v[104:107], a[228:231], v[44:47], v[104:107]
    v_cvt_pk_bf16_f32 v88, v88, v89
    v_cvt_pk_bf16_f32 v89, v90, v91
    v_mfma_f32_16x16x32_bf16 v[108:111], a[244:247], v[44:47], v[108:111]
    v_cvt_pk_bf16_f32 v90, v92, v93
    v_cvt_pk_bf16_f32 v91, v94, v95
    s_cmp_lg_u32 s23, 0
    s_cbranch_scc1 M_ls_16
    buffer_store_dwordx4 v[80:83], v4, s[8:11], s48 offen offset:64
    buffer_store_dwordx4 v[88:91], v4, s[8:11], s27 offen offset:64
M_ls_16_r:
    v_mfma_f32_16x16x32_bf16 v[96:99], a[232:235], v[32:35], v[96:99]
    v_mfma_f32_16x16x32_bf16 v[100:103], a[248:251], v[32:35], v[100:103]
    v_mfma_f32_16x16x32_bf16 v[104:107], a[232:235], v[48:51], v[104:107]
    v_mfma_f32_16x16x32_bf16 v[108:111], a[248:251], v[48:51], v[108:111]
    v_mfma_f32_16x16x32_bf16 v[96:99], a[236:239], v[36:39], v[96:99]
    v_mfma_f32_16x16x32_bf16 v[100:103], a[252:255], v[36:39], v[100:103]
    v_mfma_f32_16x16x32_bf16 v[104:107], a[236:239], v[52:55], v[104:107]
    v_mfma_f32_16x16x32_bf16 v[108:111], a[252:255], v[52:55], v[108:111]
    v_mfma_f32_16x16x32_bf16 v[112:115], v[192:195], v[24:27], 0
    v_mfma_f32_16x16x32_bf16 v[116:119], v[208:211], v[24:27], 0
    v_mfma_f32_16x16x32_bf16 v[120:123], v[192:195], v[40:43], 0
    v_mfma_f32_16x16x32_bf16 v[124:127], v[208:211], v[40:43], 0
    v_mfma_f32_16x16x32_bf16 v[112:115], v[196:199], v[28:31], v[112:115]
    v_cvt_pk_bf16_f32 v96, v96, v97
    v_cvt_pk_bf16_f32 v97, v98, v99
    v_mfma_f32_16x16x32_bf16 v[116:119], v[212:215], v[28:31], v[116:119]
    v_cvt_pk_bf16_f32 v98, v100, v101
    v_cvt_pk_bf16_f32 v99, v102, v103
    v_mfma_f32_16x16x32_bf16 v[120:123], v[196:199], v[44:47], v[120:123]
    v_cvt_pk_bf16_f32 v104, v104, v105
    v_cvt_pk_bf16_f32 v105, v106, v107
    v_mfma_f32_16x16x32_bf16 v[124:127], v[212:215], v[44:47], v[124:127]
    v_cvt_pk_bf16_f32 v106, v108, v109
    v_cvt_pk_bf16_f32 v107, v110, v111
    s_cmp_lg_u32 s23, 0
    s_cbranch_scc1 M_ls_17
    buffer_store_dwordx4 v[96:99], v4, s[8:11], s48 offen offset:128
    buffer_store_dwordx4 v[104:107], v4, s[8:11], s27 offen offset:128
M_ls_17_r:
    v_mfma_f32_16x16x32_bf16 v[112:115], v[200:203], v[32:35], v[112:115]
    v_mfma_f32_16x16x32_bf16 v[116:119], v[216:219], v[32:35], v[116:119]
    v_mfma_f32_16x16x32_bf16 v[120:123], v[200:203], v[48:51], v[120:123]
    v_mfma_f32_16x16x32_bf16 v[124:127], v[216:219], v[48:51], v[124:127]
    v_mfma_f32_16x16x32_bf16 v[112:115], v[204:207], v[36:39], v[112:115]
    v_mfma_f32_16x16x32_bf16 v[116:119], v[220:223], v[36:39], v[116:119]
    v_mfma_f32_16x16x32_bf16 v[120:123], v[204:207], v[52:55], v[120:123]
    v_mfma_f32_16x16x32_bf16 v[124:127], v[220:223], v[52:55], v[124:127]
    v_mfma_f32_16x16x32_bf16 v[128:131], v[224:227], v[24:27], 0
    v_mfma_f32_16x16x32_bf16 v[132:135], v[240:243], v[24:27], 0
    v_mfma_f32_16x16x32_bf16 v[136:139], v[224:227], v[40:43], 0
    v_mfma_f32_16x16x32_bf16 v[140:143], v[240:243], v[40:43], 0
    v_mfma_f32_16x16x32_bf16 v[128:131], v[228:231], v[28:31], v[128:131]
    v_cvt_pk_bf16_f32 v112, v112, v113
    v_cvt_pk_bf16_f32 v113, v114, v115
    v_mfma_f32_16x16x32_bf16 v[132:135], v[244:247], v[28:31], v[132:135]
    v_cvt_pk_bf16_f32 v114, v116, v117
    v_cvt_pk_bf16_f32 v115, v118, v119
    v_mfma_f32_16x16x32_bf16 v[136:139], v[228:231], v[44:47], v[136:139]
    v_cvt_pk_bf16_f32 v120, v120, v121
    v_cvt_pk_bf16_f32 v121, v122, v123
    v_mfma_f32_16x16x32_bf16 v[140:143], v[244:247], v[44:47], v[140:143]
    v_cvt_pk_bf16_f32 v122, v124, v125
    v_cvt_pk_bf16_f32 v123, v126, v127
    s_cmp_lg_u32 s23, 0
    s_cbranch_scc1 M_ls_18
    buffer_store_dwordx4 v[112:115], v4, s[8:11], s48 offen offset:192
    buffer_store_dwordx4 v[120:123], v4, s[8:11], s27 offen offset:192
M_ls_18_r:
    v_mfma_f32_16x16x32_bf16 v[128:131], v[232:235], v[32:35], v[128:131]
    v_mfma_f32_16x16x32_bf16 v[132:135], v[248:251], v[32:35], v[132:135]
    v_mfma_f32_16x16x32_bf16 v[136:139], v[232:235], v[48:51], v[136:139]
    v_mfma_f32_16x16x32_bf16 v[140:143], v[248:251], v[48:51], v[140:143]
    v_mfma_f32_16x16x32_bf16 v[128:131], v[236:239], v[36:39], v[128:131]
    v_mfma_f32_16x16x32_bf16 v[132:135], v[252:255], v[36:39], v[132:135]
    v_mfma_f32_16x16x32_bf16 v[136:139], v[236:239], v[52:55], v[136:139]
    v_mfma_f32_16x16x32_bf16 v[140:143], v[252:255], v[52:55], v[140:143]
    s_nop 4
    v_cvt_pk_bf16_f32 v128, v128, v129
    v_cvt_pk_bf16_f32 v129, v130, v131
    v_cvt_pk_bf16_f32 v130, v132, v133
    v_cvt_pk_bf16_f32 v131, v134, v135
    v_cvt_pk_bf16_f32 v136, v136, v137
    v_cvt_pk_bf16_f32 v137, v138, v139
    v_cvt_pk_bf16_f32 v138, v140, v141
    v_cvt_pk_bf16_f32 v139, v142, v143
    s_cmp_lg_u32 s23, 0
    s_cbranch_scc1 M_ls_19
    buffer_store_dwordx4 v[128:131], v4, s[8:11], s48 offen offset:256
    buffer_store_dwordx4 v[136:139], v4, s[8:11], s27 offen offset:256
M_ls_19_r:
    s_add_u32 s66, s44, 5
    s_cmp_lt_u32 s66, 64
    s_cbranch_scc1 M_q_front
    s_waitcnt vmcnt(0)
    s_barrier
    s_cmp_lg_u32 s21, 0
    s_cbranch_scc1 M_q_na
    s_mov_b64 exec, 1
    v_mov_b32 v10, s22
    v_mov_b32 v11, 1
    s_cmp_lg_u32 s23, 0
    s_cbranch_scc1 M_ls_20
    buffer_store_byte v11, v10, s[8:11], s62 offen
M_ls_20_r:
    s_mov_b64 exec, -1
M_q_na:
M_q_back2:
    s_sub_u32 s27, s44, 48
    s_lshr_b32 s29, s27, 3
    s_add_u32 s29, s29, 1
    s_and_b32 s27, s27, 0xfffffff7
    s_cmp_ge_u32 s27, 5
    s_cbranch_scc1 M_q_nf1
    s_cmp_lg_u32 s21, 3
    s_cbranch_scc1 M_q_nf1
    s_lshl_b32 s27, s20, 12
    s_lshl_b32 s28, s22, 7
    s_add_u32 s27, s27, s28
    s_add_u32 s27, s27, 167915520
    s_lshl_b32 s28, s101, 2
    s_add_u32 s28, s28, s29
    v_mov_b32 v11, s28
    s_mov_b64 exec, 1
    buffer_store_dword v11, v0, s[8:11], s27 offen sc1
    s_mov_b64 exec, -1
M_q_nf1:
    s_cmp_lg_u32 s21, 0
    s_cbranch_scc1 M_ar_21
    s_mov_b64 exec, 0xff
    s_mov_b32 s30, 0
    v_lshrrev_b32 v190, 2, v0
M_ar_22:
    buffer_load_dword v191, v190, s[8:11], s62 offen sc1
    s_add_u32 s30, s30, 1
    s_cmp_ge_u32 s30, 60000
    s_cbranch_scc1 M_fail
    s_waitcnt vmcnt(0)
    v_cmp_ne_u32 vcc, 0x01010101, v191
    s_cbranch_vccz M_ar_22d
    s_branch M_ar_22
M_ar_22d:
    s_mov_b64 exec, -1
M_ar_21:
    s_barrier
    buffer_load_dwordx4 v[24:27], v5, s[8:11], s48 offen sc1
    buffer_load_dwordx4 v[56:59], v6, s[8:11], s48 offen offset:256 sc1
    s_add_u32 s27, s48, 5120
    buffer_load_dwordx4 v[28:31], v5, s[8:11], s27 offen sc1
    s_add_u32 s27, s48, 10240
    buffer_load_dwordx4 v[32:35], v5, s[8:11], s27 offen sc1
    s_add_u32 s27, s48, 15360
    buffer_load_dwordx4 v[36:39], v5, s[8:11], s27 offen sc1
    s_add_u32 s27, s48, 20480
    buffer_load_dwordx4 v[40:43], v5, s[8:11], s27 offen sc1
    buffer_load_dwordx4 v[60:63], v6, s[8:11], s27 offen offset:256 sc1
    s_add_u32 s27, s48, 25600
    buffer_load_dwordx4 v[44:47], v5, s[8:11], s27 offen sc1
    s_add_u32 s27, s48, 30720
    buffer_load_dwordx4 v[48:51], v5, s[8:11], s27 offen sc1
    s_add_u32 s27, s48, 35840
    buffer_load_dwordx4 v[52:55], v5, s[8:11], s27 offen sc1
    v_lshlrev_b32 v72, 16, v20
    v_and_b32 v73, 0xffff0000, v20
    v_lshlrev_b32 v74, 16, v21
    v_and_b32 v75, 0xffff0000, v21
    v_lshlrev_b32 v76, 16, v22
    v_and_b32 v77, 0xffff0000, v22
    v_lshlrev_b32 v78, 16, v23
    v_and_b32 v79, 0xffff0000, v23
    s_add_u32 s67, s55, s54
    s_waitcnt vmcnt(9)
    v_mfma_f32_16x16x32_bf16 v[64:67], v[16:19], v[24:27], 0
    s_waitcnt vmcnt(8)
    v_mfma_f32_16x16x32_bf16 v[68:71], v[16:19], v[56:59], 0
    s_waitcnt vmcnt(7)
    v_mfma_f32_16x16x32_bf16 v[64:67], v[16:19], v[28:31], v[64:67]
    s_waitcnt vmcnt(6)
    v_mfma_f32_16x16x32_bf16 v[64:67], v[16:19], v[32:35], v[64:67]
    s_waitcnt vmcnt(5)
    v_mfma_f32_16x16x32_bf16 v[64:67], v[16:19], v[36:39], v[64:67]
    s_waitcnt vmcnt(4)
    v_mfma_f32_16x16x32_bf16 v[64:67], v[16:19], v[40:43], v[64:67]
    s_waitcnt vmcnt(3)
    v_mfma_f32_16x16x32_bf16 v[68:71], v[16:19], v[60:63], v[68:71]
    s_waitcnt vmcnt(2)
    v_mfma_f32_16x16x32_bf16 v[64:67], v[16:19], v[44:47], v[64:67]
    s_waitcnt vmcnt(1)
    v_mfma_f32_16x16x32_bf16 v[64:67], v[16:19], v[48:51], v[64:67]
    s_waitcnt vmcnt(0)
    v_mfma_f32_16x16x32_bf16 v[64:67], v[16:19], v[52:55], v[64:67]
    s_nop 1
    v_add_f32_dpp v68, v68, v68 row_ror:8 row_mask:0xf bank_mask:0xf
    v_add_f32_dpp v69, v69, v69 row_ror:8 row_mask:0xf bank_mask:0xf
    v_add_f32_dpp v70, v70, v70 row_ror:8 row_mask:0xf bank_mask:0xf
    v_add_f32_dpp v71, v71, v71 row_ror:8 row_mask:0xf bank_mask:0xf
    v_add_f32_dpp v68, v68, v68 row_ror:4 row_mask:0xf bank_mask:0xf
    v_add_f32_dpp v69, v69, v69 row_ror:4 row_mask:0xf bank_mask:0xf
    v_add_f32_dpp v70, v70, v70 row_ror:4 row_mask:0xf bank_mask:0xf
    v_add_f32_dpp v71, v71, v71 row_ror:4 row_mask:0xf bank_mask:0xf
    v_pk_add_f32 v[72:73], v[72:73], v[64:65]
    v_pk_add_f32 v[74:75], v[74:75], v[66:67]
    v_pk_add_f32 v[76:77], v[76:77], v[68:69]
    v_pk_add_f32 v[78:79], v[78:79], v[70:71]
    v_cvt_pk_bf16_f32 v20, v72, v73
    v_cvt_pk_bf16_f32 v21, v74, v75
    v_cvt_pk_bf16_f32 v22, v76, v77
    v_cvt_pk_bf16_f32 v23, v78, v79
    v_lshlrev_b32 v72, 16, v20
    v_and_b32 v73, 0xffff0000, v20
    v_lshlrev_b32 v74, 16, v21
    v_and_b32 v75, 0xffff0000, v21
    v_lshlrev_b32 v76, 16, v22
    v_and_b32 v77, 0xffff0000, v22
    v_lshlrev_b32 v78, 16, v23
    v_and_b32 v79, 0xffff0000, v23
    v_pk_add_f32 v[92:93], v[72:73], v[74:75]
    v_pk_add_f32 v[94:95], v[76:77], v[78:79]
    v_add_f32 v92, v92, v93
    v_add_f32 v94, v94, v95
    v_mul_f32 v94, 0x3e800000, v94
    v_add_f32 v80, v92, v94
    s_nop 1
    v_add_f32_dpp v80, v80, v80 row_ror:8 row_mask:0xf bank_mask:0xf
    s_nop 1
    v_add_f32_dpp v80, v80, v80 row_ror:4 row_mask:0xf bank_mask:0xf
    s_nop 1
    v_add_f32_dpp v80, v80, v80 row_ror:2 row_mask:0xf bank_mask:0xf
    s_nop 1
    v_add_f32_dpp v80, v80, v80 row_ror:1 row_mask:0xf bank_mask:0xf
    v_mov_b32 v178, v80
    s_nop 1
    v_permlane16_swap_b32 v80, v178
    v_add_f32 v80, v80, v178
    v_mul_f32 v80, 0x3bcccccd, v80
    v_pk_add_f32 v[84:85], v[72:73], v[80:81] op_sel_hi:[1,0] neg_lo:[0,1] neg_hi:[0,1]
    v_pk_add_f32 v[86:87], v[74:75], v[80:81] op_sel_hi:[1,0] neg_lo:[0,1] neg_hi:[0,1]
    v_pk_add_f32 v[88:89], v[76:77], v[80:81] op_sel_hi:[1,0] neg_lo:[0,1] neg_hi:[0,1]
    v_pk_add_f32 v[90:91], v[78:79], v[80:81] op_sel_hi:[1,0] neg_lo:[0,1] neg_hi:[0,1]
    v_pk_mul_f32 v[84:85], v[84:85], v[84:85]
    v_pk_mul_f32 v[86:87], v[86:87], v[86:87]
    v_pk_mul_f32 v[88:89], v[88:89], v[88:89]
    v_pk_mul_f32 v[90:91], v[90:91], v[90:91]
    v_pk_add_f32 v[92:93], v[84:85], v[86:87]
    v_pk_add_f32 v[94:95], v[88:89], v[90:91]
    v_add_f32 v92, v92, v93
    v_add_f32 v94, v94, v95
    v_mul_f32 v94, 0x3e800000, v94
    v_add_f32 v81, v92, v94
    s_nop 1
    v_add_f32_dpp v81, v81, v81 row_ror:8 row_mask:0xf bank_mask:0xf
    s_nop 1
    v_add_f32_dpp v81, v81, v81 row_ror:4 row_mask:0xf bank_mask:0xf
    s_nop 1
    v_add_f32_dpp v81, v81, v81 row_ror:2 row_mask:0xf bank_mask:0xf
    s_nop 1
    v_add_f32_dpp v81, v81, v81 row_ror:1 row_mask:0xf bank_mask:0xf
    v_mov_b32 v178, v81
    s_nop 1
    v_permlane16_swap_b32 v81, v178
    v_add_f32 v81, v81, v178
    s_lshl_b32 s27, s21, 3
    s_add_u32 s27, s27, 98304
    v_mov_b32 v10, s27
    v_mov_b32 v11, 98304
    ds_write_b64 v10, v[80:81]
    s_waitcnt lgkmcnt(0)
    s_barrier
    ds_read_b128 v[84:87], v11 offset:0
    ds_read_b128 v[88:91], v11 offset:16
    s_waitcnt lgkmcnt(1)
    v_pk_add_f32 v[80:81], v[84:85], v[86:87]
    s_waitcnt lgkmcnt(0)
    v_pk_add_f32 v[92:93], v[88:89], v[90:91]
    v_pk_add_f32 v[80:81], v[80:81], v[92:93]
    v_mul_f32 v80, 0x3e800000, v80
    v_sub_f32 v84, v84, v80
    v_sub_f32 v86, v86, v80
    v_sub_f32 v88, v88, v80
    v_sub_f32 v90, v90, v80
    v_mul_f32 v85, 0x43200000, v84
    v_mul_f32 v87, 0x43200000, v86
    v_mul_f32 v89, 0x43200000, v88
    v_mul_f32 v91, 0x43200000, v90
    v_fmac_f32 v81, v84, v85
    v_fmac_f32 v81, v86, v87
    v_fmac_f32 v81, v88, v89
    v_fmac_f32 v81, v90, v91
    v_mov_b32 v82, 0x3727c5ac
    v_fmac_f32 v82, 0x3acccccd, v81
    v_rsq_f32 v82, v82
    v_pk_add_f32 v[72:73], v[72:73], v[80:81] op_sel_hi:[1,0] neg_lo:[0,1] neg_hi:[0,1]
    v_pk_add_f32 v[74:75], v[74:75], v[80:81] op_sel_hi:[1,0] neg_lo:[0,1] neg_hi:[0,1]
    v_pk_add_f32 v[76:77], v[76:77], v[80:81] op_sel_hi:[1,0] neg_lo:[0,1] neg_hi:[0,1]
    v_pk_add_f32 v[78:79], v[78:79], v[80:81] op_sel_hi:[1,0] neg_lo:[0,1] neg_hi:[0,1]
    v_pk_mul_f32 v[72:73], v[72:73], v[82:83] op_sel_hi:[1,0]
    v_pk_mul_f32 v[74:75], v[74:75], v[82:83] op_sel_hi:[1,0]
    v_pk_mul_f32 v[76:77], v[76:77], v[82:83] op_sel_hi:[1,0]
    v_pk_mul_f32 v[78:79], v[78:79], v[82:83] op_sel_hi:[1,0]
    v_cvt_pk_f16_f32 v72, v72, v73
    v_cvt_pk_f16_f32 v73, v74, v75
    v_cvt_pk_f16_f32 v74, v76, v77
    v_cvt_pk_f16_f32 v75, v78, v79
    s_cmp_lg_u32 s23, 0
    s_cbranch_scc1 M_ls_23
    s_mov_b32 exec_hi, 0
    buffer_store_dwordx2 v[72:73], v12, s[8:11], s63 offen
    s_mov_b32 exec_lo, 0x000f000f
    buffer_store_dwordx2 v[74:75], v12, s[8:11], s64 offen
    s_mov_b64 exec, -1
M_ls_23_r:
    s_add_u32 s62, s51, 20480
    s_waitcnt vmcnt(0)
    s_barrier
    s_cmp_lg_u32 s21, 0
    s_cbranch_scc1 M_q_nb
    s_mov_b64 exec, 1
    v_mov_b32 v10, s22
    v_mov_b32 v11, 1
    s_cmp_lg_u32 s23, 0
    s_cbranch_scc1 M_ls_24
    buffer_store_byte v11, v10, s[8:11], s62 offen
M_ls_24_r:
    s_mov_b64 exec, -1
M_q_nb:
    s_cmp_ge_u32 s22, 20
    s_cbranch_scc1 M_q_tab
    s_cmp_lg_u32 s21, 0
    s_cbranch_scc1 M_ar_25
    s_mov_b64 exec, 0xff
    s_mov_b32 s30, 0
    v_lshrrev_b32 v190, 2, v0
M_ar_26:
    buffer_load_dword v191, v190, s[8:11], s62 offen sc1
    s_add_u32 s30, s30, 1
    s_cmp_ge_u32 s30, 60000
    s_cbranch_scc1 M_fail
    s_waitcnt vmcnt(0)
    v_cmp_ne_u32 vcc, 0x01010101, v191
    s_cbranch_vccz M_ar_26d
    s_branch M_ar_26
M_ar_26d:
    s_mov_b64 exec, -1
M_ar_25:
    s_barrier
    s_cmp_ge_u32 s21, 2
    s_cbranch_scc1 M_q_nd
    s_mul_i32 s27, s21, 20480
    s_add_u32 s27, s27, s63
    buffer_load_dwordx4 v[24:27], v0, s[8:11], s27 offen offset:0 sc1
    buffer_load_dwordx4 v[28:31], v0, s[8:11], s27 offen offset:1024 sc1
    buffer_load_dwordx4 v[32:35], v0, s[8:11], s27 offen offset:2048 sc1
    buffer_load_dwordx4 v[36:39], v0, s[8:11], s27 offen offset:3072 sc1
    s_add_u32 s27, s27, 4096
    buffer_load_dwordx4 v[40:43], v0, s[8:11], s27 offen offset:0 sc1
    buffer_load_dwordx4 v[44:47], v0, s[8:11], s27 offen offset:1024 sc1
    buffer_load_dwordx4 v[48:51], v0, s[8:11], s27 offen offset:2048 sc1
    buffer_load_dwordx4 v[52:55], v0, s[8:11], s27 offen offset:3072 sc1
    s_add_u32 s27, s27, 4096
    buffer_load_dwordx4 v[56:59], v0, s[8:11], s27 offen offset:0 sc1
    buffer_load_dwordx4 v[60:63], v0, s[8:11], s27 offen offset:1024 sc1
    buffer_load_dwordx4 v[64:67], v0, s[8:11], s27 offen offset:2048 sc1
    buffer_load_dwordx4 v[68:71], v0, s[8:11], s27 offen offset:3072 sc1
    s_add_u32 s27, s27, 4096
    buffer_load_dwordx4 v[72:75], v0, s[8:11], s27 offen offset:0 sc1
    buffer_load_dwordx4 v[76:79], v0, s[8:11], s27 offen offset:1024 sc1
    buffer_load_dwordx4 v[80:83], v0, s[8:11], s27 offen offset:2048 sc1
    buffer_load_dwordx4 v[84:87], v0, s[8:11], s27 offen offset:3072 sc1
    s_add_u32 s27, s27, 4096
    buffer_load_dwordx4 v[88:91], v0, s[8:11], s27 offen offset:0 sc1
    buffer_load_dwordx4 v[92:95], v0, s[8:11], s27 offen offset:1024 sc1
    buffer_load_dwordx4 v[96:99], v0, s[8:11], s27 offen offset:2048 sc1
    buffer_load_dwordx4 v[100:103], v0, s[8:11], s27 offen offset:3072 sc1
    s_add_u32 s27, s27, 4096
    ds_read_b128 v[112:115], v14 offset:0
    ds_read_b128 v[116:119], v14 offset:20480
    ds_read_b128 v[120:123], v14 offset:1024
    ds_read_b128 v[124:127], v14 offset:21504
    ds_read_b128 v[128:131], v14 offset:2048
    ds_read_b128 v[132:135], v14 offset:22528
    ds_read_b128 v[136:139], v14 offset:3072
    s_lshl_b32 s27, s44, 7
    s_mul_i32 s68, s101, 6291456
    s_add_u32 s68, s68, s27
    s_add_u32 s68, s68, 176160768
    s_waitcnt vmcnt(19) lgkmcnt(6)
    v_mfma_f32_16x16x32_f16 v[104:107], v[24:27], v[112:115], 0
    ds_read_b128 v[140:143], v14 offset:23552
    s_waitcnt lgkmcnt(6)
    v_mfma_f32_16x16x32_f16 v[108:111], v[24:27], v[116:119], 0
    ds_read_b128 v[112:115], v14 offset:4096
    s_waitcnt vmcnt(18) lgkmcnt(6)
    v_mfma_f32_16x16x32_f16 v[104:107], v[28:31], v[120:123], v[104:107]
    ds_read_b128 v[116:119], v14 offset:24576
    s_waitcnt lgkmcnt(6)
    v_mfma_f32_16x16x32_f16 v[108:111], v[28:31], v[124:127], v[108:111]
    ds_read_b128 v[120:123], v14 offset:5120
    s_waitcnt vmcnt(17) lgkmcnt(6)
    v_mfma_f32_16x16x32_f16 v[104:107], v[32:35], v[128:131], v[104:107]
    ds_read_b128 v[124:127], v14 offset:25600
    s_waitcnt lgkmcnt(6)
    v_mfma_f32_16x16x32_f16 v[108:111], v[32:35], v[132:135], v[108:111]
    ds_read_b128 v[128:131], v14 offset:6144
    s_waitcnt vmcnt(16) lgkmcnt(6)
    v_mfma_f32_16x16x32_f16 v[104:107], v[36:39], v[136:139], v[104:107]
    ds_read_b128 v[132:135], v14 offset:26624
    s_waitcnt lgkmcnt(6)
    v_mfma_f32_16x16x32_f16 v[108:111], v[36:39], v[140:143], v[108:111]
    ds_read_b128 v[136:139], v14 offset:7168
    s_waitcnt vmcnt(15) lgkmcnt(6)
    v_mfma_f32_16x16x32_f16 v[104:107], v[40:43], v[112:115], v[104:107]
    ds_read_b128 v[140:143], v14 offset:27648
    s_waitcnt lgkmcnt(6)
    v_mfma_f32_16x16x32_f16 v[108:111], v[40:43], v[116:119], v[108:111]
    ds_read_b128 v[112:115], v14 offset:8192
    s_waitcnt vmcnt(14) lgkmcnt(6)
    v_mfma_f32_16x16x32_f16 v[104:107], v[44:47], v[120:123], v[104:107]
    ds_read_b128 v[116:119], v14 offset:28672
    s_waitcnt lgkmcnt(6)
    v_mfma_f32_16x16x32_f16 v[108:111], v[44:47], v[124:127], v[108:111]
    ds_read_b128 v[120:123], v14 offset:9216
    s_waitcnt vmcnt(13) lgkmcnt(6)
    v_mfma_f32_16x16x32_f16 v[104:107], v[48:51], v[128:131], v[104:107]
    ds_read_b128 v[124:127], v14 offset:29696
    s_waitcnt lgkmcnt(6)
    v_mfma_f32_16x16x32_f16 v[108:111], v[48:51], v[132:135], v[108:111]
    ds_read_b128 v[128:131], v14 offset:10240
    s_waitcnt vmcnt(12) lgkmcnt(6)
    v_mfma_f32_16x16x32_f16 v[104:107], v[52:55], v[136:139], v[104:107]
    ds_read_b128 v[132:135], v14 offset:30720
    s_waitcnt lgkmcnt(6)
    v_mfma_f32_16x16x32_f16 v[108:111], v[52:55], v[140:143], v[108:111]
    ds_read_b128 v[136:139], v14 offset:11264
    s_waitcnt vmcnt(11) lgkmcnt(6)
    v_mfma_f32_16x16x32_f16 v[104:107], v[56:59], v[112:115], v[104:107]
    ds_read_b128 v[140:143], v14 offset:31744
    s_waitcnt lgkmcnt(6)
    v_mfma_f32_16x16x32_f16 v[108:111], v[56:59], v[116:119], v[108:111]
    ds_read_b128 v[112:115], v14 offset:12288
    s_waitcnt vmcnt(10) lgkmcnt(6)
    v_mfma_f32_16x16x32_f16 v[104:107], v[60:63], v[120:123], v[104:107]
    ds_read_b128 v[116:119], v14 offset:32768
    s_waitcnt lgkmcnt(6)
    v_mfma_f32_16x16x32_f16 v[108:111], v[60:63], v[124:127], v[108:111]
    ds_read_b128 v[120:123], v14 offset:13312
    s_waitcnt vmcnt(9) lgkmcnt(6)
    v_mfma_f32_16x16x32_f16 v[104:107], v[64:67], v[128:131], v[104:107]
    ds_read_b128 v[124:127], v14 offset:33792
    s_waitcnt lgkmcnt(6)
    v_mfma_f32_16x16x32_f16 v[108:111], v[64:67], v[132:135], v[108:111]
    ds_read_b128 v[128:131], v14 offset:14336
    s_waitcnt vmcnt(8) lgkmcnt(6)
    v_mfma_f32_16x16x32_f16 v[104:107], v[68:71], v[136:139], v[104:107]
    ds_read_b128 v[132:135], v14 offset:34816
    s_waitcnt lgkmcnt(6)
    v_mfma_f32_16x16x32_f16 v[108:111], v[68:71], v[140:143], v[108:111]
    ds_read_b128 v[136:139], v14 offset:15360
    s_waitcnt vmcnt(7) lgkmcnt(6)
    v_mfma_f32_16x16x32_f16 v[104:107], v[72:75], v[112:115], v[104:107]
    ds_read_b128 v[140:143], v14 offset:35840
    s_waitcnt lgkmcnt(6)
    v_mfma_f32_16x16x32_f16 v[108:111], v[72:75], v[116:119], v[108:111]
    ds_read_b128 v[112:115], v14 offset:16384
    s_waitcnt vmcnt(6) lgkmcnt(6)
    v_mfma_f32_16x16x32_f16 v[104:107], v[76:79], v[120:123], v[104:107]
    ds_read_b128 v[116:119], v14 offset:36864
    s_waitcnt lgkmcnt(6)
    v_mfma_f32_16x16x32_f16 v[108:111], v[76:79], v[124:127], v[108:111]
    ds_read_b128 v[120:123], v14 offset:17408
    s_waitcnt vmcnt(5) lgkmcnt(6)
    v_mfma_f32_16x16x32_f16 v[104:107], v[80:83], v[128:131], v[104:107]
    ds_read_b128 v[124:127], v14 offset:37888
    s_waitcnt lgkmcnt(6)
    v_mfma_f32_16x16x32_f16 v[108:111], v[80:83], v[132:135], v[108:111]
    ds_read_b128 v[128:131], v14 offset:18432
    s_waitcnt vmcnt(4) lgkmcnt(6)
    v_mfma_f32_16x16x32_f16 v[104:107], v[84:87], v[136:139], v[104:107]
    ds_read_b128 v[132:135], v14 offset:38912
    s_waitcnt lgkmcnt(6)
    v_mfma_f32_16x16x32_f16 v[108:111], v[84:87], v[140:143], v[108:111]
    ds_read_b128 v[136:139], v14 offset:19456
    s_waitcnt vmcnt(3) lgkmcnt(6)
    v_mfma_f32_16x16x32_f16 v[104:107], v[88:91], v[112:115], v[104:107]
    ds_read_b128 v[140:143], v14 offset:39936
    s_waitcnt lgkmcnt(6)
    v_mfma_f32_16x16x32_f16 v[108:111], v[88:91], v[116:119], v[108:111]
    s_waitcnt vmcnt(2) lgkmcnt(5)
    v_mfma_f32_16x16x32_f16 v[104:107], v[92:95], v[120:123], v[104:107]
    s_waitcnt lgkmcnt(4)
    v_mfma_f32_16x16x32_f16 v[108:111], v[92:95], v[124:127], v[108:111]
    s_waitcnt vmcnt(1) lgkmcnt(3)
    v_mfma_f32_16x16x32_f16 v[104:107], v[96:99], v[128:131], v[104:107]
    s_waitcnt lgkmcnt(2)
    v_mfma_f32_16x16x32_f16 v[108:111], v[96:99], v[132:135], v[108:111]
    s_waitcnt vmcnt(0) lgkmcnt(1)
    v_mfma_f32_16x16x32_f16 v[104:107], v[100:103], v[136:139], v[104:107]
    s_waitcnt lgkmcnt(0)
    v_mfma_f32_16x16x32_f16 v[108:111], v[100:103], v[140:143], v[108:111]
    s_nop 7
M_q_nd:
    s_sub_u32 s27, s44, 54
    s_cmp_ge_u32 s27, 5
    s_cbranch_scc1 M_q_nt
    s_sub_u32 s27, 40960, s45
    s_mul_i32 s29, s21, 10240
    s_add_u32 s29, s29, s27
    s_mul_i32 s28, s88, 81920
    s_add_u32 s28, s28, s29
    s_add_u32 s28, s28, 147849216
    s_mov_b32 m0, s29
    s_nop 0
    buffer_load_dwordx4 v0, s[8:11], s28 offen offset:0 sc1 lds
    buffer_load_dwordx4 v0, s[8:11], s28 offen offset:1024 sc1 lds
    buffer_load_dwordx4 v0, s[8:11], s28 offen offset:2048 sc1 lds
    buffer_load_dwordx4 v0, s[8:11], s28 offen offset:3072 sc1 lds
    s_add_u32 s29, s29, 4096
    s_add_u32 s28, s28, 4096
    s_mov_b32 m0, s29
    s_nop 0
    buffer_load_dwordx4 v0, s[8:11], s28 offen offset:0 sc1 lds
    buffer_load_dwordx4 v0, s[8:11], s28 offen offset:1024 sc1 lds
    buffer_load_dwordx4 v0, s[8:11], s28 offen offset:2048 sc1 lds
    buffer_load_dwordx4 v0, s[8:11], s28 offen offset:3072 sc1 lds
    s_add_u32 s29, s29, 4096
    s_add_u32 s28, s28, 4096
    s_mov_b32 m0, s29
    s_nop 0
    buffer_load_dwordx4 v0, s[8:11], s28 offen offset:0 sc1 lds
    buffer_load_dwordx4 v0, s[8:11], s28 offen offset:1024 sc1 lds
M_q_nt:
    s_add_u32 s48, s48, s49
    s_sub_u32 s49, 0, s49
    s_add_u32 s51, s51, 128
    s_add_u32 s44, s44, 5
    s_cmp_lt_u32 s44, 64
    s_cbranch_scc1 M_q_top
    s_cmp_ge_u32 s21, 2
    s_cbranch_scc1 M_q_e1
    s_add_u32 s28, s68, 131072
    buffer_store_dwordx4 v[104:107], v13, s[8:11], s68 offen sc1
    buffer_store_dwordx4 v[108:111], v13, s[8:11], s28 offen sc1
    s_mov_b32 exec_hi, 0
    buffer_store_dwordx2 v[20:21], v7, s[8:11], s67 offen sc1
    s_mov_b32 exec_lo, 0x000f000f
    buffer_store_dwordx2 v[22:23], v7, s[8:11], s67 offen offset:256 sc1
    s_mov_b64 exec, -1
    s_waitcnt vmcnt(2)
    s_barrier
    s_cmp_lg_u32 s21, 0
    s_cbranch_scc1 M_bphase
    s_lshl_b32 s27, s20, 12
    s_lshl_b32 s28, s22, 7
    s_add_u32 s27, s27, s28
    s_add_u32 s27, s27, 167915520
    s_lshl_b32 s28, s101, 2
    s_add_u32 s28, s28, 3
    v_mov_b32 v11, s28
    s_mov_b64 exec, 1
    buffer_store_dword v11, v0, s[8:11], s27 offen sc1
    s_mov_b64 exec, -1
    s_branch M_bphase
M_q_tb:
    s_cmp_ge_u32 s44, 59
    s_cbranch_scc1 M_q_nx
    s_cmp_lg_u32 s101, 0
    s_cbranch_scc1 M_q_tp2
    v_lshlrev_b32 v190, 3, v0
    s_mov_b32 exec_hi, 0x0fffffff
    s_mov_b32 s28, 167948288
    s_mov_b32 s30, 0
M_q_tpl:
    buffer_load_dword v191, v190, s[8:11], s28 offen sc1
    s_add_u32 s30, s30, 1
    s_cmp_ge_u32 s30, 240000
    s_cbranch_scc1 M_fail
    s_waitcnt vmcnt(0)
    v_cmp_ne_u32 vcc, 0x01010101, v191
    s_cbranch_vccz M_q_tpd
    s_sleep 8
    s_branch M_q_tpl
M_q_tpd:
    s_mov_b64 exec, -1
M_q_tp2:
    s_sub_u32 s27, 40960, s45
    s_mul_i32 s29, s21, 10240
    s_add_u32 s29, s29, s27
    s_mul_i32 s28, s88, 81920
    s_add_u32 s28, s28, s29
    s_add_u32 s28, s28, 147849216
    s_mov_b32 m0, s29
    s_nop 0
    buffer_load_dwordx4 v0, s[8:11], s28 offen offset:0 sc1 lds
    buffer_load_dwordx4 v0, s[8:11], s28 offen offset:1024 sc1 lds
    buffer_load_dwordx4 v0, s[8:11], s28 offen offset:2048 sc1 lds
    buffer_load_dwordx4 v0, s[8:11], s28 offen offset:3072 sc1 lds
    s_add_u32 s29, s29, 4096
    s_add_u32 s28, s28, 4096
    s_mov_b32 m0, s29
    s_nop 0
    buffer_load_dwordx4 v0, s[8:11], s28 offen offset:0 sc1 lds
    buffer_load_dwordx4 v0, s[8:11], s28 offen offset:1024 sc1 lds
    buffer_load_dwordx4 v0, s[8:11], s28 offen offset:2048 sc1 lds
    buffer_load_dwordx4 v0, s[8:11], s28 offen offset:3072 sc1 lds
    s_add_u32 s29, s29, 4096
    s_add_u32 s28, s28, 4096
    s_mov_b32 m0, s29
    s_nop 0
    buffer_load_dwordx4 v0, s[8:11], s28 offen offset:0 sc1 lds
    buffer_load_dwordx4 v0, s[8:11], s28 offen offset:1024 sc1 lds
    s_branch M_q_nx
M_q_tab:
    s_cmp_ge_u32 s44, 59
    s_cbranch_scc1 M_q_nd
    s_cmp_lg_u32 s21, 0
    s_cbranch_scc1 M_ar_27
    s_mov_b64 exec, 0xff
    s_mov_b32 s30, 0
    v_lshrrev_b32 v190, 2, v0
M_ar_28:
    buffer_load_dword v191, v190, s[8:11], s62 offen sc1
    s_add_u32 s30, s30, 1
    s_cmp_ge_u32 s30, 60000
    s_cbranch_scc1 M_fail
    s_waitcnt vmcnt(0)
    v_cmp_ne_u32 vcc, 0x01010101, v191
    s_cbranch_vccz M_ar_28d
    s_sleep 1
    s_branch M_ar_28
M_ar_28d:
    s_mov_b64 exec, -1
M_ar_27:
    s_barrier
    s_cmp_ge_u32 s94, 2400
    s_cbranch_scc1 M_q_nd
    v_mov_b32 v32, v0
    v_mov_b32 v33, v1
    v_mov_b32 v34, v2
    v_mov_b32 v35, v3
    v_mov_b32 v36, v4
    v_mov_b32 v37, v5
    v_mov_b32 v38, v6
    v_mov_b32 v39, v7
    v_mov_b32 v40, v8
    v_mov_b32 v41, v9
    v_mov_b32 v42, v10
    v_mov_b32 v43, v11
    v_mov_b32 v44, v12
    v_mov_b32 v45, v13
    v_mov_b32 v46, v14
    v_mov_b32 v47, v15
    v_mov_b32 v48, v16
    v_mov_b32 v49, v17
    v_mov_b32 v50, v18
    v_mov_b32 v51, v19
    v_mov_b32 v52, v20
    v_mov_b32 v53, v21
    v_mov_b32 v54, v22
    v_mov_b32 v55, v23
    v_lshrrev_b32 v1, 4, v0
    v_lshrrev_b32 v3, 8, v0
    v_and_b32 v4, 15, v1
    v_mov_b32 v5, v0
    s_cmp_ge_u32 s94, 800
    s_cbranch_scc1 M_q_wt
    s_mov_b32 s36, s94
    s_mul_hi_u32 s37, s36, 0xccccccd
    s_mul_i32 s38, s37, 20
    s_sub_u32 s38, s36, s38
    s_lshl_b32 s37, s37, 4
    s_lshl_b32 s38, s38, 5
    v_lshlrev_b32 v7, 3, v3
    v_add_u32 v7, s38, v7
    s_mov_b32 s39, 0x666667
    s_movk_i32 s40, 640
    s_and_b32 s41, s37, 16
    s_sub_u32 s37, s37, s41
    s_lshr_b32 s41, s41, 2
    s_add_u32 s37, s37, s41
    v_and_b32 v6, 12, v4
    v_add_u32 v6, v6, v4
    v_add_u32 v6, s37, v6
    v_lshrrev_b32 v8, 1, v7
    v_cmp_eq_u32 vcc, 0, v7
    v_add_u32 v11, 0, v8
    v_mov_b32 v13, 0x00000000
    v_mov_b32 v14, 0x35cccccd
    v_mov_b32 v15, 0x354ccccd
    v_cndmask_b32 v14, v14, v15, vcc
    v_mul_u32_u24 v11, v11, v6
    v_mul_hi_u32 v12, v11, s39
    v_mul_lo_u32 v12, v12, s40
    v_sub_u32 v11, v11, v12
    v_cvt_f32_u32 v11, v11
    v_fmac_f32 v13, 0x3acccccd, v11
    v_cos_f32 v13, v13
    s_nop 0
    v_mul_f32 v16, v13, v14
    v_add_u32 v11, 0, v8
    v_mov_b32 v13, 0x3e800000
    v_mov_b32 v14, 0x35cccccd
    v_mov_b32 v15, 0x354ccccd
    v_cndmask_b32 v14, v14, v15, vcc
    v_mov_b32 v15, 320
    v_cndmask_b32 v11, v11, v15, vcc
    v_mov_b32 v15, 0
    v_cndmask_b32 v13, v13, v15, vcc
    v_mul_u32_u24 v11, v11, v6
    v_mul_hi_u32 v12, v11, s39
    v_mul_lo_u32 v12, v12, s40
    v_sub_u32 v11, v11, v12
    v_cvt_f32_u32 v11, v11
    v_fmac_f32 v13, 0x3acccccd, v11
    v_cos_f32 v13, v13
    s_nop 0
    v_mul_f32 v17, v13, v14
    v_add_u32 v11, 1, v8
    v_mov_b32 v13, 0x00000000
    v_mov_b32 v14, 0x35cccccd
    v_mul_u32_u24 v11, v11, v6
    v_mul_hi_u32 v12, v11, s39
    v_mul_lo_u32 v12, v12, s40
    v_sub_u32 v11, v11, v12
    v_cvt_f32_u32 v11, v11
    v_fmac_f32 v13, 0x3acccccd, v11
    v_cos_f32 v13, v13
    s_nop 0
    v_mul_f32 v18, v13, v14
    v_add_u32 v11, 1, v8
    v_mov_b32 v13, 0x3e800000
    v_mov_b32 v14, 0x35cccccd
    v_mul_u32_u24 v11, v11, v6
    v_mul_hi_u32 v12, v11, s39
    v_mul_lo_u32 v12, v12, s40
    v_sub_u32 v11, v11, v12
    v_cvt_f32_u32 v11, v11
    v_fmac_f32 v13, 0x3acccccd, v11
    v_cos_f32 v13, v13
    s_nop 0
    v_mul_f32 v19, v13, v14
    v_add_u32 v11, 2, v8
    v_mov_b32 v13, 0x00000000
    v_mov_b32 v14, 0x35cccccd
    v_mul_u32_u24 v11, v11, v6
    v_mul_hi_u32 v12, v11, s39
    v_mul_lo_u32 v12, v12, s40
    v_sub_u32 v11, v11, v12
    v_cvt_f32_u32 v11, v11
    v_fmac_f32 v13, 0x3acccccd, v11
    v_cos_f32 v13, v13
    s_nop 0
    v_mul_f32 v20, v13, v14
    v_add_u32 v11, 2, v8
    v_mov_b32 v13, 0x3e800000
    v_mov_b32 v14, 0x35cccccd
    v_mul_u32_u24 v11, v11, v6
    v_mul_hi_u32 v12, v11, s39
    v_mul_lo_u32 v12, v12, s40
    v_sub_u32 v11, v11, v12
    v_cvt_f32_u32 v11, v11
    v_fmac_f32 v13, 0x3acccccd, v11
    v_cos_f32 v13, v13
    s_nop 0
    v_mul_f32 v21, v13, v14
    v_add_u32 v11, 3, v8
    v_mov_b32 v13, 0x00000000
    v_mov_b32 v14, 0x35cccccd
    v_mul_u32_u24 v11, v11, v6
    v_mul_hi_u32 v12, v11, s39
    v_mul_lo_u32 v12, v12, s40
    v_sub_u32 v11, v11, v12
    v_cvt_f32_u32 v11, v11
    v_fmac_f32 v13, 0x3acccccd, v11
    v_cos_f32 v13, v13
    s_nop 0
    v_mul_f32 v22, v13, v14
    v_add_u32 v11, 3, v8
    v_mov_b32 v13, 0x3e800000
    v_mov_b32 v14, 0x35cccccd
    v_mul_u32_u24 v11, v11, v6
    v_mul_hi_u32 v12, v11, s39
    v_mul_lo_u32 v12, v12, s40
    v_sub_u32 v11, v11, v12
    v_cvt_f32_u32 v11, v11
    v_fmac_f32 v13, 0x3acccccd, v11
    v_cos_f32 v13, v13
    s_nop 0
    v_mul_f32 v23, v13, v14
    v_cvt_pk_bf16_f32 v24, v16, v17
    v_cvt_pk_bf16_f32 v25, v18, v19
    v_cvt_pk_bf16_f32 v26, v20, v21
    v_cvt_pk_bf16_f32 v27, v22, v23
    s_lshl_b32 s37, s36, 10
    s_add_u32 s37, s37, 147849216
    buffer_store_dwordx4 v[24:27], v5, s[8:11], s37 offen sc1
    s_branch M_q_te
M_q_wt:
    s_sub_u32 s37, s94, 800
    s_lshr_b32 s36, s37, 8
    s_and_b32 s37, s37, 255
    s_lshl_b32 s38, s36, 6
    v_add_u32 v6, s38, v1
    s_lshr_b32 s38, s37, 5
    s_bfe_u32 s39, s37, 0x30002
    s_lshl_b32 s39, s39, 3
    s_add_u32 s38, s38, s39
    s_and_b32 s39, s37, 3
    s_lshl_b32 s39, s39, 7
    s_add_u32 s38, s38, s39
    s_mul_i32 s38, s38, 642
    v_lshlrev_b32 v7, 1, v6
    v_lshrrev_b32 v2, 1, v6
    v_lshlrev_b32 v2, 14, v2
    v_and_b32 v24, 1, v6
    v_lshl_add_u32 v2, v24, 4, v2
    v_cmp_gt_u32 vcc, 321, v6
    s_and_saveexec_b64 s[90:91], vcc
    s_cbranch_execz M_q_ws
    s_add_u32 s39, s38, 0
    buffer_load_ushort v8, v7, s[72:75], s39 offen
    buffer_load_ushort v16, v7, s[76:79], s39 offen
    s_add_u32 s39, s38, 328704
    buffer_load_ushort v9, v7, s[72:75], s39 offen
    buffer_load_ushort v17, v7, s[76:79], s39 offen
    s_add_u32 s39, s38, 657408
    buffer_load_ushort v10, v7, s[72:75], s39 offen
    buffer_load_ushort v18, v7, s[76:79], s39 offen
    s_add_u32 s39, s38, 986112
    buffer_load_ushort v11, v7, s[72:75], s39 offen
    buffer_load_ushort v19, v7, s[76:79], s39 offen
    s_add_u32 s39, s38, 41088
    buffer_load_ushort v12, v7, s[72:75], s39 offen
    buffer_load_ushort v20, v7, s[76:79], s39 offen
    s_add_u32 s39, s38, 369792
    buffer_load_ushort v13, v7, s[72:75], s39 offen
    buffer_load_ushort v21, v7, s[76:79], s39 offen
    s_add_u32 s39, s38, 698496
    buffer_load_ushort v14, v7, s[72:75], s39 offen
    buffer_load_ushort v22, v7, s[76:79], s39 offen
    s_add_u32 s39, s38, 1027200
    buffer_load_ushort v15, v7, s[72:75], s39 offen
    buffer_load_ushort v23, v7, s[76:79], s39 offen
    s_lshl_b32 s39, s37, 6
    s_add_u32 s39, s39, 148897792
    s_waitcnt vmcnt(0)
    v_lshl_or_b32 v8, v16, 16, v8
    v_lshl_or_b32 v9, v17, 16, v9
    v_lshl_or_b32 v10, v18, 16, v10
    v_lshl_or_b32 v11, v19, 16, v11
    v_lshl_or_b32 v12, v20, 16, v12
    v_lshl_or_b32 v13, v21, 16, v13
    v_lshl_or_b32 v14, v22, 16, v14
    v_lshl_or_b32 v15, v23, 16, v15
    buffer_store_dwordx4 v[8:11], v2, s[8:11], s39 offen sc1
    buffer_store_dwordx4 v[12:15], v2, s[8:11], s39 offen offset:32 sc1
M_q_ws:
    s_mov_b64 exec, s[90:91]
M_q_te:
    s_add_u32 s94, s94, 240
    s_mov_b32 s40, 0x3e0293ee
    s_mov_b32 s41, s40
    s_cmp_lt_u32 s94, 2400
    s_cbranch_scc1 M_q_tr
    s_waitcnt vmcnt(0)
    v_mov_b32 v1, s21
    v_mov_b32 v2, 1
    s_mov_b64 exec, 1
    buffer_store_byte v2, v1, s[8:11], s95 offen sc1
    s_mov_b64 exec, -1
M_q_tr:
    s_nop 1
    v_mov_b32 v1, v33
    v_mov_b32 v2, v34
    v_mov_b32 v3, v35
    v_mov_b32 v4, v36
    v_mov_b32 v5, v37
    v_mov_b32 v6, v38
    v_mov_b32 v7, v39
    v_mov_b32 v8, v40
    v_mov_b32 v9, v41
    v_mov_b32 v10, v42
    v_mov_b32 v11, v43
    v_mov_b32 v12, v44
    v_mov_b32 v13, v45
    v_mov_b32 v14, v46
    v_mov_b32 v15, v47
    v_mov_b32 v16, v48
    v_mov_b32 v17, v49
    v_mov_b32 v18, v50
    v_mov_b32 v19, v51
    v_mov_b32 v20, v52
    v_mov_b32 v21, v53
    v_mov_b32 v22, v54
    v_mov_b32 v23, v55
    s_branch M_q_nd
M_q_e1:
    s_barrier
    s_add_u32 s28, s68, 131072
    buffer_store_dwordx4 v[104:107], v13, s[8:11], s68 offen sc1
    buffer_store_dwordx4 v[108:111], v13, s[8:11], s28 offen sc1
    s_mov_b32 exec_hi, 0
    buffer_store_dwordx2 v[20:21], v7, s[8:11], s67 offen sc1
    s_mov_b32 exec_lo, 0x000f000f
    buffer_store_dwordx2 v[22:23], v7, s[8:11], s67 offen offset:256 sc1
    s_mov_b64 exec, -1
M_bphase:
    s_mov_b32 s16, s98
    s_and_b32 s17, s99, 0xffff
    s_cmp_eq_u32 s101, 1
    s_cbranch_scc1 M_osrd
    s_add_u32 s16, s8, 138412032
    s_addc_u32 s17, s9, 0
M_osrd:
    s_cmp_ge_u32 s82, 1
    s_cbranch_scc1 M_tabok2
    s_cmp_lg_u32 s101, 0
    s_cbranch_scc1 M_b_tp2
    v_lshlrev_b32 v190, 3, v0
    s_mov_b32 exec_hi, 0x0fffffff
    s_mov_b32 s28, 167948288
    s_mov_b32 s30, 0
M_b_tpl:
    buffer_load_dword v191, v190, s[8:11], s28 offen sc1
    s_add_u32 s30, s30, 1
    s_cmp_ge_u32 s30, 240000
    s_cbranch_scc1 M_fail
    s_waitcnt vmcnt(0)
    v_cmp_ne_u32 vcc, 0x01010101, v191
    s_cbranch_vccz M_b_tpd
    s_sleep 8
    s_branch M_b_tpl
M_b_tpd:
    s_mov_b64 exec, -1
M_b_tp2:
    s_mul_i32 s29, s83, 10240
    s_add_u32 s29, s29, 0
    s_mul_i32 s28, s88, 81920
    s_add_u32 s28, s28, s29
    s_add_u32 s28, s28, 147849216
    s_mov_b32 m0, s29
    s_nop 0
    buffer_load_dwordx4 v0, s[8:11], s28 offen offset:0 sc1 lds
    buffer_load_dwordx4 v0, s[8:11], s28 offen offset:1024 sc1 lds
    buffer_load_dwordx4 v0, s[8:11], s28 offen offset:2048 sc1 lds
    buffer_load_dwordx4 v0, s[8:11], s28 offen offset:3072 sc1 lds
    s_add_u32 s29, s29, 4096
    s_add_u32 s28, s28, 4096
    s_mov_b32 m0, s29
    s_nop 0
    buffer_load_dwordx4 v0, s[8:11], s28 offen offset:0 sc1 lds
    buffer_load_dwordx4 v0, s[8:11], s28 offen offset:1024 sc1 lds
    buffer_load_dwordx4 v0, s[8:11], s28 offen offset:2048 sc1 lds
    buffer_load_dwordx4 v0, s[8:11], s28 offen offset:3072 sc1 lds
    s_add_u32 s29, s29, 4096
    s_add_u32 s28, s28, 4096
    s_mov_b32 m0, s29
    s_nop 0
    buffer_load_dwordx4 v0, s[8:11], s28 offen offset:0 sc1 lds
    buffer_load_dwordx4 v0, s[8:11], s28 offen offset:1024 sc1 lds
    s_mul_i32 s29, s83, 10240
    s_add_u32 s29, s29, 40960
    s_mul_i32 s28, s88, 81920
    s_add_u32 s28, s28, s29
    s_add_u32 s28, s28, 147849216
    s_mov_b32 m0, s29
    s_nop 0
    buffer_load_dwordx4 v0, s[8:11], s28 offen offset:0 sc1 lds
    buffer_load_dwordx4 v0, s[8:11], s28 offen offset:1024 sc1 lds
    buffer_load_dwordx4 v0, s[8:11], s28 offen offset:2048 sc1 lds
    buffer_load_dwordx4 v0, s[8:11], s28 offen offset:3072 sc1 lds
    s_add_u32 s29, s29, 4096
    s_add_u32 s28, s28, 4096
    s_mov_b32 m0, s29
    s_nop 0
    buffer_load_dwordx4 v0, s[8:11], s28 offen offset:0 sc1 lds
    buffer_load_dwordx4 v0, s[8:11], s28 offen offset:1024 sc1 lds
    buffer_load_dwordx4 v0, s[8:11], s28 offen offset:2048 sc1 lds
    buffer_load_dwordx4 v0, s[8:11], s28 offen offset:3072 sc1 lds
    s_add_u32 s29, s29, 4096
    s_add_u32 s28, s28, 4096
    s_mov_b32 m0, s29
    s_nop 0
    buffer_load_dwordx4 v0, s[8:11], s28 offen offset:0 sc1 lds
    buffer_load_dwordx4 v0, s[8:11], s28 offen offset:1024 sc1 lds
M_tabok2:
    v_mbcnt_lo_u32_b32 v0, -1, 0
    v_mbcnt_hi_u32_b32 v0, -1, v0
    s_lshl_b32 s27, s83, 6
    v_add_u32 v0, s27, v0
    s_mov_b32 s2, s81
    v_lshlrev_b32 v1, 2, v0
    v_and_b32 v102, 63, v0
    v_lshlrev_b32 v102, 4, v102
    v_lshlrev_b32 v2, 6, v0
    s_cmp_lt_u32 s2, 161
    s_cbranch_scc1 M_fft_go
    s_min_u32 s28, s89, 63
    s_lshl_b32 s29, s28, 12
    s_add_u32 s29, s29, 173654016
    v_lshlrev_b32 v190, 3, v102
    s_mov_b32 exec_hi, 0
    buffer_load_dword v191, v190, s[8:11], s29 offen sc1
    s_mov_b64 exec, 1
    s_mul_i32 s28, s28, 40960
    s_lshl_b32 s29, s88, 7
    s_add_u32 s29, s29, s28
    buffer_load_dword v191, v190, s[16:19], s29 offen sc1
    s_lshl_b32 s29, s88, 11
    s_add_u32 s29, s29, s28
    s_add_u32 s29, s29, 32505856
    buffer_load_dword v191, v190, s[8:11], s29 offen sc1
    s_mul_i32 s28, s101, 3145728
    s_min_u32 s29, s2, 159
    s_lshl_b32 s29, s29, 14
    s_add_u32 s28, s28, s29
    s_lshl_b32 s29, s83, 9
    s_add_u32 s28, s28, s29
    s_add_u32 s28, s28, 157286400
    s_cmp_lt_u32 s2, 160
    s_cselect_b32 s28, s28, 0x10000000
    buffer_load_dword v191, v190, s[8:11], s28 offen sc1
    s_mov_b64 exec, -1
    s_branch M_fft_end
M_fft_go:
    s_mov_b32 s26, 0x3f3504f3
    s_mov_b32 s27, s26
    s_lshl_b32 s34, s2, 1
    s_add_u32 s35, s34, 1
    s_cmp_eq_u32 s2, 0
    s_cselect_b32 s35, 320, s35
    s_cmp_eq_u32 s2, 160
    s_cselect_b32 s34, 1, s34
    s_cselect_b32 s35, 1, s35
    s_mul_i32 s21, s101, 6291456
    s_add_u32 s21, s21, 176160768
    s_lshl_b32 s20, s34, 13
    s_add_u32 s20, s20, s21
    s_lshl_b32 s36, s35, 13
    s_add_u32 s36, s36, s21
    s_add_u32 s21, s20, 2621440
    s_add_u32 s37, s36, 2621440
    s_cmp_eq_u32 s2, 0
    s_cselect_b32 s21, 0x10000000, s21
    s_cselect_b32 s37, 0x10000000, s37
    s_add_u32 s22, s20, 4096
    s_add_u32 s23, s21, 4096
    s_add_u32 s38, s36, 4096
    s_add_u32 s39, s37, 4096
    s_cmp_lg_u32 s83, 0
    s_cbranch_scc1 M_dp_29
    v_and_b32 v190, 7, v0
    v_lshlrev_b32 v190, 12, v190
    v_bfe_u32 v191, v0, 3, 1
    v_mul_u32_u24 v191, 1280, v191
    v_add_u32 v190, v190, v191
    s_mov_b64 exec, 0x1f1f
    s_lshr_b32 s31, s34, 5
    s_lshl_b32 s31, s31, 7
    s_add_u32 s31, s31, 167927808
    s_lshl_b32 s32, s101, 2
    s_add_u32 s32, s32, 2
    s_mov_b32 s30, 0
M_dp_30:
    buffer_load_dword v191, v190, s[8:11], s31 offen sc1
    s_add_u32 s30, s30, 1
    s_cmp_ge_u32 s30, 240000
    s_cbranch_scc1 M_fail
    s_sleep 4
    s_waitcnt vmcnt(0)
    v_cmp_gt_u32 vcc, s32, v191
    s_cbranch_vccnz M_dp_30
    s_mov_b64 exec, -1
M_dp_29:
    s_barrier
    buffer_load_dword v8, v1, s[8:11], s20 offen offset:0 sc1
    buffer_load_dword v9, v1, s[8:11], s21 offen offset:0 sc1
    buffer_load_dword v10, v1, s[8:11], s20 offen offset:1024 sc1
    buffer_load_dword v11, v1, s[8:11], s21 offen offset:1024 sc1
    buffer_load_dword v12, v1, s[8:11], s20 offen offset:2048 sc1
    buffer_load_dword v13, v1, s[8:11], s21 offen offset:2048 sc1
    buffer_load_dword v14, v1, s[8:11], s20 offen offset:3072 sc1
    buffer_load_dword v15, v1, s[8:11], s21 offen offset:3072 sc1
    buffer_load_dword v16, v1, s[8:11], s22 offen offset:0 sc1
    buffer_load_dword v17, v1, s[8:11], s23 offen offset:0 sc1
    buffer_load_dword v18, v1, s[8:11], s22 offen offset:1024 sc1
    buffer_load_dword v19, v1, s[8:11], s23 offen offset:1024 sc1
    buffer_load_dword v20, v1, s[8:11], s22 offen offset:2048 sc1
    buffer_load_dword v21, v1, s[8:11], s23 offen offset:2048 sc1
    buffer_load_dword v112, v1, s[8:11], s36 offen offset:0 sc1
    buffer_load_dword v113, v1, s[8:11], s37 offen offset:0 sc1
    buffer_load_dword v114, v1, s[8:11], s36 offen offset:1024 sc1
    buffer_load_dword v115, v1, s[8:11], s37 offen offset:1024 sc1
    buffer_load_dword v116, v1, s[8:11], s36 offen offset:2048 sc1
    buffer_load_dword v117, v1, s[8:11], s37 offen offset:2048 sc1
    buffer_load_dword v118, v1, s[8:11], s36 offen offset:3072 sc1
    buffer_load_dword v119, v1, s[8:11], s37 offen offset:3072 sc1
    buffer_load_dword v120, v1, s[8:11], s38 offen offset:0 sc1
    buffer_load_dword v121, v1, s[8:11], s39 offen offset:0 sc1
    buffer_load_dword v122, v1, s[8:11], s38 offen offset:1024 sc1
    buffer_load_dword v123, v1, s[8:11], s39 offen offset:1024 sc1
    buffer_load_dword v124, v1, s[8:11], s38 offen offset:2048 sc1
    buffer_load_dword v125, v1, s[8:11], s39 offen offset:2048 sc1
    s_lshr_b32 s24, s34, 1
    s_lshl_b32 s24, s24, 14
    s_and_b32 s25, s34, 1
    s_lshl_b32 s25, s25, 4
    s_add_u32 s24, s24, s25
    s_add_u32 s24, s24, 148897792
    buffer_load_dwordx4 v[92:95], v2, s[8:11], s24 offen sc1
    buffer_load_dwordx4 v[96:99], v2, s[8:11], s24 offen offset:32 sc1
    s_lshr_b32 s24, s35, 1
    s_lshl_b32 s24, s24, 14
    s_and_b32 s25, s35, 1
    s_lshl_b32 s25, s25, 4
    s_add_u32 s24, s24, s25
    s_add_u32 s24, s24, 148897792
    buffer_load_dwordx4 v[104:107], v2, s[8:11], s24 offen sc1
    buffer_load_dwordx4 v[108:111], v2, s[8:11], s24 offen offset:32 sc1
    s_min_u32 s28, s89, 63
    s_lshl_b32 s29, s28, 12
    s_add_u32 s29, s29, 173654016
    v_lshlrev_b32 v190, 3, v102
    s_mov_b32 exec_hi, 0
    buffer_load_dword v191, v190, s[8:11], s29 offen sc1
    s_mov_b64 exec, 1
    s_mul_i32 s28, s28, 40960
    s_lshl_b32 s29, s88, 7
    s_add_u32 s29, s29, s28
    buffer_load_dword v191, v190, s[16:19], s29 offen sc1
    s_lshl_b32 s29, s88, 11
    s_add_u32 s29, s29, s28
    s_add_u32 s29, s29, 32505856
    buffer_load_dword v191, v190, s[8:11], s29 offen sc1
    s_mul_i32 s28, s101, 3145728
    s_min_u32 s29, s2, 159
    s_lshl_b32 s29, s29, 14
    s_add_u32 s28, s28, s29
    s_lshl_b32 s29, s83, 9
    s_add_u32 s28, s28, s29
    s_add_u32 s28, s28, 157286400
    s_cmp_lt_u32 s2, 160
    s_cselect_b32 s28, s28, 0x10000000
    buffer_load_dword v191, v190, s[8:11], s28 offen sc1
    s_mov_b64 exec, -1
    v_and_b32 v3, 255, v0
    v_cvt_f32_u32 v3, v3
    v_mul_f32 v4, 0xba000000, v3
    v_cos_f32 v48, v4
    v_sin_f32 v49, v4
    v_mul_f32 v4, 0xba800000, v3
    v_cos_f32 v50, v4
    v_sin_f32 v51, v4
    v_mul_f32 v4, 0xbac00000, v3
    v_cos_f32 v52, v4
    v_sin_f32 v53, v4
    v_mul_f32 v4, 0xbb000000, v3
    v_cos_f32 v54, v4
    v_sin_f32 v55, v4
    v_mul_f32 v4, 0xbb200000, v3
    v_cos_f32 v56, v4
    v_sin_f32 v57, v4
    v_mul_f32 v4, 0xbb400000, v3
    v_cos_f32 v58, v4
    v_sin_f32 v59, v4
    v_mul_f32 v4, 0xbb600000, v3
    v_cos_f32 v60, v4
    v_sin_f32 v61, v4
    v_and_b32 v3, 31, v0
    v_cvt_f32_u32 v3, v3
    v_mul_f32 v4, 0xbb800000, v3
    v_cos_f32 v62, v4
    v_sin_f32 v63, v4
    v_mul_f32 v4, 0xbc000000, v3
    v_cos_f32 v64, v4
    v_sin_f32 v65, v4
    v_mul_f32 v4, 0xbc400000, v3
    v_cos_f32 v66, v4
    v_sin_f32 v67, v4
    v_mul_f32 v4, 0xbc800000, v3
    v_cos_f32 v68, v4
    v_sin_f32 v69, v4
    v_mul_f32 v4, 0xbca00000, v3
    v_cos_f32 v70, v4
    v_sin_f32 v71, v4
    v_mul_f32 v4, 0xbcc00000, v3
    v_cos_f32 v72, v4
    v_sin_f32 v73, v4
    v_mul_f32 v4, 0xbce00000, v3
    v_cos_f32 v74, v4
    v_sin_f32 v75, v4
    v_and_b32 v3, 3, v0
    v_cvt_f32_u32 v3, v3
    v_mul_f32 v4, 0xbd000000, v3
    v_cos_f32 v76, v4
    v_sin_f32 v77, v4
    v_mul_f32 v4, 0xbd800000, v3
    v_cos_f32 v78, v4
    v_sin_f32 v79, v4
    v_mul_f32 v4, 0xbdc00000, v3
    v_cos_f32 v80, v4
    v_sin_f32 v81, v4
    v_mul_f32 v4, 0xbe000000, v3
    v_cos_f32 v82, v4
    v_sin_f32 v83, v4
    v_mul_f32 v4, 0xbe200000, v3
    v_cos_f32 v84, v4
    v_sin_f32 v85, v4
    v_mul_f32 v4, 0xbe400000, v3
    v_cos_f32 v86, v4
    v_sin_f32 v87, v4
    v_mul_f32 v4, 0xbe600000, v3
    v_cos_f32 v88, v4
    v_sin_f32 v89, v4
    v_lshlrev_b32 v3, 3, v0
    v_lshrrev_b32 v4, 5, v0
    v_mul_u32_u24 v4, 2304, v4
    v_add_u32 v3, 81920, v3
    v_add_u32 v4, 81920, v4
    v_and_b32 v5, 31, v0
    v_lshl_add_u32 v5, v5, 3, v4
    v_bfe_u32 v6, v0, 2, 3
    v_mul_u32_u24 v6, 288, v6
    v_add_u32 v6, v6, v4
    v_and_b32 v7, 3, v0
    v_lshl_add_u32 v100, v7, 6, v6
    v_lshl_add_u32 v6, v7, 3, v6
    v_and_b32 v101, 0xe0, v0
    v_and_b32 v7, 15, v0
    v_lshl_add_u32 v101, v7, 1, v101
    v_bfe_u32 v7, v0, 4, 1
    v_add_u32 v101, v101, v7
    v_lshlrev_b32 v101, 3, v101
    s_waitcnt vmcnt(0)
    s_cmp_lg_u32 s83, 0
    s_cbranch_scc1 M_dp_31
    v_and_b32 v190, 7, v0
    v_lshlrev_b32 v190, 12, v190
    v_bfe_u32 v191, v0, 3, 1
    v_mul_u32_u24 v191, 1280, v191
    v_add_u32 v190, v190, v191
    s_mov_b64 exec, 0x1f1f
    s_lshr_b32 s31, s34, 5
    s_lshl_b32 s31, s31, 7
    s_add_u32 s31, s31, 167927808
    s_lshl_b32 s32, s101, 2
    s_add_u32 s32, s32, 3
    s_mov_b32 s30, 0
M_dp_32:
    buffer_load_dword v191, v190, s[8:11], s31 offen sc1
    s_add_u32 s30, s30, 1
    s_cmp_ge_u32 s30, 240000
    s_cbranch_scc1 M_fail
    s_waitcnt vmcnt(0)
    v_cmp_gt_u32 vcc, s32, v191
    s_cbranch_vccnz M_dp_32
    s_mov_b64 exec, -1
M_dp_31:
    s_barrier
    buffer_load_dword v22, v1, s[8:11], s22 offen offset:3072 sc1
    buffer_load_dword v23, v1, s[8:11], s23 offen offset:3072 sc1
    buffer_load_dword v126, v1, s[8:11], s38 offen offset:3072 sc1
    buffer_load_dword v127, v1, s[8:11], s39 offen offset:3072 sc1
    v_pk_add_f32 v[24:25], v[8:9], v[16:17]
    v_pk_add_f32 v[26:27], v[8:9], v[16:17] neg_lo:[0,1] neg_hi:[0,1]
    v_pk_add_f32 v[28:29], v[10:11], v[18:19]
    v_pk_add_f32 v[30:31], v[10:11], v[18:19] neg_lo:[0,1] neg_hi:[0,1]
    v_pk_add_f32 v[32:33], v[12:13], v[20:21]
    v_pk_add_f32 v[34:35], v[12:13], v[20:21] neg_lo:[0,1] neg_hi:[0,1]
    s_waitcnt vmcnt(2)
    v_pk_add_f32 v[36:37], v[14:15], v[22:23]
    v_pk_add_f32 v[38:39], v[14:15], v[22:23] neg_lo:[0,1] neg_hi:[0,1]
    v_pk_add_f32 v[40:41], v[24:25], v[32:33]
    v_pk_add_f32 v[42:43], v[24:25], v[32:33] neg_lo:[0,1] neg_hi:[0,1]
    v_pk_add_f32 v[44:45], v[28:29], v[36:37]
    v_pk_add_f32 v[46:47], v[28:29], v[36:37] neg_lo:[0,1] neg_hi:[0,1]
    v_pk_add_f32 v[8:9], v[40:41], v[44:45]
    v_pk_add_f32 v[16:17], v[40:41], v[44:45] neg_lo:[0,1] neg_hi:[0,1]
    v_pk_add_f32 v[10:11], v[42:43], v[46:47] op_sel:[0,1] op_sel_hi:[1,0] neg_lo:[0,0] neg_hi:[0,1]
    v_pk_add_f32 v[18:19], v[42:43], v[46:47] op_sel:[0,1] op_sel_hi:[1,0] neg_lo:[0,1] neg_hi:[0,0]
    v_pk_add_f32 v[12:13], v[30:31], v[30:31] op_sel:[0,1] op_sel_hi:[1,0] neg_lo:[0,0] neg_hi:[0,1]
    v_pk_add_f32 v[20:21], v[38:39], v[38:39] op_sel:[0,1] op_sel_hi:[1,0] neg_lo:[1,0] neg_hi:[1,1]
    v_pk_add_f32 v[14:15], v[26:27], v[34:35] op_sel:[0,1] op_sel_hi:[1,0] neg_lo:[0,0] neg_hi:[0,1]
    v_pk_add_f32 v[22:23], v[26:27], v[34:35] op_sel:[0,1] op_sel_hi:[1,0] neg_lo:[0,1] neg_hi:[0,0]
    v_pk_add_f32 v[24:25], v[12:13], v[20:21]
    v_pk_add_f32 v[28:29], v[12:13], v[20:21] neg_lo:[0,1] neg_hi:[0,1]
    v_pk_fma_f32 v[32:33], v[24:25], s[26:27], v[14:15] neg_lo:[0,0,0] neg_hi:[0,0,0]
    v_pk_fma_f32 v[36:37], v[24:25], s[26:27], v[14:15] neg_lo:[1,0,0] neg_hi:[1,0,0]
    v_pk_fma_f32 v[40:41], v[28:29], s[26:27], v[22:23] op_sel:[1,0,0] op_sel_hi:[0,1,1] neg_lo:[0,0,0] neg_hi:[1,0,0]
    v_pk_fma_f32 v[42:43], v[28:29], s[26:27], v[22:23] op_sel:[1,0,0] op_sel_hi:[0,1,1] neg_lo:[1,0,0] neg_hi:[0,0,0]
    v_pk_mul_f32 v[44:45], v[32:33], v[48:49] op_sel:[0,0] op_sel_hi:[1,0]
    v_pk_mul_f32 v[46:47], v[10:11], v[50:51] op_sel:[0,0] op_sel_hi:[1,0]
    v_pk_mul_f32 v[26:27], v[40:41], v[52:53] op_sel:[0,0] op_sel_hi:[1,0]
    v_pk_mul_f32 v[30:31], v[16:17], v[54:55] op_sel:[0,0] op_sel_hi:[1,0]
    v_pk_mul_f32 v[34:35], v[36:37], v[56:57] op_sel:[0,0] op_sel_hi:[1,0]
    v_pk_mul_f32 v[38:39], v[18:19], v[58:59] op_sel:[0,0] op_sel_hi:[1,0]
    v_pk_mul_f32 v[12:13], v[42:43], v[60:61] op_sel:[0,0] op_sel_hi:[1,0]
    v_pk_fma_f32 v[44:45], v[32:33], v[48:49], v[44:45] op_sel:[1,1,0] op_sel_hi:[0,1,1] neg_lo:[1,0,0] neg_hi:[0,0,0]
    v_pk_fma_f32 v[46:47], v[10:11], v[50:51], v[46:47] op_sel:[1,1,0] op_sel_hi:[0,1,1] neg_lo:[1,0,0] neg_hi:[0,0,0]
    v_pk_fma_f32 v[26:27], v[40:41], v[52:53], v[26:27] op_sel:[1,1,0] op_sel_hi:[0,1,1] neg_lo:[1,0,0] neg_hi:[0,0,0]
    v_pk_fma_f32 v[30:31], v[16:17], v[54:55], v[30:31] op_sel:[1,1,0] op_sel_hi:[0,1,1] neg_lo:[1,0,0] neg_hi:[0,0,0]
    v_pk_fma_f32 v[34:35], v[36:37], v[56:57], v[34:35] op_sel:[1,1,0] op_sel_hi:[0,1,1] neg_lo:[1,0,0] neg_hi:[0,0,0]
    v_pk_fma_f32 v[38:39], v[18:19], v[58:59], v[38:39] op_sel:[1,1,0] op_sel_hi:[0,1,1] neg_lo:[1,0,0] neg_hi:[0,0,0]
    v_pk_fma_f32 v[12:13], v[42:43], v[60:61], v[12:13] op_sel:[1,1,0] op_sel_hi:[0,1,1] neg_lo:[1,0,0] neg_hi:[0,0,0]
    ds_write_b64 v3, v[8:9] offset:0
    v_pk_add_f32 v[128:129], v[112:113], v[120:121]
    v_pk_add_f32 v[130:131], v[112:113], v[120:121] neg_lo:[0,1] neg_hi:[0,1]
    v_pk_add_f32 v[132:133], v[114:115], v[122:123]
    ds_write_b64 v3, v[44:45] offset:2304
    v_pk_add_f32 v[134:135], v[114:115], v[122:123] neg_lo:[0,1] neg_hi:[0,1]
    v_pk_add_f32 v[136:137], v[116:117], v[124:125]
    v_pk_add_f32 v[138:139], v[116:117], v[124:125] neg_lo:[0,1] neg_hi:[0,1]
    ds_write_b64 v3, v[46:47] offset:4608
    s_waitcnt vmcnt(0)
    v_pk_add_f32 v[140:141], v[118:119], v[126:127]
    v_pk_add_f32 v[142:143], v[118:119], v[126:127] neg_lo:[0,1] neg_hi:[0,1]
    v_pk_add_f32 v[144:145], v[128:129], v[136:137]
    ds_write_b64 v3, v[26:27] offset:6912
    v_pk_add_f32 v[146:147], v[128:129], v[136:137] neg_lo:[0,1] neg_hi:[0,1]
    v_pk_add_f32 v[148:149], v[132:133], v[140:141]
    v_pk_add_f32 v[150:151], v[132:133], v[140:141] neg_lo:[0,1] neg_hi:[0,1]
    ds_write_b64 v3, v[30:31] offset:9216
    v_pk_add_f32 v[112:113], v[144:145], v[148:149]
    v_pk_add_f32 v[120:121], v[144:145], v[148:149] neg_lo:[0,1] neg_hi:[0,1]
    v_pk_add_f32 v[114:115], v[146:147], v[150:151] op_sel:[0,1] op_sel_hi:[1,0] neg_lo:[0,0] neg_hi:[0,1]
    ds_write_b64 v3, v[34:35] offset:11520
    v_pk_add_f32 v[122:123], v[146:147], v[150:151] op_sel:[0,1] op_sel_hi:[1,0] neg_lo:[0,1] neg_hi:[0,0]
    v_pk_add_f32 v[116:117], v[134:135], v[134:135] op_sel:[0,1] op_sel_hi:[1,0] neg_lo:[0,0] neg_hi:[0,1]
    v_pk_add_f32 v[124:125], v[142:143], v[142:143] op_sel:[0,1] op_sel_hi:[1,0] neg_lo:[1,0] neg_hi:[1,1]
    ds_write_b64 v3, v[38:39] offset:13824
    v_pk_add_f32 v[118:119], v[130:131], v[138:139] op_sel:[0,1] op_sel_hi:[1,0] neg_lo:[0,0] neg_hi:[0,1]
    v_pk_add_f32 v[126:127], v[130:131], v[138:139] op_sel:[0,1] op_sel_hi:[1,0] neg_lo:[0,1] neg_hi:[0,0]
    v_pk_add_f32 v[128:129], v[116:117], v[124:125]
    ds_write_b64 v3, v[12:13] offset:16128
    v_pk_add_f32 v[132:133], v[116:117], v[124:125] neg_lo:[0,1] neg_hi:[0,1]
    v_pk_fma_f32 v[136:137], v[128:129], s[26:27], v[118:119] neg_lo:[0,0,0] neg_hi:[0,0,0]
    v_pk_fma_f32 v[140:141], v[128:129], s[26:27], v[118:119] neg_lo:[1,0,0] neg_hi:[1,0,0]
    v_pk_fma_f32 v[144:145], v[132:133], s[26:27], v[126:127] op_sel:[1,0,0] op_sel_hi:[0,1,1] neg_lo:[0,0,0] neg_hi:[1,0,0]
    v_pk_fma_f32 v[146:147], v[132:133], s[26:27], v[126:127] op_sel:[1,0,0] op_sel_hi:[0,1,1] neg_lo:[1,0,0] neg_hi:[0,0,0]
    v_pk_mul_f32 v[148:149], v[136:137], v[48:49] op_sel:[0,0] op_sel_hi:[1,0]
    v_pk_mul_f32 v[150:151], v[114:115], v[50:51] op_sel:[0,0] op_sel_hi:[1,0]
    v_pk_mul_f32 v[130:131], v[144:145], v[52:53] op_sel:[0,0] op_sel_hi:[1,0]
    v_pk_mul_f32 v[134:135], v[120:121], v[54:55] op_sel:[0,0] op_sel_hi:[1,0]
    v_pk_mul_f32 v[138:139], v[140:141], v[56:57] op_sel:[0,0] op_sel_hi:[1,0]
    v_pk_mul_f32 v[142:143], v[122:123], v[58:59] op_sel:[0,0] op_sel_hi:[1,0]
    v_pk_mul_f32 v[116:117], v[146:147], v[60:61] op_sel:[0,0] op_sel_hi:[1,0]
    v_pk_fma_f32 v[148:149], v[136:137], v[48:49], v[148:149] op_sel:[1,1,0] op_sel_hi:[0,1,1] neg_lo:[1,0,0] neg_hi:[0,0,0]
    v_pk_fma_f32 v[150:151], v[114:115], v[50:51], v[150:151] op_sel:[1,1,0] op_sel_hi:[0,1,1] neg_lo:[1,0,0] neg_hi:[0,0,0]
    v_pk_fma_f32 v[130:131], v[144:145], v[52:53], v[130:131] op_sel:[1,1,0] op_sel_hi:[0,1,1] neg_lo:[1,0,0] neg_hi:[0,0,0]
    v_pk_fma_f32 v[134:135], v[120:121], v[54:55], v[134:135] op_sel:[1,1,0] op_sel_hi:[0,1,1] neg_lo:[1,0,0] neg_hi:[0,0,0]
    v_pk_fma_f32 v[138:139], v[140:141], v[56:57], v[138:139] op_sel:[1,1,0] op_sel_hi:[0,1,1] neg_lo:[1,0,0] neg_hi:[0,0,0]
    v_pk_fma_f32 v[142:143], v[122:123], v[58:59], v[142:143] op_sel:[1,1,0] op_sel_hi:[0,1,1] neg_lo:[1,0,0] neg_hi:[0,0,0]
    v_pk_fma_f32 v[116:117], v[146:147], v[60:61], v[116:117] op_sel:[1,1,0] op_sel_hi:[0,1,1] neg_lo:[1,0,0] neg_hi:[0,0,0]
    ds_write_b64 v3, v[112:113] offset:18432
    ds_write_b64 v3, v[148:149] offset:20736
    ds_write_b64 v3, v[150:151] offset:23040
    ds_write_b64 v3, v[130:131] offset:25344
    ds_write_b64 v3, v[134:135] offset:27648
    ds_write_b64 v3, v[138:139] offset:29952
    ds_write_b64 v3, v[142:143] offset:32256
    ds_write_b64 v3, v[116:117] offset:34560
    s_waitcnt lgkmcnt(0)
    s_barrier
    ds_read_b64 v[20:21], v5 offset:0
    ds_read_b64 v[14:15], v5 offset:256
    ds_read_b64 v[22:23], v5 offset:512
    ds_read_b64 v[24:25], v5 offset:768
    ds_read_b64 v[28:29], v5 offset:1024
    ds_read_b64 v[32:33], v5 offset:1280
    ds_read_b64 v[10:11], v5 offset:1536
    ds_read_b64 v[40:41], v5 offset:1792
    ds_read_b64 v[124:125], v5 offset:18432
    ds_read_b64 v[118:119], v5 offset:18688
    ds_read_b64 v[126:127], v5 offset:18944
    ds_read_b64 v[128:129], v5 offset:19200
    ds_read_b64 v[132:133], v5 offset:19456
    ds_read_b64 v[136:137], v5 offset:19712
    ds_read_b64 v[114:115], v5 offset:19968
    ds_read_b64 v[144:145], v5 offset:20224
    s_waitcnt lgkmcnt(11)
    v_pk_add_f32 v[16:17], v[20:21], v[28:29]
    v_pk_add_f32 v[36:37], v[20:21], v[28:29] neg_lo:[0,1] neg_hi:[0,1]
    s_waitcnt lgkmcnt(10)
    v_pk_add_f32 v[18:19], v[14:15], v[32:33]
    v_pk_add_f32 v[42:43], v[14:15], v[32:33] neg_lo:[0,1] neg_hi:[0,1]
    s_waitcnt lgkmcnt(9)
    v_pk_add_f32 v[8:9], v[22:23], v[10:11]
    v_pk_add_f32 v[44:45], v[22:23], v[10:11] neg_lo:[0,1] neg_hi:[0,1]
    s_waitcnt lgkmcnt(8)
    v_pk_add_f32 v[46:47], v[24:25], v[40:41]
    v_pk_add_f32 v[26:27], v[24:25], v[40:41] neg_lo:[0,1] neg_hi:[0,1]
    v_pk_add_f32 v[30:31], v[16:17], v[8:9]
    v_pk_add_f32 v[34:35], v[16:17], v[8:9] neg_lo:[0,1] neg_hi:[0,1]
    v_pk_add_f32 v[38:39], v[18:19], v[46:47]
    v_pk_add_f32 v[12:13], v[18:19], v[46:47] neg_lo:[0,1] neg_hi:[0,1]
    v_pk_add_f32 v[20:21], v[30:31], v[38:39]
    v_pk_add_f32 v[28:29], v[30:31], v[38:39] neg_lo:[0,1] neg_hi:[0,1]
    v_pk_add_f32 v[14:15], v[34:35], v[12:13] op_sel:[0,1] op_sel_hi:[1,0] neg_lo:[0,0] neg_hi:[0,1]
    v_pk_add_f32 v[32:33], v[34:35], v[12:13] op_sel:[0,1] op_sel_hi:[1,0] neg_lo:[0,1] neg_hi:[0,0]
    v_pk_add_f32 v[22:23], v[42:43], v[42:43] op_sel:[0,1] op_sel_hi:[1,0] neg_lo:[0,0] neg_hi:[0,1]
    v_pk_add_f32 v[10:11], v[26:27], v[26:27] op_sel:[0,1] op_sel_hi:[1,0] neg_lo:[1,0] neg_hi:[1,1]
    v_pk_add_f32 v[24:25], v[36:37], v[44:45] op_sel:[0,1] op_sel_hi:[1,0] neg_lo:[0,0] neg_hi:[0,1]
    v_pk_add_f32 v[40:41], v[36:37], v[44:45] op_sel:[0,1] op_sel_hi:[1,0] neg_lo:[0,1] neg_hi:[0,0]
    v_pk_add_f32 v[16:17], v[22:23], v[10:11]
    v_pk_add_f32 v[18:19], v[22:23], v[10:11] neg_lo:[0,1] neg_hi:[0,1]
    v_pk_fma_f32 v[8:9], v[16:17], s[26:27], v[24:25] neg_lo:[0,0,0] neg_hi:[0,0,0]
    v_pk_fma_f32 v[46:47], v[16:17], s[26:27], v[24:25] neg_lo:[1,0,0] neg_hi:[1,0,0]
    v_pk_fma_f32 v[30:31], v[18:19], s[26:27], v[40:41] op_sel:[1,0,0] op_sel_hi:[0,1,1] neg_lo:[0,0,0] neg_hi:[1,0,0]
    v_pk_fma_f32 v[34:35], v[18:19], s[26:27], v[40:41] op_sel:[1,0,0] op_sel_hi:[0,1,1] neg_lo:[1,0,0] neg_hi:[0,0,0]
    v_pk_mul_f32 v[38:39], v[8:9], v[62:63] op_sel:[0,0] op_sel_hi:[1,0]
    v_pk_mul_f32 v[12:13], v[14:15], v[64:65] op_sel:[0,0] op_sel_hi:[1,0]
    v_pk_mul_f32 v[36:37], v[30:31], v[66:67] op_sel:[0,0] op_sel_hi:[1,0]
    v_pk_mul_f32 v[42:43], v[28:29], v[68:69] op_sel:[0,0] op_sel_hi:[1,0]
    v_pk_mul_f32 v[44:45], v[46:47], v[70:71] op_sel:[0,0] op_sel_hi:[1,0]
    v_pk_mul_f32 v[26:27], v[32:33], v[72:73] op_sel:[0,0] op_sel_hi:[1,0]
    v_pk_mul_f32 v[22:23], v[34:35], v[74:75] op_sel:[0,0] op_sel_hi:[1,0]
    v_pk_fma_f32 v[38:39], v[8:9], v[62:63], v[38:39] op_sel:[1,1,0] op_sel_hi:[0,1,1] neg_lo:[1,0,0] neg_hi:[0,0,0]
    v_pk_fma_f32 v[12:13], v[14:15], v[64:65], v[12:13] op_sel:[1,1,0] op_sel_hi:[0,1,1] neg_lo:[1,0,0] neg_hi:[0,0,0]
    v_pk_fma_f32 v[36:37], v[30:31], v[66:67], v[36:37] op_sel:[1,1,0] op_sel_hi:[0,1,1] neg_lo:[1,0,0] neg_hi:[0,0,0]
    v_pk_fma_f32 v[42:43], v[28:29], v[68:69], v[42:43] op_sel:[1,1,0] op_sel_hi:[0,1,1] neg_lo:[1,0,0] neg_hi:[0,0,0]
    v_pk_fma_f32 v[44:45], v[46:47], v[70:71], v[44:45] op_sel:[1,1,0] op_sel_hi:[0,1,1] neg_lo:[1,0,0] neg_hi:[0,0,0]
    v_pk_fma_f32 v[26:27], v[32:33], v[72:73], v[26:27] op_sel:[1,1,0] op_sel_hi:[0,1,1] neg_lo:[1,0,0] neg_hi:[0,0,0]
    v_pk_fma_f32 v[22:23], v[34:35], v[74:75], v[22:23] op_sel:[1,1,0] op_sel_hi:[0,1,1] neg_lo:[1,0,0] neg_hi:[0,0,0]
    ds_write_b64 v5, v[20:21] offset:0
    s_waitcnt lgkmcnt(4)
    v_pk_add_f32 v[120:121], v[124:125], v[132:133]
    v_pk_add_f32 v[140:141], v[124:125], v[132:133] neg_lo:[0,1] neg_hi:[0,1]
    s_waitcnt lgkmcnt(3)
    v_pk_add_f32 v[122:123], v[118:119], v[136:137]
    ds_write_b64 v5, v[38:39] offset:288
    v_pk_add_f32 v[146:147], v[118:119], v[136:137] neg_lo:[0,1] neg_hi:[0,1]
    s_waitcnt lgkmcnt(3)
    v_pk_add_f32 v[112:113], v[126:127], v[114:115]
    v_pk_add_f32 v[148:149], v[126:127], v[114:115] neg_lo:[0,1] neg_hi:[0,1]
    ds_write_b64 v5, v[12:13] offset:576
    s_waitcnt lgkmcnt(3)
    v_pk_add_f32 v[150:151], v[128:129], v[144:145]
    v_pk_add_f32 v[130:131], v[128:129], v[144:145] neg_lo:[0,1] neg_hi:[0,1]
    v_pk_add_f32 v[134:135], v[120:121], v[112:113]
    ds_write_b64 v5, v[36:37] offset:864
    v_pk_add_f32 v[138:139], v[120:121], v[112:113] neg_lo:[0,1] neg_hi:[0,1]
    v_pk_add_f32 v[142:143], v[122:123], v[150:151]
    v_pk_add_f32 v[116:117], v[122:123], v[150:151] neg_lo:[0,1] neg_hi:[0,1]
    ds_write_b64 v5, v[42:43] offset:1152
    v_pk_add_f32 v[124:125], v[134:135], v[142:143]
    v_pk_add_f32 v[132:133], v[134:135], v[142:143] neg_lo:[0,1] neg_hi:[0,1]
    v_pk_add_f32 v[118:119], v[138:139], v[116:117] op_sel:[0,1] op_sel_hi:[1,0] neg_lo:[0,0] neg_hi:[0,1]
    ds_write_b64 v5, v[44:45] offset:1440
    v_pk_add_f32 v[136:137], v[138:139], v[116:117] op_sel:[0,1] op_sel_hi:[1,0] neg_lo:[0,1] neg_hi:[0,0]
    v_pk_add_f32 v[126:127], v[146:147], v[146:147] op_sel:[0,1] op_sel_hi:[1,0] neg_lo:[0,0] neg_hi:[0,1]
    v_pk_add_f32 v[114:115], v[130:131], v[130:131] op_sel:[0,1] op_sel_hi:[1,0] neg_lo:[1,0] neg_hi:[1,1]
    ds_write_b64 v5, v[26:27] offset:1728
    v_pk_add_f32 v[128:129], v[140:141], v[148:149] op_sel:[0,1] op_sel_hi:[1,0] neg_lo:[0,0] neg_hi:[0,1]
    v_pk_add_f32 v[144:145], v[140:141], v[148:149] op_sel:[0,1] op_sel_hi:[1,0] neg_lo:[0,1] neg_hi:[0,0]
    v_pk_add_f32 v[120:121], v[126:127], v[114:115]
    ds_write_b64 v5, v[22:23] offset:2016
    v_pk_add_f32 v[122:123], v[126:127], v[114:115] neg_lo:[0,1] neg_hi:[0,1]
    v_pk_fma_f32 v[112:113], v[120:121], s[26:27], v[128:129] neg_lo:[0,0,0] neg_hi:[0,0,0]
    ds_read_b64 v[10:11], v6 offset:0
    v_pk_fma_f32 v[150:151], v[120:121], s[26:27], v[128:129] neg_lo:[1,0,0] neg_hi:[1,0,0]
    v_pk_fma_f32 v[134:135], v[122:123], s[26:27], v[144:145] op_sel:[1,0,0] op_sel_hi:[0,1,1] neg_lo:[0,0,0] neg_hi:[1,0,0]
    ds_read_b64 v[24:25], v6 offset:32
    v_pk_fma_f32 v[138:139], v[122:123], s[26:27], v[144:145] op_sel:[1,0,0] op_sel_hi:[0,1,1] neg_lo:[1,0,0] neg_hi:[0,0,0]
    v_pk_mul_f32 v[142:143], v[112:113], v[62:63] op_sel:[0,0] op_sel_hi:[1,0]
    ds_read_b64 v[40:41], v6 offset:64
    v_pk_mul_f32 v[116:117], v[118:119], v[64:65] op_sel:[0,0] op_sel_hi:[1,0]
    v_pk_mul_f32 v[140:141], v[134:135], v[66:67] op_sel:[0,0] op_sel_hi:[1,0]
    ds_read_b64 v[16:17], v6 offset:96
    v_pk_mul_f32 v[146:147], v[132:133], v[68:69] op_sel:[0,0] op_sel_hi:[1,0]
    v_pk_mul_f32 v[148:149], v[150:151], v[70:71] op_sel:[0,0] op_sel_hi:[1,0]
    ds_read_b64 v[18:19], v6 offset:128
    v_pk_mul_f32 v[130:131], v[136:137], v[72:73] op_sel:[0,0] op_sel_hi:[1,0]
    v_pk_mul_f32 v[126:127], v[138:139], v[74:75] op_sel:[0,0] op_sel_hi:[1,0]
    ds_read_b64 v[8:9], v6 offset:160
    v_pk_fma_f32 v[142:143], v[112:113], v[62:63], v[142:143] op_sel:[1,1,0] op_sel_hi:[0,1,1] neg_lo:[1,0,0] neg_hi:[0,0,0]
    v_pk_fma_f32 v[116:117], v[118:119], v[64:65], v[116:117] op_sel:[1,1,0] op_sel_hi:[0,1,1] neg_lo:[1,0,0] neg_hi:[0,0,0]
    ds_read_b64 v[14:15], v6 offset:192
    v_pk_fma_f32 v[140:141], v[134:135], v[66:67], v[140:141] op_sel:[1,1,0] op_sel_hi:[0,1,1] neg_lo:[1,0,0] neg_hi:[0,0,0]
    v_pk_fma_f32 v[146:147], v[132:133], v[68:69], v[146:147] op_sel:[1,1,0] op_sel_hi:[0,1,1] neg_lo:[1,0,0] neg_hi:[0,0,0]
    ds_read_b64 v[30:31], v6 offset:224
    v_pk_fma_f32 v[148:149], v[150:151], v[70:71], v[148:149] op_sel:[1,1,0] op_sel_hi:[0,1,1] neg_lo:[1,0,0] neg_hi:[0,0,0]
    v_pk_fma_f32 v[130:131], v[136:137], v[72:73], v[130:131] op_sel:[1,1,0] op_sel_hi:[0,1,1] neg_lo:[1,0,0] neg_hi:[0,0,0]
    v_pk_fma_f32 v[126:127], v[138:139], v[74:75], v[126:127] op_sel:[1,1,0] op_sel_hi:[0,1,1] neg_lo:[1,0,0] neg_hi:[0,0,0]
    ds_write_b64 v5, v[124:125] offset:18432
    s_waitcnt lgkmcnt(4)
    v_pk_add_f32 v[28:29], v[10:11], v[18:19]
    v_pk_add_f32 v[46:47], v[10:11], v[18:19] neg_lo:[0,1] neg_hi:[0,1]
    s_waitcnt lgkmcnt(3)
    v_pk_add_f32 v[32:33], v[24:25], v[8:9]
    ds_write_b64 v5, v[142:143] offset:18720
    v_pk_add_f32 v[34:35], v[24:25], v[8:9] neg_lo:[0,1] neg_hi:[0,1]
    s_waitcnt lgkmcnt(3)
    v_pk_add_f32 v[20:21], v[40:41], v[14:15]
    v_pk_add_f32 v[38:39], v[40:41], v[14:15] neg_lo:[0,1] neg_hi:[0,1]
    ds_write_b64 v5, v[116:117] offset:19008
    s_waitcnt lgkmcnt(3)
    v_pk_add_f32 v[12:13], v[16:17], v[30:31]
    v_pk_add_f32 v[36:37], v[16:17], v[30:31] neg_lo:[0,1] neg_hi:[0,1]
    v_pk_add_f32 v[42:43], v[28:29], v[20:21]
    ds_write_b64 v5, v[140:141] offset:19296
    v_pk_add_f32 v[44:45], v[28:29], v[20:21] neg_lo:[0,1] neg_hi:[0,1]
    v_pk_add_f32 v[26:27], v[32:33], v[12:13]
    v_pk_add_f32 v[22:23], v[32:33], v[12:13] neg_lo:[0,1] neg_hi:[0,1]
    ds_write_b64 v5, v[146:147] offset:19584
    v_pk_add_f32 v[10:11], v[42:43], v[26:27]
    v_pk_add_f32 v[18:19], v[42:43], v[26:27] neg_lo:[0,1] neg_hi:[0,1]
    v_pk_add_f32 v[24:25], v[44:45], v[22:23] op_sel:[0,1] op_sel_hi:[1,0] neg_lo:[0,0] neg_hi:[0,1]
    ds_write_b64 v5, v[148:149] offset:19872
    v_pk_add_f32 v[8:9], v[44:45], v[22:23] op_sel:[0,1] op_sel_hi:[1,0] neg_lo:[0,1] neg_hi:[0,0]
    v_pk_add_f32 v[40:41], v[34:35], v[34:35] op_sel:[0,1] op_sel_hi:[1,0] neg_lo:[0,0] neg_hi:[0,1]
    v_pk_add_f32 v[14:15], v[36:37], v[36:37] op_sel:[0,1] op_sel_hi:[1,0] neg_lo:[1,0] neg_hi:[1,1]
    ds_write_b64 v5, v[130:131] offset:20160
    v_pk_add_f32 v[16:17], v[46:47], v[38:39] op_sel:[0,1] op_sel_hi:[1,0] neg_lo:[0,0] neg_hi:[0,1]
    v_pk_add_f32 v[30:31], v[46:47], v[38:39] op_sel:[0,1] op_sel_hi:[1,0] neg_lo:[0,1] neg_hi:[0,0]
    v_pk_add_f32 v[28:29], v[40:41], v[14:15]
    ds_write_b64 v5, v[126:127] offset:20448
    v_pk_add_f32 v[32:33], v[40:41], v[14:15] neg_lo:[0,1] neg_hi:[0,1]
    v_pk_fma_f32 v[20:21], v[28:29], s[26:27], v[16:17] neg_lo:[0,0,0] neg_hi:[0,0,0]
    ds_read_b64 v[114:115], v6 offset:18432
    v_pk_fma_f32 v[12:13], v[28:29], s[26:27], v[16:17] neg_lo:[1,0,0] neg_hi:[1,0,0]
    v_pk_fma_f32 v[42:43], v[32:33], s[26:27], v[30:31] op_sel:[1,0,0] op_sel_hi:[0,1,1] neg_lo:[0,0,0] neg_hi:[1,0,0]
    ds_read_b64 v[128:129], v6 offset:18464
    v_pk_fma_f32 v[44:45], v[32:33], s[26:27], v[30:31] op_sel:[1,0,0] op_sel_hi:[0,1,1] neg_lo:[1,0,0] neg_hi:[0,0,0]
    v_pk_mul_f32 v[26:27], v[20:21], v[76:77] op_sel:[0,0] op_sel_hi:[1,0]
    ds_read_b64 v[144:145], v6 offset:18496
    v_pk_mul_f32 v[22:23], v[24:25], v[78:79] op_sel:[0,0] op_sel_hi:[1,0]
    v_pk_mul_f32 v[46:47], v[42:43], v[80:81] op_sel:[0,0] op_sel_hi:[1,0]
    ds_read_b64 v[120:121], v6 offset:18528
    v_pk_mul_f32 v[34:35], v[18:19], v[82:83] op_sel:[0,0] op_sel_hi:[1,0]
    v_pk_mul_f32 v[38:39], v[12:13], v[84:85] op_sel:[0,0] op_sel_hi:[1,0]
    ds_read_b64 v[122:123], v6 offset:18560
    v_pk_mul_f32 v[36:37], v[8:9], v[86:87] op_sel:[0,0] op_sel_hi:[1,0]
    v_pk_mul_f32 v[40:41], v[44:45], v[88:89] op_sel:[0,0] op_sel_hi:[1,0]
    ds_read_b64 v[112:113], v6 offset:18592
    v_pk_fma_f32 v[26:27], v[20:21], v[76:77], v[26:27] op_sel:[1,1,0] op_sel_hi:[0,1,1] neg_lo:[1,0,0] neg_hi:[0,0,0]
    v_pk_fma_f32 v[22:23], v[24:25], v[78:79], v[22:23] op_sel:[1,1,0] op_sel_hi:[0,1,1] neg_lo:[1,0,0] neg_hi:[0,0,0]
    ds_read_b64 v[118:119], v6 offset:18624
    v_pk_fma_f32 v[46:47], v[42:43], v[80:81], v[46:47] op_sel:[1,1,0] op_sel_hi:[0,1,1] neg_lo:[1,0,0] neg_hi:[0,0,0]
    v_pk_fma_f32 v[34:35], v[18:19], v[82:83], v[34:35] op_sel:[1,1,0] op_sel_hi:[0,1,1] neg_lo:[1,0,0] neg_hi:[0,0,0]
    ds_read_b64 v[134:135], v6 offset:18656
    v_pk_fma_f32 v[38:39], v[12:13], v[84:85], v[38:39] op_sel:[1,1,0] op_sel_hi:[0,1,1] neg_lo:[1,0,0] neg_hi:[0,0,0]
    v_pk_fma_f32 v[36:37], v[8:9], v[86:87], v[36:37] op_sel:[1,1,0] op_sel_hi:[0,1,1] neg_lo:[1,0,0] neg_hi:[0,0,0]
    v_pk_fma_f32 v[40:41], v[44:45], v[88:89], v[40:41] op_sel:[1,1,0] op_sel_hi:[0,1,1] neg_lo:[1,0,0] neg_hi:[0,0,0]
    ds_write_b64 v6, v[10:11] offset:0
    s_waitcnt lgkmcnt(4)
    v_pk_add_f32 v[132:133], v[114:115], v[122:123]
    v_pk_add_f32 v[150:151], v[114:115], v[122:123] neg_lo:[0,1] neg_hi:[0,1]
    s_waitcnt lgkmcnt(3)
    v_pk_add_f32 v[136:137], v[128:129], v[112:113]
    ds_write_b64 v6, v[26:27] offset:32
    v_pk_add_f32 v[138:139], v[128:129], v[112:113] neg_lo:[0,1] neg_hi:[0,1]
    s_waitcnt lgkmcnt(3)
    v_pk_add_f32 v[124:125], v[144:145], v[118:119]
    v_pk_add_f32 v[142:143], v[144:145], v[118:119] neg_lo:[0,1] neg_hi:[0,1]
    ds_write_b64 v6, v[22:23] offset:64
    s_waitcnt lgkmcnt(3)
    v_pk_add_f32 v[116:117], v[120:121], v[134:135]
    v_pk_add_f32 v[140:141], v[120:121], v[134:135] neg_lo:[0,1] neg_hi:[0,1]
    v_pk_add_f32 v[146:147], v[132:133], v[124:125]
    ds_write_b64 v6, v[46:47] offset:96
    v_pk_add_f32 v[148:149], v[132:133], v[124:125] neg_lo:[0,1] neg_hi:[0,1]
    v_pk_add_f32 v[130:131], v[136:137], v[116:117]
    v_pk_add_f32 v[126:127], v[136:137], v[116:117] neg_lo:[0,1] neg_hi:[0,1]
    ds_write_b64 v6, v[34:35] offset:128
    v_pk_add_f32 v[114:115], v[146:147], v[130:131]
    v_pk_add_f32 v[122:123], v[146:147], v[130:131] neg_lo:[0,1] neg_hi:[0,1]
    v_pk_add_f32 v[128:129], v[148:149], v[126:127] op_sel:[0,1] op_sel_hi:[1,0] neg_lo:[0,0] neg_hi:[0,1]
    ds_write_b64 v6, v[38:39] offset:160
    v_pk_add_f32 v[112:113], v[148:149], v[126:127] op_sel:[0,1] op_sel_hi:[1,0] neg_lo:[0,1] neg_hi:[0,0]
    v_pk_add_f32 v[144:145], v[138:139], v[138:139] op_sel:[0,1] op_sel_hi:[1,0] neg_lo:[0,0] neg_hi:[0,1]
    v_pk_add_f32 v[118:119], v[140:141], v[140:141] op_sel:[0,1] op_sel_hi:[1,0] neg_lo:[1,0] neg_hi:[1,1]
    ds_write_b64 v6, v[36:37] offset:192
    v_pk_add_f32 v[120:121], v[150:151], v[142:143] op_sel:[0,1] op_sel_hi:[1,0] neg_lo:[0,0] neg_hi:[0,1]
    v_pk_add_f32 v[134:135], v[150:151], v[142:143] op_sel:[0,1] op_sel_hi:[1,0] neg_lo:[0,1] neg_hi:[0,0]
    v_pk_add_f32 v[132:133], v[144:145], v[118:119]
    ds_write_b64 v6, v[40:41] offset:224
    v_pk_add_f32 v[136:137], v[144:145], v[118:119] neg_lo:[0,1] neg_hi:[0,1]
    v_pk_fma_f32 v[124:125], v[132:133], s[26:27], v[120:121] neg_lo:[0,0,0] neg_hi:[0,0,0]
    ds_read_b64 v[14:15], v100 offset:0
    v_pk_fma_f32 v[116:117], v[132:133], s[26:27], v[120:121] neg_lo:[1,0,0] neg_hi:[1,0,0]
    v_pk_fma_f32 v[146:147], v[136:137], s[26:27], v[134:135] op_sel:[1,0,0] op_sel_hi:[0,1,1] neg_lo:[0,0,0] neg_hi:[1,0,0]
    ds_read_b64 v[16:17], v100 offset:8
    v_pk_fma_f32 v[148:149], v[136:137], s[26:27], v[134:135] op_sel:[1,0,0] op_sel_hi:[0,1,1] neg_lo:[1,0,0] neg_hi:[0,0,0]
    v_pk_mul_f32 v[130:131], v[124:125], v[76:77] op_sel:[0,0] op_sel_hi:[1,0]
    ds_read_b64 v[30:31], v100 offset:16
    v_pk_mul_f32 v[126:127], v[128:129], v[78:79] op_sel:[0,0] op_sel_hi:[1,0]
    v_pk_mul_f32 v[150:151], v[146:147], v[80:81] op_sel:[0,0] op_sel_hi:[1,0]
    ds_read_b64 v[28:29], v100 offset:24
    v_pk_mul_f32 v[138:139], v[122:123], v[82:83] op_sel:[0,0] op_sel_hi:[1,0]
    v_pk_mul_f32 v[142:143], v[116:117], v[84:85] op_sel:[0,0] op_sel_hi:[1,0]
    ds_read_b64 v[32:33], v100 offset:32
    v_pk_mul_f32 v[140:141], v[112:113], v[86:87] op_sel:[0,0] op_sel_hi:[1,0]
    v_pk_mul_f32 v[144:145], v[148:149], v[88:89] op_sel:[0,0] op_sel_hi:[1,0]
    ds_read_b64 v[20:21], v100 offset:40
    v_pk_fma_f32 v[130:131], v[124:125], v[76:77], v[130:131] op_sel:[1,1,0] op_sel_hi:[0,1,1] neg_lo:[1,0,0] neg_hi:[0,0,0]
    v_pk_fma_f32 v[126:127], v[128:129], v[78:79], v[126:127] op_sel:[1,1,0] op_sel_hi:[0,1,1] neg_lo:[1,0,0] neg_hi:[0,0,0]
    ds_read_b64 v[24:25], v100 offset:48
    v_pk_fma_f32 v[150:151], v[146:147], v[80:81], v[150:151] op_sel:[1,1,0] op_sel_hi:[0,1,1] neg_lo:[1,0,0] neg_hi:[0,0,0]
    v_pk_fma_f32 v[138:139], v[122:123], v[82:83], v[138:139] op_sel:[1,1,0] op_sel_hi:[0,1,1] neg_lo:[1,0,0] neg_hi:[0,0,0]
    ds_read_b64 v[42:43], v100 offset:56
    v_pk_fma_f32 v[142:143], v[116:117], v[84:85], v[142:143] op_sel:[1,1,0] op_sel_hi:[0,1,1] neg_lo:[1,0,0] neg_hi:[0,0,0]
    v_pk_fma_f32 v[140:141], v[112:113], v[86:87], v[140:141] op_sel:[1,1,0] op_sel_hi:[0,1,1] neg_lo:[1,0,0] neg_hi:[0,0,0]
    v_pk_fma_f32 v[144:145], v[148:149], v[88:89], v[144:145] op_sel:[1,1,0] op_sel_hi:[0,1,1] neg_lo:[1,0,0] neg_hi:[0,0,0]
    ds_write_b64 v6, v[114:115] offset:18432
    s_waitcnt lgkmcnt(6)
    v_pk_add_f32 v[18:19], v[14:15], v[30:31]
    v_pk_add_f32 v[12:13], v[14:15], v[30:31] neg_lo:[0,1] neg_hi:[0,1]
    s_waitcnt lgkmcnt(5)
    v_pk_add_f32 v[8:9], v[16:17], v[28:29]
    ds_write_b64 v6, v[130:131] offset:18464
    v_pk_add_f32 v[44:45], v[16:17], v[28:29] neg_lo:[0,1] neg_hi:[0,1]
    v_pk_add_f32 v[10:11], v[18:19], v[8:9]
    v_pk_add_f32 v[26:27], v[18:19], v[8:9] neg_lo:[0,1] neg_hi:[0,1]
    ds_write_b64 v6, v[126:127] offset:18496
    v_pk_add_f32 v[22:23], v[12:13], v[44:45] op_sel:[0,1] op_sel_hi:[1,0] neg_lo:[0,0] neg_hi:[0,1]
    v_pk_add_f32 v[46:47], v[12:13], v[44:45] op_sel:[0,1] op_sel_hi:[1,0] neg_lo:[0,1] neg_hi:[0,0]
    s_waitcnt lgkmcnt(4)
    v_pk_add_f32 v[34:35], v[32:33], v[24:25]
    ds_write_b64 v6, v[150:151] offset:18528
    v_pk_add_f32 v[38:39], v[32:33], v[24:25] neg_lo:[0,1] neg_hi:[0,1]
    s_waitcnt lgkmcnt(4)
    v_pk_add_f32 v[36:37], v[20:21], v[42:43]
    v_pk_add_f32 v[40:41], v[20:21], v[42:43] neg_lo:[0,1] neg_hi:[0,1]
    ds_write_b64 v6, v[138:139] offset:18560
    v_pk_add_f32 v[14:15], v[34:35], v[36:37]
    v_pk_add_f32 v[16:17], v[34:35], v[36:37] neg_lo:[0,1] neg_hi:[0,1]
    v_pk_add_f32 v[30:31], v[38:39], v[40:41] op_sel:[0,1] op_sel_hi:[1,0] neg_lo:[0,0] neg_hi:[0,1]
    ds_write_b64 v6, v[142:143] offset:18592
    v_pk_add_f32 v[28:29], v[38:39], v[40:41] op_sel:[0,1] op_sel_hi:[1,0] neg_lo:[0,1] neg_hi:[0,0]
    v_lshlrev_b32 v18, 16, v92
    v_and_b32 v19, 0xffff0000, v92
    ds_write_b64 v6, v[140:141] offset:18624
    v_lshlrev_b32 v12, 16, v93
    v_and_b32 v13, 0xffff0000, v93
    v_lshlrev_b32 v8, 16, v94
    ds_write_b64 v6, v[144:145] offset:18656
    v_and_b32 v9, 0xffff0000, v94
    v_lshlrev_b32 v44, 16, v95
    ds_read_b64 v[118:119], v100 offset:18432
    v_and_b32 v45, 0xffff0000, v95
    v_pk_mul_f32 v[32:33], v[10:11], v[18:19] op_sel:[0,0] op_sel_hi:[1,0]
    ds_read_b64 v[120:121], v100 offset:18440
    v_pk_mul_f32 v[20:21], v[22:23], v[12:13] op_sel:[0,0] op_sel_hi:[1,0]
    v_pk_mul_f32 v[24:25], v[26:27], v[8:9] op_sel:[0,0] op_sel_hi:[1,0]
    ds_read_b64 v[134:135], v100 offset:18448
    v_pk_mul_f32 v[42:43], v[46:47], v[44:45] op_sel:[0,0] op_sel_hi:[1,0]
    v_pk_fma_f32 v[32:33], v[10:11], v[18:19], v[32:33] op_sel:[1,1,0] op_sel_hi:[0,1,1] neg_lo:[1,0,0] neg_hi:[0,0,0]
    ds_read_b64 v[132:133], v100 offset:18456
    v_pk_fma_f32 v[20:21], v[22:23], v[12:13], v[20:21] op_sel:[1,1,0] op_sel_hi:[0,1,1] neg_lo:[1,0,0] neg_hi:[0,0,0]
    v_pk_fma_f32 v[24:25], v[26:27], v[8:9], v[24:25] op_sel:[1,1,0] op_sel_hi:[0,1,1] neg_lo:[1,0,0] neg_hi:[0,0,0]
    ds_read_b64 v[136:137], v100 offset:18464
    v_pk_fma_f32 v[42:43], v[46:47], v[44:45], v[42:43] op_sel:[1,1,0] op_sel_hi:[0,1,1] neg_lo:[1,0,0] neg_hi:[0,0,0]
    v_lshlrev_b32 v34, 16, v96
    ds_read_b64 v[124:125], v100 offset:18472
    v_and_b32 v35, 0xffff0000, v96
    v_lshlrev_b32 v38, 16, v97
    ds_read_b64 v[128:129], v100 offset:18480
    v_and_b32 v39, 0xffff0000, v97
    v_lshlrev_b32 v36, 16, v98
    ds_read_b64 v[146:147], v100 offset:18488
    v_and_b32 v37, 0xffff0000, v98
    v_lshlrev_b32 v40, 16, v99
    v_and_b32 v41, 0xffff0000, v99
    v_pk_mul_f32 v[10:11], v[14:15], v[34:35] op_sel:[0,0] op_sel_hi:[1,0]
    v_pk_mul_f32 v[22:23], v[30:31], v[38:39] op_sel:[0,0] op_sel_hi:[1,0]
    v_pk_mul_f32 v[26:27], v[16:17], v[36:37] op_sel:[0,0] op_sel_hi:[1,0]
    v_pk_mul_f32 v[46:47], v[28:29], v[40:41] op_sel:[0,0] op_sel_hi:[1,0]
    v_pk_fma_f32 v[10:11], v[14:15], v[34:35], v[10:11] op_sel:[1,1,0] op_sel_hi:[0,1,1] neg_lo:[1,0,0] neg_hi:[0,0,0]
    v_pk_fma_f32 v[22:23], v[30:31], v[38:39], v[22:23] op_sel:[1,1,0] op_sel_hi:[0,1,1] neg_lo:[1,0,0] neg_hi:[0,0,0]
    v_pk_fma_f32 v[26:27], v[16:17], v[36:37], v[26:27] op_sel:[1,1,0] op_sel_hi:[0,1,1] neg_lo:[1,0,0] neg_hi:[0,0,0]
    v_pk_fma_f32 v[46:47], v[28:29], v[40:41], v[46:47] op_sel:[1,1,0] op_sel_hi:[0,1,1] neg_lo:[1,0,0] neg_hi:[0,0,0]
    v_pk_add_f32 v[18:19], v[32:33], v[24:25]
    v_pk_add_f32 v[12:13], v[32:33], v[24:25] neg_lo:[0,1] neg_hi:[0,1]
    v_pk_add_f32 v[8:9], v[20:21], v[42:43]
    v_pk_add_f32 v[44:45], v[20:21], v[42:43] neg_lo:[0,1] neg_hi:[0,1]
    v_pk_add_f32 v[14:15], v[18:19], v[8:9]
    v_pk_add_f32 v[30:31], v[18:19], v[8:9] neg_lo:[0,1] neg_hi:[0,1]
    v_pk_add_f32 v[16:17], v[12:13], v[44:45] op_sel:[0,1] op_sel_hi:[1,0] neg_lo:[0,1] neg_hi:[0,0]
    v_pk_add_f32 v[28:29], v[12:13], v[44:45] op_sel:[0,1] op_sel_hi:[1,0] neg_lo:[0,0] neg_hi:[0,1]
    v_pk_add_f32 v[34:35], v[10:11], v[26:27]
    v_pk_add_f32 v[38:39], v[10:11], v[26:27] neg_lo:[0,1] neg_hi:[0,1]
    v_pk_add_f32 v[36:37], v[22:23], v[46:47]
    v_pk_add_f32 v[40:41], v[22:23], v[46:47] neg_lo:[0,1] neg_hi:[0,1]
    v_pk_add_f32 v[32:33], v[34:35], v[36:37]
    v_pk_add_f32 v[20:21], v[34:35], v[36:37] neg_lo:[0,1] neg_hi:[0,1]
    v_pk_add_f32 v[24:25], v[38:39], v[40:41] op_sel:[0,1] op_sel_hi:[1,0] neg_lo:[0,1] neg_hi:[0,0]
    v_pk_add_f32 v[42:43], v[38:39], v[40:41] op_sel:[0,1] op_sel_hi:[1,0] neg_lo:[0,0] neg_hi:[0,1]
    ds_write_b64 v100, v[14:15] offset:0
    s_waitcnt lgkmcnt(6)
    v_pk_add_f32 v[122:123], v[118:119], v[134:135]
    v_pk_add_f32 v[116:117], v[118:119], v[134:135] neg_lo:[0,1] neg_hi:[0,1]
    s_waitcnt lgkmcnt(5)
    v_pk_add_f32 v[112:113], v[120:121], v[132:133]
    ds_write_b64 v100, v[16:17] offset:8
    v_pk_add_f32 v[148:149], v[120:121], v[132:133] neg_lo:[0,1] neg_hi:[0,1]
    v_pk_add_f32 v[114:115], v[122:123], v[112:113]
    v_pk_add_f32 v[130:131], v[122:123], v[112:113] neg_lo:[0,1] neg_hi:[0,1]
    ds_write_b64 v100, v[30:31] offset:16
    v_pk_add_f32 v[126:127], v[116:117], v[148:149] op_sel:[0,1] op_sel_hi:[1,0] neg_lo:[0,0] neg_hi:[0,1]
    v_pk_add_f32 v[150:151], v[116:117], v[148:149] op_sel:[0,1] op_sel_hi:[1,0] neg_lo:[0,1] neg_hi:[0,0]
    s_waitcnt lgkmcnt(4)
    v_pk_add_f32 v[138:139], v[136:137], v[128:129]
    ds_write_b64 v100, v[28:29] offset:24
    v_pk_add_f32 v[142:143], v[136:137], v[128:129] neg_lo:[0,1] neg_hi:[0,1]
    s_waitcnt lgkmcnt(4)
    v_pk_add_f32 v[140:141], v[124:125], v[146:147]
    v_pk_add_f32 v[144:145], v[124:125], v[146:147] neg_lo:[0,1] neg_hi:[0,1]
    ds_write_b64 v100, v[32:33] offset:32
    v_pk_add_f32 v[118:119], v[138:139], v[140:141]
    v_pk_add_f32 v[120:121], v[138:139], v[140:141] neg_lo:[0,1] neg_hi:[0,1]
    v_pk_add_f32 v[134:135], v[142:143], v[144:145] op_sel:[0,1] op_sel_hi:[1,0] neg_lo:[0,0] neg_hi:[0,1]
    ds_write_b64 v100, v[24:25] offset:40
    v_pk_add_f32 v[132:133], v[142:143], v[144:145] op_sel:[0,1] op_sel_hi:[1,0] neg_lo:[0,1] neg_hi:[0,0]
    v_lshlrev_b32 v122, 16, v104
    v_and_b32 v123, 0xffff0000, v104
    ds_write_b64 v100, v[20:21] offset:48
    v_lshlrev_b32 v116, 16, v105
    v_and_b32 v117, 0xffff0000, v105
    v_lshlrev_b32 v112, 16, v106
    ds_write_b64 v100, v[42:43] offset:56
    v_and_b32 v113, 0xffff0000, v106
    v_lshlrev_b32 v148, 16, v107
    ds_read_b64 v[18:19], v6 offset:0
    v_and_b32 v149, 0xffff0000, v107
    v_pk_mul_f32 v[136:137], v[114:115], v[122:123] op_sel:[0,0] op_sel_hi:[1,0]
    ds_read_b64 v[12:13], v6 offset:32
    v_pk_mul_f32 v[124:125], v[126:127], v[116:117] op_sel:[0,0] op_sel_hi:[1,0]
    v_pk_mul_f32 v[128:129], v[130:131], v[112:113] op_sel:[0,0] op_sel_hi:[1,0]
    ds_read_b64 v[8:9], v6 offset:64
    v_pk_mul_f32 v[146:147], v[150:151], v[148:149] op_sel:[0,0] op_sel_hi:[1,0]
    v_pk_fma_f32 v[136:137], v[114:115], v[122:123], v[136:137] op_sel:[1,1,0] op_sel_hi:[0,1,1] neg_lo:[1,0,0] neg_hi:[0,0,0]
    ds_read_b64 v[44:45], v6 offset:96
    v_pk_fma_f32 v[124:125], v[126:127], v[116:117], v[124:125] op_sel:[1,1,0] op_sel_hi:[0,1,1] neg_lo:[1,0,0] neg_hi:[0,0,0]
    v_pk_fma_f32 v[128:129], v[130:131], v[112:113], v[128:129] op_sel:[1,1,0] op_sel_hi:[0,1,1] neg_lo:[1,0,0] neg_hi:[0,0,0]
    ds_read_b64 v[10:11], v6 offset:128
    v_pk_fma_f32 v[146:147], v[150:151], v[148:149], v[146:147] op_sel:[1,1,0] op_sel_hi:[0,1,1] neg_lo:[1,0,0] neg_hi:[0,0,0]
    v_lshlrev_b32 v138, 16, v108
    ds_read_b64 v[22:23], v6 offset:160
    v_and_b32 v139, 0xffff0000, v108
    v_lshlrev_b32 v142, 16, v109
    ds_read_b64 v[26:27], v6 offset:192
    v_and_b32 v143, 0xffff0000, v109
    v_lshlrev_b32 v140, 16, v110
    ds_read_b64 v[46:47], v6 offset:224
    v_and_b32 v141, 0xffff0000, v110
    v_lshlrev_b32 v144, 16, v111
    v_and_b32 v145, 0xffff0000, v111
    v_pk_mul_f32 v[114:115], v[118:119], v[138:139] op_sel:[0,0] op_sel_hi:[1,0]
    v_pk_mul_f32 v[126:127], v[134:135], v[142:143] op_sel:[0,0] op_sel_hi:[1,0]
    v_pk_mul_f32 v[130:131], v[120:121], v[140:141] op_sel:[0,0] op_sel_hi:[1,0]
    v_pk_mul_f32 v[150:151], v[132:133], v[144:145] op_sel:[0,0] op_sel_hi:[1,0]
    v_pk_fma_f32 v[114:115], v[118:119], v[138:139], v[114:115] op_sel:[1,1,0] op_sel_hi:[0,1,1] neg_lo:[1,0,0] neg_hi:[0,0,0]
    v_pk_fma_f32 v[126:127], v[134:135], v[142:143], v[126:127] op_sel:[1,1,0] op_sel_hi:[0,1,1] neg_lo:[1,0,0] neg_hi:[0,0,0]
    v_pk_fma_f32 v[130:131], v[120:121], v[140:141], v[130:131] op_sel:[1,1,0] op_sel_hi:[0,1,1] neg_lo:[1,0,0] neg_hi:[0,0,0]
    v_pk_fma_f32 v[150:151], v[132:133], v[144:145], v[150:151] op_sel:[1,1,0] op_sel_hi:[0,1,1] neg_lo:[1,0,0] neg_hi:[0,0,0]
    v_pk_add_f32 v[122:123], v[136:137], v[128:129]
    v_pk_add_f32 v[116:117], v[136:137], v[128:129] neg_lo:[0,1] neg_hi:[0,1]
    v_pk_add_f32 v[112:113], v[124:125], v[146:147]
    v_pk_add_f32 v[148:149], v[124:125], v[146:147] neg_lo:[0,1] neg_hi:[0,1]
    v_pk_add_f32 v[118:119], v[122:123], v[112:113]
    v_pk_add_f32 v[134:135], v[122:123], v[112:113] neg_lo:[0,1] neg_hi:[0,1]
    v_pk_add_f32 v[120:121], v[116:117], v[148:149] op_sel:[0,1] op_sel_hi:[1,0] neg_lo:[0,1] neg_hi:[0,0]
    v_pk_add_f32 v[132:133], v[116:117], v[148:149] op_sel:[0,1] op_sel_hi:[1,0] neg_lo:[0,0] neg_hi:[0,1]
    v_pk_add_f32 v[138:139], v[114:115], v[130:131]
    v_pk_add_f32 v[142:143], v[114:115], v[130:131] neg_lo:[0,1] neg_hi:[0,1]
    v_pk_add_f32 v[140:141], v[126:127], v[150:151]
    v_pk_add_f32 v[144:145], v[126:127], v[150:151] neg_lo:[0,1] neg_hi:[0,1]
    v_pk_add_f32 v[136:137], v[138:139], v[140:141]
    v_pk_add_f32 v[124:125], v[138:139], v[140:141] neg_lo:[0,1] neg_hi:[0,1]
    v_pk_add_f32 v[128:129], v[142:143], v[144:145] op_sel:[0,1] op_sel_hi:[1,0] neg_lo:[0,1] neg_hi:[0,0]
    v_pk_add_f32 v[146:147], v[142:143], v[144:145] op_sel:[0,1] op_sel_hi:[1,0] neg_lo:[0,0] neg_hi:[0,1]
    ds_write_b64 v100, v[118:119] offset:18432
    s_waitcnt lgkmcnt(7)
    v_pk_mul_f32 v[34:35], v[12:13], v[76:77] op_sel:[0,0] op_sel_hi:[1,0]
    s_waitcnt lgkmcnt(6)
    v_pk_mul_f32 v[38:39], v[8:9], v[78:79] op_sel:[0,0] op_sel_hi:[1,0]
    s_waitcnt lgkmcnt(5)
    v_pk_mul_f32 v[36:37], v[44:45], v[80:81] op_sel:[0,0] op_sel_hi:[1,0]
    ds_write_b64 v100, v[120:121] offset:18440
    s_waitcnt lgkmcnt(5)
    v_pk_mul_f32 v[40:41], v[10:11], v[82:83] op_sel:[0,0] op_sel_hi:[1,0]
    s_waitcnt lgkmcnt(4)
    v_pk_mul_f32 v[14:15], v[22:23], v[84:85] op_sel:[0,0] op_sel_hi:[1,0]
    s_waitcnt lgkmcnt(3)
    v_pk_mul_f32 v[16:17], v[26:27], v[86:87] op_sel:[0,0] op_sel_hi:[1,0]
    ds_write_b64 v100, v[134:135] offset:18448
    s_waitcnt lgkmcnt(3)
    v_pk_mul_f32 v[30:31], v[46:47], v[88:89] op_sel:[0,0] op_sel_hi:[1,0]
    v_pk_fma_f32 v[34:35], v[12:13], v[76:77], v[34:35] op_sel:[1,1,0] op_sel_hi:[0,1,1] neg_lo:[0,0,0] neg_hi:[1,0,0]
    v_pk_fma_f32 v[38:39], v[8:9], v[78:79], v[38:39] op_sel:[1,1,0] op_sel_hi:[0,1,1] neg_lo:[0,0,0] neg_hi:[1,0,0]
    ds_write_b64 v100, v[132:133] offset:18456
    v_pk_fma_f32 v[36:37], v[44:45], v[80:81], v[36:37] op_sel:[1,1,0] op_sel_hi:[0,1,1] neg_lo:[0,0,0] neg_hi:[1,0,0]
    v_pk_fma_f32 v[40:41], v[10:11], v[82:83], v[40:41] op_sel:[1,1,0] op_sel_hi:[0,1,1] neg_lo:[0,0,0] neg_hi:[1,0,0]
    v_pk_fma_f32 v[14:15], v[22:23], v[84:85], v[14:15] op_sel:[1,1,0] op_sel_hi:[0,1,1] neg_lo:[0,0,0] neg_hi:[1,0,0]
    ds_write_b64 v100, v[136:137] offset:18464
    v_pk_fma_f32 v[16:17], v[26:27], v[86:87], v[16:17] op_sel:[1,1,0] op_sel_hi:[0,1,1] neg_lo:[0,0,0] neg_hi:[1,0,0]
    v_pk_fma_f32 v[30:31], v[46:47], v[88:89], v[30:31] op_sel:[1,1,0] op_sel_hi:[0,1,1] neg_lo:[0,0,0] neg_hi:[1,0,0]
    v_pk_add_f32 v[28:29], v[18:19], v[40:41]
    ds_write_b64 v100, v[128:129] offset:18472
    v_pk_add_f32 v[32:33], v[18:19], v[40:41] neg_lo:[0,1] neg_hi:[0,1]
    v_pk_add_f32 v[24:25], v[34:35], v[14:15]
    v_pk_add_f32 v[20:21], v[34:35], v[14:15] neg_lo:[0,1] neg_hi:[0,1]
    ds_write_b64 v100, v[124:125] offset:18480
    v_pk_add_f32 v[42:43], v[38:39], v[16:17]
    v_pk_add_f32 v[12:13], v[38:39], v[16:17] neg_lo:[0,1] neg_hi:[0,1]
    v_pk_add_f32 v[8:9], v[36:37], v[30:31]
    ds_write_b64 v100, v[146:147] offset:18488
    v_pk_add_f32 v[44:45], v[36:37], v[30:31] neg_lo:[0,1] neg_hi:[0,1]
    v_pk_add_f32 v[10:11], v[28:29], v[42:43]
    ds_read_b64 v[122:123], v6 offset:18432
    v_pk_add_f32 v[22:23], v[28:29], v[42:43] neg_lo:[0,1] neg_hi:[0,1]
    v_pk_add_f32 v[26:27], v[24:25], v[8:9]
    ds_read_b64 v[116:117], v6 offset:18464
    v_pk_add_f32 v[46:47], v[24:25], v[8:9] neg_lo:[0,1] neg_hi:[0,1]
    v_pk_add_f32 v[18:19], v[10:11], v[26:27]
    ds_read_b64 v[112:113], v6 offset:18496
    v_pk_add_f32 v[40:41], v[10:11], v[26:27] neg_lo:[0,1] neg_hi:[0,1]
    v_pk_add_f32 v[34:35], v[22:23], v[46:47] op_sel:[0,1] op_sel_hi:[1,0] neg_lo:[0,1] neg_hi:[0,0]
    ds_read_b64 v[148:149], v6 offset:18528
    v_pk_add_f32 v[14:15], v[22:23], v[46:47] op_sel:[0,1] op_sel_hi:[1,0] neg_lo:[0,0] neg_hi:[0,1]
    v_pk_add_f32 v[38:39], v[20:21], v[20:21] op_sel:[0,1] op_sel_hi:[1,0] neg_lo:[0,1] neg_hi:[0,0]
    ds_read_b64 v[114:115], v6 offset:18560
    v_pk_add_f32 v[16:17], v[44:45], v[44:45] op_sel:[0,1] op_sel_hi:[1,0] neg_lo:[1,1] neg_hi:[1,0]
    v_pk_add_f32 v[36:37], v[32:33], v[12:13] op_sel:[0,1] op_sel_hi:[1,0] neg_lo:[0,1] neg_hi:[0,0]
    ds_read_b64 v[126:127], v6 offset:18592
    v_pk_add_f32 v[30:31], v[32:33], v[12:13] op_sel:[0,1] op_sel_hi:[1,0] neg_lo:[0,0] neg_hi:[0,1]
    v_pk_add_f32 v[28:29], v[38:39], v[16:17]
    ds_read_b64 v[130:131], v6 offset:18624
    v_pk_add_f32 v[24:25], v[38:39], v[16:17] neg_lo:[0,1] neg_hi:[0,1]
    v_pk_fma_f32 v[42:43], v[28:29], s[26:27], v[36:37] neg_lo:[0,0,0] neg_hi:[0,0,0]
    ds_read_b64 v[150:151], v6 offset:18656
    v_pk_fma_f32 v[8:9], v[28:29], s[26:27], v[36:37] neg_lo:[1,0,0] neg_hi:[1,0,0]
    v_pk_fma_f32 v[10:11], v[24:25], s[26:27], v[30:31] op_sel:[1,0,0] op_sel_hi:[0,1,1] neg_lo:[1,0,0] neg_hi:[0,0,0]
    v_pk_fma_f32 v[22:23], v[24:25], s[26:27], v[30:31] op_sel:[1,0,0] op_sel_hi:[0,1,1] neg_lo:[0,0,0] neg_hi:[1,0,0]
    ds_write_b64 v6, v[18:19] offset:0
    s_waitcnt lgkmcnt(7)
    v_pk_mul_f32 v[138:139], v[116:117], v[76:77] op_sel:[0,0] op_sel_hi:[1,0]
    s_waitcnt lgkmcnt(6)
    v_pk_mul_f32 v[142:143], v[112:113], v[78:79] op_sel:[0,0] op_sel_hi:[1,0]
    s_waitcnt lgkmcnt(5)
    v_pk_mul_f32 v[140:141], v[148:149], v[80:81] op_sel:[0,0] op_sel_hi:[1,0]
    ds_write_b64 v6, v[42:43] offset:32
    s_waitcnt lgkmcnt(5)
    v_pk_mul_f32 v[144:145], v[114:115], v[82:83] op_sel:[0,0] op_sel_hi:[1,0]
    s_waitcnt lgkmcnt(4)
    v_pk_mul_f32 v[118:119], v[126:127], v[84:85] op_sel:[0,0] op_sel_hi:[1,0]
    s_waitcnt lgkmcnt(3)
    v_pk_mul_f32 v[120:121], v[130:131], v[86:87] op_sel:[0,0] op_sel_hi:[1,0]
    ds_write_b64 v6, v[34:35] offset:64
    s_waitcnt lgkmcnt(3)
    v_pk_mul_f32 v[134:135], v[150:151], v[88:89] op_sel:[0,0] op_sel_hi:[1,0]
    v_pk_fma_f32 v[138:139], v[116:117], v[76:77], v[138:139] op_sel:[1,1,0] op_sel_hi:[0,1,1] neg_lo:[0,0,0] neg_hi:[1,0,0]
    v_pk_fma_f32 v[142:143], v[112:113], v[78:79], v[142:143] op_sel:[1,1,0] op_sel_hi:[0,1,1] neg_lo:[0,0,0] neg_hi:[1,0,0]
    ds_write_b64 v6, v[10:11] offset:96
    v_pk_fma_f32 v[140:141], v[148:149], v[80:81], v[140:141] op_sel:[1,1,0] op_sel_hi:[0,1,1] neg_lo:[0,0,0] neg_hi:[1,0,0]
    v_pk_fma_f32 v[144:145], v[114:115], v[82:83], v[144:145] op_sel:[1,1,0] op_sel_hi:[0,1,1] neg_lo:[0,0,0] neg_hi:[1,0,0]
    v_pk_fma_f32 v[118:119], v[126:127], v[84:85], v[118:119] op_sel:[1,1,0] op_sel_hi:[0,1,1] neg_lo:[0,0,0] neg_hi:[1,0,0]
    ds_write_b64 v6, v[40:41] offset:128
    v_pk_fma_f32 v[120:121], v[130:131], v[86:87], v[120:121] op_sel:[1,1,0] op_sel_hi:[0,1,1] neg_lo:[0,0,0] neg_hi:[1,0,0]
    v_pk_fma_f32 v[134:135], v[150:151], v[88:89], v[134:135] op_sel:[1,1,0] op_sel_hi:[0,1,1] neg_lo:[0,0,0] neg_hi:[1,0,0]
    v_pk_add_f32 v[132:133], v[122:123], v[144:145]
    ds_write_b64 v6, v[8:9] offset:160
    v_pk_add_f32 v[136:137], v[122:123], v[144:145] neg_lo:[0,1] neg_hi:[0,1]
    v_pk_add_f32 v[128:129], v[138:139], v[118:119]
    v_pk_add_f32 v[124:125], v[138:139], v[118:119] neg_lo:[0,1] neg_hi:[0,1]
    ds_write_b64 v6, v[14:15] offset:192
    v_pk_add_f32 v[146:147], v[142:143], v[120:121]
    v_pk_add_f32 v[116:117], v[142:143], v[120:121] neg_lo:[0,1] neg_hi:[0,1]
    v_pk_add_f32 v[112:113], v[140:141], v[134:135]
    ds_write_b64 v6, v[22:23] offset:224
    v_pk_add_f32 v[148:149], v[140:141], v[134:135] neg_lo:[0,1] neg_hi:[0,1]
    v_pk_add_f32 v[114:115], v[132:133], v[146:147]
    ds_read_b64 v[26:27], v5 offset:0
    v_pk_add_f32 v[126:127], v[132:133], v[146:147] neg_lo:[0,1] neg_hi:[0,1]
    v_pk_add_f32 v[130:131], v[128:129], v[112:113]
    ds_read_b64 v[46:47], v5 offset:288
    v_pk_add_f32 v[150:151], v[128:129], v[112:113] neg_lo:[0,1] neg_hi:[0,1]
    v_pk_add_f32 v[122:123], v[114:115], v[130:131]
    ds_read_b64 v[32:33], v5 offset:576
    v_pk_add_f32 v[144:145], v[114:115], v[130:131] neg_lo:[0,1] neg_hi:[0,1]
    v_pk_add_f32 v[138:139], v[126:127], v[150:151] op_sel:[0,1] op_sel_hi:[1,0] neg_lo:[0,1] neg_hi:[0,0]
    ds_read_b64 v[20:21], v5 offset:864
    v_pk_add_f32 v[118:119], v[126:127], v[150:151] op_sel:[0,1] op_sel_hi:[1,0] neg_lo:[0,0] neg_hi:[0,1]
    v_pk_add_f32 v[142:143], v[124:125], v[124:125] op_sel:[0,1] op_sel_hi:[1,0] neg_lo:[0,1] neg_hi:[0,0]
    ds_read_b64 v[12:13], v5 offset:1152
    v_pk_add_f32 v[120:121], v[148:149], v[148:149] op_sel:[0,1] op_sel_hi:[1,0] neg_lo:[1,1] neg_hi:[1,0]
    v_pk_add_f32 v[140:141], v[136:137], v[116:117] op_sel:[0,1] op_sel_hi:[1,0] neg_lo:[0,1] neg_hi:[0,0]
    ds_read_b64 v[44:45], v5 offset:1440
    v_pk_add_f32 v[134:135], v[136:137], v[116:117] op_sel:[0,1] op_sel_hi:[1,0] neg_lo:[0,0] neg_hi:[0,1]
    v_pk_add_f32 v[132:133], v[142:143], v[120:121]
    ds_read_b64 v[38:39], v5 offset:1728
    v_pk_add_f32 v[128:129], v[142:143], v[120:121] neg_lo:[0,1] neg_hi:[0,1]
    v_pk_fma_f32 v[146:147], v[132:133], s[26:27], v[140:141] neg_lo:[0,0,0] neg_hi:[0,0,0]
    ds_read_b64 v[16:17], v5 offset:2016
    v_pk_fma_f32 v[112:113], v[132:133], s[26:27], v[140:141] neg_lo:[1,0,0] neg_hi:[1,0,0]
    v_pk_fma_f32 v[114:115], v[128:129], s[26:27], v[134:135] op_sel:[1,0,0] op_sel_hi:[0,1,1] neg_lo:[1,0,0] neg_hi:[0,0,0]
    v_pk_fma_f32 v[126:127], v[128:129], s[26:27], v[134:135] op_sel:[1,0,0] op_sel_hi:[0,1,1] neg_lo:[0,0,0] neg_hi:[1,0,0]
    ds_write_b64 v6, v[122:123] offset:18432
    s_waitcnt lgkmcnt(7)
    v_pk_mul_f32 v[36:37], v[46:47], v[62:63] op_sel:[0,0] op_sel_hi:[1,0]
    s_waitcnt lgkmcnt(6)
    v_pk_mul_f32 v[30:31], v[32:33], v[64:65] op_sel:[0,0] op_sel_hi:[1,0]
    s_waitcnt lgkmcnt(5)
    v_pk_mul_f32 v[28:29], v[20:21], v[66:67] op_sel:[0,0] op_sel_hi:[1,0]
    ds_write_b64 v6, v[146:147] offset:18464
    s_waitcnt lgkmcnt(5)
    v_pk_mul_f32 v[24:25], v[12:13], v[68:69] op_sel:[0,0] op_sel_hi:[1,0]
    s_waitcnt lgkmcnt(4)
    v_pk_mul_f32 v[18:19], v[44:45], v[70:71] op_sel:[0,0] op_sel_hi:[1,0]
    s_waitcnt lgkmcnt(3)
    v_pk_mul_f32 v[42:43], v[38:39], v[72:73] op_sel:[0,0] op_sel_hi:[1,0]
    ds_write_b64 v6, v[138:139] offset:18496
    s_waitcnt lgkmcnt(3)
    v_pk_mul_f32 v[34:35], v[16:17], v[74:75] op_sel:[0,0] op_sel_hi:[1,0]
    v_pk_fma_f32 v[36:37], v[46:47], v[62:63], v[36:37] op_sel:[1,1,0] op_sel_hi:[0,1,1] neg_lo:[0,0,0] neg_hi:[1,0,0]
    v_pk_fma_f32 v[30:31], v[32:33], v[64:65], v[30:31] op_sel:[1,1,0] op_sel_hi:[0,1,1] neg_lo:[0,0,0] neg_hi:[1,0,0]
    ds_write_b64 v6, v[114:115] offset:18528
    v_pk_fma_f32 v[28:29], v[20:21], v[66:67], v[28:29] op_sel:[1,1,0] op_sel_hi:[0,1,1] neg_lo:[0,0,0] neg_hi:[1,0,0]
    v_pk_fma_f32 v[24:25], v[12:13], v[68:69], v[24:25] op_sel:[1,1,0] op_sel_hi:[0,1,1] neg_lo:[0,0,0] neg_hi:[1,0,0]
    v_pk_fma_f32 v[18:19], v[44:45], v[70:71], v[18:19] op_sel:[1,1,0] op_sel_hi:[0,1,1] neg_lo:[0,0,0] neg_hi:[1,0,0]
    ds_write_b64 v6, v[144:145] offset:18560
    v_pk_fma_f32 v[42:43], v[38:39], v[72:73], v[42:43] op_sel:[1,1,0] op_sel_hi:[0,1,1] neg_lo:[0,0,0] neg_hi:[1,0,0]
    v_pk_fma_f32 v[34:35], v[16:17], v[74:75], v[34:35] op_sel:[1,1,0] op_sel_hi:[0,1,1] neg_lo:[0,0,0] neg_hi:[1,0,0]
    v_pk_add_f32 v[10:11], v[26:27], v[24:25]
    ds_write_b64 v6, v[112:113] offset:18592
    v_pk_add_f32 v[40:41], v[26:27], v[24:25] neg_lo:[0,1] neg_hi:[0,1]
    v_pk_add_f32 v[8:9], v[36:37], v[18:19]
    v_pk_add_f32 v[14:15], v[36:37], v[18:19] neg_lo:[0,1] neg_hi:[0,1]
    ds_write_b64 v6, v[118:119] offset:18624
    v_pk_add_f32 v[22:23], v[30:31], v[42:43]
    v_pk_add_f32 v[46:47], v[30:31], v[42:43] neg_lo:[0,1] neg_hi:[0,1]
    v_pk_add_f32 v[32:33], v[28:29], v[34:35]
    ds_write_b64 v6, v[126:127] offset:18656
    v_pk_add_f32 v[20:21], v[28:29], v[34:35] neg_lo:[0,1] neg_hi:[0,1]
    v_pk_add_f32 v[12:13], v[10:11], v[22:23]
    ds_read_b64 v[130:131], v5 offset:18432
    v_pk_add_f32 v[44:45], v[10:11], v[22:23] neg_lo:[0,1] neg_hi:[0,1]
    v_pk_add_f32 v[38:39], v[8:9], v[32:33]
    ds_read_b64 v[150:151], v5 offset:18720
    v_pk_add_f32 v[16:17], v[8:9], v[32:33] neg_lo:[0,1] neg_hi:[0,1]
    v_pk_add_f32 v[26:27], v[12:13], v[38:39]
    ds_read_b64 v[136:137], v5 offset:19008
    v_pk_add_f32 v[24:25], v[12:13], v[38:39] neg_lo:[0,1] neg_hi:[0,1]
    v_pk_add_f32 v[36:37], v[44:45], v[16:17] op_sel:[0,1] op_sel_hi:[1,0] neg_lo:[0,1] neg_hi:[0,0]
    ds_read_b64 v[124:125], v5 offset:19296
    v_pk_add_f32 v[18:19], v[44:45], v[16:17] op_sel:[0,1] op_sel_hi:[1,0] neg_lo:[0,0] neg_hi:[0,1]
    v_pk_add_f32 v[30:31], v[14:15], v[14:15] op_sel:[0,1] op_sel_hi:[1,0] neg_lo:[0,1] neg_hi:[0,0]
    ds_read_b64 v[116:117], v5 offset:19584
    v_pk_add_f32 v[42:43], v[20:21], v[20:21] op_sel:[0,1] op_sel_hi:[1,0] neg_lo:[1,1] neg_hi:[1,0]
    v_pk_add_f32 v[28:29], v[40:41], v[46:47] op_sel:[0,1] op_sel_hi:[1,0] neg_lo:[0,1] neg_hi:[0,0]
    ds_read_b64 v[148:149], v5 offset:19872
    v_pk_add_f32 v[34:35], v[40:41], v[46:47] op_sel:[0,1] op_sel_hi:[1,0] neg_lo:[0,0] neg_hi:[0,1]
    v_pk_add_f32 v[10:11], v[30:31], v[42:43]
    ds_read_b64 v[142:143], v5 offset:20160
    v_pk_add_f32 v[8:9], v[30:31], v[42:43] neg_lo:[0,1] neg_hi:[0,1]
    v_pk_fma_f32 v[22:23], v[10:11], s[26:27], v[28:29] neg_lo:[0,0,0] neg_hi:[0,0,0]
    ds_read_b64 v[120:121], v5 offset:20448
    v_pk_fma_f32 v[32:33], v[10:11], s[26:27], v[28:29] neg_lo:[1,0,0] neg_hi:[1,0,0]
    v_pk_fma_f32 v[12:13], v[8:9], s[26:27], v[34:35] op_sel:[1,0,0] op_sel_hi:[0,1,1] neg_lo:[1,0,0] neg_hi:[0,0,0]
    v_pk_fma_f32 v[44:45], v[8:9], s[26:27], v[34:35] op_sel:[1,0,0] op_sel_hi:[0,1,1] neg_lo:[0,0,0] neg_hi:[1,0,0]
    ds_write_b64 v5, v[26:27] offset:0
    s_waitcnt lgkmcnt(7)
    v_pk_mul_f32 v[140:141], v[150:151], v[62:63] op_sel:[0,0] op_sel_hi:[1,0]
    s_waitcnt lgkmcnt(6)
    v_pk_mul_f32 v[134:135], v[136:137], v[64:65] op_sel:[0,0] op_sel_hi:[1,0]
    s_waitcnt lgkmcnt(5)
    v_pk_mul_f32 v[132:133], v[124:125], v[66:67] op_sel:[0,0] op_sel_hi:[1,0]
    ds_write_b64 v5, v[22:23] offset:256
    s_waitcnt lgkmcnt(5)
    v_pk_mul_f32 v[128:129], v[116:117], v[68:69] op_sel:[0,0] op_sel_hi:[1,0]
    s_waitcnt lgkmcnt(4)
    v_pk_mul_f32 v[122:123], v[148:149], v[70:71] op_sel:[0,0] op_sel_hi:[1,0]
    s_waitcnt lgkmcnt(3)
    v_pk_mul_f32 v[146:147], v[142:143], v[72:73] op_sel:[0,0] op_sel_hi:[1,0]
    ds_write_b64 v5, v[36:37] offset:512
    s_waitcnt lgkmcnt(3)
    v_pk_mul_f32 v[138:139], v[120:121], v[74:75] op_sel:[0,0] op_sel_hi:[1,0]
    v_pk_fma_f32 v[140:141], v[150:151], v[62:63], v[140:141] op_sel:[1,1,0] op_sel_hi:[0,1,1] neg_lo:[0,0,0] neg_hi:[1,0,0]
    v_pk_fma_f32 v[134:135], v[136:137], v[64:65], v[134:135] op_sel:[1,1,0] op_sel_hi:[0,1,1] neg_lo:[0,0,0] neg_hi:[1,0,0]
    ds_write_b64 v5, v[12:13] offset:768
    v_pk_fma_f32 v[132:133], v[124:125], v[66:67], v[132:133] op_sel:[1,1,0] op_sel_hi:[0,1,1] neg_lo:[0,0,0] neg_hi:[1,0,0]
    v_pk_fma_f32 v[128:129], v[116:117], v[68:69], v[128:129] op_sel:[1,1,0] op_sel_hi:[0,1,1] neg_lo:[0,0,0] neg_hi:[1,0,0]
    v_pk_fma_f32 v[122:123], v[148:149], v[70:71], v[122:123] op_sel:[1,1,0] op_sel_hi:[0,1,1] neg_lo:[0,0,0] neg_hi:[1,0,0]
    ds_write_b64 v5, v[24:25] offset:1024
    v_pk_fma_f32 v[146:147], v[142:143], v[72:73], v[146:147] op_sel:[1,1,0] op_sel_hi:[0,1,1] neg_lo:[0,0,0] neg_hi:[1,0,0]
    v_pk_fma_f32 v[138:139], v[120:121], v[74:75], v[138:139] op_sel:[1,1,0] op_sel_hi:[0,1,1] neg_lo:[0,0,0] neg_hi:[1,0,0]
    v_pk_add_f32 v[114:115], v[130:131], v[128:129]
    ds_write_b64 v5, v[32:33] offset:1280
    v_pk_add_f32 v[144:145], v[130:131], v[128:129] neg_lo:[0,1] neg_hi:[0,1]
    v_pk_add_f32 v[112:113], v[140:141], v[122:123]
    v_pk_add_f32 v[118:119], v[140:141], v[122:123] neg_lo:[0,1] neg_hi:[0,1]
    ds_write_b64 v5, v[18:19] offset:1536
    v_pk_add_f32 v[126:127], v[134:135], v[146:147]
    v_pk_add_f32 v[150:151], v[134:135], v[146:147] neg_lo:[0,1] neg_hi:[0,1]
    v_pk_add_f32 v[136:137], v[132:133], v[138:139]
    ds_write_b64 v5, v[44:45] offset:1792
    v_pk_add_f32 v[124:125], v[132:133], v[138:139] neg_lo:[0,1] neg_hi:[0,1]
    v_pk_add_f32 v[116:117], v[114:115], v[126:127]
    v_pk_add_f32 v[148:149], v[114:115], v[126:127] neg_lo:[0,1] neg_hi:[0,1]
    v_pk_add_f32 v[142:143], v[112:113], v[136:137]
    v_pk_add_f32 v[120:121], v[112:113], v[136:137] neg_lo:[0,1] neg_hi:[0,1]
    v_pk_add_f32 v[130:131], v[116:117], v[142:143]
    v_pk_add_f32 v[128:129], v[116:117], v[142:143] neg_lo:[0,1] neg_hi:[0,1]
    v_pk_add_f32 v[140:141], v[148:149], v[120:121] op_sel:[0,1] op_sel_hi:[1,0] neg_lo:[0,1] neg_hi:[0,0]
    v_pk_add_f32 v[122:123], v[148:149], v[120:121] op_sel:[0,1] op_sel_hi:[1,0] neg_lo:[0,0] neg_hi:[0,1]
    v_pk_add_f32 v[134:135], v[118:119], v[118:119] op_sel:[0,1] op_sel_hi:[1,0] neg_lo:[0,1] neg_hi:[0,0]
    v_pk_add_f32 v[146:147], v[124:125], v[124:125] op_sel:[0,1] op_sel_hi:[1,0] neg_lo:[1,1] neg_hi:[1,0]
    v_pk_add_f32 v[132:133], v[144:145], v[150:151] op_sel:[0,1] op_sel_hi:[1,0] neg_lo:[0,1] neg_hi:[0,0]
    v_pk_add_f32 v[138:139], v[144:145], v[150:151] op_sel:[0,1] op_sel_hi:[1,0] neg_lo:[0,0] neg_hi:[0,1]
    v_pk_add_f32 v[114:115], v[134:135], v[146:147]
    v_pk_add_f32 v[112:113], v[134:135], v[146:147] neg_lo:[0,1] neg_hi:[0,1]
    v_pk_fma_f32 v[126:127], v[114:115], s[26:27], v[132:133] neg_lo:[0,0,0] neg_hi:[0,0,0]
    v_pk_fma_f32 v[136:137], v[114:115], s[26:27], v[132:133] neg_lo:[1,0,0] neg_hi:[1,0,0]
    v_pk_fma_f32 v[116:117], v[112:113], s[26:27], v[138:139] op_sel:[1,0,0] op_sel_hi:[0,1,1] neg_lo:[1,0,0] neg_hi:[0,0,0]
    v_pk_fma_f32 v[148:149], v[112:113], s[26:27], v[138:139] op_sel:[1,0,0] op_sel_hi:[0,1,1] neg_lo:[0,0,0] neg_hi:[1,0,0]
    ds_write_b64 v5, v[130:131] offset:18432
    ds_write_b64 v5, v[126:127] offset:18688
    ds_write_b64 v5, v[140:141] offset:18944
    ds_write_b64 v5, v[116:117] offset:19200
    ds_write_b64 v5, v[128:129] offset:19456
    ds_write_b64 v5, v[136:137] offset:19712
    ds_write_b64 v5, v[122:123] offset:19968
    ds_write_b64 v5, v[148:149] offset:20224
    s_waitcnt lgkmcnt(0)
    s_barrier
    ds_read_b64 v[38:39], v3 offset:0
    ds_read_b64 v[16:17], v3 offset:2304
    ds_read_b64 v[40:41], v3 offset:4608
    ds_read_b64 v[14:15], v3 offset:6912
    ds_read_b64 v[46:47], v3 offset:9216
    ds_read_b64 v[20:21], v3 offset:11520
    ds_read_b64 v[30:31], v3 offset:13824
    ds_read_b64 v[42:43], v3 offset:16128
    ds_read_b64 v[142:143], v3 offset:18432
    ds_read_b64 v[120:121], v3 offset:20736
    ds_read_b64 v[144:145], v3 offset:23040
    ds_read_b64 v[118:119], v3 offset:25344
    ds_read_b64 v[150:151], v3 offset:27648
    ds_read_b64 v[124:125], v3 offset:29952
    ds_read_b64 v[134:135], v3 offset:32256
    ds_read_b64 v[146:147], v3 offset:34560
    s_waitcnt lgkmcnt(14)
    v_pk_mul_f32 v[28:29], v[16:17], v[48:49] op_sel:[0,0] op_sel_hi:[1,0]
    s_waitcnt lgkmcnt(13)
    v_pk_mul_f32 v[34:35], v[40:41], v[50:51] op_sel:[0,0] op_sel_hi:[1,0]
    s_waitcnt lgkmcnt(12)
    v_pk_mul_f32 v[10:11], v[14:15], v[52:53] op_sel:[0,0] op_sel_hi:[1,0]
    s_waitcnt lgkmcnt(11)
    v_pk_mul_f32 v[8:9], v[46:47], v[54:55] op_sel:[0,0] op_sel_hi:[1,0]
    s_waitcnt lgkmcnt(10)
    v_pk_mul_f32 v[26:27], v[20:21], v[56:57] op_sel:[0,0] op_sel_hi:[1,0]
    s_waitcnt lgkmcnt(9)
    v_pk_mul_f32 v[22:23], v[30:31], v[58:59] op_sel:[0,0] op_sel_hi:[1,0]
    s_waitcnt lgkmcnt(8)
    v_pk_mul_f32 v[36:37], v[42:43], v[60:61] op_sel:[0,0] op_sel_hi:[1,0]
    v_pk_fma_f32 v[28:29], v[16:17], v[48:49], v[28:29] op_sel:[1,1,0] op_sel_hi:[0,1,1] neg_lo:[0,0,0] neg_hi:[1,0,0]
    v_pk_fma_f32 v[34:35], v[40:41], v[50:51], v[34:35] op_sel:[1,1,0] op_sel_hi:[0,1,1] neg_lo:[0,0,0] neg_hi:[1,0,0]
    v_pk_fma_f32 v[10:11], v[14:15], v[52:53], v[10:11] op_sel:[1,1,0] op_sel_hi:[0,1,1] neg_lo:[0,0,0] neg_hi:[1,0,0]
    v_pk_fma_f32 v[8:9], v[46:47], v[54:55], v[8:9] op_sel:[1,1,0] op_sel_hi:[0,1,1] neg_lo:[0,0,0] neg_hi:[1,0,0]
    v_pk_fma_f32 v[26:27], v[20:21], v[56:57], v[26:27] op_sel:[1,1,0] op_sel_hi:[0,1,1] neg_lo:[0,0,0] neg_hi:[1,0,0]
    v_pk_fma_f32 v[22:23], v[30:31], v[58:59], v[22:23] op_sel:[1,1,0] op_sel_hi:[0,1,1] neg_lo:[0,0,0] neg_hi:[1,0,0]
    v_pk_fma_f32 v[36:37], v[42:43], v[60:61], v[36:37] op_sel:[1,1,0] op_sel_hi:[0,1,1] neg_lo:[0,0,0] neg_hi:[1,0,0]
    v_pk_add_f32 v[12:13], v[38:39], v[8:9]
    v_pk_add_f32 v[24:25], v[38:39], v[8:9] neg_lo:[0,1] neg_hi:[0,1]
    v_pk_add_f32 v[32:33], v[28:29], v[26:27]
    v_pk_add_f32 v[18:19], v[28:29], v[26:27] neg_lo:[0,1] neg_hi:[0,1]
    v_pk_add_f32 v[44:45], v[34:35], v[22:23]
    v_pk_add_f32 v[16:17], v[34:35], v[22:23] neg_lo:[0,1] neg_hi:[0,1]
    v_pk_add_f32 v[40:41], v[10:11], v[36:37]
    v_pk_add_f32 v[14:15], v[10:11], v[36:37] neg_lo:[0,1] neg_hi:[0,1]
    v_pk_add_f32 v[46:47], v[12:13], v[44:45]
    v_pk_add_f32 v[20:21], v[12:13], v[44:45] neg_lo:[0,1] neg_hi:[0,1]
    v_pk_add_f32 v[30:31], v[32:33], v[40:41]
    v_pk_add_f32 v[42:43], v[32:33], v[40:41] neg_lo:[0,1] neg_hi:[0,1]
    v_pk_add_f32 v[38:39], v[46:47], v[30:31]
    v_pk_add_f32 v[8:9], v[46:47], v[30:31] neg_lo:[0,1] neg_hi:[0,1]
    v_pk_add_f32 v[28:29], v[20:21], v[42:43] op_sel:[0,1] op_sel_hi:[1,0] neg_lo:[0,1] neg_hi:[0,0]
    v_pk_add_f32 v[26:27], v[20:21], v[42:43] op_sel:[0,1] op_sel_hi:[1,0] neg_lo:[0,0] neg_hi:[0,1]
    v_pk_add_f32 v[34:35], v[18:19], v[18:19] op_sel:[0,1] op_sel_hi:[1,0] neg_lo:[0,1] neg_hi:[0,0]
    v_pk_add_f32 v[22:23], v[14:15], v[14:15] op_sel:[0,1] op_sel_hi:[1,0] neg_lo:[1,1] neg_hi:[1,0]
    v_pk_add_f32 v[10:11], v[24:25], v[16:17] op_sel:[0,1] op_sel_hi:[1,0] neg_lo:[0,1] neg_hi:[0,0]
    v_pk_add_f32 v[36:37], v[24:25], v[16:17] op_sel:[0,1] op_sel_hi:[1,0] neg_lo:[0,0] neg_hi:[0,1]
    v_pk_add_f32 v[12:13], v[34:35], v[22:23]
    v_pk_add_f32 v[32:33], v[34:35], v[22:23] neg_lo:[0,1] neg_hi:[0,1]
    v_pk_fma_f32 v[44:45], v[12:13], s[26:27], v[10:11] neg_lo:[0,0,0] neg_hi:[0,0,0]
    v_pk_fma_f32 v[40:41], v[12:13], s[26:27], v[10:11] neg_lo:[1,0,0] neg_hi:[1,0,0]
    v_pk_fma_f32 v[46:47], v[32:33], s[26:27], v[36:37] op_sel:[1,0,0] op_sel_hi:[0,1,1] neg_lo:[1,0,0] neg_hi:[0,0,0]
    v_pk_fma_f32 v[20:21], v[32:33], s[26:27], v[36:37] op_sel:[1,0,0] op_sel_hi:[0,1,1] neg_lo:[0,0,0] neg_hi:[1,0,0]
    s_waitcnt lgkmcnt(6)
    v_pk_mul_f32 v[132:133], v[120:121], v[48:49] op_sel:[0,0] op_sel_hi:[1,0]
    s_waitcnt lgkmcnt(5)
    v_pk_mul_f32 v[138:139], v[144:145], v[50:51] op_sel:[0,0] op_sel_hi:[1,0]
    s_waitcnt lgkmcnt(4)
    v_pk_mul_f32 v[114:115], v[118:119], v[52:53] op_sel:[0,0] op_sel_hi:[1,0]
    s_waitcnt lgkmcnt(3)
    v_pk_mul_f32 v[112:113], v[150:151], v[54:55] op_sel:[0,0] op_sel_hi:[1,0]
    s_waitcnt lgkmcnt(2)
    v_pk_mul_f32 v[130:131], v[124:125], v[56:57] op_sel:[0,0] op_sel_hi:[1,0]
    s_waitcnt lgkmcnt(1)
    v_pk_mul_f32 v[126:127], v[134:135], v[58:59] op_sel:[0,0] op_sel_hi:[1,0]
    s_waitcnt lgkmcnt(0)
    v_pk_mul_f32 v[140:141], v[146:147], v[60:61] op_sel:[0,0] op_sel_hi:[1,0]
    v_pk_fma_f32 v[132:133], v[120:121], v[48:49], v[132:133] op_sel:[1,1,0] op_sel_hi:[0,1,1] neg_lo:[0,0,0] neg_hi:[1,0,0]
    v_pk_fma_f32 v[138:139], v[144:145], v[50:51], v[138:139] op_sel:[1,1,0] op_sel_hi:[0,1,1] neg_lo:[0,0,0] neg_hi:[1,0,0]
    v_pk_fma_f32 v[114:115], v[118:119], v[52:53], v[114:115] op_sel:[1,1,0] op_sel_hi:[0,1,1] neg_lo:[0,0,0] neg_hi:[1,0,0]
    v_pk_fma_f32 v[112:113], v[150:151], v[54:55], v[112:113] op_sel:[1,1,0] op_sel_hi:[0,1,1] neg_lo:[0,0,0] neg_hi:[1,0,0]
    v_pk_fma_f32 v[130:131], v[124:125], v[56:57], v[130:131] op_sel:[1,1,0] op_sel_hi:[0,1,1] neg_lo:[0,0,0] neg_hi:[1,0,0]
    v_pk_fma_f32 v[126:127], v[134:135], v[58:59], v[126:127] op_sel:[1,1,0] op_sel_hi:[0,1,1] neg_lo:[0,0,0] neg_hi:[1,0,0]
    v_pk_fma_f32 v[140:141], v[146:147], v[60:61], v[140:141] op_sel:[1,1,0] op_sel_hi:[0,1,1] neg_lo:[0,0,0] neg_hi:[1,0,0]
    v_pk_add_f32 v[116:117], v[142:143], v[112:113]
    v_pk_add_f32 v[128:129], v[142:143], v[112:113] neg_lo:[0,1] neg_hi:[0,1]
    v_pk_add_f32 v[136:137], v[132:133], v[130:131]
    v_pk_add_f32 v[122:123], v[132:133], v[130:131] neg_lo:[0,1] neg_hi:[0,1]
    v_pk_add_f32 v[148:149], v[138:139], v[126:127]
    v_pk_add_f32 v[120:121], v[138:139], v[126:127] neg_lo:[0,1] neg_hi:[0,1]
    v_pk_add_f32 v[144:145], v[114:115], v[140:141]
    v_pk_add_f32 v[118:119], v[114:115], v[140:141] neg_lo:[0,1] neg_hi:[0,1]
    v_pk_add_f32 v[150:151], v[116:117], v[148:149]
    v_pk_add_f32 v[124:125], v[116:117], v[148:149] neg_lo:[0,1] neg_hi:[0,1]
    v_pk_add_f32 v[134:135], v[136:137], v[144:145]
    v_pk_add_f32 v[146:147], v[136:137], v[144:145] neg_lo:[0,1] neg_hi:[0,1]
    v_pk_add_f32 v[142:143], v[150:151], v[134:135]
    v_pk_add_f32 v[112:113], v[150:151], v[134:135] neg_lo:[0,1] neg_hi:[0,1]
    v_pk_add_f32 v[132:133], v[124:125], v[146:147] op_sel:[0,1] op_sel_hi:[1,0] neg_lo:[0,1] neg_hi:[0,0]
    v_pk_add_f32 v[130:131], v[124:125], v[146:147] op_sel:[0,1] op_sel_hi:[1,0] neg_lo:[0,0] neg_hi:[0,1]
    v_pk_add_f32 v[138:139], v[122:123], v[122:123] op_sel:[0,1] op_sel_hi:[1,0] neg_lo:[0,1] neg_hi:[0,0]
    v_pk_add_f32 v[126:127], v[118:119], v[118:119] op_sel:[0,1] op_sel_hi:[1,0] neg_lo:[1,1] neg_hi:[1,0]
    v_pk_add_f32 v[114:115], v[128:129], v[120:121] op_sel:[0,1] op_sel_hi:[1,0] neg_lo:[0,1] neg_hi:[0,0]
    v_pk_add_f32 v[140:141], v[128:129], v[120:121] op_sel:[0,1] op_sel_hi:[1,0] neg_lo:[0,0] neg_hi:[0,1]
    v_pk_add_f32 v[116:117], v[138:139], v[126:127]
    v_pk_add_f32 v[136:137], v[138:139], v[126:127] neg_lo:[0,1] neg_hi:[0,1]
    v_pk_fma_f32 v[148:149], v[116:117], s[26:27], v[114:115] neg_lo:[0,0,0] neg_hi:[0,0,0]
    v_pk_fma_f32 v[144:145], v[116:117], s[26:27], v[114:115] neg_lo:[1,0,0] neg_hi:[1,0,0]
    v_pk_fma_f32 v[150:151], v[136:137], s[26:27], v[140:141] op_sel:[1,0,0] op_sel_hi:[0,1,1] neg_lo:[1,0,0] neg_hi:[0,0,0]
    v_pk_fma_f32 v[124:125], v[136:137], s[26:27], v[140:141] op_sel:[1,0,0] op_sel_hi:[0,1,1] neg_lo:[0,0,0] neg_hi:[1,0,0]
    s_mul_i32 s22, s101, 3145728
    s_add_u32 s22, s22, 157286400
    s_lshl_b32 s21, s2, 14
    s_add_u32 s21, s21, s22
    s_cmp_eq_u32 s2, 0
    s_cbranch_scc1 M_fft_c0
    v_cvt_pk_bf16_f32 v38, v38, v39
    v_cvt_pk_bf16_f32 v39, v142, v143
    v_cvt_pk_bf16_f32 v44, v44, v45
    v_cvt_pk_bf16_f32 v45, v148, v149
    v_cvt_pk_bf16_f32 v28, v28, v29
    v_cvt_pk_bf16_f32 v29, v132, v133
    v_cvt_pk_bf16_f32 v46, v46, v47
    v_cvt_pk_bf16_f32 v47, v150, v151
    v_cvt_pk_bf16_f32 v8, v8, v9
    v_cvt_pk_bf16_f32 v9, v112, v113
    v_cvt_pk_bf16_f32 v40, v40, v41
    v_cvt_pk_bf16_f32 v41, v144, v145
    v_cvt_pk_bf16_f32 v26, v26, v27
    v_cvt_pk_bf16_f32 v27, v130, v131
    v_cvt_pk_bf16_f32 v20, v20, v21
    v_cvt_pk_bf16_f32 v21, v124, v125
    s_cmp_eq_u32 s2, 160
    s_cbranch_scc1 M_fft_c1
    buffer_store_dwordx2 v[38:39], v101, s[8:11], s21 offen offset:0 sc1
    buffer_store_dwordx2 v[44:45], v101, s[8:11], s21 offen offset:2048 sc1
    s_add_u32 s21, s21, 4096
    buffer_store_dwordx2 v[28:29], v101, s[8:11], s21 offen offset:0 sc1
    buffer_store_dwordx2 v[46:47], v101, s[8:11], s21 offen offset:2048 sc1
    s_add_u32 s21, s21, 4096
    buffer_store_dwordx2 v[8:9], v101, s[8:11], s21 offen offset:0 sc1
    buffer_store_dwordx2 v[40:41], v101, s[8:11], s21 offen offset:2048 sc1
    s_add_u32 s21, s21, 4096
    buffer_store_dwordx2 v[26:27], v101, s[8:11], s21 offen offset:0 sc1
    buffer_store_dwordx2 v[20:21], v101, s[8:11], s21 offen offset:2048 sc1
    s_add_u32 s21, s21, 4096
    s_branch M_fft_end
M_fft_c0:
    v_cvt_pk_bf16_f32 v38, v38, v142
    v_cvt_pk_bf16_f32 v44, v44, v148
    v_cvt_pk_bf16_f32 v28, v28, v132
    v_cvt_pk_bf16_f32 v46, v46, v150
    v_cvt_pk_bf16_f32 v8, v8, v112
    v_cvt_pk_bf16_f32 v40, v40, v144
    v_cvt_pk_bf16_f32 v26, v26, v130
    v_cvt_pk_bf16_f32 v20, v20, v124
    s_sub_u32 s22, s22, 4
M_fft_c1:
    buffer_store_dword v38, v101, s[8:11], s22 offen offset:4 sc1
    buffer_store_dword v44, v101, s[8:11], s22 offen offset:2052 sc1
    s_add_u32 s22, s22, 4096
    buffer_store_dword v28, v101, s[8:11], s22 offen offset:4 sc1
    buffer_store_dword v46, v101, s[8:11], s22 offen offset:2052 sc1
    s_add_u32 s22, s22, 4096
    buffer_store_dword v8, v101, s[8:11], s22 offen offset:4 sc1
    buffer_store_dword v40, v101, s[8:11], s22 offen offset:2052 sc1
    s_add_u32 s22, s22, 4096
    buffer_store_dword v26, v101, s[8:11], s22 offen offset:4 sc1
    buffer_store_dword v20, v101, s[8:11], s22 offen offset:2052 sc1
    s_add_u32 s22, s22, 4096
M_fft_end:
    s_waitcnt vmcnt(0) lgkmcnt(0)
    s_barrier
    s_cmp_lg_u32 s83, 0
    s_cbranch_scc1 M_gb_35
    s_mov_b32 s23, s85
    s_add_u32 s28, s86, 167841792
    s_lshl_b32 s27, s82, 7
    s_mov_b64 exec, 1
    s_add_u32 s31, s27, s84
    v_mov_b32 v190, s31
    v_mov_b32 v191, 1
    s_cmp_lg_u32 s23, 0
    s_cbranch_scc1 M_ls_36
    buffer_store_byte v191, v190, s[8:11], s28 offen
M_ls_36_r:
    s_cmp_lg_u32 s84, 31
    s_cbranch_scc1 M_gb_33
    s_mov_b64 exec, -1
    v_mbcnt_lo_u32_b32 v189, -1, 0
    s_mov_b64 exec, 0xff
    v_lshl_add_u32 v190, v189, 2, s27
    s_mov_b32 s30, 0
M_gs_37:
    buffer_load_dword v191, v190, s[8:11], s28 offen sc1
    s_add_u32 s30, s30, 1
    s_cmp_ge_u32 s30, 240000
    s_cbranch_scc1 M_fail
    s_waitcnt vmcnt(0)
    v_cmp_ne_u32 vcc, 0x1010101, v191
    s_cbranch_vccnz M_gs_37
    s_mov_b64 exec, 1
    v_mov_b32 v190, s27
    v_mov_b32 v191, 1
    buffer_store_dword v191, v190, s[8:11], s28 offen offset:1024 sc1
M_gb_33:
    s_mov_b64 exec, -1
M_gb_35:
    s_cmp_lg_u32 s83, 0
    s_cbranch_scc1 M_gb_34
    s_add_u32 s28, s86, 167841792
    v_mbcnt_lo_u32_b32 v189, -1, 0
    s_mov_b64 exec, 0x3f
    v_lshlrev_b32 v190, 7, v189
    v_add_u32 v190, 1024, v190
    s_mov_b32 s30, 0
M_gs_38:
    buffer_load_dword v191, v190, s[8:11], s28 offen sc1
    s_add_u32 s30, s30, 1
    s_cmp_ge_u32 s30, 240000
    s_cbranch_scc1 M_fail
    s_waitcnt vmcnt(0)
    v_cmp_ne_u32 vcc, 0x1, v191
    s_cbranch_vccnz M_gs_38
    s_mov_b64 exec, -1
M_gb_34:
    s_barrier
    s_cmp_ge_u32 s89, 64
    s_cbranch_scc1 M_noid
    v_mbcnt_lo_u32_b32 v0, -1, 0
    v_mbcnt_hi_u32_b32 v0, -1, v0
    s_mov_b32 s23, s85
    v_lshlrev_b32 v1, 4, v0
    v_lshrrev_b32 v3, 4, v0
    v_and_b32 v4, 15, v0
    v_lshlrev_b32 v2, 15, v3
    v_lshl_add_u32 v2, v4, 4, v2
    s_mul_i32 s24, s101, 3145728
    s_lshl_b32 s25, s89, 8
    s_add_u32 s24, s24, s25
    s_add_u32 s24, s24, 157286400
    s_add_u32 s25, s24, 0
    buffer_load_dwordx4 v[64:67], v2, s[8:11], s25 offen sc1
    s_add_u32 s25, s24, 16384
    buffer_load_dwordx4 v[68:71], v2, s[8:11], s25 offen sc1
    s_add_u32 s25, s24, 131072
    buffer_load_dwordx4 v[72:75], v2, s[8:11], s25 offen sc1
    s_add_u32 s25, s24, 147456
    buffer_load_dwordx4 v[76:79], v2, s[8:11], s25 offen sc1
    s_add_u32 s25, s24, 262144
    buffer_load_dwordx4 v[80:83], v2, s[8:11], s25 offen sc1
    s_add_u32 s25, s24, 278528
    buffer_load_dwordx4 v[84:87], v2, s[8:11], s25 offen sc1
    s_add_u32 s25, s24, 393216
    buffer_load_dwordx4 v[88:91], v2, s[8:11], s25 offen sc1
    s_add_u32 s25, s24, 409600
    buffer_load_dwordx4 v[92:95], v2, s[8:11], s25 offen sc1
    s_add_u32 s25, s24, 524288
    buffer_load_dwordx4 v[96:99], v2, s[8:11], s25 offen sc1
    s_add_u32 s25, s24, 540672
    buffer_load_dwordx4 v[100:103], v2, s[8:11], s25 offen sc1
    s_add_u32 s25, s24, 655360
    buffer_load_dwordx4 v[104:107], v2, s[8:11], s25 offen sc1
    s_add_u32 s25, s24, 671744
    buffer_load_dwordx4 v[108:111], v2, s[8:11], s25 offen sc1
    s_add_u32 s25, s24, 786432
    buffer_load_dwordx4 v[112:115], v2, s[8:11], s25 offen sc1
    s_add_u32 s25, s24, 802816
    buffer_load_dwordx4 v[116:119], v2, s[8:11], s25 offen sc1
    s_add_u32 s25, s24, 917504
    buffer_load_dwordx4 v[120:123], v2, s[8:11], s25 offen sc1
    s_add_u32 s25, s24, 933888
    buffer_load_dwordx4 v[124:127], v2, s[8:11], s25 offen sc1
    s_mul_i32 s29, s89, 40960
    v_mul_u32_u24 v5, 1280, v4
    v_lshl_add_u32 v5, v3, 4, v5
    v_add_u32 v6, 40960, v1
    s_lshl_b32 s31, s88, 7
    s_add_u32 s30, s29, s31
    s_add_u32 s31, s30, s80
    s_add_u32 s32, s31, 20480
    s_add_u32 s33, s30, 20480
    ds_read_b128 v[44:47], v1 offset:0
    ds_read_b128 v[48:51], v1 offset:20480
    ds_read_b128 v[52:55], v6 offset:0
    ds_read_b128 v[56:59], v6 offset:20480
    s_waitcnt vmcnt(14)
    v_swap_b32 v66, v68
    v_swap_b32 v67, v69
    s_waitcnt lgkmcnt(3)
    s_nop 0
    v_mfma_f32_16x16x32_bf16 v[12:15], v[44:47], v[64:67], 0
    ds_read_b128 v[60:63], v1 offset:1024
    v_mfma_f32_16x16x32_bf16 v[28:31], v[44:47], v[68:71], 0
    s_waitcnt lgkmcnt(3)
    v_mfma_f32_16x16x32_bf16 v[16:19], v[48:51], v[64:67], 0
    ds_read_b128 v[44:47], v1 offset:21504
    v_mfma_f32_16x16x32_bf16 v[32:35], v[48:51], v[68:71], 0
    s_waitcnt lgkmcnt(3)
    v_mfma_f32_16x16x32_bf16 v[20:23], v[52:55], v[64:67], 0
    ds_read_b128 v[48:51], v6 offset:1024
    v_mfma_f32_16x16x32_bf16 v[36:39], v[52:55], v[68:71], 0
    s_waitcnt vmcnt(12)
    v_swap_b32 v74, v76
    v_swap_b32 v75, v77
    s_waitcnt lgkmcnt(3)
    v_mfma_f32_16x16x32_bf16 v[24:27], v[56:59], v[64:67], 0
    ds_read_b128 v[52:55], v6 offset:21504
    v_mfma_f32_16x16x32_bf16 v[40:43], v[56:59], v[68:71], 0
    s_add_u32 s25, s24, 1048576
    buffer_load_dwordx4 v[128:131], v2, s[8:11], s25 offen sc1
    s_add_u32 s25, s24, 1064960
    buffer_load_dwordx4 v[132:135], v2, s[8:11], s25 offen sc1
    s_add_u32 s25, s24, 1179648
    buffer_load_dwordx4 v[136:139], v2, s[8:11], s25 offen sc1
    s_add_u32 s25, s24, 1196032
    buffer_load_dwordx4 v[140:143], v2, s[8:11], s25 offen sc1
    s_add_u32 s25, s24, 1310720
    buffer_load_dwordx4 v[144:147], v2, s[8:11], s25 offen sc1
    s_add_u32 s25, s24, 1327104
    buffer_load_dwordx4 v[148:151], v2, s[8:11], s25 offen sc1
    s_add_u32 s25, s24, 1441792
    buffer_load_dwordx4 v[152:155], v2, s[8:11], s25 offen sc1
    s_add_u32 s25, s24, 1458176
    buffer_load_dwordx4 v[156:159], v2, s[8:11], s25 offen sc1
    s_waitcnt lgkmcnt(3)
    v_mfma_f32_16x16x32_bf16 v[12:15], v[60:63], v[72:75], v[12:15]
    ds_read_b128 v[56:59], v1 offset:2048
    v_mfma_f32_16x16x32_bf16 v[28:31], v[60:63], v[76:79], v[28:31]
    s_waitcnt lgkmcnt(3)
    v_mfma_f32_16x16x32_bf16 v[16:19], v[44:47], v[72:75], v[16:19]
    ds_read_b128 v[60:63], v1 offset:22528
    v_mfma_f32_16x16x32_bf16 v[32:35], v[44:47], v[76:79], v[32:35]
    s_waitcnt lgkmcnt(3)
    v_mfma_f32_16x16x32_bf16 v[20:23], v[48:51], v[72:75], v[20:23]
    ds_read_b128 v[44:47], v6 offset:2048
    v_mfma_f32_16x16x32_bf16 v[36:39], v[48:51], v[76:79], v[36:39]
    s_waitcnt vmcnt(18)
    v_swap_b32 v82, v84
    v_swap_b32 v83, v85
    s_waitcnt lgkmcnt(3)
    v_mfma_f32_16x16x32_bf16 v[24:27], v[52:55], v[72:75], v[24:27]
    ds_read_b128 v[48:51], v6 offset:22528
    v_mfma_f32_16x16x32_bf16 v[40:43], v[52:55], v[76:79], v[40:43]
    s_waitcnt lgkmcnt(3)
    v_mfma_f32_16x16x32_bf16 v[12:15], v[56:59], v[80:83], v[12:15]
    ds_read_b128 v[52:55], v1 offset:3072
    v_mfma_f32_16x16x32_bf16 v[28:31], v[56:59], v[84:87], v[28:31]
    s_waitcnt lgkmcnt(3)
    v_mfma_f32_16x16x32_bf16 v[16:19], v[60:63], v[80:83], v[16:19]
    ds_read_b128 v[56:59], v1 offset:23552
    v_mfma_f32_16x16x32_bf16 v[32:35], v[60:63], v[84:87], v[32:35]
    s_waitcnt lgkmcnt(3)
    v_mfma_f32_16x16x32_bf16 v[20:23], v[44:47], v[80:83], v[20:23]
    ds_read_b128 v[60:63], v6 offset:3072
    v_mfma_f32_16x16x32_bf16 v[36:39], v[44:47], v[84:87], v[36:39]
    s_waitcnt vmcnt(16)
    v_swap_b32 v90, v92
    v_swap_b32 v91, v93
    s_waitcnt lgkmcnt(3)
    v_mfma_f32_16x16x32_bf16 v[24:27], v[48:51], v[80:83], v[24:27]
    ds_read_b128 v[44:47], v6 offset:23552
    v_mfma_f32_16x16x32_bf16 v[40:43], v[48:51], v[84:87], v[40:43]
    s_add_u32 s25, s24, 1572864
    buffer_load_dwordx4 v[160:163], v2, s[8:11], s25 offen sc1
    s_add_u32 s25, s24, 1589248
    buffer_load_dwordx4 v[164:167], v2, s[8:11], s25 offen sc1
    s_add_u32 s25, s24, 1703936
    buffer_load_dwordx4 v[168:171], v2, s[8:11], s25 offen sc1
    s_add_u32 s25, s24, 1720320
    buffer_load_dwordx4 v[172:175], v2, s[8:11], s25 offen sc1
    s_add_u32 s25, s24, 1835008
    buffer_load_dwordx4 v[176:179], v2, s[8:11], s25 offen sc1
    s_add_u32 s25, s24, 1851392
    buffer_load_dwordx4 v[180:183], v2, s[8:11], s25 offen sc1
    s_add_u32 s25, s24, 1966080
    buffer_load_dwordx4 v[64:67], v2, s[8:11], s25 offen sc1
    s_add_u32 s25, s24, 1982464
    buffer_load_dwordx4 v[68:71], v2, s[8:11], s25 offen sc1
    s_waitcnt lgkmcnt(3)
    v_mfma_f32_16x16x32_bf16 v[12:15], v[52:55], v[88:91], v[12:15]
    ds_read_b128 v[48:51], v1 offset:4096
    v_mfma_f32_16x16x32_bf16 v[28:31], v[52:55], v[92:95], v[28:31]
    s_waitcnt lgkmcnt(3)
    v_mfma_f32_16x16x32_bf16 v[16:19], v[56:59], v[88:91], v[16:19]
    ds_read_b128 v[52:55], v1 offset:24576
    v_mfma_f32_16x16x32_bf16 v[32:35], v[56:59], v[92:95], v[32:35]
    s_waitcnt lgkmcnt(3)
    v_mfma_f32_16x16x32_bf16 v[20:23], v[60:63], v[88:91], v[20:23]
    ds_read_b128 v[56:59], v6 offset:4096
    v_mfma_f32_16x16x32_bf16 v[36:39], v[60:63], v[92:95], v[36:39]
    s_waitcnt vmcnt(22)
    v_swap_b32 v98, v100
    v_swap_b32 v99, v101
    s_waitcnt lgkmcnt(3)
    v_mfma_f32_16x16x32_bf16 v[24:27], v[44:47], v[88:91], v[24:27]
    ds_read_b128 v[60:63], v6 offset:24576
    v_mfma_f32_16x16x32_bf16 v[40:43], v[44:47], v[92:95], v[40:43]
    s_waitcnt lgkmcnt(3)
    v_mfma_f32_16x16x32_bf16 v[12:15], v[48:51], v[96:99], v[12:15]
    ds_read_b128 v[44:47], v1 offset:5120
    v_mfma_f32_16x16x32_bf16 v[28:31], v[48:51], v[100:103], v[28:31]
    s_waitcnt lgkmcnt(3)
    v_mfma_f32_16x16x32_bf16 v[16:19], v[52:55], v[96:99], v[16:19]
    ds_read_b128 v[48:51], v1 offset:25600
    v_mfma_f32_16x16x32_bf16 v[32:35], v[52:55], v[100:103], v[32:35]
    s_waitcnt lgkmcnt(3)
    v_mfma_f32_16x16x32_bf16 v[20:23], v[56:59], v[96:99], v[20:23]
    ds_read_b128 v[52:55], v6 offset:5120
    v_mfma_f32_16x16x32_bf16 v[36:39], v[56:59], v[100:103], v[36:39]
    s_waitcnt vmcnt(20)
    v_swap_b32 v106, v108
    v_swap_b32 v107, v109
    s_waitcnt lgkmcnt(3)
    v_mfma_f32_16x16x32_bf16 v[24:27], v[60:63], v[96:99], v[24:27]
    ds_read_b128 v[56:59], v6 offset:25600
    v_mfma_f32_16x16x32_bf16 v[40:43], v[60:63], v[100:103], v[40:43]
    s_add_u32 s25, s24, 2097152
    buffer_load_dwordx4 v[72:75], v2, s[8:11], s25 offen sc1
    s_add_u32 s25, s24, 2113536
    buffer_load_dwordx4 v[76:79], v2, s[8:11], s25 offen sc1
    s_add_u32 s25, s24, 2228224
    buffer_load_dwordx4 v[80:83], v2, s[8:11], s25 offen sc1
    s_add_u32 s25, s24, 2244608
    buffer_load_dwordx4 v[84:87], v2, s[8:11], s25 offen sc1
    s_add_u32 s25, s24, 2359296
    buffer_load_dwordx4 v[88:91], v2, s[8:11], s25 offen sc1
    s_add_u32 s25, s24, 2375680
    buffer_load_dwordx4 v[92:95], v2, s[8:11], s25 offen sc1
    s_add_u32 s25, s24, 2490368
    buffer_load_dwordx4 v[96:99], v2, s[8:11], s25 offen sc1
    s_add_u32 s25, s24, 2506752
    buffer_load_dwordx4 v[100:103], v2, s[8:11], s25 offen sc1
    s_waitcnt lgkmcnt(3)
    v_mfma_f32_16x16x32_bf16 v[12:15], v[44:47], v[104:107], v[12:15]
    ds_read_b128 v[60:63], v1 offset:6144
    v_mfma_f32_16x16x32_bf16 v[28:31], v[44:47], v[108:111], v[28:31]
    s_waitcnt lgkmcnt(3)
    v_mfma_f32_16x16x32_bf16 v[16:19], v[48:51], v[104:107], v[16:19]
    ds_read_b128 v[44:47], v1 offset:26624
    v_mfma_f32_16x16x32_bf16 v[32:35], v[48:51], v[108:111], v[32:35]
    s_waitcnt lgkmcnt(3)
    v_mfma_f32_16x16x32_bf16 v[20:23], v[52:55], v[104:107], v[20:23]
    ds_read_b128 v[48:51], v6 offset:6144
    v_mfma_f32_16x16x32_bf16 v[36:39], v[52:55], v[108:111], v[36:39]
    s_waitcnt vmcnt(26)
    v_swap_b32 v114, v116
    v_swap_b32 v115, v117
    s_waitcnt lgkmcnt(3)
    v_mfma_f32_16x16x32_bf16 v[24:27], v[56:59], v[104:107], v[24:27]
    ds_read_b128 v[52:55], v6 offset:26624
    v_mfma_f32_16x16x32_bf16 v[40:43], v[56:59], v[108:111], v[40:43]
    s_waitcnt lgkmcnt(3)
    v_mfma_f32_16x16x32_bf16 v[12:15], v[60:63], v[112:115], v[12:15]
    ds_read_b128 v[56:59], v1 offset:7168
    v_mfma_f32_16x16x32_bf16 v[28:31], v[60:63], v[116:119], v[28:31]
    s_waitcnt lgkmcnt(3)
    v_mfma_f32_16x16x32_bf16 v[16:19], v[44:47], v[112:115], v[16:19]
    ds_read_b128 v[60:63], v1 offset:27648
    v_mfma_f32_16x16x32_bf16 v[32:35], v[44:47], v[116:119], v[32:35]
    s_waitcnt lgkmcnt(3)
    v_mfma_f32_16x16x32_bf16 v[20:23], v[48:51], v[112:115], v[20:23]
    ds_read_b128 v[44:47], v6 offset:7168
    v_mfma_f32_16x16x32_bf16 v[36:39], v[48:51], v[116:119], v[36:39]
    s_waitcnt vmcnt(24)
    v_swap_b32 v122, v124
    v_swap_b32 v123, v125
    s_waitcnt lgkmcnt(3)
    v_mfma_f32_16x16x32_bf16 v[24:27], v[52:55], v[112:115], v[24:27]
    ds_read_b128 v[48:51], v6 offset:27648
    v_mfma_f32_16x16x32_bf16 v[40:43], v[52:55], v[116:119], v[40:43]
    s_waitcnt lgkmcnt(3)
    v_mfma_f32_16x16x32_bf16 v[12:15], v[56:59], v[120:123], v[12:15]
    ds_read_b128 v[52:55], v1 offset:8192
    v_mfma_f32_16x16x32_bf16 v[28:31], v[56:59], v[124:127], v[28:31]
    s_waitcnt lgkmcnt(3)
    v_mfma_f32_16x16x32_bf16 v[16:19], v[60:63], v[120:123], v[16:19]
    ds_read_b128 v[56:59], v1 offset:28672
    v_mfma_f32_16x16x32_bf16 v[32:35], v[60:63], v[124:127], v[32:35]
    s_waitcnt lgkmcnt(3)
    v_mfma_f32_16x16x32_bf16 v[20:23], v[44:47], v[120:123], v[20:23]
    ds_read_b128 v[60:63], v6 offset:8192
    v_mfma_f32_16x16x32_bf16 v[36:39], v[44:47], v[124:127], v[36:39]
    s_waitcnt vmcnt(22)
    v_swap_b32 v130, v132
    v_swap_b32 v131, v133
    s_waitcnt lgkmcnt(3)
    v_mfma_f32_16x16x32_bf16 v[24:27], v[48:51], v[120:123], v[24:27]
    ds_read_b128 v[44:47], v6 offset:28672
    v_mfma_f32_16x16x32_bf16 v[40:43], v[48:51], v[124:127], v[40:43]
    s_waitcnt lgkmcnt(3)
    v_mfma_f32_16x16x32_bf16 v[12:15], v[52:55], v[128:131], v[12:15]
    ds_read_b128 v[48:51], v1 offset:9216
    v_mfma_f32_16x16x32_bf16 v[28:31], v[52:55], v[132:135], v[28:31]
    s_waitcnt lgkmcnt(3)
    v_mfma_f32_16x16x32_bf16 v[16:19], v[56:59], v[128:131], v[16:19]
    ds_read_b128 v[52:55], v1 offset:29696
    v_mfma_f32_16x16x32_bf16 v[32:35], v[56:59], v[132:135], v[32:35]
    s_waitcnt lgkmcnt(3)
    v_mfma_f32_16x16x32_bf16 v[20:23], v[60:63], v[128:131], v[20:23]
    ds_read_b128 v[56:59], v6 offset:9216
    v_mfma_f32_16x16x32_bf16 v[36:39], v[60:63], v[132:135], v[36:39]
    s_waitcnt vmcnt(20)
    v_swap_b32 v138, v140
    v_swap_b32 v139, v141
    s_waitcnt lgkmcnt(3)
    v_mfma_f32_16x16x32_bf16 v[24:27], v[44:47], v[128:131], v[24:27]
    ds_read_b128 v[60:63], v6 offset:29696
    v_mfma_f32_16x16x32_bf16 v[40:43], v[44:47], v[132:135], v[40:43]
    s_waitcnt lgkmcnt(3)
    v_mfma_f32_16x16x32_bf16 v[12:15], v[48:51], v[136:139], v[12:15]
    ds_read_b128 v[44:47], v1 offset:10240
    v_mfma_f32_16x16x32_bf16 v[28:31], v[48:51], v[140:143], v[28:31]
    s_waitcnt lgkmcnt(3)
    v_mfma_f32_16x16x32_bf16 v[16:19], v[52:55], v[136:139], v[16:19]
    ds_read_b128 v[48:51], v1 offset:30720
    v_mfma_f32_16x16x32_bf16 v[32:35], v[52:55], v[140:143], v[32:35]
    s_waitcnt lgkmcnt(3)
    v_mfma_f32_16x16x32_bf16 v[20:23], v[56:59], v[136:139], v[20:23]
    ds_read_b128 v[52:55], v6 offset:10240
    v_mfma_f32_16x16x32_bf16 v[36:39], v[56:59], v[140:143], v[36:39]
    s_waitcnt vmcnt(18)
    v_swap_b32 v146, v148
    v_swap_b32 v147, v149
    s_waitcnt lgkmcnt(3)
    v_mfma_f32_16x16x32_bf16 v[24:27], v[60:63], v[136:139], v[24:27]
    ds_read_b128 v[56:59], v6 offset:30720
    v_mfma_f32_16x16x32_bf16 v[40:43], v[60:63], v[140:143], v[40:43]
    buffer_load_dwordx4 v[104:107], v5, s[8:11], s31 offen offset:0 sc1
    buffer_load_dwordx4 v[108:111], v5, s[8:11], s31 offen offset:64 sc1
    buffer_load_dwordx4 v[112:115], v5, s[8:11], s32 offen offset:0 sc1
    buffer_load_dwordx4 v[116:119], v5, s[8:11], s32 offen offset:64 sc1
    s_waitcnt lgkmcnt(3)
    v_mfma_f32_16x16x32_bf16 v[12:15], v[44:47], v[144:147], v[12:15]
    ds_read_b128 v[60:63], v1 offset:11264
    v_mfma_f32_16x16x32_bf16 v[28:31], v[44:47], v[148:151], v[28:31]
    s_waitcnt lgkmcnt(3)
    v_mfma_f32_16x16x32_bf16 v[16:19], v[48:51], v[144:147], v[16:19]
    ds_read_b128 v[44:47], v1 offset:31744
    v_mfma_f32_16x16x32_bf16 v[32:35], v[48:51], v[148:151], v[32:35]
    s_waitcnt lgkmcnt(3)
    v_mfma_f32_16x16x32_bf16 v[20:23], v[52:55], v[144:147], v[20:23]
    ds_read_b128 v[48:51], v6 offset:11264
    v_mfma_f32_16x16x32_bf16 v[36:39], v[52:55], v[148:151], v[36:39]
    s_waitcnt vmcnt(20)
    v_swap_b32 v154, v156
    v_swap_b32 v155, v157
    s_waitcnt lgkmcnt(3)
    v_mfma_f32_16x16x32_bf16 v[24:27], v[56:59], v[144:147], v[24:27]
    ds_read_b128 v[52:55], v6 offset:31744
    v_mfma_f32_16x16x32_bf16 v[40:43], v[56:59], v[148:151], v[40:43]
    s_waitcnt lgkmcnt(3)
    v_mfma_f32_16x16x32_bf16 v[12:15], v[60:63], v[152:155], v[12:15]
    ds_read_b128 v[56:59], v1 offset:12288
    v_mfma_f32_16x16x32_bf16 v[28:31], v[60:63], v[156:159], v[28:31]
    s_waitcnt lgkmcnt(3)
    v_mfma_f32_16x16x32_bf16 v[16:19], v[44:47], v[152:155], v[16:19]
    ds_read_b128 v[60:63], v1 offset:32768
    v_mfma_f32_16x16x32_bf16 v[32:35], v[44:47], v[156:159], v[32:35]
    s_waitcnt lgkmcnt(3)
    v_mfma_f32_16x16x32_bf16 v[20:23], v[48:51], v[152:155], v[20:23]
    ds_read_b128 v[44:47], v6 offset:12288
    v_mfma_f32_16x16x32_bf16 v[36:39], v[48:51], v[156:159], v[36:39]
    s_waitcnt vmcnt(18)
    v_swap_b32 v162, v164
    v_swap_b32 v163, v165
    s_waitcnt lgkmcnt(3)
    v_mfma_f32_16x16x32_bf16 v[24:27], v[52:55], v[152:155], v[24:27]
    ds_read_b128 v[48:51], v6 offset:32768
    v_mfma_f32_16x16x32_bf16 v[40:43], v[52:55], v[156:159], v[40:43]
    s_waitcnt lgkmcnt(3)
    v_mfma_f32_16x16x32_bf16 v[12:15], v[56:59], v[160:163], v[12:15]
    ds_read_b128 v[52:55], v1 offset:13312
    v_mfma_f32_16x16x32_bf16 v[28:31], v[56:59], v[164:167], v[28:31]
    s_waitcnt lgkmcnt(3)
    v_mfma_f32_16x16x32_bf16 v[16:19], v[60:63], v[160:163], v[16:19]
    ds_read_b128 v[56:59], v1 offset:33792
    v_mfma_f32_16x16x32_bf16 v[32:35], v[60:63], v[164:167], v[32:35]
    s_waitcnt lgkmcnt(3)
    v_mfma_f32_16x16x32_bf16 v[20:23], v[44:47], v[160:163], v[20:23]
    ds_read_b128 v[60:63], v6 offset:13312
    v_mfma_f32_16x16x32_bf16 v[36:39], v[44:47], v[164:167], v[36:39]
    s_waitcnt vmcnt(16)
    v_swap_b32 v170, v172
    v_swap_b32 v171, v173
    s_waitcnt lgkmcnt(3)
    v_mfma_f32_16x16x32_bf16 v[24:27], v[48:51], v[160:163], v[24:27]
    ds_read_b128 v[44:47], v6 offset:33792
    v_mfma_f32_16x16x32_bf16 v[40:43], v[48:51], v[164:167], v[40:43]
    s_waitcnt lgkmcnt(3)
    v_mfma_f32_16x16x32_bf16 v[12:15], v[52:55], v[168:171], v[12:15]
    ds_read_b128 v[48:51], v1 offset:14336
    v_mfma_f32_16x16x32_bf16 v[28:31], v[52:55], v[172:175], v[28:31]
    s_waitcnt lgkmcnt(3)
    v_mfma_f32_16x16x32_bf16 v[16:19], v[56:59], v[168:171], v[16:19]
    ds_read_b128 v[52:55], v1 offset:34816
    v_mfma_f32_16x16x32_bf16 v[32:35], v[56:59], v[172:175], v[32:35]
    s_waitcnt lgkmcnt(3)
    v_mfma_f32_16x16x32_bf16 v[20:23], v[60:63], v[168:171], v[20:23]
    ds_read_b128 v[56:59], v6 offset:14336
    v_mfma_f32_16x16x32_bf16 v[36:39], v[60:63], v[172:175], v[36:39]
    s_waitcnt vmcnt(14)
    v_swap_b32 v178, v180
    v_swap_b32 v179, v181
    s_waitcnt lgkmcnt(3)
    v_mfma_f32_16x16x32_bf16 v[24:27], v[44:47], v[168:171], v[24:27]
    ds_read_b128 v[60:63], v6 offset:34816
    v_mfma_f32_16x16x32_bf16 v[40:43], v[44:47], v[172:175], v[40:43]
    s_waitcnt lgkmcnt(3)
    v_mfma_f32_16x16x32_bf16 v[12:15], v[48:51], v[176:179], v[12:15]
    ds_read_b128 v[44:47], v1 offset:15360
    v_mfma_f32_16x16x32_bf16 v[28:31], v[48:51], v[180:183], v[28:31]
    s_waitcnt lgkmcnt(3)
    v_mfma_f32_16x16x32_bf16 v[16:19], v[52:55], v[176:179], v[16:19]
    ds_read_b128 v[48:51], v1 offset:35840
    v_mfma_f32_16x16x32_bf16 v[32:35], v[52:55], v[180:183], v[32:35]
    s_waitcnt lgkmcnt(3)
    v_mfma_f32_16x16x32_bf16 v[20:23], v[56:59], v[176:179], v[20:23]
    ds_read_b128 v[52:55], v6 offset:15360
    v_mfma_f32_16x16x32_bf16 v[36:39], v[56:59], v[180:183], v[36:39]
    s_waitcnt vmcnt(12)
    v_swap_b32 v66, v68
    v_swap_b32 v67, v69
    s_waitcnt lgkmcnt(3)
    v_mfma_f32_16x16x32_bf16 v[24:27], v[60:63], v[176:179], v[24:27]
    ds_read_b128 v[56:59], v6 offset:35840
    v_mfma_f32_16x16x32_bf16 v[40:43], v[60:63], v[180:183], v[40:43]
    s_waitcnt lgkmcnt(3)
    v_mfma_f32_16x16x32_bf16 v[12:15], v[44:47], v[64:67], v[12:15]
    ds_read_b128 v[60:63], v1 offset:16384
    v_mfma_f32_16x16x32_bf16 v[28:31], v[44:47], v[68:71], v[28:31]
    s_waitcnt lgkmcnt(3)
    v_mfma_f32_16x16x32_bf16 v[16:19], v[48:51], v[64:67], v[16:19]
    ds_read_b128 v[44:47], v1 offset:36864
    v_mfma_f32_16x16x32_bf16 v[32:35], v[48:51], v[68:71], v[32:35]
    s_waitcnt lgkmcnt(3)
    v_mfma_f32_16x16x32_bf16 v[20:23], v[52:55], v[64:67], v[20:23]
    ds_read_b128 v[48:51], v6 offset:16384
    v_mfma_f32_16x16x32_bf16 v[36:39], v[52:55], v[68:71], v[36:39]
    s_waitcnt vmcnt(10)
    v_swap_b32 v74, v76
    v_swap_b32 v75, v77
    s_waitcnt lgkmcnt(3)
    v_mfma_f32_16x16x32_bf16 v[24:27], v[56:59], v[64:67], v[24:27]
    ds_read_b128 v[52:55], v6 offset:36864
    v_mfma_f32_16x16x32_bf16 v[40:43], v[56:59], v[68:71], v[40:43]
    s_waitcnt lgkmcnt(3)
    v_mfma_f32_16x16x32_bf16 v[12:15], v[60:63], v[72:75], v[12:15]
    ds_read_b128 v[56:59], v1 offset:17408
    v_mfma_f32_16x16x32_bf16 v[28:31], v[60:63], v[76:79], v[28:31]
    s_waitcnt lgkmcnt(3)
    v_mfma_f32_16x16x32_bf16 v[16:19], v[44:47], v[72:75], v[16:19]
    ds_read_b128 v[60:63], v1 offset:37888
    v_mfma_f32_16x16x32_bf16 v[32:35], v[44:47], v[76:79], v[32:35]
    s_waitcnt lgkmcnt(3)
    v_mfma_f32_16x16x32_bf16 v[20:23], v[48:51], v[72:75], v[20:23]
    ds_read_b128 v[44:47], v6 offset:17408
    v_mfma_f32_16x16x32_bf16 v[36:39], v[48:51], v[76:79], v[36:39]
    s_waitcnt vmcnt(8)
    v_swap_b32 v82, v84
    v_swap_b32 v83, v85
    s_waitcnt lgkmcnt(3)
    v_mfma_f32_16x16x32_bf16 v[24:27], v[52:55], v[72:75], v[24:27]
    ds_read_b128 v[48:51], v6 offset:37888
    v_mfma_f32_16x16x32_bf16 v[40:43], v[52:55], v[76:79], v[40:43]
    s_waitcnt lgkmcnt(3)
    v_mfma_f32_16x16x32_bf16 v[12:15], v[56:59], v[80:83], v[12:15]
    ds_read_b128 v[52:55], v1 offset:18432
    v_mfma_f32_16x16x32_bf16 v[28:31], v[56:59], v[84:87], v[28:31]
    s_waitcnt lgkmcnt(3)
    v_mfma_f32_16x16x32_bf16 v[16:19], v[60:63], v[80:83], v[16:19]
    ds_read_b128 v[56:59], v1 offset:38912
    v_mfma_f32_16x16x32_bf16 v[32:35], v[60:63], v[84:87], v[32:35]
    s_waitcnt lgkmcnt(3)
    v_mfma_f32_16x16x32_bf16 v[20:23], v[44:47], v[80:83], v[20:23]
    ds_read_b128 v[60:63], v6 offset:18432
    v_mfma_f32_16x16x32_bf16 v[36:39], v[44:47], v[84:87], v[36:39]
    s_waitcnt vmcnt(6)
    v_swap_b32 v90, v92
    v_swap_b32 v91, v93
    s_waitcnt lgkmcnt(3)
    v_mfma_f32_16x16x32_bf16 v[24:27], v[48:51], v[80:83], v[24:27]
    ds_read_b128 v[44:47], v6 offset:38912
    v_mfma_f32_16x16x32_bf16 v[40:43], v[48:51], v[84:87], v[40:43]
    s_waitcnt lgkmcnt(3)
    v_mfma_f32_16x16x32_bf16 v[12:15], v[52:55], v[88:91], v[12:15]
    ds_read_b128 v[48:51], v1 offset:19456
    v_mfma_f32_16x16x32_bf16 v[28:31], v[52:55], v[92:95], v[28:31]
    s_waitcnt lgkmcnt(3)
    v_mfma_f32_16x16x32_bf16 v[16:19], v[56:59], v[88:91], v[16:19]
    ds_read_b128 v[52:55], v1 offset:39936
    v_mfma_f32_16x16x32_bf16 v[32:35], v[56:59], v[92:95], v[32:35]
    s_waitcnt lgkmcnt(3)
    v_mfma_f32_16x16x32_bf16 v[20:23], v[60:63], v[88:91], v[20:23]
    ds_read_b128 v[56:59], v6 offset:19456
    v_mfma_f32_16x16x32_bf16 v[36:39], v[60:63], v[92:95], v[36:39]
    s_waitcnt vmcnt(4)
    v_swap_b32 v98, v100
    v_swap_b32 v99, v101
    s_waitcnt lgkmcnt(3)
    v_mfma_f32_16x16x32_bf16 v[24:27], v[44:47], v[88:91], v[24:27]
    ds_read_b128 v[60:63], v6 offset:39936
    v_mfma_f32_16x16x32_bf16 v[40:43], v[44:47], v[92:95], v[40:43]
    s_waitcnt lgkmcnt(3)
    v_mfma_f32_16x16x32_bf16 v[12:15], v[48:51], v[96:99], v[12:15]
    v_mfma_f32_16x16x32_bf16 v[28:31], v[48:51], v[100:103], v[28:31]
    s_waitcnt lgkmcnt(2)
    v_mfma_f32_16x16x32_bf16 v[16:19], v[52:55], v[96:99], v[16:19]
    v_mfma_f32_16x16x32_bf16 v[32:35], v[52:55], v[100:103], v[32:35]
    s_waitcnt lgkmcnt(1)
    v_mfma_f32_16x16x32_bf16 v[20:23], v[56:59], v[96:99], v[20:23]
    v_mfma_f32_16x16x32_bf16 v[36:39], v[56:59], v[100:103], v[36:39]
    s_waitcnt lgkmcnt(0)
    v_mfma_f32_16x16x32_bf16 v[24:27], v[60:63], v[96:99], v[24:27]
    v_mfma_f32_16x16x32_bf16 v[40:43], v[60:63], v[100:103], v[40:43]
    s_waitcnt vmcnt(3)
    v_lshlrev_b32 v8, 16, v104
    v_and_b32 v9, 0xffff0000, v104
    v_pk_add_f32 v[12:13], v[12:13], v[8:9]
    v_cvt_pk_bf16_f32 v104, v12, v13
    v_lshlrev_b32 v8, 16, v105
    v_and_b32 v9, 0xffff0000, v105
    v_pk_add_f32 v[14:15], v[14:15], v[8:9]
    v_cvt_pk_bf16_f32 v105, v14, v15
    v_lshlrev_b32 v8, 16, v106
    v_and_b32 v9, 0xffff0000, v106
    v_pk_add_f32 v[16:17], v[16:17], v[8:9]
    v_cvt_pk_bf16_f32 v106, v16, v17
    v_lshlrev_b32 v8, 16, v107
    v_and_b32 v9, 0xffff0000, v107
    v_pk_add_f32 v[18:19], v[18:19], v[8:9]
    v_cvt_pk_bf16_f32 v107, v18, v19
    s_waitcnt vmcnt(2)
    v_lshlrev_b32 v8, 16, v108
    v_and_b32 v9, 0xffff0000, v108
    v_pk_add_f32 v[20:21], v[20:21], v[8:9]
    v_cvt_pk_bf16_f32 v108, v20, v21
    v_lshlrev_b32 v8, 16, v109
    v_and_b32 v9, 0xffff0000, v109
    v_pk_add_f32 v[22:23], v[22:23], v[8:9]
    v_cvt_pk_bf16_f32 v109, v22, v23
    v_lshlrev_b32 v8, 16, v110
    v_and_b32 v9, 0xffff0000, v110
    v_pk_add_f32 v[24:25], v[24:25], v[8:9]
    v_cvt_pk_bf16_f32 v110, v24, v25
    v_lshlrev_b32 v8, 16, v111
    v_and_b32 v9, 0xffff0000, v111
    v_pk_add_f32 v[26:27], v[26:27], v[8:9]
    v_cvt_pk_bf16_f32 v111, v26, v27
    s_waitcnt vmcnt(1)
    v_lshlrev_b32 v8, 16, v112
    v_and_b32 v9, 0xffff0000, v112
    v_pk_add_f32 v[28:29], v[28:29], v[8:9]
    v_cvt_pk_bf16_f32 v112, v28, v29
    v_lshlrev_b32 v8, 16, v113
    v_and_b32 v9, 0xffff0000, v113
    v_pk_add_f32 v[30:31], v[30:31], v[8:9]
    v_cvt_pk_bf16_f32 v113, v30, v31
    v_lshlrev_b32 v8, 16, v114
    v_and_b32 v9, 0xffff0000, v114
    v_pk_add_f32 v[32:33], v[32:33], v[8:9]
    v_cvt_pk_bf16_f32 v114, v32, v33
    v_lshlrev_b32 v8, 16, v115
    v_and_b32 v9, 0xffff0000, v115
    v_pk_add_f32 v[34:35], v[34:35], v[8:9]
    v_cvt_pk_bf16_f32 v115, v34, v35
    s_waitcnt vmcnt(0)
    v_lshlrev_b32 v8, 16, v116
    v_and_b32 v9, 0xffff0000, v116
    v_pk_add_f32 v[36:37], v[36:37], v[8:9]
    v_cvt_pk_bf16_f32 v116, v36, v37
    v_lshlrev_b32 v8, 16, v117
    v_and_b32 v9, 0xffff0000, v117
    v_pk_add_f32 v[38:39], v[38:39], v[8:9]
    v_cvt_pk_bf16_f32 v117, v38, v39
    v_lshlrev_b32 v8, 16, v118
    v_and_b32 v9, 0xffff0000, v118
    v_pk_add_f32 v[40:41], v[40:41], v[8:9]
    v_cvt_pk_bf16_f32 v118, v40, v41
    v_lshlrev_b32 v8, 16, v119
    v_and_b32 v9, 0xffff0000, v119
    v_pk_add_f32 v[42:43], v[42:43], v[8:9]
    v_cvt_pk_bf16_f32 v119, v42, v43
    s_cmp_eq_u32 s101, 1
    s_cbranch_scc1 M_id_out
    v_lshlrev_b32 v12, 16, v104
    v_and_b32 v13, 0xffff0000, v104
    v_lshlrev_b32 v14, 16, v105
    v_and_b32 v15, 0xffff0000, v105
    v_lshlrev_b32 v16, 16, v106
    v_and_b32 v17, 0xffff0000, v106
    v_lshlrev_b32 v18, 16, v107
    v_and_b32 v19, 0xffff0000, v107
    v_lshlrev_b32 v20, 16, v108
    v_and_b32 v21, 0xffff0000, v108
    v_lshlrev_b32 v22, 16, v109
    v_and_b32 v23, 0xffff0000, v109
    v_lshlrev_b32 v24, 16, v110
    v_and_b32 v25, 0xffff0000, v110
    v_lshlrev_b32 v26, 16, v111
    v_and_b32 v27, 0xffff0000, v111
    v_lshlrev_b32 v28, 16, v112
    v_and_b32 v29, 0xffff0000, v112
    v_lshlrev_b32 v30, 16, v113
    v_and_b32 v31, 0xffff0000, v113
    v_lshlrev_b32 v32, 16, v114
    v_and_b32 v33, 0xffff0000, v114
    v_lshlrev_b32 v34, 16, v115
    v_and_b32 v35, 0xffff0000, v115
    v_lshlrev_b32 v36, 16, v116
    v_and_b32 v37, 0xffff0000, v116
    v_lshlrev_b32 v38, 16, v117
    v_and_b32 v39, 0xffff0000, v117
    v_lshlrev_b32 v40, 16, v118
    v_and_b32 v41, 0xffff0000, v118
    v_lshlrev_b32 v42, 16, v119
    v_and_b32 v43, 0xffff0000, v119
    v_pk_add_f32 v[124:125], v[12:13], v[14:15]
    v_pk_add_f32 v[128:129], v[28:29], v[30:31]
    v_pk_add_f32 v[124:125], v[124:125], v[16:17]
    v_pk_add_f32 v[128:129], v[128:129], v[32:33]
    v_pk_add_f32 v[124:125], v[124:125], v[18:19]
    v_pk_add_f32 v[128:129], v[128:129], v[34:35]
    v_pk_add_f32 v[124:125], v[124:125], v[20:21]
    v_pk_add_f32 v[128:129], v[128:129], v[36:37]
    v_pk_add_f32 v[124:125], v[124:125], v[22:23]
    v_pk_add_f32 v[128:129], v[128:129], v[38:39]
    v_pk_add_f32 v[124:125], v[124:125], v[24:25]
    v_pk_add_f32 v[128:129], v[128:129], v[40:41]
    v_pk_add_f32 v[124:125], v[124:125], v[26:27]
    v_pk_add_f32 v[128:129], v[128:129], v[42:43]
    v_add_f32 v124, v124, v125
    v_add_f32 v128, v128, v129
    v_mov_b32 v132, v124
    v_mov_b32 v133, v128
    s_nop 0
    v_permlane16_swap_b32 v124, v132
    v_permlane16_swap_b32 v128, v133
    v_add_f32 v124, v124, v132
    v_add_f32 v128, v128, v133
    v_mov_b32 v132, v124
    v_mov_b32 v133, v128
    s_nop 0
    v_permlane32_swap_b32 v124, v132
    v_permlane32_swap_b32 v128, v133
    v_add_f32 v124, v124, v132
    v_add_f32 v128, v128, v133
    v_mul_f32 v124, 0x3c800000, v124
    v_mov_b64 v[126:127], 0
    v_mul_f32 v128, 0x3c800000, v128
    v_mov_b64 v[130:131], 0
    v_pk_add_f32 v[8:9], v[12:13], v[124:125] op_sel_hi:[1,0] neg_lo:[0,1] neg_hi:[0,1]
    v_pk_add_f32 v[10:11], v[28:29], v[128:129] op_sel_hi:[1,0] neg_lo:[0,1] neg_hi:[0,1]
    v_pk_fma_f32 v[126:127], v[8:9], v[8:9], v[126:127]
    v_pk_fma_f32 v[130:131], v[10:11], v[10:11], v[130:131]
    v_pk_add_f32 v[8:9], v[14:15], v[124:125] op_sel_hi:[1,0] neg_lo:[0,1] neg_hi:[0,1]
    v_pk_add_f32 v[10:11], v[30:31], v[128:129] op_sel_hi:[1,0] neg_lo:[0,1] neg_hi:[0,1]
    v_pk_fma_f32 v[126:127], v[8:9], v[8:9], v[126:127]
    v_pk_fma_f32 v[130:131], v[10:11], v[10:11], v[130:131]
    v_pk_add_f32 v[8:9], v[16:17], v[124:125] op_sel_hi:[1,0] neg_lo:[0,1] neg_hi:[0,1]
    v_pk_add_f32 v[10:11], v[32:33], v[128:129] op_sel_hi:[1,0] neg_lo:[0,1] neg_hi:[0,1]
    v_pk_fma_f32 v[126:127], v[8:9], v[8:9], v[126:127]
    v_pk_fma_f32 v[130:131], v[10:11], v[10:11], v[130:131]
    v_pk_add_f32 v[8:9], v[18:19], v[124:125] op_sel_hi:[1,0] neg_lo:[0,1] neg_hi:[0,1]
    v_pk_add_f32 v[10:11], v[34:35], v[128:129] op_sel_hi:[1,0] neg_lo:[0,1] neg_hi:[0,1]
    v_pk_fma_f32 v[126:127], v[8:9], v[8:9], v[126:127]
    v_pk_fma_f32 v[130:131], v[10:11], v[10:11], v[130:131]
    v_pk_add_f32 v[8:9], v[20:21], v[124:125] op_sel_hi:[1,0] neg_lo:[0,1] neg_hi:[0,1]
    v_pk_add_f32 v[10:11], v[36:37], v[128:129] op_sel_hi:[1,0] neg_lo:[0,1] neg_hi:[0,1]
    v_pk_fma_f32 v[126:127], v[8:9], v[8:9], v[126:127]
    v_pk_fma_f32 v[130:131], v[10:11], v[10:11], v[130:131]
    v_pk_add_f32 v[8:9], v[22:23], v[124:125] op_sel_hi:[1,0] neg_lo:[0,1] neg_hi:[0,1]
    v_pk_add_f32 v[10:11], v[38:39], v[128:129] op_sel_hi:[1,0] neg_lo:[0,1] neg_hi:[0,1]
    v_pk_fma_f32 v[126:127], v[8:9], v[8:9], v[126:127]
    v_pk_fma_f32 v[130:131], v[10:11], v[10:11], v[130:131]
    v_pk_add_f32 v[8:9], v[24:25], v[124:125] op_sel_hi:[1,0] neg_lo:[0,1] neg_hi:[0,1]
    v_pk_add_f32 v[10:11], v[40:41], v[128:129] op_sel_hi:[1,0] neg_lo:[0,1] neg_hi:[0,1]
    v_pk_fma_f32 v[126:127], v[8:9], v[8:9], v[126:127]
    v_pk_fma_f32 v[130:131], v[10:11], v[10:11], v[130:131]
    v_pk_add_f32 v[8:9], v[26:27], v[124:125] op_sel_hi:[1,0] neg_lo:[0,1] neg_hi:[0,1]
    v_pk_add_f32 v[10:11], v[42:43], v[128:129] op_sel_hi:[1,0] neg_lo:[0,1] neg_hi:[0,1]
    v_pk_fma_f32 v[126:127], v[8:9], v[8:9], v[126:127]
    v_pk_fma_f32 v[130:131], v[10:11], v[10:11], v[130:131]
    v_add_f32 v125, v126, v127
    v_add_f32 v129, v130, v131
    v_mov_b32 v132, v125
    v_mov_b32 v133, v129
    s_nop 0
    v_permlane16_swap_b32 v125, v132
    v_permlane16_swap_b32 v129, v133
    v_add_f32 v125, v125, v132
    v_add_f32 v129, v129, v133
    v_mov_b32 v132, v125
    v_mov_b32 v133, v129
    s_nop 0
    v_permlane32_swap_b32 v125, v132
    v_permlane32_swap_b32 v129, v133
    v_add_f32 v125, v125, v132
    v_add_f32 v129, v129, v133
    v_min_u32 v124, -2, v124
    v_min_u32 v125, -2, v125
    v_min_u32 v128, -2, v128
    v_min_u32 v129, -2, v129
    s_lshl_b32 s24, s89, 12
    s_add_u32 s24, s24, 173654016
    s_lshl_b32 s25, s88, 3
    s_add_u32 s25, s25, s24
    v_lshlrev_b32 v7, 7, v4
    v_lshl_add_u32 v2, v3, 5, v7
    s_mov_b64 exec, 0xffff
    s_cmp_lg_u32 s23, 0
    s_cbranch_scc1 M_ls_39
    buffer_store_dwordx2 v[124:125], v7, s[8:11], s25 offen offset:0
    buffer_store_dwordx2 v[128:129], v7, s[8:11], s25 offen offset:2048
M_ls_39_r:
    s_mov_b64 exec, -1
    v_cmp_gt_u32_e64 s[36:37], 3, v3
    v_cmp_gt_u32_e64 s[38:39], 2, v3
    s_mov_b32 s34, 0
M_id_poll:
    buffer_load_dwordx4 v[136:139], v2, s[8:11], s24 offen offset:0 sc1
    buffer_load_dwordx4 v[140:143], v2, s[8:11], s24 offen offset:16 sc1
    buffer_load_dwordx4 v[144:147], v2, s[8:11], s24 offen offset:2048 sc1
    buffer_load_dwordx4 v[148:151], v2, s[8:11], s24 offen offset:2064 sc1
    s_add_u32 s34, s34, 1
    s_cmp_ge_u32 s34, 60000
    s_cbranch_scc1 M_fail
    s_waitcnt vmcnt(3)
    v_cndmask_b32_e64 v136, 0, v136, s[36:37]
    v_cndmask_b32_e64 v137, 0, v137, s[36:37]
    v_cndmask_b32_e64 v138, 0, v138, s[36:37]
    v_cndmask_b32_e64 v139, 0, v139, s[36:37]
    s_waitcnt vmcnt(2)
    v_cndmask_b32_e64 v140, 0, v140, s[38:39]
    v_cndmask_b32_e64 v141, 0, v141, s[38:39]
    v_cndmask_b32_e64 v142, 0, v142, s[38:39]
    v_cndmask_b32_e64 v143, 0, v143, s[38:39]
    s_waitcnt vmcnt(1)
    v_cndmask_b32_e64 v144, 0, v144, s[36:37]
    v_cndmask_b32_e64 v145, 0, v145, s[36:37]
    v_cndmask_b32_e64 v146, 0, v146, s[36:37]
    v_cndmask_b32_e64 v147, 0, v147, s[36:37]
    s_waitcnt vmcnt(0)
    v_cndmask_b32_e64 v148, 0, v148, s[38:39]
    v_cndmask_b32_e64 v149, 0, v149, s[38:39]
    v_cndmask_b32_e64 v150, 0, v150, s[38:39]
    v_cndmask_b32_e64 v151, 0, v151, s[38:39]
    v_max3_u32 v8, v136, v137, v138
    v_max3_u32 v8, v8, v139, v140
    v_max3_u32 v8, v8, v141, v142
    v_max3_u32 v8, v8, v143, v144
    v_max3_u32 v8, v8, v145, v146
    v_max3_u32 v8, v8, v147, v148
    v_max3_u32 v8, v8, v149, v150
    v_max_u32 v8, v8, v151
    v_cmp_eq_u32 vcc, -1, v8
    s_cbranch_vccnz M_id_poll
    v_add_f32 v124, v136, v138
    v_add_f32 v125, v140, v142
    v_add_f32 v124, v124, v125
    v_add_f32 v128, v144, v146
    v_add_f32 v129, v148, v150
    v_add_f32 v128, v128, v129
    v_mov_b32 v132, v124
    v_mov_b32 v133, v128
    s_nop 0
    v_permlane16_swap_b32 v124, v132
    v_permlane16_swap_b32 v128, v133
    v_add_f32 v124, v124, v132
    v_add_f32 v128, v128, v133
    v_mov_b32 v132, v124
    v_mov_b32 v133, v128
    s_nop 0
    v_permlane32_swap_b32 v124, v132
    v_permlane32_swap_b32 v128, v133
    v_add_f32 v124, v124, v132
    v_add_f32 v128, v128, v133
    v_mul_f32 v124, 0x3dcccccd, v124
    v_add_f32 v125, v137, v139
    v_add_f32 v126, v141, v143
    v_add_f32 v125, v125, v126
    v_sub_f32 v8, v136, v124
    v_cndmask_b32_e64 v8, 0, v8, s[36:37]
    v_mul_f32 v9, 0x42800000, v8
    v_fmac_f32 v125, v8, v9
    v_sub_f32 v8, v138, v124
    v_cndmask_b32_e64 v8, 0, v8, s[36:37]
    v_mul_f32 v9, 0x42800000, v8
    v_fmac_f32 v125, v8, v9
    v_sub_f32 v8, v140, v124
    v_cndmask_b32_e64 v8, 0, v8, s[38:39]
    v_mul_f32 v9, 0x42800000, v8
    v_fmac_f32 v125, v8, v9
    v_sub_f32 v8, v142, v124
    v_cndmask_b32_e64 v8, 0, v8, s[38:39]
    v_mul_f32 v9, 0x42800000, v8
    v_fmac_f32 v125, v8, v9
    v_mul_f32 v128, 0x3dcccccd, v128
    v_add_f32 v129, v145, v147
    v_add_f32 v130, v149, v151
    v_add_f32 v129, v129, v130
    v_sub_f32 v8, v144, v128
    v_cndmask_b32_e64 v8, 0, v8, s[36:37]
    v_mul_f32 v9, 0x42800000, v8
    v_fmac_f32 v129, v8, v9
    v_sub_f32 v8, v146, v128
    v_cndmask_b32_e64 v8, 0, v8, s[36:37]
    v_mul_f32 v9, 0x42800000, v8
    v_fmac_f32 v129, v8, v9
    v_sub_f32 v8, v148, v128
    v_cndmask_b32_e64 v8, 0, v8, s[38:39]
    v_mul_f32 v9, 0x42800000, v8
    v_fmac_f32 v129, v8, v9
    v_sub_f32 v8, v150, v128
    v_cndmask_b32_e64 v8, 0, v8, s[38:39]
    v_mul_f32 v9, 0x42800000, v8
    v_fmac_f32 v129, v8, v9
    v_mov_b32 v132, v125
    v_mov_b32 v133, v129
    s_nop 0
    v_permlane16_swap_b32 v125, v132
    v_permlane16_swap_b32 v129, v133
    v_add_f32 v125, v125, v132
    v_add_f32 v129, v129, v133
    v_mov_b32 v132, v125
    v_mov_b32 v133, v129
    s_nop 0
    v_permlane32_swap_b32 v125, v132
    v_permlane32_swap_b32 v129, v133
    v_add_f32 v125, v125, v132
    v_add_f32 v129, v129, v133
    v_mov_b32 v126, 0x3727c5ac
    v_fmac_f32 v126, 0x3acccccd, v125
    v_rsq_f32 v126, v126
    v_mov_b32 v130, 0x3727c5ac
    v_fmac_f32 v130, 0x3acccccd, v129
    v_rsq_f32 v130, v130
    s_lshl_b32 s25, s88, 11
    s_add_u32 s25, s25, s29
    s_add_u32 s25, s25, 32505856
    s_add_u32 s24, s25, 20480
    v_pk_add_f32 v[12:13], v[12:13], v[124:125] op_sel_hi:[1,0] neg_lo:[0,1] neg_hi:[0,1]
    v_pk_add_f32 v[14:15], v[14:15], v[124:125] op_sel_hi:[1,0] neg_lo:[0,1] neg_hi:[0,1]
    v_pk_add_f32 v[16:17], v[16:17], v[124:125] op_sel_hi:[1,0] neg_lo:[0,1] neg_hi:[0,1]
    v_pk_add_f32 v[18:19], v[18:19], v[124:125] op_sel_hi:[1,0] neg_lo:[0,1] neg_hi:[0,1]
    v_pk_add_f32 v[20:21], v[20:21], v[124:125] op_sel_hi:[1,0] neg_lo:[0,1] neg_hi:[0,1]
    v_pk_add_f32 v[22:23], v[22:23], v[124:125] op_sel_hi:[1,0] neg_lo:[0,1] neg_hi:[0,1]
    v_pk_add_f32 v[24:25], v[24:25], v[124:125] op_sel_hi:[1,0] neg_lo:[0,1] neg_hi:[0,1]
    v_pk_add_f32 v[26:27], v[26:27], v[124:125] op_sel_hi:[1,0] neg_lo:[0,1] neg_hi:[0,1]
    v_pk_mul_f32 v[12:13], v[12:13], v[126:127] op_sel_hi:[1,0]
    v_pk_mul_f32 v[14:15], v[14:15], v[126:127] op_sel_hi:[1,0]
    v_pk_mul_f32 v[16:17], v[16:17], v[126:127] op_sel_hi:[1,0]
    v_pk_mul_f32 v[18:19], v[18:19], v[126:127] op_sel_hi:[1,0]
    v_pk_mul_f32 v[20:21], v[20:21], v[126:127] op_sel_hi:[1,0]
    v_pk_mul_f32 v[22:23], v[22:23], v[126:127] op_sel_hi:[1,0]
    v_pk_mul_f32 v[24:25], v[24:25], v[126:127] op_sel_hi:[1,0]
    v_pk_mul_f32 v[26:27], v[26:27], v[126:127] op_sel_hi:[1,0]
    v_cvt_pk_bf16_f32 v12, v12, v13
    v_cvt_pk_bf16_f32 v13, v14, v15
    v_cvt_pk_bf16_f32 v14, v16, v17
    v_cvt_pk_bf16_f32 v15, v18, v19
    v_cvt_pk_bf16_f32 v16, v20, v21
    v_cvt_pk_bf16_f32 v17, v22, v23
    v_cvt_pk_bf16_f32 v18, v24, v25
    v_cvt_pk_bf16_f32 v19, v26, v27
    v_pk_add_f32 v[28:29], v[28:29], v[128:129] op_sel_hi:[1,0] neg_lo:[0,1] neg_hi:[0,1]
    v_pk_add_f32 v[30:31], v[30:31], v[128:129] op_sel_hi:[1,0] neg_lo:[0,1] neg_hi:[0,1]
    v_pk_add_f32 v[32:33], v[32:33], v[128:129] op_sel_hi:[1,0] neg_lo:[0,1] neg_hi:[0,1]
    v_pk_add_f32 v[34:35], v[34:35], v[128:129] op_sel_hi:[1,0] neg_lo:[0,1] neg_hi:[0,1]
    v_pk_add_f32 v[36:37], v[36:37], v[128:129] op_sel_hi:[1,0] neg_lo:[0,1] neg_hi:[0,1]
    v_pk_add_f32 v[38:39], v[38:39], v[128:129] op_sel_hi:[1,0] neg_lo:[0,1] neg_hi:[0,1]
    v_pk_add_f32 v[40:41], v[40:41], v[128:129] op_sel_hi:[1,0] neg_lo:[0,1] neg_hi:[0,1]
    v_pk_add_f32 v[42:43], v[42:43], v[128:129] op_sel_hi:[1,0] neg_lo:[0,1] neg_hi:[0,1]
    v_pk_mul_f32 v[28:29], v[28:29], v[130:131] op_sel_hi:[1,0]
    v_pk_mul_f32 v[30:31], v[30:31], v[130:131] op_sel_hi:[1,0]
    v_pk_mul_f32 v[32:33], v[32:33], v[130:131] op_sel_hi:[1,0]
    v_pk_mul_f32 v[34:35], v[34:35], v[130:131] op_sel_hi:[1,0]
    v_pk_mul_f32 v[36:37], v[36:37], v[130:131] op_sel_hi:[1,0]
    v_pk_mul_f32 v[38:39], v[38:39], v[130:131] op_sel_hi:[1,0]
    v_pk_mul_f32 v[40:41], v[40:41], v[130:131] op_sel_hi:[1,0]
    v_pk_mul_f32 v[42:43], v[42:43], v[130:131] op_sel_hi:[1,0]
    v_cvt_pk_bf16_f32 v28, v28, v29
    v_cvt_pk_bf16_f32 v29, v30, v31
    v_cvt_pk_bf16_f32 v30, v32, v33
    v_cvt_pk_bf16_f32 v31, v34, v35
    v_cvt_pk_bf16_f32 v32, v36, v37
    v_cvt_pk_bf16_f32 v33, v38, v39
    v_cvt_pk_bf16_f32 v34, v40, v41
    v_cvt_pk_bf16_f32 v35, v42, v43
    s_cmp_lg_u32 s82, 0
    s_cbranch_scc1 M_id_nl
    s_add_u32 s34, s25, 76546048
    s_add_u32 s35, s34, 20480
    s_cmp_lg_u32 s23, 0
    s_cbranch_scc1 M_ls_40
    buffer_store_dwordx4 v[12:15], v1, s[8:11], s34 offen offset:0
    buffer_store_dwordx4 v[16:19], v1, s[8:11], s34 offen offset:1024
    buffer_store_dwordx4 v[28:31], v1, s[8:11], s35 offen offset:0
    buffer_store_dwordx4 v[32:35], v1, s[8:11], s35 offen offset:1024
M_ls_40_r:
    s_mul_i32 s34, s89, 10
    s_add_u32 s34, s34, s88
    s_add_u32 s34, s34, 167956480
    v_mov_b32 v8, 1
    s_waitcnt vmcnt(0)
    s_mov_b64 exec, 1
    s_cmp_lg_u32 s23, 0
    s_cbranch_scc1 M_ls_41
    buffer_store_byte v8, v1, s[8:11], s34 offen
M_ls_41_r:
    s_mov_b64 exec, -1
    s_mov_b32 s68, s25
    s_mov_b32 s69, s24
    s_mov_b32 s70, s30
    s_mov_b32 s71, s33
    s_branch M_noid
M_id_nl:
    buffer_store_dwordx4 v[12:15], v1, s[8:11], s25 offen offset:0 sc1
    buffer_store_dwordx4 v[16:19], v1, s[8:11], s25 offen offset:1024 sc1
    buffer_store_dwordx4 v[28:31], v1, s[8:11], s24 offen offset:0 sc1
    buffer_store_dwordx4 v[32:35], v1, s[8:11], s24 offen offset:1024 sc1
M_id_out:
    buffer_store_dwordx4 v[104:107], v5, s[16:19], s30 offen offset:0 sc1
    buffer_store_dwordx4 v[108:111], v5, s[16:19], s30 offen offset:64 sc1
    buffer_store_dwordx4 v[112:115], v5, s[16:19], s33 offen offset:0 sc1
    buffer_store_dwordx4 v[116:119], v5, s[16:19], s33 offen offset:64 sc1
    s_cmp_eq_u32 s101, 1
    s_cbranch_scc1 M_end
    s_lshl_b32 s24, s89, 7
    s_lshl_b32 s25, s88, 2
    s_add_u32 s24, s24, s25
    s_add_u32 s24, s24, 167919616
    v_mov_b32 v8, 1
    s_waitcnt vmcnt(0)
    s_mov_b64 exec, 1
    buffer_store_dword v8, v1, s[8:11], s24 offen sc1
    s_mov_b64 exec, -1
M_noid:
    s_add_u32 s20, s82, 2
    s_mov_b32 s21, s83
    s_mov_b32 s22, s84
    s_mov_b32 s23, s85
    s_cmp_eq_u32 s101, 1
    s_cbranch_scc1 M_end
    s_mov_b32 s101, 1
    v_mbcnt_lo_u32_b32 v0, -1, 0
    v_mbcnt_hi_u32_b32 v0, -1, v0
    v_lshlrev_b32 v0, 4, v0
    s_waitcnt lgkmcnt(0)
    s_barrier
    s_branch M_bulk
M_ls_12:
    s_nop 7
    buffer_store_byte v11, v10, s[8:11], s62 offen sc1
    s_branch M_ls_12_r
M_ls_15:
    s_nop 7
    buffer_store_dwordx4 v[64:67], v4, s[8:11], s48 offen offset:0 sc1
    buffer_store_dwordx4 v[72:75], v4, s[8:11], s27 offen offset:0 sc1
    s_branch M_ls_15_r
M_ls_16:
    s_nop 7
    buffer_store_dwordx4 v[80:83], v4, s[8:11], s48 offen offset:64 sc1
    buffer_store_dwordx4 v[88:91], v4, s[8:11], s27 offen offset:64 sc1
    s_branch M_ls_16_r
M_ls_17:
    s_nop 7
    buffer_store_dwordx4 v[96:99], v4, s[8:11], s48 offen offset:128 sc1
    buffer_store_dwordx4 v[104:107], v4, s[8:11], s27 offen offset:128 sc1
    s_branch M_ls_17_r
M_ls_18:
    s_nop 7
    buffer_store_dwordx4 v[112:115], v4, s[8:11], s48 offen offset:192 sc1
    buffer_store_dwordx4 v[120:123], v4, s[8:11], s27 offen offset:192 sc1
    s_branch M_ls_18_r
M_ls_19:
    s_nop 7
    buffer_store_dwordx4 v[128:131], v4, s[8:11], s48 offen offset:256 sc1
    buffer_store_dwordx4 v[136:139], v4, s[8:11], s27 offen offset:256 sc1
    s_branch M_ls_19_r
M_ls_20:
    s_nop 7
    buffer_store_byte v11, v10, s[8:11], s62 offen sc1
    s_branch M_ls_20_r
M_ls_23:
    s_nop 7
    s_mov_b32 exec_hi, 0
    buffer_store_dwordx2 v[72:73], v12, s[8:11], s63 offen sc1
    s_mov_b32 exec_lo, 0x000f000f
    buffer_store_dwordx2 v[74:75], v12, s[8:11], s64 offen sc1
    s_mov_b64 exec, -1
    s_branch M_ls_23_r
M_ls_24:
    s_nop 7
    buffer_store_byte v11, v10, s[8:11], s62 offen sc1
    s_branch M_ls_24_r
M_ls_36:
    s_nop 7
    buffer_store_byte v191, v190, s[8:11], s28 offen sc1
    s_branch M_ls_36_r
M_ls_39:
    s_nop 7
    buffer_store_dwordx2 v[124:125], v7, s[8:11], s25 offen offset:0 sc1
    buffer_store_dwordx2 v[128:129], v7, s[8:11], s25 offen offset:2048 sc1
    s_branch M_ls_39_r
M_ls_40:
    s_nop 7
    buffer_store_dwordx4 v[12:15], v1, s[8:11], s34 offen offset:0 sc1
    buffer_store_dwordx4 v[16:19], v1, s[8:11], s34 offen offset:1024 sc1
    buffer_store_dwordx4 v[28:31], v1, s[8:11], s35 offen offset:0 sc1
    buffer_store_dwordx4 v[32:35], v1, s[8:11], s35 offen offset:1024 sc1
    s_branch M_ls_40_r
M_ls_41:
    s_nop 7
    buffer_store_byte v8, v1, s[8:11], s34 offen sc1
    s_branch M_ls_41_r
M_fail:
    s_mov_b64 exec, 1
    v_mov_b32 v12, 1
    v_mov_b32 v13, 48
    buffer_atomic_add v12, v13, s[12:15], 0 offen
M_end:
    s_endpgm

.section .rodata,"a"
.p2align 6
.amdhsa_kernel interleave_layers__memory_aug_recurrent_mem_tr__spectral_gfnet__prompt_kernel
  .amdhsa_next_free_vgpr 512
  .amdhsa_next_free_sgpr 102
  .amdhsa_accum_offset 256
  .amdhsa_group_segment_fixed_size 0
  .amdhsa_kernarg_size 104
  .amdhsa_user_sgpr_count 2
  .amdhsa_user_sgpr_kernarg_segment_ptr 1
  .amdhsa_system_sgpr_workgroup_id_x 1
  .amdhsa_float_denorm_mode_32 3
  .amdhsa_float_denorm_mode_16_64 3
.end_amdhsa_kernel
```

```asm
; @launch kernel=interleave_layers__memory_aug_recurrent_mem_tr__spectral_gfnet__prompt_kernel grid=(256,1,1) block=(256,1,1) lds=163840
.amdgcn_target "amdgcn-amd-amdhsa--gfx950"
.text
.globl interleave_layers__memory_aug_recurrent_mem_tr__spectral_gfnet__prompt_kernel
.p2align 8
.type interleave_layers__memory_aug_recurrent_mem_tr__spectral_gfnet__prompt_kernel,@function
interleave_layers__memory_aug_recurrent_mem_tr__spectral_gfnet__prompt_kernel:
    s_cmp_ge_u32 s2, 256
    s_cbranch_scc1 M_end
    s_load_dwordx2 s[16:17], s[0:1], 0
    s_load_dwordx2 s[8:9], s[0:1], 96
    s_load_dwordx2 s[12:13], s[0:1], 88
    s_load_dwordx2 s[72:73], s[0:1], 16
    s_load_dwordx2 s[76:77], s[0:1], 24
    s_load_dwordx2 s[80:81], s[0:1], 32
    s_load_dwordx2 s[84:85], s[0:1], 40
    s_load_dwordx2 s[68:69], s[0:1], 8
    s_getreg_b32 s24, hwreg(HW_REG_XCC_ID)
    s_and_b32 s24, s24, 7
    s_getpc_b64 s[26:27]
M_cpf:
    s_lshr_b32 s28, s2, 3
    s_lshl_b32 s28, s28, 8
    v_add_u32 v13, s28, v0
    v_lshlrev_b32 v13, 6, v13
    v_cmp_gt_u32 vcc, M_end - M_cpf, v13
    s_and_saveexec_b64 s[28:29], vcc
    s_cbranch_execz M_cpfd
    global_load_dword v14, v13, s[26:27]
M_cpfd:
    s_mov_b64 exec, s[28:29]
    v_lshrrev_b32 v12, 6, v0
    v_and_b32 v0, 63, v0
    v_readfirstlane_b32 s21, v12
    v_lshlrev_b32 v0, 4, v0
    s_waitcnt lgkmcnt(0)
    s_and_b32 s9, s9, 0xffff
    s_mov_b32 s10, 268435456
    s_mov_b32 s11, 0x00020000
    s_and_b32 s13, s13, 0xffff
    s_mov_b32 s14, 256
    s_mov_b32 s15, 0x00020000
    s_and_b32 s17, s17, 0xffff
    s_mov_b32 s18, 2621440
    s_mov_b32 s19, 0x00020000
    s_and_b32 s73, s73, 0xffff
    s_mov_b32 s74, 5242880
    s_mov_b32 s75, 0x00020000
    s_and_b32 s77, s77, 0xffff
    s_mov_b32 s78, 5242880
    s_mov_b32 s79, 0x00020000
    s_and_b32 s81, s81, 0xffff
    s_mov_b32 s82, 5242880
    s_mov_b32 s83, 0x00020000
    s_and_b32 s85, s85, 0xffff
    s_mov_b32 s86, 5242880
    s_mov_b32 s87, 0x00020000
    s_and_b32 s69, s69, 0xffff
    s_mov_b32 s70, 10240
    s_mov_b32 s71, 0x00020000
    s_mov_b32 s5, 0
    s_mov_b32 s101, 0
    s_cmp_eq_u32 s21, 0
    s_cbranch_scc1 M_tick
    s_cmp_eq_u32 s21, 3
    s_cbranch_scc1 M_zero
    v_mov_b32 v28, -1
    v_mov_b32 v29, -1
    v_mov_b32 v30, -1
    v_mov_b32 v31, -1
    s_lshl_b32 s26, s2, 1
    s_add_u32 s26, s26, s21
    s_lshl_b32 s26, s26, 12
    s_add_u32 s26, s26, 171962368
    buffer_store_dwordx4 v[28:31], v0, s[8:11], s26 offen offset:0 sc1
    buffer_store_dwordx4 v[28:31], v0, s[8:11], s26 offen offset:1024 sc1
    buffer_store_dwordx4 v[28:31], v0, s[8:11], s26 offen offset:2048 sc1
    buffer_store_dwordx4 v[28:31], v0, s[8:11], s26 offen offset:3072 sc1
    s_branch M_notick
M_zero:
    v_mov_b32 v28, 0
    v_mov_b32 v29, 0
    v_mov_b32 v30, 0
    v_mov_b32 v31, 0
    s_lshl_b32 s26, s2, 9
    s_add_u32 s26, s26, 167837696
    s_mov_b32 exec_hi, 0
    buffer_store_dwordx4 v[28:31], v0, s[8:11], s26 offen sc1
    s_mov_b64 exec, -1
    s_cmp_ge_u32 s2, 10
    s_cbranch_scc1 M_notick
    v_bfe_u32 v6, v0, 4, 3
    v_mul_u32_u24 v6, 1280, v6
    v_lshrrev_b32 v7, 8, v0
    v_lshl_add_u32 v6, v7, 5, v6
    v_bfe_u32 v7, v0, 7, 1
    v_lshl_add_u32 v6, v7, 2, v6
    s_lshl_b32 s26, s2, 7
    buffer_load_dword v32, v6, s[68:71], s26 offen offset:0
    buffer_load_dword v33, v6, s[68:71], s26 offen offset:8
    buffer_load_dword v34, v6, s[68:71], s26 offen offset:16
    buffer_load_dword v35, v6, s[68:71], s26 offen offset:24
    v_and_b32 v7, 0x200, v0
    v_bfe_u32 v12, v0, 6, 1
    v_lshl_or_b32 v7, v12, 8, v7
    v_bfe_u32 v12, v0, 4, 1
    v_lshl_or_b32 v7, v12, 7, v7
    v_bfe_u32 v12, v0, 5, 1
    v_lshl_or_b32 v7, v12, 6, v7
    v_bfe_u32 v12, v0, 8, 1
    v_lshl_or_b32 v7, v12, 5, v7
    v_bfe_u32 v12, v0, 7, 1
    v_lshl_or_b32 v7, v12, 4, v7
    s_lshl_b32 s26, s2, 10
    s_add_u32 s26, s26, 167772160
    s_waitcnt vmcnt(0)
    v_min_u32 v32, -2, v32
    v_min_u32 v33, -2, v33
    v_min_u32 v34, -2, v34
    v_min_u32 v35, -2, v35
    buffer_store_dwordx4 v[32:35], v7, s[8:11], s26 offen sc1
    s_branch M_notick
M_tick:
    s_lshr_b32 s25, 5, s24
    s_and_b32 s25, s25, 1
    s_cmp_lg_u32 s25, 1
    s_cbranch_scc1 M_nocal
    s_bfe_u32 s25, s2, 0x20003
    s_lshl_b32 s26, s25, 13
    s_lshr_b32 s27, s2, 5
    s_lshl_b32 s27, s27, 15
    s_add_u32 s26, s26, s27
    s_lshl_b32 s27, s24, 8
    s_add_u32 s26, s26, s27
    s_add_u32 s26, s26, 171966464
    v_mov_b32 v28, -1
    v_mov_b32 v29, -1
    v_mov_b32 v30, -1
    v_mov_b32 v31, -1
    s_mov_b64 exec, 0xff
    s_mov_b32 s27, -1
    s_waitcnt vmcnt(0)
    s_memtime s[28:29]
    buffer_store_dwordx4 v[28:31], v0, s[8:11], s26 offen sc1
    s_waitcnt vmcnt(0)
    s_memtime s[30:31]
    s_waitcnt lgkmcnt(0)
    s_sub_u32 s28, s30, s28
    s_min_u32 s27, s27, s28
    s_memtime s[28:29]
    buffer_store_dwordx4 v[28:31], v0, s[8:11], s26 offen sc1
    s_waitcnt vmcnt(0)
    s_memtime s[30:31]
    s_waitcnt lgkmcnt(0)
    s_sub_u32 s28, s30, s28
    s_min_u32 s27, s27, s28
    s_memtime s[28:29]
    buffer_store_dwordx4 v[28:31], v0, s[8:11], s26 offen sc1
    s_waitcnt vmcnt(0)
    s_memtime s[30:31]
    s_waitcnt lgkmcnt(0)
    s_sub_u32 s28, s30, s28
    s_min_u32 s27, s27, s28
    s_memtime s[28:29]
    buffer_store_dwordx4 v[28:31], v0, s[8:11], s26 offen sc1
    s_waitcnt vmcnt(0)
    s_memtime s[30:31]
    s_waitcnt lgkmcnt(0)
    s_sub_u32 s28, s30, s28
    s_min_u32 s27, s27, s28
    s_mov_b64 exec, 1
    s_min_u32 s27, s27, 0xffff
    s_sub_u32 s27, 0x10000, s27
    s_lshl_b32 s27, s27, 2
    s_or_b32 s27, s27, s25
    v_mov_b32 v28, s27
    v_mov_b32 v29, 60
    buffer_atomic_umax v28, v29, s[12:15], 0 offen
M_nocal:
    s_mov_b64 exec, 1
    v_mov_b32 v28, 1
    s_lshl_b32 s25, s24, 2
    v_mov_b32 v29, s25
    buffer_atomic_add v28, v29, s[12:15], 0 offen sc0
    s_mov_b64 exec, -1
M_notick:
    s_lshl_b32 s20, s24, 2
    s_lshr_b32 s20, 0x54321706, s20
    s_and_b32 s20, s20, 7
    s_waitcnt vmcnt(0)
    s_cmp_lg_u32 s21, 0
    s_cbranch_scc1 M_notick2
    s_mov_b64 exec, 1
    v_mov_b32 v29, 23296
    ds_write_b32 v29, v28
    s_waitcnt lgkmcnt(0)
    s_mov_b64 exec, -1
M_notick2:
    s_barrier
    s_cmp_lg_u32 s21, 0
    s_cbranch_scc1 M_noarr
    s_mov_b64 exec, 1
    v_mov_b32 v30, 1
    v_mov_b32 v29, 32
    buffer_atomic_add v30, v29, s[12:15], 0 offen
    s_mov_b64 exec, -1
M_noarr:
    v_mov_b32 v29, 23296
    ds_read_b32 v28, v29
    s_waitcnt lgkmcnt(0)
    v_readfirstlane_b32 s25, v28
    s_and_b32 s22, s25, 31
    s_mov_b32 s23, 0
    s_mov_b32 s32, 0
    s_cmp_ge_u32 s20, 3
    s_cbranch_scc1 M_lw_done
M_loadw:
    s_barrier
    s_cmp_lt_u32 s20, 2
    s_cbranch_scc1 M_lw_chain
    s_cmp_lt_u32 s20, 4
    s_cbranch_scc1 M_lw_bulk
    s_lshl_b32 s34, s22, 2
    s_add_u32 s34, s34, s20
    s_sub_u32 s34, s34, 4
    s_mov_b32 s92, s33
    s_mov_b32 s33, s21
    v_lshrrev_b32 v1, 4, v0
    v_lshrrev_b32 v3, 8, v0
    v_and_b32 v4, 15, v1
    v_mov_b32 v5, v0
    v_mul_u32_u24 v6, 1280, v4
    v_lshl_add_u32 v6, v3, 4, v6
    s_mul_i32 s36, s34, 20480
    s_mul_i32 s35, s33, 320
    s_add_u32 s36, s36, s35
    buffer_load_dwordx4 v[8:11], v6, s[16:19], s36 offen offset:0
    buffer_load_dwordx4 v[12:15], v6, s[16:19], s36 offen offset:64
    buffer_load_dwordx4 v[16:19], v6, s[16:19], s36 offen offset:128
    buffer_load_dwordx4 v[20:23], v6, s[16:19], s36 offen offset:192
    buffer_load_dwordx4 v[24:27], v6, s[16:19], s36 offen offset:256
    s_waitcnt vmcnt(4)
    v_lshlrev_b32 v32, 16, v8
    v_and_b32 v33, 0xffff0000, v8
    v_lshlrev_b32 v34, 16, v9
    v_and_b32 v35, 0xffff0000, v9
    v_lshlrev_b32 v36, 16, v10
    v_and_b32 v37, 0xffff0000, v10
    v_lshlrev_b32 v38, 16, v11
    v_and_b32 v39, 0xffff0000, v11
    s_waitcnt vmcnt(3)
    v_lshlrev_b32 v40, 16, v12
    v_and_b32 v41, 0xffff0000, v12
    v_lshlrev_b32 v42, 16, v13
    v_and_b32 v43, 0xffff0000, v13
    v_lshlrev_b32 v44, 16, v14
    v_and_b32 v45, 0xffff0000, v14
    v_lshlrev_b32 v46, 16, v15
    v_and_b32 v47, 0xffff0000, v15
    s_waitcnt vmcnt(2)
    v_lshlrev_b32 v48, 16, v16
    v_and_b32 v49, 0xffff0000, v16
    v_lshlrev_b32 v50, 16, v17
    v_and_b32 v51, 0xffff0000, v17
    v_lshlrev_b32 v52, 16, v18
    v_and_b32 v53, 0xffff0000, v18
    v_lshlrev_b32 v54, 16, v19
    v_and_b32 v55, 0xffff0000, v19
    s_waitcnt vmcnt(1)
    v_lshlrev_b32 v56, 16, v20
    v_and_b32 v57, 0xffff0000, v20
    v_lshlrev_b32 v58, 16, v21
    v_and_b32 v59, 0xffff0000, v21
    v_lshlrev_b32 v60, 16, v22
    v_and_b32 v61, 0xffff0000, v22
    v_lshlrev_b32 v62, 16, v23
    v_and_b32 v63, 0xffff0000, v23
    s_waitcnt vmcnt(0)
    v_lshlrev_b32 v64, 16, v24
    v_and_b32 v65, 0xffff0000, v24
    v_lshlrev_b32 v66, 16, v25
    v_and_b32 v67, 0xffff0000, v25
    v_lshlrev_b32 v68, 16, v26
    v_and_b32 v69, 0xffff0000, v26
    v_lshlrev_b32 v70, 16, v27
    v_and_b32 v71, 0xffff0000, v27
    v_add_f32 v72, v32, v33
    v_add_f32 v72, v72, v34
    v_add_f32 v72, v72, v35
    v_add_f32 v72, v72, v36
    v_add_f32 v72, v72, v37
    v_add_f32 v72, v72, v38
    v_add_f32 v72, v72, v39
    v_add_f32 v72, v72, v40
    v_add_f32 v72, v72, v41
    v_add_f32 v72, v72, v42
    v_add_f32 v72, v72, v43
    v_add_f32 v72, v72, v44
    v_add_f32 v72, v72, v45
    v_add_f32 v72, v72, v46
    v_add_f32 v72, v72, v47
    v_add_f32 v72, v72, v48
    v_add_f32 v72, v72, v49
    v_add_f32 v72, v72, v50
    v_add_f32 v72, v72, v51
    v_add_f32 v72, v72, v52
    v_add_f32 v72, v72, v53
    v_add_f32 v72, v72, v54
    v_add_f32 v72, v72, v55
    v_add_f32 v72, v72, v56
    v_add_f32 v72, v72, v57
    v_add_f32 v72, v72, v58
    v_add_f32 v72, v72, v59
    v_add_f32 v72, v72, v60
    v_add_f32 v72, v72, v61
    v_add_f32 v72, v72, v62
    v_add_f32 v72, v72, v63
    v_add_f32 v72, v72, v64
    v_add_f32 v72, v72, v65
    v_add_f32 v72, v72, v66
    v_add_f32 v72, v72, v67
    v_add_f32 v72, v72, v68
    v_add_f32 v72, v72, v69
    v_add_f32 v72, v72, v70
    v_add_f32 v72, v72, v71
    v_lshlrev_b32 v77, 4, v4
    s_lshl_b32 s35, s33, 2
    v_add_u32 v76, s35, v77
    v_mov_b32 v73, v72
    s_nop 1
    v_permlane16_swap_b32 v72, v73
    v_add_f32 v72, v72, v73
    v_mov_b32 v73, v72
    s_nop 1
    v_permlane32_swap_b32 v72, v73
    v_add_f32 v72, v72, v73
    ds_write_b32 v76, v72 offset:0
    s_waitcnt lgkmcnt(0)
    s_barrier
    ds_read_b128 v[80:83], v77 offset:0
    s_waitcnt lgkmcnt(0)
    v_add_f32 v80, v80, v81
    v_add_f32 v82, v82, v83
    v_add_f32 v72, v80, v82
    v_mul_f32 v72, 0x3acccccd, v72
    v_sub_f32 v32, v32, v72
    v_sub_f32 v33, v33, v72
    v_sub_f32 v34, v34, v72
    v_sub_f32 v35, v35, v72
    v_sub_f32 v36, v36, v72
    v_sub_f32 v37, v37, v72
    v_sub_f32 v38, v38, v72
    v_sub_f32 v39, v39, v72
    v_sub_f32 v40, v40, v72
    v_sub_f32 v41, v41, v72
    v_sub_f32 v42, v42, v72
    v_sub_f32 v43, v43, v72
    v_sub_f32 v44, v44, v72
    v_sub_f32 v45, v45, v72
    v_sub_f32 v46, v46, v72
    v_sub_f32 v47, v47, v72
    v_sub_f32 v48, v48, v72
    v_sub_f32 v49, v49, v72
    v_sub_f32 v50, v50, v72
    v_sub_f32 v51, v51, v72
    v_sub_f32 v52, v52, v72
    v_sub_f32 v53, v53, v72
    v_sub_f32 v54, v54, v72
    v_sub_f32 v55, v55, v72
    v_sub_f32 v56, v56, v72
    v_sub_f32 v57, v57, v72
    v_sub_f32 v58, v58, v72
    v_sub_f32 v59, v59, v72
    v_sub_f32 v60, v60, v72
    v_sub_f32 v61, v61, v72
    v_sub_f32 v62, v62, v72
    v_sub_f32 v63, v63, v72
    v_sub_f32 v64, v64, v72
    v_sub_f32 v65, v65, v72
    v_sub_f32 v66, v66, v72
    v_sub_f32 v67, v67, v72
    v_sub_f32 v68, v68, v72
    v_sub_f32 v69, v69, v72
    v_sub_f32 v70, v70, v72
    v_sub_f32 v71, v71, v72
    v_mul_f32 v74, v32, v32
    v_fmac_f32 v74, v33, v33
    v_fmac_f32 v74, v34, v34
    v_fmac_f32 v74, v35, v35
    v_fmac_f32 v74, v36, v36
    v_fmac_f32 v74, v37, v37
    v_fmac_f32 v74, v38, v38
    v_fmac_f32 v74, v39, v39
    v_fmac_f32 v74, v40, v40
    v_fmac_f32 v74, v41, v41
    v_fmac_f32 v74, v42, v42
    v_fmac_f32 v74, v43, v43
    v_fmac_f32 v74, v44, v44
    v_fmac_f32 v74, v45, v45
    v_fmac_f32 v74, v46, v46
    v_fmac_f32 v74, v47, v47
    v_fmac_f32 v74, v48, v48
    v_fmac_f32 v74, v49, v49
    v_fmac_f32 v74, v50, v50
    v_fmac_f32 v74, v51, v51
    v_fmac_f32 v74, v52, v52
    v_fmac_f32 v74, v53, v53
    v_fmac_f32 v74, v54, v54
    v_fmac_f32 v74, v55, v55
    v_fmac_f32 v74, v56, v56
    v_fmac_f32 v74, v57, v57
    v_fmac_f32 v74, v58, v58
    v_fmac_f32 v74, v59, v59
    v_fmac_f32 v74, v60, v60
    v_fmac_f32 v74, v61, v61
    v_fmac_f32 v74, v62, v62
    v_fmac_f32 v74, v63, v63
    v_fmac_f32 v74, v64, v64
    v_fmac_f32 v74, v65, v65
    v_fmac_f32 v74, v66, v66
    v_fmac_f32 v74, v67, v67
    v_fmac_f32 v74, v68, v68
    v_fmac_f32 v74, v69, v69
    v_fmac_f32 v74, v70, v70
    v_fmac_f32 v74, v71, v71
    v_mov_b32 v73, v74
    s_nop 1
    v_permlane16_swap_b32 v74, v73
    v_add_f32 v74, v74, v73
    v_mov_b32 v73, v74
    s_nop 1
    v_permlane32_swap_b32 v74, v73
    v_add_f32 v74, v74, v73
    ds_write_b32 v76, v74 offset:512
    s_waitcnt lgkmcnt(0)
    s_barrier
    ds_read_b128 v[80:83], v77 offset:512
    s_waitcnt lgkmcnt(0)
    v_add_f32 v80, v80, v81
    v_add_f32 v82, v82, v83
    v_add_f32 v74, v80, v82
    v_mov_b32 v75, 0x3727c5ac
    v_fmac_f32 v75, 0x3acccccd, v74
    v_rsq_f32 v75, v75
    s_nop 0
    v_mul_f32 v32, v32, v75
    v_mul_f32 v33, v33, v75
    v_mul_f32 v34, v34, v75
    v_mul_f32 v35, v35, v75
    v_mul_f32 v36, v36, v75
    v_mul_f32 v37, v37, v75
    v_mul_f32 v38, v38, v75
    v_mul_f32 v39, v39, v75
    v_mul_f32 v40, v40, v75
    v_mul_f32 v41, v41, v75
    v_mul_f32 v42, v42, v75
    v_mul_f32 v43, v43, v75
    v_mul_f32 v44, v44, v75
    v_mul_f32 v45, v45, v75
    v_mul_f32 v46, v46, v75
    v_mul_f32 v47, v47, v75
    v_mul_f32 v48, v48, v75
    v_mul_f32 v49, v49, v75
    v_mul_f32 v50, v50, v75
    v_mul_f32 v51, v51, v75
    v_mul_f32 v52, v52, v75
    v_mul_f32 v53, v53, v75
    v_mul_f32 v54, v54, v75
    v_mul_f32 v55, v55, v75
    v_mul_f32 v56, v56, v75
    v_mul_f32 v57, v57, v75
    v_mul_f32 v58, v58, v75
    v_mul_f32 v59, v59, v75
    v_mul_f32 v60, v60, v75
    v_mul_f32 v61, v61, v75
    v_mul_f32 v62, v62, v75
    v_mul_f32 v63, v63, v75
    v_mul_f32 v64, v64, v75
    v_mul_f32 v65, v65, v75
    v_mul_f32 v66, v66, v75
    v_mul_f32 v67, v67, v75
    v_mul_f32 v68, v68, v75
    v_mul_f32 v69, v69, v75
    v_mul_f32 v70, v70, v75
    v_mul_f32 v71, v71, v75
    v_cvt_pk_bf16_f32 v8, v32, v33
    v_cvt_pk_bf16_f32 v9, v34, v35
    v_cvt_pk_bf16_f32 v10, v36, v37
    v_cvt_pk_bf16_f32 v11, v38, v39
    v_cvt_pk_bf16_f32 v12, v40, v41
    v_cvt_pk_bf16_f32 v13, v42, v43
    v_cvt_pk_bf16_f32 v14, v44, v45
    v_cvt_pk_bf16_f32 v15, v46, v47
    v_cvt_pk_bf16_f32 v16, v48, v49
    v_cvt_pk_bf16_f32 v17, v50, v51
    v_cvt_pk_bf16_f32 v18, v52, v53
    v_cvt_pk_bf16_f32 v19, v54, v55
    v_cvt_pk_bf16_f32 v20, v56, v57
    v_cvt_pk_bf16_f32 v21, v58, v59
    v_cvt_pk_bf16_f32 v22, v60, v61
    v_cvt_pk_bf16_f32 v23, v62, v63
    v_cvt_pk_bf16_f32 v24, v64, v65
    v_cvt_pk_bf16_f32 v25, v66, v67
    v_cvt_pk_bf16_f32 v26, v68, v69
    v_cvt_pk_bf16_f32 v27, v70, v71
    s_mul_i32 s36, s34, 20480
    s_mul_i32 s35, s33, 5120
    s_add_u32 s36, s36, s35
    s_add_u32 s36, s36, 29360128
    s_add_u32 s35, s36, 4096
    buffer_store_dwordx4 v[8:11], v5, s[8:11], s36 offen offset:0 sc1
    buffer_store_dwordx4 v[12:15], v5, s[8:11], s36 offen offset:1024 sc1
    buffer_store_dwordx4 v[16:19], v5, s[8:11], s36 offen offset:2048 sc1
    buffer_store_dwordx4 v[20:23], v5, s[8:11], s36 offen offset:3072 sc1
    buffer_store_dwordx4 v[24:27], v5, s[8:11], s35 offen offset:0 sc1
    s_mov_b32 s33, s92
    s_waitcnt vmcnt(0)
    s_barrier
    s_cmp_lg_u32 s21, 0
    s_cbranch_scc1 M_lw_bulk
    s_lshr_b32 s27, s34, 1
    s_lshl_b32 s27, s27, 7
    s_and_b32 s28, s34, 1
    s_mul_i32 s28, s28, 20
    s_add_u32 s27, s27, s28
    s_add_u32 s27, s27, 167911424
    v_lshrrev_b32 v12, 2, v0
    v_mov_b32 v13, 1
    s_mov_b64 exec, 31
    buffer_store_dword v13, v12, s[8:11], s27 offen sc1
    s_mov_b64 exec, -1
M_lw_bulk:
    v_lshrrev_b32 v12, 8, v0
    v_lshlrev_b32 v12, 16, v12
    v_and_b32 v14, 0xf0, v0
    v_add_u32 v12, v12, v14
    s_lshl_b32 s46, s22, 8
    s_lshl_b32 s27, s21, 13
    v_add_u32 v4, s27, v0
    v_add_u32 v5, 32768, v4
    s_cmp_eq_u32 s20, 2
    s_cbranch_scc1 M_bl_kv
    s_mul_i32 s27, s21, 40960
    v_add_u32 v7, s27, v0
    v_lshrrev_b32 v8, 8, v0
    v_mul_u32_u24 v8, 40960, v8
    s_lshl_b32 s47, s22, 6
    s_add_u32 s47, s47, s21
    s_mul_i32 s47, s47, 2560
    v_and_b32 v14, 0xf0, v0
    v_add_u32 v8, v8, v14
    v_bfe_u32 v14, v0, 6, 2
    v_lshl_add_u32 v9, v14, 8, v8
    s_mov_b32 s44, 0x05040100
    s_mov_b32 s45, 0x07060302
    s_add_u32 s27, s47, 0
    buffer_load_dwordx4 v[16:19], v8, s[84:87], s27 offen
    s_add_u32 s27, s47, 1280
    buffer_load_dwordx4 v[20:23], v8, s[84:87], s27 offen
    s_add_u32 s27, s47, 10240
    buffer_load_dwordx4 v[24:27], v8, s[84:87], s27 offen
    s_add_u32 s27, s47, 11520
    buffer_load_dwordx4 v[28:31], v8, s[84:87], s27 offen
    s_add_u32 s27, s47, 20480
    buffer_load_dwordx4 v[32:35], v8, s[84:87], s27 offen
    s_add_u32 s27, s47, 21760
    buffer_load_dwordx4 v[36:39], v8, s[84:87], s27 offen
    s_add_u32 s27, s47, 30720
    buffer_load_dwordx4 v[40:43], v8, s[84:87], s27 offen
    s_add_u32 s27, s47, 32000
    buffer_load_dwordx4 v[44:47], v8, s[84:87], s27 offen
    s_add_u32 s27, s47, 320
    buffer_load_dwordx4 v[48:51], v8, s[84:87], s27 offen
    s_add_u32 s27, s47, 1600
    buffer_load_dwordx4 v[52:55], v8, s[84:87], s27 offen
    s_add_u32 s27, s47, 10560
    buffer_load_dwordx4 v[56:59], v8, s[84:87], s27 offen
    s_add_u32 s27, s47, 11840
    buffer_load_dwordx4 v[60:63], v8, s[84:87], s27 offen
    s_add_u32 s27, s47, 20800
    buffer_load_dwordx4 v[64:67], v8, s[84:87], s27 offen
    s_add_u32 s27, s47, 22080
    buffer_load_dwordx4 v[68:71], v8, s[84:87], s27 offen
    s_add_u32 s27, s47, 31040
    buffer_load_dwordx4 v[72:75], v8, s[84:87], s27 offen
    s_add_u32 s27, s47, 32320
    buffer_load_dwordx4 v[76:79], v8, s[84:87], s27 offen
    v_and_b32 v13, 0x300, v0
    s_lshl_b32 s27, s21, 10
    s_add_u32 s27, s27, 0
    v_add_u32 v13, s27, v0
    s_waitcnt vmcnt(14)
    v_perm_b32 v80, v20, v16, s44
    s_waitcnt vmcnt(12)
    v_perm_b32 v81, v28, v24, s44
    s_waitcnt vmcnt(10)
    v_perm_b32 v82, v36, v32, s44
    s_waitcnt vmcnt(8)
    v_perm_b32 v83, v44, v40, s44
    ds_write_b128 v13, v[80:83] offset:0
    v_perm_b32 v84, v20, v16, s45
    v_perm_b32 v85, v28, v24, s45
    v_perm_b32 v86, v36, v32, s45
    v_perm_b32 v87, v44, v40, s45
    ds_write_b128 v13, v[84:87] offset:4096
    v_perm_b32 v80, v21, v17, s44
    v_perm_b32 v81, v29, v25, s44
    v_perm_b32 v82, v37, v33, s44
    v_perm_b32 v83, v45, v41, s44
    ds_write_b128 v13, v[80:83] offset:8192
    v_perm_b32 v84, v21, v17, s45
    v_perm_b32 v85, v29, v25, s45
    v_perm_b32 v86, v37, v33, s45
    v_perm_b32 v87, v45, v41, s45
    ds_write_b128 v13, v[84:87] offset:12288
    v_perm_b32 v80, v22, v18, s44
    v_perm_b32 v81, v30, v26, s44
    v_perm_b32 v82, v38, v34, s44
    v_perm_b32 v83, v46, v42, s44
    ds_write_b128 v13, v[80:83] offset:16384
    v_perm_b32 v84, v22, v18, s45
    v_perm_b32 v85, v30, v26, s45
    v_perm_b32 v86, v38, v34, s45
    v_perm_b32 v87, v46, v42, s45
    ds_write_b128 v13, v[84:87] offset:20480
    v_perm_b32 v80, v23, v19, s44
    v_perm_b32 v81, v31, v27, s44
    v_perm_b32 v82, v39, v35, s44
    v_perm_b32 v83, v47, v43, s44
    ds_write_b128 v13, v[80:83] offset:24576
    v_perm_b32 v84, v23, v19, s45
    v_perm_b32 v85, v31, v27, s45
    v_perm_b32 v86, v39, v35, s45
    v_perm_b32 v87, v47, v43, s45
    ds_write_b128 v13, v[84:87] offset:28672
    s_add_u32 s27, s47, 640
    buffer_load_dwordx4 v[16:19], v8, s[84:87], s27 offen
    s_add_u32 s27, s47, 1920
    buffer_load_dwordx4 v[20:23], v8, s[84:87], s27 offen
    s_add_u32 s27, s47, 10880
    buffer_load_dwordx4 v[24:27], v8, s[84:87], s27 offen
    s_add_u32 s27, s47, 12160
    buffer_load_dwordx4 v[28:31], v8, s[84:87], s27 offen
    s_add_u32 s27, s47, 21120
    buffer_load_dwordx4 v[32:35], v8, s[84:87], s27 offen
    s_add_u32 s27, s47, 22400
    buffer_load_dwordx4 v[36:39], v8, s[84:87], s27 offen
    s_add_u32 s27, s47, 31360
    buffer_load_dwordx4 v[40:43], v8, s[84:87], s27 offen
    s_add_u32 s27, s47, 32640
    buffer_load_dwordx4 v[44:47], v8, s[84:87], s27 offen
    v_and_b32 v13, 0x300, v0
    s_lshl_b32 s27, s21, 10
    s_add_u32 s27, s27, 40960
    v_add_u32 v13, s27, v0
    s_waitcnt vmcnt(14)
    v_perm_b32 v80, v52, v48, s44
    s_waitcnt vmcnt(12)
    v_perm_b32 v81, v60, v56, s44
    s_waitcnt vmcnt(10)
    v_perm_b32 v82, v68, v64, s44
    s_waitcnt vmcnt(8)
    v_perm_b32 v83, v76, v72, s44
    ds_write_b128 v13, v[80:83] offset:0
    v_perm_b32 v84, v52, v48, s45
    v_perm_b32 v85, v60, v56, s45
    v_perm_b32 v86, v68, v64, s45
    v_perm_b32 v87, v76, v72, s45
    ds_write_b128 v13, v[84:87] offset:4096
    v_perm_b32 v80, v53, v49, s44
    v_perm_b32 v81, v61, v57, s44
    v_perm_b32 v82, v69, v65, s44
    v_perm_b32 v83, v77, v73, s44
    ds_write_b128 v13, v[80:83] offset:8192
    v_perm_b32 v84, v53, v49, s45
    v_perm_b32 v85, v61, v57, s45
    v_perm_b32 v86, v69, v65, s45
    v_perm_b32 v87, v77, v73, s45
    ds_write_b128 v13, v[84:87] offset:12288
    v_perm_b32 v80, v54, v50, s44
    v_perm_b32 v81, v62, v58, s44
    v_perm_b32 v82, v70, v66, s44
    v_perm_b32 v83, v78, v74, s44
    ds_write_b128 v13, v[80:83] offset:16384
    v_perm_b32 v84, v54, v50, s45
    v_perm_b32 v85, v62, v58, s45
    v_perm_b32 v86, v70, v66, s45
    v_perm_b32 v87, v78, v74, s45
    ds_write_b128 v13, v[84:87] offset:20480
    v_perm_b32 v80, v55, v51, s44
    v_perm_b32 v81, v63, v59, s44
    v_perm_b32 v82, v71, v67, s44
    v_perm_b32 v83, v79, v75, s44
    ds_write_b128 v13, v[80:83] offset:24576
    v_perm_b32 v84, v55, v51, s45
    v_perm_b32 v85, v63, v59, s45
    v_perm_b32 v86, v71, v67, s45
    v_perm_b32 v87, v79, v75, s45
    ds_write_b128 v13, v[84:87] offset:28672
    s_add_u32 s27, s47, 960
    buffer_load_dwordx4 v[48:51], v8, s[84:87], s27 offen
    s_add_u32 s27, s47, 2240
    buffer_load_dwordx4 v[52:55], v8, s[84:87], s27 offen
    s_add_u32 s27, s47, 11200
    buffer_load_dwordx4 v[56:59], v8, s[84:87], s27 offen
    s_add_u32 s27, s47, 12480
    buffer_load_dwordx4 v[60:63], v8, s[84:87], s27 offen
    s_add_u32 s27, s47, 21440
    buffer_load_dwordx4 v[64:67], v8, s[84:87], s27 offen
    s_add_u32 s27, s47, 22720
    buffer_load_dwordx4 v[68:71], v8, s[84:87], s27 offen
    s_add_u32 s27, s47, 31680
    buffer_load_dwordx4 v[72:75], v8, s[84:87], s27 offen
    s_add_u32 s27, s47, 32960
    buffer_load_dwordx4 v[76:79], v8, s[84:87], s27 offen
    v_and_b32 v13, 0x300, v0
    s_lshl_b32 s27, s21, 10
    s_add_u32 s27, s27, 81920
    v_add_u32 v13, s27, v0
    s_waitcnt vmcnt(14)
    v_perm_b32 v80, v20, v16, s44
    s_waitcnt vmcnt(12)
    v_perm_b32 v81, v28, v24, s44
    s_waitcnt vmcnt(10)
    v_perm_b32 v82, v36, v32, s44
    s_waitcnt vmcnt(8)
    v_perm_b32 v83, v44, v40, s44
    ds_write_b128 v13, v[80:83] offset:0
    v_perm_b32 v84, v20, v16, s45
    v_perm_b32 v85, v28, v24, s45
    v_perm_b32 v86, v36, v32, s45
    v_perm_b32 v87, v44, v40, s45
    ds_write_b128 v13, v[84:87] offset:4096
    v_perm_b32 v80, v21, v17, s44
    v_perm_b32 v81, v29, v25, s44
    v_perm_b32 v82, v37, v33, s44
    v_perm_b32 v83, v45, v41, s44
    ds_write_b128 v13, v[80:83] offset:8192
    v_perm_b32 v84, v21, v17, s45
    v_perm_b32 v85, v29, v25, s45
    v_perm_b32 v86, v37, v33, s45
    v_perm_b32 v87, v45, v41, s45
    ds_write_b128 v13, v[84:87] offset:12288
    v_perm_b32 v80, v22, v18, s44
    v_perm_b32 v81, v30, v26, s44
    v_perm_b32 v82, v38, v34, s44
    v_perm_b32 v83, v46, v42, s44
    ds_write_b128 v13, v[80:83] offset:16384
    v_perm_b32 v84, v22, v18, s45
    v_perm_b32 v85, v30, v26, s45
    v_perm_b32 v86, v38, v34, s45
    v_perm_b32 v87, v46, v42, s45
    ds_write_b128 v13, v[84:87] offset:20480
    v_perm_b32 v80, v23, v19, s44
    v_perm_b32 v81, v31, v27, s44
    v_perm_b32 v82, v39, v35, s44
    v_perm_b32 v83, v47, v43, s44
    ds_write_b128 v13, v[80:83] offset:24576
    v_perm_b32 v84, v23, v19, s45
    v_perm_b32 v85, v31, v27, s45
    v_perm_b32 v86, v39, v35, s45
    v_perm_b32 v87, v47, v43, s45
    ds_write_b128 v13, v[84:87] offset:28672
    s_add_u32 s27, s47, 256
    buffer_load_dwordx4 v[16:19], v9, s[84:87], s27 offen
    s_add_u32 s27, s47, 1536
    buffer_load_dwordx4 v[20:23], v9, s[84:87], s27 offen
    s_add_u32 s27, s47, 10496
    buffer_load_dwordx4 v[24:27], v9, s[84:87], s27 offen
    s_add_u32 s27, s47, 11776
    buffer_load_dwordx4 v[28:31], v9, s[84:87], s27 offen
    s_add_u32 s27, s47, 20736
    buffer_load_dwordx4 v[32:35], v9, s[84:87], s27 offen
    s_add_u32 s27, s47, 22016
    buffer_load_dwordx4 v[36:39], v9, s[84:87], s27 offen
    s_add_u32 s27, s47, 30976
    buffer_load_dwordx4 v[40:43], v9, s[84:87], s27 offen
    s_add_u32 s27, s47, 32256
    buffer_load_dwordx4 v[44:47], v9, s[84:87], s27 offen
    v_and_b32 v13, 0x300, v0
    s_lshl_b32 s27, s21, 10
    s_add_u32 s27, s27, 122880
    v_add_u32 v13, s27, v0
    s_waitcnt vmcnt(14)
    v_perm_b32 v80, v52, v48, s44
    s_waitcnt vmcnt(12)
    v_perm_b32 v81, v60, v56, s44
    s_waitcnt vmcnt(10)
    v_perm_b32 v82, v68, v64, s44
    s_waitcnt vmcnt(8)
    v_perm_b32 v83, v76, v72, s44
    ds_write_b128 v13, v[80:83] offset:0
    v_perm_b32 v84, v52, v48, s45
    v_perm_b32 v85, v60, v56, s45
    v_perm_b32 v86, v68, v64, s45
    v_perm_b32 v87, v76, v72, s45
    ds_write_b128 v13, v[84:87] offset:4096
    v_perm_b32 v80, v53, v49, s44
    v_perm_b32 v81, v61, v57, s44
    v_perm_b32 v82, v69, v65, s44
    v_perm_b32 v83, v77, v73, s44
    ds_write_b128 v13, v[80:83] offset:8192
    v_perm_b32 v84, v53, v49, s45
    v_perm_b32 v85, v61, v57, s45
    v_perm_b32 v86, v69, v65, s45
    v_perm_b32 v87, v77, v73, s45
    ds_write_b128 v13, v[84:87] offset:12288
    v_perm_b32 v80, v54, v50, s44
    v_perm_b32 v81, v62, v58, s44
    v_perm_b32 v82, v70, v66, s44
    v_perm_b32 v83, v78, v74, s44
    ds_write_b128 v13, v[80:83] offset:16384
    v_perm_b32 v84, v54, v50, s45
    v_perm_b32 v85, v62, v58, s45
    v_perm_b32 v86, v70, v66, s45
    v_perm_b32 v87, v78, v74, s45
    ds_write_b128 v13, v[84:87] offset:20480
    v_perm_b32 v80, v55, v51, s44
    v_perm_b32 v81, v63, v59, s44
    v_perm_b32 v82, v71, v67, s44
    v_perm_b32 v83, v79, v75, s44
    ds_write_b128 v13, v[80:83] offset:24576
    v_perm_b32 v84, v55, v51, s45
    v_perm_b32 v85, v63, v59, s45
    v_perm_b32 v86, v71, v67, s45
    v_perm_b32 v87, v79, v75, s45
    ds_write_b128 v13, v[84:87] offset:28672
    v_and_b32 v13, 0x300, v0
    s_lshl_b32 s27, s21, 10
    s_add_u32 s27, s27, 32768
    v_add_u32 v13, s27, v13
    v_bfe_u32 v14, v0, 6, 2
    v_mul_u32_u24 v14, 40960, v14
    v_add_u32 v13, v13, v14
    v_bfe_u32 v14, v0, 4, 2
    v_lshl_add_u32 v13, v14, 6, v13
    s_waitcnt vmcnt(6)
    v_perm_b32 v80, v20, v16, s44
    s_waitcnt vmcnt(4)
    v_perm_b32 v81, v28, v24, s44
    s_waitcnt vmcnt(2)
    v_perm_b32 v82, v36, v32, s44
    s_waitcnt vmcnt(0)
    v_perm_b32 v83, v44, v40, s44
    ds_write_b128 v13, v[80:83] offset:0
    v_perm_b32 v84, v20, v16, s45
    v_perm_b32 v85, v28, v24, s45
    v_perm_b32 v86, v36, v32, s45
    v_perm_b32 v87, v44, v40, s45
    ds_write_b128 v13, v[84:87] offset:4096
    v_perm_b32 v80, v21, v17, s44
    v_perm_b32 v81, v29, v25, s44
    v_perm_b32 v82, v37, v33, s44
    v_perm_b32 v83, v45, v41, s44
    ds_write_b128 v13, v[80:83] offset:16
    v_perm_b32 v84, v21, v17, s45
    v_perm_b32 v85, v29, v25, s45
    v_perm_b32 v86, v37, v33, s45
    v_perm_b32 v87, v45, v41, s45
    ds_write_b128 v13, v[84:87] offset:4112
    v_perm_b32 v80, v22, v18, s44
    v_perm_b32 v81, v30, v26, s44
    v_perm_b32 v82, v38, v34, s44
    v_perm_b32 v83, v46, v42, s44
    ds_write_b128 v13, v[80:83] offset:32
    v_perm_b32 v84, v22, v18, s45
    v_perm_b32 v85, v30, v26, s45
    v_perm_b32 v86, v38, v34, s45
    v_perm_b32 v87, v46, v42, s45
    ds_write_b128 v13, v[84:87] offset:4128
    v_perm_b32 v80, v23, v19, s44
    v_perm_b32 v81, v31, v27, s44
    v_perm_b32 v82, v39, v35, s44
    v_perm_b32 v83, v47, v43, s44
    ds_write_b128 v13, v[80:83] offset:48
    v_perm_b32 v84, v23, v19, s45
    v_perm_b32 v85, v31, v27, s45
    v_perm_b32 v86, v39, v35, s45
    v_perm_b32 v87, v47, v43, s45
    ds_write_b128 v13, v[84:87] offset:4144
    s_waitcnt lgkmcnt(0)
    s_barrier
    ds_read_b128 a[160:163], v7 offset:0
    ds_read_b128 a[164:167], v7 offset:1024
    ds_read_b128 a[168:171], v7 offset:2048
    ds_read_b128 a[172:175], v7 offset:3072
    ds_read_b128 a[176:179], v7 offset:4096
    ds_read_b128 a[180:183], v7 offset:5120
    ds_read_b128 a[184:187], v7 offset:6144
    ds_read_b128 a[188:191], v7 offset:7168
    ds_read_b128 a[192:195], v7 offset:8192
    ds_read_b128 a[196:199], v7 offset:9216
    ds_read_b128 a[200:203], v7 offset:10240
    ds_read_b128 a[204:207], v7 offset:11264
    ds_read_b128 a[208:211], v7 offset:12288
    ds_read_b128 a[212:215], v7 offset:13312
    ds_read_b128 a[216:219], v7 offset:14336
    ds_read_b128 a[220:223], v7 offset:15360
    ds_read_b128 a[224:227], v7 offset:16384
    ds_read_b128 a[228:231], v7 offset:17408
    ds_read_b128 a[232:235], v7 offset:18432
    ds_read_b128 a[236:239], v7 offset:19456
    ds_read_b128 a[240:243], v7 offset:20480
    ds_read_b128 a[244:247], v7 offset:21504
    ds_read_b128 a[248:251], v7 offset:22528
    ds_read_b128 a[252:255], v7 offset:23552
    ds_read_b128 v[192:195], v7 offset:24576
    ds_read_b128 v[196:199], v7 offset:25600
    ds_read_b128 v[200:203], v7 offset:26624
    ds_read_b128 v[204:207], v7 offset:27648
    ds_read_b128 v[208:211], v7 offset:28672
    ds_read_b128 v[212:215], v7 offset:29696
    ds_read_b128 v[216:219], v7 offset:30720
    ds_read_b128 v[220:223], v7 offset:31744
    ds_read_b128 v[224:227], v7 offset:32768
    ds_read_b128 v[228:231], v7 offset:33792
    ds_read_b128 v[232:235], v7 offset:34816
    ds_read_b128 v[236:239], v7 offset:35840
    ds_read_b128 v[240:243], v7 offset:36864
    ds_read_b128 v[244:247], v7 offset:37888
    ds_read_b128 v[248:251], v7 offset:38912
    ds_read_b128 v[252:255], v7 offset:39936
    s_waitcnt lgkmcnt(0)
    s_barrier
    s_mov_b32 s44, 0x05040100
    s_mov_b32 s45, 0x07060302
    s_add_u32 s26, s21, 0
    s_lshl_b32 s27, s26, 18
    s_add_u32 s27, s27, s46
    buffer_load_dwordx4 v[16:19], v12, s[72:75], s27 offen
    s_add_u32 s27, s27, 8192
    buffer_load_dwordx4 v[20:23], v12, s[72:75], s27 offen
    s_add_u32 s27, s27, 8192
    buffer_load_dwordx4 v[24:27], v12, s[72:75], s27 offen
    s_add_u32 s27, s27, 8192
    buffer_load_dwordx4 v[28:31], v12, s[72:75], s27 offen
    s_add_u32 s27, s27, 8192
    buffer_load_dwordx4 v[32:35], v12, s[72:75], s27 offen
    s_add_u32 s27, s27, 8192
    buffer_load_dwordx4 v[36:39], v12, s[72:75], s27 offen
    s_add_u32 s27, s27, 8192
    buffer_load_dwordx4 v[40:43], v12, s[72:75], s27 offen
    s_add_u32 s27, s27, 8192
    buffer_load_dwordx4 v[44:47], v12, s[72:75], s27 offen
    s_add_u32 s26, s21, 4
    s_lshl_b32 s27, s26, 18
    s_add_u32 s27, s27, s46
    buffer_load_dwordx4 v[48:51], v12, s[72:75], s27 offen
    s_add_u32 s27, s27, 8192
    buffer_load_dwordx4 v[52:55], v12, s[72:75], s27 offen
    s_add_u32 s27, s27, 8192
    buffer_load_dwordx4 v[56:59], v12, s[72:75], s27 offen
    s_add_u32 s27, s27, 8192
    buffer_load_dwordx4 v[60:63], v12, s[72:75], s27 offen
    s_add_u32 s27, s27, 8192
    buffer_load_dwordx4 v[64:67], v12, s[72:75], s27 offen
    s_add_u32 s27, s27, 8192
    buffer_load_dwordx4 v[68:71], v12, s[72:75], s27 offen
    s_add_u32 s27, s27, 8192
    buffer_load_dwordx4 v[72:75], v12, s[72:75], s27 offen
    s_add_u32 s27, s27, 8192
    buffer_load_dwordx4 v[76:79], v12, s[72:75], s27 offen
    s_lshl_b32 s27, s21, 11
    s_add_u32 s27, s27, 0
    v_add_u32 v13, s27, v0
    s_waitcnt vmcnt(14)
    v_perm_b32 v80, v20, v16, s44
    s_waitcnt vmcnt(12)
    v_perm_b32 v81, v28, v24, s44
    s_waitcnt vmcnt(10)
    v_perm_b32 v82, v36, v32, s44
    s_waitcnt vmcnt(8)
    v_perm_b32 v83, v44, v40, s44
    ds_write_b128 v13, v[80:83] offset:0
    v_perm_b32 v84, v20, v16, s45
    v_perm_b32 v85, v28, v24, s45
    v_perm_b32 v86, v36, v32, s45
    v_perm_b32 v87, v44, v40, s45
    ds_write_b128 v13, v[84:87] offset:1024
    v_perm_b32 v80, v21, v17, s44
    v_perm_b32 v81, v29, v25, s44
    v_perm_b32 v82, v37, v33, s44
    v_perm_b32 v83, v45, v41, s44
    ds_write_b128 v13, v[80:83] offset:8192
    v_perm_b32 v84, v21, v17, s45
    v_perm_b32 v85, v29, v25, s45
    v_perm_b32 v86, v37, v33, s45
    v_perm_b32 v87, v45, v41, s45
    ds_write_b128 v13, v[84:87] offset:9216
    v_perm_b32 v80, v22, v18, s44
    v_perm_b32 v81, v30, v26, s44
    v_perm_b32 v82, v38, v34, s44
    v_perm_b32 v83, v46, v42, s44
    ds_write_b128 v13, v[80:83] offset:16384
    v_perm_b32 v84, v22, v18, s45
    v_perm_b32 v85, v30, v26, s45
    v_perm_b32 v86, v38, v34, s45
    v_perm_b32 v87, v46, v42, s45
    ds_write_b128 v13, v[84:87] offset:17408
    v_perm_b32 v80, v23, v19, s44
    v_perm_b32 v81, v31, v27, s44
    v_perm_b32 v82, v39, v35, s44
    v_perm_b32 v83, v47, v43, s44
    ds_write_b128 v13, v[80:83] offset:24576
    v_perm_b32 v84, v23, v19, s45
    v_perm_b32 v85, v31, v27, s45
    v_perm_b32 v86, v39, v35, s45
    v_perm_b32 v87, v47, v43, s45
    ds_write_b128 v13, v[84:87] offset:25600
    s_add_u32 s26, s21, 8
    s_lshl_b32 s27, s26, 18
    s_add_u32 s27, s27, s46
    buffer_load_dwordx4 v[16:19], v12, s[72:75], s27 offen
    s_add_u32 s27, s27, 8192
    buffer_load_dwordx4 v[20:23], v12, s[72:75], s27 offen
    s_add_u32 s27, s27, 8192
    buffer_load_dwordx4 v[24:27], v12, s[72:75], s27 offen
    s_add_u32 s27, s27, 8192
    buffer_load_dwordx4 v[28:31], v12, s[72:75], s27 offen
    s_add_u32 s27, s27, 8192
    buffer_load_dwordx4 v[32:35], v12, s[72:75], s27 offen
    s_add_u32 s27, s27, 8192
    buffer_load_dwordx4 v[36:39], v12, s[72:75], s27 offen
    s_add_u32 s27, s27, 8192
    buffer_load_dwordx4 v[40:43], v12, s[72:75], s27 offen
    s_add_u32 s27, s27, 8192
    buffer_load_dwordx4 v[44:47], v12, s[72:75], s27 offen
    s_waitcnt lgkmcnt(0)
    s_barrier
    ds_read_b128 a[0:3], v4 offset:0
    ds_read_b128 a[80:83], v4 offset:1024
    ds_read_b128 a[4:7], v4 offset:2048
    ds_read_b128 a[84:87], v4 offset:3072
    ds_read_b128 a[8:11], v4 offset:4096
    ds_read_b128 a[88:91], v4 offset:5120
    ds_read_b128 a[12:15], v4 offset:6144
    ds_read_b128 a[92:95], v4 offset:7168
    s_lshl_b32 s27, s21, 11
    s_add_u32 s27, s27, 32768
    v_add_u32 v13, s27, v0
    s_waitcnt vmcnt(14)
    v_perm_b32 v80, v52, v48, s44
    s_waitcnt vmcnt(12)
    v_perm_b32 v81, v60, v56, s44
    s_waitcnt vmcnt(10)
    v_perm_b32 v82, v68, v64, s44
    s_waitcnt vmcnt(8)
    v_perm_b32 v83, v76, v72, s44
    ds_write_b128 v13, v[80:83] offset:0
    v_perm_b32 v84, v52, v48, s45
    v_perm_b32 v85, v60, v56, s45
    v_perm_b32 v86, v68, v64, s45
    v_perm_b32 v87, v76, v72, s45
    ds_write_b128 v13, v[84:87] offset:1024
    v_perm_b32 v80, v53, v49, s44
    v_perm_b32 v81, v61, v57, s44
    v_perm_b32 v82, v69, v65, s44
    v_perm_b32 v83, v77, v73, s44
    ds_write_b128 v13, v[80:83] offset:8192
    v_perm_b32 v84, v53, v49, s45
    v_perm_b32 v85, v61, v57, s45
    v_perm_b32 v86, v69, v65, s45
    v_perm_b32 v87, v77, v73, s45
    ds_write_b128 v13, v[84:87] offset:9216
    v_perm_b32 v80, v54, v50, s44
    v_perm_b32 v81, v62, v58, s44
    v_perm_b32 v82, v70, v66, s44
    v_perm_b32 v83, v78, v74, s44
    ds_write_b128 v13, v[80:83] offset:16384
    v_perm_b32 v84, v54, v50, s45
    v_perm_b32 v85, v62, v58, s45
    v_perm_b32 v86, v70, v66, s45
    v_perm_b32 v87, v78, v74, s45
    ds_write_b128 v13, v[84:87] offset:17408
    v_perm_b32 v80, v55, v51, s44
    v_perm_b32 v81, v63, v59, s44
    v_perm_b32 v82, v71, v67, s44
    v_perm_b32 v83, v79, v75, s44
    ds_write_b128 v13, v[80:83] offset:24576
    v_perm_b32 v84, v55, v51, s45
    v_perm_b32 v85, v63, v59, s45
    v_perm_b32 v86, v71, v67, s45
    v_perm_b32 v87, v79, v75, s45
    ds_write_b128 v13, v[84:87] offset:25600
    s_add_u32 s26, s21, 12
    s_lshl_b32 s27, s26, 18
    s_add_u32 s27, s27, s46
    buffer_load_dwordx4 v[48:51], v12, s[72:75], s27 offen
    s_add_u32 s27, s27, 8192
    buffer_load_dwordx4 v[52:55], v12, s[72:75], s27 offen
    s_add_u32 s27, s27, 8192
    buffer_load_dwordx4 v[56:59], v12, s[72:75], s27 offen
    s_add_u32 s27, s27, 8192
    buffer_load_dwordx4 v[60:63], v12, s[72:75], s27 offen
    s_add_u32 s27, s27, 8192
    buffer_load_dwordx4 v[64:67], v12, s[72:75], s27 offen
    s_add_u32 s27, s27, 8192
    buffer_load_dwordx4 v[68:71], v12, s[72:75], s27 offen
    s_add_u32 s27, s27, 8192
    buffer_load_dwordx4 v[72:75], v12, s[72:75], s27 offen
    s_add_u32 s27, s27, 8192
    buffer_load_dwordx4 v[76:79], v12, s[72:75], s27 offen
    s_waitcnt lgkmcnt(0)
    s_barrier
    ds_read_b128 a[16:19], v5 offset:0
    ds_read_b128 a[96:99], v5 offset:1024
    ds_read_b128 a[20:23], v5 offset:2048
    ds_read_b128 a[100:103], v5 offset:3072
    ds_read_b128 a[24:27], v5 offset:4096
    ds_read_b128 a[104:107], v5 offset:5120
    ds_read_b128 a[28:31], v5 offset:6144
    ds_read_b128 a[108:111], v5 offset:7168
    s_lshl_b32 s27, s21, 11
    s_add_u32 s27, s27, 0
    v_add_u32 v13, s27, v0
    s_waitcnt vmcnt(14)
    v_perm_b32 v80, v20, v16, s44
    s_waitcnt vmcnt(12)
    v_perm_b32 v81, v28, v24, s44
    s_waitcnt vmcnt(10)
    v_perm_b32 v82, v36, v32, s44
    s_waitcnt vmcnt(8)
    v_perm_b32 v83, v44, v40, s44
    ds_write_b128 v13, v[80:83] offset:0
    v_perm_b32 v84, v20, v16, s45
    v_perm_b32 v85, v28, v24, s45
    v_perm_b32 v86, v36, v32, s45
    v_perm_b32 v87, v44, v40, s45
    ds_write_b128 v13, v[84:87] offset:1024
    v_perm_b32 v80, v21, v17, s44
    v_perm_b32 v81, v29, v25, s44
    v_perm_b32 v82, v37, v33, s44
    v_perm_b32 v83, v45, v41, s44
    ds_write_b128 v13, v[80:83] offset:8192
    v_perm_b32 v84, v21, v17, s45
    v_perm_b32 v85, v29, v25, s45
    v_perm_b32 v86, v37, v33, s45
    v_perm_b32 v87, v45, v41, s45
    ds_write_b128 v13, v[84:87] offset:9216
    v_perm_b32 v80, v22, v18, s44
    v_perm_b32 v81, v30, v26, s44
    v_perm_b32 v82, v38, v34, s44
    v_perm_b32 v83, v46, v42, s44
    ds_write_b128 v13, v[80:83] offset:16384
    v_perm_b32 v84, v22, v18, s45
    v_perm_b32 v85, v30, v26, s45
    v_perm_b32 v86, v38, v34, s45
    v_perm_b32 v87, v46, v42, s45
    ds_write_b128 v13, v[84:87] offset:17408
    v_perm_b32 v80, v23, v19, s44
    v_perm_b32 v81, v31, v27, s44
    v_perm_b32 v82, v39, v35, s44
    v_perm_b32 v83, v47, v43, s44
    ds_write_b128 v13, v[80:83] offset:24576
    v_perm_b32 v84, v23, v19, s45
    v_perm_b32 v85, v31, v27, s45
    v_perm_b32 v86, v39, v35, s45
    v_perm_b32 v87, v47, v43, s45
    ds_write_b128 v13, v[84:87] offset:25600
    s_add_u32 s26, s21, 16
    s_lshl_b32 s27, s26, 18
    s_add_u32 s27, s27, s46
    buffer_load_dwordx4 v[16:19], v12, s[72:75], s27 offen
    s_add_u32 s27, s27, 8192
    buffer_load_dwordx4 v[20:23], v12, s[72:75], s27 offen
    s_add_u32 s27, s27, 8192
    buffer_load_dwordx4 v[24:27], v12, s[72:75], s27 offen
    s_add_u32 s27, s27, 8192
    buffer_load_dwordx4 v[28:31], v12, s[72:75], s27 offen
    s_add_u32 s27, s27, 8192
    buffer_load_dwordx4 v[32:35], v12, s[72:75], s27 offen
    s_add_u32 s27, s27, 8192
    buffer_load_dwordx4 v[36:39], v12, s[72:75], s27 offen
    s_add_u32 s27, s27, 8192
    buffer_load_dwordx4 v[40:43], v12, s[72:75], s27 offen
    s_add_u32 s27, s27, 8192
    buffer_load_dwordx4 v[44:47], v12, s[72:75], s27 offen
    s_waitcnt lgkmcnt(0)
    s_barrier
    ds_read_b128 a[32:35], v4 offset:0
    ds_read_b128 a[112:115], v4 offset:1024
    ds_read_b128 a[36:39], v4 offset:2048
    ds_read_b128 a[116:119], v4 offset:3072
    ds_read_b128 a[40:43], v4 offset:4096
    ds_read_b128 a[120:123], v4 offset:5120
    ds_read_b128 a[44:47], v4 offset:6144
    ds_read_b128 a[124:127], v4 offset:7168
    s_lshl_b32 s27, s21, 11
    s_add_u32 s27, s27, 32768
    v_add_u32 v13, s27, v0
    s_waitcnt vmcnt(14)
    v_perm_b32 v80, v52, v48, s44
    s_waitcnt vmcnt(12)
    v_perm_b32 v81, v60, v56, s44
    s_waitcnt vmcnt(10)
    v_perm_b32 v82, v68, v64, s44
    s_waitcnt vmcnt(8)
    v_perm_b32 v83, v76, v72, s44
    ds_write_b128 v13, v[80:83] offset:0
    v_perm_b32 v84, v52, v48, s45
    v_perm_b32 v85, v60, v56, s45
    v_perm_b32 v86, v68, v64, s45
    v_perm_b32 v87, v76, v72, s45
    ds_write_b128 v13, v[84:87] offset:1024
    v_perm_b32 v80, v53, v49, s44
    v_perm_b32 v81, v61, v57, s44
    v_perm_b32 v82, v69, v65, s44
    v_perm_b32 v83, v77, v73, s44
    ds_write_b128 v13, v[80:83] offset:8192
    v_perm_b32 v84, v53, v49, s45
    v_perm_b32 v85, v61, v57, s45
    v_perm_b32 v86, v69, v65, s45
    v_perm_b32 v87, v77, v73, s45
    ds_write_b128 v13, v[84:87] offset:9216
    v_perm_b32 v80, v54, v50, s44
    v_perm_b32 v81, v62, v58, s44
    v_perm_b32 v82, v70, v66, s44
    v_perm_b32 v83, v78, v74, s44
    ds_write_b128 v13, v[80:83] offset:16384
    v_perm_b32 v84, v54, v50, s45
    v_perm_b32 v85, v62, v58, s45
    v_perm_b32 v86, v70, v66, s45
    v_perm_b32 v87, v78, v74, s45
    ds_write_b128 v13, v[84:87] offset:17408
    v_perm_b32 v80, v55, v51, s44
    v_perm_b32 v81, v63, v59, s44
    v_perm_b32 v82, v71, v67, s44
    v_perm_b32 v83, v79, v75, s44
    ds_write_b128 v13, v[80:83] offset:24576
    v_perm_b32 v84, v55, v51, s45
    v_perm_b32 v85, v63, v59, s45
    v_perm_b32 v86, v71, v67, s45
    v_perm_b32 v87, v79, v75, s45
    ds_write_b128 v13, v[84:87] offset:25600
    s_waitcnt lgkmcnt(0)
    s_barrier
    ds_read_b128 a[48:51], v5 offset:0
    ds_read_b128 a[128:131], v5 offset:1024
    ds_read_b128 a[52:55], v5 offset:2048
    ds_read_b128 a[132:135], v5 offset:3072
    ds_read_b128 a[56:59], v5 offset:4096
    ds_read_b128 a[136:139], v5 offset:5120
    ds_read_b128 a[60:63], v5 offset:6144
    ds_read_b128 a[140:143], v5 offset:7168
    s_lshl_b32 s27, s21, 11
    s_add_u32 s27, s27, 0
    v_add_u32 v13, s27, v0
    s_waitcnt vmcnt(6)
    v_perm_b32 v80, v20, v16, s44
    s_waitcnt vmcnt(4)
    v_perm_b32 v81, v28, v24, s44
    s_waitcnt vmcnt(2)
    v_perm_b32 v82, v36, v32, s44
    s_waitcnt vmcnt(0)
    v_perm_b32 v83, v44, v40, s44
    ds_write_b128 v13, v[80:83] offset:0
    v_perm_b32 v84, v20, v16, s45
    v_perm_b32 v85, v28, v24, s45
    v_perm_b32 v86, v36, v32, s45
    v_perm_b32 v87, v44, v40, s45
    ds_write_b128 v13, v[84:87] offset:1024
    v_perm_b32 v80, v21, v17, s44
    v_perm_b32 v81, v29, v25, s44
    v_perm_b32 v82, v37, v33, s44
    v_perm_b32 v83, v45, v41, s44
    ds_write_b128 v13, v[80:83] offset:8192
    v_perm_b32 v84, v21, v17, s45
    v_perm_b32 v85, v29, v25, s45
    v_perm_b32 v86, v37, v33, s45
    v_perm_b32 v87, v45, v41, s45
    ds_write_b128 v13, v[84:87] offset:9216
    v_perm_b32 v80, v22, v18, s44
    v_perm_b32 v81, v30, v26, s44
    v_perm_b32 v82, v38, v34, s44
    v_perm_b32 v83, v46, v42, s44
    ds_write_b128 v13, v[80:83] offset:16384
    v_perm_b32 v84, v22, v18, s45
    v_perm_b32 v85, v30, v26, s45
    v_perm_b32 v86, v38, v34, s45
    v_perm_b32 v87, v46, v42, s45
    ds_write_b128 v13, v[84:87] offset:17408
    v_perm_b32 v80, v23, v19, s44
    v_perm_b32 v81, v31, v27, s44
    v_perm_b32 v82, v39, v35, s44
    v_perm_b32 v83, v47, v43, s44
    ds_write_b128 v13, v[80:83] offset:24576
    v_perm_b32 v84, v23, v19, s45
    v_perm_b32 v85, v31, v27, s45
    v_perm_b32 v86, v39, v35, s45
    v_perm_b32 v87, v47, v43, s45
    ds_write_b128 v13, v[84:87] offset:25600
    s_waitcnt lgkmcnt(0)
    s_barrier
    ds_read_b128 a[64:67], v4 offset:0
    ds_read_b128 a[144:147], v4 offset:1024
    ds_read_b128 a[68:71], v4 offset:2048
    ds_read_b128 a[148:151], v4 offset:3072
    ds_read_b128 a[72:75], v4 offset:4096
    ds_read_b128 a[152:155], v4 offset:5120
    ds_read_b128 a[76:79], v4 offset:6144
    ds_read_b128 a[156:159], v4 offset:7168
    s_waitcnt lgkmcnt(0)
    s_branch M_lw_done
M_bl_kv:
    s_mov_b32 s44, 0x05040100
    s_mov_b32 s45, 0x07060302
    s_add_u32 s26, s21, 0
    s_lshl_b32 s27, s26, 18
    s_add_u32 s27, s27, s46
    buffer_load_dwordx4 v[16:19], v12, s[76:79], s27 offen
    s_add_u32 s27, s27, 8192
    buffer_load_dwordx4 v[20:23], v12, s[76:79], s27 offen
    s_add_u32 s27, s27, 8192
    buffer_load_dwordx4 v[24:27], v12, s[76:79], s27 offen
    s_add_u32 s27, s27, 8192
    buffer_load_dwordx4 v[28:31], v12, s[76:79], s27 offen
    s_add_u32 s27, s27, 8192
    buffer_load_dwordx4 v[32:35], v12, s[76:79], s27 offen
    s_add_u32 s27, s27, 8192
    buffer_load_dwordx4 v[36:39], v12, s[76:79], s27 offen
    s_add_u32 s27, s27, 8192
    buffer_load_dwordx4 v[40:43], v12, s[76:79], s27 offen
    s_add_u32 s27, s27, 8192
    buffer_load_dwordx4 v[44:47], v12, s[76:79], s27 offen
    s_add_u32 s26, s21, 4
    s_lshl_b32 s27, s26, 18
    s_add_u32 s27, s27, s46
    buffer_load_dwordx4 v[48:51], v12, s[76:79], s27 offen
    s_add_u32 s27, s27, 8192
    buffer_load_dwordx4 v[52:55], v12, s[76:79], s27 offen
    s_add_u32 s27, s27, 8192
    buffer_load_dwordx4 v[56:59], v12, s[76:79], s27 offen
    s_add_u32 s27, s27, 8192
    buffer_load_dwordx4 v[60:63], v12, s[76:79], s27 offen
    s_add_u32 s27, s27, 8192
    buffer_load_dwordx4 v[64:67], v12, s[76:79], s27 offen
    s_add_u32 s27, s27, 8192
    buffer_load_dwordx4 v[68:71], v12, s[76:79], s27 offen
    s_add_u32 s27, s27, 8192
    buffer_load_dwordx4 v[72:75], v12, s[76:79], s27 offen
    s_add_u32 s27, s27, 8192
    buffer_load_dwordx4 v[76:79], v12, s[76:79], s27 offen
    s_lshl_b32 s27, s21, 11
    s_add_u32 s27, s27, 0
    v_add_u32 v13, s27, v0
    s_waitcnt vmcnt(14)
    v_perm_b32 v80, v20, v16, s44
    s_waitcnt vmcnt(12)
    v_perm_b32 v81, v28, v24, s44
    s_waitcnt vmcnt(10)
    v_perm_b32 v82, v36, v32, s44
    s_waitcnt vmcnt(8)
    v_perm_b32 v83, v44, v40, s44
    ds_write_b128 v13, v[80:83] offset:0
    v_perm_b32 v84, v20, v16, s45
    v_perm_b32 v85, v28, v24, s45
    v_perm_b32 v86, v36, v32, s45
    v_perm_b32 v87, v44, v40, s45
    ds_write_b128 v13, v[84:87] offset:1024
    v_perm_b32 v80, v21, v17, s44
    v_perm_b32 v81, v29, v25, s44
    v_perm_b32 v82, v37, v33, s44
    v_perm_b32 v83, v45, v41, s44
    ds_write_b128 v13, v[80:83] offset:8192
    v_perm_b32 v84, v21, v17, s45
    v_perm_b32 v85, v29, v25, s45
    v_perm_b32 v86, v37, v33, s45
    v_perm_b32 v87, v45, v41, s45
    ds_write_b128 v13, v[84:87] offset:9216
    v_perm_b32 v80, v22, v18, s44
    v_perm_b32 v81, v30, v26, s44
    v_perm_b32 v82, v38, v34, s44
    v_perm_b32 v83, v46, v42, s44
    ds_write_b128 v13, v[80:83] offset:16384
    v_perm_b32 v84, v22, v18, s45
    v_perm_b32 v85, v30, v26, s45
    v_perm_b32 v86, v38, v34, s45
    v_perm_b32 v87, v46, v42, s45
    ds_write_b128 v13, v[84:87] offset:17408
    v_perm_b32 v80, v23, v19, s44
    v_perm_b32 v81, v31, v27, s44
    v_perm_b32 v82, v39, v35, s44
    v_perm_b32 v83, v47, v43, s44
    ds_write_b128 v13, v[80:83] offset:24576
    v_perm_b32 v84, v23, v19, s45
    v_perm_b32 v85, v31, v27, s45
    v_perm_b32 v86, v39, v35, s45
    v_perm_b32 v87, v47, v43, s45
    ds_write_b128 v13, v[84:87] offset:25600
    s_add_u32 s26, s21, 8
    s_lshl_b32 s27, s26, 18
    s_add_u32 s27, s27, s46
    buffer_load_dwordx4 v[16:19], v12, s[76:79], s27 offen
    s_add_u32 s27, s27, 8192
    buffer_load_dwordx4 v[20:23], v12, s[76:79], s27 offen
    s_add_u32 s27, s27, 8192
    buffer_load_dwordx4 v[24:27], v12, s[76:79], s27 offen
    s_add_u32 s27, s27, 8192
    buffer_load_dwordx4 v[28:31], v12, s[76:79], s27 offen
    s_add_u32 s27, s27, 8192
    buffer_load_dwordx4 v[32:35], v12, s[76:79], s27 offen
    s_add_u32 s27, s27, 8192
    buffer_load_dwordx4 v[36:39], v12, s[76:79], s27 offen
    s_add_u32 s27, s27, 8192
    buffer_load_dwordx4 v[40:43], v12, s[76:79], s27 offen
    s_add_u32 s27, s27, 8192
    buffer_load_dwordx4 v[44:47], v12, s[76:79], s27 offen
    s_waitcnt lgkmcnt(0)
    s_barrier
    ds_read_b128 a[0:3], v4 offset:0
    ds_read_b128 a[80:83], v4 offset:1024
    ds_read_b128 a[4:7], v4 offset:2048
    ds_read_b128 a[84:87], v4 offset:3072
    ds_read_b128 a[8:11], v4 offset:4096
    ds_read_b128 a[88:91], v4 offset:5120
    ds_read_b128 a[12:15], v4 offset:6144
    ds_read_b128 a[92:95], v4 offset:7168
    s_lshl_b32 s27, s21, 11
    s_add_u32 s27, s27, 32768
    v_add_u32 v13, s27, v0
    s_waitcnt vmcnt(14)
    v_perm_b32 v80, v52, v48, s44
    s_waitcnt vmcnt(12)
    v_perm_b32 v81, v60, v56, s44
    s_waitcnt vmcnt(10)
    v_perm_b32 v82, v68, v64, s44
    s_waitcnt vmcnt(8)
    v_perm_b32 v83, v76, v72, s44
    ds_write_b128 v13, v[80:83] offset:0
    v_perm_b32 v84, v52, v48, s45
    v_perm_b32 v85, v60, v56, s45
    v_perm_b32 v86, v68, v64, s45
    v_perm_b32 v87, v76, v72, s45
    ds_write_b128 v13, v[84:87] offset:1024
    v_perm_b32 v80, v53, v49, s44
    v_perm_b32 v81, v61, v57, s44
    v_perm_b32 v82, v69, v65, s44
    v_perm_b32 v83, v77, v73, s44
    ds_write_b128 v13, v[80:83] offset:8192
    v_perm_b32 v84, v53, v49, s45
    v_perm_b32 v85, v61, v57, s45
    v_perm_b32 v86, v69, v65, s45
    v_perm_b32 v87, v77, v73, s45
    ds_write_b128 v13, v[84:87] offset:9216
    v_perm_b32 v80, v54, v50, s44
    v_perm_b32 v81, v62, v58, s44
    v_perm_b32 v82, v70, v66, s44
    v_perm_b32 v83, v78, v74, s44
    ds_write_b128 v13, v[80:83] offset:16384
    v_perm_b32 v84, v54, v50, s45
    v_perm_b32 v85, v62, v58, s45
    v_perm_b32 v86, v70, v66, s45
    v_perm_b32 v87, v78, v74, s45
    ds_write_b128 v13, v[84:87] offset:17408
    v_perm_b32 v80, v55, v51, s44
    v_perm_b32 v81, v63, v59, s44
    v_perm_b32 v82, v71, v67, s44
    v_perm_b32 v83, v79, v75, s44
    ds_write_b128 v13, v[80:83] offset:24576
    v_perm_b32 v84, v55, v51, s45
    v_perm_b32 v85, v63, v59, s45
    v_perm_b32 v86, v71, v67, s45
    v_perm_b32 v87, v79, v75, s45
    ds_write_b128 v13, v[84:87] offset:25600
    s_add_u32 s26, s21, 12
    s_lshl_b32 s27, s26, 18
    s_add_u32 s27, s27, s46
    buffer_load_dwordx4 v[48:51], v12, s[76:79], s27 offen
    s_add_u32 s27, s27, 8192
    buffer_load_dwordx4 v[52:55], v12, s[76:79], s27 offen
    s_add_u32 s27, s27, 8192
    buffer_load_dwordx4 v[56:59], v12, s[76:79], s27 offen
    s_add_u32 s27, s27, 8192
    buffer_load_dwordx4 v[60:63], v12, s[76:79], s27 offen
    s_add_u32 s27, s27, 8192
    buffer_load_dwordx4 v[64:67], v12, s[76:79], s27 offen
    s_add_u32 s27, s27, 8192
    buffer_load_dwordx4 v[68:71], v12, s[76:79], s27 offen
    s_add_u32 s27, s27, 8192
    buffer_load_dwordx4 v[72:75], v12, s[76:79], s27 offen
    s_add_u32 s27, s27, 8192
    buffer_load_dwordx4 v[76:79], v12, s[76:79], s27 offen
    s_waitcnt lgkmcnt(0)
    s_barrier
    ds_read_b128 a[16:19], v5 offset:0
    ds_read_b128 a[96:99], v5 offset:1024
    ds_read_b128 a[20:23], v5 offset:2048
    ds_read_b128 a[100:103], v5 offset:3072
    ds_read_b128 a[24:27], v5 offset:4096
    ds_read_b128 a[104:107], v5 offset:5120
    ds_read_b128 a[28:31], v5 offset:6144
    ds_read_b128 a[108:111], v5 offset:7168
    s_lshl_b32 s27, s21, 11
    s_add_u32 s27, s27, 0
    v_add_u32 v13, s27, v0
    s_waitcnt vmcnt(14)
    v_perm_b32 v80, v20, v16, s44
    s_waitcnt vmcnt(12)
    v_perm_b32 v81, v28, v24, s44
    s_waitcnt vmcnt(10)
    v_perm_b32 v82, v36, v32, s44
    s_waitcnt vmcnt(8)
    v_perm_b32 v83, v44, v40, s44
    ds_write_b128 v13, v[80:83] offset:0
    v_perm_b32 v84, v20, v16, s45
    v_perm_b32 v85, v28, v24, s45
    v_perm_b32 v86, v36, v32, s45
    v_perm_b32 v87, v44, v40, s45
    ds_write_b128 v13, v[84:87] offset:1024
    v_perm_b32 v80, v21, v17, s44
    v_perm_b32 v81, v29, v25, s44
    v_perm_b32 v82, v37, v33, s44
    v_perm_b32 v83, v45, v41, s44
    ds_write_b128 v13, v[80:83] offset:8192
    v_perm_b32 v84, v21, v17, s45
    v_perm_b32 v85, v29, v25, s45
    v_perm_b32 v86, v37, v33, s45
    v_perm_b32 v87, v45, v41, s45
    ds_write_b128 v13, v[84:87] offset:9216
    v_perm_b32 v80, v22, v18, s44
    v_perm_b32 v81, v30, v26, s44
    v_perm_b32 v82, v38, v34, s44
    v_perm_b32 v83, v46, v42, s44
    ds_write_b128 v13, v[80:83] offset:16384
    v_perm_b32 v84, v22, v18, s45
    v_perm_b32 v85, v30, v26, s45
    v_perm_b32 v86, v38, v34, s45
    v_perm_b32 v87, v46, v42, s45
    ds_write_b128 v13, v[84:87] offset:17408
    v_perm_b32 v80, v23, v19, s44
    v_perm_b32 v81, v31, v27, s44
    v_perm_b32 v82, v39, v35, s44
    v_perm_b32 v83, v47, v43, s44
    ds_write_b128 v13, v[80:83] offset:24576
    v_perm_b32 v84, v23, v19, s45
    v_perm_b32 v85, v31, v27, s45
    v_perm_b32 v86, v39, v35, s45
    v_perm_b32 v87, v47, v43, s45
    ds_write_b128 v13, v[84:87] offset:25600
    s_add_u32 s26, s21, 16
    s_lshl_b32 s27, s26, 18
    s_add_u32 s27, s27, s46
    buffer_load_dwordx4 v[16:19], v12, s[76:79], s27 offen
    s_add_u32 s27, s27, 8192
    buffer_load_dwordx4 v[20:23], v12, s[76:79], s27 offen
    s_add_u32 s27, s27, 8192
    buffer_load_dwordx4 v[24:27], v12, s[76:79], s27 offen
    s_add_u32 s27, s27, 8192
    buffer_load_dwordx4 v[28:31], v12, s[76:79], s27 offen
    s_add_u32 s27, s27, 8192
    buffer_load_dwordx4 v[32:35], v12, s[76:79], s27 offen
    s_add_u32 s27, s27, 8192
    buffer_load_dwordx4 v[36:39], v12, s[76:79], s27 offen
    s_add_u32 s27, s27, 8192
    buffer_load_dwordx4 v[40:43], v12, s[76:79], s27 offen
    s_add_u32 s27, s27, 8192
    buffer_load_dwordx4 v[44:47], v12, s[76:79], s27 offen
    s_waitcnt lgkmcnt(0)
    s_barrier
    ds_read_b128 a[32:35], v4 offset:0
    ds_read_b128 a[112:115], v4 offset:1024
    ds_read_b128 a[36:39], v4 offset:2048
    ds_read_b128 a[116:119], v4 offset:3072
    ds_read_b128 a[40:43], v4 offset:4096
    ds_read_b128 a[120:123], v4 offset:5120
    ds_read_b128 a[44:47], v4 offset:6144
    ds_read_b128 a[124:127], v4 offset:7168
    s_lshl_b32 s27, s21, 11
    s_add_u32 s27, s27, 32768
    v_add_u32 v13, s27, v0
    s_waitcnt vmcnt(14)
    v_perm_b32 v80, v52, v48, s44
    s_waitcnt vmcnt(12)
    v_perm_b32 v81, v60, v56, s44
    s_waitcnt vmcnt(10)
    v_perm_b32 v82, v68, v64, s44
    s_waitcnt vmcnt(8)
    v_perm_b32 v83, v76, v72, s44
    ds_write_b128 v13, v[80:83] offset:0
    v_perm_b32 v84, v52, v48, s45
    v_perm_b32 v85, v60, v56, s45
    v_perm_b32 v86, v68, v64, s45
    v_perm_b32 v87, v76, v72, s45
    ds_write_b128 v13, v[84:87] offset:1024
    v_perm_b32 v80, v53, v49, s44
    v_perm_b32 v81, v61, v57, s44
    v_perm_b32 v82, v69, v65, s44
    v_perm_b32 v83, v77, v73, s44
    ds_write_b128 v13, v[80:83] offset:8192
    v_perm_b32 v84, v53, v49, s45
    v_perm_b32 v85, v61, v57, s45
    v_perm_b32 v86, v69, v65, s45
    v_perm_b32 v87, v77, v73, s45
    ds_write_b128 v13, v[84:87] offset:9216
    v_perm_b32 v80, v54, v50, s44
    v_perm_b32 v81, v62, v58, s44
    v_perm_b32 v82, v70, v66, s44
    v_perm_b32 v83, v78, v74, s44
    ds_write_b128 v13, v[80:83] offset:16384
    v_perm_b32 v84, v54, v50, s45
    v_perm_b32 v85, v62, v58, s45
    v_perm_b32 v86, v70, v66, s45
    v_perm_b32 v87, v78, v74, s45
    ds_write_b128 v13, v[84:87] offset:17408
    v_perm_b32 v80, v55, v51, s44
    v_perm_b32 v81, v63, v59, s44
    v_perm_b32 v82, v71, v67, s44
    v_perm_b32 v83, v79, v75, s44
    ds_write_b128 v13, v[80:83] offset:24576
    v_perm_b32 v84, v55, v51, s45
    v_perm_b32 v85, v63, v59, s45
    v_perm_b32 v86, v71, v67, s45
    v_perm_b32 v87, v79, v75, s45
    ds_write_b128 v13, v[84:87] offset:25600
    s_add_u32 s26, s21, 0
    s_lshl_b32 s27, s26, 18
    s_add_u32 s27, s27, s46
    buffer_load_dwordx4 v[48:51], v12, s[80:83], s27 offen
    s_add_u32 s27, s27, 8192
    buffer_load_dwordx4 v[52:55], v12, s[80:83], s27 offen
    s_add_u32 s27, s27, 8192
    buffer_load_dwordx4 v[56:59], v12, s[80:83], s27 offen
    s_add_u32 s27, s27, 8192
    buffer_load_dwordx4 v[60:63], v12, s[80:83], s27 offen
    s_add_u32 s27, s27, 8192
    buffer_load_dwordx4 v[64:67], v12, s[80:83], s27 offen
    s_add_u32 s27, s27, 8192
    buffer_load_dwordx4 v[68:71], v12, s[80:83], s27 offen
    s_add_u32 s27, s27, 8192
    buffer_load_dwordx4 v[72:75], v12, s[80:83], s27 offen
    s_add_u32 s27, s27, 8192
    buffer_load_dwordx4 v[76:79], v12, s[80:83], s27 offen
    s_waitcnt lgkmcnt(0)
    s_barrier
    ds_read_b128 a[48:51], v5 offset:0
    ds_read_b128 a[128:131], v5 offset:1024
    ds_read_b128 a[52:55], v5 offset:2048
    ds_read_b128 a[132:135], v5 offset:3072
    ds_read_b128 a[56:59], v5 offset:4096
    ds_read_b128 a[136:139], v5 offset:5120
    ds_read_b128 a[60:63], v5 offset:6144
    ds_read_b128 a[140:143], v5 offset:7168
    s_lshl_b32 s27, s21, 11
    s_add_u32 s27, s27, 0
    v_add_u32 v13, s27, v0
    s_waitcnt vmcnt(14)
    v_perm_b32 v80, v20, v16, s44
    s_waitcnt vmcnt(12)
    v_perm_b32 v81, v28, v24, s44
    s_waitcnt vmcnt(10)
    v_perm_b32 v82, v36, v32, s44
    s_waitcnt vmcnt(8)
    v_perm_b32 v83, v44, v40, s44
    ds_write_b128 v13, v[80:83] offset:0
    v_perm_b32 v84, v20, v16, s45
    v_perm_b32 v85, v28, v24, s45
    v_perm_b32 v86, v36, v32, s45
    v_perm_b32 v87, v44, v40, s45
    ds_write_b128 v13, v[84:87] offset:1024
    v_perm_b32 v80, v21, v17, s44
    v_perm_b32 v81, v29, v25, s44
    v_perm_b32 v82, v37, v33, s44
    v_perm_b32 v83, v45, v41, s44
    ds_write_b128 v13, v[80:83] offset:8192
    v_perm_b32 v84, v21, v17, s45
    v_perm_b32 v85, v29, v25, s45
    v_perm_b32 v86, v37, v33, s45
    v_perm_b32 v87, v45, v41, s45
    ds_write_b128 v13, v[84:87] offset:9216
    v_perm_b32 v80, v22, v18, s44
    v_perm_b32 v81, v30, v26, s44
    v_perm_b32 v82, v38, v34, s44
    v_perm_b32 v83, v46, v42, s44
    ds_write_b128 v13, v[80:83] offset:16384
    v_perm_b32 v84, v22, v18, s45
    v_perm_b32 v85, v30, v26, s45
    v_perm_b32 v86, v38, v34, s45
    v_perm_b32 v87, v46, v42, s45
    ds_write_b128 v13, v[84:87] offset:17408
    v_perm_b32 v80, v23, v19, s44
    v_perm_b32 v81, v31, v27, s44
    v_perm_b32 v82, v39, v35, s44
    v_perm_b32 v83, v47, v43, s44
    ds_write_b128 v13, v[80:83] offset:24576
    v_perm_b32 v84, v23, v19, s45
    v_perm_b32 v85, v31, v27, s45
    v_perm_b32 v86, v39, v35, s45
    v_perm_b32 v87, v47, v43, s45
    ds_write_b128 v13, v[84:87] offset:25600
    s_add_u32 s26, s21, 4
    s_lshl_b32 s27, s26, 18
    s_add_u32 s27, s27, s46
    buffer_load_dwordx4 v[16:19], v12, s[80:83], s27 offen
    s_add_u32 s27, s27, 8192
    buffer_load_dwordx4 v[20:23], v12, s[80:83], s27 offen
    s_add_u32 s27, s27, 8192
    buffer_load_dwordx4 v[24:27], v12, s[80:83], s27 offen
    s_add_u32 s27, s27, 8192
    buffer_load_dwordx4 v[28:31], v12, s[80:83], s27 offen
    s_add_u32 s27, s27, 8192
    buffer_load_dwordx4 v[32:35], v12, s[80:83], s27 offen
    s_add_u32 s27, s27, 8192
    buffer_load_dwordx4 v[36:39], v12, s[80:83], s27 offen
    s_add_u32 s27, s27, 8192
    buffer_load_dwordx4 v[40:43], v12, s[80:83], s27 offen
    s_add_u32 s27, s27, 8192
    buffer_load_dwordx4 v[44:47], v12, s[80:83], s27 offen
    s_waitcnt lgkmcnt(0)
    s_barrier
    ds_read_b128 a[64:67], v4 offset:0
    ds_read_b128 a[144:147], v4 offset:1024
    ds_read_b128 a[68:71], v4 offset:2048
    ds_read_b128 a[148:151], v4 offset:3072
    ds_read_b128 a[72:75], v4 offset:4096
    ds_read_b128 a[152:155], v4 offset:5120
    ds_read_b128 a[76:79], v4 offset:6144
    ds_read_b128 a[156:159], v4 offset:7168
    s_lshl_b32 s27, s21, 11
    s_add_u32 s27, s27, 32768
    v_add_u32 v13, s27, v0
    s_waitcnt vmcnt(14)
    v_perm_b32 v80, v52, v48, s44
    s_waitcnt vmcnt(12)
    v_perm_b32 v81, v60, v56, s44
    s_waitcnt vmcnt(10)
    v_perm_b32 v82, v68, v64, s44
    s_waitcnt vmcnt(8)
    v_perm_b32 v83, v76, v72, s44
    ds_write_b128 v13, v[80:83] offset:0
    v_perm_b32 v84, v52, v48, s45
    v_perm_b32 v85, v60, v56, s45
    v_perm_b32 v86, v68, v64, s45
    v_perm_b32 v87, v76, v72, s45
    ds_write_b128 v13, v[84:87] offset:1024
    v_perm_b32 v80, v53, v49, s44
    v_perm_b32 v81, v61, v57, s44
    v_perm_b32 v82, v69, v65, s44
    v_perm_b32 v83, v77, v73, s44
    ds_write_b128 v13, v[80:83] offset:8192
    v_perm_b32 v84, v53, v49, s45
    v_perm_b32 v85, v61, v57, s45
    v_perm_b32 v86, v69, v65, s45
    v_perm_b32 v87, v77, v73, s45
    ds_write_b128 v13, v[84:87] offset:9216
    v_perm_b32 v80, v54, v50, s44
    v_perm_b32 v81, v62, v58, s44
    v_perm_b32 v82, v70, v66, s44
    v_perm_b32 v83, v78, v74, s44
    ds_write_b128 v13, v[80:83] offset:16384
    v_perm_b32 v84, v54, v50, s45
    v_perm_b32 v85, v62, v58, s45
    v_perm_b32 v86, v70, v66, s45
    v_perm_b32 v87, v78, v74, s45
    ds_write_b128 v13, v[84:87] offset:17408
    v_perm_b32 v80, v55, v51, s44
    v_perm_b32 v81, v63, v59, s44
    v_perm_b32 v82, v71, v67, s44
    v_perm_b32 v83, v79, v75, s44
    ds_write_b128 v13, v[80:83] offset:24576
    v_perm_b32 v84, v55, v51, s45
    v_perm_b32 v85, v63, v59, s45
    v_perm_b32 v86, v71, v67, s45
    v_perm_b32 v87, v79, v75, s45
    ds_write_b128 v13, v[84:87] offset:25600
    s_add_u32 s26, s21, 8
    s_lshl_b32 s27, s26, 18
    s_add_u32 s27, s27, s46
    buffer_load_dwordx4 v[48:51], v12, s[80:83], s27 offen
    s_add_u32 s27, s27, 8192
    buffer_load_dwordx4 v[52:55], v12, s[80:83], s27 offen
    s_add_u32 s27, s27, 8192
    buffer_load_dwordx4 v[56:59], v12, s[80:83], s27 offen
    s_add_u32 s27, s27, 8192
    buffer_load_dwordx4 v[60:63], v12, s[80:83], s27 offen
    s_add_u32 s27, s27, 8192
    buffer_load_dwordx4 v[64:67], v12, s[80:83], s27 offen
    s_add_u32 s27, s27, 8192
    buffer_load_dwordx4 v[68:71], v12, s[80:83], s27 offen
    s_add_u32 s27, s27, 8192
    buffer_load_dwordx4 v[72:75], v12, s[80:83], s27 offen
    s_add_u32 s27, s27, 8192
    buffer_load_dwordx4 v[76:79], v12, s[80:83], s27 offen
    s_waitcnt lgkmcnt(0)
    s_barrier
    ds_read_b128 a[160:163], v5 offset:0
    ds_read_b128 a[240:243], v5 offset:1024
    ds_read_b128 a[164:167], v5 offset:2048
    ds_read_b128 a[244:247], v5 offset:3072
    ds_read_b128 a[168:171], v5 offset:4096
    ds_read_b128 a[248:251], v5 offset:5120
    ds_read_b128 a[172:175], v5 offset:6144
    ds_read_b128 a[252:255], v5 offset:7168
    s_lshl_b32 s27, s21, 11
    s_add_u32 s27, s27, 0
    v_add_u32 v13, s27, v0
    s_waitcnt vmcnt(14)
    v_perm_b32 v80, v20, v16, s44
    s_waitcnt vmcnt(12)
    v_perm_b32 v81, v28, v24, s44
    s_waitcnt vmcnt(10)
    v_perm_b32 v82, v36, v32, s44
    s_waitcnt vmcnt(8)
    v_perm_b32 v83, v44, v40, s44
    ds_write_b128 v13, v[80:83] offset:0
    v_perm_b32 v84, v20, v16, s45
    v_perm_b32 v85, v28, v24, s45
    v_perm_b32 v86, v36, v32, s45
    v_perm_b32 v87, v44, v40, s45
    ds_write_b128 v13, v[84:87] offset:1024
    v_perm_b32 v80, v21, v17, s44
    v_perm_b32 v81, v29, v25, s44
    v_perm_b32 v82, v37, v33, s44
    v_perm_b32 v83, v45, v41, s44
    ds_write_b128 v13, v[80:83] offset:8192
    v_perm_b32 v84, v21, v17, s45
    v_perm_b32 v85, v29, v25, s45
    v_perm_b32 v86, v37, v33, s45
    v_perm_b32 v87, v45, v41, s45
    ds_write_b128 v13, v[84:87] offset:9216
    v_perm_b32 v80, v22, v18, s44
    v_perm_b32 v81, v30, v26, s44
    v_perm_b32 v82, v38, v34, s44
    v_perm_b32 v83, v46, v42, s44
    ds_write_b128 v13, v[80:83] offset:16384
    v_perm_b32 v84, v22, v18, s45
    v_perm_b32 v85, v30, v26, s45
    v_perm_b32 v86, v38, v34, s45
    v_perm_b32 v87, v46, v42, s45
    ds_write_b128 v13, v[84:87] offset:17408
    v_perm_b32 v80, v23, v19, s44
    v_perm_b32 v81, v31, v27, s44
    v_perm_b32 v82, v39, v35, s44
    v_perm_b32 v83, v47, v43, s44
    ds_write_b128 v13, v[80:83] offset:24576
    v_perm_b32 v84, v23, v19, s45
    v_perm_b32 v85, v31, v27, s45
    v_perm_b32 v86, v39, v35, s45
    v_perm_b32 v87, v47, v43, s45
    ds_write_b128 v13, v[84:87] offset:25600
    s_add_u32 s26, s21, 12
    s_lshl_b32 s27, s26, 18
    s_add_u32 s27, s27, s46
    buffer_load_dwordx4 v[16:19], v12, s[80:83], s27 offen
    s_add_u32 s27, s27, 8192
    buffer_load_dwordx4 v[20:23], v12, s[80:83], s27 offen
    s_add_u32 s27, s27, 8192
    buffer_load_dwordx4 v[24:27], v12, s[80:83], s27 offen
    s_add_u32 s27, s27, 8192
    buffer_load_dwordx4 v[28:31], v12, s[80:83], s27 offen
    s_add_u32 s27, s27, 8192
    buffer_load_dwordx4 v[32:35], v12, s[80:83], s27 offen
    s_add_u32 s27, s27, 8192
    buffer_load_dwordx4 v[36:39], v12, s[80:83], s27 offen
    s_add_u32 s27, s27, 8192
    buffer_load_dwordx4 v[40:43], v12, s[80:83], s27 offen
    s_add_u32 s27, s27, 8192
    buffer_load_dwordx4 v[44:47], v12, s[80:83], s27 offen
    s_waitcnt lgkmcnt(0)
    s_barrier
    ds_read_b128 a[176:179], v4 offset:0
    ds_read_b128 v[192:195], v4 offset:1024
    ds_read_b128 a[180:183], v4 offset:2048
    ds_read_b128 v[196:199], v4 offset:3072
    ds_read_b128 a[184:187], v4 offset:4096
    ds_read_b128 v[200:203], v4 offset:5120
    ds_read_b128 a[188:191], v4 offset:6144
    ds_read_b128 v[204:207], v4 offset:7168
    s_lshl_b32 s27, s21, 11
    s_add_u32 s27, s27, 32768
    v_add_u32 v13, s27, v0
    s_waitcnt vmcnt(14)
    v_perm_b32 v80, v52, v48, s44
    s_waitcnt vmcnt(12)
    v_perm_b32 v81, v60, v56, s44
    s_waitcnt vmcnt(10)
    v_perm_b32 v82, v68, v64, s44
    s_waitcnt vmcnt(8)
    v_perm_b32 v83, v76, v72, s44
    ds_write_b128 v13, v[80:83] offset:0
    v_perm_b32 v84, v52, v48, s45
    v_perm_b32 v85, v60, v56, s45
    v_perm_b32 v86, v68, v64, s45
    v_perm_b32 v87, v76, v72, s45
    ds_write_b128 v13, v[84:87] offset:1024
    v_perm_b32 v80, v53, v49, s44
    v_perm_b32 v81, v61, v57, s44
    v_perm_b32 v82, v69, v65, s44
    v_perm_b32 v83, v77, v73, s44
    ds_write_b128 v13, v[80:83] offset:8192
    v_perm_b32 v84, v53, v49, s45
    v_perm_b32 v85, v61, v57, s45
    v_perm_b32 v86, v69, v65, s45
    v_perm_b32 v87, v77, v73, s45
    ds_write_b128 v13, v[84:87] offset:9216
    v_perm_b32 v80, v54, v50, s44
    v_perm_b32 v81, v62, v58, s44
    v_perm_b32 v82, v70, v66, s44
    v_perm_b32 v83, v78, v74, s44
    ds_write_b128 v13, v[80:83] offset:16384
    v_perm_b32 v84, v54, v50, s45
    v_perm_b32 v85, v62, v58, s45
    v_perm_b32 v86, v70, v66, s45
    v_perm_b32 v87, v78, v74, s45
    ds_write_b128 v13, v[84:87] offset:17408
    v_perm_b32 v80, v55, v51, s44
    v_perm_b32 v81, v63, v59, s44
    v_perm_b32 v82, v71, v67, s44
    v_perm_b32 v83, v79, v75, s44
    ds_write_b128 v13, v[80:83] offset:24576
    v_perm_b32 v84, v55, v51, s45
    v_perm_b32 v85, v63, v59, s45
    v_perm_b32 v86, v71, v67, s45
    v_perm_b32 v87, v79, v75, s45
    ds_write_b128 v13, v[84:87] offset:25600
    s_add_u32 s26, s21, 16
    s_lshl_b32 s27, s26, 18
    s_add_u32 s27, s27, s46
    buffer_load_dwordx4 v[48:51], v12, s[80:83], s27 offen
    s_add_u32 s27, s27, 8192
    buffer_load_dwordx4 v[52:55], v12, s[80:83], s27 offen
    s_add_u32 s27, s27, 8192
    buffer_load_dwordx4 v[56:59], v12, s[80:83], s27 offen
    s_add_u32 s27, s27, 8192
    buffer_load_dwordx4 v[60:63], v12, s[80:83], s27 offen
    s_add_u32 s27, s27, 8192
    buffer_load_dwordx4 v[64:67], v12, s[80:83], s27 offen
    s_add_u32 s27, s27, 8192
    buffer_load_dwordx4 v[68:71], v12, s[80:83], s27 offen
    s_add_u32 s27, s27, 8192
    buffer_load_dwordx4 v[72:75], v12, s[80:83], s27 offen
    s_add_u32 s27, s27, 8192
    buffer_load_dwordx4 v[76:79], v12, s[80:83], s27 offen
    s_waitcnt lgkmcnt(0)
    s_barrier
    ds_read_b128 a[192:195], v5 offset:0
    ds_read_b128 v[208:211], v5 offset:1024
    ds_read_b128 a[196:199], v5 offset:2048
    ds_read_b128 v[212:215], v5 offset:3072
    ds_read_b128 a[200:203], v5 offset:4096
    ds_read_b128 v[216:219], v5 offset:5120
    ds_read_b128 a[204:207], v5 offset:6144
    ds_read_b128 v[220:223], v5 offset:7168
    s_lshl_b32 s27, s21, 11
    s_add_u32 s27, s27, 0
    v_add_u32 v13, s27, v0
    s_waitcnt vmcnt(14)
    v_perm_b32 v80, v20, v16, s44
    s_waitcnt vmcnt(12)
    v_perm_b32 v81, v28, v24, s44
    s_waitcnt vmcnt(10)
    v_perm_b32 v82, v36, v32, s44
    s_waitcnt vmcnt(8)
    v_perm_b32 v83, v44, v40, s44
    ds_write_b128 v13, v[80:83] offset:0
    v_perm_b32 v84, v20, v16, s45
    v_perm_b32 v85, v28, v24, s45
    v_perm_b32 v86, v36, v32, s45
    v_perm_b32 v87, v44, v40, s45
    ds_write_b128 v13, v[84:87] offset:1024
    v_perm_b32 v80, v21, v17, s44
    v_perm_b32 v81, v29, v25, s44
    v_perm_b32 v82, v37, v33, s44
    v_perm_b32 v83, v45, v41, s44
    ds_write_b128 v13, v[80:83] offset:8192
    v_perm_b32 v84, v21, v17, s45
    v_perm_b32 v85, v29, v25, s45
    v_perm_b32 v86, v37, v33, s45
    v_perm_b32 v87, v45, v41, s45
    ds_write_b128 v13, v[84:87] offset:9216
    v_perm_b32 v80, v22, v18, s44
    v_perm_b32 v81, v30, v26, s44
    v_perm_b32 v82, v38, v34, s44
    v_perm_b32 v83, v46, v42, s44
    ds_write_b128 v13, v[80:83] offset:16384
    v_perm_b32 v84, v22, v18, s45
    v_perm_b32 v85, v30, v26, s45
    v_perm_b32 v86, v38, v34, s45
    v_perm_b32 v87, v46, v42, s45
    ds_write_b128 v13, v[84:87] offset:17408
    v_perm_b32 v80, v23, v19, s44
    v_perm_b32 v81, v31, v27, s44
    v_perm_b32 v82, v39, v35, s44
    v_perm_b32 v83, v47, v43, s44
    ds_write_b128 v13, v[80:83] offset:24576
    v_perm_b32 v84, v23, v19, s45
    v_perm_b32 v85, v31, v27, s45
    v_perm_b32 v86, v39, v35, s45
    v_perm_b32 v87, v47, v43, s45
    ds_write_b128 v13, v[84:87] offset:25600
    s_waitcnt lgkmcnt(0)
    s_barrier
    ds_read_b128 a[208:211], v4 offset:0
    ds_read_b128 v[224:227], v4 offset:1024
    ds_read_b128 a[212:215], v4 offset:2048
    ds_read_b128 v[228:231], v4 offset:3072
    ds_read_b128 a[216:219], v4 offset:4096
    ds_read_b128 v[232:235], v4 offset:5120
    ds_read_b128 a[220:223], v4 offset:6144
    ds_read_b128 v[236:239], v4 offset:7168
    s_lshl_b32 s27, s21, 11
    s_add_u32 s27, s27, 32768
    v_add_u32 v13, s27, v0
    s_waitcnt vmcnt(6)
    v_perm_b32 v80, v52, v48, s44
    s_waitcnt vmcnt(4)
    v_perm_b32 v81, v60, v56, s44
    s_waitcnt vmcnt(2)
    v_perm_b32 v82, v68, v64, s44
    s_waitcnt vmcnt(0)
    v_perm_b32 v83, v76, v72, s44
    ds_write_b128 v13, v[80:83] offset:0
    v_perm_b32 v84, v52, v48, s45
    v_perm_b32 v85, v60, v56, s45
    v_perm_b32 v86, v68, v64, s45
    v_perm_b32 v87, v76, v72, s45
    ds_write_b128 v13, v[84:87] offset:1024
    v_perm_b32 v80, v53, v49, s44
    v_perm_b32 v81, v61, v57, s44
    v_perm_b32 v82, v69, v65, s44
    v_perm_b32 v83, v77, v73, s44
    ds_write_b128 v13, v[80:83] offset:8192
    v_perm_b32 v84, v53, v49, s45
    v_perm_b32 v85, v61, v57, s45
    v_perm_b32 v86, v69, v65, s45
    v_perm_b32 v87, v77, v73, s45
    ds_write_b128 v13, v[84:87] offset:9216
    v_perm_b32 v80, v54, v50, s44
    v_perm_b32 v81, v62, v58, s44
    v_perm_b32 v82, v70, v66, s44
    v_perm_b32 v83, v78, v74, s44
    ds_write_b128 v13, v[80:83] offset:16384
    v_perm_b32 v84, v54, v50, s45
    v_perm_b32 v85, v62, v58, s45
    v_perm_b32 v86, v70, v66, s45
    v_perm_b32 v87, v78, v74, s45
    ds_write_b128 v13, v[84:87] offset:17408
    v_perm_b32 v80, v55, v51, s44
    v_perm_b32 v81, v63, v59, s44
    v_perm_b32 v82, v71, v67, s44
    v_perm_b32 v83, v79, v75, s44
    ds_write_b128 v13, v[80:83] offset:24576
    v_perm_b32 v84, v55, v51, s45
    v_perm_b32 v85, v63, v59, s45
    v_perm_b32 v86, v71, v67, s45
    v_perm_b32 v87, v79, v75, s45
    ds_write_b128 v13, v[84:87] offset:25600
    s_waitcnt lgkmcnt(0)
    s_barrier
    ds_read_b128 a[224:227], v5 offset:0
    ds_read_b128 v[240:243], v5 offset:1024
    ds_read_b128 a[228:231], v5 offset:2048
    ds_read_b128 v[244:247], v5 offset:3072
    ds_read_b128 a[232:235], v5 offset:4096
    ds_read_b128 v[248:251], v5 offset:5120
    ds_read_b128 a[236:239], v5 offset:6144
    ds_read_b128 v[252:255], v5 offset:7168
    s_waitcnt lgkmcnt(0)
    s_branch M_lw_done
M_lw_chain:
    v_lshrrev_b32 v12, 8, v0
    v_lshlrev_b32 v12, 16, v12
    v_and_b32 v14, 0xf0, v0
    v_add_u32 v12, v12, v14
    s_lshl_b32 s46, s22, 8
    s_lshl_b32 s27, s21, 13
    s_add_u32 s28, s27, 106496
    v_add_u32 v4, s28, v0
    s_add_u32 s28, s27, 24576
    v_add_u32 v5, s28, v0
    s_lshl_b32 s27, s21, 12
    v_add_u32 v6, s27, v0
    s_mul_i32 s27, s21, 20480
    s_add_u32 s27, s27, 24576
    v_add_u32 v7, s27, v0
    s_mul_i32 s48, s20, 10
    s_and_b32 s27, s21, 1
    s_add_u32 s49, s27, 10
    s_sub_u32 s49, s49, s48
    s_add_u32 s48, s48, s27
    v_lshrrev_b32 v8, 9, v0
    v_lshlrev_b32 v8, 4, v8
    v_bfe_u32 v14, v0, 8, 1
    v_add_u32 v8, v8, v14
    v_mul_u32_u24 v8, 2560, v8
    s_and_b32 s47, s21, 1
    s_lshl_b32 s47, s47, 6
    s_lshr_b32 s27, s21, 1
    s_lshl_b32 s27, s27, 2
    s_add_u32 s47, s47, s27
    s_lshl_b32 s27, s22, 7
    s_add_u32 s47, s47, s27
    s_mul_i32 s47, s47, 1280
    s_mul_i32 s27, s20, 640
    s_add_u32 s47, s47, s27
    v_and_b32 v14, 0xf0, v0
    v_add_u32 v8, v8, v14
    s_mov_b32 s90, 5242880
    s_mov_b32 s91, 0x00020000
    s_mov_b32 s44, 0x05040100
    s_mov_b32 s45, 0x07060302
    s_add_u32 s27, s47, 0
    buffer_load_dwordx4 v[16:19], v8, s[84:87], s27 offen
    s_add_u32 s27, s47, 10240
    buffer_load_dwordx4 v[20:23], v8, s[84:87], s27 offen
    s_add_u32 s27, s47, 1280
    buffer_load_dwordx4 v[24:27], v8, s[84:87], s27 offen
    s_add_u32 s27, s47, 11520
    buffer_load_dwordx4 v[28:31], v8, s[84:87], s27 offen
    s_add_u32 s27, s47, 20480
    buffer_load_dwordx4 v[32:35], v8, s[84:87], s27 offen
    s_add_u32 s27, s47, 30720
    buffer_load_dwordx4 v[36:39], v8, s[84:87], s27 offen
    s_add_u32 s27, s47, 21760
    buffer_load_dwordx4 v[40:43], v8, s[84:87], s27 offen
    s_add_u32 s27, s47, 32000
    buffer_load_dwordx4 v[44:47], v8, s[84:87], s27 offen
    s_add_u32 s27, s47, 256
    buffer_load_dwordx4 v[48:51], v8, s[84:87], s27 offen
    s_add_u32 s27, s47, 10496
    buffer_load_dwordx4 v[52:55], v8, s[84:87], s27 offen
    s_add_u32 s27, s47, 1536
    buffer_load_dwordx4 v[56:59], v8, s[84:87], s27 offen
    s_add_u32 s27, s47, 11776
    buffer_load_dwordx4 v[60:63], v8, s[84:87], s27 offen
    s_add_u32 s27, s47, 20736
    buffer_load_dwordx4 v[64:67], v8, s[84:87], s27 offen
    s_add_u32 s27, s47, 30976
    buffer_load_dwordx4 v[68:71], v8, s[84:87], s27 offen
    s_add_u32 s27, s47, 22016
    buffer_load_dwordx4 v[72:75], v8, s[84:87], s27 offen
    s_add_u32 s27, s47, 32256
    buffer_load_dwordx4 v[76:79], v8, s[84:87], s27 offen
    v_and_b32 v13, 0x300, v0
    s_lshl_b32 s27, s21, 10
    s_add_u32 s27, s27, 24576
    v_add_u32 v13, s27, v13
    v_bfe_u32 v14, v0, 7, 1
    v_mul_u32_u24 v14, 20480, v14
    v_add_u32 v13, v13, v14
    v_bfe_u32 v14, v0, 5, 2
    v_lshl_add_u32 v13, v14, 6, v13
    v_and_b32 v14, 16, v0
    v_add_u32 v13, v13, v14
    s_waitcnt vmcnt(14)
    v_perm_b32 v80, v20, v16, s44
    s_waitcnt vmcnt(12)
    v_perm_b32 v81, v28, v24, s44
    s_waitcnt vmcnt(10)
    v_perm_b32 v82, v36, v32, s44
    s_waitcnt vmcnt(8)
    v_perm_b32 v83, v44, v40, s44
    ds_write_b128 v13, v[80:83] offset:0
    v_perm_b32 v84, v20, v16, s45
    v_perm_b32 v85, v28, v24, s45
    v_perm_b32 v86, v36, v32, s45
    v_perm_b32 v87, v44, v40, s45
    ds_write_b128 v13, v[84:87] offset:4096
    v_perm_b32 v80, v21, v17, s44
    v_perm_b32 v81, v29, v25, s44
    v_perm_b32 v82, v37, v33, s44
    v_perm_b32 v83, v45, v41, s44
    ds_write_b128 v13, v[80:83] offset:32
    v_perm_b32 v84, v21, v17, s45
    v_perm_b32 v85, v29, v25, s45
    v_perm_b32 v86, v37, v33, s45
    v_perm_b32 v87, v45, v41, s45
    ds_write_b128 v13, v[84:87] offset:4128
    v_perm_b32 v80, v22, v18, s44
    v_perm_b32 v81, v30, v26, s44
    v_perm_b32 v82, v38, v34, s44
    v_perm_b32 v83, v46, v42, s44
    ds_write_b128 v13, v[80:83] offset:8192
    v_perm_b32 v84, v22, v18, s45
    v_perm_b32 v85, v30, v26, s45
    v_perm_b32 v86, v38, v34, s45
    v_perm_b32 v87, v46, v42, s45
    ds_write_b128 v13, v[84:87] offset:12288
    v_perm_b32 v80, v23, v19, s44
    v_perm_b32 v81, v31, v27, s44
    v_perm_b32 v82, v39, v35, s44
    v_perm_b32 v83, v47, v43, s44
    ds_write_b128 v13, v[80:83] offset:8224
    v_perm_b32 v84, v23, v19, s45
    v_perm_b32 v85, v31, v27, s45
    v_perm_b32 v86, v39, v35, s45
    v_perm_b32 v87, v47, v43, s45
    ds_write_b128 v13, v[84:87] offset:12320
    s_mov_b32 exec_lo, 0x00ff00ff
    s_mov_b32 exec_hi, 0x00ff00ff
    s_add_u32 s27, s47, 512
    buffer_load_dwordx4 v[16:19], v8, s[84:87], s27 offen
    s_add_u32 s27, s47, 10752
    buffer_load_dwordx4 v[20:23], v8, s[84:87], s27 offen
    s_add_u32 s27, s47, 1792
    buffer_load_dwordx4 v[24:27], v8, s[84:87], s27 offen
    s_add_u32 s27, s47, 12032
    buffer_load_dwordx4 v[28:31], v8, s[84:87], s27 offen
    s_add_u32 s27, s47, 20992
    buffer_load_dwordx4 v[32:35], v8, s[84:87], s27 offen
    s_add_u32 s27, s47, 31232
    buffer_load_dwordx4 v[36:39], v8, s[84:87], s27 offen
    s_add_u32 s27, s47, 22272
    buffer_load_dwordx4 v[40:43], v8, s[84:87], s27 offen
    s_add_u32 s27, s47, 32512
    buffer_load_dwordx4 v[44:47], v8, s[84:87], s27 offen
    s_mov_b64 exec, -1
    v_and_b32 v13, 0x300, v0
    s_lshl_b32 s27, s21, 10
    s_add_u32 s27, s27, 65536
    v_add_u32 v13, s27, v13
    v_bfe_u32 v14, v0, 7, 1
    v_mul_u32_u24 v14, 20480, v14
    v_add_u32 v13, v13, v14
    v_bfe_u32 v14, v0, 5, 2
    v_lshl_add_u32 v13, v14, 6, v13
    v_and_b32 v14, 16, v0
    v_add_u32 v13, v13, v14
    s_waitcnt vmcnt(14)
    v_perm_b32 v80, v52, v48, s44
    s_waitcnt vmcnt(12)
    v_perm_b32 v81, v60, v56, s44
    s_waitcnt vmcnt(10)
    v_perm_b32 v82, v68, v64, s44
    s_waitcnt vmcnt(8)
    v_perm_b32 v83, v76, v72, s44
    ds_write_b128 v13, v[80:83] offset:0
    v_perm_b32 v84, v52, v48, s45
    v_perm_b32 v85, v60, v56, s45
    v_perm_b32 v86, v68, v64, s45
    v_perm_b32 v87, v76, v72, s45
    ds_write_b128 v13, v[84:87] offset:4096
    v_perm_b32 v80, v53, v49, s44
    v_perm_b32 v81, v61, v57, s44
    v_perm_b32 v82, v69, v65, s44
    v_perm_b32 v83, v77, v73, s44
    ds_write_b128 v13, v[80:83] offset:32
    v_perm_b32 v84, v53, v49, s45
    v_perm_b32 v85, v61, v57, s45
    v_perm_b32 v86, v69, v65, s45
    v_perm_b32 v87, v77, v73, s45
    ds_write_b128 v13, v[84:87] offset:4128
    v_perm_b32 v80, v54, v50, s44
    v_perm_b32 v81, v62, v58, s44
    v_perm_b32 v82, v70, v66, s44
    v_perm_b32 v83, v78, v74, s44
    ds_write_b128 v13, v[80:83] offset:8192
    v_perm_b32 v84, v54, v50, s45
    v_perm_b32 v85, v62, v58, s45
    v_perm_b32 v86, v70, v66, s45
    v_perm_b32 v87, v78, v74, s45
    ds_write_b128 v13, v[84:87] offset:12288
    v_perm_b32 v80, v55, v51, s44
    v_perm_b32 v81, v63, v59, s44
    v_perm_b32 v82, v71, v67, s44
    v_perm_b32 v83, v79, v75, s44
    ds_write_b128 v13, v[80:83] offset:8224
    v_perm_b32 v84, v55, v51, s45
    v_perm_b32 v85, v63, v59, s45
    v_perm_b32 v86, v71, v67, s45
    v_perm_b32 v87, v79, v75, s45
    ds_write_b128 v13, v[84:87] offset:12320
    s_cmp_lt_u32 s21, 2
    s_cselect_b32 s26, s48, s48
    s_cselect_b32 s27, 0, 2
    s_cselect_b64 s[88:89], s[76:77], s[76:77]
    s_add_u32 s26, s26, s27
    s_lshl_b32 s27, s26, 18
    s_add_u32 s27, s27, s46
    buffer_load_dwordx4 v[48:51], v12, s[88:91], s27 offen
    s_add_u32 s27, s27, 8192
    buffer_load_dwordx4 v[52:55], v12, s[88:91], s27 offen
    s_add_u32 s27, s27, 8192
    buffer_load_dwordx4 v[56:59], v12, s[88:91], s27 offen
    s_add_u32 s27, s27, 8192
    buffer_load_dwordx4 v[60:63], v12, s[88:91], s27 offen
    s_add_u32 s27, s27, 8192
    buffer_load_dwordx4 v[64:67], v12, s[88:91], s27 offen
    s_add_u32 s27, s27, 8192
    buffer_load_dwordx4 v[68:71], v12, s[88:91], s27 offen
    s_add_u32 s27, s27, 8192
    buffer_load_dwordx4 v[72:75], v12, s[88:91], s27 offen
    s_add_u32 s27, s27, 8192
    buffer_load_dwordx4 v[76:79], v12, s[88:91], s27 offen
    v_and_b32 v13, 0x300, v0
    s_lshl_b32 s27, s21, 10
    s_add_u32 s27, s27, 40960
    v_add_u32 v13, s27, v13
    v_bfe_u32 v14, v0, 5, 2
    v_mul_u32_u24 v14, 20480, v14
    v_add_u32 v13, v13, v14
    v_bfe_u32 v14, v0, 4, 1
    v_lshl_add_u32 v13, v14, 6, v13
    s_mov_b32 exec_lo, 0x00ff00ff
    s_mov_b32 exec_hi, 0x00ff00ff
    s_waitcnt vmcnt(14)
    v_perm_b32 v80, v20, v16, s44
    s_waitcnt vmcnt(12)
    v_perm_b32 v81, v28, v24, s44
    s_waitcnt vmcnt(10)
    v_perm_b32 v82, v36, v32, s44
    s_waitcnt vmcnt(8)
    v_perm_b32 v83, v44, v40, s44
    ds_write_b128 v13, v[80:83] offset:0
    v_perm_b32 v84, v20, v16, s45
    v_perm_b32 v85, v28, v24, s45
    v_perm_b32 v86, v36, v32, s45
    v_perm_b32 v87, v44, v40, s45
    ds_write_b128 v13, v[84:87] offset:16
    v_perm_b32 v80, v21, v17, s44
    v_perm_b32 v81, v29, v25, s44
    v_perm_b32 v82, v37, v33, s44
    v_perm_b32 v83, v45, v41, s44
    ds_write_b128 v13, v[80:83] offset:128
    v_perm_b32 v84, v21, v17, s45
    v_perm_b32 v85, v29, v25, s45
    v_perm_b32 v86, v37, v33, s45
    v_perm_b32 v87, v45, v41, s45
    ds_write_b128 v13, v[84:87] offset:144
    v_perm_b32 v80, v22, v18, s44
    v_perm_b32 v81, v30, v26, s44
    v_perm_b32 v82, v38, v34, s44
    v_perm_b32 v83, v46, v42, s44
    ds_write_b128 v13, v[80:83] offset:32
    v_perm_b32 v84, v22, v18, s45
    v_perm_b32 v85, v30, v26, s45
    v_perm_b32 v86, v38, v34, s45
    v_perm_b32 v87, v46, v42, s45
    ds_write_b128 v13, v[84:87] offset:48
    v_perm_b32 v80, v23, v19, s44
    v_perm_b32 v81, v31, v27, s44
    v_perm_b32 v82, v39, v35, s44
    v_perm_b32 v83, v47, v43, s44
    ds_write_b128 v13, v[80:83] offset:160
    v_perm_b32 v84, v23, v19, s45
    v_perm_b32 v85, v31, v27, s45
    v_perm_b32 v86, v39, v35, s45
    v_perm_b32 v87, v47, v43, s45
    ds_write_b128 v13, v[84:87] offset:176
    s_mov_b64 exec, -1
    s_cmp_lt_u32 s21, 2
    s_cselect_b32 s26, s48, s49
    s_cselect_b32 s27, 6, 4
    s_cselect_b64 s[88:89], s[76:77], s[72:73]
    s_add_u32 s26, s26, s27
    s_lshl_b32 s27, s26, 18
    s_add_u32 s27, s27, s46
    buffer_load_dwordx4 v[16:19], v12, s[88:91], s27 offen
    s_add_u32 s27, s27, 8192
    buffer_load_dwordx4 v[20:23], v12, s[88:91], s27 offen
    s_add_u32 s27, s27, 8192
    buffer_load_dwordx4 v[24:27], v12, s[88:91], s27 offen
    s_add_u32 s27, s27, 8192
    buffer_load_dwordx4 v[28:31], v12, s[88:91], s27 offen
    s_add_u32 s27, s27, 8192
    buffer_load_dwordx4 v[32:35], v12, s[88:91], s27 offen
    s_add_u32 s27, s27, 8192
    buffer_load_dwordx4 v[36:39], v12, s[88:91], s27 offen
    s_add_u32 s27, s27, 8192
    buffer_load_dwordx4 v[40:43], v12, s[88:91], s27 offen
    s_add_u32 s27, s27, 8192
    buffer_load_dwordx4 v[44:47], v12, s[88:91], s27 offen
    s_waitcnt lgkmcnt(0)
    s_barrier
    ds_read_b128 v[160:163], v7 offset:0
    ds_read_b128 v[164:167], v7 offset:1024
    ds_read_b128 v[152:155], v7 offset:2048
    ds_read_b128 v[156:159], v7 offset:3072
    ds_read_b128 v[144:147], v7 offset:4096
    ds_read_b128 v[148:151], v7 offset:5120
    ds_read_b128 v[136:139], v7 offset:6144
    ds_read_b128 v[140:143], v7 offset:7168
    ds_read_b128 v[128:131], v7 offset:8192
    ds_read_b128 v[132:135], v7 offset:9216
    ds_read_b128 v[120:123], v7 offset:10240
    ds_read_b128 v[124:127], v7 offset:11264
    ds_read_b128 v[112:115], v7 offset:12288
    ds_read_b128 v[116:119], v7 offset:13312
    ds_read_b128 v[104:107], v7 offset:14336
    ds_read_b128 v[108:111], v7 offset:15360
    ds_read_b128 v[96:99], v7 offset:16384
    ds_read_b128 v[100:103], v7 offset:17408
    ds_read_b128 v[88:91], v7 offset:18432
    ds_read_b128 v[92:95], v7 offset:19456
    s_lshl_b32 s27, s21, 11
    s_add_u32 s27, s27, 106496
    v_add_u32 v13, s27, v0
    s_waitcnt vmcnt(14)
    v_perm_b32 v80, v52, v48, s44
    s_waitcnt vmcnt(12)
    v_perm_b32 v81, v60, v56, s44
    s_waitcnt vmcnt(10)
    v_perm_b32 v82, v68, v64, s44
    s_waitcnt vmcnt(8)
    v_perm_b32 v83, v76, v72, s44
    ds_write_b128 v13, v[80:83] offset:0
    v_perm_b32 v84, v52, v48, s45
    v_perm_b32 v85, v60, v56, s45
    v_perm_b32 v86, v68, v64, s45
    v_perm_b32 v87, v76, v72, s45
    ds_write_b128 v13, v[84:87] offset:1024
    v_perm_b32 v80, v53, v49, s44
    v_perm_b32 v81, v61, v57, s44
    v_perm_b32 v82, v69, v65, s44
    v_perm_b32 v83, v77, v73, s44
    ds_write_b128 v13, v[80:83] offset:8192
    v_perm_b32 v84, v53, v49, s45
    v_perm_b32 v85, v61, v57, s45
    v_perm_b32 v86, v69, v65, s45
    v_perm_b32 v87, v77, v73, s45
    ds_write_b128 v13, v[84:87] offset:9216
    v_perm_b32 v80, v54, v50, s44
    v_perm_b32 v81, v62, v58, s44
    v_perm_b32 v82, v70, v66, s44
    v_perm_b32 v83, v78, v74, s44
    ds_write_b128 v13, v[80:83] offset:16384
    v_perm_b32 v84, v54, v50, s45
    v_perm_b32 v85, v62, v58, s45
    v_perm_b32 v86, v70, v66, s45
    v_perm_b32 v87, v78, v74, s45
    ds_write_b128 v13, v[84:87] offset:17408
    v_perm_b32 v80, v55, v51, s44
    v_perm_b32 v81, v63, v59, s44
    v_perm_b32 v82, v71, v67, s44
    v_perm_b32 v83, v79, v75, s44
    ds_write_b128 v13, v[80:83] offset:24576
    v_perm_b32 v84, v55, v51, s45
    v_perm_b32 v85, v63, v59, s45
    v_perm_b32 v86, v71, v67, s45
    v_perm_b32 v87, v79, v75, s45
    ds_write_b128 v13, v[84:87] offset:25600
    s_cmp_lt_u32 s21, 2
    s_cselect_b32 s26, s49, s49
    s_cselect_b32 s27, 4, 8
    s_cselect_b64 s[88:89], s[76:77], s[76:77]
    s_add_u32 s26, s26, s27
    s_lshl_b32 s27, s26, 18
    s_add_u32 s27, s27, s46
    buffer_load_dwordx4 v[48:51], v12, s[88:91], s27 offen
    s_add_u32 s27, s27, 8192
    buffer_load_dwordx4 v[52:55], v12, s[88:91], s27 offen
    s_add_u32 s27, s27, 8192
    buffer_load_dwordx4 v[56:59], v12, s[88:91], s27 offen
    s_add_u32 s27, s27, 8192
    buffer_load_dwordx4 v[60:63], v12, s[88:91], s27 offen
    s_add_u32 s27, s27, 8192
    buffer_load_dwordx4 v[64:67], v12, s[88:91], s27 offen
    s_add_u32 s27, s27, 8192
    buffer_load_dwordx4 v[68:71], v12, s[88:91], s27 offen
    s_add_u32 s27, s27, 8192
    buffer_load_dwordx4 v[72:75], v12, s[88:91], s27 offen
    s_add_u32 s27, s27, 8192
    buffer_load_dwordx4 v[76:79], v12, s[88:91], s27 offen
    s_waitcnt lgkmcnt(0)
    s_barrier
    ds_read_b128 a[248:251], v4 offset:0
    ds_read_b128 a[240:243], v4 offset:1024
    ds_read_b128 a[252:255], v4 offset:2048
    ds_read_b128 a[244:247], v4 offset:3072
    ds_read_b128 a[216:219], v4 offset:4096
    ds_read_b128 a[208:211], v4 offset:5120
    ds_read_b128 a[220:223], v4 offset:6144
    ds_read_b128 a[212:215], v4 offset:7168
    s_lshl_b32 s27, s21, 11
    s_add_u32 s27, s27, 24576
    v_add_u32 v13, s27, v0
    s_waitcnt vmcnt(14)
    v_perm_b32 v80, v20, v16, s44
    s_waitcnt vmcnt(12)
    v_perm_b32 v81, v28, v24, s44
    s_waitcnt vmcnt(10)
    v_perm_b32 v82, v36, v32, s44
    s_waitcnt vmcnt(8)
    v_perm_b32 v83, v44, v40, s44
    ds_write_b128 v13, v[80:83] offset:0
    v_perm_b32 v84, v20, v16, s45
    v_perm_b32 v85, v28, v24, s45
    v_perm_b32 v86, v36, v32, s45
    v_perm_b32 v87, v44, v40, s45
    ds_write_b128 v13, v[84:87] offset:1024
    v_perm_b32 v80, v21, v17, s44
    v_perm_b32 v81, v29, v25, s44
    v_perm_b32 v82, v37, v33, s44
    v_perm_b32 v83, v45, v41, s44
    ds_write_b128 v13, v[80:83] offset:8192
    v_perm_b32 v84, v21, v17, s45
    v_perm_b32 v85, v29, v25, s45
    v_perm_b32 v86, v37, v33, s45
    v_perm_b32 v87, v45, v41, s45
    ds_write_b128 v13, v[84:87] offset:9216
    v_perm_b32 v80, v22, v18, s44
    v_perm_b32 v81, v30, v26, s44
    v_perm_b32 v82, v38, v34, s44
    v_perm_b32 v83, v46, v42, s44
    ds_write_b128 v13, v[80:83] offset:16384
    v_perm_b32 v84, v22, v18, s45
    v_perm_b32 v85, v30, v26, s45
    v_perm_b32 v86, v38, v34, s45
    v_perm_b32 v87, v46, v42, s45
    ds_write_b128 v13, v[84:87] offset:17408
    v_perm_b32 v80, v23, v19, s44
    v_perm_b32 v81, v31, v27, s44
    v_perm_b32 v82, v39, v35, s44
    v_perm_b32 v83, v47, v43, s44
    ds_write_b128 v13, v[80:83] offset:24576
    v_perm_b32 v84, v23, v19, s45
    v_perm_b32 v85, v31, v27, s45
    v_perm_b32 v86, v39, v35, s45
    v_perm_b32 v87, v47, v43, s45
    ds_write_b128 v13, v[84:87] offset:25600
    s_cmp_lt_u32 s21, 2
    s_cselect_b32 s26, s49, s49
    s_cselect_b32 s27, 0, 2
    s_cselect_b64 s[88:89], s[80:81], s[80:81]
    s_add_u32 s26, s26, s27
    s_lshl_b32 s27, s26, 18
    s_add_u32 s27, s27, s46
    buffer_load_dwordx4 v[16:19], v12, s[88:91], s27 offen
    s_add_u32 s27, s27, 8192
    buffer_load_dwordx4 v[20:23], v12, s[88:91], s27 offen
    s_add_u32 s27, s27, 8192
    buffer_load_dwordx4 v[24:27], v12, s[88:91], s27 offen
    s_add_u32 s27, s27, 8192
    buffer_load_dwordx4 v[28:31], v12, s[88:91], s27 offen
    s_add_u32 s27, s27, 8192
    buffer_load_dwordx4 v[32:35], v12, s[88:91], s27 offen
    s_add_u32 s27, s27, 8192
    buffer_load_dwordx4 v[36:39], v12, s[88:91], s27 offen
    s_add_u32 s27, s27, 8192
    buffer_load_dwordx4 v[40:43], v12, s[88:91], s27 offen
    s_add_u32 s27, s27, 8192
    buffer_load_dwordx4 v[44:47], v12, s[88:91], s27 offen
    s_waitcnt lgkmcnt(0)
    s_barrier
    ds_read_b128 a[168:171], v5 offset:0
    ds_read_b128 a[160:163], v5 offset:1024
    ds_read_b128 a[172:175], v5 offset:2048
    ds_read_b128 a[164:167], v5 offset:3072
    ds_read_b128 a[120:123], v5 offset:4096
    ds_read_b128 a[112:115], v5 offset:5120
    ds_read_b128 a[124:127], v5 offset:6144
    ds_read_b128 a[116:119], v5 offset:7168
    s_lshl_b32 s27, s21, 11
    s_add_u32 s27, s27, 106496
    v_add_u32 v13, s27, v0
    s_waitcnt vmcnt(14)
    v_perm_b32 v80, v52, v48, s44
    s_waitcnt vmcnt(12)
    v_perm_b32 v81, v60, v56, s44
    s_waitcnt vmcnt(10)
    v_perm_b32 v82, v68, v64, s44
    s_waitcnt vmcnt(8)
    v_perm_b32 v83, v76, v72, s44
    ds_write_b128 v13, v[80:83] offset:0
    v_perm_b32 v84, v52, v48, s45
    v_perm_b32 v85, v60, v56, s45
    v_perm_b32 v86, v68, v64, s45
    v_perm_b32 v87, v76, v72, s45
    ds_write_b128 v13, v[84:87] offset:1024
    v_perm_b32 v80, v53, v49, s44
    v_perm_b32 v81, v61, v57, s44
    v_perm_b32 v82, v69, v65, s44
    v_perm_b32 v83, v77, v73, s44
    ds_write_b128 v13, v[80:83] offset:8192
    v_perm_b32 v84, v53, v49, s45
    v_perm_b32 v85, v61, v57, s45
    v_perm_b32 v86, v69, v65, s45
    v_perm_b32 v87, v77, v73, s45
    ds_write_b128 v13, v[84:87] offset:9216
    v_perm_b32 v80, v54, v50, s44
    v_perm_b32 v81, v62, v58, s44
    v_perm_b32 v82, v70, v66, s44
    v_perm_b32 v83, v78, v74, s44
    ds_write_b128 v13, v[80:83] offset:16384
    v_perm_b32 v84, v54, v50, s45
    v_perm_b32 v85, v62, v58, s45
    v_perm_b32 v86, v70, v66, s45
    v_perm_b32 v87, v78, v74, s45
    ds_write_b128 v13, v[84:87] offset:17408
    v_perm_b32 v80, v55, v51, s44
    v_perm_b32 v81, v63, v59, s44
    v_perm_b32 v82, v71, v67, s44
    v_perm_b32 v83, v79, v75, s44
    ds_write_b128 v13, v[80:83] offset:24576
    v_perm_b32 v84, v55, v51, s45
    v_perm_b32 v85, v63, v59, s45
    v_perm_b32 v86, v71, v67, s45
    v_perm_b32 v87, v79, v75, s45
    ds_write_b128 v13, v[84:87] offset:25600
    s_cmp_lt_u32 s21, 2
    s_cselect_b32 s26, s49, s49
    s_cselect_b32 s27, 4, 6
    s_cselect_b64 s[88:89], s[80:81], s[80:81]
    s_add_u32 s26, s26, s27
    s_lshl_b32 s27, s26, 18
    s_add_u32 s27, s27, s46
    buffer_load_dwordx4 v[48:51], v12, s[88:91], s27 offen
    s_add_u32 s27, s27, 8192
    buffer_load_dwordx4 v[52:55], v12, s[88:91], s27 offen
    s_add_u32 s27, s27, 8192
    buffer_load_dwordx4 v[56:59], v12, s[88:91], s27 offen
    s_add_u32 s27, s27, 8192
    buffer_load_dwordx4 v[60:63], v12, s[88:91], s27 offen
    s_add_u32 s27, s27, 8192
    buffer_load_dwordx4 v[64:67], v12, s[88:91], s27 offen
    s_add_u32 s27, s27, 8192
    buffer_load_dwordx4 v[68:71], v12, s[88:91], s27 offen
    s_add_u32 s27, s27, 8192
    buffer_load_dwordx4 v[72:75], v12, s[88:91], s27 offen
    s_add_u32 s27, s27, 8192
    buffer_load_dwordx4 v[76:79], v12, s[88:91], s27 offen
    s_waitcnt lgkmcnt(0)
    s_barrier
    ds_read_b128 a[72:75], v4 offset:0
    ds_read_b128 a[64:67], v4 offset:1024
    ds_read_b128 a[76:79], v4 offset:2048
    ds_read_b128 a[68:71], v4 offset:3072
    ds_read_b128 a[48:51], v4 offset:4096
    ds_read_b128 a[40:43], v4 offset:5120
    ds_read_b128 a[52:55], v4 offset:6144
    ds_read_b128 a[44:47], v4 offset:7168
    s_lshl_b32 s27, s21, 11
    s_add_u32 s27, s27, 24576
    v_add_u32 v13, s27, v0
    s_waitcnt vmcnt(14)
    v_perm_b32 v80, v20, v16, s44
    s_waitcnt vmcnt(12)
    v_perm_b32 v81, v28, v24, s44
    s_waitcnt vmcnt(10)
    v_perm_b32 v82, v36, v32, s44
    s_waitcnt vmcnt(8)
    v_perm_b32 v83, v44, v40, s44
    ds_write_b128 v13, v[80:83] offset:0
    v_perm_b32 v84, v20, v16, s45
    v_perm_b32 v85, v28, v24, s45
    v_perm_b32 v86, v36, v32, s45
    v_perm_b32 v87, v44, v40, s45
    ds_write_b128 v13, v[84:87] offset:1024
    v_perm_b32 v80, v21, v17, s44
    v_perm_b32 v81, v29, v25, s44
    v_perm_b32 v82, v37, v33, s44
    v_perm_b32 v83, v45, v41, s44
    ds_write_b128 v13, v[80:83] offset:8192
    v_perm_b32 v84, v21, v17, s45
    v_perm_b32 v85, v29, v25, s45
    v_perm_b32 v86, v37, v33, s45
    v_perm_b32 v87, v45, v41, s45
    ds_write_b128 v13, v[84:87] offset:9216
    v_perm_b32 v80, v22, v18, s44
    v_perm_b32 v81, v30, v26, s44
    v_perm_b32 v82, v38, v34, s44
    v_perm_b32 v83, v46, v42, s44
    ds_write_b128 v13, v[80:83] offset:16384
    v_perm_b32 v84, v22, v18, s45
    v_perm_b32 v85, v30, v26, s45
    v_perm_b32 v86, v38, v34, s45
    v_perm_b32 v87, v46, v42, s45
    ds_write_b128 v13, v[84:87] offset:17408
    v_perm_b32 v80, v23, v19, s44
    v_perm_b32 v81, v31, v27, s44
    v_perm_b32 v82, v39, v35, s44
    v_perm_b32 v83, v47, v43, s44
    ds_write_b128 v13, v[80:83] offset:24576
    v_perm_b32 v84, v23, v19, s45
    v_perm_b32 v85, v31, v27, s45
    v_perm_b32 v86, v39, v35, s45
    v_perm_b32 v87, v47, v43, s45
    ds_write_b128 v13, v[84:87] offset:25600
    s_cmp_lt_u32 s21, 2
    s_cselect_b32 s26, s49, s48
    s_cselect_b32 s27, 8, 4
    s_cselect_b64 s[88:89], s[80:81], s[80:81]
    s_add_u32 s26, s26, s27
    s_lshl_b32 s27, s26, 18
    s_add_u32 s27, s27, s46
    buffer_load_dwordx4 v[16:19], v12, s[88:91], s27 offen
    s_add_u32 s27, s27, 8192
    buffer_load_dwordx4 v[20:23], v12, s[88:91], s27 offen
    s_add_u32 s27, s27, 8192
    buffer_load_dwordx4 v[24:27], v12, s[88:91], s27 offen
    s_add_u32 s27, s27, 8192
    buffer_load_dwordx4 v[28:31], v12, s[88:91], s27 offen
    s_add_u32 s27, s27, 8192
    buffer_load_dwordx4 v[32:35], v12, s[88:91], s27 offen
    s_add_u32 s27, s27, 8192
    buffer_load_dwordx4 v[36:39], v12, s[88:91], s27 offen
    s_add_u32 s27, s27, 8192
    buffer_load_dwordx4 v[40:43], v12, s[88:91], s27 offen
    s_add_u32 s27, s27, 8192
    buffer_load_dwordx4 v[44:47], v12, s[88:91], s27 offen
    s_waitcnt lgkmcnt(0)
    s_barrier
    ds_read_b128 a[32:35], v5 offset:0
    ds_read_b128 a[24:27], v5 offset:1024
    ds_read_b128 a[36:39], v5 offset:2048
    ds_read_b128 a[28:31], v5 offset:3072
    ds_read_b128 a[16:19], v5 offset:4096
    ds_read_b128 a[8:11], v5 offset:5120
    ds_read_b128 a[20:23], v5 offset:6144
    ds_read_b128 a[12:15], v5 offset:7168
    s_lshl_b32 s27, s21, 11
    s_add_u32 s27, s27, 106496
    v_add_u32 v13, s27, v0
    s_waitcnt vmcnt(14)
    v_perm_b32 v80, v52, v48, s44
    s_waitcnt vmcnt(12)
    v_perm_b32 v81, v60, v56, s44
    s_waitcnt vmcnt(10)
    v_perm_b32 v82, v68, v64, s44
    s_waitcnt vmcnt(8)
    v_perm_b32 v83, v76, v72, s44
    ds_write_b128 v13, v[80:83] offset:0
    v_perm_b32 v84, v52, v48, s45
    v_perm_b32 v85, v60, v56, s45
    v_perm_b32 v86, v68, v64, s45
    v_perm_b32 v87, v76, v72, s45
    ds_write_b128 v13, v[84:87] offset:1024
    v_perm_b32 v80, v53, v49, s44
    v_perm_b32 v81, v61, v57, s44
    v_perm_b32 v82, v69, v65, s44
    v_perm_b32 v83, v77, v73, s44
    ds_write_b128 v13, v[80:83] offset:8192
    v_perm_b32 v84, v53, v49, s45
    v_perm_b32 v85, v61, v57, s45
    v_perm_b32 v86, v69, v65, s45
    v_perm_b32 v87, v77, v73, s45
    ds_write_b128 v13, v[84:87] offset:9216
    v_perm_b32 v80, v54, v50, s44
    v_perm_b32 v81, v62, v58, s44
    v_perm_b32 v82, v70, v66, s44
    v_perm_b32 v83, v78, v74, s44
    ds_write_b128 v13, v[80:83] offset:16384
    v_perm_b32 v84, v54, v50, s45
    v_perm_b32 v85, v62, v58, s45
    v_perm_b32 v86, v70, v66, s45
    v_perm_b32 v87, v78, v74, s45
    ds_write_b128 v13, v[84:87] offset:17408
    v_perm_b32 v80, v55, v51, s44
    v_perm_b32 v81, v63, v59, s44
    v_perm_b32 v82, v71, v67, s44
    v_perm_b32 v83, v79, v75, s44
    ds_write_b128 v13, v[80:83] offset:24576
    v_perm_b32 v84, v55, v51, s45
    v_perm_b32 v85, v63, v59, s45
    v_perm_b32 v86, v71, v67, s45
    v_perm_b32 v87, v79, v75, s45
    ds_write_b128 v13, v[84:87] offset:25600
    s_cmp_lt_u32 s21, 2
    s_cselect_b32 s26, s48, s48
    s_cselect_b32 s27, 6, 8
    s_cselect_b64 s[88:89], s[80:81], s[80:81]
    s_add_u32 s26, s26, s27
    s_lshl_b32 s27, s26, 18
    s_add_u32 s27, s27, s46
    buffer_load_dwordx4 v[48:51], v12, s[88:91], s27 offen
    s_add_u32 s27, s27, 8192
    buffer_load_dwordx4 v[52:55], v12, s[88:91], s27 offen
    s_add_u32 s27, s27, 8192
    buffer_load_dwordx4 v[56:59], v12, s[88:91], s27 offen
    s_add_u32 s27, s27, 8192
    buffer_load_dwordx4 v[60:63], v12, s[88:91], s27 offen
    s_add_u32 s27, s27, 8192
    buffer_load_dwordx4 v[64:67], v12, s[88:91], s27 offen
    s_add_u32 s27, s27, 8192
    buffer_load_dwordx4 v[68:71], v12, s[88:91], s27 offen
    s_add_u32 s27, s27, 8192
    buffer_load_dwordx4 v[72:75], v12, s[88:91], s27 offen
    s_add_u32 s27, s27, 8192
    buffer_load_dwordx4 v[76:79], v12, s[88:91], s27 offen
    s_waitcnt lgkmcnt(0)
    s_barrier
    ds_read_b128 a[0:3], v4 offset:0
    ds_read_b128 v[248:251], v4 offset:1024
    ds_read_b128 a[4:7], v4 offset:2048
    ds_read_b128 v[252:255], v4 offset:3072
    ds_read_b128 v[240:243], v4 offset:4096
    ds_read_b128 v[232:235], v4 offset:5120
    ds_read_b128 v[244:247], v4 offset:6144
    ds_read_b128 v[236:239], v4 offset:7168
    s_lshl_b32 s27, s21, 11
    s_add_u32 s27, s27, 24576
    v_add_u32 v13, s27, v0
    s_waitcnt vmcnt(14)
    v_perm_b32 v80, v20, v16, s44
    s_waitcnt vmcnt(12)
    v_perm_b32 v81, v28, v24, s44
    s_waitcnt vmcnt(10)
    v_perm_b32 v82, v36, v32, s44
    s_waitcnt vmcnt(8)
    v_perm_b32 v83, v44, v40, s44
    ds_write_b128 v13, v[80:83] offset:0
    v_perm_b32 v84, v20, v16, s45
    v_perm_b32 v85, v28, v24, s45
    v_perm_b32 v86, v36, v32, s45
    v_perm_b32 v87, v44, v40, s45
    ds_write_b128 v13, v[84:87] offset:1024
    v_perm_b32 v80, v21, v17, s44
    v_perm_b32 v81, v29, v25, s44
    v_perm_b32 v82, v37, v33, s44
    v_perm_b32 v83, v45, v41, s44
    ds_write_b128 v13, v[80:83] offset:8192
    v_perm_b32 v84, v21, v17, s45
    v_perm_b32 v85, v29, v25, s45
    v_perm_b32 v86, v37, v33, s45
    v_perm_b32 v87, v45, v41, s45
    ds_write_b128 v13, v[84:87] offset:9216
    v_perm_b32 v80, v22, v18, s44
    v_perm_b32 v81, v30, v26, s44
    v_perm_b32 v82, v38, v34, s44
    v_perm_b32 v83, v46, v42, s44
    ds_write_b128 v13, v[80:83] offset:16384
    v_perm_b32 v84, v22, v18, s45
    v_perm_b32 v85, v30, v26, s45
    v_perm_b32 v86, v38, v34, s45
    v_perm_b32 v87, v46, v42, s45
    ds_write_b128 v13, v[84:87] offset:17408
    v_perm_b32 v80, v23, v19, s44
    v_perm_b32 v81, v31, v27, s44
    v_perm_b32 v82, v39, v35, s44
    v_perm_b32 v83, v47, v43, s44
    ds_write_b128 v13, v[80:83] offset:24576
    v_perm_b32 v84, v23, v19, s45
    v_perm_b32 v85, v31, v27, s45
    v_perm_b32 v86, v39, v35, s45
    v_perm_b32 v87, v47, v43, s45
    ds_write_b128 v13, v[84:87] offset:25600
    s_cmp_lt_u32 s21, 2
    s_cselect_b32 s26, s48, s48
    s_cselect_b32 s27, 0, 0
    s_cselect_b64 s[88:89], s[72:73], s[80:81]
    s_add_u32 s26, s26, s27
    s_lshl_b32 s27, s26, 18
    s_add_u32 s27, s27, s46
    buffer_load_dwordx4 v[16:19], v12, s[88:91], s27 offen
    s_add_u32 s27, s27, 8192
    buffer_load_dwordx4 v[20:23], v12, s[88:91], s27 offen
    s_add_u32 s27, s27, 8192
    buffer_load_dwordx4 v[24:27], v12, s[88:91], s27 offen
    s_add_u32 s27, s27, 8192
    buffer_load_dwordx4 v[28:31], v12, s[88:91], s27 offen
    s_add_u32 s27, s27, 8192
    buffer_load_dwordx4 v[32:35], v12, s[88:91], s27 offen
    s_add_u32 s27, s27, 8192
    buffer_load_dwordx4 v[36:39], v12, s[88:91], s27 offen
    s_add_u32 s27, s27, 8192
    buffer_load_dwordx4 v[40:43], v12, s[88:91], s27 offen
    s_add_u32 s27, s27, 8192
    buffer_load_dwordx4 v[44:47], v12, s[88:91], s27 offen
    s_waitcnt lgkmcnt(0)
    s_barrier
    ds_read_b128 v[224:227], v5 offset:0
    ds_read_b128 v[216:219], v5 offset:1024
    ds_read_b128 v[228:231], v5 offset:2048
    ds_read_b128 v[220:223], v5 offset:3072
    ds_read_b128 v[208:211], v5 offset:4096
    ds_read_b128 v[200:203], v5 offset:5120
    ds_read_b128 v[212:215], v5 offset:6144
    ds_read_b128 v[204:207], v5 offset:7168
    s_lshl_b32 s27, s21, 11
    s_add_u32 s27, s27, 106496
    v_add_u32 v13, s27, v0
    s_waitcnt vmcnt(14)
    v_perm_b32 v80, v52, v48, s44
    s_waitcnt vmcnt(12)
    v_perm_b32 v81, v60, v56, s44
    s_waitcnt vmcnt(10)
    v_perm_b32 v82, v68, v64, s44
    s_waitcnt vmcnt(8)
    v_perm_b32 v83, v76, v72, s44
    ds_write_b128 v13, v[80:83] offset:0
    v_perm_b32 v84, v52, v48, s45
    v_perm_b32 v85, v60, v56, s45
    v_perm_b32 v86, v68, v64, s45
    v_perm_b32 v87, v76, v72, s45
    ds_write_b128 v13, v[84:87] offset:1024
    v_perm_b32 v80, v53, v49, s44
    v_perm_b32 v81, v61, v57, s44
    v_perm_b32 v82, v69, v65, s44
    v_perm_b32 v83, v77, v73, s44
    ds_write_b128 v13, v[80:83] offset:8192
    v_perm_b32 v84, v53, v49, s45
    v_perm_b32 v85, v61, v57, s45
    v_perm_b32 v86, v69, v65, s45
    v_perm_b32 v87, v77, v73, s45
    ds_write_b128 v13, v[84:87] offset:9216
    v_perm_b32 v80, v54, v50, s44
    v_perm_b32 v81, v62, v58, s44
    v_perm_b32 v82, v70, v66, s44
    v_perm_b32 v83, v78, v74, s44
    ds_write_b128 v13, v[80:83] offset:16384
    v_perm_b32 v84, v54, v50, s45
    v_perm_b32 v85, v62, v58, s45
    v_perm_b32 v86, v70, v66, s45
    v_perm_b32 v87, v78, v74, s45
    ds_write_b128 v13, v[84:87] offset:17408
    v_perm_b32 v80, v55, v51, s44
    v_perm_b32 v81, v63, v59, s44
    v_perm_b32 v82, v71, v67, s44
    v_perm_b32 v83, v79, v75, s44
    ds_write_b128 v13, v[80:83] offset:24576
    v_perm_b32 v84, v55, v51, s45
    v_perm_b32 v85, v63, v59, s45
    v_perm_b32 v86, v71, v67, s45
    v_perm_b32 v87, v79, v75, s45
    ds_write_b128 v13, v[84:87] offset:25600
    s_cmp_lt_u32 s21, 2
    s_cselect_b32 s26, s48, s48
    s_cselect_b32 s27, 2, 2
    s_cselect_b64 s[88:89], s[72:73], s[80:81]
    s_add_u32 s26, s26, s27
    s_lshl_b32 s27, s26, 18
    s_add_u32 s27, s27, s46
    buffer_load_dwordx4 v[48:51], v12, s[88:91], s27 offen
    s_add_u32 s27, s27, 8192
    buffer_load_dwordx4 v[52:55], v12, s[88:91], s27 offen
    s_add_u32 s27, s27, 8192
    buffer_load_dwordx4 v[56:59], v12, s[88:91], s27 offen
    s_add_u32 s27, s27, 8192
    buffer_load_dwordx4 v[60:63], v12, s[88:91], s27 offen
    s_add_u32 s27, s27, 8192
    buffer_load_dwordx4 v[64:67], v12, s[88:91], s27 offen
    s_add_u32 s27, s27, 8192
    buffer_load_dwordx4 v[68:71], v12, s[88:91], s27 offen
    s_add_u32 s27, s27, 8192
    buffer_load_dwordx4 v[72:75], v12, s[88:91], s27 offen
    s_add_u32 s27, s27, 8192
    buffer_load_dwordx4 v[76:79], v12, s[88:91], s27 offen
    s_waitcnt lgkmcnt(0)
    s_barrier
    ds_read_b128 v[192:195], v4 offset:0
    ds_read_b128 v[184:187], v4 offset:1024
    ds_read_b128 v[196:199], v4 offset:2048
    ds_read_b128 v[188:191], v4 offset:3072
    ds_read_b128 v[176:179], v4 offset:4096
    ds_read_b128 v[168:171], v4 offset:5120
    ds_read_b128 v[180:183], v4 offset:6144
    ds_read_b128 v[172:175], v4 offset:7168
    s_waitcnt lgkmcnt(0)
    s_barrier
    s_and_b32 s28, s21, 1
    s_lshl_b32 s28, s28, 10
    s_mov_b32 s29, 2048
    s_mov_b32 s30, 4096
    s_cmp_lt_u32 s21, 2
    s_cselect_b32 s29, 24576, s29
    s_cselect_b32 s30, 34816, s30
    s_add_u32 s29, s29, s28
    v_add_u32 v13, s29, v0
    s_add_u32 s29, s29, s30
    s_waitcnt vmcnt(14)
    v_perm_b32 v80, v20, v16, s44
    s_waitcnt vmcnt(12)
    v_perm_b32 v81, v28, v24, s44
    s_waitcnt vmcnt(10)
    v_perm_b32 v82, v36, v32, s44
    s_waitcnt vmcnt(8)
    v_perm_b32 v83, v44, v40, s44
    ds_write_b128 v13, v[80:83]
    v_add_u32 v14, s29, v0
    s_add_u32 s29, s29, s30
    v_perm_b32 v84, v21, v17, s44
    v_perm_b32 v85, v29, v25, s44
    v_perm_b32 v86, v37, v33, s44
    v_perm_b32 v87, v45, v41, s44
    ds_write_b128 v14, v[84:87]
    v_add_u32 v13, s29, v0
    s_add_u32 s29, s29, s30
    v_perm_b32 v80, v22, v18, s44
    v_perm_b32 v81, v30, v26, s44
    v_perm_b32 v82, v38, v34, s44
    v_perm_b32 v83, v46, v42, s44
    ds_write_b128 v13, v[80:83]
    v_add_u32 v14, s29, v0
    s_add_u32 s29, s29, s30
    v_perm_b32 v84, v23, v19, s44
    v_perm_b32 v85, v31, v27, s44
    v_perm_b32 v86, v39, v35, s44
    v_perm_b32 v87, v47, v43, s44
    ds_write_b128 v14, v[84:87]
    s_mov_b32 s29, 28672
    s_mov_b32 s30, 34816
    s_cmp_lt_u32 s21, 2
    s_cselect_b32 s29, 26624, s29
    s_cselect_b32 s30, 34816, s30
    s_add_u32 s29, s29, s28
    v_add_u32 v13, s29, v0
    s_add_u32 s29, s29, s30
    v_perm_b32 v80, v20, v16, s45
    v_perm_b32 v81, v28, v24, s45
    v_perm_b32 v82, v36, v32, s45
    v_perm_b32 v83, v44, v40, s45
    ds_write_b128 v13, v[80:83]
    v_add_u32 v14, s29, v0
    s_add_u32 s29, s29, s30
    v_perm_b32 v84, v21, v17, s45
    v_perm_b32 v85, v29, v25, s45
    v_perm_b32 v86, v37, v33, s45
    v_perm_b32 v87, v45, v41, s45
    ds_write_b128 v14, v[84:87]
    v_add_u32 v13, s29, v0
    s_add_u32 s29, s29, s30
    v_perm_b32 v80, v22, v18, s45
    v_perm_b32 v81, v30, v26, s45
    v_perm_b32 v82, v38, v34, s45
    v_perm_b32 v83, v46, v42, s45
    ds_write_b128 v13, v[80:83]
    v_add_u32 v14, s29, v0
    s_add_u32 s29, s29, s30
    v_perm_b32 v84, v23, v19, s45
    v_perm_b32 v85, v31, v27, s45
    v_perm_b32 v86, v39, v35, s45
    v_perm_b32 v87, v47, v43, s45
    ds_write_b128 v14, v[84:87]
    s_cmp_lt_u32 s21, 2
    s_cselect_b32 s26, s48, s48
    s_cselect_b32 s27, 4, 4
    s_cselect_b64 s[88:89], s[72:73], s[76:77]
    s_add_u32 s26, s26, s27
    s_lshl_b32 s27, s26, 18
    s_add_u32 s27, s27, s46
    buffer_load_dwordx4 v[16:19], v12, s[88:91], s27 offen
    s_add_u32 s27, s27, 8192
    buffer_load_dwordx4 v[20:23], v12, s[88:91], s27 offen
    s_add_u32 s27, s27, 8192
    buffer_load_dwordx4 v[24:27], v12, s[88:91], s27 offen
    s_add_u32 s27, s27, 8192
    buffer_load_dwordx4 v[28:31], v12, s[88:91], s27 offen
    s_add_u32 s27, s27, 8192
    buffer_load_dwordx4 v[32:35], v12, s[88:91], s27 offen
    s_add_u32 s27, s27, 8192
    buffer_load_dwordx4 v[36:39], v12, s[88:91], s27 offen
    s_add_u32 s27, s27, 8192
    buffer_load_dwordx4 v[40:43], v12, s[88:91], s27 offen
    s_add_u32 s27, s27, 8192
    buffer_load_dwordx4 v[44:47], v12, s[88:91], s27 offen
    s_waitcnt lgkmcnt(0)
    s_barrier
    ds_read_b128 a[232:235], v6 offset:2048
    ds_read_b128 a[236:239], v6 offset:3072
    s_waitcnt lgkmcnt(0)
    s_barrier
    s_and_b32 s28, s21, 1
    s_lshl_b32 s28, s28, 10
    s_mov_b32 s29, 32768
    s_mov_b32 s30, 34816
    s_cmp_lt_u32 s21, 2
    s_cselect_b32 s29, 0, s29
    s_cselect_b32 s30, 4096, s30
    s_add_u32 s29, s29, s28
    v_add_u32 v13, s29, v0
    s_add_u32 s29, s29, s30
    s_waitcnt vmcnt(14)
    v_perm_b32 v80, v52, v48, s44
    s_waitcnt vmcnt(12)
    v_perm_b32 v81, v60, v56, s44
    s_waitcnt vmcnt(10)
    v_perm_b32 v82, v68, v64, s44
    s_waitcnt vmcnt(8)
    v_perm_b32 v83, v76, v72, s44
    ds_write_b128 v13, v[80:83]
    v_add_u32 v14, s29, v0
    s_add_u32 s29, s29, s30
    v_perm_b32 v84, v53, v49, s44
    v_perm_b32 v85, v61, v57, s44
    v_perm_b32 v86, v69, v65, s44
    v_perm_b32 v87, v77, v73, s44
    ds_write_b128 v14, v[84:87]
    v_add_u32 v13, s29, v0
    s_add_u32 s29, s29, s30
    v_perm_b32 v80, v54, v50, s44
    v_perm_b32 v81, v62, v58, s44
    v_perm_b32 v82, v70, v66, s44
    v_perm_b32 v83, v78, v74, s44
    ds_write_b128 v13, v[80:83]
    v_add_u32 v14, s29, v0
    s_add_u32 s29, s29, s30
    v_perm_b32 v84, v55, v51, s44
    v_perm_b32 v85, v63, v59, s44
    v_perm_b32 v86, v71, v67, s44
    v_perm_b32 v87, v79, v75, s44
    ds_write_b128 v14, v[84:87]
    s_mov_b32 s29, 2048
    s_mov_b32 s30, 4096
    s_cmp_lt_u32 s21, 2
    s_cselect_b32 s29, 30720, s29
    s_cselect_b32 s30, 34816, s30
    s_add_u32 s29, s29, s28
    v_add_u32 v13, s29, v0
    s_add_u32 s29, s29, s30
    v_perm_b32 v80, v52, v48, s45
    v_perm_b32 v81, v60, v56, s45
    v_perm_b32 v82, v68, v64, s45
    v_perm_b32 v83, v76, v72, s45
    ds_write_b128 v13, v[80:83]
    v_add_u32 v14, s29, v0
    s_add_u32 s29, s29, s30
    v_perm_b32 v84, v53, v49, s45
    v_perm_b32 v85, v61, v57, s45
    v_perm_b32 v86, v69, v65, s45
    v_perm_b32 v87, v77, v73, s45
    ds_write_b128 v14, v[84:87]
    v_add_u32 v13, s29, v0
    s_add_u32 s29, s29, s30
    v_perm_b32 v80, v54, v50, s45
    v_perm_b32 v81, v62, v58, s45
    v_perm_b32 v82, v70, v66, s45
    v_perm_b32 v83, v78, v74, s45
    ds_write_b128 v13, v[80:83]
    v_add_u32 v14, s29, v0
    s_add_u32 s29, s29, s30
    v_perm_b32 v84, v55, v51, s45
    v_perm_b32 v85, v63, v59, s45
    v_perm_b32 v86, v71, v67, s45
    v_perm_b32 v87, v79, v75, s45
    ds_write_b128 v14, v[84:87]
    s_cmp_lt_u32 s21, 2
    s_cselect_b32 s26, s48, s48
    s_cselect_b32 s27, 6, 8
    s_cselect_b64 s[88:89], s[72:73], s[72:73]
    s_add_u32 s26, s26, s27
    s_lshl_b32 s27, s26, 18
    s_add_u32 s27, s27, s46
    buffer_load_dwordx4 v[48:51], v12, s[88:91], s27 offen
    s_add_u32 s27, s27, 8192
    buffer_load_dwordx4 v[52:55], v12, s[88:91], s27 offen
    s_add_u32 s27, s27, 8192
    buffer_load_dwordx4 v[56:59], v12, s[88:91], s27 offen
    s_add_u32 s27, s27, 8192
    buffer_load_dwordx4 v[60:63], v12, s[88:91], s27 offen
    s_add_u32 s27, s27, 8192
    buffer_load_dwordx4 v[64:67], v12, s[88:91], s27 offen
    s_add_u32 s27, s27, 8192
    buffer_load_dwordx4 v[68:71], v12, s[88:91], s27 offen
    s_add_u32 s27, s27, 8192
    buffer_load_dwordx4 v[72:75], v12, s[88:91], s27 offen
    s_add_u32 s27, s27, 8192
    buffer_load_dwordx4 v[76:79], v12, s[88:91], s27 offen
    s_waitcnt lgkmcnt(0)
    s_barrier
    ds_read_b128 a[224:227], v6 offset:0
    ds_read_b128 a[228:231], v6 offset:1024
    ds_read_b128 a[200:203], v6 offset:2048
    ds_read_b128 a[204:207], v6 offset:3072
    s_waitcnt lgkmcnt(0)
    s_barrier
    s_and_b32 s28, s21, 1
    s_lshl_b32 s28, s28, 10
    s_mov_b32 s29, 2048
    s_mov_b32 s30, 4096
    s_cmp_lt_u32 s21, 2
    s_cselect_b32 s29, 34816, s29
    s_cselect_b32 s30, 34816, s30
    s_add_u32 s29, s29, s28
    v_add_u32 v13, s29, v0
    s_add_u32 s29, s29, s30
    s_waitcnt vmcnt(14)
    v_perm_b32 v80, v20, v16, s44
    s_waitcnt vmcnt(12)
    v_perm_b32 v81, v28, v24, s44
    s_waitcnt vmcnt(10)
    v_perm_b32 v82, v36, v32, s44
    s_waitcnt vmcnt(8)
    v_perm_b32 v83, v44, v40, s44
    ds_write_b128 v13, v[80:83]
    v_add_u32 v14, s29, v0
    s_add_u32 s29, s29, s30
    v_perm_b32 v84, v21, v17, s44
    v_perm_b32 v85, v29, v25, s44
    v_perm_b32 v86, v37, v33, s44
    v_perm_b32 v87, v45, v41, s44
    ds_write_b128 v14, v[84:87]
    v_add_u32 v13, s29, v0
    s_add_u32 s29, s29, s30
    v_perm_b32 v80, v22, v18, s44
    v_perm_b32 v81, v30, v26, s44
    v_perm_b32 v82, v38, v34, s44
    v_perm_b32 v83, v46, v42, s44
    ds_write_b128 v13, v[80:83]
    v_add_u32 v14, s29, v0
    s_add_u32 s29, s29, s30
    v_perm_b32 v84, v23, v19, s44
    v_perm_b32 v85, v31, v27, s44
    v_perm_b32 v86, v39, v35, s44
    v_perm_b32 v87, v47, v43, s44
    ds_write_b128 v14, v[84:87]
    s_mov_b32 s29, 36864
    s_mov_b32 s30, 34816
    s_cmp_lt_u32 s21, 2
    s_cselect_b32 s29, 0, s29
    s_cselect_b32 s30, 4096, s30
    s_add_u32 s29, s29, s28
    v_add_u32 v13, s29, v0
    s_add_u32 s29, s29, s30
    v_perm_b32 v80, v20, v16, s45
    v_perm_b32 v81, v28, v24, s45
    v_perm_b32 v82, v36, v32, s45
    v_perm_b32 v83, v44, v40, s45
    ds_write_b128 v13, v[80:83]
    v_add_u32 v14, s29, v0
    s_add_u32 s29, s29, s30
    v_perm_b32 v84, v21, v17, s45
    v_perm_b32 v85, v29, v25, s45
    v_perm_b32 v86, v37, v33, s45
    v_perm_b32 v87, v45, v41, s45
    ds_write_b128 v14, v[84:87]
    v_add_u32 v13, s29, v0
    s_add_u32 s29, s29, s30
    v_perm_b32 v80, v22, v18, s45
    v_perm_b32 v81, v30, v26, s45
    v_perm_b32 v82, v38, v34, s45
    v_perm_b32 v83, v46, v42, s45
    ds_write_b128 v13, v[80:83]
    v_add_u32 v14, s29, v0
    s_add_u32 s29, s29, s30
    v_perm_b32 v84, v23, v19, s45
    v_perm_b32 v85, v31, v27, s45
    v_perm_b32 v86, v39, v35, s45
    v_perm_b32 v87, v47, v43, s45
    ds_write_b128 v14, v[84:87]
    s_cmp_lt_u32 s21, 2
    s_cselect_b32 s26, s48, s49
    s_cselect_b32 s27, 8, 0
    s_cselect_b64 s[88:89], s[76:77], s[72:73]
    s_add_u32 s26, s26, s27
    s_lshl_b32 s27, s26, 18
    s_add_u32 s27, s27, s46
    buffer_load_dwordx4 v[16:19], v12, s[88:91], s27 offen
    s_add_u32 s27, s27, 8192
    buffer_load_dwordx4 v[20:23], v12, s[88:91], s27 offen
    s_add_u32 s27, s27, 8192
    buffer_load_dwordx4 v[24:27], v12, s[88:91], s27 offen
    s_add_u32 s27, s27, 8192
    buffer_load_dwordx4 v[28:31], v12, s[88:91], s27 offen
    s_add_u32 s27, s27, 8192
    buffer_load_dwordx4 v[32:35], v12, s[88:91], s27 offen
    s_add_u32 s27, s27, 8192
    buffer_load_dwordx4 v[36:39], v12, s[88:91], s27 offen
    s_add_u32 s27, s27, 8192
    buffer_load_dwordx4 v[40:43], v12, s[88:91], s27 offen
    s_add_u32 s27, s27, 8192
    buffer_load_dwordx4 v[44:47], v12, s[88:91], s27 offen
    s_waitcnt lgkmcnt(0)
    s_barrier
    ds_read_b128 a[192:195], v6 offset:0
    ds_read_b128 a[196:199], v6 offset:1024
    ds_read_b128 a[184:187], v6 offset:2048
    ds_read_b128 a[188:191], v6 offset:3072
    s_waitcnt lgkmcnt(0)
    s_barrier
    s_and_b32 s28, s21, 1
    s_lshl_b32 s28, s28, 10
    s_mov_b32 s29, 40960
    s_mov_b32 s30, 34816
    s_cmp_lt_u32 s21, 2
    s_cselect_b32 s29, 0, s29
    s_cselect_b32 s30, 4096, s30
    s_add_u32 s29, s29, s28
    v_add_u32 v13, s29, v0
    s_add_u32 s29, s29, s30
    s_waitcnt vmcnt(14)
    v_perm_b32 v80, v52, v48, s44
    s_waitcnt vmcnt(12)
    v_perm_b32 v81, v60, v56, s44
    s_waitcnt vmcnt(10)
    v_perm_b32 v82, v68, v64, s44
    s_waitcnt vmcnt(8)
    v_perm_b32 v83, v76, v72, s44
    ds_write_b128 v13, v[80:83]
    v_add_u32 v14, s29, v0
    s_add_u32 s29, s29, s30
    v_perm_b32 v84, v53, v49, s44
    v_perm_b32 v85, v61, v57, s44
    v_perm_b32 v86, v69, v65, s44
    v_perm_b32 v87, v77, v73, s44
    ds_write_b128 v14, v[84:87]
    v_add_u32 v13, s29, v0
    s_add_u32 s29, s29, s30
    v_perm_b32 v80, v54, v50, s44
    v_perm_b32 v81, v62, v58, s44
    v_perm_b32 v82, v70, v66, s44
    v_perm_b32 v83, v78, v74, s44
    ds_write_b128 v13, v[80:83]
    v_add_u32 v14, s29, v0
    s_add_u32 s29, s29, s30
    v_perm_b32 v84, v55, v51, s44
    v_perm_b32 v85, v63, v59, s44
    v_perm_b32 v86, v71, v67, s44
    v_perm_b32 v87, v79, v75, s44
    ds_write_b128 v14, v[84:87]
    s_mov_b32 s29, 2048
    s_mov_b32 s30, 4096
    s_cmp_lt_u32 s21, 2
    s_cselect_b32 s29, 38912, s29
    s_cselect_b32 s30, 34816, s30
    s_add_u32 s29, s29, s28
    v_add_u32 v13, s29, v0
    s_add_u32 s29, s29, s30
    v_perm_b32 v80, v52, v48, s45
    v_perm_b32 v81, v60, v56, s45
    v_perm_b32 v82, v68, v64, s45
    v_perm_b32 v83, v76, v72, s45
    ds_write_b128 v13, v[80:83]
    v_add_u32 v14, s29, v0
    s_add_u32 s29, s29, s30
    v_perm_b32 v84, v53, v49, s45
    v_perm_b32 v85, v61, v57, s45
    v_perm_b32 v86, v69, v65, s45
    v_perm_b32 v87, v77, v73, s45
    ds_write_b128 v14, v[84:87]
    v_add_u32 v13, s29, v0
    s_add_u32 s29, s29, s30
    v_perm_b32 v80, v54, v50, s45
    v_perm_b32 v81, v62, v58, s45
    v_perm_b32 v82, v70, v66, s45
    v_perm_b32 v83, v78, v74, s45
    ds_write_b128 v13, v[80:83]
    v_add_u32 v14, s29, v0
    s_add_u32 s29, s29, s30
    v_perm_b32 v84, v55, v51, s45
    v_perm_b32 v85, v63, v59, s45
    v_perm_b32 v86, v71, v67, s45
    v_perm_b32 v87, v79, v75, s45
    ds_write_b128 v14, v[84:87]
    s_cmp_lt_u32 s21, 2
    s_cselect_b32 s26, s49, s49
    s_cselect_b32 s27, 2, 6
    s_cselect_b64 s[88:89], s[72:73], s[72:73]
    s_add_u32 s26, s26, s27
    s_lshl_b32 s27, s26, 18
    s_add_u32 s27, s27, s46
    buffer_load_dwordx4 v[48:51], v12, s[88:91], s27 offen
    s_add_u32 s27, s27, 8192
    buffer_load_dwordx4 v[52:55], v12, s[88:91], s27 offen
    s_add_u32 s27, s27, 8192
    buffer_load_dwordx4 v[56:59], v12, s[88:91], s27 offen
    s_add_u32 s27, s27, 8192
    buffer_load_dwordx4 v[60:63], v12, s[88:91], s27 offen
    s_add_u32 s27, s27, 8192
    buffer_load_dwordx4 v[64:67], v12, s[88:91], s27 offen
    s_add_u32 s27, s27, 8192
    buffer_load_dwordx4 v[68:71], v12, s[88:91], s27 offen
    s_add_u32 s27, s27, 8192
    buffer_load_dwordx4 v[72:75], v12, s[88:91], s27 offen
    s_add_u32 s27, s27, 8192
    buffer_load_dwordx4 v[76:79], v12, s[88:91], s27 offen
    s_waitcnt lgkmcnt(0)
    s_barrier
    ds_read_b128 a[176:179], v6 offset:0
    ds_read_b128 a[180:183], v6 offset:1024
    ds_read_b128 a[152:155], v6 offset:2048
    ds_read_b128 a[156:159], v6 offset:3072
    s_waitcnt lgkmcnt(0)
    s_barrier
    s_and_b32 s28, s21, 1
    s_lshl_b32 s28, s28, 10
    s_mov_b32 s29, 2048
    s_mov_b32 s30, 4096
    s_cmp_lt_u32 s21, 2
    s_cselect_b32 s29, 43008, s29
    s_cselect_b32 s30, 34816, s30
    s_add_u32 s29, s29, s28
    v_add_u32 v13, s29, v0
    s_add_u32 s29, s29, s30
    s_waitcnt vmcnt(14)
    v_perm_b32 v80, v20, v16, s44
    s_waitcnt vmcnt(12)
    v_perm_b32 v81, v28, v24, s44
    s_waitcnt vmcnt(10)
    v_perm_b32 v82, v36, v32, s44
    s_waitcnt vmcnt(8)
    v_perm_b32 v83, v44, v40, s44
    ds_write_b128 v13, v[80:83]
    v_add_u32 v14, s29, v0
    s_add_u32 s29, s29, s30
    v_perm_b32 v84, v21, v17, s44
    v_perm_b32 v85, v29, v25, s44
    v_perm_b32 v86, v37, v33, s44
    v_perm_b32 v87, v45, v41, s44
    ds_write_b128 v14, v[84:87]
    v_add_u32 v13, s29, v0
    s_add_u32 s29, s29, s30
    v_perm_b32 v80, v22, v18, s44
    v_perm_b32 v81, v30, v26, s44
    v_perm_b32 v82, v38, v34, s44
    v_perm_b32 v83, v46, v42, s44
    ds_write_b128 v13, v[80:83]
    v_add_u32 v14, s29, v0
    s_add_u32 s29, s29, s30
    v_perm_b32 v84, v23, v19, s44
    v_perm_b32 v85, v31, v27, s44
    v_perm_b32 v86, v39, v35, s44
    v_perm_b32 v87, v47, v43, s44
    ds_write_b128 v14, v[84:87]
    s_mov_b32 s29, 45056
    s_mov_b32 s30, 34816
    s_cmp_lt_u32 s21, 2
    s_cselect_b32 s29, 0, s29
    s_cselect_b32 s30, 4096, s30
    s_add_u32 s29, s29, s28
    v_add_u32 v13, s29, v0
    s_add_u32 s29, s29, s30
    v_perm_b32 v80, v20, v16, s45
    v_perm_b32 v81, v28, v24, s45
    v_perm_b32 v82, v36, v32, s45
    v_perm_b32 v83, v44, v40, s45
    ds_write_b128 v13, v[80:83]
    v_add_u32 v14, s29, v0
    s_add_u32 s29, s29, s30
    v_perm_b32 v84, v21, v17, s45
    v_perm_b32 v85, v29, v25, s45
    v_perm_b32 v86, v37, v33, s45
    v_perm_b32 v87, v45, v41, s45
    ds_write_b128 v14, v[84:87]
    v_add_u32 v13, s29, v0
    s_add_u32 s29, s29, s30
    v_perm_b32 v80, v22, v18, s45
    v_perm_b32 v81, v30, v26, s45
    v_perm_b32 v82, v38, v34, s45
    v_perm_b32 v83, v46, v42, s45
    ds_write_b128 v13, v[80:83]
    v_add_u32 v14, s29, v0
    s_add_u32 s29, s29, s30
    v_perm_b32 v84, v23, v19, s45
    v_perm_b32 v85, v31, v27, s45
    v_perm_b32 v86, v39, v35, s45
    v_perm_b32 v87, v47, v43, s45
    ds_write_b128 v14, v[84:87]
    s_cmp_lt_u32 s21, 2
    s_cselect_b32 s26, s49, s49
    s_cselect_b32 s27, 8, 0
    s_cselect_b64 s[88:89], s[72:73], s[76:77]
    s_add_u32 s26, s26, s27
    s_lshl_b32 s27, s26, 18
    s_add_u32 s27, s27, s46
    buffer_load_dwordx4 v[16:19], v12, s[88:91], s27 offen
    s_add_u32 s27, s27, 8192
    buffer_load_dwordx4 v[20:23], v12, s[88:91], s27 offen
    s_add_u32 s27, s27, 8192
    buffer_load_dwordx4 v[24:27], v12, s[88:91], s27 offen
    s_add_u32 s27, s27, 8192
    buffer_load_dwordx4 v[28:31], v12, s[88:91], s27 offen
    s_add_u32 s27, s27, 8192
    buffer_load_dwordx4 v[32:35], v12, s[88:91], s27 offen
    s_add_u32 s27, s27, 8192
    buffer_load_dwordx4 v[36:39], v12, s[88:91], s27 offen
    s_add_u32 s27, s27, 8192
    buffer_load_dwordx4 v[40:43], v12, s[88:91], s27 offen
    s_add_u32 s27, s27, 8192
    buffer_load_dwordx4 v[44:47], v12, s[88:91], s27 offen
    s_waitcnt lgkmcnt(0)
    s_barrier
    ds_read_b128 a[144:147], v6 offset:0
    ds_read_b128 a[148:151], v6 offset:1024
    ds_read_b128 a[136:139], v6 offset:2048
    ds_read_b128 a[140:143], v6 offset:3072
    s_waitcnt lgkmcnt(0)
    s_barrier
    s_and_b32 s28, s21, 1
    s_lshl_b32 s28, s28, 10
    s_mov_b32 s29, 49152
    s_mov_b32 s30, 34816
    s_cmp_lt_u32 s21, 2
    s_cselect_b32 s29, 0, s29
    s_cselect_b32 s30, 4096, s30
    s_add_u32 s29, s29, s28
    v_add_u32 v13, s29, v0
    s_add_u32 s29, s29, s30
    s_waitcnt vmcnt(14)
    v_perm_b32 v80, v52, v48, s44
    s_waitcnt vmcnt(12)
    v_perm_b32 v81, v60, v56, s44
    s_waitcnt vmcnt(10)
    v_perm_b32 v82, v68, v64, s44
    s_waitcnt vmcnt(8)
    v_perm_b32 v83, v76, v72, s44
    ds_write_b128 v13, v[80:83]
    v_add_u32 v14, s29, v0
    s_add_u32 s29, s29, s30
    v_perm_b32 v84, v53, v49, s44
    v_perm_b32 v85, v61, v57, s44
    v_perm_b32 v86, v69, v65, s44
    v_perm_b32 v87, v77, v73, s44
    ds_write_b128 v14, v[84:87]
    v_add_u32 v13, s29, v0
    s_add_u32 s29, s29, s30
    v_perm_b32 v80, v54, v50, s44
    v_perm_b32 v81, v62, v58, s44
    v_perm_b32 v82, v70, v66, s44
    v_perm_b32 v83, v78, v74, s44
    ds_write_b128 v13, v[80:83]
    v_add_u32 v14, s29, v0
    s_add_u32 s29, s29, s30
    v_perm_b32 v84, v55, v51, s44
    v_perm_b32 v85, v63, v59, s44
    v_perm_b32 v86, v71, v67, s44
    v_perm_b32 v87, v79, v75, s44
    ds_write_b128 v14, v[84:87]
    s_mov_b32 s29, 2048
    s_mov_b32 s30, 4096
    s_cmp_lt_u32 s21, 2
    s_cselect_b32 s29, 47104, s29
    s_cselect_b32 s30, 34816, s30
    s_add_u32 s29, s29, s28
    v_add_u32 v13, s29, v0
    s_add_u32 s29, s29, s30
    v_perm_b32 v80, v52, v48, s45
    v_perm_b32 v81, v60, v56, s45
    v_perm_b32 v82, v68, v64, s45
    v_perm_b32 v83, v76, v72, s45
    ds_write_b128 v13, v[80:83]
    v_add_u32 v14, s29, v0
    s_add_u32 s29, s29, s30
    v_perm_b32 v84, v53, v49, s45
    v_perm_b32 v85, v61, v57, s45
    v_perm_b32 v86, v69, v65, s45
    v_perm_b32 v87, v77, v73, s45
    ds_write_b128 v14, v[84:87]
    v_add_u32 v13, s29, v0
    s_add_u32 s29, s29, s30
    v_perm_b32 v80, v54, v50, s45
    v_perm_b32 v81, v62, v58, s45
    v_perm_b32 v82, v70, v66, s45
    v_perm_b32 v83, v78, v74, s45
    ds_write_b128 v13, v[80:83]
    v_add_u32 v14, s29, v0
    s_add_u32 s29, s29, s30
    v_perm_b32 v84, v55, v51, s45
    v_perm_b32 v85, v63, v59, s45
    v_perm_b32 v86, v71, v67, s45
    v_perm_b32 v87, v79, v75, s45
    ds_write_b128 v14, v[84:87]
    s_cmp_lt_u32 s21, 2
    s_cselect_b32 s26, s49, s49
    s_cselect_b32 s27, 2, 6
    s_cselect_b64 s[88:89], s[76:77], s[76:77]
    s_add_u32 s26, s26, s27
    s_lshl_b32 s27, s26, 18
    s_add_u32 s27, s27, s46
    buffer_load_dwordx4 v[48:51], v12, s[88:91], s27 offen
    s_add_u32 s27, s27, 8192
    buffer_load_dwordx4 v[52:55], v12, s[88:91], s27 offen
    s_add_u32 s27, s27, 8192
    buffer_load_dwordx4 v[56:59], v12, s[88:91], s27 offen
    s_add_u32 s27, s27, 8192
    buffer_load_dwordx4 v[60:63], v12, s[88:91], s27 offen
    s_add_u32 s27, s27, 8192
    buffer_load_dwordx4 v[64:67], v12, s[88:91], s27 offen
    s_add_u32 s27, s27, 8192
    buffer_load_dwordx4 v[68:71], v12, s[88:91], s27 offen
    s_add_u32 s27, s27, 8192
    buffer_load_dwordx4 v[72:75], v12, s[88:91], s27 offen
    s_add_u32 s27, s27, 8192
    buffer_load_dwordx4 v[76:79], v12, s[88:91], s27 offen
    s_waitcnt lgkmcnt(0)
    s_barrier
    ds_read_b128 a[128:131], v6 offset:0
    ds_read_b128 a[132:135], v6 offset:1024
    ds_read_b128 a[104:107], v6 offset:2048
    ds_read_b128 a[108:111], v6 offset:3072
    s_waitcnt lgkmcnt(0)
    s_barrier
    s_and_b32 s28, s21, 1
    s_lshl_b32 s28, s28, 10
    s_mov_b32 s29, 2048
    s_mov_b32 s30, 4096
    s_cmp_lt_u32 s21, 2
    s_cselect_b32 s29, 51200, s29
    s_cselect_b32 s30, 34816, s30
    s_add_u32 s29, s29, s28
    v_add_u32 v13, s29, v0
    s_add_u32 s29, s29, s30
    s_waitcnt vmcnt(14)
    v_perm_b32 v80, v20, v16, s44
    s_waitcnt vmcnt(12)
    v_perm_b32 v81, v28, v24, s44
    s_waitcnt vmcnt(10)
    v_perm_b32 v82, v36, v32, s44
    s_waitcnt vmcnt(8)
    v_perm_b32 v83, v44, v40, s44
    ds_write_b128 v13, v[80:83]
    v_add_u32 v14, s29, v0
    s_add_u32 s29, s29, s30
    v_perm_b32 v84, v21, v17, s44
    v_perm_b32 v85, v29, v25, s44
    v_perm_b32 v86, v37, v33, s44
    v_perm_b32 v87, v45, v41, s44
    ds_write_b128 v14, v[84:87]
    v_add_u32 v13, s29, v0
    s_add_u32 s29, s29, s30
    v_perm_b32 v80, v22, v18, s44
    v_perm_b32 v81, v30, v26, s44
    v_perm_b32 v82, v38, v34, s44
    v_perm_b32 v83, v46, v42, s44
    ds_write_b128 v13, v[80:83]
    v_add_u32 v14, s29, v0
    s_add_u32 s29, s29, s30
    v_perm_b32 v84, v23, v19, s44
    v_perm_b32 v85, v31, v27, s44
    v_perm_b32 v86, v39, v35, s44
    v_perm_b32 v87, v47, v43, s44
    ds_write_b128 v14, v[84:87]
    s_mov_b32 s29, 53248
    s_mov_b32 s30, 34816
    s_cmp_lt_u32 s21, 2
    s_cselect_b32 s29, 0, s29
    s_cselect_b32 s30, 4096, s30
    s_add_u32 s29, s29, s28
    v_add_u32 v13, s29, v0
    s_add_u32 s29, s29, s30
    v_perm_b32 v80, v20, v16, s45
    v_perm_b32 v81, v28, v24, s45
    v_perm_b32 v82, v36, v32, s45
    v_perm_b32 v83, v44, v40, s45
    ds_write_b128 v13, v[80:83]
    v_add_u32 v14, s29, v0
    s_add_u32 s29, s29, s30
    v_perm_b32 v84, v21, v17, s45
    v_perm_b32 v85, v29, v25, s45
    v_perm_b32 v86, v37, v33, s45
    v_perm_b32 v87, v45, v41, s45
    ds_write_b128 v14, v[84:87]
    v_add_u32 v13, s29, v0
    s_add_u32 s29, s29, s30
    v_perm_b32 v80, v22, v18, s45
    v_perm_b32 v81, v30, v26, s45
    v_perm_b32 v82, v38, v34, s45
    v_perm_b32 v83, v46, v42, s45
    ds_write_b128 v13, v[80:83]
    v_add_u32 v14, s29, v0
    s_add_u32 s29, s29, s30
    v_perm_b32 v84, v23, v19, s45
    v_perm_b32 v85, v31, v27, s45
    v_perm_b32 v86, v39, v35, s45
    v_perm_b32 v87, v47, v43, s45
    ds_write_b128 v14, v[84:87]
    s_waitcnt lgkmcnt(0)
    s_barrier
    ds_read_b128 a[96:99], v6 offset:0
    ds_read_b128 a[100:103], v6 offset:1024
    ds_read_b128 a[88:91], v6 offset:2048
    ds_read_b128 a[92:95], v6 offset:3072
    s_waitcnt lgkmcnt(0)
    s_barrier
    s_and_b32 s28, s21, 1
    s_lshl_b32 s28, s28, 10
    s_mov_b32 s29, 57344
    s_mov_b32 s30, 34816
    s_cmp_lt_u32 s21, 2
    s_cselect_b32 s29, 0, s29
    s_cselect_b32 s30, 4096, s30
    s_add_u32 s29, s29, s28
    v_add_u32 v13, s29, v0
    s_add_u32 s29, s29, s30
    s_waitcnt vmcnt(6)
    v_perm_b32 v80, v52, v48, s44
    s_waitcnt vmcnt(4)
    v_perm_b32 v81, v60, v56, s44
    s_waitcnt vmcnt(2)
    v_perm_b32 v82, v68, v64, s44
    s_waitcnt vmcnt(0)
    v_perm_b32 v83, v76, v72, s44
    ds_write_b128 v13, v[80:83]
    v_add_u32 v14, s29, v0
    s_add_u32 s29, s29, s30
    v_perm_b32 v84, v53, v49, s44
    v_perm_b32 v85, v61, v57, s44
    v_perm_b32 v86, v69, v65, s44
    v_perm_b32 v87, v77, v73, s44
    ds_write_b128 v14, v[84:87]
    v_add_u32 v13, s29, v0
    s_add_u32 s29, s29, s30
    v_perm_b32 v80, v54, v50, s44
    v_perm_b32 v81, v62, v58, s44
    v_perm_b32 v82, v70, v66, s44
    v_perm_b32 v83, v78, v74, s44
    ds_write_b128 v13, v[80:83]
    v_add_u32 v14, s29, v0
    s_add_u32 s29, s29, s30
    v_perm_b32 v84, v55, v51, s44
    v_perm_b32 v85, v63, v59, s44
    v_perm_b32 v86, v71, v67, s44
    v_perm_b32 v87, v79, v75, s44
    ds_write_b128 v14, v[84:87]
    s_mov_b32 s29, 2048
    s_mov_b32 s30, 4096
    s_cmp_lt_u32 s21, 2
    s_cselect_b32 s29, 55296, s29
    s_cselect_b32 s30, 34816, s30
    s_add_u32 s29, s29, s28
    v_add_u32 v13, s29, v0
    s_add_u32 s29, s29, s30
    v_perm_b32 v80, v52, v48, s45
    v_perm_b32 v81, v60, v56, s45
    v_perm_b32 v82, v68, v64, s45
    v_perm_b32 v83, v76, v72, s45
    ds_write_b128 v13, v[80:83]
    v_add_u32 v14, s29, v0
    s_add_u32 s29, s29, s30
    v_perm_b32 v84, v53, v49, s45
    v_perm_b32 v85, v61, v57, s45
    v_perm_b32 v86, v69, v65, s45
    v_perm_b32 v87, v77, v73, s45
    ds_write_b128 v14, v[84:87]
    v_add_u32 v13, s29, v0
    s_add_u32 s29, s29, s30
    v_perm_b32 v80, v54, v50, s45
    v_perm_b32 v81, v62, v58, s45
    v_perm_b32 v82, v70, v66, s45
    v_perm_b32 v83, v78, v74, s45
    ds_write_b128 v13, v[80:83]
    v_add_u32 v14, s29, v0
    s_add_u32 s29, s29, s30
    v_perm_b32 v84, v55, v51, s45
    v_perm_b32 v85, v63, v59, s45
    v_perm_b32 v86, v71, v67, s45
    v_perm_b32 v87, v79, v75, s45
    ds_write_b128 v14, v[84:87]
    s_waitcnt lgkmcnt(0)
    s_barrier
    ds_read_b128 a[80:83], v6 offset:0
    ds_read_b128 a[84:87], v6 offset:1024
    ds_read_b128 a[56:59], v6 offset:2048
    ds_read_b128 a[60:63], v6 offset:3072
    s_waitcnt lgkmcnt(0)
M_lw_done:
    s_cmp_lg_u32 s32, 0
    s_cbranch_scc1 M_role_ok
    s_mov_b32 s32, 1
    s_mov_b32 s30, 0
    v_bfe_u32 v12, v0, 4, 4
    v_lshlrev_b32 v12, 2, v12
M_modepoll:
    buffer_load_dword v13, v12, s[12:15], 0 offen sc1
    s_waitcnt vmcnt(0)
    v_readlane_b32 s31, v13, 8
    s_cmp_eq_u32 s31, 256
    s_cbranch_scc1 M_modegot
    s_sleep 2
    s_add_u32 s30, s30, 1
    s_cmp_lt_u32 s30, 60000
    s_cbranch_scc1 M_modepoll
    s_branch M_fail
M_modegot:
    s_cmp_eq_u32 s30, 0
    s_cbranch_scc1 M_moderd
    buffer_load_dword v13, v12, s[12:15], 0 offen sc1
    s_waitcnt vmcnt(0)
M_moderd:
    v_readlane_b32 s33, v13, 15
    s_nop 0
    s_and_b32 s33, s33, 3
    s_lshl_b32 s33, s33, 13
    s_xor_b32 s33, s33, 16384
    v_cmp_ne_u32 vcc, 32, v13
    s_and_b32 s31, vcc_lo, 0xff
    s_cmp_lg_u32 s31, 0
    s_cbranch_scc1 M_slowm
    s_cmp_ge_u32 s20, 3
    s_cbranch_scc1 M_loadw
    s_branch M_role_ok
M_slowm:
    s_mov_b32 s23, 1
    s_mov_b32 s31, s25
    v_readlane_b32 s30, v13, 0
    s_cmp_gt_u32 s24, 0
    s_cselect_b32 s30, s30, 0
    s_add_u32 s31, s31, s30
    v_readlane_b32 s30, v13, 1
    s_cmp_gt_u32 s24, 1
    s_cselect_b32 s30, s30, 0
    s_add_u32 s31, s31, s30
    v_readlane_b32 s30, v13, 2
    s_cmp_gt_u32 s24, 2
    s_cselect_b32 s30, s30, 0
    s_add_u32 s31, s31, s30
    v_readlane_b32 s30, v13, 3
    s_cmp_gt_u32 s24, 3
    s_cselect_b32 s30, s30, 0
    s_add_u32 s31, s31, s30
    v_readlane_b32 s30, v13, 4
    s_cmp_gt_u32 s24, 4
    s_cselect_b32 s30, s30, 0
    s_add_u32 s31, s31, s30
    v_readlane_b32 s30, v13, 5
    s_cmp_gt_u32 s24, 5
    s_cselect_b32 s30, s30, 0
    s_add_u32 s31, s31, s30
    v_readlane_b32 s30, v13, 6
    s_cmp_gt_u32 s24, 6
    s_cselect_b32 s30, s30, 0
    s_add_u32 s31, s31, s30
    s_lshr_b32 s20, s31, 5
    s_and_b32 s22, s31, 31
    s_and_b32 s20, s20, 7
    s_and_b32 s22, s22, 31
    s_branch M_loadw
M_role_ok:
    s_mov_b32 s25, s33
    s_cmp_ge_u32 s20, 2
    s_cbranch_scc1 M_bulk
    v_lshrrev_b32 v36, 8, v0
    v_bfe_u32 v37, v0, 4, 4
    v_bfe_u32 v38, v0, 4, 3
    v_bfe_u32 v39, v0, 7, 1
    s_mov_b32 s36, 0x00ff00ff
    s_mov_b32 s37, 0x00ff00ff
    s_not_b64 s[18:19], s[36:37]
    v_mov_b32 v1, 0x4444
    v_mov_b32 v40, 0xeeee
    v_cndmask_b32_e64 v1, v1, v40, s[18:19]
    v_and_b32 v40, 1, v36
    v_lshlrev_b32 v40, 2, v40
    v_lshrrev_b32 v41, 1, v36
    v_add_u32 v40, v40, v41
    v_mul_u32_u24 v40, 288, v40
    v_lshl_add_u32 v40, v37, 2, v40
    s_lshl_b32 s27, s21, 6
    v_add_u32 v2, s27, v40
    v_mul_u32_u24 v40, 288, v38
    v_lshl_add_u32 v3, v36, 4, v40
    s_lshr_b32 s27, s21, 1
    s_lshl_b32 s27, s27, 10
    s_and_b32 s28, s21, 1
    s_lshl_b32 s28, s28, 3
    s_add_u32 s27, s27, s28
    s_add_u32 s27, s27, 13312
    v_and_b32 v40, 0x37f, v0
    v_add_u32 v4, s27, v40
    s_mul_i32 s27, s21, 34816
    s_add_u32 s27, s27, 24576
    v_add_u32 v5, s27, v0
    v_and_b32 v6, 0x200, v0
    v_bfe_u32 v40, v0, 6, 1
    v_lshl_or_b32 v6, v40, 8, v6
    v_bfe_u32 v40, v0, 4, 1
    v_lshl_or_b32 v6, v40, 7, v6
    v_bfe_u32 v40, v0, 5, 1
    v_lshl_or_b32 v6, v40, 6, v6
    v_bfe_u32 v40, v0, 8, 1
    v_lshl_or_b32 v6, v40, 5, v6
    v_bfe_u32 v40, v0, 7, 1
    v_lshl_or_b32 v6, v40, 4, v6
    s_lshl_b32 s27, s21, 13
    s_lshl_b32 s28, s22, 5
    s_add_u32 s27, s27, s28
    s_add_u32 s27, s27, 135168
    v_lshrrev_b32 v40, 7, v0
    v_lshlrev_b32 v40, 10, v40
    v_lshl_add_u32 v40, v38, 2, v40
    v_add_u32 v7, s27, v40
    v_lshrrev_b32 v40, 7, v0
    v_mul_u32_u24 v40, 4224, v40
    v_lshl_add_u32 v8, v38, 4, v40
    v_lshlrev_b32 v9, 3, v0
    s_mul_i32 s34, s20, 671744
    s_add_u32 s34, s34, 172228608
    s_lshl_b32 s35, s21, 10
    s_mul_i32 s27, s22, 4224
    s_add_u32 s35, s35, s27
    s_and_b32 s27, s22, 1
    s_bfe_u32 s28, s22, 0x10001
    s_bfe_u32 s29, s22, 0x10002
    s_lshl_b32 s30, s27, 2
    s_lshl_b32 s31, s28, 1
    s_or_b32 s30, s30, s31
    s_or_b32 s30, s30, s29
    s_and_b32 s31, s22, 0x18
    s_or_b32 s30, s30, s31
    s_lshl_b32 s33, s30, 7
    s_lshl_b32 s32, s22, 7
    s_cmp_eq_u32 s21, 0
    s_cbranch_scc1 M_c_r0
    s_lshl_b32 s32, s22, 10
    s_add_u32 s32, s32, 135168
    s_lshl_b32 s33, s27, 4
    s_lshl_b32 s28, s28, 8
    s_or_b32 s33, s33, s28
    s_lshl_b32 s29, s29, 7
    s_or_b32 s33, s33, s29
    s_bfe_u32 s28, s22, 0x10003
    s_lshl_b32 s28, s28, 5
    s_or_b32 s33, s33, s28
    s_bfe_u32 s28, s22, 0x10004
    s_lshl_b32 s28, s28, 9
    s_or_b32 s33, s33, s28
    s_add_u32 s33, s33, 4096
M_c_r0:
    s_mul_i32 s41, s20, 20480
    s_add_u32 s41, s41, 173605504
    s_lshl_b32 s46, s20, 17
    s_add_u32 s46, s46, 171966464
    s_add_u32 s46, s46, s25
    s_xor_b32 s47, s46, 0x20000
    s_mov_b32 s38, 0x00ff00ff
    s_mov_b32 s39, 0
    s_mov_b32 s62, 0x00030003
    s_mov_b32 s63, 0x00030003
    s_mov_b32 s40, 0x3e0293ee
    s_movk_i32 s45, 0x3f80
    s_mov_b32 s68, 0x33800000
    s_mov_b32 s69, 0x18000000
    s_lshl_b32 s51, s22, 7
    s_add_u32 s52, s51, 167862272
    s_lshl_b32 s51, s22, 8
    s_add_u32 s51, s51, 167854080
    s_mov_b32 s24, 0x3f803f80
    s_mov_b32 s25, 0x3f803f80
    s_mov_b32 s16, 0x3f003f00
    s_mov_b32 s17, 0x3f003f00
    s_lshl_b32 s53, s22, 13
    s_add_u32 s53, s53, 218103808
    s_lshl_b32 s27, s20, 12
    s_add_u32 s53, s53, s27
    s_lshl_b32 s27, s20, 2
    s_add_u32 s52, s52, s27
    s_cmp_eq_u32 s20, 0
    s_cselect_b64 s[66:67], -1, 0
    s_mov_b32 s44, 0
    s_mov_b32 s54, 0
    s_mov_b32 s71, 0
    s_mov_b32 s4, 0x10000000
    s_mov_b32 s60, 0x10000000
    s_mov_b32 s64, 0x10000000
    s_mov_b32 s65, 0x10000000
    v_mov_b32 v40, 23296
    v_mov_b64 v[10:11], 0
    ds_write_b64 v40, v[10:11]
    s_waitcnt vmcnt(0) lgkmcnt(0)
    s_barrier
M_c_disp:
    s_cmp_lg_u32 s23, 0
    s_cbranch_scc1 M_c_slow
    s_cmp_eq_u32 s21, 1
    s_cbranch_scc1 M_c0_1_layer
    s_cmp_eq_u32 s21, 2
    s_cbranch_scc1 M_c0_2_layer
    s_cmp_eq_u32 s21, 3
    s_cbranch_scc1 M_c0_3_layer
M_c0_0_layer:
    s_lshr_b32 s27, s44, 6
    s_mul_i32 s50, s27, 33554432
    s_lshl_b32 s27, s22, 13
    s_add_u32 s50, s50, s27
    s_add_u32 s50, s50, 37748736
    s_barrier
    s_mov_b32 s26, 0x10010000
    s_mov_b32 s3, s26
    s_mul_i32 s27, s20, 5120
    s_add_u32 s48, s27, 167772160
    s_sub_u32 s49, 167777280, s27
    s_and_b32 s55, s44, 3
    s_mul_i32 s55, s55, 167936
    s_add_u32 s55, s55, s34
    s_add_u32 s58, s55, s35
    s_and_b32 s57, s44, 63
    s_add_u32 s43, s55, s32
    s_add_u32 s61, s43, 33792
    s_add_u32 s100, s43, 67584
    s_add_u32 s101, s43, 101376
    s_add_u32 s42, s44, 2
    s_or_b32 s28, s44, 63
    s_add_u32 s28, s28, 1
    s_min_u32 s42, s42, s28
    ds_read_b128 v[56:59], v5 offset:0
    ds_read_b128 v[60:63], v5 offset:1024
    ds_read_b128 v[64:67], v5 offset:2048
    ds_read_b128 v[68:71], v5 offset:3072
    v_mov_b64 v[12:13], 0
    v_mov_b64 v[14:15], 0
    v_mov_b64 v[16:17], 0
    v_mov_b64 v[18:19], 0
    v_mov_b64 v[20:21], 0
    v_mov_b64 v[22:23], 0
    v_mov_b64 v[24:25], 0
    v_mov_b64 v[26:27], 0
    v_mov_b64 v[28:29], 0
    v_mov_b64 v[30:31], 0
    v_mov_b64 v[32:33], 0
    v_mov_b64 v[34:35], 0
    s_mov_b32 s70, 0
    s_waitcnt lgkmcnt(0)
M_c0_0_top:
    s_nop 0
    s_barrier
    ds_read_b128 v[36:39], v6 offset:13312
    ds_read_b128 v[40:43], v6 offset:14336
    s_mov_b32 m0, 8192
    s_nop 0
    buffer_load_dwordx4 v0, s[8:11], s49 offen offset:0 sc1 lds
    buffer_load_dwordx4 v0, s[8:11], s49 offen offset:1024 sc1 lds
M_c0_0_lr_r:
    s_waitcnt lgkmcnt(1)
    v_smfmac_f32_16x16x64_bf16 v[20:23], v[36:39], v[56:63], v1
    ds_read_b128 v[56:59], v5 offset:4096
    v_smfmac_f32_16x16x64_bf16 v[24:27], v[36:39], v[64:71], v1
    ds_read_b128 v[60:63], v5 offset:5120
    v_smfmac_f32_16x16x64_bf16 v[28:31], v[36:39], a[248:255], v1
    ds_read_b128 v[64:67], v5 offset:6144
    v_smfmac_f32_16x16x64_bf16 v[32:35], v[36:39], a[240:247], v1
    ds_read_b128 v[68:71], v5 offset:7168
    v_smfmac_f32_16x16x64_bf16 v[12:15], v[36:39], a[232:239], v1
    ds_read_b128 v[44:47], v6 offset:15360
    s_waitcnt lgkmcnt(3)
    v_smfmac_f32_16x16x64_bf16 v[16:19], v[36:39], v[56:63], v1
    ds_read_b128 v[56:59], v5 offset:8192
    v_smfmac_f32_16x16x64_bf16 v[20:23], v[40:43], a[224:231], v1
    ds_read_b128 v[60:63], v5 offset:9216
    s_waitcnt lgkmcnt(3)
    v_smfmac_f32_16x16x64_bf16 v[24:27], v[40:43], v[64:71], v1
    ds_read_b128 v[64:67], v5 offset:10240
    v_smfmac_f32_16x16x64_bf16 v[28:31], v[40:43], a[216:223], v1
    ds_read_b128 v[68:71], v5 offset:11264
    v_smfmac_f32_16x16x64_bf16 v[32:35], v[40:43], a[208:215], v1
    ds_read_b128 v[48:51], v6 offset:16384
    s_waitcnt lgkmcnt(3)
    v_smfmac_f32_16x16x64_bf16 v[12:15], v[40:43], v[56:63], v1
    ds_read_b128 v[56:59], v5 offset:12288
    v_smfmac_f32_16x16x64_bf16 v[16:19], v[40:43], a[200:207], v1
    ds_read_b128 v[60:63], v5 offset:13312
    s_waitcnt lgkmcnt(3)
    v_smfmac_f32_16x16x64_bf16 v[20:23], v[44:47], v[64:71], v1
    ds_read_b128 v[64:67], v5 offset:14336
    v_smfmac_f32_16x16x64_bf16 v[24:27], v[44:47], a[192:199], v1
    ds_read_b128 v[68:71], v5 offset:15360
    v_smfmac_f32_16x16x64_bf16 v[28:31], v[44:47], a[184:191], v1
    ds_read_b128 v[52:55], v6 offset:17408
    s_waitcnt lgkmcnt(3)
    v_smfmac_f32_16x16x64_bf16 v[32:35], v[44:47], v[56:63], v1
    ds_read_b128 v[56:59], v5 offset:16384
    v_smfmac_f32_16x16x64_bf16 v[20:23], v[48:51], a[176:183], v1
    ds_read_b128 v[60:63], v5 offset:17408
    s_waitcnt lgkmcnt(3)
    v_max3_u32 v10, v36, v40, v44
    v_smfmac_f32_16x16x64_bf16 v[24:27], v[48:51], v[64:71], v1
    ds_read_b128 v[64:67], v5 offset:18432
    s_waitcnt lgkmcnt(3)
    v_max3_u32 v10, v10, v48, v52
    v_smfmac_f32_16x16x64_bf16 v[28:31], v[48:51], a[168:175], v1
    ds_read_b128 v[68:71], v5 offset:19456
    v_cmp_eq_u32 vcc, -1, v10
    v_smfmac_f32_16x16x64_bf16 v[32:35], v[48:51], a[160:167], v1
    s_cbranch_vccnz M_c0_0_lr
    s_waitcnt vmcnt(0)
    s_barrier
    ds_read_b128 v[36:39], v6 offset:8192
    ds_read_b128 v[40:43], v6 offset:9216
    s_waitcnt lgkmcnt(4)
    v_smfmac_f32_16x16x64_bf16 v[20:23], v[52:55], v[56:63], v1
    ds_read_b128 v[44:47], v6 offset:10240
    ds_read_b128 v[48:51], v6 offset:11264
    v_smfmac_f32_16x16x64_bf16 v[24:27], v[52:55], a[152:159], v1
    ds_read_b32 v11, v6 offset:12288
    ds_read_b128 v[56:59], v5 offset:20480
    s_waitcnt lgkmcnt(6)
    v_smfmac_f32_16x16x64_bf16 v[28:31], v[52:55], v[64:71], v1
    ds_read_b128 v[60:63], v5 offset:21504
    s_waitcnt lgkmcnt(4)
    v_max3_u32 v10, v36, v40, v44
    v_smfmac_f32_16x16x64_bf16 v[32:35], v[52:55], a[144:151], v1
    s_waitcnt lgkmcnt(2)
    v_max3_u32 v10, v10, v48, v11
    v_cmp_eq_u32 vcc, -1, v10
    s_cbranch_vccnz M_c0_0_rr
M_c0_0_rr_r:
    ds_read_b128 v[64:67], v5 offset:22528
    ds_read_b128 v[68:71], v5 offset:23552
    ds_read_b128 v[52:55], v6 offset:12288
    buffer_store_dwordx4 v[76:79], v0, s[8:11], s4 offen offset:0 sc1
    s_mov_b32 s4, 0x10000000
    s_mov_b64 exec, 0x3ff
    buffer_store_dwordx4 v[72:75], v0, s[8:11], s60 offen sc1
    s_mov_b64 exec, -1
    s_mov_b32 s60, 0x10000000
    v_smfmac_f32_16x16x64_bf16 v[20:23], v[36:39], a[136:143], v1
    s_waitcnt lgkmcnt(3)
    v_smfmac_f32_16x16x64_bf16 v[24:27], v[36:39], v[56:63], v1
    ds_read_b128 v[56:59], v5 offset:24576
    v_smfmac_f32_16x16x64_bf16 v[20:23], v[40:43], a[128:135], v1
    ds_read_b128 v[60:63], v5 offset:25600
    s_waitcnt lgkmcnt(3)
    v_smfmac_f32_16x16x64_bf16 v[24:27], v[40:43], v[64:71], v1
    ds_read_b128 v[64:67], v5 offset:26624
    v_smfmac_f32_16x16x64_bf16 v[20:23], v[44:47], a[120:127], v1
    ds_read_b128 v[68:71], v5 offset:27648
    v_smfmac_f32_16x16x64_bf16 v[24:27], v[44:47], a[112:119], v1
    s_waitcnt lgkmcnt(2)
    v_smfmac_f32_16x16x64_bf16 v[20:23], v[48:51], v[56:63], v1
    ds_read_b128 v[56:59], v5 offset:28672
    v_smfmac_f32_16x16x64_bf16 v[24:27], v[48:51], a[104:111], v1
    ds_read_b128 v[60:63], v5 offset:29696
    s_waitcnt lgkmcnt(2)
    v_smfmac_f32_16x16x64_bf16 v[20:23], v[52:55], v[64:71], v1
    ds_read_b128 v[64:67], v5 offset:30720
    v_smfmac_f32_16x16x64_bf16 v[24:27], v[52:55], a[96:103], v1
    ds_read_b128 v[68:71], v5 offset:31744
    v_smfmac_f32_16x16x64_bf16 v[28:31], v[36:39], a[88:95], v1
    s_cmp_eq_u32 s57, 0
    s_cbranch_scc1 M_c0_0_first
M_c0_0_first_r:
    s_waitcnt lgkmcnt(2)
    v_smfmac_f32_16x16x64_bf16 v[32:35], v[36:39], v[56:63], v1
    ds_read_b128 v[56:59], v5 offset:32768
    v_permlane32_swap_b32 v20, v21
    v_smfmac_f32_16x16x64_bf16 v[28:31], v[40:43], a[80:87], v1
    ds_read_b128 v[60:63], v5 offset:33792
    s_waitcnt lgkmcnt(2)
    v_permlane32_swap_b32 v22, v23
    v_smfmac_f32_16x16x64_bf16 v[32:35], v[40:43], v[64:71], v1
    ds_read_b128 v[64:67], v0 offset:2048
    v_permlane32_swap_b32 v24, v25
    v_smfmac_f32_16x16x64_bf16 v[28:31], v[44:47], a[72:79], v1
    ds_read_b128 v[68:71], v0 offset:3072
    v_permlane32_swap_b32 v26, v27
    v_smfmac_f32_16x16x64_bf16 v[32:35], v[44:47], a[64:71], v1
    s_waitcnt lgkmcnt(2)
    v_add_f32 v20, v20, v21
    v_add_f32 v22, v22, v23
    v_smfmac_f32_16x16x64_bf16 v[28:31], v[48:51], v[56:63], v1
    ds_read_b128 v[56:59], v0 offset:0
    v_add_f32 v24, v24, v25
    v_add_f32 v26, v26, v27
    v_smfmac_f32_16x16x64_bf16 v[32:35], v[48:51], a[56:63], v1
    ds_read_b128 v[60:63], v0 offset:1024
    v_mul_f32 v20, s40, v20
    v_mul_f32 v24, s40, v24
    v_smfmac_f32_16x16x64_bf16 v[28:31], v[52:55], a[48:55], v1
    v_mul_f32 v22, s40, v22
    v_mul_f32 v26, s40, v26
    v_smfmac_f32_16x16x64_bf16 v[32:35], v[52:55], a[40:47], v1
    v_cvt_pk_bf16_f32 v20, v20, v24
    v_cvt_pk_bf16_f32 v21, v22, v26
    v_smfmac_f32_16x16x64_bf16 v[12:15], v[36:39], a[32:39], v1
    ds_write_b32 v2, v20 offset:18432
    v_smfmac_f32_16x16x64_bf16 v[16:19], v[36:39], a[24:31], v1
    ds_write_b32 v2, v21 offset:19008
    v_permlane32_swap_b32 v28, v29
    v_smfmac_f32_16x16x64_bf16 v[12:15], v[40:43], a[16:23], v1
    ds_read_b128 v[36:39], v6 offset:15360
    v_permlane32_swap_b32 v30, v31
    v_smfmac_f32_16x16x64_bf16 v[16:19], v[40:43], a[8:15], v1
    ds_read_b128 v[40:43], v6 offset:16384
    v_permlane32_swap_b32 v32, v33
    v_smfmac_f32_16x16x64_bf16 v[12:15], v[44:47], a[0:7], v1
    s_waitcnt lgkmcnt(2)
    s_barrier
    v_permlane32_swap_b32 v34, v35
    v_smfmac_f32_16x16x64_bf16 v[16:19], v[44:47], v[248:255], v1
    ds_read_b128 v[20:23], v3 offset:18432
    v_add_f32 v28, v28, v29
    v_add_f32 v30, v30, v31
    v_smfmac_f32_16x16x64_bf16 v[12:15], v[48:51], v[240:247], v1
    ds_read_b128 v[24:27], v3 offset:18496
    v_add_f32 v32, v32, v33
    v_add_f32 v34, v34, v35
    v_smfmac_f32_16x16x64_bf16 v[16:19], v[48:51], v[232:239], v1
    ds_read_b128 v[72:75], v3 offset:18560
    v_cvt_pk_bf16_f32 v28, v28, v32
    v_cvt_pk_bf16_f32 v29, v30, v34
    v_smfmac_f32_16x16x64_bf16 v[12:15], v[52:55], v[224:231], v1
    ds_write_b32 v2, v28 offset:20736
    ds_read_b128 v[44:47], v3 offset:18624
    v_smfmac_f32_16x16x64_bf16 v[16:19], v[52:55], v[216:223], v1
    ds_write_b32 v2, v29 offset:21312
    s_waitcnt lgkmcnt(7)
    v_smfmac_f32_16x16x64_bf16 v[12:15], v[36:39], v[208:215], v1
    ds_read_b128 v[48:51], v6 offset:17408
    v_mov_b64 v[10:11], s[16:17]
    v_smfmac_f32_16x16x64_bf16 v[16:19], v[36:39], v[200:207], v1
    s_waitcnt lgkmcnt(6)
    v_mfma_f32_16x16x32_bf16 v[28:31], v[56:59], v[20:23], 0
    ds_read_b128 v[56:59], v0 offset:4096
    s_waitcnt lgkmcnt(6)
    v_mfma_f32_16x16x32_bf16 v[28:31], v[60:63], v[24:27], v[28:31]
    ds_read_b128 v[60:63], v0 offset:5120
    s_waitcnt lgkmcnt(3)
    s_barrier
    v_mfma_f32_16x16x32_bf16 v[28:31], v[64:67], v[72:75], v[28:31]
    ds_read_b128 v[64:67], v0 offset:6144
    v_mfma_f32_16x16x32_bf16 v[28:31], v[68:71], v[44:47], v[28:31]
    ds_read_b128 v[68:71], v0 offset:7168
    v_smfmac_f32_16x16x64_bf16 v[12:15], v[40:43], v[192:199], v1
    ds_read_b128 v[36:39], v3 offset:20736
    v_smfmac_f32_16x16x64_bf16 v[16:19], v[40:43], v[184:191], v1
    ds_read_b128 v[52:55], v3 offset:20800
    s_waitcnt lgkmcnt(4)
    v_mfma_f32_16x16x32_bf16 v[32:35], v[56:59], v[20:23], 0
    s_nop 0
    v_exp_f32 v28, v28
    ds_read_b128 v[56:59], v3 offset:20864
    v_mfma_f32_16x16x32_bf16 v[32:35], v[60:63], v[24:27], v[32:35]
    s_waitcnt lgkmcnt(3)
    v_exp_f32 v29, v29
    ds_read_b128 v[60:63], v3 offset:20928
    v_mfma_f32_16x16x32_bf16 v[32:35], v[64:67], v[72:75], v[32:35]
    v_exp_f32 v30, v30
    v_mfma_f32_16x16x32_bf16 v[32:35], v[68:71], v[44:47], v[32:35]
    s_waitcnt lgkmcnt(3)
    v_exp_f32 v31, v31
    v_mfma_f32_16x16x32_bf16 v[40:43], v[36:39], v[20:23], 0
    s_waitcnt lgkmcnt(2)
    v_cvt_pk_bf16_f32 v28, v28, v29
    v_cvt_pk_bf16_f32 v29, v30, v31
    v_mfma_f32_16x16x32_bf16 v[40:43], v[52:55], v[24:27], v[40:43]
    s_waitcnt lgkmcnt(1)
    v_mov_b64 v[64:65], s[24:25]
    v_mov_b64 v[66:67], s[24:25]
    v_mfma_f32_16x16x32_bf16 v[40:43], v[56:59], v[72:75], v[40:43]
    s_waitcnt lgkmcnt(0)
    v_exp_f32 v32, v32
    v_mfma_f32_16x16x32_bf16 v[40:43], v[60:63], v[44:47], v[40:43]
    v_exp_f32 v33, v33
    v_smfmac_f32_16x16x64_bf16 v[12:15], v[48:51], v[176:183], v1
    v_exp_f32 v34, v34
    v_smfmac_f32_16x16x64_bf16 v[16:19], v[48:51], v[168:175], v1
    v_exp_f32 v35, v35
    v_cvt_pk_bf16_f32 v30, v32, v33
    v_cvt_pk_bf16_f32 v31, v34, v35
    s_nop 0
    v_exp_f32 v40, v40
    v_mfma_f32_16x16x32_bf16 v[72:75], v[64:67], v[28:31], 0
    v_exp_f32 v41, v41
    v_mfma_f32_16x16x32_bf16 v[20:23], v[80:83], v[28:31], 0
    v_exp_f32 v42, v42
    v_mfma_f32_16x16x32_bf16 v[24:27], v[84:87], v[28:31], 0
    v_exp_f32 v43, v43
    v_cvt_pk_bf16_f32 v40, v40, v41
    v_cvt_pk_bf16_f32 v41, v42, v43
    v_cvt_pk_bf16_f32 v12, v12, v13
    v_cvt_pk_bf16_f32 v13, v14, v15
    v_mfma_f32_16x16x16_bf16 v[72:75], v[10:11], v[40:41], v[72:75]
    v_cvt_pk_bf16_f32 v14, v16, v17
    v_cvt_pk_bf16_f32 v15, v18, v19
M_c0_0_fin:
    v_mfma_f32_16x16x16_bf16 v[20:23], v[12:13], v[40:41], v[20:23]
    s_cmp_eq_u32 s57, 63
    v_cndmask_b32_e64 v76, v12, v36, s[66:67]
    v_cndmask_b32_e64 v77, v13, v37, s[66:67]
    v_mfma_f32_16x16x16_bf16 v[24:27], v[14:15], v[40:41], v[24:27]
    v_cndmask_b32_e64 v78, v14, v38, s[66:67]
    v_cndmask_b32_e64 v79, v15, v39, s[66:67]
    s_cbranch_scc1 M_c0_0_last
    v_rcp_f32 v74, v72
    v_subrev_u32 v73, s68, v72
    v_cmp_lt_u32 vcc, s69, v73
    v_mov_b64 v[44:45], 0
    v_mov_b64 v[46:47], 0
    v_cndmask_b32_e64 v20, v20, v24, s[18:19]
    v_cndmask_b32_e64 v21, v21, v25, s[18:19]
    v_cndmask_b32_e64 v22, v22, v26, s[18:19]
    v_cndmask_b32_e64 v23, v23, v27, s[18:19]
    v_pk_mul_f32 v[20:21], v[20:21], v[74:75] op_sel_hi:[1,0]
    v_pk_mul_f32 v[22:23], v[22:23], v[74:75] op_sel_hi:[1,0]
    v_cvt_pk_bf16_f32 v20, v20, v21
    v_cvt_pk_bf16_f32 v21, v22, v23
    ds_write_b64 v0, v[20:21] offset:13312
    s_cbranch_vccnz M_c0_0_zbad
M_c0_0_zok:
    s_cmp_lt_u32 s54, s42
    s_cbranch_scc1 M_c0_0_first2
M_c0_0_first2_r:
    buffer_load_dwordx4 v[80:83], v0, s[8:11], s3 offen offset:0 sc1
    buffer_load_dwordx4 v[84:87], v0, s[8:11], s3 offen offset:1024 sc1
    s_waitcnt lgkmcnt(0)
    s_barrier
    ds_read_b128 v[32:35], v0 offset:13312
    ds_read_b128 v[52:55], v0 offset:14336
    s_mov_b32 m0, 0
    s_nop 0
    buffer_load_dwordx4 v0, s[8:11], s26 offen offset:0 sc1 lds
    buffer_load_dwordx4 v0, s[8:11], s26 offen offset:1024 sc1 lds
    v_mov_b64 v[68:69], 0
    v_mov_b64 v[70:71], 0
    v_mov_b64 v[64:65], 0
    v_mov_b64 v[66:67], 0
    v_mov_b64 v[60:61], 0
    v_mov_b64 v[62:63], 0
    v_mov_b64 v[56:57], 0
    v_mov_b64 v[58:59], 0
    s_waitcnt lgkmcnt(1)
    s_nop 0
    v_smfmac_f32_16x16x64_bf16 v[56:59], v[32:35], v[160:167], v1
    v_smfmac_f32_16x16x64_bf16 v[60:63], v[32:35], v[144:151], v1
    s_waitcnt lgkmcnt(0)
    v_smfmac_f32_16x16x64_bf16 v[56:59], v[52:55], v[152:159], v1
    v_smfmac_f32_16x16x64_bf16 v[60:63], v[52:55], v[136:143], v1
    v_smfmac_f32_16x16x64_bf16 v[64:67], v[32:35], v[128:135], v1
    v_smfmac_f32_16x16x64_bf16 v[68:71], v[32:35], v[112:119], v1
    v_permlane32_swap_b32 v56, v57
    v_smfmac_f32_16x16x64_bf16 v[64:67], v[52:55], v[120:127], v1
    v_permlane32_swap_b32 v58, v59
    v_smfmac_f32_16x16x64_bf16 v[68:71], v[52:55], v[104:111], v1
    v_add_f32 v56, v56, v57
    v_add_f32 v58, v58, v59
    v_smfmac_f32_16x16x64_bf16 v[44:47], v[32:35], v[96:103], v1
    v_permlane32_swap_b32 v60, v61
    v_smfmac_f32_16x16x64_bf16 v[44:47], v[52:55], v[88:95], v1
    v_permlane32_swap_b32 v62, v63
    v_add_f32 v60, v60, v61
    v_add_f32 v62, v62, v63
    v_cvt_pk_bf16_f32 v36, v56, v60
    v_cvt_pk_bf16_f32 v38, v58, v62
    v_permlane32_swap_b32 v64, v65
    v_permlane32_swap_b32 v66, v67
    v_add_f32 v64, v64, v65
    v_add_f32 v66, v66, v67
    v_permlane32_swap_b32 v68, v69
    v_permlane32_swap_b32 v70, v71
    v_add_f32 v68, v68, v69
    v_add_f32 v70, v70, v71
    v_cvt_pk_bf16_f32 v37, v64, v68
    v_cvt_pk_bf16_f32 v39, v66, v70
    buffer_store_dwordx4 v[36:39], v0, s[8:11], s58 offen
    v_permlane32_swap_b32 v44, v45
    v_permlane32_swap_b32 v46, v47
    v_add_f32 v44, v44, v45
    v_add_f32 v46, v46, v47
    v_cvt_pk_bf16_f32 v44, v44, v46
    buffer_store_dword v44, v7, s[8:11], s55 offen
    v_and_b32 v32, 16, v0
    v_bfe_u32 v33, v0, 5, 2
    v_lshlrev_b32_e64 v32, v32, s45
    v_cmp_eq_u32_e64 s[64:65], 0, v33
    v_cmp_eq_u32_e64 vcc, 1, v33
    s_add_u32 s27, s44, 1
    s_and_b32 s27, s27, 3
    v_cndmask_b32_e64 v72, 0, v32, s[64:65]
    v_cndmask_b32_e64 v73, 0, v32, vcc
    v_cmp_eq_u32_e64 s[64:65], 2, v33
    v_cmp_eq_u32_e64 vcc, 3, v33
    s_mul_i32 s48, s27, 5120
    s_add_u32 s48, s48, s41
    v_cndmask_b32_e64 v74, 0, v32, s[64:65]
    v_cndmask_b32_e64 v75, 0, v32, vcc
    s_lshl_b32 s27, s27, 15
    s_add_u32 s49, s27, s47
    v_bfe_u32 v11, v0, 4, 3
    v_lshlrev_b32 v11, 3, v11
    v_lshrrev_b32 v32, 8, v0
    v_lshl_add_u32 v11, v32, 6, v11
    s_add_u32 s56, s27, s46
    s_add_u32 s56, s56, s33
    s_add_u32 s58, s48, s33
    s_nop 15
    s_nop 15
    buffer_load_dwordx4 v[12:15], v8, s[8:11], s43 offen sc1
    buffer_load_dwordx4 v[16:19], v8, s[8:11], s61 offen sc1
    buffer_load_dwordx4 v[20:23], v8, s[8:11], s100 offen sc1
    buffer_load_dwordx4 v[24:27], v8, s[8:11], s101 offen sc1
    s_nop 15
    s_nop 11
    buffer_load_dwordx4 v[40:43], v8, s[8:11], s43 offen sc1
    buffer_load_dwordx4 v[44:47], v8, s[8:11], s61 offen sc1
    buffer_load_dwordx4 v[48:51], v8, s[8:11], s100 offen sc1
    buffer_load_dwordx4 v[52:55], v8, s[8:11], s101 offen sc1
    s_nop 7
    s_waitcnt vmcnt(7)
    v_mfma_f32_16x16x32_bf16 v[28:31], v[72:75], v[12:15], 0
    s_waitcnt vmcnt(6)
    v_mfma_f32_16x16x32_bf16 v[28:31], v[72:75], v[16:19], v[28:31]
    s_waitcnt vmcnt(5)
    v_mfma_f32_16x16x32_bf16 v[28:31], v[72:75], v[20:23], v[28:31]
    s_waitcnt vmcnt(4)
    v_mfma_f32_16x16x32_bf16 v[28:31], v[72:75], v[24:27], v[28:31]
    v_max3_u32 v32, v12, v16, v20
    v_max_u32 v32, v32, v24
    v_cmp_eq_u32 vcc, -1, v32
    s_cbranch_vccnz M_c0_0_wq1
    v_mov_b32 v5, v5
    v_mov_b32 v5, v5
    v_mov_b32 v5, v5
    v_mov_b32 v5, v5
    v_add_f32_dpp v28, v28, v28 row_ror:8 row_mask:0xf bank_mask:0xf
    v_add_f32_dpp v29, v29, v29 row_ror:8 row_mask:0xf bank_mask:0xf
    v_add_f32_dpp v30, v30, v30 row_ror:8 row_mask:0xf bank_mask:0xf
    v_add_f32_dpp v31, v31, v31 row_ror:8 row_mask:0xf bank_mask:0xf
    v_cmp_u_f32 vcc, v28, v28
    v_cvt_pk_bf16_f32 v28, v28, v29
    v_cvt_pk_bf16_f32 v29, v30, v31
    s_cbranch_vccnz M_c0_0_wrb_e0
    s_mov_b64 exec, s[38:39]
    buffer_store_dwordx2 v[28:29], v11, s[8:11], s58 offen
M_c0_0_wrb_d:
    s_barrier
    buffer_store_dwordx2 v[28:29], v11, s[8:11], s56 offen sc1
M_c0_0_wrb_g:
    s_mov_b64 exec, -1
    s_waitcnt vmcnt(2)
    ds_read_b128 v[56:59], v5 offset:0
    ds_read_b128 v[60:63], v5 offset:1024
    ds_read_b128 v[64:67], v5 offset:2048
    ds_read_b128 v[68:71], v5 offset:3072
    v_mov_b64 v[12:13], 0
    v_mov_b64 v[14:15], 0
    v_mov_b64 v[16:17], 0
    v_mov_b64 v[18:19], 0
    v_mov_b64 v[20:21], 0
    v_mov_b64 v[22:23], 0
    v_mov_b64 v[24:25], 0
    v_mov_b64 v[26:27], 0
    v_mov_b64 v[28:29], 0
    v_mov_b64 v[30:31], 0
    v_mov_b64 v[32:33], 0
    v_mov_b64 v[34:35], 0
    ds_read_b64 v[36:37], v0 offset:23296
    s_waitcnt lgkmcnt(0)
    v_min_u32 v36, v36, v37
    s_nop 0
    v_readfirstlane_b32 s28, v36
    s_nop 0
    s_max_u32 s54, s54, s28
    s_and_b32 s26, s44, 63
    s_add_u32 s26, s26, 2
    s_min_u32 s26, s26, 63
    s_lshl_b32 s26, s26, 18
    s_add_u32 s26, s26, s50
    s_add_u32 s3, s26, 16777216
    s_lshl_b32 s4, s44, 18
    s_add_u32 s4, s4, s53
    v_mov_b64 v[72:73], -1
    v_mov_b64 v[74:75], -1
    s_add_u32 s28, s44, 3
    s_and_b32 s29, s28, 3
    s_mul_i32 s31, s22, 160
    s_mul_i32 s28, s29, 167936
    s_add_u32 s28, s28, s34
    s_add_u32 s64, s28, s35
    s_mul_i32 s65, s29, 5120
    s_add_u32 s65, s65, s41
    s_add_u32 s65, s65, s31
    s_lshl_b32 s60, s29, 15
    s_add_u32 s60, s60, s47
    s_add_u32 s60, s60, s31
    s_add_u32 s44, s44, 1
    s_and_b32 s55, s44, 3
    s_mul_i32 s55, s55, 167936
    s_add_u32 s55, s55, s34
    s_add_u32 s58, s55, s35
    s_and_b32 s57, s44, 63
    s_add_u32 s43, s55, s32
    s_add_u32 s61, s43, 33792
    s_add_u32 s100, s43, 67584
    s_add_u32 s101, s43, 101376
    s_add_u32 s42, s44, 2
    s_or_b32 s28, s44, 63
    s_add_u32 s28, s28, 1
    s_min_u32 s42, s42, s28
    s_nop 15
    s_nop 15
    s_nop 1
    buffer_store_dwordx4 v[72:75], v0, s[8:11], s64 offen offset:0
    buffer_store_dwordx4 v[72:75], v0, s[8:11], s64 offen offset:1024
    s_mov_b64 exec, 0x3ff
    buffer_store_dwordx4 v[72:75], v0, s[8:11], s65 offen
    s_mov_b64 exec, -1
    s_mov_b32 s65, 0x10000000
    s_mov_b32 s64, 0x10000000
    s_mov_b32 s70, 0
    s_branch M_c0_0_top
M_c0_0_restart:
    s_waitcnt vmcnt(0) lgkmcnt(0)
    s_nop 7
    s_barrier
    ds_read_b128 v[56:59], v5 offset:0
    ds_read_b128 v[60:63], v5 offset:1024
    ds_read_b128 v[64:67], v5 offset:2048
    ds_read_b128 v[68:71], v5 offset:3072
    v_mov_b64 v[12:13], 0
    v_mov_b64 v[14:15], 0
    v_mov_b64 v[16:17], 0
    v_mov_b64 v[18:19], 0
    v_mov_b64 v[20:21], 0
    v_mov_b64 v[22:23], 0
    v_mov_b64 v[24:25], 0
    v_mov_b64 v[26:27], 0
    v_mov_b64 v[28:29], 0
    v_mov_b64 v[30:31], 0
    v_mov_b64 v[32:33], 0
    v_mov_b64 v[34:35], 0
    s_waitcnt vmcnt(0) lgkmcnt(0)
    s_branch M_c0_0_top
M_c0_0_zbad:
    s_cmp_eq_u32 s70, 2
    s_cbranch_scc1 M_c0_0_zok
    v_cmp_u_f32 vcc, v72, v72
    s_cbranch_vccz M_c0_0_exact
    s_cmp_eq_u32 s70, 1
    s_cbranch_scc1 M_c0_0_exact
M_c0_0_vfy0:
    s_mov_b32 s70, 1
    s_mov_b32 s30, 0
    s_waitcnt vmcnt(0) lgkmcnt(0)
    s_nop 7
M_c0_0_vfy:
    v_mov_b32 v10, 0
    s_add_u32 s59, s48, 4096
    buffer_load_dwordx4 v[36:39], v0, s[8:11], s48 offen offset:0 sc1
    buffer_load_dwordx4 v[40:43], v0, s[8:11], s48 offen offset:1024 sc1
    buffer_load_dwordx4 v[44:47], v0, s[8:11], s48 offen offset:2048 sc1
    buffer_load_dwordx4 v[48:51], v0, s[8:11], s48 offen offset:3072 sc1
    buffer_load_dwordx4 v[52:55], v0, s[8:11], s59 offen offset:0 sc1
    s_waitcnt vmcnt(4)
    v_max3_u32 v10, v10, v36, v37
    v_max3_u32 v10, v10, v38, v39
    s_waitcnt vmcnt(3)
    v_max3_u32 v10, v10, v40, v41
    v_max3_u32 v10, v10, v42, v43
    s_waitcnt vmcnt(2)
    v_max3_u32 v10, v10, v44, v45
    v_max3_u32 v10, v10, v46, v47
    s_waitcnt vmcnt(1)
    v_max3_u32 v10, v10, v48, v49
    v_max3_u32 v10, v10, v50, v51
    s_waitcnt vmcnt(0)
    v_max3_u32 v10, v10, v52, v53
    v_max3_u32 v10, v10, v54, v55
    s_add_u32 s59, s49, 4096
    buffer_load_dwordx4 v[36:39], v0, s[8:11], s49 offen offset:0 sc1
    buffer_load_dwordx4 v[40:43], v0, s[8:11], s49 offen offset:1024 sc1
    buffer_load_dwordx4 v[44:47], v0, s[8:11], s49 offen offset:2048 sc1
    buffer_load_dwordx4 v[48:51], v0, s[8:11], s49 offen offset:3072 sc1
    buffer_load_dwordx4 v[52:55], v0, s[8:11], s59 offen offset:0 sc1
    s_waitcnt vmcnt(4)
    v_max3_u32 v10, v10, v36, v37
    v_max3_u32 v10, v10, v38, v39
    s_waitcnt vmcnt(3)
    v_max3_u32 v10, v10, v40, v41
    v_max3_u32 v10, v10, v42, v43
    s_waitcnt vmcnt(2)
    v_max3_u32 v10, v10, v44, v45
    v_max3_u32 v10, v10, v46, v47
    s_waitcnt vmcnt(1)
    v_max3_u32 v10, v10, v48, v49
    v_max3_u32 v10, v10, v50, v51
    s_waitcnt vmcnt(0)
    v_max3_u32 v10, v10, v52, v53
    v_max3_u32 v10, v10, v54, v55
    v_cmp_eq_u32 vcc, -1, v10
    s_cbranch_vccz M_c0_0_restart
    s_add_u32 s30, s30, 1
    s_cmp_ge_u32 s30, 60000
    s_cbranch_scc1 M_fail
    s_branch M_c0_0_vfy
M_c0_0_exact:
    s_nop 7
    s_mov_b32 s70, 2
    s_waitcnt lgkmcnt(0)
    ds_read_b128 v[20:23], v3 offset:18432
    ds_read_b128 v[24:27], v3 offset:18496
    ds_read_b128 v[72:75], v3 offset:18560
    ds_read_b128 v[44:47], v3 offset:18624
    ds_read_b128 v[56:59], v0 offset:0
    s_waitcnt lgkmcnt(0)
    v_mfma_f32_16x16x32_bf16 v[28:31], v[56:59], v[20:23], 0
    s_nop 3
    ds_read_b128 v[60:63], v0 offset:1024
    s_waitcnt lgkmcnt(0)
    v_mfma_f32_16x16x32_bf16 v[28:31], v[60:63], v[24:27], v[28:31]
    s_nop 3
    ds_read_b128 v[56:59], v0 offset:2048
    s_waitcnt lgkmcnt(0)
    v_mfma_f32_16x16x32_bf16 v[28:31], v[56:59], v[72:75], v[28:31]
    s_nop 3
    ds_read_b128 v[60:63], v0 offset:3072
    s_waitcnt lgkmcnt(0)
    v_mfma_f32_16x16x32_bf16 v[28:31], v[60:63], v[44:47], v[28:31]
    s_nop 3
    ds_read_b128 v[56:59], v0 offset:4096
    s_waitcnt lgkmcnt(0)
    v_mfma_f32_16x16x32_bf16 v[32:35], v[56:59], v[20:23], 0
    s_nop 3
    ds_read_b128 v[60:63], v0 offset:5120
    s_waitcnt lgkmcnt(0)
    v_mfma_f32_16x16x32_bf16 v[32:35], v[60:63], v[24:27], v[32:35]
    s_nop 3
    ds_read_b128 v[56:59], v0 offset:6144
    s_waitcnt lgkmcnt(0)
    v_mfma_f32_16x16x32_bf16 v[32:35], v[56:59], v[72:75], v[32:35]
    s_nop 3
    ds_read_b128 v[60:63], v0 offset:7168
    s_waitcnt lgkmcnt(0)
    v_mfma_f32_16x16x32_bf16 v[32:35], v[60:63], v[44:47], v[32:35]
    s_nop 3
    ds_read_b128 v[56:59], v3 offset:20736
    s_waitcnt lgkmcnt(0)
    v_mfma_f32_16x16x32_bf16 v[40:43], v[56:59], v[20:23], 0
    s_nop 3
    ds_read_b128 v[60:63], v3 offset:20800
    s_waitcnt lgkmcnt(0)
    v_mfma_f32_16x16x32_bf16 v[40:43], v[60:63], v[24:27], v[40:43]
    s_nop 3
    ds_read_b128 v[56:59], v3 offset:20864
    s_waitcnt lgkmcnt(0)
    v_mfma_f32_16x16x32_bf16 v[40:43], v[56:59], v[72:75], v[40:43]
    s_nop 3
    ds_read_b128 v[60:63], v3 offset:20928
    s_waitcnt lgkmcnt(0)
    v_mfma_f32_16x16x32_bf16 v[40:43], v[60:63], v[44:47], v[40:43]
    s_nop 3
    v_max3_f32 v68, v28, v29, v30
    v_max3_f32 v68, v68, v31, v32
    v_max3_f32 v68, v68, v33, v34
    s_nop 0
    v_max3_f32 v68, v68, v35, v40
    v_max3_f32 v68, v68, v41, v42
    v_max_f32 v68, v68, v43
    v_mov_b32 v69, v68
    s_nop 1
    v_permlane16_swap_b32 v68, v69
    v_max_f32 v68, v68, v69
    v_mov_b32 v69, v68
    s_nop 1
    v_permlane32_swap_b32 v68, v69
    v_max_f32 v68, v68, v69
    v_sub_f32 v28, v28, v68
    v_exp_f32 v28, v28
    v_sub_f32 v29, v29, v68
    v_exp_f32 v29, v29
    v_sub_f32 v30, v30, v68
    v_exp_f32 v30, v30
    v_sub_f32 v31, v31, v68
    v_exp_f32 v31, v31
    v_sub_f32 v32, v32, v68
    v_exp_f32 v32, v32
    v_sub_f32 v33, v33, v68
    v_exp_f32 v33, v33
    v_sub_f32 v34, v34, v68
    v_exp_f32 v34, v34
    v_sub_f32 v35, v35, v68
    v_exp_f32 v35, v35
    v_sub_f32 v40, v40, v68
    v_exp_f32 v40, v40
    v_sub_f32 v41, v41, v68
    v_exp_f32 v41, v41
    v_sub_f32 v42, v42, v68
    v_exp_f32 v42, v42
    v_sub_f32 v43, v43, v68
    v_exp_f32 v43, v43
    v_cvt_pk_bf16_f32 v28, v28, v29
    v_cvt_pk_bf16_f32 v29, v30, v31
    v_cvt_pk_bf16_f32 v30, v32, v33
    v_cvt_pk_bf16_f32 v31, v34, v35
    v_cvt_pk_bf16_f32 v40, v40, v41
    v_cvt_pk_bf16_f32 v41, v42, v43
    v_mfma_f32_16x16x32_bf16 v[20:23], v[80:83], v[28:31], 0
    v_mfma_f32_16x16x32_bf16 v[24:27], v[84:87], v[28:31], 0
    v_mfma_f32_16x16x32_bf16 v[72:75], v[64:67], v[28:31], 0
    ds_read_b128 v[36:39], v3 offset:20736
    s_waitcnt lgkmcnt(0)
    s_nop 7
    v_mfma_f32_16x16x16_bf16 v[72:75], v[10:11], v[40:41], v[72:75]
    s_nop 7
    s_branch M_c0_0_fin
M_c0_0_last:
    s_cmp_lg_u32 s70, 0
    s_cbranch_scc1 M_c0_0_last2
    v_cmp_u_f32 vcc, v32, v32
    s_cbranch_vccnz M_c0_0_vfy0
M_c0_0_last2:
    s_lshl_b32 s4, s44, 18
    s_add_u32 s4, s4, s53
    buffer_store_dwordx4 v[76:79], v0, s[8:11], s4 offen offset:0 sc1
    s_mov_b32 s4, 0x10000000
    s_waitcnt vmcnt(0) lgkmcnt(0)
    s_barrier
    s_nop 7
    v_mov_b64 v[72:73], -1
    v_mov_b64 v[74:75], -1
    s_add_u32 s28, s44, 3
    s_and_b32 s29, s28, 3
    s_mul_i32 s31, s22, 160
    s_mul_i32 s28, s29, 167936
    s_add_u32 s28, s28, s34
    s_add_u32 s64, s28, s35
    s_mul_i32 s65, s29, 5120
    s_add_u32 s65, s65, s41
    s_add_u32 s65, s65, s31
    s_lshl_b32 s60, s29, 15
    s_add_u32 s60, s60, s47
    s_add_u32 s60, s60, s31
    buffer_store_dwordx4 v[72:75], v0, s[8:11], s64 offen offset:0
    buffer_store_dwordx4 v[72:75], v0, s[8:11], s64 offen offset:1024
    s_mov_b64 exec, 0x3ff
    buffer_store_dwordx4 v[72:75], v0, s[8:11], s65 offen
    s_mov_b64 exec, -1
    s_mov_b32 s65, 0x10000000
    s_mov_b32 s64, 0x10000000
    s_mov_b64 exec, 0x3ff
    buffer_store_dwordx4 v[72:75], v0, s[8:11], s60 offen sc1
    s_mov_b64 exec, -1
    s_mov_b32 s60, 0x10000000
    s_waitcnt vmcnt(0)
    s_add_u32 s44, s44, 1
    s_branch M_c_fft
    s_cmp_eq_u32 s44, 128
    s_cbranch_scc1 M_end
    s_branch M_c0_0_layer
M_c0_0_lr:
    s_mov_b32 s30, 0
M_c0_0_lr_l:
    s_waitcnt lgkmcnt(0)
    ds_read_b128 v[36:39], v6 offset:13312
    ds_read_b128 v[40:43], v6 offset:14336
    ds_read_b128 v[44:47], v6 offset:15360
    ds_read_b128 v[48:51], v6 offset:16384
    ds_read_b128 v[52:55], v6 offset:17408
    s_waitcnt lgkmcnt(2)
    v_max3_u32 v10, v36, v40, v44
    s_waitcnt lgkmcnt(0)
    v_max3_u32 v10, v10, v48, v52
    v_cmp_eq_u32 vcc, -1, v10
    s_cbranch_vccz M_c0_0_lr_d
    s_add_u32 s30, s30, 1
    s_cmp_ge_u32 s30, 480000
    s_cbranch_scc1 M_fail
    s_branch M_c0_0_lr_l
M_c0_0_lr_d:
    ds_read_b128 v[56:59], v5 offset:0
    ds_read_b128 v[60:63], v5 offset:1024
    ds_read_b128 v[64:67], v5 offset:2048
    ds_read_b128 v[68:71], v5 offset:3072
    v_mov_b64 v[12:13], 0
    v_mov_b64 v[14:15], 0
    v_mov_b64 v[16:17], 0
    v_mov_b64 v[18:19], 0
    v_mov_b64 v[20:21], 0
    v_mov_b64 v[22:23], 0
    v_mov_b64 v[24:25], 0
    v_mov_b64 v[26:27], 0
    v_mov_b64 v[28:29], 0
    v_mov_b64 v[30:31], 0
    v_mov_b64 v[32:33], 0
    v_mov_b64 v[34:35], 0
    s_waitcnt lgkmcnt(0)
    s_branch M_c0_0_lr_r
M_c0_0_rr:
    s_mov_b32 s30, 0
M_c0_0_rr_l:
    s_waitcnt lgkmcnt(0)
    s_and_b32 s27, s30, 1
    s_cbranch_scc1 M_c0_0_rr_n
    s_waitcnt vmcnt(2)
    s_mov_b32 m0, 8192
    s_nop 0
    buffer_load_dwordx4 v0, s[8:11], s49 offen offset:0 sc1 lds
    buffer_load_dwordx4 v0, s[8:11], s49 offen offset:1024 sc1 lds
M_c0_0_rr_n:
    ds_read_b128 v[36:39], v6 offset:8192
    ds_read_b128 v[40:43], v6 offset:9216
    ds_read_b128 v[44:47], v6 offset:10240
    ds_read_b128 v[48:51], v6 offset:11264
    ds_read_b32 v11, v6 offset:12288
    s_waitcnt lgkmcnt(2)
    v_max3_u32 v10, v36, v40, v44
    s_waitcnt lgkmcnt(0)
    v_max3_u32 v10, v10, v48, v11
    v_cmp_eq_u32 vcc, -1, v10
    s_cbranch_vccz M_c0_0_rr_d
    s_add_u32 s30, s30, 1
    s_cmp_ge_u32 s30, 480000
    s_cbranch_scc1 M_fail
    s_branch M_c0_0_rr_l
M_c0_0_rr_d:
    s_branch M_c0_0_rr_r
M_c0_0_first:
    s_mul_i32 s27, s21, 167936
    s_add_u32 s27, s27, s34
    s_mul_i32 s28, s22, 4224
    s_add_u32 s28, s28, s27
    s_mov_b32 exec_hi, 0
    buffer_load_dword v10, v9, s[8:11], s28 offen sc1
    s_lshl_b32 s28, s22, 10
    s_add_u32 s28, s28, s27
    s_add_u32 s28, s28, 135168
    s_mov_b64 exec, 0xff
    buffer_load_dword v10, v9, s[8:11], s28 offen sc1
    s_mul_i32 s27, s21, 5120
    s_add_u32 s27, s27, s41
    s_mul_i32 s28, s22, 160
    s_add_u32 s28, s28, s27
    s_mov_b64 exec, 3
    buffer_load_dword v10, v9, s[8:11], s28 offen sc1
    s_mov_b64 exec, -1
    s_barrier
    s_and_b32 s26, s44, 63
    s_lshl_b32 s26, s26, 18
    s_add_u32 s26, s26, s50
    s_add_u32 s3, s26, 16777216
    s_mov_b32 m0, 0
    s_nop 0
    buffer_load_dwordx4 v0, s[8:11], s26 offen offset:0 sc1 lds
    buffer_load_dwordx4 v0, s[8:11], s26 offen offset:1024 sc1 lds
    buffer_load_dwordx4 v[80:83], v0, s[8:11], s3 offen offset:0 sc1
    buffer_load_dwordx4 v[84:87], v0, s[8:11], s3 offen offset:1024 sc1
    s_and_b32 s26, s44, 63
    s_add_u32 s26, s26, 1
    s_min_u32 s26, s26, 63
    s_lshl_b32 s26, s26, 18
    s_add_u32 s26, s26, s50
    s_add_u32 s3, s26, 16777216
    s_waitcnt vmcnt(0) lgkmcnt(0)
    s_barrier
    s_branch M_c0_0_first_r
M_c0_0_first2:
    ds_read_b64 v[10:11], v0 offset:23296
    s_waitcnt lgkmcnt(0)
    v_min_u32 v10, v10, v11
    s_nop 0
    v_readfirstlane_b32 s28, v10
    s_nop 0
    s_max_u32 s54, s54, s28
    s_add_u32 s27, s44, 2
    s_or_b32 s28, s44, 63
    s_add_u32 s28, s28, 1
    s_min_u32 s27, s27, s28
    s_cmp_lt_u32 s54, s27
    s_cbranch_scc1 M_c0_0_p2
M_c0_0_p2_r:
    s_branch M_c0_0_first2_r
M_c0_0_wq1:
    buffer_load_dwordx4 v[12:15], v8, s[8:11], s43 offen sc1
    buffer_load_dwordx4 v[16:19], v8, s[8:11], s61 offen sc1
    buffer_load_dwordx4 v[20:23], v8, s[8:11], s100 offen sc1
    buffer_load_dwordx4 v[24:27], v8, s[8:11], s101 offen sc1
    s_waitcnt vmcnt(7)
    v_mfma_f32_16x16x32_bf16 v[28:31], v[72:75], v[40:43], 0
    s_waitcnt vmcnt(6)
    v_mfma_f32_16x16x32_bf16 v[28:31], v[72:75], v[44:47], v[28:31]
    s_waitcnt vmcnt(5)
    v_mfma_f32_16x16x32_bf16 v[28:31], v[72:75], v[48:51], v[28:31]
    s_waitcnt vmcnt(4)
    v_mfma_f32_16x16x32_bf16 v[28:31], v[72:75], v[52:55], v[28:31]
    v_max3_u32 v32, v40, v44, v48
    v_max_u32 v32, v32, v52
    v_cmp_eq_u32 vcc, -1, v32
    s_cbranch_vccnz M_c0_0_wqx
    v_mov_b32 v5, v5
    v_mov_b32 v5, v5
    v_mov_b32 v5, v5
    v_mov_b32 v5, v5
    v_add_f32_dpp v28, v28, v28 row_ror:8 row_mask:0xf bank_mask:0xf
    v_add_f32_dpp v29, v29, v29 row_ror:8 row_mask:0xf bank_mask:0xf
    v_add_f32_dpp v30, v30, v30 row_ror:8 row_mask:0xf bank_mask:0xf
    v_add_f32_dpp v31, v31, v31 row_ror:8 row_mask:0xf bank_mask:0xf
    v_cmp_u_f32 vcc, v28, v28
    v_cvt_pk_bf16_f32 v28, v28, v29
    v_cvt_pk_bf16_f32 v29, v30, v31
    s_cbranch_vccnz M_c0_0_wqe1
    s_mov_b64 exec, s[38:39]
    buffer_store_dwordx2 v[28:29], v11, s[8:11], s58 offen
    s_barrier
    buffer_store_dwordx2 v[28:29], v11, s[8:11], s56 offen sc1
    s_branch M_c0_0_wrb_g
M_c0_0_wqx:
    s_branch M_c0_0_wrb_i1
M_c0_0_wqe1:
    s_waitcnt vmcnt(0)
    buffer_load_dwordx4 v[12:15], v8, s[8:11], s43 offen sc1
    buffer_load_dwordx4 v[16:19], v8, s[8:11], s61 offen sc1
    buffer_load_dwordx4 v[20:23], v8, s[8:11], s100 offen sc1
    buffer_load_dwordx4 v[24:27], v8, s[8:11], s101 offen sc1
    s_branch M_c0_0_wrb_e1
M_c0_0_wrb_l:
    s_waitcnt vmcnt(4)
    v_mfma_f32_16x16x32_bf16 v[28:31], v[72:75], v[12:15], 0
    v_mfma_f32_16x16x32_bf16 v[28:31], v[72:75], v[16:19], v[28:31]
    v_mfma_f32_16x16x32_bf16 v[28:31], v[72:75], v[20:23], v[28:31]
    v_mfma_f32_16x16x32_bf16 v[28:31], v[72:75], v[24:27], v[28:31]
    v_max3_u32 v32, v12, v16, v20
    v_max_u32 v32, v32, v24
    v_cmp_eq_u32 vcc, -1, v32
    s_cbranch_vccz M_c0_0_wrb_x0
M_c0_0_wrb_i0:
    buffer_load_dwordx4 v[12:15], v8, s[8:11], s43 offen sc1
    buffer_load_dwordx4 v[16:19], v8, s[8:11], s61 offen sc1
    buffer_load_dwordx4 v[20:23], v8, s[8:11], s100 offen sc1
    buffer_load_dwordx4 v[24:27], v8, s[8:11], s101 offen sc1
    s_waitcnt vmcnt(4)
    v_mfma_f32_16x16x32_bf16 v[28:31], v[72:75], v[40:43], 0
    v_mfma_f32_16x16x32_bf16 v[28:31], v[72:75], v[44:47], v[28:31]
    v_mfma_f32_16x16x32_bf16 v[28:31], v[72:75], v[48:51], v[28:31]
    v_mfma_f32_16x16x32_bf16 v[28:31], v[72:75], v[52:55], v[28:31]
    v_max3_u32 v32, v40, v44, v48
    v_max_u32 v32, v32, v52
    v_cmp_eq_u32 vcc, -1, v32
    s_cbranch_vccz M_c0_0_wrb_x1
M_c0_0_wrb_i1:
    buffer_load_dwordx4 v[40:43], v8, s[8:11], s43 offen sc1
    buffer_load_dwordx4 v[44:47], v8, s[8:11], s61 offen sc1
    buffer_load_dwordx4 v[48:51], v8, s[8:11], s100 offen sc1
    buffer_load_dwordx4 v[52:55], v8, s[8:11], s101 offen sc1
    s_add_u32 s71, s71, 1
    s_cmp_lt_u32 s71, 240000
    s_cbranch_scc1 M_c0_0_wrb_l
    s_branch M_fail
M_c0_0_wrb_x0:
    s_nop 3
    v_add_f32_dpp v28, v28, v28 row_ror:8 row_mask:0xf bank_mask:0xf
    v_add_f32_dpp v29, v29, v29 row_ror:8 row_mask:0xf bank_mask:0xf
    v_add_f32_dpp v30, v30, v30 row_ror:8 row_mask:0xf bank_mask:0xf
    v_add_f32_dpp v31, v31, v31 row_ror:8 row_mask:0xf bank_mask:0xf
    v_cmp_u_f32 vcc, v28, v28
    v_cvt_pk_bf16_f32 v28, v28, v29
    v_cvt_pk_bf16_f32 v29, v30, v31
    s_cbranch_vccz M_c0_0_wrb_n
M_c0_0_wrb_e0:
    v_max3_u32 v32, v12, v13, v14
    v_max3_u32 v32, v32, v15, v16
    v_max3_u32 v32, v32, v17, v18
    v_max3_u32 v32, v32, v19, v20
    v_max3_u32 v32, v32, v21, v22
    v_max3_u32 v32, v32, v23, v24
    v_max3_u32 v32, v32, v25, v26
    v_max_u32 v32, v32, v27
    v_cmp_eq_u32 vcc, -1, v32
    s_cbranch_vccnz M_c0_0_wrb_i0
    v_min_u32 v28, -2, v28
    v_min_u32 v29, -2, v29
    s_branch M_c0_0_wrb_n
M_c0_0_wrb_x1:
    s_nop 3
    v_add_f32_dpp v28, v28, v28 row_ror:8 row_mask:0xf bank_mask:0xf
    v_add_f32_dpp v29, v29, v29 row_ror:8 row_mask:0xf bank_mask:0xf
    v_add_f32_dpp v30, v30, v30 row_ror:8 row_mask:0xf bank_mask:0xf
    v_add_f32_dpp v31, v31, v31 row_ror:8 row_mask:0xf bank_mask:0xf
    v_cmp_u_f32 vcc, v28, v28
    v_cvt_pk_bf16_f32 v28, v28, v29
    v_cvt_pk_bf16_f32 v29, v30, v31
    s_cbranch_vccz M_c0_0_wrb_n
M_c0_0_wrb_e1:
    v_max3_u32 v32, v40, v41, v42
    v_max3_u32 v32, v32, v43, v44
    v_max3_u32 v32, v32, v45, v46
    v_max3_u32 v32, v32, v47, v48
    v_max3_u32 v32, v32, v49, v50
    v_max3_u32 v32, v32, v51, v52
    v_max3_u32 v32, v32, v53, v54
    v_max_u32 v32, v32, v55
    v_cmp_eq_u32 vcc, -1, v32
    s_cbranch_vccnz M_c0_0_wrb_i1
    v_min_u32 v28, -2, v28
    v_min_u32 v29, -2, v29
M_c0_0_wrb_n:
    s_mov_b64 exec, s[38:39]
    buffer_store_dwordx2 v[28:29], v11, s[8:11], s58 offen
    s_branch M_c0_0_wrb_d
M_c0_0_p2:
    s_mov_b32 s30, 0
M_c0_0_p2_l:
    s_waitcnt lgkmcnt(0)
    s_mov_b64 exec, 3
    buffer_load_dword v10, v9, s[8:11], s51 offen sc1
    s_waitcnt vmcnt(0)
    s_mov_b64 exec, -1
    v_readlane_b32 s54, v10, 0
    v_readlane_b32 s28, v10, 1
    s_nop 3
    s_min_u32 s54, s54, s28
    s_cmp_ge_u32 s54, s27
    s_cbranch_scc1 M_c0_0_p2_r
    s_sleep 2
    s_add_u32 s30, s30, 1
    s_cmp_ge_u32 s30, 240000
    s_cbranch_scc1 M_fail
    s_branch M_c0_0_p2_l
M_c0_1_layer:
    s_lshr_b32 s27, s44, 6
    s_mul_i32 s50, s27, 33554432
    s_lshl_b32 s27, s22, 13
    s_add_u32 s50, s50, s27
    s_add_u32 s50, s50, 37748736
    s_barrier
    s_mov_b32 s26, 0x10010000
    s_mov_b32 s3, s26
    s_mul_i32 s27, s20, 5120
    s_add_u32 s48, s27, 167772160
    s_sub_u32 s49, 167777280, s27
    s_and_b32 s55, s44, 3
    s_mul_i32 s55, s55, 167936
    s_add_u32 s55, s55, s34
    s_add_u32 s58, s55, s35
    s_and_b32 s57, s44, 63
    s_add_u32 s43, s55, s32
    s_sub_u32 s27, s57, 1
    s_max_i32 s27, s27, 0
    s_lshl_b64 s[100:101], 1, s27
    s_lshl_b32 s27, s27, 7
    s_sub_u32 s61, s52, s27
    s_add_u32 s42, s44, 2
    s_or_b32 s28, s44, 63
    s_add_u32 s28, s28, 1
    s_min_u32 s42, s42, s28
    ds_read_b128 v[56:59], v5 offset:0
    ds_read_b128 v[60:63], v5 offset:1024
    ds_read_b128 v[64:67], v5 offset:2048
    ds_read_b128 v[68:71], v5 offset:3072
    v_mov_b64 v[12:13], 0
    v_mov_b64 v[14:15], 0
    v_mov_b64 v[16:17], 0
    v_mov_b64 v[18:19], 0
    v_mov_b64 v[20:21], 0
    v_mov_b64 v[22:23], 0
    v_mov_b64 v[24:25], 0
    v_mov_b64 v[26:27], 0
    v_mov_b64 v[28:29], 0
    v_mov_b64 v[30:31], 0
    v_mov_b64 v[32:33], 0
    v_mov_b64 v[34:35], 0
    s_mov_b32 s70, 0
    s_waitcnt lgkmcnt(0)
M_c0_1_top:
    s_nop 0
    s_barrier
    ds_read_b128 v[36:39], v6 offset:13312
    ds_read_b128 v[40:43], v6 offset:14336
    s_mov_b32 m0, 8192
    s_nop 0
    buffer_load_dwordx4 v0, s[8:11], s49 offen offset:2048 sc1 lds
M_c0_1_lr_r:
    s_waitcnt lgkmcnt(1)
    v_smfmac_f32_16x16x64_bf16 v[20:23], v[36:39], v[56:63], v1
    ds_read_b128 v[56:59], v5 offset:4096
    v_smfmac_f32_16x16x64_bf16 v[24:27], v[36:39], v[64:71], v1
    ds_read_b128 v[60:63], v5 offset:5120
    v_smfmac_f32_16x16x64_bf16 v[28:31], v[36:39], a[248:255], v1
    ds_read_b128 v[64:67], v5 offset:6144
    v_smfmac_f32_16x16x64_bf16 v[32:35], v[36:39], a[240:247], v1
    ds_read_b128 v[68:71], v5 offset:7168
    v_smfmac_f32_16x16x64_bf16 v[12:15], v[36:39], a[232:239], v1
    ds_read_b128 v[44:47], v6 offset:15360
    s_waitcnt lgkmcnt(3)
    v_smfmac_f32_16x16x64_bf16 v[16:19], v[36:39], v[56:63], v1
    ds_read_b128 v[56:59], v5 offset:8192
    v_smfmac_f32_16x16x64_bf16 v[20:23], v[40:43], a[224:231], v1
    ds_read_b128 v[60:63], v5 offset:9216
    s_waitcnt lgkmcnt(3)
    v_smfmac_f32_16x16x64_bf16 v[24:27], v[40:43], v[64:71], v1
    ds_read_b128 v[64:67], v5 offset:10240
    v_smfmac_f32_16x16x64_bf16 v[28:31], v[40:43], a[216:223], v1
    ds_read_b128 v[68:71], v5 offset:11264
    v_smfmac_f32_16x16x64_bf16 v[32:35], v[40:43], a[208:215], v1
    ds_read_b128 v[48:51], v6 offset:16384
    s_waitcnt lgkmcnt(3)
    v_smfmac_f32_16x16x64_bf16 v[12:15], v[40:43], v[56:63], v1
    ds_read_b128 v[56:59], v5 offset:12288
    v_smfmac_f32_16x16x64_bf16 v[16:19], v[40:43], a[200:207], v1
    ds_read_b128 v[60:63], v5 offset:13312
    s_waitcnt lgkmcnt(3)
    v_smfmac_f32_16x16x64_bf16 v[20:23], v[44:47], v[64:71], v1
    ds_read_b128 v[64:67], v5 offset:14336
    v_smfmac_f32_16x16x64_bf16 v[24:27], v[44:47], a[192:199], v1
    ds_read_b128 v[68:71], v5 offset:15360
    v_smfmac_f32_16x16x64_bf16 v[28:31], v[44:47], a[184:191], v1
    ds_read_b128 v[52:55], v6 offset:17408
    s_waitcnt lgkmcnt(3)
    v_smfmac_f32_16x16x64_bf16 v[32:35], v[44:47], v[56:63], v1
    ds_read_b128 v[56:59], v5 offset:16384
    v_smfmac_f32_16x16x64_bf16 v[20:23], v[48:51], a[176:183], v1
    ds_read_b128 v[60:63], v5 offset:17408
    s_waitcnt lgkmcnt(3)
    v_max3_u32 v10, v36, v40, v44
    v_smfmac_f32_16x16x64_bf16 v[24:27], v[48:51], v[64:71], v1
    ds_read_b128 v[64:67], v5 offset:18432
    s_waitcnt lgkmcnt(3)
    v_max3_u32 v10, v10, v48, v52
    v_smfmac_f32_16x16x64_bf16 v[28:31], v[48:51], a[168:175], v1
    ds_read_b128 v[68:71], v5 offset:19456
    v_cmp_eq_u32 vcc, -1, v10
    v_smfmac_f32_16x16x64_bf16 v[32:35], v[48:51], a[160:167], v1
    s_cbranch_vccnz M_c0_1_lr
    s_waitcnt vmcnt(0)
    s_barrier
    ds_read_b128 v[36:39], v6 offset:8192
    ds_read_b128 v[40:43], v6 offset:9216
    s_waitcnt lgkmcnt(4)
    v_smfmac_f32_16x16x64_bf16 v[20:23], v[52:55], v[56:63], v1
    ds_read_b128 v[44:47], v6 offset:10240
    ds_read_b128 v[48:51], v6 offset:11264
    v_smfmac_f32_16x16x64_bf16 v[24:27], v[52:55], a[152:159], v1
    ds_read_b32 v11, v6 offset:12288
    ds_read_b128 v[56:59], v5 offset:20480
    s_waitcnt lgkmcnt(6)
    v_smfmac_f32_16x16x64_bf16 v[28:31], v[52:55], v[64:71], v1
    ds_read_b128 v[60:63], v5 offset:21504
    s_waitcnt lgkmcnt(4)
    v_max3_u32 v10, v36, v40, v44
    v_smfmac_f32_16x16x64_bf16 v[32:35], v[52:55], a[144:151], v1
    s_waitcnt lgkmcnt(2)
    v_max3_u32 v10, v10, v48, v11
    v_cmp_eq_u32 vcc, -1, v10
    s_cbranch_vccnz M_c0_1_rr
M_c0_1_rr_r:
    s_mov_b32 m0, 23296
    ds_read_b128 v[64:67], v5 offset:22528
    ds_read_b128 v[68:71], v5 offset:23552
    ds_read_b128 v[52:55], v6 offset:12288
    buffer_store_dwordx4 v[76:79], v0, s[8:11], s4 offen offset:1024 sc1
    s_mov_b32 s4, 0x10000000
    s_mov_b64 exec, 3
    buffer_load_dword v9, s[8:11], s51 offen sc1 lds
    s_mov_b64 exec, s[100:101]
    buffer_store_dword v9, v9, s[8:11], s61 offen sc1
    s_mov_b64 exec, -1
    v_smfmac_f32_16x16x64_bf16 v[20:23], v[36:39], a[136:143], v1
    s_waitcnt lgkmcnt(3)
    v_smfmac_f32_16x16x64_bf16 v[24:27], v[36:39], v[56:63], v1
    ds_read_b128 v[56:59], v5 offset:24576
    v_smfmac_f32_16x16x64_bf16 v[20:23], v[40:43], a[128:135], v1
    ds_read_b128 v[60:63], v5 offset:25600
    s_waitcnt lgkmcnt(3)
    v_smfmac_f32_16x16x64_bf16 v[24:27], v[40:43], v[64:71], v1
    ds_read_b128 v[64:67], v5 offset:26624
    v_smfmac_f32_16x16x64_bf16 v[20:23], v[44:47], a[120:127], v1
    ds_read_b128 v[68:71], v5 offset:27648
    v_smfmac_f32_16x16x64_bf16 v[24:27], v[44:47], a[112:119], v1
    s_waitcnt lgkmcnt(2)
    v_smfmac_f32_16x16x64_bf16 v[20:23], v[48:51], v[56:63], v1
    ds_read_b128 v[56:59], v5 offset:28672
    v_smfmac_f32_16x16x64_bf16 v[24:27], v[48:51], a[104:111], v1
    ds_read_b128 v[60:63], v5 offset:29696
    s_waitcnt lgkmcnt(2)
    v_smfmac_f32_16x16x64_bf16 v[20:23], v[52:55], v[64:71], v1
    ds_read_b128 v[64:67], v5 offset:30720
    v_smfmac_f32_16x16x64_bf16 v[24:27], v[52:55], a[96:103], v1
    ds_read_b128 v[68:71], v5 offset:31744
    v_smfmac_f32_16x16x64_bf16 v[28:31], v[36:39], a[88:95], v1
    s_cmp_eq_u32 s57, 0
    s_cbranch_scc1 M_c0_1_first
M_c0_1_first_r:
    s_waitcnt lgkmcnt(2)
    v_smfmac_f32_16x16x64_bf16 v[32:35], v[36:39], v[56:63], v1
    ds_read_b128 v[56:59], v5 offset:32768
    v_permlane32_swap_b32 v20, v21
    v_smfmac_f32_16x16x64_bf16 v[28:31], v[40:43], a[80:87], v1
    ds_read_b128 v[60:63], v5 offset:33792
    s_waitcnt lgkmcnt(2)
    v_permlane32_swap_b32 v22, v23
    v_smfmac_f32_16x16x64_bf16 v[32:35], v[40:43], v[64:71], v1
    ds_read_b128 v[64:67], v0 offset:2048
    v_permlane32_swap_b32 v24, v25
    v_smfmac_f32_16x16x64_bf16 v[28:31], v[44:47], a[72:79], v1
    ds_read_b128 v[68:71], v0 offset:3072
    v_permlane32_swap_b32 v26, v27
    v_smfmac_f32_16x16x64_bf16 v[32:35], v[44:47], a[64:71], v1
    s_waitcnt lgkmcnt(2)
    v_add_f32 v20, v20, v21
    v_add_f32 v22, v22, v23
    v_smfmac_f32_16x16x64_bf16 v[28:31], v[48:51], v[56:63], v1
    ds_read_b128 v[56:59], v0 offset:0
    v_add_f32 v24, v24, v25
    v_add_f32 v26, v26, v27
    v_smfmac_f32_16x16x64_bf16 v[32:35], v[48:51], a[56:63], v1
    ds_read_b128 v[60:63], v0 offset:1024
    v_mul_f32 v20, s40, v20
    v_mul_f32 v24, s40, v24
    v_smfmac_f32_16x16x64_bf16 v[28:31], v[52:55], a[48:55], v1
    v_mul_f32 v22, s40, v22
    v_mul_f32 v26, s40, v26
    v_smfmac_f32_16x16x64_bf16 v[32:35], v[52:55], a[40:47], v1
    v_cvt_pk_bf16_f32 v20, v20, v24
    v_cvt_pk_bf16_f32 v21, v22, v26
    v_smfmac_f32_16x16x64_bf16 v[12:15], v[36:39], a[32:39], v1
    ds_write_b32 v2, v20 offset:18432
    v_smfmac_f32_16x16x64_bf16 v[16:19], v[36:39], a[24:31], v1
    ds_write_b32 v2, v21 offset:19008
    v_permlane32_swap_b32 v28, v29
    v_smfmac_f32_16x16x64_bf16 v[12:15], v[40:43], a[16:23], v1
    ds_read_b128 v[36:39], v6 offset:15360
    v_permlane32_swap_b32 v30, v31
    v_smfmac_f32_16x16x64_bf16 v[16:19], v[40:43], a[8:15], v1
    ds_read_b128 v[40:43], v6 offset:16384
    v_permlane32_swap_b32 v32, v33
    v_smfmac_f32_16x16x64_bf16 v[12:15], v[44:47], a[0:7], v1
    s_waitcnt lgkmcnt(2)
    s_barrier
    v_permlane32_swap_b32 v34, v35
    v_smfmac_f32_16x16x64_bf16 v[16:19], v[44:47], v[248:255], v1
    ds_read_b128 v[20:23], v3 offset:18432
    v_add_f32 v28, v28, v29
    v_add_f32 v30, v30, v31
    v_smfmac_f32_16x16x64_bf16 v[12:15], v[48:51], v[240:247], v1
    ds_read_b128 v[24:27], v3 offset:18496
    v_add_f32 v32, v32, v33
    v_add_f32 v34, v34, v35
    v_smfmac_f32_16x16x64_bf16 v[16:19], v[48:51], v[232:239], v1
    ds_read_b128 v[72:75], v3 offset:18560
    v_cvt_pk_bf16_f32 v28, v28, v32
    v_cvt_pk_bf16_f32 v29, v30, v34
    v_smfmac_f32_16x16x64_bf16 v[12:15], v[52:55], v[224:231], v1
    ds_write_b32 v2, v28 offset:20736
    ds_read_b128 v[44:47], v3 offset:18624
    v_smfmac_f32_16x16x64_bf16 v[16:19], v[52:55], v[216:223], v1
    ds_write_b32 v2, v29 offset:21312
    s_waitcnt lgkmcnt(7)
    v_smfmac_f32_16x16x64_bf16 v[12:15], v[36:39], v[208:215], v1
    ds_read_b128 v[48:51], v6 offset:17408
    v_mov_b64 v[10:11], s[16:17]
    v_smfmac_f32_16x16x64_bf16 v[16:19], v[36:39], v[200:207], v1
    s_waitcnt lgkmcnt(6)
    v_mfma_f32_16x16x32_bf16 v[28:31], v[56:59], v[20:23], 0
    ds_read_b128 v[56:59], v0 offset:4096
    s_waitcnt lgkmcnt(6)
    v_mfma_f32_16x16x32_bf16 v[28:31], v[60:63], v[24:27], v[28:31]
    ds_read_b128 v[60:63], v0 offset:5120
    s_waitcnt lgkmcnt(3)
    s_barrier
    v_mfma_f32_16x16x32_bf16 v[28:31], v[64:67], v[72:75], v[28:31]
    ds_read_b128 v[64:67], v0 offset:6144
    v_mfma_f32_16x16x32_bf16 v[28:31], v[68:71], v[44:47], v[28:31]
    ds_read_b128 v[68:71], v0 offset:7168
    v_smfmac_f32_16x16x64_bf16 v[12:15], v[40:43], v[192:199], v1
    ds_read_b128 v[36:39], v3 offset:20736
    v_smfmac_f32_16x16x64_bf16 v[16:19], v[40:43], v[184:191], v1
    ds_read_b128 v[52:55], v3 offset:20800
    s_waitcnt lgkmcnt(4)
    v_mfma_f32_16x16x32_bf16 v[32:35], v[56:59], v[20:23], 0
    s_nop 0
    v_exp_f32 v28, v28
    ds_read_b128 v[56:59], v3 offset:20864
    v_mfma_f32_16x16x32_bf16 v[32:35], v[60:63], v[24:27], v[32:35]
    s_waitcnt lgkmcnt(3)
    v_exp_f32 v29, v29
    ds_read_b128 v[60:63], v3 offset:20928
    v_mfma_f32_16x16x32_bf16 v[32:35], v[64:67], v[72:75], v[32:35]
    v_exp_f32 v30, v30
    v_mfma_f32_16x16x32_bf16 v[32:35], v[68:71], v[44:47], v[32:35]
    s_waitcnt lgkmcnt(3)
    v_exp_f32 v31, v31
    v_mfma_f32_16x16x32_bf16 v[40:43], v[36:39], v[20:23], 0
    s_waitcnt lgkmcnt(2)
    v_cvt_pk_bf16_f32 v28, v28, v29
    v_cvt_pk_bf16_f32 v29, v30, v31
    v_mfma_f32_16x16x32_bf16 v[40:43], v[52:55], v[24:27], v[40:43]
    s_waitcnt lgkmcnt(1)
    v_mov_b64 v[64:65], s[24:25]
    v_mov_b64 v[66:67], s[24:25]
    v_mfma_f32_16x16x32_bf16 v[40:43], v[56:59], v[72:75], v[40:43]
    s_waitcnt lgkmcnt(0)
    v_exp_f32 v32, v32
    v_mfma_f32_16x16x32_bf16 v[40:43], v[60:63], v[44:47], v[40:43]
    v_exp_f32 v33, v33
    v_smfmac_f32_16x16x64_bf16 v[12:15], v[48:51], v[176:183], v1
    v_exp_f32 v34, v34
    v_smfmac_f32_16x16x64_bf16 v[16:19], v[48:51], v[168:175], v1
    v_exp_f32 v35, v35
    v_cvt_pk_bf16_f32 v30, v32, v33
    v_cvt_pk_bf16_f32 v31, v34, v35
    s_nop 0
    v_exp_f32 v40, v40
    v_mfma_f32_16x16x32_bf16 v[72:75], v[64:67], v[28:31], 0
    v_exp_f32 v41, v41
    v_mfma_f32_16x16x32_bf16 v[20:23], v[80:83], v[28:31], 0
    v_exp_f32 v42, v42
    v_mfma_f32_16x16x32_bf16 v[24:27], v[84:87], v[28:31], 0
    v_exp_f32 v43, v43
    v_cvt_pk_bf16_f32 v40, v40, v41
    v_cvt_pk_bf16_f32 v41, v42, v43
    v_cvt_pk_bf16_f32 v12, v12, v13
    v_cvt_pk_bf16_f32 v13, v14, v15
    v_mfma_f32_16x16x16_bf16 v[72:75], v[10:11], v[40:41], v[72:75]
    v_cvt_pk_bf16_f32 v14, v16, v17
    v_cvt_pk_bf16_f32 v15, v18, v19
M_c0_1_fin:
    v_mfma_f32_16x16x16_bf16 v[20:23], v[12:13], v[40:41], v[20:23]
    s_cmp_eq_u32 s57, 63
    v_cndmask_b32_e64 v76, v12, v52, s[66:67]
    v_cndmask_b32_e64 v77, v13, v53, s[66:67]
    v_mfma_f32_16x16x16_bf16 v[24:27], v[14:15], v[40:41], v[24:27]
    v_cndmask_b32_e64 v78, v14, v54, s[66:67]
    v_cndmask_b32_e64 v79, v15, v55, s[66:67]
    s_cbranch_scc1 M_c0_1_last
    v_rcp_f32 v74, v72
    v_subrev_u32 v73, s68, v72
    v_cmp_lt_u32 vcc, s69, v73
    v_mov_b64 v[44:45], 0
    v_mov_b64 v[46:47], 0
    v_cndmask_b32_e64 v20, v20, v24, s[18:19]
    v_cndmask_b32_e64 v21, v21, v25, s[18:19]
    v_cndmask_b32_e64 v22, v22, v26, s[18:19]
    v_cndmask_b32_e64 v23, v23, v27, s[18:19]
    v_pk_mul_f32 v[20:21], v[20:21], v[74:75] op_sel_hi:[1,0]
    v_pk_mul_f32 v[22:23], v[22:23], v[74:75] op_sel_hi:[1,0]
    v_cvt_pk_bf16_f32 v20, v20, v21
    v_cvt_pk_bf16_f32 v21, v22, v23
    ds_write_b64 v0, v[20:21] offset:13320
    s_cbranch_vccnz M_c0_1_zbad
M_c0_1_zok:
    s_cmp_lt_u32 s54, s42
    s_cbranch_scc1 M_c0_1_first2
M_c0_1_first2_r:
    buffer_load_dwordx4 v[80:83], v0, s[8:11], s3 offen offset:0 sc1
    buffer_load_dwordx4 v[84:87], v0, s[8:11], s3 offen offset:1024 sc1
    s_waitcnt lgkmcnt(0)
    s_barrier
    ds_read_b128 v[32:35], v0 offset:13312
    ds_read_b128 v[52:55], v0 offset:14336
    s_mov_b32 m0, 2048
    s_nop 0
    buffer_load_dwordx4 v0, s[8:11], s26 offen offset:0 sc1 lds
    buffer_load_dwordx4 v0, s[8:11], s26 offen offset:1024 sc1 lds
    v_mov_b64 v[68:69], 0
    v_mov_b64 v[70:71], 0
    v_mov_b64 v[64:65], 0
    v_mov_b64 v[66:67], 0
    v_mov_b64 v[60:61], 0
    v_mov_b64 v[62:63], 0
    v_mov_b64 v[56:57], 0
    v_mov_b64 v[58:59], 0
    s_waitcnt lgkmcnt(1)
    s_nop 0
    v_smfmac_f32_16x16x64_bf16 v[56:59], v[32:35], v[160:167], v1
    v_smfmac_f32_16x16x64_bf16 v[60:63], v[32:35], v[144:151], v1
    s_waitcnt lgkmcnt(0)
    v_smfmac_f32_16x16x64_bf16 v[56:59], v[52:55], v[152:159], v1
    v_smfmac_f32_16x16x64_bf16 v[60:63], v[52:55], v[136:143], v1
    v_smfmac_f32_16x16x64_bf16 v[64:67], v[32:35], v[128:135], v1
    v_smfmac_f32_16x16x64_bf16 v[68:71], v[32:35], v[112:119], v1
    v_permlane32_swap_b32 v56, v57
    v_smfmac_f32_16x16x64_bf16 v[64:67], v[52:55], v[120:127], v1
    v_permlane32_swap_b32 v58, v59
    v_smfmac_f32_16x16x64_bf16 v[68:71], v[52:55], v[104:111], v1
    v_add_f32 v56, v56, v57
    v_add_f32 v58, v58, v59
    v_smfmac_f32_16x16x64_bf16 v[44:47], v[32:35], v[96:103], v1
    v_permlane32_swap_b32 v60, v61
    v_smfmac_f32_16x16x64_bf16 v[44:47], v[52:55], v[88:95], v1
    v_permlane32_swap_b32 v62, v63
    v_add_f32 v60, v60, v61
    v_add_f32 v62, v62, v63
    v_cvt_pk_bf16_f32 v36, v56, v60
    v_cvt_pk_bf16_f32 v38, v58, v62
    v_permlane32_swap_b32 v64, v65
    v_permlane32_swap_b32 v66, v67
    v_add_f32 v64, v64, v65
    v_add_f32 v66, v66, v67
    v_permlane32_swap_b32 v68, v69
    v_permlane32_swap_b32 v70, v71
    v_add_f32 v68, v68, v69
    v_add_f32 v70, v70, v71
    v_cvt_pk_bf16_f32 v37, v64, v68
    v_cvt_pk_bf16_f32 v39, v66, v70
    buffer_store_dwordx4 v[36:39], v0, s[8:11], s58 offen
    v_permlane32_swap_b32 v44, v45
    v_permlane32_swap_b32 v46, v47
    v_add_f32 v44, v44, v45
    v_add_f32 v46, v46, v47
    v_cvt_pk_bf16_f32 v44, v44, v46
    buffer_store_dword v44, v7, s[8:11], s55 offen
    v_bfe_u32 v34, v0, 4, 1
    v_bfe_u32 v33, v0, 7, 1
    v_lshl_add_u32 v33, v33, 1, v34
    v_bfe_u32 v32, v0, 6, 1
    v_lshlrev_b32 v32, 4, v32
    v_lshlrev_b32_e64 v32, v32, s45
    v_cmp_eq_u32_e64 s[64:65], 0, v33
    v_cmp_eq_u32_e64 vcc, 1, v33
    s_add_u32 s27, s44, 1
    s_and_b32 s27, s27, 3
    v_cndmask_b32_e64 v72, 0, v32, s[64:65]
    v_cndmask_b32_e64 v73, 0, v32, vcc
    v_cmp_eq_u32_e64 s[64:65], 2, v33
    v_cmp_eq_u32_e64 vcc, 3, v33
    s_mul_i32 s48, s27, 5120
    s_add_u32 s48, s48, s41
    v_cndmask_b32_e64 v74, 0, v32, s[64:65]
    v_cndmask_b32_e64 v75, 0, v32, vcc
    s_lshl_b32 s27, s27, 15
    s_add_u32 s49, s27, s47
    v_bfe_u32 v32, v0, 8, 1
    v_lshlrev_b32 v11, 6, v32
    v_lshl_add_u32 v11, v34, 3, v11
    v_lshrrev_b32 v33, 9, v0
    v_lshl_add_u32 v11, v33, 2, v11
    s_add_u32 s56, s27, s46
    s_add_u32 s56, s56, s33
    s_add_u32 s58, s48, s33
    s_nop 15
    s_nop 15
    buffer_load_dwordx4 v[12:15], v0, s[8:11], s43 offen sc1
    s_nop 15
    s_nop 15
    s_nop 9
    buffer_load_dwordx4 v[16:19], v0, s[8:11], s43 offen sc1
    s_nop 7
    s_waitcnt vmcnt(1)
    v_mfma_f32_16x16x32_bf16 v[28:31], v[72:75], v[12:15], 0
    v_cmp_eq_u32 vcc, -1, v12
    s_cbranch_vccnz M_c0_1_wq1
    v_mov_b32 v5, v5
    v_mov_b32 v5, v5
    v_mov_b32 v5, v5
    v_mov_b32 v5, v5
    v_mov_b32 v5, v5
    v_mov_b32 v5, v5
    v_add_f32_dpp v28, v28, v28 row_ror:8 row_mask:0xf bank_mask:0xf
    v_add_f32_dpp v29, v29, v29 row_ror:8 row_mask:0xf bank_mask:0xf
    s_nop 0
    v_add_f32_dpp v28, v28, v28 row_ror:4 row_mask:0xf bank_mask:0xf
    v_add_f32_dpp v29, v29, v29 row_ror:4 row_mask:0xf bank_mask:0xf
    s_nop 0
    v_add_f32_dpp v28, v28, v28 row_ror:2 row_mask:0xf bank_mask:0xf
    v_add_f32_dpp v29, v29, v29 row_ror:2 row_mask:0xf bank_mask:0xf
    v_cmp_u_f32 vcc, v28, v28
    v_cvt_pk_bf16_f32 v28, v28, v29
    s_cbranch_vccnz M_c0_1_wrb_e0
    s_mov_b64 exec, s[62:63]
    buffer_store_dword v28, v11, s[8:11], s58 offen
M_c0_1_wrb_d:
    s_barrier
    buffer_store_dword v28, v11, s[8:11], s56 offen sc1
M_c0_1_wrb_g:
    s_mov_b64 exec, -1
    s_waitcnt vmcnt(2)
    ds_read_b128 v[56:59], v5 offset:0
    ds_read_b128 v[60:63], v5 offset:1024
    ds_read_b128 v[64:67], v5 offset:2048
    ds_read_b128 v[68:71], v5 offset:3072
    v_mov_b64 v[12:13], 0
    v_mov_b64 v[14:15], 0
    v_mov_b64 v[16:17], 0
    v_mov_b64 v[18:19], 0
    v_mov_b64 v[20:21], 0
    v_mov_b64 v[22:23], 0
    v_mov_b64 v[24:25], 0
    v_mov_b64 v[26:27], 0
    v_mov_b64 v[28:29], 0
    v_mov_b64 v[30:31], 0
    v_mov_b64 v[32:33], 0
    v_mov_b64 v[34:35], 0
    ds_read_b64 v[36:37], v0 offset:23296
    s_waitcnt lgkmcnt(0)
    v_min_u32 v36, v36, v37
    s_nop 0
    v_readfirstlane_b32 s28, v36
    s_nop 0
    s_max_u32 s54, s54, s28
    s_and_b32 s26, s44, 63
    s_add_u32 s26, s26, 2
    s_min_u32 s26, s26, 63
    s_lshl_b32 s26, s26, 18
    s_add_u32 s26, s26, s50
    s_add_u32 s26, s26, 2048
    s_add_u32 s3, s26, 16777216
    s_lshl_b32 s4, s44, 18
    s_add_u32 s4, s4, s53
    v_mov_b64 v[72:73], -1
    v_mov_b64 v[74:75], -1
    s_add_u32 s28, s44, 3
    s_and_b32 s29, s28, 3
    s_mul_i32 s31, s22, 160
    s_mul_i32 s28, s29, 167936
    s_add_u32 s28, s28, s34
    s_add_u32 s64, s28, s35
    s_lshl_b32 s65, s22, 10
    s_add_u32 s65, s65, s28
    s_add_u32 s65, s65, 135168
    s_add_u32 s44, s44, 1
    s_and_b32 s55, s44, 3
    s_mul_i32 s55, s55, 167936
    s_add_u32 s55, s55, s34
    s_add_u32 s58, s55, s35
    s_and_b32 s57, s44, 63
    s_add_u32 s43, s55, s32
    s_sub_u32 s27, s57, 1
    s_max_i32 s27, s27, 0
    s_lshl_b64 s[100:101], 1, s27
    s_lshl_b32 s27, s27, 7
    s_sub_u32 s61, s52, s27
    s_add_u32 s42, s44, 2
    s_or_b32 s28, s44, 63
    s_add_u32 s28, s28, 1
    s_min_u32 s42, s42, s28
    s_nop 15
    s_nop 15
    s_nop 1
    buffer_store_dwordx4 v[72:75], v0, s[8:11], s64 offen offset:1024
    buffer_store_dwordx4 v[72:75], v0, s[8:11], s64 offen offset:2048
    buffer_store_dwordx4 v[72:75], v0, s[8:11], s65 offen
    s_mov_b32 s65, 0x10000000
    s_mov_b32 s64, 0x10000000
    s_mov_b32 s70, 0
    s_branch M_c0_1_top
M_c0_1_restart:
    s_waitcnt vmcnt(0) lgkmcnt(0)
    s_nop 7
    s_barrier
    ds_read_b128 v[56:59], v5 offset:0
    ds_read_b128 v[60:63], v5 offset:1024
    ds_read_b128 v[64:67], v5 offset:2048
    ds_read_b128 v[68:71], v5 offset:3072
    v_mov_b64 v[12:13], 0
    v_mov_b64 v[14:15], 0
    v_mov_b64 v[16:17], 0
    v_mov_b64 v[18:19], 0
    v_mov_b64 v[20:21], 0
    v_mov_b64 v[22:23], 0
    v_mov_b64 v[24:25], 0
    v_mov_b64 v[26:27], 0
    v_mov_b64 v[28:29], 0
    v_mov_b64 v[30:31], 0
    v_mov_b64 v[32:33], 0
    v_mov_b64 v[34:35], 0
    s_waitcnt vmcnt(0) lgkmcnt(0)
    s_branch M_c0_1_top
M_c0_1_zbad:
    s_cmp_eq_u32 s70, 2
    s_cbranch_scc1 M_c0_1_zok
    v_cmp_u_f32 vcc, v72, v72
    s_cbranch_vccz M_c0_1_exact
    s_cmp_eq_u32 s70, 1
    s_cbranch_scc1 M_c0_1_exact
M_c0_1_vfy0:
    s_mov_b32 s70, 1
    s_mov_b32 s30, 0
    s_waitcnt vmcnt(0) lgkmcnt(0)
    s_nop 7
M_c0_1_vfy:
    v_mov_b32 v10, 0
    s_add_u32 s59, s48, 4096
    buffer_load_dwordx4 v[36:39], v0, s[8:11], s48 offen offset:0 sc1
    buffer_load_dwordx4 v[40:43], v0, s[8:11], s48 offen offset:1024 sc1
    buffer_load_dwordx4 v[44:47], v0, s[8:11], s48 offen offset:2048 sc1
    buffer_load_dwordx4 v[48:51], v0, s[8:11], s48 offen offset:3072 sc1
    buffer_load_dwordx4 v[52:55], v0, s[8:11], s59 offen offset:0 sc1
    s_waitcnt vmcnt(4)
    v_max3_u32 v10, v10, v36, v37
    v_max3_u32 v10, v10, v38, v39
    s_waitcnt vmcnt(3)
    v_max3_u32 v10, v10, v40, v41
    v_max3_u32 v10, v10, v42, v43
    s_waitcnt vmcnt(2)
    v_max3_u32 v10, v10, v44, v45
    v_max3_u32 v10, v10, v46, v47
    s_waitcnt vmcnt(1)
    v_max3_u32 v10, v10, v48, v49
    v_max3_u32 v10, v10, v50, v51
    s_waitcnt vmcnt(0)
    v_max3_u32 v10, v10, v52, v53
    v_max3_u32 v10, v10, v54, v55
    s_add_u32 s59, s49, 4096
    buffer_load_dwordx4 v[36:39], v0, s[8:11], s49 offen offset:0 sc1
    buffer_load_dwordx4 v[40:43], v0, s[8:11], s49 offen offset:1024 sc1
    buffer_load_dwordx4 v[44:47], v0, s[8:11], s49 offen offset:2048 sc1
    buffer_load_dwordx4 v[48:51], v0, s[8:11], s49 offen offset:3072 sc1
    buffer_load_dwordx4 v[52:55], v0, s[8:11], s59 offen offset:0 sc1
    s_waitcnt vmcnt(4)
    v_max3_u32 v10, v10, v36, v37
    v_max3_u32 v10, v10, v38, v39
    s_waitcnt vmcnt(3)
    v_max3_u32 v10, v10, v40, v41
    v_max3_u32 v10, v10, v42, v43
    s_waitcnt vmcnt(2)
    v_max3_u32 v10, v10, v44, v45
    v_max3_u32 v10, v10, v46, v47
    s_waitcnt vmcnt(1)
    v_max3_u32 v10, v10, v48, v49
    v_max3_u32 v10, v10, v50, v51
    s_waitcnt vmcnt(0)
    v_max3_u32 v10, v10, v52, v53
    v_max3_u32 v10, v10, v54, v55
    v_cmp_eq_u32 vcc, -1, v10
    s_cbranch_vccz M_c0_1_restart
    s_add_u32 s30, s30, 1
    s_cmp_ge_u32 s30, 60000
    s_cbranch_scc1 M_fail
    s_branch M_c0_1_vfy
M_c0_1_exact:
    s_nop 7
    s_mov_b32 s70, 2
    s_waitcnt lgkmcnt(0)
    ds_read_b128 v[20:23], v3 offset:18432
    ds_read_b128 v[24:27], v3 offset:18496
    ds_read_b128 v[72:75], v3 offset:18560
    ds_read_b128 v[44:47], v3 offset:18624
    ds_read_b128 v[56:59], v0 offset:0
    s_waitcnt lgkmcnt(0)
    v_mfma_f32_16x16x32_bf16 v[28:31], v[56:59], v[20:23], 0
    s_nop 3
    ds_read_b128 v[60:63], v0 offset:1024
    s_waitcnt lgkmcnt(0)
    v_mfma_f32_16x16x32_bf16 v[28:31], v[60:63], v[24:27], v[28:31]
    s_nop 3
    ds_read_b128 v[56:59], v0 offset:2048
    s_waitcnt lgkmcnt(0)
    v_mfma_f32_16x16x32_bf16 v[28:31], v[56:59], v[72:75], v[28:31]
    s_nop 3
    ds_read_b128 v[60:63], v0 offset:3072
    s_waitcnt lgkmcnt(0)
    v_mfma_f32_16x16x32_bf16 v[28:31], v[60:63], v[44:47], v[28:31]
    s_nop 3
    ds_read_b128 v[56:59], v0 offset:4096
    s_waitcnt lgkmcnt(0)
    v_mfma_f32_16x16x32_bf16 v[32:35], v[56:59], v[20:23], 0
    s_nop 3
    ds_read_b128 v[60:63], v0 offset:5120
    s_waitcnt lgkmcnt(0)
    v_mfma_f32_16x16x32_bf16 v[32:35], v[60:63], v[24:27], v[32:35]
    s_nop 3
    ds_read_b128 v[56:59], v0 offset:6144
    s_waitcnt lgkmcnt(0)
    v_mfma_f32_16x16x32_bf16 v[32:35], v[56:59], v[72:75], v[32:35]
    s_nop 3
    ds_read_b128 v[60:63], v0 offset:7168
    s_waitcnt lgkmcnt(0)
    v_mfma_f32_16x16x32_bf16 v[32:35], v[60:63], v[44:47], v[32:35]
    s_nop 3
    ds_read_b128 v[56:59], v3 offset:20736
    s_waitcnt lgkmcnt(0)
    v_mfma_f32_16x16x32_bf16 v[40:43], v[56:59], v[20:23], 0
    s_nop 3
    ds_read_b128 v[60:63], v3 offset:20800
    s_waitcnt lgkmcnt(0)
    v_mfma_f32_16x16x32_bf16 v[40:43], v[60:63], v[24:27], v[40:43]
    s_nop 3
    ds_read_b128 v[56:59], v3 offset:20864
    s_waitcnt lgkmcnt(0)
    v_mfma_f32_16x16x32_bf16 v[40:43], v[56:59], v[72:75], v[40:43]
    s_nop 3
    ds_read_b128 v[60:63], v3 offset:20928
    s_waitcnt lgkmcnt(0)
    v_mfma_f32_16x16x32_bf16 v[40:43], v[60:63], v[44:47], v[40:43]
    s_nop 3
    v_max3_f32 v68, v28, v29, v30
    v_max3_f32 v68, v68, v31, v32
    v_max3_f32 v68, v68, v33, v34
    s_nop 0
    v_max3_f32 v68, v68, v35, v40
    v_max3_f32 v68, v68, v41, v42
    v_max_f32 v68, v68, v43
    v_mov_b32 v69, v68
    s_nop 1
    v_permlane16_swap_b32 v68, v69
    v_max_f32 v68, v68, v69
    v_mov_b32 v69, v68
    s_nop 1
    v_permlane32_swap_b32 v68, v69
    v_max_f32 v68, v68, v69
    v_sub_f32 v28, v28, v68
    v_exp_f32 v28, v28
    v_sub_f32 v29, v29, v68
    v_exp_f32 v29, v29
    v_sub_f32 v30, v30, v68
    v_exp_f32 v30, v30
    v_sub_f32 v31, v31, v68
    v_exp_f32 v31, v31
    v_sub_f32 v32, v32, v68
    v_exp_f32 v32, v32
    v_sub_f32 v33, v33, v68
    v_exp_f32 v33, v33
    v_sub_f32 v34, v34, v68
    v_exp_f32 v34, v34
    v_sub_f32 v35, v35, v68
    v_exp_f32 v35, v35
    v_sub_f32 v40, v40, v68
    v_exp_f32 v40, v40
    v_sub_f32 v41, v41, v68
    v_exp_f32 v41, v41
    v_sub_f32 v42, v42, v68
    v_exp_f32 v42, v42
    v_sub_f32 v43, v43, v68
    v_exp_f32 v43, v43
    v_cvt_pk_bf16_f32 v28, v28, v29
    v_cvt_pk_bf16_f32 v29, v30, v31
    v_cvt_pk_bf16_f32 v30, v32, v33
    v_cvt_pk_bf16_f32 v31, v34, v35
    v_cvt_pk_bf16_f32 v40, v40, v41
    v_cvt_pk_bf16_f32 v41, v42, v43
    v_mfma_f32_16x16x32_bf16 v[20:23], v[80:83], v[28:31], 0
    v_mfma_f32_16x16x32_bf16 v[24:27], v[84:87], v[28:31], 0
    v_mfma_f32_16x16x32_bf16 v[72:75], v[64:67], v[28:31], 0
    ds_read_b128 v[52:55], v3 offset:20800
    s_waitcnt lgkmcnt(0)
    s_nop 7
    v_mfma_f32_16x16x16_bf16 v[72:75], v[10:11], v[40:41], v[72:75]
    s_nop 7
    s_branch M_c0_1_fin
M_c0_1_last:
    s_cmp_lg_u32 s70, 0
    s_cbranch_scc1 M_c0_1_last2
    v_cmp_u_f32 vcc, v32, v32
    s_cbranch_vccnz M_c0_1_vfy0
M_c0_1_last2:
    s_lshl_b32 s4, s44, 18
    s_add_u32 s4, s4, s53
    buffer_store_dwordx4 v[76:79], v0, s[8:11], s4 offen offset:1024 sc1
    s_mov_b32 s4, 0x10000000
    s_waitcnt vmcnt(0) lgkmcnt(0)
    s_barrier
    v_mov_b32 v11, 8192
    s_mov_b64 exec, 1
    buffer_store_dword v11, v0, s[8:11], s52 offen sc1
    s_mov_b64 exec, -1
    s_add_u32 s52, s52, 4096
    s_nop 7
    v_mov_b64 v[72:73], -1
    v_mov_b64 v[74:75], -1
    s_add_u32 s28, s44, 3
    s_and_b32 s29, s28, 3
    s_mul_i32 s31, s22, 160
    s_mul_i32 s28, s29, 167936
    s_add_u32 s28, s28, s34
    s_add_u32 s64, s28, s35
    s_lshl_b32 s65, s22, 10
    s_add_u32 s65, s65, s28
    s_add_u32 s65, s65, 135168
    buffer_store_dwordx4 v[72:75], v0, s[8:11], s64 offen offset:1024
    buffer_store_dwordx4 v[72:75], v0, s[8:11], s64 offen offset:2048
    buffer_store_dwordx4 v[72:75], v0, s[8:11], s65 offen
    s_mov_b32 s65, 0x10000000
    s_mov_b32 s64, 0x10000000
    s_waitcnt vmcnt(0)
    s_add_u32 s44, s44, 1
    s_branch M_c_fft
    s_cmp_eq_u32 s44, 128
    s_cbranch_scc1 M_end
    s_branch M_c0_1_layer
M_c0_1_lr:
    s_mov_b32 s30, 0
M_c0_1_lr_l:
    s_waitcnt lgkmcnt(0)
    ds_read_b128 v[36:39], v6 offset:13312
    ds_read_b128 v[40:43], v6 offset:14336
    ds_read_b128 v[44:47], v6 offset:15360
    ds_read_b128 v[48:51], v6 offset:16384
    ds_read_b128 v[52:55], v6 offset:17408
    s_waitcnt lgkmcnt(2)
    v_max3_u32 v10, v36, v40, v44
    s_waitcnt lgkmcnt(0)
    v_max3_u32 v10, v10, v48, v52
    v_cmp_eq_u32 vcc, -1, v10
    s_cbranch_vccz M_c0_1_lr_d
    s_add_u32 s30, s30, 1
    s_cmp_ge_u32 s30, 480000
    s_cbranch_scc1 M_fail
    s_branch M_c0_1_lr_l
M_c0_1_lr_d:
    ds_read_b128 v[56:59], v5 offset:0
    ds_read_b128 v[60:63], v5 offset:1024
    ds_read_b128 v[64:67], v5 offset:2048
    ds_read_b128 v[68:71], v5 offset:3072
    v_mov_b64 v[12:13], 0
    v_mov_b64 v[14:15], 0
    v_mov_b64 v[16:17], 0
    v_mov_b64 v[18:19], 0
    v_mov_b64 v[20:21], 0
    v_mov_b64 v[22:23], 0
    v_mov_b64 v[24:25], 0
    v_mov_b64 v[26:27], 0
    v_mov_b64 v[28:29], 0
    v_mov_b64 v[30:31], 0
    v_mov_b64 v[32:33], 0
    v_mov_b64 v[34:35], 0
    s_waitcnt lgkmcnt(0)
    s_branch M_c0_1_lr_r
M_c0_1_rr:
    s_mov_b32 s30, 0
M_c0_1_rr_l:
    s_waitcnt lgkmcnt(0)
    s_and_b32 s27, s30, 1
    s_cbranch_scc1 M_c0_1_rr_n
    s_waitcnt vmcnt(1)
    s_mov_b32 m0, 8192
    s_nop 0
    buffer_load_dwordx4 v0, s[8:11], s49 offen offset:2048 sc1 lds
M_c0_1_rr_n:
    ds_read_b128 v[36:39], v6 offset:8192
    ds_read_b128 v[40:43], v6 offset:9216
    ds_read_b128 v[44:47], v6 offset:10240
    ds_read_b128 v[48:51], v6 offset:11264
    ds_read_b32 v11, v6 offset:12288
    s_waitcnt lgkmcnt(2)
    v_max3_u32 v10, v36, v40, v44
    s_waitcnt lgkmcnt(0)
    v_max3_u32 v10, v10, v48, v11
    v_cmp_eq_u32 vcc, -1, v10
    s_cbranch_vccz M_c0_1_rr_d
    s_add_u32 s30, s30, 1
    s_cmp_ge_u32 s30, 480000
    s_cbranch_scc1 M_fail
    s_branch M_c0_1_rr_l
M_c0_1_rr_d:
    s_branch M_c0_1_rr_r
M_c0_1_first:
    s_mul_i32 s27, s21, 167936
    s_add_u32 s27, s27, s34
    s_mul_i32 s28, s22, 4224
    s_add_u32 s28, s28, s27
    s_mov_b32 exec_hi, 0
    buffer_load_dword v10, v9, s[8:11], s28 offen sc1
    s_lshl_b32 s28, s22, 10
    s_add_u32 s28, s28, s27
    s_add_u32 s28, s28, 135168
    s_mov_b64 exec, 0xff
    buffer_load_dword v10, v9, s[8:11], s28 offen sc1
    s_mul_i32 s27, s21, 5120
    s_add_u32 s27, s27, s41
    s_mul_i32 s28, s22, 160
    s_add_u32 s28, s28, s27
    s_mov_b64 exec, 3
    buffer_load_dword v10, v9, s[8:11], s28 offen sc1
    s_mov_b64 exec, -1
    s_barrier
    s_and_b32 s26, s44, 63
    s_lshl_b32 s26, s26, 18
    s_add_u32 s26, s26, s50
    s_add_u32 s26, s26, 2048
    s_add_u32 s3, s26, 16777216
    s_mov_b32 m0, 2048
    s_nop 0
    buffer_load_dwordx4 v0, s[8:11], s26 offen offset:0 sc1 lds
    buffer_load_dwordx4 v0, s[8:11], s26 offen offset:1024 sc1 lds
    buffer_load_dwordx4 v[80:83], v0, s[8:11], s3 offen offset:0 sc1
    buffer_load_dwordx4 v[84:87], v0, s[8:11], s3 offen offset:1024 sc1
    s_and_b32 s26, s44, 63
    s_add_u32 s26, s26, 1
    s_min_u32 s26, s26, 63
    s_lshl_b32 s26, s26, 18
    s_add_u32 s26, s26, s50
    s_add_u32 s26, s26, 2048
    s_add_u32 s3, s26, 16777216
    s_waitcnt vmcnt(0) lgkmcnt(0)
    s_barrier
    s_branch M_c0_1_first_r
M_c0_1_first2:
    ds_read_b64 v[10:11], v0 offset:23296
    s_waitcnt lgkmcnt(0)
    v_min_u32 v10, v10, v11
    s_nop 0
    v_readfirstlane_b32 s28, v10
    s_nop 0
    s_max_u32 s54, s54, s28
    s_add_u32 s27, s44, 2
    s_or_b32 s28, s44, 63
    s_add_u32 s28, s28, 1
    s_min_u32 s27, s27, s28
    s_cmp_lt_u32 s54, s27
    s_cbranch_scc1 M_c0_1_p2
M_c0_1_p2_r:
    s_branch M_c0_1_first2_r
M_c0_1_wq1:
    buffer_load_dwordx4 v[12:15], v0, s[8:11], s43 offen sc1
    s_waitcnt vmcnt(1)
    v_mfma_f32_16x16x32_bf16 v[28:31], v[72:75], v[16:19], 0
    v_cmp_eq_u32 vcc, -1, v16
    s_cbranch_vccnz M_c0_1_wqx
    v_mov_b32 v5, v5
    v_mov_b32 v5, v5
    v_mov_b32 v5, v5
    v_mov_b32 v5, v5
    v_mov_b32 v5, v5
    v_mov_b32 v5, v5
    v_add_f32_dpp v28, v28, v28 row_ror:8 row_mask:0xf bank_mask:0xf
    v_add_f32_dpp v29, v29, v29 row_ror:8 row_mask:0xf bank_mask:0xf
    s_nop 0
    v_add_f32_dpp v28, v28, v28 row_ror:4 row_mask:0xf bank_mask:0xf
    v_add_f32_dpp v29, v29, v29 row_ror:4 row_mask:0xf bank_mask:0xf
    s_nop 0
    v_add_f32_dpp v28, v28, v28 row_ror:2 row_mask:0xf bank_mask:0xf
    v_add_f32_dpp v29, v29, v29 row_ror:2 row_mask:0xf bank_mask:0xf
    v_cmp_u_f32 vcc, v28, v28
    v_cvt_pk_bf16_f32 v28, v28, v29
    s_cbranch_vccnz M_c0_1_wqe1
    s_mov_b64 exec, s[62:63]
    buffer_store_dword v28, v11, s[8:11], s58 offen
    s_barrier
    buffer_store_dword v28, v11, s[8:11], s56 offen sc1
    s_branch M_c0_1_wrb_g
M_c0_1_wqx:
    s_branch M_c0_1_wrb_i1
M_c0_1_wqe1:
    s_waitcnt vmcnt(0)
    buffer_load_dwordx4 v[12:15], v0, s[8:11], s43 offen sc1
    s_branch M_c0_1_wrb_e1
M_c0_1_wrb_l:
    s_waitcnt vmcnt(1)
    v_mfma_f32_16x16x32_bf16 v[28:31], v[72:75], v[12:15], 0
    v_cmp_eq_u32 vcc, -1, v12
    s_cbranch_vccz M_c0_1_wrb_x0
M_c0_1_wrb_i0:
    buffer_load_dwordx4 v[12:15], v0, s[8:11], s43 offen sc1
    s_waitcnt vmcnt(1)
    v_mfma_f32_16x16x32_bf16 v[28:31], v[72:75], v[16:19], 0
    v_cmp_eq_u32 vcc, -1, v16
    s_cbranch_vccz M_c0_1_wrb_x1
M_c0_1_wrb_i1:
    buffer_load_dwordx4 v[16:19], v0, s[8:11], s43 offen sc1
    s_add_u32 s71, s71, 1
    s_cmp_lt_u32 s71, 240000
    s_cbranch_scc1 M_c0_1_wrb_l
    s_branch M_fail
M_c0_1_wrb_x0:
    s_nop 5
    v_add_f32_dpp v28, v28, v28 row_ror:8 row_mask:0xf bank_mask:0xf
    v_add_f32_dpp v29, v29, v29 row_ror:8 row_mask:0xf bank_mask:0xf
    s_nop 0
    v_add_f32_dpp v28, v28, v28 row_ror:4 row_mask:0xf bank_mask:0xf
    v_add_f32_dpp v29, v29, v29 row_ror:4 row_mask:0xf bank_mask:0xf
    s_nop 0
    v_add_f32_dpp v28, v28, v28 row_ror:2 row_mask:0xf bank_mask:0xf
    v_add_f32_dpp v29, v29, v29 row_ror:2 row_mask:0xf bank_mask:0xf
    v_cmp_u_f32 vcc, v28, v28
    v_cvt_pk_bf16_f32 v28, v28, v29
    s_cbranch_vccz M_c0_1_wrb_n
M_c0_1_wrb_e0:
    v_max3_u32 v32, v12, v13, v14
    v_max_u32 v32, v32, v15
    v_cmp_eq_u32 vcc, -1, v32
    s_cbranch_vccnz M_c0_1_wrb_i0
    v_min_u32 v28, -2, v28
    v_min_u32 v29, -2, v29
    s_branch M_c0_1_wrb_n
M_c0_1_wrb_x1:
    s_nop 5
    v_add_f32_dpp v28, v28, v28 row_ror:8 row_mask:0xf bank_mask:0xf
    v_add_f32_dpp v29, v29, v29 row_ror:8 row_mask:0xf bank_mask:0xf
    s_nop 0
    v_add_f32_dpp v28, v28, v28 row_ror:4 row_mask:0xf bank_mask:0xf
    v_add_f32_dpp v29, v29, v29 row_ror:4 row_mask:0xf bank_mask:0xf
    s_nop 0
    v_add_f32_dpp v28, v28, v28 row_ror:2 row_mask:0xf bank_mask:0xf
    v_add_f32_dpp v29, v29, v29 row_ror:2 row_mask:0xf bank_mask:0xf
    v_cmp_u_f32 vcc, v28, v28
    v_cvt_pk_bf16_f32 v28, v28, v29
    s_cbranch_vccz M_c0_1_wrb_n
M_c0_1_wrb_e1:
    v_max3_u32 v32, v16, v17, v18
    v_max_u32 v32, v32, v19
    v_cmp_eq_u32 vcc, -1, v32
    s_cbranch_vccnz M_c0_1_wrb_i1
    v_min_u32 v28, -2, v28
    v_min_u32 v29, -2, v29
M_c0_1_wrb_n:
    s_mov_b64 exec, s[62:63]
    buffer_store_dword v28, v11, s[8:11], s58 offen
    s_branch M_c0_1_wrb_d
M_c0_1_p2:
    s_mov_b32 s30, 0
M_c0_1_p2_l:
    s_waitcnt lgkmcnt(0)
    s_mov_b64 exec, 3
    buffer_load_dword v10, v9, s[8:11], s51 offen sc1
    s_waitcnt vmcnt(0)
    s_mov_b64 exec, -1
    v_readlane_b32 s54, v10, 0
    v_readlane_b32 s28, v10, 1
    s_nop 3
    s_min_u32 s54, s54, s28
    s_cmp_ge_u32 s54, s27
    s_cbranch_scc1 M_c0_1_p2_r
    s_sleep 2
    s_add_u32 s30, s30, 1
    s_cmp_ge_u32 s30, 240000
    s_cbranch_scc1 M_fail
    s_branch M_c0_1_p2_l
M_c0_2_layer:
    s_lshr_b32 s27, s44, 6
    s_mul_i32 s50, s27, 33554432
    s_lshl_b32 s27, s22, 13
    s_add_u32 s50, s50, s27
    s_add_u32 s50, s50, 37748736
    s_barrier
    s_mov_b32 s26, 0x10010000
    s_mov_b32 s3, s26
    s_mul_i32 s27, s20, 5120
    s_add_u32 s48, s27, 167772160
    s_sub_u32 s49, 167777280, s27
    s_mov_b32 m0, 13312
    s_nop 0
    buffer_load_dwordx4 v0, s[8:11], s48 offen offset:0 sc1 lds
    buffer_load_dwordx4 v0, s[8:11], s48 offen offset:1024 sc1 lds
    buffer_load_dwordx4 v0, s[8:11], s48 offen offset:2048 sc1 lds
    s_and_b32 s55, s44, 3
    s_mul_i32 s55, s55, 167936
    s_add_u32 s55, s55, s34
    s_add_u32 s58, s55, s35
    s_and_b32 s57, s44, 63
    s_add_u32 s42, s44, 2
    s_or_b32 s28, s44, 63
    s_add_u32 s28, s28, 1
    s_min_u32 s42, s42, s28
    s_sub_u32 s61, s3, 4096
    s_cmp_ge_u32 s54, s42
    s_cselect_b32 s61, s61, 0x10000000
    ds_read_b128 v[56:59], v5 offset:0
    ds_read_b128 v[60:63], v5 offset:1024
    ds_read_b128 v[64:67], v5 offset:2048
    ds_read_b128 v[68:71], v5 offset:3072
    v_mov_b64 v[12:13], 0
    v_mov_b64 v[14:15], 0
    v_mov_b64 v[16:17], 0
    v_mov_b64 v[18:19], 0
    v_mov_b64 v[20:21], 0
    v_mov_b64 v[22:23], 0
    v_mov_b64 v[24:25], 0
    v_mov_b64 v[26:27], 0
    v_mov_b64 v[28:29], 0
    v_mov_b64 v[30:31], 0
    v_mov_b64 v[32:33], 0
    v_mov_b64 v[34:35], 0
    s_mov_b32 s70, 0
    s_waitcnt vmcnt(0) lgkmcnt(0)
M_c0_2_top:
    s_waitcnt vmcnt(6)
    s_barrier
    ds_read_b128 v[36:39], v6 offset:13312
    ds_read_b128 v[40:43], v6 offset:14336
    s_mov_b32 m0, 8192
    s_nop 0
    buffer_load_dwordx4 v0, s[8:11], s49 offen offset:3072 sc1 lds
M_c0_2_lr_r:
    s_waitcnt lgkmcnt(1)
    v_smfmac_f32_16x16x64_bf16 v[20:23], v[36:39], v[56:63], v1
    ds_read_b128 v[56:59], v5 offset:4096
    v_smfmac_f32_16x16x64_bf16 v[24:27], v[36:39], v[64:71], v1
    ds_read_b128 v[60:63], v5 offset:5120
    v_smfmac_f32_16x16x64_bf16 v[28:31], v[36:39], a[248:255], v1
    ds_read_b128 v[64:67], v5 offset:6144
    v_smfmac_f32_16x16x64_bf16 v[32:35], v[36:39], a[240:247], v1
    ds_read_b128 v[68:71], v5 offset:7168
    v_smfmac_f32_16x16x64_bf16 v[12:15], v[36:39], a[232:239], v1
    ds_read_b128 v[44:47], v6 offset:15360
    s_waitcnt lgkmcnt(3)
    v_smfmac_f32_16x16x64_bf16 v[16:19], v[36:39], v[56:63], v1
    ds_read_b128 v[56:59], v5 offset:8192
    v_smfmac_f32_16x16x64_bf16 v[20:23], v[40:43], a[224:231], v1
    ds_read_b128 v[60:63], v5 offset:9216
    s_waitcnt lgkmcnt(3)
    v_smfmac_f32_16x16x64_bf16 v[24:27], v[40:43], v[64:71], v1
    ds_read_b128 v[64:67], v5 offset:10240
    v_smfmac_f32_16x16x64_bf16 v[28:31], v[40:43], a[216:223], v1
    ds_read_b128 v[68:71], v5 offset:11264
    v_smfmac_f32_16x16x64_bf16 v[32:35], v[40:43], a[208:215], v1
    ds_read_b128 v[48:51], v6 offset:16384
    s_waitcnt lgkmcnt(3)
    v_smfmac_f32_16x16x64_bf16 v[12:15], v[40:43], v[56:63], v1
    ds_read_b128 v[56:59], v5 offset:12288
    v_smfmac_f32_16x16x64_bf16 v[16:19], v[40:43], a[200:207], v1
    ds_read_b128 v[60:63], v5 offset:13312
    s_waitcnt lgkmcnt(3)
    v_smfmac_f32_16x16x64_bf16 v[20:23], v[44:47], v[64:71], v1
    ds_read_b128 v[64:67], v5 offset:14336
    v_smfmac_f32_16x16x64_bf16 v[24:27], v[44:47], a[192:199], v1
    ds_read_b128 v[68:71], v5 offset:15360
    v_smfmac_f32_16x16x64_bf16 v[28:31], v[44:47], a[184:191], v1
    ds_read_b128 v[52:55], v6 offset:17408
    s_waitcnt lgkmcnt(3)
    v_smfmac_f32_16x16x64_bf16 v[32:35], v[44:47], v[56:63], v1
    ds_read_b128 v[56:59], v5 offset:16384
    v_smfmac_f32_16x16x64_bf16 v[20:23], v[48:51], a[176:183], v1
    ds_read_b128 v[60:63], v5 offset:17408
    s_waitcnt lgkmcnt(3)
    v_max3_u32 v10, v36, v40, v44
    v_smfmac_f32_16x16x64_bf16 v[24:27], v[48:51], v[64:71], v1
    ds_read_b128 v[64:67], v5 offset:18432
    s_waitcnt lgkmcnt(3)
    v_max3_u32 v10, v10, v48, v52
    v_smfmac_f32_16x16x64_bf16 v[28:31], v[48:51], a[168:175], v1
    ds_read_b128 v[68:71], v5 offset:19456
    v_cmp_eq_u32 vcc, -1, v10
    v_smfmac_f32_16x16x64_bf16 v[32:35], v[48:51], a[160:167], v1
    s_cbranch_vccnz M_c0_2_lr
    s_waitcnt vmcnt(0)
    s_barrier
    ds_read_b128 v[36:39], v6 offset:8192
    ds_read_b128 v[40:43], v6 offset:9216
    s_waitcnt lgkmcnt(4)
    v_smfmac_f32_16x16x64_bf16 v[20:23], v[52:55], v[56:63], v1
    ds_read_b128 v[44:47], v6 offset:10240
    ds_read_b128 v[48:51], v6 offset:11264
    v_smfmac_f32_16x16x64_bf16 v[24:27], v[52:55], a[152:159], v1
    ds_read_b32 v11, v6 offset:12288
    ds_read_b128 v[56:59], v5 offset:20480
    s_waitcnt lgkmcnt(6)
    v_smfmac_f32_16x16x64_bf16 v[28:31], v[52:55], v[64:71], v1
    ds_read_b128 v[60:63], v5 offset:21504
    s_waitcnt lgkmcnt(4)
    v_max3_u32 v10, v36, v40, v44
    v_smfmac_f32_16x16x64_bf16 v[32:35], v[52:55], a[144:151], v1
    s_waitcnt lgkmcnt(2)
    v_max3_u32 v10, v10, v48, v11
    v_cmp_eq_u32 vcc, -1, v10
    s_cbranch_vccnz M_c0_2_rr
M_c0_2_rr_r:
    s_mov_b32 m0, 23040
    ds_read_b128 v[64:67], v5 offset:22528
    ds_read_b128 v[68:71], v5 offset:23552
    ds_read_b128 v[52:55], v6 offset:12288
    buffer_store_dwordx4 v[76:79], v0, s[8:11], s4 offen offset:2048 sc1
    s_mov_b32 s4, 0x10000000
    buffer_load_dword v9, s[8:11], s61 offen sc1 lds
    v_smfmac_f32_16x16x64_bf16 v[20:23], v[36:39], a[136:143], v1
    s_waitcnt lgkmcnt(3)
    v_smfmac_f32_16x16x64_bf16 v[24:27], v[36:39], v[56:63], v1
    ds_read_b128 v[56:59], v5 offset:24576
    v_smfmac_f32_16x16x64_bf16 v[20:23], v[40:43], a[128:135], v1
    ds_read_b128 v[60:63], v5 offset:25600
    s_waitcnt lgkmcnt(3)
    v_smfmac_f32_16x16x64_bf16 v[24:27], v[40:43], v[64:71], v1
    ds_read_b128 v[64:67], v5 offset:26624
    v_smfmac_f32_16x16x64_bf16 v[20:23], v[44:47], a[120:127], v1
    ds_read_b128 v[68:71], v5 offset:27648
    v_smfmac_f32_16x16x64_bf16 v[24:27], v[44:47], a[112:119], v1
    s_waitcnt lgkmcnt(2)
    v_smfmac_f32_16x16x64_bf16 v[20:23], v[48:51], v[56:63], v1
    ds_read_b128 v[56:59], v5 offset:28672
    v_smfmac_f32_16x16x64_bf16 v[24:27], v[48:51], a[104:111], v1
    ds_read_b128 v[60:63], v5 offset:29696
    s_waitcnt lgkmcnt(2)
    v_smfmac_f32_16x16x64_bf16 v[20:23], v[52:55], v[64:71], v1
    ds_read_b128 v[64:67], v5 offset:30720
    v_smfmac_f32_16x16x64_bf16 v[24:27], v[52:55], a[96:103], v1
    ds_read_b128 v[68:71], v5 offset:31744
    v_smfmac_f32_16x16x64_bf16 v[28:31], v[36:39], a[88:95], v1
    s_cmp_eq_u32 s57, 0
    s_cbranch_scc1 M_c0_2_first
M_c0_2_first_r:
    s_waitcnt lgkmcnt(2)
    v_smfmac_f32_16x16x64_bf16 v[32:35], v[36:39], v[56:63], v1
    ds_read_b128 v[56:59], v5 offset:32768
    v_permlane32_swap_b32 v20, v21
    v_smfmac_f32_16x16x64_bf16 v[28:31], v[40:43], a[80:87], v1
    ds_read_b128 v[60:63], v5 offset:33792
    s_waitcnt lgkmcnt(2)
    v_permlane32_swap_b32 v22, v23
    v_smfmac_f32_16x16x64_bf16 v[32:35], v[40:43], v[64:71], v1
    ds_read_b128 v[64:67], v0 offset:2048
    v_permlane32_swap_b32 v24, v25
    v_smfmac_f32_16x16x64_bf16 v[28:31], v[44:47], a[72:79], v1
    ds_read_b128 v[68:71], v0 offset:3072
    v_permlane32_swap_b32 v26, v27
    v_smfmac_f32_16x16x64_bf16 v[32:35], v[44:47], a[64:71], v1
    s_waitcnt lgkmcnt(2)
    v_add_f32 v20, v20, v21
    v_add_f32 v22, v22, v23
    v_smfmac_f32_16x16x64_bf16 v[28:31], v[48:51], v[56:63], v1
    ds_read_b128 v[56:59], v0 offset:0
    v_add_f32 v24, v24, v25
    v_add_f32 v26, v26, v27
    v_smfmac_f32_16x16x64_bf16 v[32:35], v[48:51], a[56:63], v1
    ds_read_b128 v[60:63], v0 offset:1024
    v_mul_f32 v20, s40, v20
    v_mul_f32 v24, s40, v24
    v_smfmac_f32_16x16x64_bf16 v[28:31], v[52:55], a[48:55], v1
    v_mul_f32 v22, s40, v22
    v_mul_f32 v26, s40, v26
    v_smfmac_f32_16x16x64_bf16 v[32:35], v[52:55], a[40:47], v1
    v_cvt_pk_bf16_f32 v20, v20, v24
    v_cvt_pk_bf16_f32 v21, v22, v26
    v_smfmac_f32_16x16x64_bf16 v[12:15], v[36:39], a[32:39], v1
    ds_write_b32 v2, v20 offset:18432
    v_smfmac_f32_16x16x64_bf16 v[16:19], v[36:39], a[24:31], v1
    ds_write_b32 v2, v21 offset:19008
    v_permlane32_swap_b32 v28, v29
    v_smfmac_f32_16x16x64_bf16 v[12:15], v[40:43], a[16:23], v1
    ds_read_b128 v[36:39], v6 offset:15360
    v_permlane32_swap_b32 v30, v31
    v_smfmac_f32_16x16x64_bf16 v[16:19], v[40:43], a[8:15], v1
    ds_read_b128 v[40:43], v6 offset:16384
    v_permlane32_swap_b32 v32, v33
    v_smfmac_f32_16x16x64_bf16 v[12:15], v[44:47], a[0:7], v1
    s_waitcnt lgkmcnt(2)
    s_barrier
    v_permlane32_swap_b32 v34, v35
    v_smfmac_f32_16x16x64_bf16 v[16:19], v[44:47], v[248:255], v1
    ds_read_b128 v[20:23], v3 offset:18432
    v_add_f32 v28, v28, v29
    v_add_f32 v30, v30, v31
    v_smfmac_f32_16x16x64_bf16 v[12:15], v[48:51], v[240:247], v1
    ds_read_b128 v[24:27], v3 offset:18496
    v_add_f32 v32, v32, v33
    v_add_f32 v34, v34, v35
    v_smfmac_f32_16x16x64_bf16 v[16:19], v[48:51], v[232:239], v1
    ds_read_b128 v[72:75], v3 offset:18560
    v_cvt_pk_bf16_f32 v28, v28, v32
    v_cvt_pk_bf16_f32 v29, v30, v34
    v_smfmac_f32_16x16x64_bf16 v[12:15], v[52:55], v[224:231], v1
    ds_write_b32 v2, v28 offset:20736
    ds_read_b128 v[44:47], v3 offset:18624
    v_smfmac_f32_16x16x64_bf16 v[16:19], v[52:55], v[216:223], v1
    ds_write_b32 v2, v29 offset:21312
    s_waitcnt lgkmcnt(7)
    v_smfmac_f32_16x16x64_bf16 v[12:15], v[36:39], v[208:215], v1
    ds_read_b128 v[48:51], v6 offset:17408
    v_mov_b64 v[10:11], s[16:17]
    v_smfmac_f32_16x16x64_bf16 v[16:19], v[36:39], v[200:207], v1
    s_waitcnt lgkmcnt(6)
    v_mfma_f32_16x16x32_bf16 v[28:31], v[56:59], v[20:23], 0
    ds_read_b128 v[56:59], v0 offset:4096
    s_waitcnt lgkmcnt(6)
    v_mfma_f32_16x16x32_bf16 v[28:31], v[60:63], v[24:27], v[28:31]
    ds_read_b128 v[60:63], v0 offset:5120
    s_waitcnt lgkmcnt(3)
    s_barrier
    v_mfma_f32_16x16x32_bf16 v[28:31], v[64:67], v[72:75], v[28:31]
    ds_read_b128 v[64:67], v0 offset:6144
    v_mfma_f32_16x16x32_bf16 v[28:31], v[68:71], v[44:47], v[28:31]
    ds_read_b128 v[68:71], v0 offset:7168
    v_smfmac_f32_16x16x64_bf16 v[12:15], v[40:43], v[192:199], v1
    ds_read_b128 v[36:39], v3 offset:20736
    v_smfmac_f32_16x16x64_bf16 v[16:19], v[40:43], v[184:191], v1
    ds_read_b128 v[52:55], v3 offset:20800
    s_waitcnt lgkmcnt(4)
    v_mfma_f32_16x16x32_bf16 v[32:35], v[56:59], v[20:23], 0
    s_nop 0
    v_exp_f32 v28, v28
    ds_read_b128 v[56:59], v3 offset:20864
    v_mfma_f32_16x16x32_bf16 v[32:35], v[60:63], v[24:27], v[32:35]
    s_waitcnt lgkmcnt(3)
    v_exp_f32 v29, v29
    ds_read_b128 v[60:63], v3 offset:20928
    v_mfma_f32_16x16x32_bf16 v[32:35], v[64:67], v[72:75], v[32:35]
    v_exp_f32 v30, v30
    v_mfma_f32_16x16x32_bf16 v[32:35], v[68:71], v[44:47], v[32:35]
    s_waitcnt lgkmcnt(3)
    v_exp_f32 v31, v31
    v_mfma_f32_16x16x32_bf16 v[40:43], v[36:39], v[20:23], 0
    s_waitcnt lgkmcnt(2)
    v_cvt_pk_bf16_f32 v28, v28, v29
    v_cvt_pk_bf16_f32 v29, v30, v31
    v_mfma_f32_16x16x32_bf16 v[40:43], v[52:55], v[24:27], v[40:43]
    s_waitcnt lgkmcnt(1)
    v_mov_b64 v[64:65], s[24:25]
    v_mov_b64 v[66:67], s[24:25]
    v_mfma_f32_16x16x32_bf16 v[40:43], v[56:59], v[72:75], v[40:43]
    s_waitcnt lgkmcnt(0)
    v_exp_f32 v32, v32
    v_mfma_f32_16x16x32_bf16 v[40:43], v[60:63], v[44:47], v[40:43]
    v_exp_f32 v33, v33
    v_smfmac_f32_16x16x64_bf16 v[12:15], v[48:51], v[176:183], v1
    v_exp_f32 v34, v34
    v_smfmac_f32_16x16x64_bf16 v[16:19], v[48:51], v[168:175], v1
    v_exp_f32 v35, v35
    v_cvt_pk_bf16_f32 v30, v32, v33
    v_cvt_pk_bf16_f32 v31, v34, v35
    s_nop 0
    v_exp_f32 v40, v40
    v_mfma_f32_16x16x32_bf16 v[72:75], v[64:67], v[28:31], 0
    v_exp_f32 v41, v41
    v_mfma_f32_16x16x32_bf16 v[20:23], v[80:83], v[28:31], 0
    v_exp_f32 v42, v42
    v_mfma_f32_16x16x32_bf16 v[24:27], v[84:87], v[28:31], 0
    v_exp_f32 v43, v43
    v_cvt_pk_bf16_f32 v40, v40, v41
    v_cvt_pk_bf16_f32 v41, v42, v43
    v_cvt_pk_bf16_f32 v12, v12, v13
    v_cvt_pk_bf16_f32 v13, v14, v15
    v_mfma_f32_16x16x16_bf16 v[72:75], v[10:11], v[40:41], v[72:75]
    v_cvt_pk_bf16_f32 v14, v16, v17
    v_cvt_pk_bf16_f32 v15, v18, v19
M_c0_2_fin:
    v_mfma_f32_16x16x16_bf16 v[20:23], v[12:13], v[40:41], v[20:23]
    s_cmp_eq_u32 s57, 63
    v_cndmask_b32_e64 v76, v12, v56, s[66:67]
    v_cndmask_b32_e64 v77, v13, v57, s[66:67]
    v_mfma_f32_16x16x16_bf16 v[24:27], v[14:15], v[40:41], v[24:27]
    v_cndmask_b32_e64 v78, v14, v58, s[66:67]
    v_cndmask_b32_e64 v79, v15, v59, s[66:67]
    s_cbranch_scc1 M_c0_2_last
    v_rcp_f32 v74, v72
    v_subrev_u32 v73, s68, v72
    v_cmp_lt_u32 vcc, s69, v73
    v_mov_b64 v[44:45], 0
    v_mov_b64 v[46:47], 0
    v_cndmask_b32_e64 v20, v20, v24, s[18:19]
    v_cndmask_b32_e64 v21, v21, v25, s[18:19]
    v_cndmask_b32_e64 v22, v22, v26, s[18:19]
    v_cndmask_b32_e64 v23, v23, v27, s[18:19]
    v_pk_mul_f32 v[20:21], v[20:21], v[74:75] op_sel_hi:[1,0]
    v_pk_mul_f32 v[22:23], v[22:23], v[74:75] op_sel_hi:[1,0]
    v_cvt_pk_bf16_f32 v20, v20, v21
    v_cvt_pk_bf16_f32 v21, v22, v23
    ds_write_b64 v0, v[20:21] offset:14336
    s_cbranch_vccnz M_c0_2_zbad
M_c0_2_zok:
    s_cmp_lt_u32 s54, s42
    s_cbranch_scc1 M_c0_2_first2
M_c0_2_first2_r:
    buffer_load_dwordx4 v[80:83], v0, s[8:11], s3 offen offset:0 sc1
    buffer_load_dwordx4 v[84:87], v0, s[8:11], s3 offen offset:1024 sc1
    s_waitcnt lgkmcnt(0)
    s_barrier
    ds_read_b128 v[32:35], v0 offset:13312
    ds_read_b128 v[52:55], v0 offset:14336
    s_mov_b32 m0, 4096
    s_nop 0
    buffer_load_dwordx4 v0, s[8:11], s26 offen offset:0 sc1 lds
    buffer_load_dwordx4 v0, s[8:11], s26 offen offset:1024 sc1 lds
    v_mov_b64 v[68:69], 0
    v_mov_b64 v[70:71], 0
    v_mov_b64 v[64:65], 0
    v_mov_b64 v[66:67], 0
    v_mov_b64 v[60:61], 0
    v_mov_b64 v[62:63], 0
    v_mov_b64 v[56:57], 0
    v_mov_b64 v[58:59], 0
    s_waitcnt lgkmcnt(1)
    s_nop 0
    v_smfmac_f32_16x16x64_bf16 v[56:59], v[32:35], v[160:167], v1
    v_smfmac_f32_16x16x64_bf16 v[60:63], v[32:35], v[144:151], v1
    s_waitcnt lgkmcnt(0)
    v_smfmac_f32_16x16x64_bf16 v[56:59], v[52:55], v[152:159], v1
    v_smfmac_f32_16x16x64_bf16 v[60:63], v[52:55], v[136:143], v1
    v_smfmac_f32_16x16x64_bf16 v[64:67], v[32:35], v[128:135], v1
    v_smfmac_f32_16x16x64_bf16 v[68:71], v[32:35], v[112:119], v1
    v_permlane32_swap_b32 v56, v57
    v_smfmac_f32_16x16x64_bf16 v[64:67], v[52:55], v[120:127], v1
    v_permlane32_swap_b32 v58, v59
    v_smfmac_f32_16x16x64_bf16 v[68:71], v[52:55], v[104:111], v1
    v_add_f32 v56, v56, v57
    v_add_f32 v58, v58, v59
    v_smfmac_f32_16x16x64_bf16 v[44:47], v[32:35], v[96:103], v1
    v_permlane32_swap_b32 v60, v61
    v_smfmac_f32_16x16x64_bf16 v[44:47], v[52:55], v[88:95], v1
    v_permlane32_swap_b32 v62, v63
    v_add_f32 v60, v60, v61
    v_add_f32 v62, v62, v63
    v_cvt_pk_bf16_f32 v36, v56, v60
    v_cvt_pk_bf16_f32 v38, v58, v62
    v_permlane32_swap_b32 v64, v65
    v_permlane32_swap_b32 v66, v67
    v_add_f32 v64, v64, v65
    v_add_f32 v66, v66, v67
    v_permlane32_swap_b32 v68, v69
    v_permlane32_swap_b32 v70, v71
    v_add_f32 v68, v68, v69
    v_add_f32 v70, v70, v71
    v_cvt_pk_bf16_f32 v37, v64, v68
    v_cvt_pk_bf16_f32 v39, v66, v70
    buffer_store_dwordx4 v[36:39], v0, s[8:11], s58 offen
    v_permlane32_swap_b32 v44, v45
    v_permlane32_swap_b32 v46, v47
    v_add_f32 v44, v44, v45
    v_add_f32 v46, v46, v47
    v_cvt_pk_bf16_f32 v44, v44, v46
    buffer_store_dword v44, v7, s[8:11], s55 offen
    s_add_u32 s27, s44, 1
    s_and_b32 s27, s27, 3
    s_mul_i32 s48, s27, 5120
    s_add_u32 s48, s48, s41
    s_lshl_b32 s27, s27, 15
    s_add_u32 s49, s27, s47
    ds_read_b128 v[56:59], v5 offset:0
    ds_read_b128 v[60:63], v5 offset:1024
    ds_read_b128 v[64:67], v5 offset:2048
    ds_read_b128 v[68:71], v5 offset:3072
    v_mov_b64 v[12:13], 0
    v_mov_b64 v[14:15], 0
    v_mov_b64 v[16:17], 0
    v_mov_b64 v[18:19], 0
    v_mov_b64 v[20:21], 0
    v_mov_b64 v[22:23], 0
    v_mov_b64 v[24:25], 0
    v_mov_b64 v[26:27], 0
    v_mov_b64 v[28:29], 0
    v_mov_b64 v[30:31], 0
    v_mov_b64 v[32:33], 0
    v_mov_b64 v[34:35], 0
    ds_read_b64 v[10:11], v0 offset:23296
    s_waitcnt lgkmcnt(0)
    v_min_u32 v10, v10, v11
    s_nop 0
    v_readfirstlane_b32 s28, v10
    s_nop 0
    s_max_u32 s54, s54, s28
    s_barrier
    s_and_b32 s26, s44, 63
    s_add_u32 s26, s26, 2
    s_min_u32 s26, s26, 63
    s_lshl_b32 s26, s26, 18
    s_add_u32 s26, s26, s50
    s_add_u32 s26, s26, 4096
    s_add_u32 s3, s26, 16777216
    s_lshl_b32 s4, s44, 18
    s_add_u32 s4, s4, s53
    s_add_u32 s44, s44, 1
    s_and_b32 s55, s44, 3
    s_mul_i32 s55, s55, 167936
    s_add_u32 s55, s55, s34
    s_add_u32 s58, s55, s35
    s_and_b32 s57, s44, 63
    s_add_u32 s42, s44, 2
    s_or_b32 s28, s44, 63
    s_add_u32 s28, s28, 1
    s_min_u32 s42, s42, s28
    s_sub_u32 s61, s3, 4096
    s_cmp_ge_u32 s54, s42
    s_cselect_b32 s61, s61, 0x10000000
    s_nop 15
    s_nop 15
    s_nop 5
    s_mov_b32 m0, 13312
    s_nop 0
    buffer_load_dwordx4 v0, s[8:11], s48 offen offset:0 sc1 lds
    buffer_load_dwordx4 v0, s[8:11], s48 offen offset:1024 sc1 lds
    buffer_load_dwordx4 v0, s[8:11], s48 offen offset:2048 sc1 lds
    s_nop 13
    s_mov_b32 m0, 13312
    s_nop 0
    buffer_load_dwordx4 v0, s[8:11], s48 offen offset:0 sc1 lds
    buffer_load_dwordx4 v0, s[8:11], s48 offen offset:1024 sc1 lds
    buffer_load_dwordx4 v0, s[8:11], s48 offen offset:2048 sc1 lds
    s_nop 13
    s_mov_b32 m0, 13312
    s_nop 0
    buffer_load_dwordx4 v0, s[8:11], s48 offen offset:0 sc1 lds
    buffer_load_dwordx4 v0, s[8:11], s48 offen offset:1024 sc1 lds
    buffer_load_dwordx4 v0, s[8:11], s48 offen offset:2048 sc1 lds
    s_mov_b32 s70, 0
    s_branch M_c0_2_top
M_c0_2_restart:
    s_waitcnt vmcnt(0) lgkmcnt(0)
    s_nop 7
    s_barrier
    s_mov_b32 m0, 13312
    s_nop 0
    buffer_load_dwordx4 v0, s[8:11], s48 offen offset:0 sc1 lds
    buffer_load_dwordx4 v0, s[8:11], s48 offen offset:1024 sc1 lds
    buffer_load_dwordx4 v0, s[8:11], s48 offen offset:2048 sc1 lds
    ds_read_b128 v[56:59], v5 offset:0
    ds_read_b128 v[60:63], v5 offset:1024
    ds_read_b128 v[64:67], v5 offset:2048
    ds_read_b128 v[68:71], v5 offset:3072
    v_mov_b64 v[12:13], 0
    v_mov_b64 v[14:15], 0
    v_mov_b64 v[16:17], 0
    v_mov_b64 v[18:19], 0
    v_mov_b64 v[20:21], 0
    v_mov_b64 v[22:23], 0
    v_mov_b64 v[24:25], 0
    v_mov_b64 v[26:27], 0
    v_mov_b64 v[28:29], 0
    v_mov_b64 v[30:31], 0
    v_mov_b64 v[32:33], 0
    v_mov_b64 v[34:35], 0
    s_waitcnt vmcnt(0) lgkmcnt(0)
    s_branch M_c0_2_top
M_c0_2_zbad:
    s_cmp_eq_u32 s70, 2
    s_cbranch_scc1 M_c0_2_zok
    v_cmp_u_f32 vcc, v72, v72
    s_cbranch_vccz M_c0_2_exact
    s_cmp_eq_u32 s70, 1
    s_cbranch_scc1 M_c0_2_exact
M_c0_2_vfy0:
    s_mov_b32 s70, 1
    s_mov_b32 s30, 0
    s_waitcnt vmcnt(0) lgkmcnt(0)
    s_nop 7
M_c0_2_vfy:
    v_mov_b32 v10, 0
    s_add_u32 s59, s48, 4096
    buffer_load_dwordx4 v[36:39], v0, s[8:11], s48 offen offset:0 sc1
    buffer_load_dwordx4 v[40:43], v0, s[8:11], s48 offen offset:1024 sc1
    buffer_load_dwordx4 v[44:47], v0, s[8:11], s48 offen offset:2048 sc1
    buffer_load_dwordx4 v[48:51], v0, s[8:11], s48 offen offset:3072 sc1
    buffer_load_dwordx4 v[52:55], v0, s[8:11], s59 offen offset:0 sc1
    s_waitcnt vmcnt(4)
    v_max3_u32 v10, v10, v36, v37
    v_max3_u32 v10, v10, v38, v39
    s_waitcnt vmcnt(3)
    v_max3_u32 v10, v10, v40, v41
    v_max3_u32 v10, v10, v42, v43
    s_waitcnt vmcnt(2)
    v_max3_u32 v10, v10, v44, v45
    v_max3_u32 v10, v10, v46, v47
    s_waitcnt vmcnt(1)
    v_max3_u32 v10, v10, v48, v49
    v_max3_u32 v10, v10, v50, v51
    s_waitcnt vmcnt(0)
    v_max3_u32 v10, v10, v52, v53
    v_max3_u32 v10, v10, v54, v55
    s_add_u32 s59, s49, 4096
    buffer_load_dwordx4 v[36:39], v0, s[8:11], s49 offen offset:0 sc1
    buffer_load_dwordx4 v[40:43], v0, s[8:11], s49 offen offset:1024 sc1
    buffer_load_dwordx4 v[44:47], v0, s[8:11], s49 offen offset:2048 sc1
    buffer_load_dwordx4 v[48:51], v0, s[8:11], s49 offen offset:3072 sc1
    buffer_load_dwordx4 v[52:55], v0, s[8:11], s59 offen offset:0 sc1
    s_waitcnt vmcnt(4)
    v_max3_u32 v10, v10, v36, v37
    v_max3_u32 v10, v10, v38, v39
    s_waitcnt vmcnt(3)
    v_max3_u32 v10, v10, v40, v41
    v_max3_u32 v10, v10, v42, v43
    s_waitcnt vmcnt(2)
    v_max3_u32 v10, v10, v44, v45
    v_max3_u32 v10, v10, v46, v47
    s_waitcnt vmcnt(1)
    v_max3_u32 v10, v10, v48, v49
    v_max3_u32 v10, v10, v50, v51
    s_waitcnt vmcnt(0)
    v_max3_u32 v10, v10, v52, v53
    v_max3_u32 v10, v10, v54, v55
    v_cmp_eq_u32 vcc, -1, v10
    s_cbranch_vccz M_c0_2_restart
    s_add_u32 s30, s30, 1
    s_cmp_ge_u32 s30, 60000
    s_cbranch_scc1 M_fail
    s_branch M_c0_2_vfy
M_c0_2_exact:
    s_nop 7
    s_mov_b32 s70, 2
    s_waitcnt lgkmcnt(0)
    ds_read_b128 v[20:23], v3 offset:18432
    ds_read_b128 v[24:27], v3 offset:18496
    ds_read_b128 v[72:75], v3 offset:18560
    ds_read_b128 v[44:47], v3 offset:18624
    ds_read_b128 v[56:59], v0 offset:0
    s_waitcnt lgkmcnt(0)
    v_mfma_f32_16x16x32_bf16 v[28:31], v[56:59], v[20:23], 0
    s_nop 3
    ds_read_b128 v[60:63], v0 offset:1024
    s_waitcnt lgkmcnt(0)
    v_mfma_f32_16x16x32_bf16 v[28:31], v[60:63], v[24:27], v[28:31]
    s_nop 3
    ds_read_b128 v[56:59], v0 offset:2048
    s_waitcnt lgkmcnt(0)
    v_mfma_f32_16x16x32_bf16 v[28:31], v[56:59], v[72:75], v[28:31]
    s_nop 3
    ds_read_b128 v[60:63], v0 offset:3072
    s_waitcnt lgkmcnt(0)
    v_mfma_f32_16x16x32_bf16 v[28:31], v[60:63], v[44:47], v[28:31]
    s_nop 3
    ds_read_b128 v[56:59], v0 offset:4096
    s_waitcnt lgkmcnt(0)
    v_mfma_f32_16x16x32_bf16 v[32:35], v[56:59], v[20:23], 0
    s_nop 3
    ds_read_b128 v[60:63], v0 offset:5120
    s_waitcnt lgkmcnt(0)
    v_mfma_f32_16x16x32_bf16 v[32:35], v[60:63], v[24:27], v[32:35]
    s_nop 3
    ds_read_b128 v[56:59], v0 offset:6144
    s_waitcnt lgkmcnt(0)
    v_mfma_f32_16x16x32_bf16 v[32:35], v[56:59], v[72:75], v[32:35]
    s_nop 3
    ds_read_b128 v[60:63], v0 offset:7168
    s_waitcnt lgkmcnt(0)
    v_mfma_f32_16x16x32_bf16 v[32:35], v[60:63], v[44:47], v[32:35]
    s_nop 3
    ds_read_b128 v[56:59], v3 offset:20736
    s_waitcnt lgkmcnt(0)
    v_mfma_f32_16x16x32_bf16 v[40:43], v[56:59], v[20:23], 0
    s_nop 3
    ds_read_b128 v[60:63], v3 offset:20800
    s_waitcnt lgkmcnt(0)
    v_mfma_f32_16x16x32_bf16 v[40:43], v[60:63], v[24:27], v[40:43]
    s_nop 3
    ds_read_b128 v[56:59], v3 offset:20864
    s_waitcnt lgkmcnt(0)
    v_mfma_f32_16x16x32_bf16 v[40:43], v[56:59], v[72:75], v[40:43]
    s_nop 3
    ds_read_b128 v[60:63], v3 offset:20928
    s_waitcnt lgkmcnt(0)
    v_mfma_f32_16x16x32_bf16 v[40:43], v[60:63], v[44:47], v[40:43]
    s_nop 3
    v_max3_f32 v68, v28, v29, v30
    v_max3_f32 v68, v68, v31, v32
    v_max3_f32 v68, v68, v33, v34
    s_nop 0
    v_max3_f32 v68, v68, v35, v40
    v_max3_f32 v68, v68, v41, v42
    v_max_f32 v68, v68, v43
    v_mov_b32 v69, v68
    s_nop 1
    v_permlane16_swap_b32 v68, v69
    v_max_f32 v68, v68, v69
    v_mov_b32 v69, v68
    s_nop 1
    v_permlane32_swap_b32 v68, v69
    v_max_f32 v68, v68, v69
    v_sub_f32 v28, v28, v68
    v_exp_f32 v28, v28
    v_sub_f32 v29, v29, v68
    v_exp_f32 v29, v29
    v_sub_f32 v30, v30, v68
    v_exp_f32 v30, v30
    v_sub_f32 v31, v31, v68
    v_exp_f32 v31, v31
    v_sub_f32 v32, v32, v68
    v_exp_f32 v32, v32
    v_sub_f32 v33, v33, v68
    v_exp_f32 v33, v33
    v_sub_f32 v34, v34, v68
    v_exp_f32 v34, v34
    v_sub_f32 v35, v35, v68
    v_exp_f32 v35, v35
    v_sub_f32 v40, v40, v68
    v_exp_f32 v40, v40
    v_sub_f32 v41, v41, v68
    v_exp_f32 v41, v41
    v_sub_f32 v42, v42, v68
    v_exp_f32 v42, v42
    v_sub_f32 v43, v43, v68
    v_exp_f32 v43, v43
    v_cvt_pk_bf16_f32 v28, v28, v29
    v_cvt_pk_bf16_f32 v29, v30, v31
    v_cvt_pk_bf16_f32 v30, v32, v33
    v_cvt_pk_bf16_f32 v31, v34, v35
    v_cvt_pk_bf16_f32 v40, v40, v41
    v_cvt_pk_bf16_f32 v41, v42, v43
    v_mfma_f32_16x16x32_bf16 v[20:23], v[80:83], v[28:31], 0
    v_mfma_f32_16x16x32_bf16 v[24:27], v[84:87], v[28:31], 0
    v_mfma_f32_16x16x32_bf16 v[72:75], v[64:67], v[28:31], 0
    ds_read_b128 v[56:59], v3 offset:20864
    s_waitcnt lgkmcnt(0)
    s_nop 7
    v_mfma_f32_16x16x16_bf16 v[72:75], v[10:11], v[40:41], v[72:75]
    s_nop 7
    s_branch M_c0_2_fin
M_c0_2_last:
    s_cmp_lg_u32 s70, 0
    s_cbranch_scc1 M_c0_2_last2
    v_cmp_u_f32 vcc, v32, v32
    s_cbranch_vccnz M_c0_2_vfy0
M_c0_2_last2:
    s_lshl_b32 s4, s44, 18
    s_add_u32 s4, s4, s53
    buffer_store_dwordx4 v[76:79], v0, s[8:11], s4 offen offset:2048 sc1
    s_mov_b32 s4, 0x10000000
    s_waitcnt vmcnt(0) lgkmcnt(0)
    s_barrier
    s_nop 7
    v_mov_b64 v[72:73], -1
    v_mov_b64 v[74:75], -1
    s_add_u32 s28, s44, 3
    s_and_b32 s29, s28, 3
    s_mul_i32 s31, s22, 160
    s_waitcnt vmcnt(0)
    s_add_u32 s44, s44, 1
    s_branch M_c_fft
    s_cmp_eq_u32 s44, 128
    s_cbranch_scc1 M_end
    s_branch M_c0_2_layer
M_c0_2_lr:
    s_mov_b32 s30, 0
M_c0_2_lr_l:
    s_waitcnt lgkmcnt(0)
    s_and_b32 s27, s30, 1
    s_cbranch_scc0 M_c0_2_lr_n
    s_waitcnt vmcnt(3)
    s_mov_b32 m0, 13312
    s_nop 0
    buffer_load_dwordx4 v0, s[8:11], s48 offen offset:0 sc1 lds
    buffer_load_dwordx4 v0, s[8:11], s48 offen offset:1024 sc1 lds
    buffer_load_dwordx4 v0, s[8:11], s48 offen offset:2048 sc1 lds
M_c0_2_lr_n:
    ds_read_b128 v[36:39], v6 offset:13312
    ds_read_b128 v[40:43], v6 offset:14336
    ds_read_b128 v[44:47], v6 offset:15360
    ds_read_b128 v[48:51], v6 offset:16384
    ds_read_b128 v[52:55], v6 offset:17408
    s_waitcnt lgkmcnt(2)
    v_max3_u32 v10, v36, v40, v44
    s_waitcnt lgkmcnt(0)
    v_max3_u32 v10, v10, v48, v52
    v_cmp_eq_u32 vcc, -1, v10
    s_cbranch_vccz M_c0_2_lr_d
    s_add_u32 s30, s30, 1
    s_cmp_ge_u32 s30, 480000
    s_cbranch_scc1 M_fail
    s_branch M_c0_2_lr_l
M_c0_2_lr_d:
    ds_read_b128 v[56:59], v5 offset:0
    ds_read_b128 v[60:63], v5 offset:1024
    ds_read_b128 v[64:67], v5 offset:2048
    ds_read_b128 v[68:71], v5 offset:3072
    v_mov_b64 v[12:13], 0
    v_mov_b64 v[14:15], 0
    v_mov_b64 v[16:17], 0
    v_mov_b64 v[18:19], 0
    v_mov_b64 v[20:21], 0
    v_mov_b64 v[22:23], 0
    v_mov_b64 v[24:25], 0
    v_mov_b64 v[26:27], 0
    v_mov_b64 v[28:29], 0
    v_mov_b64 v[30:31], 0
    v_mov_b64 v[32:33], 0
    v_mov_b64 v[34:35], 0
    s_waitcnt lgkmcnt(0)
    s_branch M_c0_2_lr_r
M_c0_2_rr:
    s_mov_b32 s30, 0
M_c0_2_rr_l:
    s_waitcnt lgkmcnt(0)
    s_and_b32 s27, s30, 1
    s_cbranch_scc1 M_c0_2_rr_n
    s_waitcnt vmcnt(1)
    s_mov_b32 m0, 8192
    s_nop 0
    buffer_load_dwordx4 v0, s[8:11], s49 offen offset:3072 sc1 lds
M_c0_2_rr_n:
    ds_read_b128 v[36:39], v6 offset:8192
    ds_read_b128 v[40:43], v6 offset:9216
    ds_read_b128 v[44:47], v6 offset:10240
    ds_read_b128 v[48:51], v6 offset:11264
    ds_read_b32 v11, v6 offset:12288
    s_waitcnt lgkmcnt(2)
    v_max3_u32 v10, v36, v40, v44
    s_waitcnt lgkmcnt(0)
    v_max3_u32 v10, v10, v48, v11
    v_cmp_eq_u32 vcc, -1, v10
    s_cbranch_vccz M_c0_2_rr_d
    s_add_u32 s30, s30, 1
    s_cmp_ge_u32 s30, 480000
    s_cbranch_scc1 M_fail
    s_branch M_c0_2_rr_l
M_c0_2_rr_d:
    s_branch M_c0_2_rr_r
M_c0_2_first:
    s_mul_i32 s27, s21, 167936
    s_add_u32 s27, s27, s34
    s_mul_i32 s28, s22, 4224
    s_add_u32 s28, s28, s27
    s_mov_b32 exec_hi, 0
    buffer_load_dword v10, v9, s[8:11], s28 offen sc1
    s_lshl_b32 s28, s22, 10
    s_add_u32 s28, s28, s27
    s_add_u32 s28, s28, 135168
    s_mov_b64 exec, 0xff
    buffer_load_dword v10, v9, s[8:11], s28 offen sc1
    s_mul_i32 s27, s21, 5120
    s_add_u32 s27, s27, s41
    s_mul_i32 s28, s22, 160
    s_add_u32 s28, s28, s27
    s_mov_b64 exec, 3
    buffer_load_dword v10, v9, s[8:11], s28 offen sc1
    s_mov_b64 exec, -1
    s_barrier
    s_and_b32 s26, s44, 63
    s_lshl_b32 s26, s26, 18
    s_add_u32 s26, s26, s50
    s_add_u32 s26, s26, 4096
    s_add_u32 s3, s26, 16777216
    s_mov_b32 m0, 4096
    s_nop 0
    buffer_load_dwordx4 v0, s[8:11], s26 offen offset:0 sc1 lds
    buffer_load_dwordx4 v0, s[8:11], s26 offen offset:1024 sc1 lds
    buffer_load_dwordx4 v[80:83], v0, s[8:11], s3 offen offset:0 sc1
    buffer_load_dwordx4 v[84:87], v0, s[8:11], s3 offen offset:1024 sc1
    s_and_b32 s26, s44, 63
    s_add_u32 s26, s26, 1
    s_min_u32 s26, s26, 63
    s_lshl_b32 s26, s26, 18
    s_add_u32 s26, s26, s50
    s_add_u32 s26, s26, 4096
    s_add_u32 s3, s26, 16777216
    s_waitcnt vmcnt(0) lgkmcnt(0)
    s_barrier
    s_branch M_c0_2_first_r
M_c0_2_first2:
    ds_read_b64 v[10:11], v0 offset:23296
    s_waitcnt lgkmcnt(0)
    v_min_u32 v10, v10, v11
    s_nop 0
    v_readfirstlane_b32 s28, v10
    s_nop 0
    s_max_u32 s54, s54, s28
    s_add_u32 s27, s44, 2
    s_or_b32 s28, s44, 63
    s_add_u32 s28, s28, 1
    s_min_u32 s27, s27, s28
    s_cmp_lt_u32 s54, s27
    s_cbranch_scc1 M_c0_2_p2
M_c0_2_p2_r:
    s_branch M_c0_2_first2_r
M_c0_2_p2:
    s_mov_b32 s30, 0
M_c0_2_p2_l:
    s_waitcnt lgkmcnt(0)
    s_mov_b64 exec, 3
    buffer_load_dword v10, v9, s[8:11], s51 offen sc1
    s_waitcnt vmcnt(0)
    s_mov_b64 exec, -1
    v_readlane_b32 s54, v10, 0
    v_readlane_b32 s28, v10, 1
    s_nop 3
    s_min_u32 s54, s54, s28
    s_cmp_ge_u32 s54, s27
    s_cbranch_scc1 M_c0_2_p2_r
    s_sleep 2
    s_add_u32 s30, s30, 1
    s_cmp_ge_u32 s30, 240000
    s_cbranch_scc1 M_fail
    s_branch M_c0_2_p2_l
M_c0_3_layer:
    s_lshr_b32 s27, s44, 6
    s_mul_i32 s50, s27, 33554432
    s_lshl_b32 s27, s22, 13
    s_add_u32 s50, s50, s27
    s_add_u32 s50, s50, 37748736
    s_barrier
    s_mov_b32 s26, 0x10010000
    s_mov_b32 s3, s26
    s_mul_i32 s27, s20, 5120
    s_add_u32 s48, s27, 167772160
    s_sub_u32 s49, 167777280, s27
    s_mov_b32 m0, 13312
    s_nop 0
    buffer_load_dwordx4 v0, s[8:11], s48 offen offset:3072 sc1 lds
    s_mov_b32 m0, 17408
    s_add_u32 s59, s48, 4096
    buffer_load_dwordx4 v0, s[8:11], s59 offen offset:0 sc1 lds
    s_and_b32 s55, s44, 3
    s_mul_i32 s55, s55, 167936
    s_add_u32 s55, s55, s34
    s_add_u32 s58, s55, s35
    s_and_b32 s57, s44, 63
    s_add_u32 s42, s44, 2
    s_or_b32 s28, s44, 63
    s_add_u32 s28, s28, 1
    s_min_u32 s42, s42, s28
    s_sub_u32 s61, s26, 6144
    s_cmp_ge_u32 s54, s42
    s_cselect_b32 s61, s61, 0x10000000
    ds_read_b128 v[56:59], v5 offset:0
    ds_read_b128 v[60:63], v5 offset:1024
    ds_read_b128 v[64:67], v5 offset:2048
    ds_read_b128 v[68:71], v5 offset:3072
    v_mov_b64 v[12:13], 0
    v_mov_b64 v[14:15], 0
    v_mov_b64 v[16:17], 0
    v_mov_b64 v[18:19], 0
    v_mov_b64 v[20:21], 0
    v_mov_b64 v[22:23], 0
    v_mov_b64 v[24:25], 0
    v_mov_b64 v[26:27], 0
    v_mov_b64 v[28:29], 0
    v_mov_b64 v[30:31], 0
    v_mov_b64 v[32:33], 0
    v_mov_b64 v[34:35], 0
    s_mov_b32 s70, 0
    s_waitcnt vmcnt(0) lgkmcnt(0)
M_c0_3_top:
    s_waitcnt vmcnt(4)
    s_barrier
    ds_read_b128 v[36:39], v6 offset:13312
    ds_read_b128 v[40:43], v6 offset:14336
    s_mov_b32 m0, 12288
    s_add_u32 s59, s49, 4096
    buffer_load_dwordx4 v0, s[8:11], s59 offen offset:0 sc1 lds
M_c0_3_lr_r:
    s_waitcnt lgkmcnt(1)
    v_smfmac_f32_16x16x64_bf16 v[20:23], v[36:39], v[56:63], v1
    ds_read_b128 v[56:59], v5 offset:4096
    v_smfmac_f32_16x16x64_bf16 v[24:27], v[36:39], v[64:71], v1
    ds_read_b128 v[60:63], v5 offset:5120
    v_smfmac_f32_16x16x64_bf16 v[28:31], v[36:39], a[248:255], v1
    ds_read_b128 v[64:67], v5 offset:6144
    v_smfmac_f32_16x16x64_bf16 v[32:35], v[36:39], a[240:247], v1
    ds_read_b128 v[68:71], v5 offset:7168
    v_smfmac_f32_16x16x64_bf16 v[12:15], v[36:39], a[232:239], v1
    ds_read_b128 v[44:47], v6 offset:15360
    s_waitcnt lgkmcnt(3)
    v_smfmac_f32_16x16x64_bf16 v[16:19], v[36:39], v[56:63], v1
    ds_read_b128 v[56:59], v5 offset:8192
    v_smfmac_f32_16x16x64_bf16 v[20:23], v[40:43], a[224:231], v1
    ds_read_b128 v[60:63], v5 offset:9216
    s_waitcnt lgkmcnt(3)
    v_smfmac_f32_16x16x64_bf16 v[24:27], v[40:43], v[64:71], v1
    ds_read_b128 v[64:67], v5 offset:10240
    v_smfmac_f32_16x16x64_bf16 v[28:31], v[40:43], a[216:223], v1
    ds_read_b128 v[68:71], v5 offset:11264
    v_smfmac_f32_16x16x64_bf16 v[32:35], v[40:43], a[208:215], v1
    ds_read_b128 v[48:51], v6 offset:16384
    s_waitcnt lgkmcnt(3)
    v_smfmac_f32_16x16x64_bf16 v[12:15], v[40:43], v[56:63], v1
    ds_read_b128 v[56:59], v5 offset:12288
    v_smfmac_f32_16x16x64_bf16 v[16:19], v[40:43], a[200:207], v1
    ds_read_b128 v[60:63], v5 offset:13312
    s_waitcnt lgkmcnt(3)
    v_smfmac_f32_16x16x64_bf16 v[20:23], v[44:47], v[64:71], v1
    ds_read_b128 v[64:67], v5 offset:14336
    v_smfmac_f32_16x16x64_bf16 v[24:27], v[44:47], a[192:199], v1
    ds_read_b128 v[68:71], v5 offset:15360
    v_smfmac_f32_16x16x64_bf16 v[28:31], v[44:47], a[184:191], v1
    ds_read_b128 v[52:55], v6 offset:17408
    s_waitcnt lgkmcnt(3)
    v_smfmac_f32_16x16x64_bf16 v[32:35], v[44:47], v[56:63], v1
    ds_read_b128 v[56:59], v5 offset:16384
    v_smfmac_f32_16x16x64_bf16 v[20:23], v[48:51], a[176:183], v1
    ds_read_b128 v[60:63], v5 offset:17408
    s_waitcnt lgkmcnt(3)
    v_max3_u32 v10, v36, v40, v44
    v_smfmac_f32_16x16x64_bf16 v[24:27], v[48:51], v[64:71], v1
    ds_read_b128 v[64:67], v5 offset:18432
    s_waitcnt lgkmcnt(3)
    v_max3_u32 v10, v10, v48, v52
    v_smfmac_f32_16x16x64_bf16 v[28:31], v[48:51], a[168:175], v1
    ds_read_b128 v[68:71], v5 offset:19456
    v_cmp_eq_u32 vcc, -1, v10
    v_smfmac_f32_16x16x64_bf16 v[32:35], v[48:51], a[160:167], v1
    s_cbranch_vccnz M_c0_3_lr
    s_waitcnt vmcnt(0)
    s_barrier
    ds_read_b128 v[36:39], v6 offset:8192
    ds_read_b128 v[40:43], v6 offset:9216
    s_waitcnt lgkmcnt(4)
    v_smfmac_f32_16x16x64_bf16 v[20:23], v[52:55], v[56:63], v1
    ds_read_b128 v[44:47], v6 offset:10240
    ds_read_b128 v[48:51], v6 offset:11264
    v_smfmac_f32_16x16x64_bf16 v[24:27], v[52:55], a[152:159], v1
    ds_read_b32 v11, v6 offset:12288
    ds_read_b128 v[56:59], v5 offset:20480
    s_waitcnt lgkmcnt(6)
    v_smfmac_f32_16x16x64_bf16 v[28:31], v[52:55], v[64:71], v1
    ds_read_b128 v[60:63], v5 offset:21504
    s_waitcnt lgkmcnt(4)
    v_max3_u32 v10, v36, v40, v44
    v_smfmac_f32_16x16x64_bf16 v[32:35], v[52:55], a[144:151], v1
    s_waitcnt lgkmcnt(2)
    v_max3_u32 v10, v10, v48, v11
    v_cmp_eq_u32 vcc, -1, v10
    s_cbranch_vccnz M_c0_3_rr
M_c0_3_rr_r:
    s_mov_b32 m0, 23040
    ds_read_b128 v[64:67], v5 offset:22528
    ds_read_b128 v[68:71], v5 offset:23552
    ds_read_b128 v[52:55], v6 offset:12288
    buffer_store_dwordx4 v[76:79], v0, s[8:11], s4 offen offset:3072 sc1
    s_mov_b32 s4, 0x10000000
    buffer_load_dword v9, s[8:11], s61 offen sc1 lds
    v_smfmac_f32_16x16x64_bf16 v[20:23], v[36:39], a[136:143], v1
    s_waitcnt lgkmcnt(3)
    v_smfmac_f32_16x16x64_bf16 v[24:27], v[36:39], v[56:63], v1
    ds_read_b128 v[56:59], v5 offset:24576
    v_smfmac_f32_16x16x64_bf16 v[20:23], v[40:43], a[128:135], v1
    ds_read_b128 v[60:63], v5 offset:25600
    s_waitcnt lgkmcnt(3)
    v_smfmac_f32_16x16x64_bf16 v[24:27], v[40:43], v[64:71], v1
    ds_read_b128 v[64:67], v5 offset:26624
    v_smfmac_f32_16x16x64_bf16 v[20:23], v[44:47], a[120:127], v1
    ds_read_b128 v[68:71], v5 offset:27648
    v_smfmac_f32_16x16x64_bf16 v[24:27], v[44:47], a[112:119], v1
    s_waitcnt lgkmcnt(2)
    v_smfmac_f32_16x16x64_bf16 v[20:23], v[48:51], v[56:63], v1
    ds_read_b128 v[56:59], v5 offset:28672
    v_smfmac_f32_16x16x64_bf16 v[24:27], v[48:51], a[104:111], v1
    ds_read_b128 v[60:63], v5 offset:29696
    s_waitcnt lgkmcnt(2)
    v_smfmac_f32_16x16x64_bf16 v[20:23], v[52:55], v[64:71], v1
    ds_read_b128 v[64:67], v5 offset:30720
    v_smfmac_f32_16x16x64_bf16 v[24:27], v[52:55], a[96:103], v1
    ds_read_b128 v[68:71], v5 offset:31744
    v_smfmac_f32_16x16x64_bf16 v[28:31], v[36:39], a[88:95], v1
    s_cmp_eq_u32 s57, 0
    s_cbranch_scc1 M_c0_3_first
M_c0_3_first_r:
    s_waitcnt lgkmcnt(2)
    v_smfmac_f32_16x16x64_bf16 v[32:35], v[36:39], v[56:63], v1
    ds_read_b128 v[56:59], v5 offset:32768
    v_permlane32_swap_b32 v20, v21
    v_smfmac_f32_16x16x64_bf16 v[28:31], v[40:43], a[80:87], v1
    ds_read_b128 v[60:63], v5 offset:33792
    s_waitcnt lgkmcnt(2)
    v_permlane32_swap_b32 v22, v23
    v_smfmac_f32_16x16x64_bf16 v[32:35], v[40:43], v[64:71], v1
    ds_read_b128 v[64:67], v0 offset:2048
    v_permlane32_swap_b32 v24, v25
    v_smfmac_f32_16x16x64_bf16 v[28:31], v[44:47], a[72:79], v1
    ds_read_b128 v[68:71], v0 offset:3072
    v_permlane32_swap_b32 v26, v27
    v_smfmac_f32_16x16x64_bf16 v[32:35], v[44:47], a[64:71], v1
    s_waitcnt lgkmcnt(2)
    v_add_f32 v20, v20, v21
    v_add_f32 v22, v22, v23
    v_smfmac_f32_16x16x64_bf16 v[28:31], v[48:51], v[56:63], v1
    ds_read_b128 v[56:59], v0 offset:0
    v_add_f32 v24, v24, v25
    v_add_f32 v26, v26, v27
    v_smfmac_f32_16x16x64_bf16 v[32:35], v[48:51], a[56:63], v1
    ds_read_b128 v[60:63], v0 offset:1024
    v_mul_f32 v20, s40, v20
    v_mul_f32 v24, s40, v24
    v_smfmac_f32_16x16x64_bf16 v[28:31], v[52:55], a[48:55], v1
    v_mul_f32 v22, s40, v22
    v_mul_f32 v26, s40, v26
    v_smfmac_f32_16x16x64_bf16 v[32:35], v[52:55], a[40:47], v1
    v_cvt_pk_bf16_f32 v20, v20, v24
    v_cvt_pk_bf16_f32 v21, v22, v26
    v_smfmac_f32_16x16x64_bf16 v[12:15], v[36:39], a[32:39], v1
    ds_write_b32 v2, v20 offset:18432
    v_smfmac_f32_16x16x64_bf16 v[16:19], v[36:39], a[24:31], v1
    ds_write_b32 v2, v21 offset:19008
    v_permlane32_swap_b32 v28, v29
    v_smfmac_f32_16x16x64_bf16 v[12:15], v[40:43], a[16:23], v1
    ds_read_b128 v[36:39], v6 offset:15360
    v_permlane32_swap_b32 v30, v31
    v_smfmac_f32_16x16x64_bf16 v[16:19], v[40:43], a[8:15], v1
    ds_read_b128 v[40:43], v6 offset:16384
    v_permlane32_swap_b32 v32, v33
    v_smfmac_f32_16x16x64_bf16 v[12:15], v[44:47], a[0:7], v1
    s_waitcnt lgkmcnt(2)
    s_barrier
    v_permlane32_swap_b32 v34, v35
    v_smfmac_f32_16x16x64_bf16 v[16:19], v[44:47], v[248:255], v1
    ds_read_b128 v[20:23], v3 offset:18432
    v_add_f32 v28, v28, v29
    v_add_f32 v30, v30, v31
    v_smfmac_f32_16x16x64_bf16 v[12:15], v[48:51], v[240:247], v1
    ds_read_b128 v[24:27], v3 offset:18496
    v_add_f32 v32, v32, v33
    v_add_f32 v34, v34, v35
    v_smfmac_f32_16x16x64_bf16 v[16:19], v[48:51], v[232:239], v1
    ds_read_b128 v[72:75], v3 offset:18560
    v_cvt_pk_bf16_f32 v28, v28, v32
    v_cvt_pk_bf16_f32 v29, v30, v34
    v_smfmac_f32_16x16x64_bf16 v[12:15], v[52:55], v[224:231], v1
    ds_write_b32 v2, v28 offset:20736
    ds_read_b128 v[44:47], v3 offset:18624
    v_smfmac_f32_16x16x64_bf16 v[16:19], v[52:55], v[216:223], v1
    ds_write_b32 v2, v29 offset:21312
    s_waitcnt lgkmcnt(7)
    v_smfmac_f32_16x16x64_bf16 v[12:15], v[36:39], v[208:215], v1
    ds_read_b128 v[48:51], v6 offset:17408
    v_mov_b64 v[10:11], s[16:17]
    v_smfmac_f32_16x16x64_bf16 v[16:19], v[36:39], v[200:207], v1
    s_waitcnt lgkmcnt(6)
    v_mfma_f32_16x16x32_bf16 v[28:31], v[56:59], v[20:23], 0
    ds_read_b128 v[56:59], v0 offset:4096
    s_waitcnt lgkmcnt(6)
    v_mfma_f32_16x16x32_bf16 v[28:31], v[60:63], v[24:27], v[28:31]
    ds_read_b128 v[60:63], v0 offset:5120
    s_waitcnt lgkmcnt(3)
    s_barrier
    v_mfma_f32_16x16x32_bf16 v[28:31], v[64:67], v[72:75], v[28:31]
    ds_read_b128 v[64:67], v0 offset:6144
    v_mfma_f32_16x16x32_bf16 v[28:31], v[68:71], v[44:47], v[28:31]
    ds_read_b128 v[68:71], v0 offset:7168
    v_smfmac_f32_16x16x64_bf16 v[12:15], v[40:43], v[192:199], v1
    ds_read_b128 v[36:39], v3 offset:20736
    v_smfmac_f32_16x16x64_bf16 v[16:19], v[40:43], v[184:191], v1
    ds_read_b128 v[52:55], v3 offset:20800
    s_waitcnt lgkmcnt(4)
    v_mfma_f32_16x16x32_bf16 v[32:35], v[56:59], v[20:23], 0
    s_nop 0
    v_exp_f32 v28, v28
    ds_read_b128 v[56:59], v3 offset:20864
    v_mfma_f32_16x16x32_bf16 v[32:35], v[60:63], v[24:27], v[32:35]
    s_waitcnt lgkmcnt(3)
    v_exp_f32 v29, v29
    ds_read_b128 v[60:63], v3 offset:20928
    v_mfma_f32_16x16x32_bf16 v[32:35], v[64:67], v[72:75], v[32:35]
    v_exp_f32 v30, v30
    v_mfma_f32_16x16x32_bf16 v[32:35], v[68:71], v[44:47], v[32:35]
    s_waitcnt lgkmcnt(3)
    v_exp_f32 v31, v31
    v_mfma_f32_16x16x32_bf16 v[40:43], v[36:39], v[20:23], 0
    s_waitcnt lgkmcnt(2)
    v_cvt_pk_bf16_f32 v28, v28, v29
    v_cvt_pk_bf16_f32 v29, v30, v31
    v_mfma_f32_16x16x32_bf16 v[40:43], v[52:55], v[24:27], v[40:43]
    s_waitcnt lgkmcnt(1)
    v_mov_b64 v[64:65], s[24:25]
    v_mov_b64 v[66:67], s[24:25]
    v_mfma_f32_16x16x32_bf16 v[40:43], v[56:59], v[72:75], v[40:43]
    s_waitcnt lgkmcnt(0)
    v_exp_f32 v32, v32
    v_mfma_f32_16x16x32_bf16 v[40:43], v[60:63], v[44:47], v[40:43]
    v_exp_f32 v33, v33
    v_smfmac_f32_16x16x64_bf16 v[12:15], v[48:51], v[176:183], v1
    v_exp_f32 v34, v34
    v_smfmac_f32_16x16x64_bf16 v[16:19], v[48:51], v[168:175], v1
    v_exp_f32 v35, v35
    v_cvt_pk_bf16_f32 v30, v32, v33
    v_cvt_pk_bf16_f32 v31, v34, v35
    s_nop 0
    v_exp_f32 v40, v40
    v_mfma_f32_16x16x32_bf16 v[72:75], v[64:67], v[28:31], 0
    v_exp_f32 v41, v41
    v_mfma_f32_16x16x32_bf16 v[20:23], v[80:83], v[28:31], 0
    v_exp_f32 v42, v42
    v_mfma_f32_16x16x32_bf16 v[24:27], v[84:87], v[28:31], 0
    v_exp_f32 v43, v43
    v_cvt_pk_bf16_f32 v40, v40, v41
    v_cvt_pk_bf16_f32 v41, v42, v43
    v_cvt_pk_bf16_f32 v12, v12, v13
    v_cvt_pk_bf16_f32 v13, v14, v15
    v_mfma_f32_16x16x16_bf16 v[72:75], v[10:11], v[40:41], v[72:75]
    v_cvt_pk_bf16_f32 v14, v16, v17
    v_cvt_pk_bf16_f32 v15, v18, v19
M_c0_3_fin:
    v_mfma_f32_16x16x16_bf16 v[20:23], v[12:13], v[40:41], v[20:23]
    s_cmp_eq_u32 s57, 63
    v_cndmask_b32_e64 v76, v12, v60, s[66:67]
    v_cndmask_b32_e64 v77, v13, v61, s[66:67]
    v_mfma_f32_16x16x16_bf16 v[24:27], v[14:15], v[40:41], v[24:27]
    v_cndmask_b32_e64 v78, v14, v62, s[66:67]
    v_cndmask_b32_e64 v79, v15, v63, s[66:67]
    s_cbranch_scc1 M_c0_3_last
    v_rcp_f32 v74, v72
    v_subrev_u32 v73, s68, v72
    v_cmp_lt_u32 vcc, s69, v73
    v_mov_b64 v[44:45], 0
    v_mov_b64 v[46:47], 0
    v_cndmask_b32_e64 v20, v20, v24, s[18:19]
    v_cndmask_b32_e64 v21, v21, v25, s[18:19]
    v_cndmask_b32_e64 v22, v22, v26, s[18:19]
    v_cndmask_b32_e64 v23, v23, v27, s[18:19]
    v_pk_mul_f32 v[20:21], v[20:21], v[74:75] op_sel_hi:[1,0]
    v_pk_mul_f32 v[22:23], v[22:23], v[74:75] op_sel_hi:[1,0]
    v_cvt_pk_bf16_f32 v20, v20, v21
    v_cvt_pk_bf16_f32 v21, v22, v23
    ds_write_b64 v0, v[20:21] offset:14344
    s_cbranch_vccnz M_c0_3_zbad
M_c0_3_zok:
    s_cmp_lt_u32 s54, s42
    s_cbranch_scc1 M_c0_3_first2
M_c0_3_first2_r:
    buffer_load_dwordx4 v[80:83], v0, s[8:11], s3 offen offset:0 sc1
    buffer_load_dwordx4 v[84:87], v0, s[8:11], s3 offen offset:1024 sc1
    s_waitcnt lgkmcnt(0)
    s_barrier
    ds_read_b128 v[32:35], v0 offset:13312
    ds_read_b128 v[52:55], v0 offset:14336
    s_mov_b32 m0, 6144
    s_nop 0
    buffer_load_dwordx4 v0, s[8:11], s26 offen offset:0 sc1 lds
    buffer_load_dwordx4 v0, s[8:11], s26 offen offset:1024 sc1 lds
    v_mov_b64 v[68:69], 0
    v_mov_b64 v[70:71], 0
    v_mov_b64 v[64:65], 0
    v_mov_b64 v[66:67], 0
    v_mov_b64 v[60:61], 0
    v_mov_b64 v[62:63], 0
    v_mov_b64 v[56:57], 0
    v_mov_b64 v[58:59], 0
    s_waitcnt lgkmcnt(1)
    s_nop 0
    v_smfmac_f32_16x16x64_bf16 v[56:59], v[32:35], v[160:167], v1
    v_smfmac_f32_16x16x64_bf16 v[60:63], v[32:35], v[144:151], v1
    s_waitcnt lgkmcnt(0)
    v_smfmac_f32_16x16x64_bf16 v[56:59], v[52:55], v[152:159], v1
    v_smfmac_f32_16x16x64_bf16 v[60:63], v[52:55], v[136:143], v1
    v_smfmac_f32_16x16x64_bf16 v[64:67], v[32:35], v[128:135], v1
    v_smfmac_f32_16x16x64_bf16 v[68:71], v[32:35], v[112:119], v1
    v_permlane32_swap_b32 v56, v57
    v_smfmac_f32_16x16x64_bf16 v[64:67], v[52:55], v[120:127], v1
    v_permlane32_swap_b32 v58, v59
    v_smfmac_f32_16x16x64_bf16 v[68:71], v[52:55], v[104:111], v1
    v_add_f32 v56, v56, v57
    v_add_f32 v58, v58, v59
    v_smfmac_f32_16x16x64_bf16 v[44:47], v[32:35], v[96:103], v1
    v_permlane32_swap_b32 v60, v61
    v_smfmac_f32_16x16x64_bf16 v[44:47], v[52:55], v[88:95], v1
    v_permlane32_swap_b32 v62, v63
    v_add_f32 v60, v60, v61
    v_add_f32 v62, v62, v63
    v_cvt_pk_bf16_f32 v36, v56, v60
    v_cvt_pk_bf16_f32 v38, v58, v62
    v_permlane32_swap_b32 v64, v65
    v_permlane32_swap_b32 v66, v67
    v_add_f32 v64, v64, v65
    v_add_f32 v66, v66, v67
    v_permlane32_swap_b32 v68, v69
    v_permlane32_swap_b32 v70, v71
    v_add_f32 v68, v68, v69
    v_add_f32 v70, v70, v71
    v_cvt_pk_bf16_f32 v37, v64, v68
    v_cvt_pk_bf16_f32 v39, v66, v70
    buffer_store_dwordx4 v[36:39], v0, s[8:11], s58 offen
    v_permlane32_swap_b32 v44, v45
    v_permlane32_swap_b32 v46, v47
    v_add_f32 v44, v44, v45
    v_add_f32 v46, v46, v47
    v_cvt_pk_bf16_f32 v44, v44, v46
    buffer_store_dword v44, v7, s[8:11], s55 offen
    s_add_u32 s27, s44, 1
    s_and_b32 s27, s27, 3
    s_mul_i32 s48, s27, 5120
    s_add_u32 s48, s48, s41
    s_lshl_b32 s27, s27, 15
    s_add_u32 s49, s27, s47
    ds_read_b128 v[56:59], v5 offset:0
    ds_read_b128 v[60:63], v5 offset:1024
    ds_read_b128 v[64:67], v5 offset:2048
    ds_read_b128 v[68:71], v5 offset:3072
    v_mov_b64 v[12:13], 0
    v_mov_b64 v[14:15], 0
    v_mov_b64 v[16:17], 0
    v_mov_b64 v[18:19], 0
    v_mov_b64 v[20:21], 0
    v_mov_b64 v[22:23], 0
    v_mov_b64 v[24:25], 0
    v_mov_b64 v[26:27], 0
    v_mov_b64 v[28:29], 0
    v_mov_b64 v[30:31], 0
    v_mov_b64 v[32:33], 0
    v_mov_b64 v[34:35], 0
    ds_read_b64 v[10:11], v0 offset:23296
    s_waitcnt lgkmcnt(0)
    v_min_u32 v10, v10, v11
    s_nop 0
    v_readfirstlane_b32 s28, v10
    s_nop 0
    s_max_u32 s54, s54, s28
    s_barrier
    s_and_b32 s26, s44, 63
    s_add_u32 s26, s26, 2
    s_min_u32 s26, s26, 63
    s_lshl_b32 s26, s26, 18
    s_add_u32 s26, s26, s50
    s_add_u32 s26, s26, 6144
    s_add_u32 s3, s26, 16777216
    s_lshl_b32 s4, s44, 18
    s_add_u32 s4, s4, s53
    s_add_u32 s44, s44, 1
    s_and_b32 s55, s44, 3
    s_mul_i32 s55, s55, 167936
    s_add_u32 s55, s55, s34
    s_add_u32 s58, s55, s35
    s_and_b32 s57, s44, 63
    s_add_u32 s42, s44, 2
    s_or_b32 s28, s44, 63
    s_add_u32 s28, s28, 1
    s_min_u32 s42, s42, s28
    s_sub_u32 s61, s26, 6144
    s_cmp_ge_u32 s54, s42
    s_cselect_b32 s61, s61, 0x10000000
    s_nop 15
    s_nop 15
    s_nop 5
    s_mov_b32 m0, 13312
    s_nop 0
    buffer_load_dwordx4 v0, s[8:11], s48 offen offset:3072 sc1 lds
    s_mov_b32 m0, 17408
    s_add_u32 s59, s48, 4096
    buffer_load_dwordx4 v0, s[8:11], s59 offen offset:0 sc1 lds
    s_nop 13
    s_mov_b32 m0, 13312
    s_nop 0
    buffer_load_dwordx4 v0, s[8:11], s48 offen offset:3072 sc1 lds
    s_mov_b32 m0, 17408
    s_add_u32 s59, s48, 4096
    buffer_load_dwordx4 v0, s[8:11], s59 offen offset:0 sc1 lds
    s_nop 13
    s_mov_b32 m0, 13312
    s_nop 0
    buffer_load_dwordx4 v0, s[8:11], s48 offen offset:3072 sc1 lds
    s_mov_b32 m0, 17408
    s_add_u32 s59, s48, 4096
    buffer_load_dwordx4 v0, s[8:11], s59 offen offset:0 sc1 lds
    s_mov_b32 s70, 0
    s_branch M_c0_3_top
M_c0_3_restart:
    s_waitcnt vmcnt(0) lgkmcnt(0)
    s_nop 7
    s_barrier
    s_mov_b32 m0, 13312
    s_nop 0
    buffer_load_dwordx4 v0, s[8:11], s48 offen offset:3072 sc1 lds
    s_mov_b32 m0, 17408
    s_add_u32 s59, s48, 4096
    buffer_load_dwordx4 v0, s[8:11], s59 offen offset:0 sc1 lds
    ds_read_b128 v[56:59], v5 offset:0
    ds_read_b128 v[60:63], v5 offset:1024
    ds_read_b128 v[64:67], v5 offset:2048
    ds_read_b128 v[68:71], v5 offset:3072
    v_mov_b64 v[12:13], 0
    v_mov_b64 v[14:15], 0
    v_mov_b64 v[16:17], 0
    v_mov_b64 v[18:19], 0
    v_mov_b64 v[20:21], 0
    v_mov_b64 v[22:23], 0
    v_mov_b64 v[24:25], 0
    v_mov_b64 v[26:27], 0
    v_mov_b64 v[28:29], 0
    v_mov_b64 v[30:31], 0
    v_mov_b64 v[32:33], 0
    v_mov_b64 v[34:35], 0
    s_waitcnt vmcnt(0) lgkmcnt(0)
    s_branch M_c0_3_top
M_c0_3_zbad:
    s_cmp_eq_u32 s70, 2
    s_cbranch_scc1 M_c0_3_zok
    v_cmp_u_f32 vcc, v72, v72
    s_cbranch_vccz M_c0_3_exact
    s_cmp_eq_u32 s70, 1
    s_cbranch_scc1 M_c0_3_exact
M_c0_3_vfy0:
    s_mov_b32 s70, 1
    s_mov_b32 s30, 0
    s_waitcnt vmcnt(0) lgkmcnt(0)
    s_nop 7
M_c0_3_vfy:
    v_mov_b32 v10, 0
    s_add_u32 s59, s48, 4096
    buffer_load_dwordx4 v[36:39], v0, s[8:11], s48 offen offset:0 sc1
    buffer_load_dwordx4 v[40:43], v0, s[8:11], s48 offen offset:1024 sc1
    buffer_load_dwordx4 v[44:47], v0, s[8:11], s48 offen offset:2048 sc1
    buffer_load_dwordx4 v[48:51], v0, s[8:11], s48 offen offset:3072 sc1
    buffer_load_dwordx4 v[52:55], v0, s[8:11], s59 offen offset:0 sc1
    s_waitcnt vmcnt(4)
    v_max3_u32 v10, v10, v36, v37
    v_max3_u32 v10, v10, v38, v39
    s_waitcnt vmcnt(3)
    v_max3_u32 v10, v10, v40, v41
    v_max3_u32 v10, v10, v42, v43
    s_waitcnt vmcnt(2)
    v_max3_u32 v10, v10, v44, v45
    v_max3_u32 v10, v10, v46, v47
    s_waitcnt vmcnt(1)
    v_max3_u32 v10, v10, v48, v49
    v_max3_u32 v10, v10, v50, v51
    s_waitcnt vmcnt(0)
    v_max3_u32 v10, v10, v52, v53
    v_max3_u32 v10, v10, v54, v55
    s_add_u32 s59, s49, 4096
    buffer_load_dwordx4 v[36:39], v0, s[8:11], s49 offen offset:0 sc1
    buffer_load_dwordx4 v[40:43], v0, s[8:11], s49 offen offset:1024 sc1
    buffer_load_dwordx4 v[44:47], v0, s[8:11], s49 offen offset:2048 sc1
    buffer_load_dwordx4 v[48:51], v0, s[8:11], s49 offen offset:3072 sc1
    buffer_load_dwordx4 v[52:55], v0, s[8:11], s59 offen offset:0 sc1
    s_waitcnt vmcnt(4)
    v_max3_u32 v10, v10, v36, v37
    v_max3_u32 v10, v10, v38, v39
    s_waitcnt vmcnt(3)
    v_max3_u32 v10, v10, v40, v41
    v_max3_u32 v10, v10, v42, v43
    s_waitcnt vmcnt(2)
    v_max3_u32 v10, v10, v44, v45
    v_max3_u32 v10, v10, v46, v47
    s_waitcnt vmcnt(1)
    v_max3_u32 v10, v10, v48, v49
    v_max3_u32 v10, v10, v50, v51
    s_waitcnt vmcnt(0)
    v_max3_u32 v10, v10, v52, v53
    v_max3_u32 v10, v10, v54, v55
    v_cmp_eq_u32 vcc, -1, v10
    s_cbranch_vccz M_c0_3_restart
    s_add_u32 s30, s30, 1
    s_cmp_ge_u32 s30, 60000
    s_cbranch_scc1 M_fail
    s_branch M_c0_3_vfy
M_c0_3_exact:
    s_nop 7
    s_mov_b32 s70, 2
    s_waitcnt lgkmcnt(0)
    ds_read_b128 v[20:23], v3 offset:18432
    ds_read_b128 v[24:27], v3 offset:18496
    ds_read_b128 v[72:75], v3 offset:18560
    ds_read_b128 v[44:47], v3 offset:18624
    ds_read_b128 v[56:59], v0 offset:0
    s_waitcnt lgkmcnt(0)
    v_mfma_f32_16x16x32_bf16 v[28:31], v[56:59], v[20:23], 0
    s_nop 3
    ds_read_b128 v[60:63], v0 offset:1024
    s_waitcnt lgkmcnt(0)
    v_mfma_f32_16x16x32_bf16 v[28:31], v[60:63], v[24:27], v[28:31]
    s_nop 3
    ds_read_b128 v[56:59], v0 offset:2048
    s_waitcnt lgkmcnt(0)
    v_mfma_f32_16x16x32_bf16 v[28:31], v[56:59], v[72:75], v[28:31]
    s_nop 3
    ds_read_b128 v[60:63], v0 offset:3072
    s_waitcnt lgkmcnt(0)
    v_mfma_f32_16x16x32_bf16 v[28:31], v[60:63], v[44:47], v[28:31]
    s_nop 3
    ds_read_b128 v[56:59], v0 offset:4096
    s_waitcnt lgkmcnt(0)
    v_mfma_f32_16x16x32_bf16 v[32:35], v[56:59], v[20:23], 0
    s_nop 3
    ds_read_b128 v[60:63], v0 offset:5120
    s_waitcnt lgkmcnt(0)
    v_mfma_f32_16x16x32_bf16 v[32:35], v[60:63], v[24:27], v[32:35]
    s_nop 3
    ds_read_b128 v[56:59], v0 offset:6144
    s_waitcnt lgkmcnt(0)
    v_mfma_f32_16x16x32_bf16 v[32:35], v[56:59], v[72:75], v[32:35]
    s_nop 3
    ds_read_b128 v[60:63], v0 offset:7168
    s_waitcnt lgkmcnt(0)
    v_mfma_f32_16x16x32_bf16 v[32:35], v[60:63], v[44:47], v[32:35]
    s_nop 3
    ds_read_b128 v[56:59], v3 offset:20736
    s_waitcnt lgkmcnt(0)
    v_mfma_f32_16x16x32_bf16 v[40:43], v[56:59], v[20:23], 0
    s_nop 3
    ds_read_b128 v[60:63], v3 offset:20800
    s_waitcnt lgkmcnt(0)
    v_mfma_f32_16x16x32_bf16 v[40:43], v[60:63], v[24:27], v[40:43]
    s_nop 3
    ds_read_b128 v[56:59], v3 offset:20864
    s_waitcnt lgkmcnt(0)
    v_mfma_f32_16x16x32_bf16 v[40:43], v[56:59], v[72:75], v[40:43]
    s_nop 3
    ds_read_b128 v[60:63], v3 offset:20928
    s_waitcnt lgkmcnt(0)
    v_mfma_f32_16x16x32_bf16 v[40:43], v[60:63], v[44:47], v[40:43]
    s_nop 3
    v_max3_f32 v68, v28, v29, v30
    v_max3_f32 v68, v68, v31, v32
    v_max3_f32 v68, v68, v33, v34
    s_nop 0
    v_max3_f32 v68, v68, v35, v40
    v_max3_f32 v68, v68, v41, v42
    v_max_f32 v68, v68, v43
    v_mov_b32 v69, v68
    s_nop 1
    v_permlane16_swap_b32 v68, v69
    v_max_f32 v68, v68, v69
    v_mov_b32 v69, v68
    s_nop 1
    v_permlane32_swap_b32 v68, v69
    v_max_f32 v68, v68, v69
    v_sub_f32 v28, v28, v68
    v_exp_f32 v28, v28
    v_sub_f32 v29, v29, v68
    v_exp_f32 v29, v29
    v_sub_f32 v30, v30, v68
    v_exp_f32 v30, v30
    v_sub_f32 v31, v31, v68
    v_exp_f32 v31, v31
    v_sub_f32 v32, v32, v68
    v_exp_f32 v32, v32
    v_sub_f32 v33, v33, v68
    v_exp_f32 v33, v33
    v_sub_f32 v34, v34, v68
    v_exp_f32 v34, v34
    v_sub_f32 v35, v35, v68
    v_exp_f32 v35, v35
    v_sub_f32 v40, v40, v68
    v_exp_f32 v40, v40
    v_sub_f32 v41, v41, v68
    v_exp_f32 v41, v41
    v_sub_f32 v42, v42, v68
    v_exp_f32 v42, v42
    v_sub_f32 v43, v43, v68
    v_exp_f32 v43, v43
    v_cvt_pk_bf16_f32 v28, v28, v29
    v_cvt_pk_bf16_f32 v29, v30, v31
    v_cvt_pk_bf16_f32 v30, v32, v33
    v_cvt_pk_bf16_f32 v31, v34, v35
    v_cvt_pk_bf16_f32 v40, v40, v41
    v_cvt_pk_bf16_f32 v41, v42, v43
    v_mfma_f32_16x16x32_bf16 v[20:23], v[80:83], v[28:31], 0
    v_mfma_f32_16x16x32_bf16 v[24:27], v[84:87], v[28:31], 0
    v_mfma_f32_16x16x32_bf16 v[72:75], v[64:67], v[28:31], 0
    ds_read_b128 v[60:63], v3 offset:20928
    s_waitcnt lgkmcnt(0)
    s_nop 7
    v_mfma_f32_16x16x16_bf16 v[72:75], v[10:11], v[40:41], v[72:75]
    s_nop 7
    s_branch M_c0_3_fin
M_c0_3_last:
    s_cmp_lg_u32 s70, 0
    s_cbranch_scc1 M_c0_3_last2
    v_cmp_u_f32 vcc, v32, v32
    s_cbranch_vccnz M_c0_3_vfy0
M_c0_3_last2:
    s_lshl_b32 s4, s44, 18
    s_add_u32 s4, s4, s53
    buffer_store_dwordx4 v[76:79], v0, s[8:11], s4 offen offset:3072 sc1
    s_mov_b32 s4, 0x10000000
    s_waitcnt vmcnt(0) lgkmcnt(0)
    s_barrier
    s_nop 7
    v_mov_b64 v[72:73], -1
    v_mov_b64 v[74:75], -1
    s_add_u32 s28, s44, 3
    s_and_b32 s29, s28, 3
    s_mul_i32 s31, s22, 160
    s_waitcnt vmcnt(0)
    s_add_u32 s44, s44, 1
    s_branch M_c_fft
    s_cmp_eq_u32 s44, 128
    s_cbranch_scc1 M_end
    s_branch M_c0_3_layer
M_c0_3_lr:
    s_mov_b32 s30, 0
M_c0_3_lr_l:
    s_waitcnt lgkmcnt(0)
    s_and_b32 s27, s30, 1
    s_cbranch_scc0 M_c0_3_lr_n
    s_waitcnt vmcnt(2)
    s_mov_b32 m0, 13312
    s_nop 0
    buffer_load_dwordx4 v0, s[8:11], s48 offen offset:3072 sc1 lds
    s_mov_b32 m0, 17408
    s_add_u32 s59, s48, 4096
    buffer_load_dwordx4 v0, s[8:11], s59 offen offset:0 sc1 lds
M_c0_3_lr_n:
    ds_read_b128 v[36:39], v6 offset:13312
    ds_read_b128 v[40:43], v6 offset:14336
    ds_read_b128 v[44:47], v6 offset:15360
    ds_read_b128 v[48:51], v6 offset:16384
    ds_read_b128 v[52:55], v6 offset:17408
    s_waitcnt lgkmcnt(2)
    v_max3_u32 v10, v36, v40, v44
    s_waitcnt lgkmcnt(0)
    v_max3_u32 v10, v10, v48, v52
    v_cmp_eq_u32 vcc, -1, v10
    s_cbranch_vccz M_c0_3_lr_d
    s_add_u32 s30, s30, 1
    s_cmp_ge_u32 s30, 480000
    s_cbranch_scc1 M_fail
    s_branch M_c0_3_lr_l
M_c0_3_lr_d:
    ds_read_b128 v[56:59], v5 offset:0
    ds_read_b128 v[60:63], v5 offset:1024
    ds_read_b128 v[64:67], v5 offset:2048
    ds_read_b128 v[68:71], v5 offset:3072
    v_mov_b64 v[12:13], 0
    v_mov_b64 v[14:15], 0
    v_mov_b64 v[16:17], 0
    v_mov_b64 v[18:19], 0
    v_mov_b64 v[20:21], 0
    v_mov_b64 v[22:23], 0
    v_mov_b64 v[24:25], 0
    v_mov_b64 v[26:27], 0
    v_mov_b64 v[28:29], 0
    v_mov_b64 v[30:31], 0
    v_mov_b64 v[32:33], 0
    v_mov_b64 v[34:35], 0
    s_waitcnt lgkmcnt(0)
    s_branch M_c0_3_lr_r
M_c0_3_rr:
    s_mov_b32 s30, 0
M_c0_3_rr_l:
    s_waitcnt lgkmcnt(0)
    s_and_b32 s27, s30, 1
    s_cbranch_scc1 M_c0_3_rr_n
    s_waitcnt vmcnt(1)
    s_mov_b32 m0, 12288
    s_add_u32 s59, s49, 4096
    buffer_load_dwordx4 v0, s[8:11], s59 offen offset:0 sc1 lds
M_c0_3_rr_n:
    ds_read_b128 v[36:39], v6 offset:8192
    ds_read_b128 v[40:43], v6 offset:9216
    ds_read_b128 v[44:47], v6 offset:10240
    ds_read_b128 v[48:51], v6 offset:11264
    ds_read_b32 v11, v6 offset:12288
    s_waitcnt lgkmcnt(2)
    v_max3_u32 v10, v36, v40, v44
    s_waitcnt lgkmcnt(0)
    v_max3_u32 v10, v10, v48, v11
    v_cmp_eq_u32 vcc, -1, v10
    s_cbranch_vccz M_c0_3_rr_d
    s_add_u32 s30, s30, 1
    s_cmp_ge_u32 s30, 480000
    s_cbranch_scc1 M_fail
    s_branch M_c0_3_rr_l
M_c0_3_rr_d:
    s_branch M_c0_3_rr_r
M_c0_3_first:
    s_mul_i32 s27, s21, 167936
    s_add_u32 s27, s27, s34
    s_mul_i32 s28, s22, 4224
    s_add_u32 s28, s28, s27
    s_mov_b32 exec_hi, 0
    buffer_load_dword v10, v9, s[8:11], s28 offen sc1
    s_lshl_b32 s28, s22, 10
    s_add_u32 s28, s28, s27
    s_add_u32 s28, s28, 135168
    s_mov_b64 exec, 0xff
    buffer_load_dword v10, v9, s[8:11], s28 offen sc1
    s_mul_i32 s27, s21, 5120
    s_add_u32 s27, s27, s41
    s_mul_i32 s28, s22, 160
    s_add_u32 s28, s28, s27
    s_mov_b64 exec, 3
    buffer_load_dword v10, v9, s[8:11], s28 offen sc1
    s_mov_b64 exec, -1
    s_add_u32 s27, s44, 1
    s_or_b32 s28, s44, 63
    s_add_u32 s28, s28, 1
    s_min_u32 s27, s27, s28
    s_cmp_lt_u32 s54, s27
    s_cbranch_scc1 M_c0_3_p1
M_c0_3_p1_r:
    s_barrier
    s_and_b32 s26, s44, 63
    s_lshl_b32 s26, s26, 18
    s_add_u32 s26, s26, s50
    s_add_u32 s26, s26, 6144
    s_add_u32 s3, s26, 16777216
    s_mov_b32 m0, 6144
    s_nop 0
    buffer_load_dwordx4 v0, s[8:11], s26 offen offset:0 sc1 lds
    buffer_load_dwordx4 v0, s[8:11], s26 offen offset:1024 sc1 lds
    buffer_load_dwordx4 v[80:83], v0, s[8:11], s3 offen offset:0 sc1
    buffer_load_dwordx4 v[84:87], v0, s[8:11], s3 offen offset:1024 sc1
    s_and_b32 s26, s44, 63
    s_add_u32 s26, s26, 1
    s_min_u32 s26, s26, 63
    s_lshl_b32 s26, s26, 18
    s_add_u32 s26, s26, s50
    s_add_u32 s26, s26, 6144
    s_add_u32 s3, s26, 16777216
    s_waitcnt vmcnt(0) lgkmcnt(0)
    s_barrier
    s_branch M_c0_3_first_r
M_c0_3_first2:
    ds_read_b64 v[10:11], v0 offset:23296
    s_waitcnt lgkmcnt(0)
    v_min_u32 v10, v10, v11
    s_nop 0
    v_readfirstlane_b32 s28, v10
    s_nop 0
    s_max_u32 s54, s54, s28
    s_add_u32 s27, s44, 2
    s_or_b32 s28, s44, 63
    s_add_u32 s28, s28, 1
    s_min_u32 s27, s27, s28
    s_cmp_lt_u32 s54, s27
    s_cbranch_scc1 M_c0_3_p2
M_c0_3_p2_r:
    s_branch M_c0_3_first2_r
M_c0_3_p1:
    s_mov_b32 s30, 0
M_c0_3_p1_l:
    s_waitcnt lgkmcnt(0)
    s_mov_b64 exec, 3
    buffer_load_dword v10, v9, s[8:11], s51 offen sc1
    s_waitcnt vmcnt(0)
    s_mov_b64 exec, -1
    v_readlane_b32 s54, v10, 0
    v_readlane_b32 s28, v10, 1
    s_nop 3
    s_min_u32 s54, s54, s28
    s_cmp_ge_u32 s54, s27
    s_cbranch_scc1 M_c0_3_p1_r
    s_sleep 2
    s_add_u32 s30, s30, 1
    s_cmp_ge_u32 s30, 240000
    s_cbranch_scc1 M_fail
    s_branch M_c0_3_p1_l
M_c0_3_p2:
    s_mov_b32 s30, 0
M_c0_3_p2_l:
    s_waitcnt lgkmcnt(0)
    s_mov_b64 exec, 3
    buffer_load_dword v10, v9, s[8:11], s51 offen sc1
    s_waitcnt vmcnt(0)
    s_mov_b64 exec, -1
    v_readlane_b32 s54, v10, 0
    v_readlane_b32 s28, v10, 1
    s_nop 3
    s_min_u32 s54, s54, s28
    s_cmp_ge_u32 s54, s27
    s_cbranch_scc1 M_c0_3_p2_r
    s_sleep 2
    s_add_u32 s30, s30, 1
    s_cmp_ge_u32 s30, 240000
    s_cbranch_scc1 M_fail
    s_branch M_c0_3_p2_l
M_c_slow:
    s_cmp_eq_u32 s21, 1
    s_cbranch_scc1 M_c1_1_layer
    s_cmp_eq_u32 s21, 2
    s_cbranch_scc1 M_c1_2_layer
    s_cmp_eq_u32 s21, 3
    s_cbranch_scc1 M_c1_3_layer
M_c1_0_layer:
    s_lshr_b32 s27, s44, 6
    s_mul_i32 s50, s27, 33554432
    s_lshl_b32 s27, s22, 13
    s_add_u32 s50, s50, s27
    s_add_u32 s50, s50, 37748736
    s_barrier
    s_mov_b32 s26, 0x10010000
    s_mov_b32 s3, s26
    s_mul_i32 s27, s20, 5120
    s_add_u32 s48, s27, 167772160
    s_sub_u32 s49, 167777280, s27
    s_and_b32 s55, s44, 3
    s_mul_i32 s55, s55, 167936
    s_add_u32 s55, s55, s34
    s_add_u32 s58, s55, s35
    s_and_b32 s57, s44, 63
    s_add_u32 s43, s55, s32
    s_add_u32 s61, s43, 33792
    s_add_u32 s100, s43, 67584
    s_add_u32 s101, s43, 101376
    s_add_u32 s42, s44, 2
    s_or_b32 s28, s44, 63
    s_add_u32 s28, s28, 1
    s_min_u32 s42, s42, s28
    ds_read_b128 v[56:59], v5 offset:0
    ds_read_b128 v[60:63], v5 offset:1024
    ds_read_b128 v[64:67], v5 offset:2048
    ds_read_b128 v[68:71], v5 offset:3072
    v_mov_b64 v[12:13], 0
    v_mov_b64 v[14:15], 0
    v_mov_b64 v[16:17], 0
    v_mov_b64 v[18:19], 0
    v_mov_b64 v[20:21], 0
    v_mov_b64 v[22:23], 0
    v_mov_b64 v[24:25], 0
    v_mov_b64 v[26:27], 0
    v_mov_b64 v[28:29], 0
    v_mov_b64 v[30:31], 0
    v_mov_b64 v[32:33], 0
    v_mov_b64 v[34:35], 0
    s_mov_b32 s70, 0
    s_waitcnt lgkmcnt(0)
M_c1_0_top:
    s_nop 0
    s_barrier
    ds_read_b128 v[36:39], v6 offset:13312
    ds_read_b128 v[40:43], v6 offset:14336
    s_mov_b32 m0, 8192
    s_nop 0
    buffer_load_dwordx4 v0, s[8:11], s49 offen offset:0 sc1 lds
    buffer_load_dwordx4 v0, s[8:11], s49 offen offset:1024 sc1 lds
M_c1_0_lr_r:
    s_waitcnt lgkmcnt(1)
    v_smfmac_f32_16x16x64_bf16 v[20:23], v[36:39], v[56:63], v1
    ds_read_b128 v[56:59], v5 offset:4096
    v_smfmac_f32_16x16x64_bf16 v[24:27], v[36:39], v[64:71], v1
    ds_read_b128 v[60:63], v5 offset:5120
    v_smfmac_f32_16x16x64_bf16 v[28:31], v[36:39], a[248:255], v1
    ds_read_b128 v[64:67], v5 offset:6144
    v_smfmac_f32_16x16x64_bf16 v[32:35], v[36:39], a[240:247], v1
    ds_read_b128 v[68:71], v5 offset:7168
    v_smfmac_f32_16x16x64_bf16 v[12:15], v[36:39], a[232:239], v1
    ds_read_b128 v[44:47], v6 offset:15360
    s_waitcnt lgkmcnt(3)
    v_smfmac_f32_16x16x64_bf16 v[16:19], v[36:39], v[56:63], v1
    ds_read_b128 v[56:59], v5 offset:8192
    v_smfmac_f32_16x16x64_bf16 v[20:23], v[40:43], a[224:231], v1
    ds_read_b128 v[60:63], v5 offset:9216
    s_waitcnt lgkmcnt(3)
    v_smfmac_f32_16x16x64_bf16 v[24:27], v[40:43], v[64:71], v1
    ds_read_b128 v[64:67], v5 offset:10240
    v_smfmac_f32_16x16x64_bf16 v[28:31], v[40:43], a[216:223], v1
    ds_read_b128 v[68:71], v5 offset:11264
    v_smfmac_f32_16x16x64_bf16 v[32:35], v[40:43], a[208:215], v1
    ds_read_b128 v[48:51], v6 offset:16384
    s_waitcnt lgkmcnt(3)
    v_smfmac_f32_16x16x64_bf16 v[12:15], v[40:43], v[56:63], v1
    ds_read_b128 v[56:59], v5 offset:12288
    v_smfmac_f32_16x16x64_bf16 v[16:19], v[40:43], a[200:207], v1
    ds_read_b128 v[60:63], v5 offset:13312
    s_waitcnt lgkmcnt(3)
    v_smfmac_f32_16x16x64_bf16 v[20:23], v[44:47], v[64:71], v1
    ds_read_b128 v[64:67], v5 offset:14336
    v_smfmac_f32_16x16x64_bf16 v[24:27], v[44:47], a[192:199], v1
    ds_read_b128 v[68:71], v5 offset:15360
    v_smfmac_f32_16x16x64_bf16 v[28:31], v[44:47], a[184:191], v1
    ds_read_b128 v[52:55], v6 offset:17408
    s_waitcnt lgkmcnt(3)
    v_smfmac_f32_16x16x64_bf16 v[32:35], v[44:47], v[56:63], v1
    ds_read_b128 v[56:59], v5 offset:16384
    v_smfmac_f32_16x16x64_bf16 v[20:23], v[48:51], a[176:183], v1
    ds_read_b128 v[60:63], v5 offset:17408
    s_waitcnt lgkmcnt(3)
    v_max3_u32 v10, v36, v40, v44
    v_smfmac_f32_16x16x64_bf16 v[24:27], v[48:51], v[64:71], v1
    ds_read_b128 v[64:67], v5 offset:18432
    s_waitcnt lgkmcnt(3)
    v_max3_u32 v10, v10, v48, v52
    v_smfmac_f32_16x16x64_bf16 v[28:31], v[48:51], a[168:175], v1
    ds_read_b128 v[68:71], v5 offset:19456
    v_cmp_eq_u32 vcc, -1, v10
    v_smfmac_f32_16x16x64_bf16 v[32:35], v[48:51], a[160:167], v1
    s_cbranch_vccnz M_c1_0_lr
    s_waitcnt vmcnt(0)
    s_barrier
    ds_read_b128 v[36:39], v6 offset:8192
    ds_read_b128 v[40:43], v6 offset:9216
    s_waitcnt lgkmcnt(4)
    v_smfmac_f32_16x16x64_bf16 v[20:23], v[52:55], v[56:63], v1
    ds_read_b128 v[44:47], v6 offset:10240
    ds_read_b128 v[48:51], v6 offset:11264
    v_smfmac_f32_16x16x64_bf16 v[24:27], v[52:55], a[152:159], v1
    ds_read_b32 v11, v6 offset:12288
    ds_read_b128 v[56:59], v5 offset:20480
    s_waitcnt lgkmcnt(6)
    v_smfmac_f32_16x16x64_bf16 v[28:31], v[52:55], v[64:71], v1
    ds_read_b128 v[60:63], v5 offset:21504
    s_waitcnt lgkmcnt(4)
    v_max3_u32 v10, v36, v40, v44
    v_smfmac_f32_16x16x64_bf16 v[32:35], v[52:55], a[144:151], v1
    s_waitcnt lgkmcnt(2)
    v_max3_u32 v10, v10, v48, v11
    v_cmp_eq_u32 vcc, -1, v10
    s_cbranch_vccnz M_c1_0_rr
M_c1_0_rr_r:
    ds_read_b128 v[64:67], v5 offset:22528
    ds_read_b128 v[68:71], v5 offset:23552
    ds_read_b128 v[52:55], v6 offset:12288
    buffer_store_dwordx4 v[76:79], v0, s[8:11], s4 offen offset:0 sc1
    s_mov_b32 s4, 0x10000000
    s_mov_b64 exec, 0x3ff
    buffer_store_dwordx4 v[72:75], v0, s[8:11], s60 offen sc1
    s_mov_b64 exec, -1
    s_mov_b32 s60, 0x10000000
    v_smfmac_f32_16x16x64_bf16 v[20:23], v[36:39], a[136:143], v1
    s_waitcnt lgkmcnt(3)
    v_smfmac_f32_16x16x64_bf16 v[24:27], v[36:39], v[56:63], v1
    ds_read_b128 v[56:59], v5 offset:24576
    v_smfmac_f32_16x16x64_bf16 v[20:23], v[40:43], a[128:135], v1
    ds_read_b128 v[60:63], v5 offset:25600
    s_waitcnt lgkmcnt(3)
    v_smfmac_f32_16x16x64_bf16 v[24:27], v[40:43], v[64:71], v1
    ds_read_b128 v[64:67], v5 offset:26624
    v_smfmac_f32_16x16x64_bf16 v[20:23], v[44:47], a[120:127], v1
    ds_read_b128 v[68:71], v5 offset:27648
    v_smfmac_f32_16x16x64_bf16 v[24:27], v[44:47], a[112:119], v1
    s_waitcnt lgkmcnt(2)
    v_smfmac_f32_16x16x64_bf16 v[20:23], v[48:51], v[56:63], v1
    ds_read_b128 v[56:59], v5 offset:28672
    v_smfmac_f32_16x16x64_bf16 v[24:27], v[48:51], a[104:111], v1
    ds_read_b128 v[60:63], v5 offset:29696
    s_waitcnt lgkmcnt(2)
    v_smfmac_f32_16x16x64_bf16 v[20:23], v[52:55], v[64:71], v1
    ds_read_b128 v[64:67], v5 offset:30720
    v_smfmac_f32_16x16x64_bf16 v[24:27], v[52:55], a[96:103], v1
    ds_read_b128 v[68:71], v5 offset:31744
    v_smfmac_f32_16x16x64_bf16 v[28:31], v[36:39], a[88:95], v1
    s_cmp_eq_u32 s57, 0
    s_cbranch_scc1 M_c1_0_first
M_c1_0_first_r:
    s_waitcnt lgkmcnt(2)
    v_smfmac_f32_16x16x64_bf16 v[32:35], v[36:39], v[56:63], v1
    ds_read_b128 v[56:59], v5 offset:32768
    v_permlane32_swap_b32 v20, v21
    v_smfmac_f32_16x16x64_bf16 v[28:31], v[40:43], a[80:87], v1
    ds_read_b128 v[60:63], v5 offset:33792
    s_waitcnt lgkmcnt(2)
    v_permlane32_swap_b32 v22, v23
    v_smfmac_f32_16x16x64_bf16 v[32:35], v[40:43], v[64:71], v1
    ds_read_b128 v[64:67], v0 offset:2048
    v_permlane32_swap_b32 v24, v25
    v_smfmac_f32_16x16x64_bf16 v[28:31], v[44:47], a[72:79], v1
    ds_read_b128 v[68:71], v0 offset:3072
    v_permlane32_swap_b32 v26, v27
    v_smfmac_f32_16x16x64_bf16 v[32:35], v[44:47], a[64:71], v1
    s_waitcnt lgkmcnt(2)
    v_add_f32 v20, v20, v21
    v_add_f32 v22, v22, v23
    v_smfmac_f32_16x16x64_bf16 v[28:31], v[48:51], v[56:63], v1
    ds_read_b128 v[56:59], v0 offset:0
    v_add_f32 v24, v24, v25
    v_add_f32 v26, v26, v27
    v_smfmac_f32_16x16x64_bf16 v[32:35], v[48:51], a[56:63], v1
    ds_read_b128 v[60:63], v0 offset:1024
    v_mul_f32 v20, s40, v20
    v_mul_f32 v24, s40, v24
    v_smfmac_f32_16x16x64_bf16 v[28:31], v[52:55], a[48:55], v1
    v_mul_f32 v22, s40, v22
    v_mul_f32 v26, s40, v26
    v_smfmac_f32_16x16x64_bf16 v[32:35], v[52:55], a[40:47], v1
    v_cvt_pk_bf16_f32 v20, v20, v24
    v_cvt_pk_bf16_f32 v21, v22, v26
    v_smfmac_f32_16x16x64_bf16 v[12:15], v[36:39], a[32:39], v1
    ds_write_b32 v2, v20 offset:18432
    v_smfmac_f32_16x16x64_bf16 v[16:19], v[36:39], a[24:31], v1
    ds_write_b32 v2, v21 offset:19008
    v_permlane32_swap_b32 v28, v29
    v_smfmac_f32_16x16x64_bf16 v[12:15], v[40:43], a[16:23], v1
    ds_read_b128 v[36:39], v6 offset:15360
    v_permlane32_swap_b32 v30, v31
    v_smfmac_f32_16x16x64_bf16 v[16:19], v[40:43], a[8:15], v1
    ds_read_b128 v[40:43], v6 offset:16384
    v_permlane32_swap_b32 v32, v33
    v_smfmac_f32_16x16x64_bf16 v[12:15], v[44:47], a[0:7], v1
    s_waitcnt lgkmcnt(2)
    s_barrier
    v_permlane32_swap_b32 v34, v35
    v_smfmac_f32_16x16x64_bf16 v[16:19], v[44:47], v[248:255], v1
    ds_read_b128 v[20:23], v3 offset:18432
    v_add_f32 v28, v28, v29
    v_add_f32 v30, v30, v31
    v_smfmac_f32_16x16x64_bf16 v[12:15], v[48:51], v[240:247], v1
    ds_read_b128 v[24:27], v3 offset:18496
    v_add_f32 v32, v32, v33
    v_add_f32 v34, v34, v35
    v_smfmac_f32_16x16x64_bf16 v[16:19], v[48:51], v[232:239], v1
    ds_read_b128 v[72:75], v3 offset:18560
    v_cvt_pk_bf16_f32 v28, v28, v32
    v_cvt_pk_bf16_f32 v29, v30, v34
    v_smfmac_f32_16x16x64_bf16 v[12:15], v[52:55], v[224:231], v1
    ds_write_b32 v2, v28 offset:20736
    ds_read_b128 v[44:47], v3 offset:18624
    v_smfmac_f32_16x16x64_bf16 v[16:19], v[52:55], v[216:223], v1
    ds_write_b32 v2, v29 offset:21312
    s_waitcnt lgkmcnt(7)
    v_smfmac_f32_16x16x64_bf16 v[12:15], v[36:39], v[208:215], v1
    ds_read_b128 v[48:51], v6 offset:17408
    v_mov_b64 v[10:11], s[16:17]
    v_smfmac_f32_16x16x64_bf16 v[16:19], v[36:39], v[200:207], v1
    s_waitcnt lgkmcnt(6)
    v_mfma_f32_16x16x32_bf16 v[28:31], v[56:59], v[20:23], 0
    ds_read_b128 v[56:59], v0 offset:4096
    s_waitcnt lgkmcnt(6)
    v_mfma_f32_16x16x32_bf16 v[28:31], v[60:63], v[24:27], v[28:31]
    ds_read_b128 v[60:63], v0 offset:5120
    s_waitcnt lgkmcnt(3)
    s_barrier
    v_mfma_f32_16x16x32_bf16 v[28:31], v[64:67], v[72:75], v[28:31]
    ds_read_b128 v[64:67], v0 offset:6144
    v_mfma_f32_16x16x32_bf16 v[28:31], v[68:71], v[44:47], v[28:31]
    ds_read_b128 v[68:71], v0 offset:7168
    v_smfmac_f32_16x16x64_bf16 v[12:15], v[40:43], v[192:199], v1
    ds_read_b128 v[36:39], v3 offset:20736
    v_smfmac_f32_16x16x64_bf16 v[16:19], v[40:43], v[184:191], v1
    ds_read_b128 v[52:55], v3 offset:20800
    s_waitcnt lgkmcnt(4)
    v_mfma_f32_16x16x32_bf16 v[32:35], v[56:59], v[20:23], 0
    s_nop 0
    v_exp_f32 v28, v28
    ds_read_b128 v[56:59], v3 offset:20864
    v_mfma_f32_16x16x32_bf16 v[32:35], v[60:63], v[24:27], v[32:35]
    s_waitcnt lgkmcnt(3)
    v_exp_f32 v29, v29
    ds_read_b128 v[60:63], v3 offset:20928
    v_mfma_f32_16x16x32_bf16 v[32:35], v[64:67], v[72:75], v[32:35]
    v_exp_f32 v30, v30
    v_mfma_f32_16x16x32_bf16 v[32:35], v[68:71], v[44:47], v[32:35]
    s_waitcnt lgkmcnt(3)
    v_exp_f32 v31, v31
    v_mfma_f32_16x16x32_bf16 v[40:43], v[36:39], v[20:23], 0
    s_waitcnt lgkmcnt(2)
    v_cvt_pk_bf16_f32 v28, v28, v29
    v_cvt_pk_bf16_f32 v29, v30, v31
    v_mfma_f32_16x16x32_bf16 v[40:43], v[52:55], v[24:27], v[40:43]
    s_waitcnt lgkmcnt(1)
    v_mov_b64 v[64:65], s[24:25]
    v_mov_b64 v[66:67], s[24:25]
    v_mfma_f32_16x16x32_bf16 v[40:43], v[56:59], v[72:75], v[40:43]
    s_waitcnt lgkmcnt(0)
    v_exp_f32 v32, v32
    v_mfma_f32_16x16x32_bf16 v[40:43], v[60:63], v[44:47], v[40:43]
    v_exp_f32 v33, v33
    v_smfmac_f32_16x16x64_bf16 v[12:15], v[48:51], v[176:183], v1
    v_exp_f32 v34, v34
    v_smfmac_f32_16x16x64_bf16 v[16:19], v[48:51], v[168:175], v1
    v_exp_f32 v35, v35
    v_cvt_pk_bf16_f32 v30, v32, v33
    v_cvt_pk_bf16_f32 v31, v34, v35
    s_nop 0
    v_exp_f32 v40, v40
    v_mfma_f32_16x16x32_bf16 v[72:75], v[64:67], v[28:31], 0
    v_exp_f32 v41, v41
    v_mfma_f32_16x16x32_bf16 v[20:23], v[80:83], v[28:31], 0
    v_exp_f32 v42, v42
    v_mfma_f32_16x16x32_bf16 v[24:27], v[84:87], v[28:31], 0
    v_exp_f32 v43, v43
    v_cvt_pk_bf16_f32 v40, v40, v41
    v_cvt_pk_bf16_f32 v41, v42, v43
    v_cvt_pk_bf16_f32 v12, v12, v13
    v_cvt_pk_bf16_f32 v13, v14, v15
    v_mfma_f32_16x16x16_bf16 v[72:75], v[10:11], v[40:41], v[72:75]
    v_cvt_pk_bf16_f32 v14, v16, v17
    v_cvt_pk_bf16_f32 v15, v18, v19
M_c1_0_fin:
    v_mfma_f32_16x16x16_bf16 v[20:23], v[12:13], v[40:41], v[20:23]
    s_cmp_eq_u32 s57, 63
    v_cndmask_b32_e64 v76, v12, v36, s[66:67]
    v_cndmask_b32_e64 v77, v13, v37, s[66:67]
    v_mfma_f32_16x16x16_bf16 v[24:27], v[14:15], v[40:41], v[24:27]
    v_cndmask_b32_e64 v78, v14, v38, s[66:67]
    v_cndmask_b32_e64 v79, v15, v39, s[66:67]
    s_cbranch_scc1 M_c1_0_last
    v_rcp_f32 v74, v72
    v_subrev_u32 v73, s68, v72
    v_cmp_lt_u32 vcc, s69, v73
    v_mov_b64 v[44:45], 0
    v_mov_b64 v[46:47], 0
    v_cndmask_b32_e64 v20, v20, v24, s[18:19]
    v_cndmask_b32_e64 v21, v21, v25, s[18:19]
    v_cndmask_b32_e64 v22, v22, v26, s[18:19]
    v_cndmask_b32_e64 v23, v23, v27, s[18:19]
    v_pk_mul_f32 v[20:21], v[20:21], v[74:75] op_sel_hi:[1,0]
    v_pk_mul_f32 v[22:23], v[22:23], v[74:75] op_sel_hi:[1,0]
    v_cvt_pk_bf16_f32 v20, v20, v21
    v_cvt_pk_bf16_f32 v21, v22, v23
    ds_write_b64 v0, v[20:21] offset:13312
    s_cbranch_vccnz M_c1_0_zbad
M_c1_0_zok:
    s_cmp_lt_u32 s54, s42
    s_cbranch_scc1 M_c1_0_first2
M_c1_0_first2_r:
    buffer_load_dwordx4 v[80:83], v0, s[8:11], s3 offen offset:0 sc1
    buffer_load_dwordx4 v[84:87], v0, s[8:11], s3 offen offset:1024 sc1
    s_waitcnt lgkmcnt(0)
    s_barrier
    ds_read_b128 v[32:35], v0 offset:13312
    ds_read_b128 v[52:55], v0 offset:14336
    s_mov_b32 m0, 0
    s_nop 0
    buffer_load_dwordx4 v0, s[8:11], s26 offen offset:0 sc1 lds
    buffer_load_dwordx4 v0, s[8:11], s26 offen offset:1024 sc1 lds
    v_mov_b64 v[68:69], 0
    v_mov_b64 v[70:71], 0
    v_mov_b64 v[64:65], 0
    v_mov_b64 v[66:67], 0
    v_mov_b64 v[60:61], 0
    v_mov_b64 v[62:63], 0
    v_mov_b64 v[56:57], 0
    v_mov_b64 v[58:59], 0
    s_waitcnt lgkmcnt(1)
    s_nop 0
    v_smfmac_f32_16x16x64_bf16 v[56:59], v[32:35], v[160:167], v1
    v_smfmac_f32_16x16x64_bf16 v[60:63], v[32:35], v[144:151], v1
    s_waitcnt lgkmcnt(0)
    v_smfmac_f32_16x16x64_bf16 v[56:59], v[52:55], v[152:159], v1
    v_smfmac_f32_16x16x64_bf16 v[60:63], v[52:55], v[136:143], v1
    v_smfmac_f32_16x16x64_bf16 v[64:67], v[32:35], v[128:135], v1
    v_smfmac_f32_16x16x64_bf16 v[68:71], v[32:35], v[112:119], v1
    v_permlane32_swap_b32 v56, v57
    v_smfmac_f32_16x16x64_bf16 v[64:67], v[52:55], v[120:127], v1
    v_permlane32_swap_b32 v58, v59
    v_smfmac_f32_16x16x64_bf16 v[68:71], v[52:55], v[104:111], v1
    v_add_f32 v56, v56, v57
    v_add_f32 v58, v58, v59
    v_smfmac_f32_16x16x64_bf16 v[44:47], v[32:35], v[96:103], v1
    v_permlane32_swap_b32 v60, v61
    v_smfmac_f32_16x16x64_bf16 v[44:47], v[52:55], v[88:95], v1
    v_permlane32_swap_b32 v62, v63
    v_add_f32 v60, v60, v61
    v_add_f32 v62, v62, v63
    v_cvt_pk_bf16_f32 v36, v56, v60
    v_cvt_pk_bf16_f32 v38, v58, v62
    v_permlane32_swap_b32 v64, v65
    v_permlane32_swap_b32 v66, v67
    v_add_f32 v64, v64, v65
    v_add_f32 v66, v66, v67
    v_permlane32_swap_b32 v68, v69
    v_permlane32_swap_b32 v70, v71
    v_add_f32 v68, v68, v69
    v_add_f32 v70, v70, v71
    v_cvt_pk_bf16_f32 v37, v64, v68
    v_cvt_pk_bf16_f32 v39, v66, v70
    buffer_store_dwordx4 v[36:39], v0, s[8:11], s58 offen sc1
    v_permlane32_swap_b32 v44, v45
    v_permlane32_swap_b32 v46, v47
    v_add_f32 v44, v44, v45
    v_add_f32 v46, v46, v47
    v_cvt_pk_bf16_f32 v44, v44, v46
    buffer_store_dword v44, v7, s[8:11], s55 offen sc1
    v_and_b32 v32, 16, v0
    v_bfe_u32 v33, v0, 5, 2
    v_lshlrev_b32_e64 v32, v32, s45
    v_cmp_eq_u32_e64 s[64:65], 0, v33
    v_cmp_eq_u32_e64 vcc, 1, v33
    s_add_u32 s27, s44, 1
    s_and_b32 s27, s27, 3
    v_cndmask_b32_e64 v72, 0, v32, s[64:65]
    v_cndmask_b32_e64 v73, 0, v32, vcc
    v_cmp_eq_u32_e64 s[64:65], 2, v33
    v_cmp_eq_u32_e64 vcc, 3, v33
    s_mul_i32 s48, s27, 5120
    s_add_u32 s48, s48, s41
    v_cndmask_b32_e64 v74, 0, v32, s[64:65]
    v_cndmask_b32_e64 v75, 0, v32, vcc
    s_lshl_b32 s27, s27, 15
    s_add_u32 s49, s27, s47
    v_bfe_u32 v11, v0, 4, 3
    v_lshlrev_b32 v11, 3, v11
    v_lshrrev_b32 v32, 8, v0
    v_lshl_add_u32 v11, v32, 6, v11
    s_add_u32 s56, s27, s46
    s_add_u32 s56, s56, s33
    s_add_u32 s58, s48, s33
    s_nop 15
    s_nop 15
    buffer_load_dwordx4 v[12:15], v8, s[8:11], s43 offen sc1
    buffer_load_dwordx4 v[16:19], v8, s[8:11], s61 offen sc1
    buffer_load_dwordx4 v[20:23], v8, s[8:11], s100 offen sc1
    buffer_load_dwordx4 v[24:27], v8, s[8:11], s101 offen sc1
    s_nop 15
    s_nop 11
    buffer_load_dwordx4 v[40:43], v8, s[8:11], s43 offen sc1
    buffer_load_dwordx4 v[44:47], v8, s[8:11], s61 offen sc1
    buffer_load_dwordx4 v[48:51], v8, s[8:11], s100 offen sc1
    buffer_load_dwordx4 v[52:55], v8, s[8:11], s101 offen sc1
    s_nop 7
    s_waitcnt vmcnt(7)
    v_mfma_f32_16x16x32_bf16 v[28:31], v[72:75], v[12:15], 0
    s_waitcnt vmcnt(6)
    v_mfma_f32_16x16x32_bf16 v[28:31], v[72:75], v[16:19], v[28:31]
    s_waitcnt vmcnt(5)
    v_mfma_f32_16x16x32_bf16 v[28:31], v[72:75], v[20:23], v[28:31]
    s_waitcnt vmcnt(4)
    v_mfma_f32_16x16x32_bf16 v[28:31], v[72:75], v[24:27], v[28:31]
    v_max3_u32 v32, v12, v16, v20
    v_max_u32 v32, v32, v24
    v_cmp_eq_u32 vcc, -1, v32
    s_cbranch_vccnz M_c1_0_wq1
    v_mov_b32 v5, v5
    v_mov_b32 v5, v5
    v_mov_b32 v5, v5
    v_mov_b32 v5, v5
    v_add_f32_dpp v28, v28, v28 row_ror:8 row_mask:0xf bank_mask:0xf
    v_add_f32_dpp v29, v29, v29 row_ror:8 row_mask:0xf bank_mask:0xf
    v_add_f32_dpp v30, v30, v30 row_ror:8 row_mask:0xf bank_mask:0xf
    v_add_f32_dpp v31, v31, v31 row_ror:8 row_mask:0xf bank_mask:0xf
    v_cmp_u_f32 vcc, v28, v28
    v_cvt_pk_bf16_f32 v28, v28, v29
    v_cvt_pk_bf16_f32 v29, v30, v31
    s_cbranch_vccnz M_c1_0_wrb_e0
    s_mov_b64 exec, s[38:39]
    buffer_store_dwordx2 v[28:29], v11, s[8:11], s58 offen sc1
M_c1_0_wrb_d:
    s_barrier
    buffer_store_dwordx2 v[28:29], v11, s[8:11], s56 offen sc1
M_c1_0_wrb_g:
    s_mov_b64 exec, -1
    s_waitcnt vmcnt(2)
    ds_read_b128 v[56:59], v5 offset:0
    ds_read_b128 v[60:63], v5 offset:1024
    ds_read_b128 v[64:67], v5 offset:2048
    ds_read_b128 v[68:71], v5 offset:3072
    v_mov_b64 v[12:13], 0
    v_mov_b64 v[14:15], 0
    v_mov_b64 v[16:17], 0
    v_mov_b64 v[18:19], 0
    v_mov_b64 v[20:21], 0
    v_mov_b64 v[22:23], 0
    v_mov_b64 v[24:25], 0
    v_mov_b64 v[26:27], 0
    v_mov_b64 v[28:29], 0
    v_mov_b64 v[30:31], 0
    v_mov_b64 v[32:33], 0
    v_mov_b64 v[34:35], 0
    ds_read_b64 v[36:37], v0 offset:23296
    s_waitcnt lgkmcnt(0)
    v_min_u32 v36, v36, v37
    s_nop 0
    v_readfirstlane_b32 s28, v36
    s_nop 0
    s_max_u32 s54, s54, s28
    s_and_b32 s26, s44, 63
    s_add_u32 s26, s26, 2
    s_min_u32 s26, s26, 63
    s_lshl_b32 s26, s26, 18
    s_add_u32 s26, s26, s50
    s_add_u32 s3, s26, 16777216
    s_lshl_b32 s4, s44, 18
    s_add_u32 s4, s4, s53
    v_mov_b64 v[72:73], -1
    v_mov_b64 v[74:75], -1
    s_add_u32 s28, s44, 3
    s_and_b32 s29, s28, 3
    s_mul_i32 s31, s22, 160
    s_mul_i32 s28, s29, 167936
    s_add_u32 s28, s28, s34
    s_add_u32 s64, s28, s35
    s_mul_i32 s65, s29, 5120
    s_add_u32 s65, s65, s41
    s_add_u32 s65, s65, s31
    s_lshl_b32 s60, s29, 15
    s_add_u32 s60, s60, s47
    s_add_u32 s60, s60, s31
    s_add_u32 s44, s44, 1
    s_and_b32 s55, s44, 3
    s_mul_i32 s55, s55, 167936
    s_add_u32 s55, s55, s34
    s_add_u32 s58, s55, s35
    s_and_b32 s57, s44, 63
    s_add_u32 s43, s55, s32
    s_add_u32 s61, s43, 33792
    s_add_u32 s100, s43, 67584
    s_add_u32 s101, s43, 101376
    s_add_u32 s42, s44, 2
    s_or_b32 s28, s44, 63
    s_add_u32 s28, s28, 1
    s_min_u32 s42, s42, s28
    s_nop 15
    s_nop 15
    s_nop 1
    buffer_store_dwordx4 v[72:75], v0, s[8:11], s64 offen offset:0 sc1
    buffer_store_dwordx4 v[72:75], v0, s[8:11], s64 offen offset:1024 sc1
    s_mov_b64 exec, 0x3ff
    buffer_store_dwordx4 v[72:75], v0, s[8:11], s65 offen sc1
    s_mov_b64 exec, -1
    s_mov_b32 s65, 0x10000000
    s_mov_b32 s64, 0x10000000
    s_mov_b32 s70, 0
    s_branch M_c1_0_top
M_c1_0_restart:
    s_waitcnt vmcnt(0) lgkmcnt(0)
    s_nop 7
    s_barrier
    ds_read_b128 v[56:59], v5 offset:0
    ds_read_b128 v[60:63], v5 offset:1024
    ds_read_b128 v[64:67], v5 offset:2048
    ds_read_b128 v[68:71], v5 offset:3072
    v_mov_b64 v[12:13], 0
    v_mov_b64 v[14:15], 0
    v_mov_b64 v[16:17], 0
    v_mov_b64 v[18:19], 0
    v_mov_b64 v[20:21], 0
    v_mov_b64 v[22:23], 0
    v_mov_b64 v[24:25], 0
    v_mov_b64 v[26:27], 0
    v_mov_b64 v[28:29], 0
    v_mov_b64 v[30:31], 0
    v_mov_b64 v[32:33], 0
    v_mov_b64 v[34:35], 0
    s_waitcnt vmcnt(0) lgkmcnt(0)
    s_branch M_c1_0_top
M_c1_0_zbad:
    s_cmp_eq_u32 s70, 2
    s_cbranch_scc1 M_c1_0_zok
    v_cmp_u_f32 vcc, v72, v72
    s_cbranch_vccz M_c1_0_exact
    s_cmp_eq_u32 s70, 1
    s_cbranch_scc1 M_c1_0_exact
M_c1_0_vfy0:
    s_mov_b32 s70, 1
    s_mov_b32 s30, 0
    s_waitcnt vmcnt(0) lgkmcnt(0)
    s_nop 7
M_c1_0_vfy:
    v_mov_b32 v10, 0
    s_add_u32 s59, s48, 4096
    buffer_load_dwordx4 v[36:39], v0, s[8:11], s48 offen offset:0 sc1
    buffer_load_dwordx4 v[40:43], v0, s[8:11], s48 offen offset:1024 sc1
    buffer_load_dwordx4 v[44:47], v0, s[8:11], s48 offen offset:2048 sc1
    buffer_load_dwordx4 v[48:51], v0, s[8:11], s48 offen offset:3072 sc1
    buffer_load_dwordx4 v[52:55], v0, s[8:11], s59 offen offset:0 sc1
    s_waitcnt vmcnt(4)
    v_max3_u32 v10, v10, v36, v37
    v_max3_u32 v10, v10, v38, v39
    s_waitcnt vmcnt(3)
    v_max3_u32 v10, v10, v40, v41
    v_max3_u32 v10, v10, v42, v43
    s_waitcnt vmcnt(2)
    v_max3_u32 v10, v10, v44, v45
    v_max3_u32 v10, v10, v46, v47
    s_waitcnt vmcnt(1)
    v_max3_u32 v10, v10, v48, v49
    v_max3_u32 v10, v10, v50, v51
    s_waitcnt vmcnt(0)
    v_max3_u32 v10, v10, v52, v53
    v_max3_u32 v10, v10, v54, v55
    s_add_u32 s59, s49, 4096
    buffer_load_dwordx4 v[36:39], v0, s[8:11], s49 offen offset:0 sc1
    buffer_load_dwordx4 v[40:43], v0, s[8:11], s49 offen offset:1024 sc1
    buffer_load_dwordx4 v[44:47], v0, s[8:11], s49 offen offset:2048 sc1
    buffer_load_dwordx4 v[48:51], v0, s[8:11], s49 offen offset:3072 sc1
    buffer_load_dwordx4 v[52:55], v0, s[8:11], s59 offen offset:0 sc1
    s_waitcnt vmcnt(4)
    v_max3_u32 v10, v10, v36, v37
    v_max3_u32 v10, v10, v38, v39
    s_waitcnt vmcnt(3)
    v_max3_u32 v10, v10, v40, v41
    v_max3_u32 v10, v10, v42, v43
    s_waitcnt vmcnt(2)
    v_max3_u32 v10, v10, v44, v45
    v_max3_u32 v10, v10, v46, v47
    s_waitcnt vmcnt(1)
    v_max3_u32 v10, v10, v48, v49
    v_max3_u32 v10, v10, v50, v51
    s_waitcnt vmcnt(0)
    v_max3_u32 v10, v10, v52, v53
    v_max3_u32 v10, v10, v54, v55
    v_cmp_eq_u32 vcc, -1, v10
    s_cbranch_vccz M_c1_0_restart
    s_add_u32 s30, s30, 1
    s_cmp_ge_u32 s30, 60000
    s_cbranch_scc1 M_fail
    s_branch M_c1_0_vfy
M_c1_0_exact:
    s_nop 7
    s_mov_b32 s70, 2
    s_waitcnt lgkmcnt(0)
    ds_read_b128 v[20:23], v3 offset:18432
    ds_read_b128 v[24:27], v3 offset:18496
    ds_read_b128 v[72:75], v3 offset:18560
    ds_read_b128 v[44:47], v3 offset:18624
    ds_read_b128 v[56:59], v0 offset:0
    s_waitcnt lgkmcnt(0)
    v_mfma_f32_16x16x32_bf16 v[28:31], v[56:59], v[20:23], 0
    s_nop 3
    ds_read_b128 v[60:63], v0 offset:1024
    s_waitcnt lgkmcnt(0)
    v_mfma_f32_16x16x32_bf16 v[28:31], v[60:63], v[24:27], v[28:31]
    s_nop 3
    ds_read_b128 v[56:59], v0 offset:2048
    s_waitcnt lgkmcnt(0)
    v_mfma_f32_16x16x32_bf16 v[28:31], v[56:59], v[72:75], v[28:31]
    s_nop 3
    ds_read_b128 v[60:63], v0 offset:3072
    s_waitcnt lgkmcnt(0)
    v_mfma_f32_16x16x32_bf16 v[28:31], v[60:63], v[44:47], v[28:31]
    s_nop 3
    ds_read_b128 v[56:59], v0 offset:4096
    s_waitcnt lgkmcnt(0)
    v_mfma_f32_16x16x32_bf16 v[32:35], v[56:59], v[20:23], 0
    s_nop 3
    ds_read_b128 v[60:63], v0 offset:5120
    s_waitcnt lgkmcnt(0)
    v_mfma_f32_16x16x32_bf16 v[32:35], v[60:63], v[24:27], v[32:35]
    s_nop 3
    ds_read_b128 v[56:59], v0 offset:6144
    s_waitcnt lgkmcnt(0)
    v_mfma_f32_16x16x32_bf16 v[32:35], v[56:59], v[72:75], v[32:35]
    s_nop 3
    ds_read_b128 v[60:63], v0 offset:7168
    s_waitcnt lgkmcnt(0)
    v_mfma_f32_16x16x32_bf16 v[32:35], v[60:63], v[44:47], v[32:35]
    s_nop 3
    ds_read_b128 v[56:59], v3 offset:20736
    s_waitcnt lgkmcnt(0)
    v_mfma_f32_16x16x32_bf16 v[40:43], v[56:59], v[20:23], 0
    s_nop 3
    ds_read_b128 v[60:63], v3 offset:20800
    s_waitcnt lgkmcnt(0)
    v_mfma_f32_16x16x32_bf16 v[40:43], v[60:63], v[24:27], v[40:43]
    s_nop 3
    ds_read_b128 v[56:59], v3 offset:20864
    s_waitcnt lgkmcnt(0)
    v_mfma_f32_16x16x32_bf16 v[40:43], v[56:59], v[72:75], v[40:43]
    s_nop 3
    ds_read_b128 v[60:63], v3 offset:20928
    s_waitcnt lgkmcnt(0)
    v_mfma_f32_16x16x32_bf16 v[40:43], v[60:63], v[44:47], v[40:43]
    s_nop 3
    v_max3_f32 v68, v28, v29, v30
    v_max3_f32 v68, v68, v31, v32
    v_max3_f32 v68, v68, v33, v34
    s_nop 0
    v_max3_f32 v68, v68, v35, v40
    v_max3_f32 v68, v68, v41, v42
    v_max_f32 v68, v68, v43
    v_mov_b32 v69, v68
    s_nop 1
    v_permlane16_swap_b32 v68, v69
    v_max_f32 v68, v68, v69
    v_mov_b32 v69, v68
    s_nop 1
    v_permlane32_swap_b32 v68, v69
    v_max_f32 v68, v68, v69
    v_sub_f32 v28, v28, v68
    v_exp_f32 v28, v28
    v_sub_f32 v29, v29, v68
    v_exp_f32 v29, v29
    v_sub_f32 v30, v30, v68
    v_exp_f32 v30, v30
    v_sub_f32 v31, v31, v68
    v_exp_f32 v31, v31
    v_sub_f32 v32, v32, v68
    v_exp_f32 v32, v32
    v_sub_f32 v33, v33, v68
    v_exp_f32 v33, v33
    v_sub_f32 v34, v34, v68
    v_exp_f32 v34, v34
    v_sub_f32 v35, v35, v68
    v_exp_f32 v35, v35
    v_sub_f32 v40, v40, v68
    v_exp_f32 v40, v40
    v_sub_f32 v41, v41, v68
    v_exp_f32 v41, v41
    v_sub_f32 v42, v42, v68
    v_exp_f32 v42, v42
    v_sub_f32 v43, v43, v68
    v_exp_f32 v43, v43
    v_cvt_pk_bf16_f32 v28, v28, v29
    v_cvt_pk_bf16_f32 v29, v30, v31
    v_cvt_pk_bf16_f32 v30, v32, v33
    v_cvt_pk_bf16_f32 v31, v34, v35
    v_cvt_pk_bf16_f32 v40, v40, v41
    v_cvt_pk_bf16_f32 v41, v42, v43
    v_mfma_f32_16x16x32_bf16 v[20:23], v[80:83], v[28:31], 0
    v_mfma_f32_16x16x32_bf16 v[24:27], v[84:87], v[28:31], 0
    v_mfma_f32_16x16x32_bf16 v[72:75], v[64:67], v[28:31], 0
    ds_read_b128 v[36:39], v3 offset:20736
    s_waitcnt lgkmcnt(0)
    s_nop 7
    v_mfma_f32_16x16x16_bf16 v[72:75], v[10:11], v[40:41], v[72:75]
    s_nop 7
    s_branch M_c1_0_fin
M_c1_0_last:
    s_cmp_lg_u32 s70, 0
    s_cbranch_scc1 M_c1_0_last2
    v_cmp_u_f32 vcc, v32, v32
    s_cbranch_vccnz M_c1_0_vfy0
M_c1_0_last2:
    s_lshl_b32 s4, s44, 18
    s_add_u32 s4, s4, s53
    buffer_store_dwordx4 v[76:79], v0, s[8:11], s4 offen offset:0 sc1
    s_mov_b32 s4, 0x10000000
    s_waitcnt vmcnt(0) lgkmcnt(0)
    s_barrier
    s_nop 7
    v_mov_b64 v[72:73], -1
    v_mov_b64 v[74:75], -1
    s_add_u32 s28, s44, 3
    s_and_b32 s29, s28, 3
    s_mul_i32 s31, s22, 160
    s_mul_i32 s28, s29, 167936
    s_add_u32 s28, s28, s34
    s_add_u32 s64, s28, s35
    s_mul_i32 s65, s29, 5120
    s_add_u32 s65, s65, s41
    s_add_u32 s65, s65, s31
    s_lshl_b32 s60, s29, 15
    s_add_u32 s60, s60, s47
    s_add_u32 s60, s60, s31
    buffer_store_dwordx4 v[72:75], v0, s[8:11], s64 offen offset:0 sc1
    buffer_store_dwordx4 v[72:75], v0, s[8:11], s64 offen offset:1024 sc1
    s_mov_b64 exec, 0x3ff
    buffer_store_dwordx4 v[72:75], v0, s[8:11], s65 offen sc1
    s_mov_b64 exec, -1
    s_mov_b32 s65, 0x10000000
    s_mov_b32 s64, 0x10000000
    s_mov_b64 exec, 0x3ff
    buffer_store_dwordx4 v[72:75], v0, s[8:11], s60 offen sc1
    s_mov_b64 exec, -1
    s_mov_b32 s60, 0x10000000
    s_waitcnt vmcnt(0)
    s_add_u32 s44, s44, 1
    s_branch M_c_fft
    s_cmp_eq_u32 s44, 128
    s_cbranch_scc1 M_end
    s_branch M_c1_0_layer
M_c1_0_lr:
    s_mov_b32 s30, 0
M_c1_0_lr_l:
    s_waitcnt lgkmcnt(0)
    ds_read_b128 v[36:39], v6 offset:13312
    ds_read_b128 v[40:43], v6 offset:14336
    ds_read_b128 v[44:47], v6 offset:15360
    ds_read_b128 v[48:51], v6 offset:16384
    ds_read_b128 v[52:55], v6 offset:17408
    s_waitcnt lgkmcnt(2)
    v_max3_u32 v10, v36, v40, v44
    s_waitcnt lgkmcnt(0)
    v_max3_u32 v10, v10, v48, v52
    v_cmp_eq_u32 vcc, -1, v10
    s_cbranch_vccz M_c1_0_lr_d
    s_add_u32 s30, s30, 1
    s_cmp_ge_u32 s30, 480000
    s_cbranch_scc1 M_fail
    s_branch M_c1_0_lr_l
M_c1_0_lr_d:
    ds_read_b128 v[56:59], v5 offset:0
    ds_read_b128 v[60:63], v5 offset:1024
    ds_read_b128 v[64:67], v5 offset:2048
    ds_read_b128 v[68:71], v5 offset:3072
    v_mov_b64 v[12:13], 0
    v_mov_b64 v[14:15], 0
    v_mov_b64 v[16:17], 0
    v_mov_b64 v[18:19], 0
    v_mov_b64 v[20:21], 0
    v_mov_b64 v[22:23], 0
    v_mov_b64 v[24:25], 0
    v_mov_b64 v[26:27], 0
    v_mov_b64 v[28:29], 0
    v_mov_b64 v[30:31], 0
    v_mov_b64 v[32:33], 0
    v_mov_b64 v[34:35], 0
    s_waitcnt lgkmcnt(0)
    s_branch M_c1_0_lr_r
M_c1_0_rr:
    s_mov_b32 s30, 0
M_c1_0_rr_l:
    s_waitcnt lgkmcnt(0)
    s_and_b32 s27, s30, 1
    s_cbranch_scc1 M_c1_0_rr_n
    s_waitcnt vmcnt(2)
    s_mov_b32 m0, 8192
    s_nop 0
    buffer_load_dwordx4 v0, s[8:11], s49 offen offset:0 sc1 lds
    buffer_load_dwordx4 v0, s[8:11], s49 offen offset:1024 sc1 lds
M_c1_0_rr_n:
    ds_read_b128 v[36:39], v6 offset:8192
    ds_read_b128 v[40:43], v6 offset:9216
    ds_read_b128 v[44:47], v6 offset:10240
    ds_read_b128 v[48:51], v6 offset:11264
    ds_read_b32 v11, v6 offset:12288
    s_waitcnt lgkmcnt(2)
    v_max3_u32 v10, v36, v40, v44
    s_waitcnt lgkmcnt(0)
    v_max3_u32 v10, v10, v48, v11
    v_cmp_eq_u32 vcc, -1, v10
    s_cbranch_vccz M_c1_0_rr_d
    s_add_u32 s30, s30, 1
    s_cmp_ge_u32 s30, 480000
    s_cbranch_scc1 M_fail
    s_branch M_c1_0_rr_l
M_c1_0_rr_d:
    s_branch M_c1_0_rr_r
M_c1_0_first:
    s_mul_i32 s27, s21, 167936
    s_add_u32 s27, s27, s34
    s_mul_i32 s28, s22, 4224
    s_add_u32 s28, s28, s27
    s_mov_b32 exec_hi, 0
    buffer_load_dword v10, v9, s[8:11], s28 offen sc1
    s_lshl_b32 s28, s22, 10
    s_add_u32 s28, s28, s27
    s_add_u32 s28, s28, 135168
    s_mov_b64 exec, 0xff
    buffer_load_dword v10, v9, s[8:11], s28 offen sc1
    s_mul_i32 s27, s21, 5120
    s_add_u32 s27, s27, s41
    s_mul_i32 s28, s22, 160
    s_add_u32 s28, s28, s27
    s_mov_b64 exec, 3
    buffer_load_dword v10, v9, s[8:11], s28 offen sc1
    s_mov_b64 exec, -1
    s_barrier
    s_and_b32 s26, s44, 63
    s_lshl_b32 s26, s26, 18
    s_add_u32 s26, s26, s50
    s_add_u32 s3, s26, 16777216
    s_mov_b32 m0, 0
    s_nop 0
    buffer_load_dwordx4 v0, s[8:11], s26 offen offset:0 sc1 lds
    buffer_load_dwordx4 v0, s[8:11], s26 offen offset:1024 sc1 lds
    buffer_load_dwordx4 v[80:83], v0, s[8:11], s3 offen offset:0 sc1
    buffer_load_dwordx4 v[84:87], v0, s[8:11], s3 offen offset:1024 sc1
    s_and_b32 s26, s44, 63
    s_add_u32 s26, s26, 1
    s_min_u32 s26, s26, 63
    s_lshl_b32 s26, s26, 18
    s_add_u32 s26, s26, s50
    s_add_u32 s3, s26, 16777216
    s_waitcnt vmcnt(0) lgkmcnt(0)
    s_barrier
    s_branch M_c1_0_first_r
M_c1_0_first2:
    ds_read_b64 v[10:11], v0 offset:23296
    s_waitcnt lgkmcnt(0)
    v_min_u32 v10, v10, v11
    s_nop 0
    v_readfirstlane_b32 s28, v10
    s_nop 0
    s_max_u32 s54, s54, s28
    s_add_u32 s27, s44, 2
    s_or_b32 s28, s44, 63
    s_add_u32 s28, s28, 1
    s_min_u32 s27, s27, s28
    s_cmp_lt_u32 s54, s27
    s_cbranch_scc1 M_c1_0_p2
M_c1_0_p2_r:
    s_branch M_c1_0_first2_r
M_c1_0_wq1:
    buffer_load_dwordx4 v[12:15], v8, s[8:11], s43 offen sc1
    buffer_load_dwordx4 v[16:19], v8, s[8:11], s61 offen sc1
    buffer_load_dwordx4 v[20:23], v8, s[8:11], s100 offen sc1
    buffer_load_dwordx4 v[24:27], v8, s[8:11], s101 offen sc1
    s_waitcnt vmcnt(7)
    v_mfma_f32_16x16x32_bf16 v[28:31], v[72:75], v[40:43], 0
    s_waitcnt vmcnt(6)
    v_mfma_f32_16x16x32_bf16 v[28:31], v[72:75], v[44:47], v[28:31]
    s_waitcnt vmcnt(5)
    v_mfma_f32_16x16x32_bf16 v[28:31], v[72:75], v[48:51], v[28:31]
    s_waitcnt vmcnt(4)
    v_mfma_f32_16x16x32_bf16 v[28:31], v[72:75], v[52:55], v[28:31]
    v_max3_u32 v32, v40, v44, v48
    v_max_u32 v32, v32, v52
    v_cmp_eq_u32 vcc, -1, v32
    s_cbranch_vccnz M_c1_0_wqx
    v_mov_b32 v5, v5
    v_mov_b32 v5, v5
    v_mov_b32 v5, v5
    v_mov_b32 v5, v5
    v_add_f32_dpp v28, v28, v28 row_ror:8 row_mask:0xf bank_mask:0xf
    v_add_f32_dpp v29, v29, v29 row_ror:8 row_mask:0xf bank_mask:0xf
    v_add_f32_dpp v30, v30, v30 row_ror:8 row_mask:0xf bank_mask:0xf
    v_add_f32_dpp v31, v31, v31 row_ror:8 row_mask:0xf bank_mask:0xf
    v_cmp_u_f32 vcc, v28, v28
    v_cvt_pk_bf16_f32 v28, v28, v29
    v_cvt_pk_bf16_f32 v29, v30, v31
    s_cbranch_vccnz M_c1_0_wqe1
    s_mov_b64 exec, s[38:39]
    buffer_store_dwordx2 v[28:29], v11, s[8:11], s58 offen sc1
    s_barrier
    buffer_store_dwordx2 v[28:29], v11, s[8:11], s56 offen sc1
    s_branch M_c1_0_wrb_g
M_c1_0_wqx:
    s_branch M_c1_0_wrb_i1
M_c1_0_wqe1:
    s_waitcnt vmcnt(0)
    buffer_load_dwordx4 v[12:15], v8, s[8:11], s43 offen sc1
    buffer_load_dwordx4 v[16:19], v8, s[8:11], s61 offen sc1
    buffer_load_dwordx4 v[20:23], v8, s[8:11], s100 offen sc1
    buffer_load_dwordx4 v[24:27], v8, s[8:11], s101 offen sc1
    s_branch M_c1_0_wrb_e1
M_c1_0_wrb_l:
    s_waitcnt vmcnt(4)
    v_mfma_f32_16x16x32_bf16 v[28:31], v[72:75], v[12:15], 0
    v_mfma_f32_16x16x32_bf16 v[28:31], v[72:75], v[16:19], v[28:31]
    v_mfma_f32_16x16x32_bf16 v[28:31], v[72:75], v[20:23], v[28:31]
    v_mfma_f32_16x16x32_bf16 v[28:31], v[72:75], v[24:27], v[28:31]
    v_max3_u32 v32, v12, v16, v20
    v_max_u32 v32, v32, v24
    v_cmp_eq_u32 vcc, -1, v32
    s_cbranch_vccz M_c1_0_wrb_x0
M_c1_0_wrb_i0:
    buffer_load_dwordx4 v[12:15], v8, s[8:11], s43 offen sc1
    buffer_load_dwordx4 v[16:19], v8, s[8:11], s61 offen sc1
    buffer_load_dwordx4 v[20:23], v8, s[8:11], s100 offen sc1
    buffer_load_dwordx4 v[24:27], v8, s[8:11], s101 offen sc1
    s_waitcnt vmcnt(4)
    v_mfma_f32_16x16x32_bf16 v[28:31], v[72:75], v[40:43], 0
    v_mfma_f32_16x16x32_bf16 v[28:31], v[72:75], v[44:47], v[28:31]
    v_mfma_f32_16x16x32_bf16 v[28:31], v[72:75], v[48:51], v[28:31]
    v_mfma_f32_16x16x32_bf16 v[28:31], v[72:75], v[52:55], v[28:31]
    v_max3_u32 v32, v40, v44, v48
    v_max_u32 v32, v32, v52
    v_cmp_eq_u32 vcc, -1, v32
    s_cbranch_vccz M_c1_0_wrb_x1
M_c1_0_wrb_i1:
    buffer_load_dwordx4 v[40:43], v8, s[8:11], s43 offen sc1
    buffer_load_dwordx4 v[44:47], v8, s[8:11], s61 offen sc1
    buffer_load_dwordx4 v[48:51], v8, s[8:11], s100 offen sc1
    buffer_load_dwordx4 v[52:55], v8, s[8:11], s101 offen sc1
    s_add_u32 s71, s71, 1
    s_cmp_lt_u32 s71, 240000
    s_cbranch_scc1 M_c1_0_wrb_l
    s_branch M_fail
M_c1_0_wrb_x0:
    s_nop 3
    v_add_f32_dpp v28, v28, v28 row_ror:8 row_mask:0xf bank_mask:0xf
    v_add_f32_dpp v29, v29, v29 row_ror:8 row_mask:0xf bank_mask:0xf
    v_add_f32_dpp v30, v30, v30 row_ror:8 row_mask:0xf bank_mask:0xf
    v_add_f32_dpp v31, v31, v31 row_ror:8 row_mask:0xf bank_mask:0xf
    v_cmp_u_f32 vcc, v28, v28
    v_cvt_pk_bf16_f32 v28, v28, v29
    v_cvt_pk_bf16_f32 v29, v30, v31
    s_cbranch_vccz M_c1_0_wrb_n
M_c1_0_wrb_e0:
    v_max3_u32 v32, v12, v13, v14
    v_max3_u32 v32, v32, v15, v16
    v_max3_u32 v32, v32, v17, v18
    v_max3_u32 v32, v32, v19, v20
    v_max3_u32 v32, v32, v21, v22
    v_max3_u32 v32, v32, v23, v24
    v_max3_u32 v32, v32, v25, v26
    v_max_u32 v32, v32, v27
    v_cmp_eq_u32 vcc, -1, v32
    s_cbranch_vccnz M_c1_0_wrb_i0
    v_min_u32 v28, -2, v28
    v_min_u32 v29, -2, v29
    s_branch M_c1_0_wrb_n
M_c1_0_wrb_x1:
    s_nop 3
    v_add_f32_dpp v28, v28, v28 row_ror:8 row_mask:0xf bank_mask:0xf
    v_add_f32_dpp v29, v29, v29 row_ror:8 row_mask:0xf bank_mask:0xf
    v_add_f32_dpp v30, v30, v30 row_ror:8 row_mask:0xf bank_mask:0xf
    v_add_f32_dpp v31, v31, v31 row_ror:8 row_mask:0xf bank_mask:0xf
    v_cmp_u_f32 vcc, v28, v28
    v_cvt_pk_bf16_f32 v28, v28, v29
    v_cvt_pk_bf16_f32 v29, v30, v31
    s_cbranch_vccz M_c1_0_wrb_n
M_c1_0_wrb_e1:
    v_max3_u32 v32, v40, v41, v42
    v_max3_u32 v32, v32, v43, v44
    v_max3_u32 v32, v32, v45, v46
    v_max3_u32 v32, v32, v47, v48
    v_max3_u32 v32, v32, v49, v50
    v_max3_u32 v32, v32, v51, v52
    v_max3_u32 v32, v32, v53, v54
    v_max_u32 v32, v32, v55
    v_cmp_eq_u32 vcc, -1, v32
    s_cbranch_vccnz M_c1_0_wrb_i1
    v_min_u32 v28, -2, v28
    v_min_u32 v29, -2, v29
M_c1_0_wrb_n:
    s_mov_b64 exec, s[38:39]
    buffer_store_dwordx2 v[28:29], v11, s[8:11], s58 offen sc1
    s_branch M_c1_0_wrb_d
M_c1_0_p2:
    s_mov_b32 s30, 0
M_c1_0_p2_l:
    s_waitcnt lgkmcnt(0)
    s_mov_b64 exec, 3
    buffer_load_dword v10, v9, s[8:11], s51 offen sc1
    s_waitcnt vmcnt(0)
    s_mov_b64 exec, -1
    v_readlane_b32 s54, v10, 0
    v_readlane_b32 s28, v10, 1
    s_nop 3
    s_min_u32 s54, s54, s28
    s_cmp_ge_u32 s54, s27
    s_cbranch_scc1 M_c1_0_p2_r
    s_sleep 2
    s_add_u32 s30, s30, 1
    s_cmp_ge_u32 s30, 240000
    s_cbranch_scc1 M_fail
    s_branch M_c1_0_p2_l
M_c1_1_layer:
    s_lshr_b32 s27, s44, 6
    s_mul_i32 s50, s27, 33554432
    s_lshl_b32 s27, s22, 13
    s_add_u32 s50, s50, s27
    s_add_u32 s50, s50, 37748736
    s_barrier
    s_mov_b32 s26, 0x10010000
    s_mov_b32 s3, s26
    s_mul_i32 s27, s20, 5120
    s_add_u32 s48, s27, 167772160
    s_sub_u32 s49, 167777280, s27
    s_and_b32 s55, s44, 3
    s_mul_i32 s55, s55, 167936
    s_add_u32 s55, s55, s34
    s_add_u32 s58, s55, s35
    s_and_b32 s57, s44, 63
    s_add_u32 s43, s55, s32
    s_sub_u32 s27, s57, 1
    s_max_i32 s27, s27, 0
    s_lshl_b64 s[100:101], 1, s27
    s_lshl_b32 s27, s27, 7
    s_sub_u32 s61, s52, s27
    s_add_u32 s42, s44, 2
    s_or_b32 s28, s44, 63
    s_add_u32 s28, s28, 1
    s_min_u32 s42, s42, s28
    ds_read_b128 v[56:59], v5 offset:0
    ds_read_b128 v[60:63], v5 offset:1024
    ds_read_b128 v[64:67], v5 offset:2048
    ds_read_b128 v[68:71], v5 offset:3072
    v_mov_b64 v[12:13], 0
    v_mov_b64 v[14:15], 0
    v_mov_b64 v[16:17], 0
    v_mov_b64 v[18:19], 0
    v_mov_b64 v[20:21], 0
    v_mov_b64 v[22:23], 0
    v_mov_b64 v[24:25], 0
    v_mov_b64 v[26:27], 0
    v_mov_b64 v[28:29], 0
    v_mov_b64 v[30:31], 0
    v_mov_b64 v[32:33], 0
    v_mov_b64 v[34:35], 0
    s_mov_b32 s70, 0
    s_waitcnt lgkmcnt(0)
M_c1_1_top:
    s_nop 0
    s_barrier
    ds_read_b128 v[36:39], v6 offset:13312
    ds_read_b128 v[40:43], v6 offset:14336
    s_mov_b32 m0, 8192
    s_nop 0
    buffer_load_dwordx4 v0, s[8:11], s49 offen offset:2048 sc1 lds
M_c1_1_lr_r:
    s_waitcnt lgkmcnt(1)
    v_smfmac_f32_16x16x64_bf16 v[20:23], v[36:39], v[56:63], v1
    ds_read_b128 v[56:59], v5 offset:4096
    v_smfmac_f32_16x16x64_bf16 v[24:27], v[36:39], v[64:71], v1
    ds_read_b128 v[60:63], v5 offset:5120
    v_smfmac_f32_16x16x64_bf16 v[28:31], v[36:39], a[248:255], v1
    ds_read_b128 v[64:67], v5 offset:6144
    v_smfmac_f32_16x16x64_bf16 v[32:35], v[36:39], a[240:247], v1
    ds_read_b128 v[68:71], v5 offset:7168
    v_smfmac_f32_16x16x64_bf16 v[12:15], v[36:39], a[232:239], v1
    ds_read_b128 v[44:47], v6 offset:15360
    s_waitcnt lgkmcnt(3)
    v_smfmac_f32_16x16x64_bf16 v[16:19], v[36:39], v[56:63], v1
    ds_read_b128 v[56:59], v5 offset:8192
    v_smfmac_f32_16x16x64_bf16 v[20:23], v[40:43], a[224:231], v1
    ds_read_b128 v[60:63], v5 offset:9216
    s_waitcnt lgkmcnt(3)
    v_smfmac_f32_16x16x64_bf16 v[24:27], v[40:43], v[64:71], v1
    ds_read_b128 v[64:67], v5 offset:10240
    v_smfmac_f32_16x16x64_bf16 v[28:31], v[40:43], a[216:223], v1
    ds_read_b128 v[68:71], v5 offset:11264
    v_smfmac_f32_16x16x64_bf16 v[32:35], v[40:43], a[208:215], v1
    ds_read_b128 v[48:51], v6 offset:16384
    s_waitcnt lgkmcnt(3)
    v_smfmac_f32_16x16x64_bf16 v[12:15], v[40:43], v[56:63], v1
    ds_read_b128 v[56:59], v5 offset:12288
    v_smfmac_f32_16x16x64_bf16 v[16:19], v[40:43], a[200:207], v1
    ds_read_b128 v[60:63], v5 offset:13312
    s_waitcnt lgkmcnt(3)
    v_smfmac_f32_16x16x64_bf16 v[20:23], v[44:47], v[64:71], v1
    ds_read_b128 v[64:67], v5 offset:14336
    v_smfmac_f32_16x16x64_bf16 v[24:27], v[44:47], a[192:199], v1
    ds_read_b128 v[68:71], v5 offset:15360
    v_smfmac_f32_16x16x64_bf16 v[28:31], v[44:47], a[184:191], v1
    ds_read_b128 v[52:55], v6 offset:17408
    s_waitcnt lgkmcnt(3)
    v_smfmac_f32_16x16x64_bf16 v[32:35], v[44:47], v[56:63], v1
    ds_read_b128 v[56:59], v5 offset:16384
    v_smfmac_f32_16x16x64_bf16 v[20:23], v[48:51], a[176:183], v1
    ds_read_b128 v[60:63], v5 offset:17408
    s_waitcnt lgkmcnt(3)
    v_max3_u32 v10, v36, v40, v44
    v_smfmac_f32_16x16x64_bf16 v[24:27], v[48:51], v[64:71], v1
    ds_read_b128 v[64:67], v5 offset:18432
    s_waitcnt lgkmcnt(3)
    v_max3_u32 v10, v10, v48, v52
    v_smfmac_f32_16x16x64_bf16 v[28:31], v[48:51], a[168:175], v1
    ds_read_b128 v[68:71], v5 offset:19456
    v_cmp_eq_u32 vcc, -1, v10
    v_smfmac_f32_16x16x64_bf16 v[32:35], v[48:51], a[160:167], v1
    s_cbranch_vccnz M_c1_1_lr
    s_waitcnt vmcnt(0)
    s_barrier
    ds_read_b128 v[36:39], v6 offset:8192
    ds_read_b128 v[40:43], v6 offset:9216
    s_waitcnt lgkmcnt(4)
    v_smfmac_f32_16x16x64_bf16 v[20:23], v[52:55], v[56:63], v1
    ds_read_b128 v[44:47], v6 offset:10240
    ds_read_b128 v[48:51], v6 offset:11264
    v_smfmac_f32_16x16x64_bf16 v[24:27], v[52:55], a[152:159], v1
    ds_read_b32 v11, v6 offset:12288
    ds_read_b128 v[56:59], v5 offset:20480
    s_waitcnt lgkmcnt(6)
    v_smfmac_f32_16x16x64_bf16 v[28:31], v[52:55], v[64:71], v1
    ds_read_b128 v[60:63], v5 offset:21504
    s_waitcnt lgkmcnt(4)
    v_max3_u32 v10, v36, v40, v44
    v_smfmac_f32_16x16x64_bf16 v[32:35], v[52:55], a[144:151], v1
    s_waitcnt lgkmcnt(2)
    v_max3_u32 v10, v10, v48, v11
    v_cmp_eq_u32 vcc, -1, v10
    s_cbranch_vccnz M_c1_1_rr
M_c1_1_rr_r:
    s_mov_b32 m0, 23296
    ds_read_b128 v[64:67], v5 offset:22528
    ds_read_b128 v[68:71], v5 offset:23552
    ds_read_b128 v[52:55], v6 offset:12288
    buffer_store_dwordx4 v[76:79], v0, s[8:11], s4 offen offset:1024 sc1
    s_mov_b32 s4, 0x10000000
    s_mov_b64 exec, 3
    buffer_load_dword v9, s[8:11], s51 offen sc1 lds
    s_mov_b64 exec, s[100:101]
    buffer_store_dword v9, v9, s[8:11], s61 offen sc1
    s_mov_b64 exec, -1
    v_smfmac_f32_16x16x64_bf16 v[20:23], v[36:39], a[136:143], v1
    s_waitcnt lgkmcnt(3)
    v_smfmac_f32_16x16x64_bf16 v[24:27], v[36:39], v[56:63], v1
    ds_read_b128 v[56:59], v5 offset:24576
    v_smfmac_f32_16x16x64_bf16 v[20:23], v[40:43], a[128:135], v1
    ds_read_b128 v[60:63], v5 offset:25600
    s_waitcnt lgkmcnt(3)
    v_smfmac_f32_16x16x64_bf16 v[24:27], v[40:43], v[64:71], v1
    ds_read_b128 v[64:67], v5 offset:26624
    v_smfmac_f32_16x16x64_bf16 v[20:23], v[44:47], a[120:127], v1
    ds_read_b128 v[68:71], v5 offset:27648
    v_smfmac_f32_16x16x64_bf16 v[24:27], v[44:47], a[112:119], v1
    s_waitcnt lgkmcnt(2)
    v_smfmac_f32_16x16x64_bf16 v[20:23], v[48:51], v[56:63], v1
    ds_read_b128 v[56:59], v5 offset:28672
    v_smfmac_f32_16x16x64_bf16 v[24:27], v[48:51], a[104:111], v1
    ds_read_b128 v[60:63], v5 offset:29696
    s_waitcnt lgkmcnt(2)
    v_smfmac_f32_16x16x64_bf16 v[20:23], v[52:55], v[64:71], v1
    ds_read_b128 v[64:67], v5 offset:30720
    v_smfmac_f32_16x16x64_bf16 v[24:27], v[52:55], a[96:103], v1
    ds_read_b128 v[68:71], v5 offset:31744
    v_smfmac_f32_16x16x64_bf16 v[28:31], v[36:39], a[88:95], v1
    s_cmp_eq_u32 s57, 0
    s_cbranch_scc1 M_c1_1_first
M_c1_1_first_r:
    s_waitcnt lgkmcnt(2)
    v_smfmac_f32_16x16x64_bf16 v[32:35], v[36:39], v[56:63], v1
    ds_read_b128 v[56:59], v5 offset:32768
    v_permlane32_swap_b32 v20, v21
    v_smfmac_f32_16x16x64_bf16 v[28:31], v[40:43], a[80:87], v1
    ds_read_b128 v[60:63], v5 offset:33792
    s_waitcnt lgkmcnt(2)
    v_permlane32_swap_b32 v22, v23
    v_smfmac_f32_16x16x64_bf16 v[32:35], v[40:43], v[64:71], v1
    ds_read_b128 v[64:67], v0 offset:2048
    v_permlane32_swap_b32 v24, v25
    v_smfmac_f32_16x16x64_bf16 v[28:31], v[44:47], a[72:79], v1
    ds_read_b128 v[68:71], v0 offset:3072
    v_permlane32_swap_b32 v26, v27
    v_smfmac_f32_16x16x64_bf16 v[32:35], v[44:47], a[64:71], v1
    s_waitcnt lgkmcnt(2)
    v_add_f32 v20, v20, v21
    v_add_f32 v22, v22, v23
    v_smfmac_f32_16x16x64_bf16 v[28:31], v[48:51], v[56:63], v1
    ds_read_b128 v[56:59], v0 offset:0
    v_add_f32 v24, v24, v25
    v_add_f32 v26, v26, v27
    v_smfmac_f32_16x16x64_bf16 v[32:35], v[48:51], a[56:63], v1
    ds_read_b128 v[60:63], v0 offset:1024
    v_mul_f32 v20, s40, v20
    v_mul_f32 v24, s40, v24
    v_smfmac_f32_16x16x64_bf16 v[28:31], v[52:55], a[48:55], v1
    v_mul_f32 v22, s40, v22
    v_mul_f32 v26, s40, v26
    v_smfmac_f32_16x16x64_bf16 v[32:35], v[52:55], a[40:47], v1
    v_cvt_pk_bf16_f32 v20, v20, v24
    v_cvt_pk_bf16_f32 v21, v22, v26
    v_smfmac_f32_16x16x64_bf16 v[12:15], v[36:39], a[32:39], v1
    ds_write_b32 v2, v20 offset:18432
    v_smfmac_f32_16x16x64_bf16 v[16:19], v[36:39], a[24:31], v1
    ds_write_b32 v2, v21 offset:19008
    v_permlane32_swap_b32 v28, v29
    v_smfmac_f32_16x16x64_bf16 v[12:15], v[40:43], a[16:23], v1
    ds_read_b128 v[36:39], v6 offset:15360
    v_permlane32_swap_b32 v30, v31
    v_smfmac_f32_16x16x64_bf16 v[16:19], v[40:43], a[8:15], v1
    ds_read_b128 v[40:43], v6 offset:16384
    v_permlane32_swap_b32 v32, v33
    v_smfmac_f32_16x16x64_bf16 v[12:15], v[44:47], a[0:7], v1
    s_waitcnt lgkmcnt(2)
    s_barrier
    v_permlane32_swap_b32 v34, v35
    v_smfmac_f32_16x16x64_bf16 v[16:19], v[44:47], v[248:255], v1
    ds_read_b128 v[20:23], v3 offset:18432
    v_add_f32 v28, v28, v29
    v_add_f32 v30, v30, v31
    v_smfmac_f32_16x16x64_bf16 v[12:15], v[48:51], v[240:247], v1
    ds_read_b128 v[24:27], v3 offset:18496
    v_add_f32 v32, v32, v33
    v_add_f32 v34, v34, v35
    v_smfmac_f32_16x16x64_bf16 v[16:19], v[48:51], v[232:239], v1
    ds_read_b128 v[72:75], v3 offset:18560
    v_cvt_pk_bf16_f32 v28, v28, v32
    v_cvt_pk_bf16_f32 v29, v30, v34
    v_smfmac_f32_16x16x64_bf16 v[12:15], v[52:55], v[224:231], v1
    ds_write_b32 v2, v28 offset:20736
    ds_read_b128 v[44:47], v3 offset:18624
    v_smfmac_f32_16x16x64_bf16 v[16:19], v[52:55], v[216:223], v1
    ds_write_b32 v2, v29 offset:21312
    s_waitcnt lgkmcnt(7)
    v_smfmac_f32_16x16x64_bf16 v[12:15], v[36:39], v[208:215], v1
    ds_read_b128 v[48:51], v6 offset:17408
    v_mov_b64 v[10:11], s[16:17]
    v_smfmac_f32_16x16x64_bf16 v[16:19], v[36:39], v[200:207], v1
    s_waitcnt lgkmcnt(6)
    v_mfma_f32_16x16x32_bf16 v[28:31], v[56:59], v[20:23], 0
    ds_read_b128 v[56:59], v0 offset:4096
    s_waitcnt lgkmcnt(6)
    v_mfma_f32_16x16x32_bf16 v[28:31], v[60:63], v[24:27], v[28:31]
    ds_read_b128 v[60:63], v0 offset:5120
    s_waitcnt lgkmcnt(3)
    s_barrier
    v_mfma_f32_16x16x32_bf16 v[28:31], v[64:67], v[72:75], v[28:31]
    ds_read_b128 v[64:67], v0 offset:6144
    v_mfma_f32_16x16x32_bf16 v[28:31], v[68:71], v[44:47], v[28:31]
    ds_read_b128 v[68:71], v0 offset:7168
    v_smfmac_f32_16x16x64_bf16 v[12:15], v[40:43], v[192:199], v1
    ds_read_b128 v[36:39], v3 offset:20736
    v_smfmac_f32_16x16x64_bf16 v[16:19], v[40:43], v[184:191], v1
    ds_read_b128 v[52:55], v3 offset:20800
    s_waitcnt lgkmcnt(4)
    v_mfma_f32_16x16x32_bf16 v[32:35], v[56:59], v[20:23], 0
    s_nop 0
    v_exp_f32 v28, v28
    ds_read_b128 v[56:59], v3 offset:20864
    v_mfma_f32_16x16x32_bf16 v[32:35], v[60:63], v[24:27], v[32:35]
    s_waitcnt lgkmcnt(3)
    v_exp_f32 v29, v29
    ds_read_b128 v[60:63], v3 offset:20928
    v_mfma_f32_16x16x32_bf16 v[32:35], v[64:67], v[72:75], v[32:35]
    v_exp_f32 v30, v30
    v_mfma_f32_16x16x32_bf16 v[32:35], v[68:71], v[44:47], v[32:35]
    s_waitcnt lgkmcnt(3)
    v_exp_f32 v31, v31
    v_mfma_f32_16x16x32_bf16 v[40:43], v[36:39], v[20:23], 0
    s_waitcnt lgkmcnt(2)
    v_cvt_pk_bf16_f32 v28, v28, v29
    v_cvt_pk_bf16_f32 v29, v30, v31
    v_mfma_f32_16x16x32_bf16 v[40:43], v[52:55], v[24:27], v[40:43]
    s_waitcnt lgkmcnt(1)
    v_mov_b64 v[64:65], s[24:25]
    v_mov_b64 v[66:67], s[24:25]
    v_mfma_f32_16x16x32_bf16 v[40:43], v[56:59], v[72:75], v[40:43]
    s_waitcnt lgkmcnt(0)
    v_exp_f32 v32, v32
    v_mfma_f32_16x16x32_bf16 v[40:43], v[60:63], v[44:47], v[40:43]
    v_exp_f32 v33, v33
    v_smfmac_f32_16x16x64_bf16 v[12:15], v[48:51], v[176:183], v1
    v_exp_f32 v34, v34
    v_smfmac_f32_16x16x64_bf16 v[16:19], v[48:51], v[168:175], v1
    v_exp_f32 v35, v35
    v_cvt_pk_bf16_f32 v30, v32, v33
    v_cvt_pk_bf16_f32 v31, v34, v35
    s_nop 0
    v_exp_f32 v40, v40
    v_mfma_f32_16x16x32_bf16 v[72:75], v[64:67], v[28:31], 0
    v_exp_f32 v41, v41
    v_mfma_f32_16x16x32_bf16 v[20:23], v[80:83], v[28:31], 0
    v_exp_f32 v42, v42
    v_mfma_f32_16x16x32_bf16 v[24:27], v[84:87], v[28:31], 0
    v_exp_f32 v43, v43
    v_cvt_pk_bf16_f32 v40, v40, v41
    v_cvt_pk_bf16_f32 v41, v42, v43
    v_cvt_pk_bf16_f32 v12, v12, v13
    v_cvt_pk_bf16_f32 v13, v14, v15
    v_mfma_f32_16x16x16_bf16 v[72:75], v[10:11], v[40:41], v[72:75]
    v_cvt_pk_bf16_f32 v14, v16, v17
    v_cvt_pk_bf16_f32 v15, v18, v19
M_c1_1_fin:
    v_mfma_f32_16x16x16_bf16 v[20:23], v[12:13], v[40:41], v[20:23]
    s_cmp_eq_u32 s57, 63
    v_cndmask_b32_e64 v76, v12, v52, s[66:67]
    v_cndmask_b32_e64 v77, v13, v53, s[66:67]
    v_mfma_f32_16x16x16_bf16 v[24:27], v[14:15], v[40:41], v[24:27]
    v_cndmask_b32_e64 v78, v14, v54, s[66:67]
    v_cndmask_b32_e64 v79, v15, v55, s[66:67]
    s_cbranch_scc1 M_c1_1_last
    v_rcp_f32 v74, v72
    v_subrev_u32 v73, s68, v72
    v_cmp_lt_u32 vcc, s69, v73
    v_mov_b64 v[44:45], 0
    v_mov_b64 v[46:47], 0
    v_cndmask_b32_e64 v20, v20, v24, s[18:19]
    v_cndmask_b32_e64 v21, v21, v25, s[18:19]
    v_cndmask_b32_e64 v22, v22, v26, s[18:19]
    v_cndmask_b32_e64 v23, v23, v27, s[18:19]
    v_pk_mul_f32 v[20:21], v[20:21], v[74:75] op_sel_hi:[1,0]
    v_pk_mul_f32 v[22:23], v[22:23], v[74:75] op_sel_hi:[1,0]
    v_cvt_pk_bf16_f32 v20, v20, v21
    v_cvt_pk_bf16_f32 v21, v22, v23
    ds_write_b64 v0, v[20:21] offset:13320
    s_cbranch_vccnz M_c1_1_zbad
M_c1_1_zok:
    s_cmp_lt_u32 s54, s42
    s_cbranch_scc1 M_c1_1_first2
M_c1_1_first2_r:
    buffer_load_dwordx4 v[80:83], v0, s[8:11], s3 offen offset:0 sc1
    buffer_load_dwordx4 v[84:87], v0, s[8:11], s3 offen offset:1024 sc1
    s_waitcnt lgkmcnt(0)
    s_barrier
    ds_read_b128 v[32:35], v0 offset:13312
    ds_read_b128 v[52:55], v0 offset:14336
    s_mov_b32 m0, 2048
    s_nop 0
    buffer_load_dwordx4 v0, s[8:11], s26 offen offset:0 sc1 lds
    buffer_load_dwordx4 v0, s[8:11], s26 offen offset:1024 sc1 lds
    v_mov_b64 v[68:69], 0
    v_mov_b64 v[70:71], 0
    v_mov_b64 v[64:65], 0
    v_mov_b64 v[66:67], 0
    v_mov_b64 v[60:61], 0
    v_mov_b64 v[62:63], 0
    v_mov_b64 v[56:57], 0
    v_mov_b64 v[58:59], 0
    s_waitcnt lgkmcnt(1)
    s_nop 0
    v_smfmac_f32_16x16x64_bf16 v[56:59], v[32:35], v[160:167], v1
    v_smfmac_f32_16x16x64_bf16 v[60:63], v[32:35], v[144:151], v1
    s_waitcnt lgkmcnt(0)
    v_smfmac_f32_16x16x64_bf16 v[56:59], v[52:55], v[152:159], v1
    v_smfmac_f32_16x16x64_bf16 v[60:63], v[52:55], v[136:143], v1
    v_smfmac_f32_16x16x64_bf16 v[64:67], v[32:35], v[128:135], v1
    v_smfmac_f32_16x16x64_bf16 v[68:71], v[32:35], v[112:119], v1
    v_permlane32_swap_b32 v56, v57
    v_smfmac_f32_16x16x64_bf16 v[64:67], v[52:55], v[120:127], v1
    v_permlane32_swap_b32 v58, v59
    v_smfmac_f32_16x16x64_bf16 v[68:71], v[52:55], v[104:111], v1
    v_add_f32 v56, v56, v57
    v_add_f32 v58, v58, v59
    v_smfmac_f32_16x16x64_bf16 v[44:47], v[32:35], v[96:103], v1
    v_permlane32_swap_b32 v60, v61
    v_smfmac_f32_16x16x64_bf16 v[44:47], v[52:55], v[88:95], v1
    v_permlane32_swap_b32 v62, v63
    v_add_f32 v60, v60, v61
    v_add_f32 v62, v62, v63
    v_cvt_pk_bf16_f32 v36, v56, v60
    v_cvt_pk_bf16_f32 v38, v58, v62
    v_permlane32_swap_b32 v64, v65
    v_permlane32_swap_b32 v66, v67
    v_add_f32 v64, v64, v65
    v_add_f32 v66, v66, v67
    v_permlane32_swap_b32 v68, v69
    v_permlane32_swap_b32 v70, v71
    v_add_f32 v68, v68, v69
    v_add_f32 v70, v70, v71
    v_cvt_pk_bf16_f32 v37, v64, v68
    v_cvt_pk_bf16_f32 v39, v66, v70
    buffer_store_dwordx4 v[36:39], v0, s[8:11], s58 offen sc1
    v_permlane32_swap_b32 v44, v45
    v_permlane32_swap_b32 v46, v47
    v_add_f32 v44, v44, v45
    v_add_f32 v46, v46, v47
    v_cvt_pk_bf16_f32 v44, v44, v46
    buffer_store_dword v44, v7, s[8:11], s55 offen sc1
    v_bfe_u32 v34, v0, 4, 1
    v_bfe_u32 v33, v0, 7, 1
    v_lshl_add_u32 v33, v33, 1, v34
    v_bfe_u32 v32, v0, 6, 1
    v_lshlrev_b32 v32, 4, v32
    v_lshlrev_b32_e64 v32, v32, s45
    v_cmp_eq_u32_e64 s[64:65], 0, v33
    v_cmp_eq_u32_e64 vcc, 1, v33
    s_add_u32 s27, s44, 1
    s_and_b32 s27, s27, 3
    v_cndmask_b32_e64 v72, 0, v32, s[64:65]
    v_cndmask_b32_e64 v73, 0, v32, vcc
    v_cmp_eq_u32_e64 s[64:65], 2, v33
    v_cmp_eq_u32_e64 vcc, 3, v33
    s_mul_i32 s48, s27, 5120
    s_add_u32 s48, s48, s41
    v_cndmask_b32_e64 v74, 0, v32, s[64:65]
    v_cndmask_b32_e64 v75, 0, v32, vcc
    s_lshl_b32 s27, s27, 15
    s_add_u32 s49, s27, s47
    v_bfe_u32 v32, v0, 8, 1
    v_lshlrev_b32 v11, 6, v32
    v_lshl_add_u32 v11, v34, 3, v11
    v_lshrrev_b32 v33, 9, v0
    v_lshl_add_u32 v11, v33, 2, v11
    s_add_u32 s56, s27, s46
    s_add_u32 s56, s56, s33
    s_add_u32 s58, s48, s33
    s_nop 15
    s_nop 15
    buffer_load_dwordx4 v[12:15], v0, s[8:11], s43 offen sc1
    s_nop 15
    s_nop 15
    s_nop 9
    buffer_load_dwordx4 v[16:19], v0, s[8:11], s43 offen sc1
    s_nop 7
    s_waitcnt vmcnt(1)
    v_mfma_f32_16x16x32_bf16 v[28:31], v[72:75], v[12:15], 0
    v_cmp_eq_u32 vcc, -1, v12
    s_cbranch_vccnz M_c1_1_wq1
    v_mov_b32 v5, v5
    v_mov_b32 v5, v5
    v_mov_b32 v5, v5
    v_mov_b32 v5, v5
    v_mov_b32 v5, v5
    v_mov_b32 v5, v5
    v_add_f32_dpp v28, v28, v28 row_ror:8 row_mask:0xf bank_mask:0xf
    v_add_f32_dpp v29, v29, v29 row_ror:8 row_mask:0xf bank_mask:0xf
    s_nop 0
    v_add_f32_dpp v28, v28, v28 row_ror:4 row_mask:0xf bank_mask:0xf
    v_add_f32_dpp v29, v29, v29 row_ror:4 row_mask:0xf bank_mask:0xf
    s_nop 0
    v_add_f32_dpp v28, v28, v28 row_ror:2 row_mask:0xf bank_mask:0xf
    v_add_f32_dpp v29, v29, v29 row_ror:2 row_mask:0xf bank_mask:0xf
    v_cmp_u_f32 vcc, v28, v28
    v_cvt_pk_bf16_f32 v28, v28, v29
    s_cbranch_vccnz M_c1_1_wrb_e0
    s_mov_b64 exec, s[62:63]
    buffer_store_dword v28, v11, s[8:11], s58 offen sc1
M_c1_1_wrb_d:
    s_barrier
    buffer_store_dword v28, v11, s[8:11], s56 offen sc1
M_c1_1_wrb_g:
    s_mov_b64 exec, -1
    s_waitcnt vmcnt(2)
    ds_read_b128 v[56:59], v5 offset:0
    ds_read_b128 v[60:63], v5 offset:1024
    ds_read_b128 v[64:67], v5 offset:2048
    ds_read_b128 v[68:71], v5 offset:3072
    v_mov_b64 v[12:13], 0
    v_mov_b64 v[14:15], 0
    v_mov_b64 v[16:17], 0
    v_mov_b64 v[18:19], 0
    v_mov_b64 v[20:21], 0
    v_mov_b64 v[22:23], 0
    v_mov_b64 v[24:25], 0
    v_mov_b64 v[26:27], 0
    v_mov_b64 v[28:29], 0
    v_mov_b64 v[30:31], 0
    v_mov_b64 v[32:33], 0
    v_mov_b64 v[34:35], 0
    ds_read_b64 v[36:37], v0 offset:23296
    s_waitcnt lgkmcnt(0)
    v_min_u32 v36, v36, v37
    s_nop 0
    v_readfirstlane_b32 s28, v36
    s_nop 0
    s_max_u32 s54, s54, s28
    s_and_b32 s26, s44, 63
    s_add_u32 s26, s26, 2
    s_min_u32 s26, s26, 63
    s_lshl_b32 s26, s26, 18
    s_add_u32 s26, s26, s50
    s_add_u32 s26, s26, 2048
    s_add_u32 s3, s26, 16777216
    s_lshl_b32 s4, s44, 18
    s_add_u32 s4, s4, s53
    v_mov_b64 v[72:73], -1
    v_mov_b64 v[74:75], -1
    s_add_u32 s28, s44, 3
    s_and_b32 s29, s28, 3
    s_mul_i32 s31, s22, 160
    s_mul_i32 s28, s29, 167936
    s_add_u32 s28, s28, s34
    s_add_u32 s64, s28, s35
    s_lshl_b32 s65, s22, 10
    s_add_u32 s65, s65, s28
    s_add_u32 s65, s65, 135168
    s_add_u32 s44, s44, 1
    s_and_b32 s55, s44, 3
    s_mul_i32 s55, s55, 167936
    s_add_u32 s55, s55, s34
    s_add_u32 s58, s55, s35
    s_and_b32 s57, s44, 63
    s_add_u32 s43, s55, s32
    s_sub_u32 s27, s57, 1
    s_max_i32 s27, s27, 0
    s_lshl_b64 s[100:101], 1, s27
    s_lshl_b32 s27, s27, 7
    s_sub_u32 s61, s52, s27
    s_add_u32 s42, s44, 2
    s_or_b32 s28, s44, 63
    s_add_u32 s28, s28, 1
    s_min_u32 s42, s42, s28
    s_nop 15
    s_nop 15
    s_nop 1
    buffer_store_dwordx4 v[72:75], v0, s[8:11], s64 offen offset:1024 sc1
    buffer_store_dwordx4 v[72:75], v0, s[8:11], s64 offen offset:2048 sc1
    buffer_store_dwordx4 v[72:75], v0, s[8:11], s65 offen sc1
    s_mov_b32 s65, 0x10000000
    s_mov_b32 s64, 0x10000000
    s_mov_b32 s70, 0
    s_branch M_c1_1_top
M_c1_1_restart:
    s_waitcnt vmcnt(0) lgkmcnt(0)
    s_nop 7
    s_barrier
    ds_read_b128 v[56:59], v5 offset:0
    ds_read_b128 v[60:63], v5 offset:1024
    ds_read_b128 v[64:67], v5 offset:2048
    ds_read_b128 v[68:71], v5 offset:3072
    v_mov_b64 v[12:13], 0
    v_mov_b64 v[14:15], 0
    v_mov_b64 v[16:17], 0
    v_mov_b64 v[18:19], 0
    v_mov_b64 v[20:21], 0
    v_mov_b64 v[22:23], 0
    v_mov_b64 v[24:25], 0
    v_mov_b64 v[26:27], 0
    v_mov_b64 v[28:29], 0
    v_mov_b64 v[30:31], 0
    v_mov_b64 v[32:33], 0
    v_mov_b64 v[34:35], 0
    s_waitcnt vmcnt(0) lgkmcnt(0)
    s_branch M_c1_1_top
M_c1_1_zbad:
    s_cmp_eq_u32 s70, 2
    s_cbranch_scc1 M_c1_1_zok
    v_cmp_u_f32 vcc, v72, v72
    s_cbranch_vccz M_c1_1_exact
    s_cmp_eq_u32 s70, 1
    s_cbranch_scc1 M_c1_1_exact
M_c1_1_vfy0:
    s_mov_b32 s70, 1
    s_mov_b32 s30, 0
    s_waitcnt vmcnt(0) lgkmcnt(0)
    s_nop 7
M_c1_1_vfy:
    v_mov_b32 v10, 0
    s_add_u32 s59, s48, 4096
    buffer_load_dwordx4 v[36:39], v0, s[8:11], s48 offen offset:0 sc1
    buffer_load_dwordx4 v[40:43], v0, s[8:11], s48 offen offset:1024 sc1
    buffer_load_dwordx4 v[44:47], v0, s[8:11], s48 offen offset:2048 sc1
    buffer_load_dwordx4 v[48:51], v0, s[8:11], s48 offen offset:3072 sc1
    buffer_load_dwordx4 v[52:55], v0, s[8:11], s59 offen offset:0 sc1
    s_waitcnt vmcnt(4)
    v_max3_u32 v10, v10, v36, v37
    v_max3_u32 v10, v10, v38, v39
    s_waitcnt vmcnt(3)
    v_max3_u32 v10, v10, v40, v41
    v_max3_u32 v10, v10, v42, v43
    s_waitcnt vmcnt(2)
    v_max3_u32 v10, v10, v44, v45
    v_max3_u32 v10, v10, v46, v47
    s_waitcnt vmcnt(1)
    v_max3_u32 v10, v10, v48, v49
    v_max3_u32 v10, v10, v50, v51
    s_waitcnt vmcnt(0)
    v_max3_u32 v10, v10, v52, v53
    v_max3_u32 v10, v10, v54, v55
    s_add_u32 s59, s49, 4096
    buffer_load_dwordx4 v[36:39], v0, s[8:11], s49 offen offset:0 sc1
    buffer_load_dwordx4 v[40:43], v0, s[8:11], s49 offen offset:1024 sc1
    buffer_load_dwordx4 v[44:47], v0, s[8:11], s49 offen offset:2048 sc1
    buffer_load_dwordx4 v[48:51], v0, s[8:11], s49 offen offset:3072 sc1
    buffer_load_dwordx4 v[52:55], v0, s[8:11], s59 offen offset:0 sc1
    s_waitcnt vmcnt(4)
    v_max3_u32 v10, v10, v36, v37
    v_max3_u32 v10, v10, v38, v39
    s_waitcnt vmcnt(3)
    v_max3_u32 v10, v10, v40, v41
    v_max3_u32 v10, v10, v42, v43
    s_waitcnt vmcnt(2)
    v_max3_u32 v10, v10, v44, v45
    v_max3_u32 v10, v10, v46, v47
    s_waitcnt vmcnt(1)
    v_max3_u32 v10, v10, v48, v49
    v_max3_u32 v10, v10, v50, v51
    s_waitcnt vmcnt(0)
    v_max3_u32 v10, v10, v52, v53
    v_max3_u32 v10, v10, v54, v55
    v_cmp_eq_u32 vcc, -1, v10
    s_cbranch_vccz M_c1_1_restart
    s_add_u32 s30, s30, 1
    s_cmp_ge_u32 s30, 60000
    s_cbranch_scc1 M_fail
    s_branch M_c1_1_vfy
M_c1_1_exact:
    s_nop 7
    s_mov_b32 s70, 2
    s_waitcnt lgkmcnt(0)
    ds_read_b128 v[20:23], v3 offset:18432
    ds_read_b128 v[24:27], v3 offset:18496
    ds_read_b128 v[72:75], v3 offset:18560
    ds_read_b128 v[44:47], v3 offset:18624
    ds_read_b128 v[56:59], v0 offset:0
    s_waitcnt lgkmcnt(0)
    v_mfma_f32_16x16x32_bf16 v[28:31], v[56:59], v[20:23], 0
    s_nop 3
    ds_read_b128 v[60:63], v0 offset:1024
    s_waitcnt lgkmcnt(0)
    v_mfma_f32_16x16x32_bf16 v[28:31], v[60:63], v[24:27], v[28:31]
    s_nop 3
    ds_read_b128 v[56:59], v0 offset:2048
    s_waitcnt lgkmcnt(0)
    v_mfma_f32_16x16x32_bf16 v[28:31], v[56:59], v[72:75], v[28:31]
    s_nop 3
    ds_read_b128 v[60:63], v0 offset:3072
    s_waitcnt lgkmcnt(0)
    v_mfma_f32_16x16x32_bf16 v[28:31], v[60:63], v[44:47], v[28:31]
    s_nop 3
    ds_read_b128 v[56:59], v0 offset:4096
    s_waitcnt lgkmcnt(0)
    v_mfma_f32_16x16x32_bf16 v[32:35], v[56:59], v[20:23], 0
    s_nop 3
    ds_read_b128 v[60:63], v0 offset:5120
    s_waitcnt lgkmcnt(0)
    v_mfma_f32_16x16x32_bf16 v[32:35], v[60:63], v[24:27], v[32:35]
    s_nop 3
    ds_read_b128 v[56:59], v0 offset:6144
    s_waitcnt lgkmcnt(0)
    v_mfma_f32_16x16x32_bf16 v[32:35], v[56:59], v[72:75], v[32:35]
    s_nop 3
    ds_read_b128 v[60:63], v0 offset:7168
    s_waitcnt lgkmcnt(0)
    v_mfma_f32_16x16x32_bf16 v[32:35], v[60:63], v[44:47], v[32:35]
    s_nop 3
    ds_read_b128 v[56:59], v3 offset:20736
    s_waitcnt lgkmcnt(0)
    v_mfma_f32_16x16x32_bf16 v[40:43], v[56:59], v[20:23], 0
    s_nop 3
    ds_read_b128 v[60:63], v3 offset:20800
    s_waitcnt lgkmcnt(0)
    v_mfma_f32_16x16x32_bf16 v[40:43], v[60:63], v[24:27], v[40:43]
    s_nop 3
    ds_read_b128 v[56:59], v3 offset:20864
    s_waitcnt lgkmcnt(0)
    v_mfma_f32_16x16x32_bf16 v[40:43], v[56:59], v[72:75], v[40:43]
    s_nop 3
    ds_read_b128 v[60:63], v3 offset:20928
    s_waitcnt lgkmcnt(0)
    v_mfma_f32_16x16x32_bf16 v[40:43], v[60:63], v[44:47], v[40:43]
    s_nop 3
    v_max3_f32 v68, v28, v29, v30
    v_max3_f32 v68, v68, v31, v32
    v_max3_f32 v68, v68, v33, v34
    s_nop 0
    v_max3_f32 v68, v68, v35, v40
    v_max3_f32 v68, v68, v41, v42
    v_max_f32 v68, v68, v43
    v_mov_b32 v69, v68
    s_nop 1
    v_permlane16_swap_b32 v68, v69
    v_max_f32 v68, v68, v69
    v_mov_b32 v69, v68
    s_nop 1
    v_permlane32_swap_b32 v68, v69
    v_max_f32 v68, v68, v69
    v_sub_f32 v28, v28, v68
    v_exp_f32 v28, v28
    v_sub_f32 v29, v29, v68
    v_exp_f32 v29, v29
    v_sub_f32 v30, v30, v68
    v_exp_f32 v30, v30
    v_sub_f32 v31, v31, v68
    v_exp_f32 v31, v31
    v_sub_f32 v32, v32, v68
    v_exp_f32 v32, v32
    v_sub_f32 v33, v33, v68
    v_exp_f32 v33, v33
    v_sub_f32 v34, v34, v68
    v_exp_f32 v34, v34
    v_sub_f32 v35, v35, v68
    v_exp_f32 v35, v35
    v_sub_f32 v40, v40, v68
    v_exp_f32 v40, v40
    v_sub_f32 v41, v41, v68
    v_exp_f32 v41, v41
    v_sub_f32 v42, v42, v68
    v_exp_f32 v42, v42
    v_sub_f32 v43, v43, v68
    v_exp_f32 v43, v43
    v_cvt_pk_bf16_f32 v28, v28, v29
    v_cvt_pk_bf16_f32 v29, v30, v31
    v_cvt_pk_bf16_f32 v30, v32, v33
    v_cvt_pk_bf16_f32 v31, v34, v35
    v_cvt_pk_bf16_f32 v40, v40, v41
    v_cvt_pk_bf16_f32 v41, v42, v43
    v_mfma_f32_16x16x32_bf16 v[20:23], v[80:83], v[28:31], 0
    v_mfma_f32_16x16x32_bf16 v[24:27], v[84:87], v[28:31], 0
    v_mfma_f32_16x16x32_bf16 v[72:75], v[64:67], v[28:31], 0
    ds_read_b128 v[52:55], v3 offset:20800
    s_waitcnt lgkmcnt(0)
    s_nop 7
    v_mfma_f32_16x16x16_bf16 v[72:75], v[10:11], v[40:41], v[72:75]
    s_nop 7
    s_branch M_c1_1_fin
M_c1_1_last:
    s_cmp_lg_u32 s70, 0
    s_cbranch_scc1 M_c1_1_last2
    v_cmp_u_f32 vcc, v32, v32
    s_cbranch_vccnz M_c1_1_vfy0
M_c1_1_last2:
    s_lshl_b32 s4, s44, 18
    s_add_u32 s4, s4, s53
    buffer_store_dwordx4 v[76:79], v0, s[8:11], s4 offen offset:1024 sc1
    s_mov_b32 s4, 0x10000000
    s_waitcnt vmcnt(0) lgkmcnt(0)
    s_barrier
    v_mov_b32 v11, 8192
    s_mov_b64 exec, 1
    buffer_store_dword v11, v0, s[8:11], s52 offen sc1
    s_mov_b64 exec, -1
    s_add_u32 s52, s52, 4096
    s_nop 7
    v_mov_b64 v[72:73], -1
    v_mov_b64 v[74:75], -1
    s_add_u32 s28, s44, 3
    s_and_b32 s29, s28, 3
    s_mul_i32 s31, s22, 160
    s_mul_i32 s28, s29, 167936
    s_add_u32 s28, s28, s34
    s_add_u32 s64, s28, s35
    s_lshl_b32 s65, s22, 10
    s_add_u32 s65, s65, s28
    s_add_u32 s65, s65, 135168
    buffer_store_dwordx4 v[72:75], v0, s[8:11], s64 offen offset:1024 sc1
    buffer_store_dwordx4 v[72:75], v0, s[8:11], s64 offen offset:2048 sc1
    buffer_store_dwordx4 v[72:75], v0, s[8:11], s65 offen sc1
    s_mov_b32 s65, 0x10000000
    s_mov_b32 s64, 0x10000000
    s_waitcnt vmcnt(0)
    s_add_u32 s44, s44, 1
    s_branch M_c_fft
    s_cmp_eq_u32 s44, 128
    s_cbranch_scc1 M_end
    s_branch M_c1_1_layer
M_c1_1_lr:
    s_mov_b32 s30, 0
M_c1_1_lr_l:
    s_waitcnt lgkmcnt(0)
    ds_read_b128 v[36:39], v6 offset:13312
    ds_read_b128 v[40:43], v6 offset:14336
    ds_read_b128 v[44:47], v6 offset:15360
    ds_read_b128 v[48:51], v6 offset:16384
    ds_read_b128 v[52:55], v6 offset:17408
    s_waitcnt lgkmcnt(2)
    v_max3_u32 v10, v36, v40, v44
    s_waitcnt lgkmcnt(0)
    v_max3_u32 v10, v10, v48, v52
    v_cmp_eq_u32 vcc, -1, v10
    s_cbranch_vccz M_c1_1_lr_d
    s_add_u32 s30, s30, 1
    s_cmp_ge_u32 s30, 480000
    s_cbranch_scc1 M_fail
    s_branch M_c1_1_lr_l
M_c1_1_lr_d:
    ds_read_b128 v[56:59], v5 offset:0
    ds_read_b128 v[60:63], v5 offset:1024
    ds_read_b128 v[64:67], v5 offset:2048
    ds_read_b128 v[68:71], v5 offset:3072
    v_mov_b64 v[12:13], 0
    v_mov_b64 v[14:15], 0
    v_mov_b64 v[16:17], 0
    v_mov_b64 v[18:19], 0
    v_mov_b64 v[20:21], 0
    v_mov_b64 v[22:23], 0
    v_mov_b64 v[24:25], 0
    v_mov_b64 v[26:27], 0
    v_mov_b64 v[28:29], 0
    v_mov_b64 v[30:31], 0
    v_mov_b64 v[32:33], 0
    v_mov_b64 v[34:35], 0
    s_waitcnt lgkmcnt(0)
    s_branch M_c1_1_lr_r
M_c1_1_rr:
    s_mov_b32 s30, 0
M_c1_1_rr_l:
    s_waitcnt lgkmcnt(0)
    s_and_b32 s27, s30, 1
    s_cbranch_scc1 M_c1_1_rr_n
    s_waitcnt vmcnt(1)
    s_mov_b32 m0, 8192
    s_nop 0
    buffer_load_dwordx4 v0, s[8:11], s49 offen offset:2048 sc1 lds
M_c1_1_rr_n:
    ds_read_b128 v[36:39], v6 offset:8192
    ds_read_b128 v[40:43], v6 offset:9216
    ds_read_b128 v[44:47], v6 offset:10240
    ds_read_b128 v[48:51], v6 offset:11264
    ds_read_b32 v11, v6 offset:12288
    s_waitcnt lgkmcnt(2)
    v_max3_u32 v10, v36, v40, v44
    s_waitcnt lgkmcnt(0)
    v_max3_u32 v10, v10, v48, v11
    v_cmp_eq_u32 vcc, -1, v10
    s_cbranch_vccz M_c1_1_rr_d
    s_add_u32 s30, s30, 1
    s_cmp_ge_u32 s30, 480000
    s_cbranch_scc1 M_fail
    s_branch M_c1_1_rr_l
M_c1_1_rr_d:
    s_branch M_c1_1_rr_r
M_c1_1_first:
    s_mul_i32 s27, s21, 167936
    s_add_u32 s27, s27, s34
    s_mul_i32 s28, s22, 4224
    s_add_u32 s28, s28, s27
    s_mov_b32 exec_hi, 0
    buffer_load_dword v10, v9, s[8:11], s28 offen sc1
    s_lshl_b32 s28, s22, 10
    s_add_u32 s28, s28, s27
    s_add_u32 s28, s28, 135168
    s_mov_b64 exec, 0xff
    buffer_load_dword v10, v9, s[8:11], s28 offen sc1
    s_mul_i32 s27, s21, 5120
    s_add_u32 s27, s27, s41
    s_mul_i32 s28, s22, 160
    s_add_u32 s28, s28, s27
    s_mov_b64 exec, 3
    buffer_load_dword v10, v9, s[8:11], s28 offen sc1
    s_mov_b64 exec, -1
    s_barrier
    s_and_b32 s26, s44, 63
    s_lshl_b32 s26, s26, 18
    s_add_u32 s26, s26, s50
    s_add_u32 s26, s26, 2048
    s_add_u32 s3, s26, 16777216
    s_mov_b32 m0, 2048
    s_nop 0
    buffer_load_dwordx4 v0, s[8:11], s26 offen offset:0 sc1 lds
    buffer_load_dwordx4 v0, s[8:11], s26 offen offset:1024 sc1 lds
    buffer_load_dwordx4 v[80:83], v0, s[8:11], s3 offen offset:0 sc1
    buffer_load_dwordx4 v[84:87], v0, s[8:11], s3 offen offset:1024 sc1
    s_and_b32 s26, s44, 63
    s_add_u32 s26, s26, 1
    s_min_u32 s26, s26, 63
    s_lshl_b32 s26, s26, 18
    s_add_u32 s26, s26, s50
    s_add_u32 s26, s26, 2048
    s_add_u32 s3, s26, 16777216
    s_waitcnt vmcnt(0) lgkmcnt(0)
    s_barrier
    s_branch M_c1_1_first_r
M_c1_1_first2:
    ds_read_b64 v[10:11], v0 offset:23296
    s_waitcnt lgkmcnt(0)
    v_min_u32 v10, v10, v11
    s_nop 0
    v_readfirstlane_b32 s28, v10
    s_nop 0
    s_max_u32 s54, s54, s28
    s_add_u32 s27, s44, 2
    s_or_b32 s28, s44, 63
    s_add_u32 s28, s28, 1
    s_min_u32 s27, s27, s28
    s_cmp_lt_u32 s54, s27
    s_cbranch_scc1 M_c1_1_p2
M_c1_1_p2_r:
    s_branch M_c1_1_first2_r
M_c1_1_wq1:
    buffer_load_dwordx4 v[12:15], v0, s[8:11], s43 offen sc1
    s_waitcnt vmcnt(1)
    v_mfma_f32_16x16x32_bf16 v[28:31], v[72:75], v[16:19], 0
    v_cmp_eq_u32 vcc, -1, v16
    s_cbranch_vccnz M_c1_1_wqx
    v_mov_b32 v5, v5
    v_mov_b32 v5, v5
    v_mov_b32 v5, v5
    v_mov_b32 v5, v5
    v_mov_b32 v5, v5
    v_mov_b32 v5, v5
    v_add_f32_dpp v28, v28, v28 row_ror:8 row_mask:0xf bank_mask:0xf
    v_add_f32_dpp v29, v29, v29 row_ror:8 row_mask:0xf bank_mask:0xf
    s_nop 0
    v_add_f32_dpp v28, v28, v28 row_ror:4 row_mask:0xf bank_mask:0xf
    v_add_f32_dpp v29, v29, v29 row_ror:4 row_mask:0xf bank_mask:0xf
    s_nop 0
    v_add_f32_dpp v28, v28, v28 row_ror:2 row_mask:0xf bank_mask:0xf
    v_add_f32_dpp v29, v29, v29 row_ror:2 row_mask:0xf bank_mask:0xf
    v_cmp_u_f32 vcc, v28, v28
    v_cvt_pk_bf16_f32 v28, v28, v29
    s_cbranch_vccnz M_c1_1_wqe1
    s_mov_b64 exec, s[62:63]
    buffer_store_dword v28, v11, s[8:11], s58 offen sc1
    s_barrier
    buffer_store_dword v28, v11, s[8:11], s56 offen sc1
    s_branch M_c1_1_wrb_g
M_c1_1_wqx:
    s_branch M_c1_1_wrb_i1
M_c1_1_wqe1:
    s_waitcnt vmcnt(0)
    buffer_load_dwordx4 v[12:15], v0, s[8:11], s43 offen sc1
    s_branch M_c1_1_wrb_e1
M_c1_1_wrb_l:
    s_waitcnt vmcnt(1)
    v_mfma_f32_16x16x32_bf16 v[28:31], v[72:75], v[12:15], 0
    v_cmp_eq_u32 vcc, -1, v12
    s_cbranch_vccz M_c1_1_wrb_x0
M_c1_1_wrb_i0:
    buffer_load_dwordx4 v[12:15], v0, s[8:11], s43 offen sc1
    s_waitcnt vmcnt(1)
    v_mfma_f32_16x16x32_bf16 v[28:31], v[72:75], v[16:19], 0
    v_cmp_eq_u32 vcc, -1, v16
    s_cbranch_vccz M_c1_1_wrb_x1
M_c1_1_wrb_i1:
    buffer_load_dwordx4 v[16:19], v0, s[8:11], s43 offen sc1
    s_add_u32 s71, s71, 1
    s_cmp_lt_u32 s71, 240000
    s_cbranch_scc1 M_c1_1_wrb_l
    s_branch M_fail
M_c1_1_wrb_x0:
    s_nop 5
    v_add_f32_dpp v28, v28, v28 row_ror:8 row_mask:0xf bank_mask:0xf
    v_add_f32_dpp v29, v29, v29 row_ror:8 row_mask:0xf bank_mask:0xf
    s_nop 0
    v_add_f32_dpp v28, v28, v28 row_ror:4 row_mask:0xf bank_mask:0xf
    v_add_f32_dpp v29, v29, v29 row_ror:4 row_mask:0xf bank_mask:0xf
    s_nop 0
    v_add_f32_dpp v28, v28, v28 row_ror:2 row_mask:0xf bank_mask:0xf
    v_add_f32_dpp v29, v29, v29 row_ror:2 row_mask:0xf bank_mask:0xf
    v_cmp_u_f32 vcc, v28, v28
    v_cvt_pk_bf16_f32 v28, v28, v29
    s_cbranch_vccz M_c1_1_wrb_n
M_c1_1_wrb_e0:
    v_max3_u32 v32, v12, v13, v14
    v_max_u32 v32, v32, v15
    v_cmp_eq_u32 vcc, -1, v32
    s_cbranch_vccnz M_c1_1_wrb_i0
    v_min_u32 v28, -2, v28
    v_min_u32 v29, -2, v29
    s_branch M_c1_1_wrb_n
M_c1_1_wrb_x1:
    s_nop 5
    v_add_f32_dpp v28, v28, v28 row_ror:8 row_mask:0xf bank_mask:0xf
    v_add_f32_dpp v29, v29, v29 row_ror:8 row_mask:0xf bank_mask:0xf
    s_nop 0
    v_add_f32_dpp v28, v28, v28 row_ror:4 row_mask:0xf bank_mask:0xf
    v_add_f32_dpp v29, v29, v29 row_ror:4 row_mask:0xf bank_mask:0xf
    s_nop 0
    v_add_f32_dpp v28, v28, v28 row_ror:2 row_mask:0xf bank_mask:0xf
    v_add_f32_dpp v29, v29, v29 row_ror:2 row_mask:0xf bank_mask:0xf
    v_cmp_u_f32 vcc, v28, v28
    v_cvt_pk_bf16_f32 v28, v28, v29
    s_cbranch_vccz M_c1_1_wrb_n
M_c1_1_wrb_e1:
    v_max3_u32 v32, v16, v17, v18
    v_max_u32 v32, v32, v19
    v_cmp_eq_u32 vcc, -1, v32
    s_cbranch_vccnz M_c1_1_wrb_i1
    v_min_u32 v28, -2, v28
    v_min_u32 v29, -2, v29
M_c1_1_wrb_n:
    s_mov_b64 exec, s[62:63]
    buffer_store_dword v28, v11, s[8:11], s58 offen sc1
    s_branch M_c1_1_wrb_d
M_c1_1_p2:
    s_mov_b32 s30, 0
M_c1_1_p2_l:
    s_waitcnt lgkmcnt(0)
    s_mov_b64 exec, 3
    buffer_load_dword v10, v9, s[8:11], s51 offen sc1
    s_waitcnt vmcnt(0)
    s_mov_b64 exec, -1
    v_readlane_b32 s54, v10, 0
    v_readlane_b32 s28, v10, 1
    s_nop 3
    s_min_u32 s54, s54, s28
    s_cmp_ge_u32 s54, s27
    s_cbranch_scc1 M_c1_1_p2_r
    s_sleep 2
    s_add_u32 s30, s30, 1
    s_cmp_ge_u32 s30, 240000
    s_cbranch_scc1 M_fail
    s_branch M_c1_1_p2_l
M_c1_2_layer:
    s_lshr_b32 s27, s44, 6
    s_mul_i32 s50, s27, 33554432
    s_lshl_b32 s27, s22, 13
    s_add_u32 s50, s50, s27
    s_add_u32 s50, s50, 37748736
    s_barrier
    s_mov_b32 s26, 0x10010000
    s_mov_b32 s3, s26
    s_mul_i32 s27, s20, 5120
    s_add_u32 s48, s27, 167772160
    s_sub_u32 s49, 167777280, s27
    s_mov_b32 m0, 13312
    s_nop 0
    buffer_load_dwordx4 v0, s[8:11], s48 offen offset:0 sc1 lds
    buffer_load_dwordx4 v0, s[8:11], s48 offen offset:1024 sc1 lds
    buffer_load_dwordx4 v0, s[8:11], s48 offen offset:2048 sc1 lds
    s_and_b32 s55, s44, 3
    s_mul_i32 s55, s55, 167936
    s_add_u32 s55, s55, s34
    s_add_u32 s58, s55, s35
    s_and_b32 s57, s44, 63
    s_add_u32 s42, s44, 2
    s_or_b32 s28, s44, 63
    s_add_u32 s28, s28, 1
    s_min_u32 s42, s42, s28
    s_sub_u32 s61, s3, 4096
    s_cmp_ge_u32 s54, s42
    s_cselect_b32 s61, s61, 0x10000000
    ds_read_b128 v[56:59], v5 offset:0
    ds_read_b128 v[60:63], v5 offset:1024
    ds_read_b128 v[64:67], v5 offset:2048
    ds_read_b128 v[68:71], v5 offset:3072
    v_mov_b64 v[12:13], 0
    v_mov_b64 v[14:15], 0
    v_mov_b64 v[16:17], 0
    v_mov_b64 v[18:19], 0
    v_mov_b64 v[20:21], 0
    v_mov_b64 v[22:23], 0
    v_mov_b64 v[24:25], 0
    v_mov_b64 v[26:27], 0
    v_mov_b64 v[28:29], 0
    v_mov_b64 v[30:31], 0
    v_mov_b64 v[32:33], 0
    v_mov_b64 v[34:35], 0
    s_mov_b32 s70, 0
    s_waitcnt vmcnt(0) lgkmcnt(0)
M_c1_2_top:
    s_waitcnt vmcnt(6)
    s_barrier
    ds_read_b128 v[36:39], v6 offset:13312
    ds_read_b128 v[40:43], v6 offset:14336
    s_mov_b32 m0, 8192
    s_nop 0
    buffer_load_dwordx4 v0, s[8:11], s49 offen offset:3072 sc1 lds
M_c1_2_lr_r:
    s_waitcnt lgkmcnt(1)
    v_smfmac_f32_16x16x64_bf16 v[20:23], v[36:39], v[56:63], v1
    ds_read_b128 v[56:59], v5 offset:4096
    v_smfmac_f32_16x16x64_bf16 v[24:27], v[36:39], v[64:71], v1
    ds_read_b128 v[60:63], v5 offset:5120
    v_smfmac_f32_16x16x64_bf16 v[28:31], v[36:39], a[248:255], v1
    ds_read_b128 v[64:67], v5 offset:6144
    v_smfmac_f32_16x16x64_bf16 v[32:35], v[36:39], a[240:247], v1
    ds_read_b128 v[68:71], v5 offset:7168
    v_smfmac_f32_16x16x64_bf16 v[12:15], v[36:39], a[232:239], v1
    ds_read_b128 v[44:47], v6 offset:15360
    s_waitcnt lgkmcnt(3)
    v_smfmac_f32_16x16x64_bf16 v[16:19], v[36:39], v[56:63], v1
    ds_read_b128 v[56:59], v5 offset:8192
    v_smfmac_f32_16x16x64_bf16 v[20:23], v[40:43], a[224:231], v1
    ds_read_b128 v[60:63], v5 offset:9216
    s_waitcnt lgkmcnt(3)
    v_smfmac_f32_16x16x64_bf16 v[24:27], v[40:43], v[64:71], v1
    ds_read_b128 v[64:67], v5 offset:10240
    v_smfmac_f32_16x16x64_bf16 v[28:31], v[40:43], a[216:223], v1
    ds_read_b128 v[68:71], v5 offset:11264
    v_smfmac_f32_16x16x64_bf16 v[32:35], v[40:43], a[208:215], v1
    ds_read_b128 v[48:51], v6 offset:16384
    s_waitcnt lgkmcnt(3)
    v_smfmac_f32_16x16x64_bf16 v[12:15], v[40:43], v[56:63], v1
    ds_read_b128 v[56:59], v5 offset:12288
    v_smfmac_f32_16x16x64_bf16 v[16:19], v[40:43], a[200:207], v1
    ds_read_b128 v[60:63], v5 offset:13312
    s_waitcnt lgkmcnt(3)
    v_smfmac_f32_16x16x64_bf16 v[20:23], v[44:47], v[64:71], v1
    ds_read_b128 v[64:67], v5 offset:14336
    v_smfmac_f32_16x16x64_bf16 v[24:27], v[44:47], a[192:199], v1
    ds_read_b128 v[68:71], v5 offset:15360
    v_smfmac_f32_16x16x64_bf16 v[28:31], v[44:47], a[184:191], v1
    ds_read_b128 v[52:55], v6 offset:17408
    s_waitcnt lgkmcnt(3)
    v_smfmac_f32_16x16x64_bf16 v[32:35], v[44:47], v[56:63], v1
    ds_read_b128 v[56:59], v5 offset:16384
    v_smfmac_f32_16x16x64_bf16 v[20:23], v[48:51], a[176:183], v1
    ds_read_b128 v[60:63], v5 offset:17408
    s_waitcnt lgkmcnt(3)
    v_max3_u32 v10, v36, v40, v44
    v_smfmac_f32_16x16x64_bf16 v[24:27], v[48:51], v[64:71], v1
    ds_read_b128 v[64:67], v5 offset:18432
    s_waitcnt lgkmcnt(3)
    v_max3_u32 v10, v10, v48, v52
    v_smfmac_f32_16x16x64_bf16 v[28:31], v[48:51], a[168:175], v1
    ds_read_b128 v[68:71], v5 offset:19456
    v_cmp_eq_u32 vcc, -1, v10
    v_smfmac_f32_16x16x64_bf16 v[32:35], v[48:51], a[160:167], v1
    s_cbranch_vccnz M_c1_2_lr
    s_waitcnt vmcnt(0)
    s_barrier
    ds_read_b128 v[36:39], v6 offset:8192
    ds_read_b128 v[40:43], v6 offset:9216
    s_waitcnt lgkmcnt(4)
    v_smfmac_f32_16x16x64_bf16 v[20:23], v[52:55], v[56:63], v1
    ds_read_b128 v[44:47], v6 offset:10240
    ds_read_b128 v[48:51], v6 offset:11264
    v_smfmac_f32_16x16x64_bf16 v[24:27], v[52:55], a[152:159], v1
    ds_read_b32 v11, v6 offset:12288
    ds_read_b128 v[56:59], v5 offset:20480
    s_waitcnt lgkmcnt(6)
    v_smfmac_f32_16x16x64_bf16 v[28:31], v[52:55], v[64:71], v1
    ds_read_b128 v[60:63], v5 offset:21504
    s_waitcnt lgkmcnt(4)
    v_max3_u32 v10, v36, v40, v44
    v_smfmac_f32_16x16x64_bf16 v[32:35], v[52:55], a[144:151], v1
    s_waitcnt lgkmcnt(2)
    v_max3_u32 v10, v10, v48, v11
    v_cmp_eq_u32 vcc, -1, v10
    s_cbranch_vccnz M_c1_2_rr
M_c1_2_rr_r:
    s_mov_b32 m0, 23040
    ds_read_b128 v[64:67], v5 offset:22528
    ds_read_b128 v[68:71], v5 offset:23552
    ds_read_b128 v[52:55], v6 offset:12288
    buffer_store_dwordx4 v[76:79], v0, s[8:11], s4 offen offset:2048 sc1
    s_mov_b32 s4, 0x10000000
    buffer_load_dword v9, s[8:11], s61 offen sc1 lds
    v_smfmac_f32_16x16x64_bf16 v[20:23], v[36:39], a[136:143], v1
    s_waitcnt lgkmcnt(3)
    v_smfmac_f32_16x16x64_bf16 v[24:27], v[36:39], v[56:63], v1
    ds_read_b128 v[56:59], v5 offset:24576
    v_smfmac_f32_16x16x64_bf16 v[20:23], v[40:43], a[128:135], v1
    ds_read_b128 v[60:63], v5 offset:25600
    s_waitcnt lgkmcnt(3)
    v_smfmac_f32_16x16x64_bf16 v[24:27], v[40:43], v[64:71], v1
    ds_read_b128 v[64:67], v5 offset:26624
    v_smfmac_f32_16x16x64_bf16 v[20:23], v[44:47], a[120:127], v1
    ds_read_b128 v[68:71], v5 offset:27648
    v_smfmac_f32_16x16x64_bf16 v[24:27], v[44:47], a[112:119], v1
    s_waitcnt lgkmcnt(2)
    v_smfmac_f32_16x16x64_bf16 v[20:23], v[48:51], v[56:63], v1
    ds_read_b128 v[56:59], v5 offset:28672
    v_smfmac_f32_16x16x64_bf16 v[24:27], v[48:51], a[104:111], v1
    ds_read_b128 v[60:63], v5 offset:29696
    s_waitcnt lgkmcnt(2)
    v_smfmac_f32_16x16x64_bf16 v[20:23], v[52:55], v[64:71], v1
    ds_read_b128 v[64:67], v5 offset:30720
    v_smfmac_f32_16x16x64_bf16 v[24:27], v[52:55], a[96:103], v1
    ds_read_b128 v[68:71], v5 offset:31744
    v_smfmac_f32_16x16x64_bf16 v[28:31], v[36:39], a[88:95], v1
    s_cmp_eq_u32 s57, 0
    s_cbranch_scc1 M_c1_2_first
M_c1_2_first_r:
    s_waitcnt lgkmcnt(2)
    v_smfmac_f32_16x16x64_bf16 v[32:35], v[36:39], v[56:63], v1
    ds_read_b128 v[56:59], v5 offset:32768
    v_permlane32_swap_b32 v20, v21
    v_smfmac_f32_16x16x64_bf16 v[28:31], v[40:43], a[80:87], v1
    ds_read_b128 v[60:63], v5 offset:33792
    s_waitcnt lgkmcnt(2)
    v_permlane32_swap_b32 v22, v23
    v_smfmac_f32_16x16x64_bf16 v[32:35], v[40:43], v[64:71], v1
    ds_read_b128 v[64:67], v0 offset:2048
    v_permlane32_swap_b32 v24, v25
    v_smfmac_f32_16x16x64_bf16 v[28:31], v[44:47], a[72:79], v1
    ds_read_b128 v[68:71], v0 offset:3072
    v_permlane32_swap_b32 v26, v27
    v_smfmac_f32_16x16x64_bf16 v[32:35], v[44:47], a[64:71], v1
    s_waitcnt lgkmcnt(2)
    v_add_f32 v20, v20, v21
    v_add_f32 v22, v22, v23
    v_smfmac_f32_16x16x64_bf16 v[28:31], v[48:51], v[56:63], v1
    ds_read_b128 v[56:59], v0 offset:0
    v_add_f32 v24, v24, v25
    v_add_f32 v26, v26, v27
    v_smfmac_f32_16x16x64_bf16 v[32:35], v[48:51], a[56:63], v1
    ds_read_b128 v[60:63], v0 offset:1024
    v_mul_f32 v20, s40, v20
    v_mul_f32 v24, s40, v24
    v_smfmac_f32_16x16x64_bf16 v[28:31], v[52:55], a[48:55], v1
    v_mul_f32 v22, s40, v22
    v_mul_f32 v26, s40, v26
    v_smfmac_f32_16x16x64_bf16 v[32:35], v[52:55], a[40:47], v1
    v_cvt_pk_bf16_f32 v20, v20, v24
    v_cvt_pk_bf16_f32 v21, v22, v26
    v_smfmac_f32_16x16x64_bf16 v[12:15], v[36:39], a[32:39], v1
    ds_write_b32 v2, v20 offset:18432
    v_smfmac_f32_16x16x64_bf16 v[16:19], v[36:39], a[24:31], v1
    ds_write_b32 v2, v21 offset:19008
    v_permlane32_swap_b32 v28, v29
    v_smfmac_f32_16x16x64_bf16 v[12:15], v[40:43], a[16:23], v1
    ds_read_b128 v[36:39], v6 offset:15360
    v_permlane32_swap_b32 v30, v31
    v_smfmac_f32_16x16x64_bf16 v[16:19], v[40:43], a[8:15], v1
    ds_read_b128 v[40:43], v6 offset:16384
    v_permlane32_swap_b32 v32, v33
    v_smfmac_f32_16x16x64_bf16 v[12:15], v[44:47], a[0:7], v1
    s_waitcnt lgkmcnt(2)
    s_barrier
    v_permlane32_swap_b32 v34, v35
    v_smfmac_f32_16x16x64_bf16 v[16:19], v[44:47], v[248:255], v1
    ds_read_b128 v[20:23], v3 offset:18432
    v_add_f32 v28, v28, v29
    v_add_f32 v30, v30, v31
    v_smfmac_f32_16x16x64_bf16 v[12:15], v[48:51], v[240:247], v1
    ds_read_b128 v[24:27], v3 offset:18496
    v_add_f32 v32, v32, v33
    v_add_f32 v34, v34, v35
    v_smfmac_f32_16x16x64_bf16 v[16:19], v[48:51], v[232:239], v1
    ds_read_b128 v[72:75], v3 offset:18560
    v_cvt_pk_bf16_f32 v28, v28, v32
    v_cvt_pk_bf16_f32 v29, v30, v34
    v_smfmac_f32_16x16x64_bf16 v[12:15], v[52:55], v[224:231], v1
    ds_write_b32 v2, v28 offset:20736
    ds_read_b128 v[44:47], v3 offset:18624
    v_smfmac_f32_16x16x64_bf16 v[16:19], v[52:55], v[216:223], v1
    ds_write_b32 v2, v29 offset:21312
    s_waitcnt lgkmcnt(7)
    v_smfmac_f32_16x16x64_bf16 v[12:15], v[36:39], v[208:215], v1
    ds_read_b128 v[48:51], v6 offset:17408
    v_mov_b64 v[10:11], s[16:17]
    v_smfmac_f32_16x16x64_bf16 v[16:19], v[36:39], v[200:207], v1
    s_waitcnt lgkmcnt(6)
    v_mfma_f32_16x16x32_bf16 v[28:31], v[56:59], v[20:23], 0
    ds_read_b128 v[56:59], v0 offset:4096
    s_waitcnt lgkmcnt(6)
    v_mfma_f32_16x16x32_bf16 v[28:31], v[60:63], v[24:27], v[28:31]
    ds_read_b128 v[60:63], v0 offset:5120
    s_waitcnt lgkmcnt(3)
    s_barrier
    v_mfma_f32_16x16x32_bf16 v[28:31], v[64:67], v[72:75], v[28:31]
    ds_read_b128 v[64:67], v0 offset:6144
    v_mfma_f32_16x16x32_bf16 v[28:31], v[68:71], v[44:47], v[28:31]
    ds_read_b128 v[68:71], v0 offset:7168
    v_smfmac_f32_16x16x64_bf16 v[12:15], v[40:43], v[192:199], v1
    ds_read_b128 v[36:39], v3 offset:20736
    v_smfmac_f32_16x16x64_bf16 v[16:19], v[40:43], v[184:191], v1
    ds_read_b128 v[52:55], v3 offset:20800
    s_waitcnt lgkmcnt(4)
    v_mfma_f32_16x16x32_bf16 v[32:35], v[56:59], v[20:23], 0
    s_nop 0
    v_exp_f32 v28, v28
    ds_read_b128 v[56:59], v3 offset:20864
    v_mfma_f32_16x16x32_bf16 v[32:35], v[60:63], v[24:27], v[32:35]
    s_waitcnt lgkmcnt(3)
    v_exp_f32 v29, v29
    ds_read_b128 v[60:63], v3 offset:20928
    v_mfma_f32_16x16x32_bf16 v[32:35], v[64:67], v[72:75], v[32:35]
    v_exp_f32 v30, v30
    v_mfma_f32_16x16x32_bf16 v[32:35], v[68:71], v[44:47], v[32:35]
    s_waitcnt lgkmcnt(3)
    v_exp_f32 v31, v31
    v_mfma_f32_16x16x32_bf16 v[40:43], v[36:39], v[20:23], 0
    s_waitcnt lgkmcnt(2)
    v_cvt_pk_bf16_f32 v28, v28, v29
    v_cvt_pk_bf16_f32 v29, v30, v31
    v_mfma_f32_16x16x32_bf16 v[40:43], v[52:55], v[24:27], v[40:43]
    s_waitcnt lgkmcnt(1)
    v_mov_b64 v[64:65], s[24:25]
    v_mov_b64 v[66:67], s[24:25]
    v_mfma_f32_16x16x32_bf16 v[40:43], v[56:59], v[72:75], v[40:43]
    s_waitcnt lgkmcnt(0)
    v_exp_f32 v32, v32
    v_mfma_f32_16x16x32_bf16 v[40:43], v[60:63], v[44:47], v[40:43]
    v_exp_f32 v33, v33
    v_smfmac_f32_16x16x64_bf16 v[12:15], v[48:51], v[176:183], v1
    v_exp_f32 v34, v34
    v_smfmac_f32_16x16x64_bf16 v[16:19], v[48:51], v[168:175], v1
    v_exp_f32 v35, v35
    v_cvt_pk_bf16_f32 v30, v32, v33
    v_cvt_pk_bf16_f32 v31, v34, v35
    s_nop 0
    v_exp_f32 v40, v40
    v_mfma_f32_16x16x32_bf16 v[72:75], v[64:67], v[28:31], 0
    v_exp_f32 v41, v41
    v_mfma_f32_16x16x32_bf16 v[20:23], v[80:83], v[28:31], 0
    v_exp_f32 v42, v42
    v_mfma_f32_16x16x32_bf16 v[24:27], v[84:87], v[28:31], 0
    v_exp_f32 v43, v43
    v_cvt_pk_bf16_f32 v40, v40, v41
    v_cvt_pk_bf16_f32 v41, v42, v43
    v_cvt_pk_bf16_f32 v12, v12, v13
    v_cvt_pk_bf16_f32 v13, v14, v15
    v_mfma_f32_16x16x16_bf16 v[72:75], v[10:11], v[40:41], v[72:75]
    v_cvt_pk_bf16_f32 v14, v16, v17
    v_cvt_pk_bf16_f32 v15, v18, v19
M_c1_2_fin:
    v_mfma_f32_16x16x16_bf16 v[20:23], v[12:13], v[40:41], v[20:23]
    s_cmp_eq_u32 s57, 63
    v_cndmask_b32_e64 v76, v12, v56, s[66:67]
    v_cndmask_b32_e64 v77, v13, v57, s[66:67]
    v_mfma_f32_16x16x16_bf16 v[24:27], v[14:15], v[40:41], v[24:27]
    v_cndmask_b32_e64 v78, v14, v58, s[66:67]
    v_cndmask_b32_e64 v79, v15, v59, s[66:67]
    s_cbranch_scc1 M_c1_2_last
    v_rcp_f32 v74, v72
    v_subrev_u32 v73, s68, v72
    v_cmp_lt_u32 vcc, s69, v73
    v_mov_b64 v[44:45], 0
    v_mov_b64 v[46:47], 0
    v_cndmask_b32_e64 v20, v20, v24, s[18:19]
    v_cndmask_b32_e64 v21, v21, v25, s[18:19]
    v_cndmask_b32_e64 v22, v22, v26, s[18:19]
    v_cndmask_b32_e64 v23, v23, v27, s[18:19]
    v_pk_mul_f32 v[20:21], v[20:21], v[74:75] op_sel_hi:[1,0]
    v_pk_mul_f32 v[22:23], v[22:23], v[74:75] op_sel_hi:[1,0]
    v_cvt_pk_bf16_f32 v20, v20, v21
    v_cvt_pk_bf16_f32 v21, v22, v23
    ds_write_b64 v0, v[20:21] offset:14336
    s_cbranch_vccnz M_c1_2_zbad
M_c1_2_zok:
    s_cmp_lt_u32 s54, s42
    s_cbranch_scc1 M_c1_2_first2
M_c1_2_first2_r:
    buffer_load_dwordx4 v[80:83], v0, s[8:11], s3 offen offset:0 sc1
    buffer_load_dwordx4 v[84:87], v0, s[8:11], s3 offen offset:1024 sc1
    s_waitcnt lgkmcnt(0)
    s_barrier
    ds_read_b128 v[32:35], v0 offset:13312
    ds_read_b128 v[52:55], v0 offset:14336
    s_mov_b32 m0, 4096
    s_nop 0
    buffer_load_dwordx4 v0, s[8:11], s26 offen offset:0 sc1 lds
    buffer_load_dwordx4 v0, s[8:11], s26 offen offset:1024 sc1 lds
    v_mov_b64 v[68:69], 0
    v_mov_b64 v[70:71], 0
    v_mov_b64 v[64:65], 0
    v_mov_b64 v[66:67], 0
    v_mov_b64 v[60:61], 0
    v_mov_b64 v[62:63], 0
    v_mov_b64 v[56:57], 0
    v_mov_b64 v[58:59], 0
    s_waitcnt lgkmcnt(1)
    s_nop 0
    v_smfmac_f32_16x16x64_bf16 v[56:59], v[32:35], v[160:167], v1
    v_smfmac_f32_16x16x64_bf16 v[60:63], v[32:35], v[144:151], v1
    s_waitcnt lgkmcnt(0)
    v_smfmac_f32_16x16x64_bf16 v[56:59], v[52:55], v[152:159], v1
    v_smfmac_f32_16x16x64_bf16 v[60:63], v[52:55], v[136:143], v1
    v_smfmac_f32_16x16x64_bf16 v[64:67], v[32:35], v[128:135], v1
    v_smfmac_f32_16x16x64_bf16 v[68:71], v[32:35], v[112:119], v1
    v_permlane32_swap_b32 v56, v57
    v_smfmac_f32_16x16x64_bf16 v[64:67], v[52:55], v[120:127], v1
    v_permlane32_swap_b32 v58, v59
    v_smfmac_f32_16x16x64_bf16 v[68:71], v[52:55], v[104:111], v1
    v_add_f32 v56, v56, v57
    v_add_f32 v58, v58, v59
    v_smfmac_f32_16x16x64_bf16 v[44:47], v[32:35], v[96:103], v1
    v_permlane32_swap_b32 v60, v61
    v_smfmac_f32_16x16x64_bf16 v[44:47], v[52:55], v[88:95], v1
    v_permlane32_swap_b32 v62, v63
    v_add_f32 v60, v60, v61
    v_add_f32 v62, v62, v63
    v_cvt_pk_bf16_f32 v36, v56, v60
    v_cvt_pk_bf16_f32 v38, v58, v62
    v_permlane32_swap_b32 v64, v65
    v_permlane32_swap_b32 v66, v67
    v_add_f32 v64, v64, v65
    v_add_f32 v66, v66, v67
    v_permlane32_swap_b32 v68, v69
    v_permlane32_swap_b32 v70, v71
    v_add_f32 v68, v68, v69
    v_add_f32 v70, v70, v71
    v_cvt_pk_bf16_f32 v37, v64, v68
    v_cvt_pk_bf16_f32 v39, v66, v70
    buffer_store_dwordx4 v[36:39], v0, s[8:11], s58 offen sc1
    v_permlane32_swap_b32 v44, v45
    v_permlane32_swap_b32 v46, v47
    v_add_f32 v44, v44, v45
    v_add_f32 v46, v46, v47
    v_cvt_pk_bf16_f32 v44, v44, v46
    buffer_store_dword v44, v7, s[8:11], s55 offen sc1
    s_add_u32 s27, s44, 1
    s_and_b32 s27, s27, 3
    s_mul_i32 s48, s27, 5120
    s_add_u32 s48, s48, s41
    s_lshl_b32 s27, s27, 15
    s_add_u32 s49, s27, s47
    ds_read_b128 v[56:59], v5 offset:0
    ds_read_b128 v[60:63], v5 offset:1024
    ds_read_b128 v[64:67], v5 offset:2048
    ds_read_b128 v[68:71], v5 offset:3072
    v_mov_b64 v[12:13], 0
    v_mov_b64 v[14:15], 0
    v_mov_b64 v[16:17], 0
    v_mov_b64 v[18:19], 0
    v_mov_b64 v[20:21], 0
    v_mov_b64 v[22:23], 0
    v_mov_b64 v[24:25], 0
    v_mov_b64 v[26:27], 0
    v_mov_b64 v[28:29], 0
    v_mov_b64 v[30:31], 0
    v_mov_b64 v[32:33], 0
    v_mov_b64 v[34:35], 0
    ds_read_b64 v[10:11], v0 offset:23296
    s_waitcnt lgkmcnt(0)
    v_min_u32 v10, v10, v11
    s_nop 0
    v_readfirstlane_b32 s28, v10
    s_nop 0
    s_max_u32 s54, s54, s28
    s_barrier
    s_and_b32 s26, s44, 63
    s_add_u32 s26, s26, 2
    s_min_u32 s26, s26, 63
    s_lshl_b32 s26, s26, 18
    s_add_u32 s26, s26, s50
    s_add_u32 s26, s26, 4096
    s_add_u32 s3, s26, 16777216
    s_lshl_b32 s4, s44, 18
    s_add_u32 s4, s4, s53
    s_add_u32 s44, s44, 1
    s_and_b32 s55, s44, 3
    s_mul_i32 s55, s55, 167936
    s_add_u32 s55, s55, s34
    s_add_u32 s58, s55, s35
    s_and_b32 s57, s44, 63
    s_add_u32 s42, s44, 2
    s_or_b32 s28, s44, 63
    s_add_u32 s28, s28, 1
    s_min_u32 s42, s42, s28
    s_sub_u32 s61, s3, 4096
    s_cmp_ge_u32 s54, s42
    s_cselect_b32 s61, s61, 0x10000000
    s_nop 15
    s_nop 15
    s_nop 5
    s_mov_b32 m0, 13312
    s_nop 0
    buffer_load_dwordx4 v0, s[8:11], s48 offen offset:0 sc1 lds
    buffer_load_dwordx4 v0, s[8:11], s48 offen offset:1024 sc1 lds
    buffer_load_dwordx4 v0, s[8:11], s48 offen offset:2048 sc1 lds
    s_nop 13
    s_mov_b32 m0, 13312
    s_nop 0
    buffer_load_dwordx4 v0, s[8:11], s48 offen offset:0 sc1 lds
    buffer_load_dwordx4 v0, s[8:11], s48 offen offset:1024 sc1 lds
    buffer_load_dwordx4 v0, s[8:11], s48 offen offset:2048 sc1 lds
    s_nop 13
    s_mov_b32 m0, 13312
    s_nop 0
    buffer_load_dwordx4 v0, s[8:11], s48 offen offset:0 sc1 lds
    buffer_load_dwordx4 v0, s[8:11], s48 offen offset:1024 sc1 lds
    buffer_load_dwordx4 v0, s[8:11], s48 offen offset:2048 sc1 lds
    s_mov_b32 s70, 0
    s_branch M_c1_2_top
M_c1_2_restart:
    s_waitcnt vmcnt(0) lgkmcnt(0)
    s_nop 7
    s_barrier
    s_mov_b32 m0, 13312
    s_nop 0
    buffer_load_dwordx4 v0, s[8:11], s48 offen offset:0 sc1 lds
    buffer_load_dwordx4 v0, s[8:11], s48 offen offset:1024 sc1 lds
    buffer_load_dwordx4 v0, s[8:11], s48 offen offset:2048 sc1 lds
    ds_read_b128 v[56:59], v5 offset:0
    ds_read_b128 v[60:63], v5 offset:1024
    ds_read_b128 v[64:67], v5 offset:2048
    ds_read_b128 v[68:71], v5 offset:3072
    v_mov_b64 v[12:13], 0
    v_mov_b64 v[14:15], 0
    v_mov_b64 v[16:17], 0
    v_mov_b64 v[18:19], 0
    v_mov_b64 v[20:21], 0
    v_mov_b64 v[22:23], 0
    v_mov_b64 v[24:25], 0
    v_mov_b64 v[26:27], 0
    v_mov_b64 v[28:29], 0
    v_mov_b64 v[30:31], 0
    v_mov_b64 v[32:33], 0
    v_mov_b64 v[34:35], 0
    s_waitcnt vmcnt(0) lgkmcnt(0)
    s_branch M_c1_2_top
M_c1_2_zbad:
    s_cmp_eq_u32 s70, 2
    s_cbranch_scc1 M_c1_2_zok
    v_cmp_u_f32 vcc, v72, v72
    s_cbranch_vccz M_c1_2_exact
    s_cmp_eq_u32 s70, 1
    s_cbranch_scc1 M_c1_2_exact
M_c1_2_vfy0:
    s_mov_b32 s70, 1
    s_mov_b32 s30, 0
    s_waitcnt vmcnt(0) lgkmcnt(0)
    s_nop 7
M_c1_2_vfy:
    v_mov_b32 v10, 0
    s_add_u32 s59, s48, 4096
    buffer_load_dwordx4 v[36:39], v0, s[8:11], s48 offen offset:0 sc1
    buffer_load_dwordx4 v[40:43], v0, s[8:11], s48 offen offset:1024 sc1
    buffer_load_dwordx4 v[44:47], v0, s[8:11], s48 offen offset:2048 sc1
    buffer_load_dwordx4 v[48:51], v0, s[8:11], s48 offen offset:3072 sc1
    buffer_load_dwordx4 v[52:55], v0, s[8:11], s59 offen offset:0 sc1
    s_waitcnt vmcnt(4)
    v_max3_u32 v10, v10, v36, v37
    v_max3_u32 v10, v10, v38, v39
    s_waitcnt vmcnt(3)
    v_max3_u32 v10, v10, v40, v41
    v_max3_u32 v10, v10, v42, v43
    s_waitcnt vmcnt(2)
    v_max3_u32 v10, v10, v44, v45
    v_max3_u32 v10, v10, v46, v47
    s_waitcnt vmcnt(1)
    v_max3_u32 v10, v10, v48, v49
    v_max3_u32 v10, v10, v50, v51
    s_waitcnt vmcnt(0)
    v_max3_u32 v10, v10, v52, v53
    v_max3_u32 v10, v10, v54, v55
    s_add_u32 s59, s49, 4096
    buffer_load_dwordx4 v[36:39], v0, s[8:11], s49 offen offset:0 sc1
    buffer_load_dwordx4 v[40:43], v0, s[8:11], s49 offen offset:1024 sc1
    buffer_load_dwordx4 v[44:47], v0, s[8:11], s49 offen offset:2048 sc1
    buffer_load_dwordx4 v[48:51], v0, s[8:11], s49 offen offset:3072 sc1
    buffer_load_dwordx4 v[52:55], v0, s[8:11], s59 offen offset:0 sc1
    s_waitcnt vmcnt(4)
    v_max3_u32 v10, v10, v36, v37
    v_max3_u32 v10, v10, v38, v39
    s_waitcnt vmcnt(3)
    v_max3_u32 v10, v10, v40, v41
    v_max3_u32 v10, v10, v42, v43
    s_waitcnt vmcnt(2)
    v_max3_u32 v10, v10, v44, v45
    v_max3_u32 v10, v10, v46, v47
    s_waitcnt vmcnt(1)
    v_max3_u32 v10, v10, v48, v49
    v_max3_u32 v10, v10, v50, v51
    s_waitcnt vmcnt(0)
    v_max3_u32 v10, v10, v52, v53
    v_max3_u32 v10, v10, v54, v55
    v_cmp_eq_u32 vcc, -1, v10
    s_cbranch_vccz M_c1_2_restart
    s_add_u32 s30, s30, 1
    s_cmp_ge_u32 s30, 60000
    s_cbranch_scc1 M_fail
    s_branch M_c1_2_vfy
M_c1_2_exact:
    s_nop 7
    s_mov_b32 s70, 2
    s_waitcnt lgkmcnt(0)
    ds_read_b128 v[20:23], v3 offset:18432
    ds_read_b128 v[24:27], v3 offset:18496
    ds_read_b128 v[72:75], v3 offset:18560
    ds_read_b128 v[44:47], v3 offset:18624
    ds_read_b128 v[56:59], v0 offset:0
    s_waitcnt lgkmcnt(0)
    v_mfma_f32_16x16x32_bf16 v[28:31], v[56:59], v[20:23], 0
    s_nop 3
    ds_read_b128 v[60:63], v0 offset:1024
    s_waitcnt lgkmcnt(0)
    v_mfma_f32_16x16x32_bf16 v[28:31], v[60:63], v[24:27], v[28:31]
    s_nop 3
    ds_read_b128 v[56:59], v0 offset:2048
    s_waitcnt lgkmcnt(0)
    v_mfma_f32_16x16x32_bf16 v[28:31], v[56:59], v[72:75], v[28:31]
    s_nop 3
    ds_read_b128 v[60:63], v0 offset:3072
    s_waitcnt lgkmcnt(0)
    v_mfma_f32_16x16x32_bf16 v[28:31], v[60:63], v[44:47], v[28:31]
    s_nop 3
    ds_read_b128 v[56:59], v0 offset:4096
    s_waitcnt lgkmcnt(0)
    v_mfma_f32_16x16x32_bf16 v[32:35], v[56:59], v[20:23], 0
    s_nop 3
    ds_read_b128 v[60:63], v0 offset:5120
    s_waitcnt lgkmcnt(0)
    v_mfma_f32_16x16x32_bf16 v[32:35], v[60:63], v[24:27], v[32:35]
    s_nop 3
    ds_read_b128 v[56:59], v0 offset:6144
    s_waitcnt lgkmcnt(0)
    v_mfma_f32_16x16x32_bf16 v[32:35], v[56:59], v[72:75], v[32:35]
    s_nop 3
    ds_read_b128 v[60:63], v0 offset:7168
    s_waitcnt lgkmcnt(0)
    v_mfma_f32_16x16x32_bf16 v[32:35], v[60:63], v[44:47], v[32:35]
    s_nop 3
    ds_read_b128 v[56:59], v3 offset:20736
    s_waitcnt lgkmcnt(0)
    v_mfma_f32_16x16x32_bf16 v[40:43], v[56:59], v[20:23], 0
    s_nop 3
    ds_read_b128 v[60:63], v3 offset:20800
    s_waitcnt lgkmcnt(0)
    v_mfma_f32_16x16x32_bf16 v[40:43], v[60:63], v[24:27], v[40:43]
    s_nop 3
    ds_read_b128 v[56:59], v3 offset:20864
    s_waitcnt lgkmcnt(0)
    v_mfma_f32_16x16x32_bf16 v[40:43], v[56:59], v[72:75], v[40:43]
    s_nop 3
    ds_read_b128 v[60:63], v3 offset:20928
    s_waitcnt lgkmcnt(0)
    v_mfma_f32_16x16x32_bf16 v[40:43], v[60:63], v[44:47], v[40:43]
    s_nop 3
    v_max3_f32 v68, v28, v29, v30
    v_max3_f32 v68, v68, v31, v32
    v_max3_f32 v68, v68, v33, v34
    s_nop 0
    v_max3_f32 v68, v68, v35, v40
    v_max3_f32 v68, v68, v41, v42
    v_max_f32 v68, v68, v43
    v_mov_b32 v69, v68
    s_nop 1
    v_permlane16_swap_b32 v68, v69
    v_max_f32 v68, v68, v69
    v_mov_b32 v69, v68
    s_nop 1
    v_permlane32_swap_b32 v68, v69
    v_max_f32 v68, v68, v69
    v_sub_f32 v28, v28, v68
    v_exp_f32 v28, v28
    v_sub_f32 v29, v29, v68
    v_exp_f32 v29, v29
    v_sub_f32 v30, v30, v68
    v_exp_f32 v30, v30
    v_sub_f32 v31, v31, v68
    v_exp_f32 v31, v31
    v_sub_f32 v32, v32, v68
    v_exp_f32 v32, v32
    v_sub_f32 v33, v33, v68
    v_exp_f32 v33, v33
    v_sub_f32 v34, v34, v68
    v_exp_f32 v34, v34
    v_sub_f32 v35, v35, v68
    v_exp_f32 v35, v35
    v_sub_f32 v40, v40, v68
    v_exp_f32 v40, v40
    v_sub_f32 v41, v41, v68
    v_exp_f32 v41, v41
    v_sub_f32 v42, v42, v68
    v_exp_f32 v42, v42
    v_sub_f32 v43, v43, v68
    v_exp_f32 v43, v43
    v_cvt_pk_bf16_f32 v28, v28, v29
    v_cvt_pk_bf16_f32 v29, v30, v31
    v_cvt_pk_bf16_f32 v30, v32, v33
    v_cvt_pk_bf16_f32 v31, v34, v35
    v_cvt_pk_bf16_f32 v40, v40, v41
    v_cvt_pk_bf16_f32 v41, v42, v43
    v_mfma_f32_16x16x32_bf16 v[20:23], v[80:83], v[28:31], 0
    v_mfma_f32_16x16x32_bf16 v[24:27], v[84:87], v[28:31], 0
    v_mfma_f32_16x16x32_bf16 v[72:75], v[64:67], v[28:31], 0
    ds_read_b128 v[56:59], v3 offset:20864
    s_waitcnt lgkmcnt(0)
    s_nop 7
    v_mfma_f32_16x16x16_bf16 v[72:75], v[10:11], v[40:41], v[72:75]
    s_nop 7
    s_branch M_c1_2_fin
M_c1_2_last:
    s_cmp_lg_u32 s70, 0
    s_cbranch_scc1 M_c1_2_last2
    v_cmp_u_f32 vcc, v32, v32
    s_cbranch_vccnz M_c1_2_vfy0
M_c1_2_last2:
    s_lshl_b32 s4, s44, 18
    s_add_u32 s4, s4, s53
    buffer_store_dwordx4 v[76:79], v0, s[8:11], s4 offen offset:2048 sc1
    s_mov_b32 s4, 0x10000000
    s_waitcnt vmcnt(0) lgkmcnt(0)
    s_barrier
    s_nop 7
    v_mov_b64 v[72:73], -1
    v_mov_b64 v[74:75], -1
    s_add_u32 s28, s44, 3
    s_and_b32 s29, s28, 3
    s_mul_i32 s31, s22, 160
    s_waitcnt vmcnt(0)
    s_add_u32 s44, s44, 1
    s_branch M_c_fft
    s_cmp_eq_u32 s44, 128
    s_cbranch_scc1 M_end
    s_branch M_c1_2_layer
M_c1_2_lr:
    s_mov_b32 s30, 0
M_c1_2_lr_l:
    s_waitcnt lgkmcnt(0)
    s_and_b32 s27, s30, 1
    s_cbranch_scc0 M_c1_2_lr_n
    s_waitcnt vmcnt(3)
    s_mov_b32 m0, 13312
    s_nop 0
    buffer_load_dwordx4 v0, s[8:11], s48 offen offset:0 sc1 lds
    buffer_load_dwordx4 v0, s[8:11], s48 offen offset:1024 sc1 lds
    buffer_load_dwordx4 v0, s[8:11], s48 offen offset:2048 sc1 lds
M_c1_2_lr_n:
    ds_read_b128 v[36:39], v6 offset:13312
    ds_read_b128 v[40:43], v6 offset:14336
    ds_read_b128 v[44:47], v6 offset:15360
    ds_read_b128 v[48:51], v6 offset:16384
    ds_read_b128 v[52:55], v6 offset:17408
    s_waitcnt lgkmcnt(2)
    v_max3_u32 v10, v36, v40, v44
    s_waitcnt lgkmcnt(0)
    v_max3_u32 v10, v10, v48, v52
    v_cmp_eq_u32 vcc, -1, v10
    s_cbranch_vccz M_c1_2_lr_d
    s_add_u32 s30, s30, 1
    s_cmp_ge_u32 s30, 480000
    s_cbranch_scc1 M_fail
    s_branch M_c1_2_lr_l
M_c1_2_lr_d:
    ds_read_b128 v[56:59], v5 offset:0
    ds_read_b128 v[60:63], v5 offset:1024
    ds_read_b128 v[64:67], v5 offset:2048
    ds_read_b128 v[68:71], v5 offset:3072
    v_mov_b64 v[12:13], 0
    v_mov_b64 v[14:15], 0
    v_mov_b64 v[16:17], 0
    v_mov_b64 v[18:19], 0
    v_mov_b64 v[20:21], 0
    v_mov_b64 v[22:23], 0
    v_mov_b64 v[24:25], 0
    v_mov_b64 v[26:27], 0
    v_mov_b64 v[28:29], 0
    v_mov_b64 v[30:31], 0
    v_mov_b64 v[32:33], 0
    v_mov_b64 v[34:35], 0
    s_waitcnt lgkmcnt(0)
    s_branch M_c1_2_lr_r
M_c1_2_rr:
    s_mov_b32 s30, 0
M_c1_2_rr_l:
    s_waitcnt lgkmcnt(0)
    s_and_b32 s27, s30, 1
    s_cbranch_scc1 M_c1_2_rr_n
    s_waitcnt vmcnt(1)
    s_mov_b32 m0, 8192
    s_nop 0
    buffer_load_dwordx4 v0, s[8:11], s49 offen offset:3072 sc1 lds
M_c1_2_rr_n:
    ds_read_b128 v[36:39], v6 offset:8192
    ds_read_b128 v[40:43], v6 offset:9216
    ds_read_b128 v[44:47], v6 offset:10240
    ds_read_b128 v[48:51], v6 offset:11264
    ds_read_b32 v11, v6 offset:12288
    s_waitcnt lgkmcnt(2)
    v_max3_u32 v10, v36, v40, v44
    s_waitcnt lgkmcnt(0)
    v_max3_u32 v10, v10, v48, v11
    v_cmp_eq_u32 vcc, -1, v10
    s_cbranch_vccz M_c1_2_rr_d
    s_add_u32 s30, s30, 1
    s_cmp_ge_u32 s30, 480000
    s_cbranch_scc1 M_fail
    s_branch M_c1_2_rr_l
M_c1_2_rr_d:
    s_branch M_c1_2_rr_r
M_c1_2_first:
    s_mul_i32 s27, s21, 167936
    s_add_u32 s27, s27, s34
    s_mul_i32 s28, s22, 4224
    s_add_u32 s28, s28, s27
    s_mov_b32 exec_hi, 0
    buffer_load_dword v10, v9, s[8:11], s28 offen sc1
    s_lshl_b32 s28, s22, 10
    s_add_u32 s28, s28, s27
    s_add_u32 s28, s28, 135168
    s_mov_b64 exec, 0xff
    buffer_load_dword v10, v9, s[8:11], s28 offen sc1
    s_mul_i32 s27, s21, 5120
    s_add_u32 s27, s27, s41
    s_mul_i32 s28, s22, 160
    s_add_u32 s28, s28, s27
    s_mov_b64 exec, 3
    buffer_load_dword v10, v9, s[8:11], s28 offen sc1
    s_mov_b64 exec, -1
    s_barrier
    s_and_b32 s26, s44, 63
    s_lshl_b32 s26, s26, 18
    s_add_u32 s26, s26, s50
    s_add_u32 s26, s26, 4096
    s_add_u32 s3, s26, 16777216
    s_mov_b32 m0, 4096
    s_nop 0
    buffer_load_dwordx4 v0, s[8:11], s26 offen offset:0 sc1 lds
    buffer_load_dwordx4 v0, s[8:11], s26 offen offset:1024 sc1 lds
    buffer_load_dwordx4 v[80:83], v0, s[8:11], s3 offen offset:0 sc1
    buffer_load_dwordx4 v[84:87], v0, s[8:11], s3 offen offset:1024 sc1
    s_and_b32 s26, s44, 63
    s_add_u32 s26, s26, 1
    s_min_u32 s26, s26, 63
    s_lshl_b32 s26, s26, 18
    s_add_u32 s26, s26, s50
    s_add_u32 s26, s26, 4096
    s_add_u32 s3, s26, 16777216
    s_waitcnt vmcnt(0) lgkmcnt(0)
    s_barrier
    s_branch M_c1_2_first_r
M_c1_2_first2:
    ds_read_b64 v[10:11], v0 offset:23296
    s_waitcnt lgkmcnt(0)
    v_min_u32 v10, v10, v11
    s_nop 0
    v_readfirstlane_b32 s28, v10
    s_nop 0
    s_max_u32 s54, s54, s28
    s_add_u32 s27, s44, 2
    s_or_b32 s28, s44, 63
    s_add_u32 s28, s28, 1
    s_min_u32 s27, s27, s28
    s_cmp_lt_u32 s54, s27
    s_cbranch_scc1 M_c1_2_p2
M_c1_2_p2_r:
    s_branch M_c1_2_first2_r
M_c1_2_p2:
    s_mov_b32 s30, 0
M_c1_2_p2_l:
    s_waitcnt lgkmcnt(0)
    s_mov_b64 exec, 3
    buffer_load_dword v10, v9, s[8:11], s51 offen sc1
    s_waitcnt vmcnt(0)
    s_mov_b64 exec, -1
    v_readlane_b32 s54, v10, 0
    v_readlane_b32 s28, v10, 1
    s_nop 3
    s_min_u32 s54, s54, s28
    s_cmp_ge_u32 s54, s27
    s_cbranch_scc1 M_c1_2_p2_r
    s_sleep 2
    s_add_u32 s30, s30, 1
    s_cmp_ge_u32 s30, 240000
    s_cbranch_scc1 M_fail
    s_branch M_c1_2_p2_l
M_c1_3_layer:
    s_lshr_b32 s27, s44, 6
    s_mul_i32 s50, s27, 33554432
    s_lshl_b32 s27, s22, 13
    s_add_u32 s50, s50, s27
    s_add_u32 s50, s50, 37748736
    s_barrier
    s_mov_b32 s26, 0x10010000
    s_mov_b32 s3, s26
    s_mul_i32 s27, s20, 5120
    s_add_u32 s48, s27, 167772160
    s_sub_u32 s49, 167777280, s27
    s_mov_b32 m0, 13312
    s_nop 0
    buffer_load_dwordx4 v0, s[8:11], s48 offen offset:3072 sc1 lds
    s_mov_b32 m0, 17408
    s_add_u32 s59, s48, 4096
    buffer_load_dwordx4 v0, s[8:11], s59 offen offset:0 sc1 lds
    s_and_b32 s55, s44, 3
    s_mul_i32 s55, s55, 167936
    s_add_u32 s55, s55, s34
    s_add_u32 s58, s55, s35
    s_and_b32 s57, s44, 63
    s_add_u32 s42, s44, 2
    s_or_b32 s28, s44, 63
    s_add_u32 s28, s28, 1
    s_min_u32 s42, s42, s28
    s_sub_u32 s61, s26, 6144
    s_cmp_ge_u32 s54, s42
    s_cselect_b32 s61, s61, 0x10000000
    ds_read_b128 v[56:59], v5 offset:0
    ds_read_b128 v[60:63], v5 offset:1024
    ds_read_b128 v[64:67], v5 offset:2048
    ds_read_b128 v[68:71], v5 offset:3072
    v_mov_b64 v[12:13], 0
    v_mov_b64 v[14:15], 0
    v_mov_b64 v[16:17], 0
    v_mov_b64 v[18:19], 0
    v_mov_b64 v[20:21], 0
    v_mov_b64 v[22:23], 0
    v_mov_b64 v[24:25], 0
    v_mov_b64 v[26:27], 0
    v_mov_b64 v[28:29], 0
    v_mov_b64 v[30:31], 0
    v_mov_b64 v[32:33], 0
    v_mov_b64 v[34:35], 0
    s_mov_b32 s70, 0
    s_waitcnt vmcnt(0) lgkmcnt(0)
M_c1_3_top:
    s_waitcnt vmcnt(4)
    s_barrier
    ds_read_b128 v[36:39], v6 offset:13312
    ds_read_b128 v[40:43], v6 offset:14336
    s_mov_b32 m0, 12288
    s_add_u32 s59, s49, 4096
    buffer_load_dwordx4 v0, s[8:11], s59 offen offset:0 sc1 lds
M_c1_3_lr_r:
    s_waitcnt lgkmcnt(1)
    v_smfmac_f32_16x16x64_bf16 v[20:23], v[36:39], v[56:63], v1
    ds_read_b128 v[56:59], v5 offset:4096
    v_smfmac_f32_16x16x64_bf16 v[24:27], v[36:39], v[64:71], v1
    ds_read_b128 v[60:63], v5 offset:5120
    v_smfmac_f32_16x16x64_bf16 v[28:31], v[36:39], a[248:255], v1
    ds_read_b128 v[64:67], v5 offset:6144
    v_smfmac_f32_16x16x64_bf16 v[32:35], v[36:39], a[240:247], v1
    ds_read_b128 v[68:71], v5 offset:7168
    v_smfmac_f32_16x16x64_bf16 v[12:15], v[36:39], a[232:239], v1
    ds_read_b128 v[44:47], v6 offset:15360
    s_waitcnt lgkmcnt(3)
    v_smfmac_f32_16x16x64_bf16 v[16:19], v[36:39], v[56:63], v1
    ds_read_b128 v[56:59], v5 offset:8192
    v_smfmac_f32_16x16x64_bf16 v[20:23], v[40:43], a[224:231], v1
    ds_read_b128 v[60:63], v5 offset:9216
    s_waitcnt lgkmcnt(3)
    v_smfmac_f32_16x16x64_bf16 v[24:27], v[40:43], v[64:71], v1
    ds_read_b128 v[64:67], v5 offset:10240
    v_smfmac_f32_16x16x64_bf16 v[28:31], v[40:43], a[216:223], v1
    ds_read_b128 v[68:71], v5 offset:11264
    v_smfmac_f32_16x16x64_bf16 v[32:35], v[40:43], a[208:215], v1
    ds_read_b128 v[48:51], v6 offset:16384
    s_waitcnt lgkmcnt(3)
    v_smfmac_f32_16x16x64_bf16 v[12:15], v[40:43], v[56:63], v1
    ds_read_b128 v[56:59], v5 offset:12288
    v_smfmac_f32_16x16x64_bf16 v[16:19], v[40:43], a[200:207], v1
    ds_read_b128 v[60:63], v5 offset:13312
    s_waitcnt lgkmcnt(3)
    v_smfmac_f32_16x16x64_bf16 v[20:23], v[44:47], v[64:71], v1
    ds_read_b128 v[64:67], v5 offset:14336
    v_smfmac_f32_16x16x64_bf16 v[24:27], v[44:47], a[192:199], v1
    ds_read_b128 v[68:71], v5 offset:15360
    v_smfmac_f32_16x16x64_bf16 v[28:31], v[44:47], a[184:191], v1
    ds_read_b128 v[52:55], v6 offset:17408
    s_waitcnt lgkmcnt(3)
    v_smfmac_f32_16x16x64_bf16 v[32:35], v[44:47], v[56:63], v1
    ds_read_b128 v[56:59], v5 offset:16384
    v_smfmac_f32_16x16x64_bf16 v[20:23], v[48:51], a[176:183], v1
    ds_read_b128 v[60:63], v5 offset:17408
    s_waitcnt lgkmcnt(3)
    v_max3_u32 v10, v36, v40, v44
    v_smfmac_f32_16x16x64_bf16 v[24:27], v[48:51], v[64:71], v1
    ds_read_b128 v[64:67], v5 offset:18432
    s_waitcnt lgkmcnt(3)
    v_max3_u32 v10, v10, v48, v52
    v_smfmac_f32_16x16x64_bf16 v[28:31], v[48:51], a[168:175], v1
    ds_read_b128 v[68:71], v5 offset:19456
    v_cmp_eq_u32 vcc, -1, v10
    v_smfmac_f32_16x16x64_bf16 v[32:35], v[48:51], a[160:167], v1
    s_cbranch_vccnz M_c1_3_lr
    s_waitcnt vmcnt(0)
    s_barrier
    ds_read_b128 v[36:39], v6 offset:8192
    ds_read_b128 v[40:43], v6 offset:9216
    s_waitcnt lgkmcnt(4)
    v_smfmac_f32_16x16x64_bf16 v[20:23], v[52:55], v[56:63], v1
    ds_read_b128 v[44:47], v6 offset:10240
    ds_read_b128 v[48:51], v6 offset:11264
    v_smfmac_f32_16x16x64_bf16 v[24:27], v[52:55], a[152:159], v1
    ds_read_b32 v11, v6 offset:12288
    ds_read_b128 v[56:59], v5 offset:20480
    s_waitcnt lgkmcnt(6)
    v_smfmac_f32_16x16x64_bf16 v[28:31], v[52:55], v[64:71], v1
    ds_read_b128 v[60:63], v5 offset:21504
    s_waitcnt lgkmcnt(4)
    v_max3_u32 v10, v36, v40, v44
    v_smfmac_f32_16x16x64_bf16 v[32:35], v[52:55], a[144:151], v1
    s_waitcnt lgkmcnt(2)
    v_max3_u32 v10, v10, v48, v11
    v_cmp_eq_u32 vcc, -1, v10
    s_cbranch_vccnz M_c1_3_rr
M_c1_3_rr_r:
    s_mov_b32 m0, 23040
    ds_read_b128 v[64:67], v5 offset:22528
    ds_read_b128 v[68:71], v5 offset:23552
    ds_read_b128 v[52:55], v6 offset:12288
    buffer_store_dwordx4 v[76:79], v0, s[8:11], s4 offen offset:3072 sc1
    s_mov_b32 s4, 0x10000000
    buffer_load_dword v9, s[8:11], s61 offen sc1 lds
    v_smfmac_f32_16x16x64_bf16 v[20:23], v[36:39], a[136:143], v1
    s_waitcnt lgkmcnt(3)
    v_smfmac_f32_16x16x64_bf16 v[24:27], v[36:39], v[56:63], v1
    ds_read_b128 v[56:59], v5 offset:24576
    v_smfmac_f32_16x16x64_bf16 v[20:23], v[40:43], a[128:135], v1
    ds_read_b128 v[60:63], v5 offset:25600
    s_waitcnt lgkmcnt(3)
    v_smfmac_f32_16x16x64_bf16 v[24:27], v[40:43], v[64:71], v1
    ds_read_b128 v[64:67], v5 offset:26624
    v_smfmac_f32_16x16x64_bf16 v[20:23], v[44:47], a[120:127], v1
    ds_read_b128 v[68:71], v5 offset:27648
    v_smfmac_f32_16x16x64_bf16 v[24:27], v[44:47], a[112:119], v1
    s_waitcnt lgkmcnt(2)
    v_smfmac_f32_16x16x64_bf16 v[20:23], v[48:51], v[56:63], v1
    ds_read_b128 v[56:59], v5 offset:28672
    v_smfmac_f32_16x16x64_bf16 v[24:27], v[48:51], a[104:111], v1
    ds_read_b128 v[60:63], v5 offset:29696
    s_waitcnt lgkmcnt(2)
    v_smfmac_f32_16x16x64_bf16 v[20:23], v[52:55], v[64:71], v1
    ds_read_b128 v[64:67], v5 offset:30720
    v_smfmac_f32_16x16x64_bf16 v[24:27], v[52:55], a[96:103], v1
    ds_read_b128 v[68:71], v5 offset:31744
    v_smfmac_f32_16x16x64_bf16 v[28:31], v[36:39], a[88:95], v1
    s_cmp_eq_u32 s57, 0
    s_cbranch_scc1 M_c1_3_first
M_c1_3_first_r:
    s_waitcnt lgkmcnt(2)
    v_smfmac_f32_16x16x64_bf16 v[32:35], v[36:39], v[56:63], v1
    ds_read_b128 v[56:59], v5 offset:32768
    v_permlane32_swap_b32 v20, v21
    v_smfmac_f32_16x16x64_bf16 v[28:31], v[40:43], a[80:87], v1
    ds_read_b128 v[60:63], v5 offset:33792
    s_waitcnt lgkmcnt(2)
    v_permlane32_swap_b32 v22, v23
    v_smfmac_f32_16x16x64_bf16 v[32:35], v[40:43], v[64:71], v1
    ds_read_b128 v[64:67], v0 offset:2048
    v_permlane32_swap_b32 v24, v25
    v_smfmac_f32_16x16x64_bf16 v[28:31], v[44:47], a[72:79], v1
    ds_read_b128 v[68:71], v0 offset:3072
    v_permlane32_swap_b32 v26, v27
    v_smfmac_f32_16x16x64_bf16 v[32:35], v[44:47], a[64:71], v1
    s_waitcnt lgkmcnt(2)
    v_add_f32 v20, v20, v21
    v_add_f32 v22, v22, v23
    v_smfmac_f32_16x16x64_bf16 v[28:31], v[48:51], v[56:63], v1
    ds_read_b128 v[56:59], v0 offset:0
    v_add_f32 v24, v24, v25
    v_add_f32 v26, v26, v27
    v_smfmac_f32_16x16x64_bf16 v[32:35], v[48:51], a[56:63], v1
    ds_read_b128 v[60:63], v0 offset:1024
    v_mul_f32 v20, s40, v20
    v_mul_f32 v24, s40, v24
    v_smfmac_f32_16x16x64_bf16 v[28:31], v[52:55], a[48:55], v1
    v_mul_f32 v22, s40, v22
    v_mul_f32 v26, s40, v26
    v_smfmac_f32_16x16x64_bf16 v[32:35], v[52:55], a[40:47], v1
    v_cvt_pk_bf16_f32 v20, v20, v24
    v_cvt_pk_bf16_f32 v21, v22, v26
    v_smfmac_f32_16x16x64_bf16 v[12:15], v[36:39], a[32:39], v1
    ds_write_b32 v2, v20 offset:18432
    v_smfmac_f32_16x16x64_bf16 v[16:19], v[36:39], a[24:31], v1
    ds_write_b32 v2, v21 offset:19008
    v_permlane32_swap_b32 v28, v29
    v_smfmac_f32_16x16x64_bf16 v[12:15], v[40:43], a[16:23], v1
    ds_read_b128 v[36:39], v6 offset:15360
    v_permlane32_swap_b32 v30, v31
    v_smfmac_f32_16x16x64_bf16 v[16:19], v[40:43], a[8:15], v1
    ds_read_b128 v[40:43], v6 offset:16384
    v_permlane32_swap_b32 v32, v33
    v_smfmac_f32_16x16x64_bf16 v[12:15], v[44:47], a[0:7], v1
    s_waitcnt lgkmcnt(2)
    s_barrier
    v_permlane32_swap_b32 v34, v35
    v_smfmac_f32_16x16x64_bf16 v[16:19], v[44:47], v[248:255], v1
    ds_read_b128 v[20:23], v3 offset:18432
    v_add_f32 v28, v28, v29
    v_add_f32 v30, v30, v31
    v_smfmac_f32_16x16x64_bf16 v[12:15], v[48:51], v[240:247], v1
    ds_read_b128 v[24:27], v3 offset:18496
    v_add_f32 v32, v32, v33
    v_add_f32 v34, v34, v35
    v_smfmac_f32_16x16x64_bf16 v[16:19], v[48:51], v[232:239], v1
    ds_read_b128 v[72:75], v3 offset:18560
    v_cvt_pk_bf16_f32 v28, v28, v32
    v_cvt_pk_bf16_f32 v29, v30, v34
    v_smfmac_f32_16x16x64_bf16 v[12:15], v[52:55], v[224:231], v1
    ds_write_b32 v2, v28 offset:20736
    ds_read_b128 v[44:47], v3 offset:18624
    v_smfmac_f32_16x16x64_bf16 v[16:19], v[52:55], v[216:223], v1
    ds_write_b32 v2, v29 offset:21312
    s_waitcnt lgkmcnt(7)
    v_smfmac_f32_16x16x64_bf16 v[12:15], v[36:39], v[208:215], v1
    ds_read_b128 v[48:51], v6 offset:17408
    v_mov_b64 v[10:11], s[16:17]
    v_smfmac_f32_16x16x64_bf16 v[16:19], v[36:39], v[200:207], v1
    s_waitcnt lgkmcnt(6)
    v_mfma_f32_16x16x32_bf16 v[28:31], v[56:59], v[20:23], 0
    ds_read_b128 v[56:59], v0 offset:4096
    s_waitcnt lgkmcnt(6)
    v_mfma_f32_16x16x32_bf16 v[28:31], v[60:63], v[24:27], v[28:31]
    ds_read_b128 v[60:63], v0 offset:5120
    s_waitcnt lgkmcnt(3)
    s_barrier
    v_mfma_f32_16x16x32_bf16 v[28:31], v[64:67], v[72:75], v[28:31]
    ds_read_b128 v[64:67], v0 offset:6144
    v_mfma_f32_16x16x32_bf16 v[28:31], v[68:71], v[44:47], v[28:31]
    ds_read_b128 v[68:71], v0 offset:7168
    v_smfmac_f32_16x16x64_bf16 v[12:15], v[40:43], v[192:199], v1
    ds_read_b128 v[36:39], v3 offset:20736
    v_smfmac_f32_16x16x64_bf16 v[16:19], v[40:43], v[184:191], v1
    ds_read_b128 v[52:55], v3 offset:20800
    s_waitcnt lgkmcnt(4)
    v_mfma_f32_16x16x32_bf16 v[32:35], v[56:59], v[20:23], 0
    s_nop 0
    v_exp_f32 v28, v28
    ds_read_b128 v[56:59], v3 offset:20864
    v_mfma_f32_16x16x32_bf16 v[32:35], v[60:63], v[24:27], v[32:35]
    s_waitcnt lgkmcnt(3)
    v_exp_f32 v29, v29
    ds_read_b128 v[60:63], v3 offset:20928
    v_mfma_f32_16x16x32_bf16 v[32:35], v[64:67], v[72:75], v[32:35]
    v_exp_f32 v30, v30
    v_mfma_f32_16x16x32_bf16 v[32:35], v[68:71], v[44:47], v[32:35]
    s_waitcnt lgkmcnt(3)
    v_exp_f32 v31, v31
    v_mfma_f32_16x16x32_bf16 v[40:43], v[36:39], v[20:23], 0
    s_waitcnt lgkmcnt(2)
    v_cvt_pk_bf16_f32 v28, v28, v29
    v_cvt_pk_bf16_f32 v29, v30, v31
    v_mfma_f32_16x16x32_bf16 v[40:43], v[52:55], v[24:27], v[40:43]
    s_waitcnt lgkmcnt(1)
    v_mov_b64 v[64:65], s[24:25]
    v_mov_b64 v[66:67], s[24:25]
    v_mfma_f32_16x16x32_bf16 v[40:43], v[56:59], v[72:75], v[40:43]
    s_waitcnt lgkmcnt(0)
    v_exp_f32 v32, v32
    v_mfma_f32_16x16x32_bf16 v[40:43], v[60:63], v[44:47], v[40:43]
    v_exp_f32 v33, v33
    v_smfmac_f32_16x16x64_bf16 v[12:15], v[48:51], v[176:183], v1
    v_exp_f32 v34, v34
    v_smfmac_f32_16x16x64_bf16 v[16:19], v[48:51], v[168:175], v1
    v_exp_f32 v35, v35
    v_cvt_pk_bf16_f32 v30, v32, v33
    v_cvt_pk_bf16_f32 v31, v34, v35
    s_nop 0
    v_exp_f32 v40, v40
    v_mfma_f32_16x16x32_bf16 v[72:75], v[64:67], v[28:31], 0
    v_exp_f32 v41, v41
    v_mfma_f32_16x16x32_bf16 v[20:23], v[80:83], v[28:31], 0
    v_exp_f32 v42, v42
    v_mfma_f32_16x16x32_bf16 v[24:27], v[84:87], v[28:31], 0
    v_exp_f32 v43, v43
    v_cvt_pk_bf16_f32 v40, v40, v41
    v_cvt_pk_bf16_f32 v41, v42, v43
    v_cvt_pk_bf16_f32 v12, v12, v13
    v_cvt_pk_bf16_f32 v13, v14, v15
    v_mfma_f32_16x16x16_bf16 v[72:75], v[10:11], v[40:41], v[72:75]
    v_cvt_pk_bf16_f32 v14, v16, v17
    v_cvt_pk_bf16_f32 v15, v18, v19
M_c1_3_fin:
    v_mfma_f32_16x16x16_bf16 v[20:23], v[12:13], v[40:41], v[20:23]
    s_cmp_eq_u32 s57, 63
    v_cndmask_b32_e64 v76, v12, v60, s[66:67]
    v_cndmask_b32_e64 v77, v13, v61, s[66:67]
    v_mfma_f32_16x16x16_bf16 v[24:27], v[14:15], v[40:41], v[24:27]
    v_cndmask_b32_e64 v78, v14, v62, s[66:67]
    v_cndmask_b32_e64 v79, v15, v63, s[66:67]
    s_cbranch_scc1 M_c1_3_last
    v_rcp_f32 v74, v72
    v_subrev_u32 v73, s68, v72
    v_cmp_lt_u32 vcc, s69, v73
    v_mov_b64 v[44:45], 0
    v_mov_b64 v[46:47], 0
    v_cndmask_b32_e64 v20, v20, v24, s[18:19]
    v_cndmask_b32_e64 v21, v21, v25, s[18:19]
    v_cndmask_b32_e64 v22, v22, v26, s[18:19]
    v_cndmask_b32_e64 v23, v23, v27, s[18:19]
    v_pk_mul_f32 v[20:21], v[20:21], v[74:75] op_sel_hi:[1,0]
    v_pk_mul_f32 v[22:23], v[22:23], v[74:75] op_sel_hi:[1,0]
    v_cvt_pk_bf16_f32 v20, v20, v21
    v_cvt_pk_bf16_f32 v21, v22, v23
    ds_write_b64 v0, v[20:21] offset:14344
    s_cbranch_vccnz M_c1_3_zbad
M_c1_3_zok:
    s_cmp_lt_u32 s54, s42
    s_cbranch_scc1 M_c1_3_first2
M_c1_3_first2_r:
    buffer_load_dwordx4 v[80:83], v0, s[8:11], s3 offen offset:0 sc1
    buffer_load_dwordx4 v[84:87], v0, s[8:11], s3 offen offset:1024 sc1
    s_waitcnt lgkmcnt(0)
    s_barrier
    ds_read_b128 v[32:35], v0 offset:13312
    ds_read_b128 v[52:55], v0 offset:14336
    s_mov_b32 m0, 6144
    s_nop 0
    buffer_load_dwordx4 v0, s[8:11], s26 offen offset:0 sc1 lds
    buffer_load_dwordx4 v0, s[8:11], s26 offen offset:1024 sc1 lds
    v_mov_b64 v[68:69], 0
    v_mov_b64 v[70:71], 0
    v_mov_b64 v[64:65], 0
    v_mov_b64 v[66:67], 0
    v_mov_b64 v[60:61], 0
    v_mov_b64 v[62:63], 0
    v_mov_b64 v[56:57], 0
    v_mov_b64 v[58:59], 0
    s_waitcnt lgkmcnt(1)
    s_nop 0
    v_smfmac_f32_16x16x64_bf16 v[56:59], v[32:35], v[160:167], v1
    v_smfmac_f32_16x16x64_bf16 v[60:63], v[32:35], v[144:151], v1
    s_waitcnt lgkmcnt(0)
    v_smfmac_f32_16x16x64_bf16 v[56:59], v[52:55], v[152:159], v1
    v_smfmac_f32_16x16x64_bf16 v[60:63], v[52:55], v[136:143], v1
    v_smfmac_f32_16x16x64_bf16 v[64:67], v[32:35], v[128:135], v1
    v_smfmac_f32_16x16x64_bf16 v[68:71], v[32:35], v[112:119], v1
    v_permlane32_swap_b32 v56, v57
    v_smfmac_f32_16x16x64_bf16 v[64:67], v[52:55], v[120:127], v1
    v_permlane32_swap_b32 v58, v59
    v_smfmac_f32_16x16x64_bf16 v[68:71], v[52:55], v[104:111], v1
    v_add_f32 v56, v56, v57
    v_add_f32 v58, v58, v59
    v_smfmac_f32_16x16x64_bf16 v[44:47], v[32:35], v[96:103], v1
    v_permlane32_swap_b32 v60, v61
    v_smfmac_f32_16x16x64_bf16 v[44:47], v[52:55], v[88:95], v1
    v_permlane32_swap_b32 v62, v63
    v_add_f32 v60, v60, v61
    v_add_f32 v62, v62, v63
    v_cvt_pk_bf16_f32 v36, v56, v60
    v_cvt_pk_bf16_f32 v38, v58, v62
    v_permlane32_swap_b32 v64, v65
    v_permlane32_swap_b32 v66, v67
    v_add_f32 v64, v64, v65
    v_add_f32 v66, v66, v67
    v_permlane32_swap_b32 v68, v69
    v_permlane32_swap_b32 v70, v71
    v_add_f32 v68, v68, v69
    v_add_f32 v70, v70, v71
    v_cvt_pk_bf16_f32 v37, v64, v68
    v_cvt_pk_bf16_f32 v39, v66, v70
    buffer_store_dwordx4 v[36:39], v0, s[8:11], s58 offen sc1
    v_permlane32_swap_b32 v44, v45
    v_permlane32_swap_b32 v46, v47
    v_add_f32 v44, v44, v45
    v_add_f32 v46, v46, v47
    v_cvt_pk_bf16_f32 v44, v44, v46
    buffer_store_dword v44, v7, s[8:11], s55 offen sc1
    s_add_u32 s27, s44, 1
    s_and_b32 s27, s27, 3
    s_mul_i32 s48, s27, 5120
    s_add_u32 s48, s48, s41
    s_lshl_b32 s27, s27, 15
    s_add_u32 s49, s27, s47
    ds_read_b128 v[56:59], v5 offset:0
    ds_read_b128 v[60:63], v5 offset:1024
    ds_read_b128 v[64:67], v5 offset:2048
    ds_read_b128 v[68:71], v5 offset:3072
    v_mov_b64 v[12:13], 0
    v_mov_b64 v[14:15], 0
    v_mov_b64 v[16:17], 0
    v_mov_b64 v[18:19], 0
    v_mov_b64 v[20:21], 0
    v_mov_b64 v[22:23], 0
    v_mov_b64 v[24:25], 0
    v_mov_b64 v[26:27], 0
    v_mov_b64 v[28:29], 0
    v_mov_b64 v[30:31], 0
    v_mov_b64 v[32:33], 0
    v_mov_b64 v[34:35], 0
    ds_read_b64 v[10:11], v0 offset:23296
    s_waitcnt lgkmcnt(0)
    v_min_u32 v10, v10, v11
    s_nop 0
    v_readfirstlane_b32 s28, v10
    s_nop 0
    s_max_u32 s54, s54, s28
    s_barrier
    s_and_b32 s26, s44, 63
    s_add_u32 s26, s26, 2
    s_min_u32 s26, s26, 63
    s_lshl_b32 s26, s26, 18
    s_add_u32 s26, s26, s50
    s_add_u32 s26, s26, 6144
    s_add_u32 s3, s26, 16777216
    s_lshl_b32 s4, s44, 18
    s_add_u32 s4, s4, s53
    s_add_u32 s44, s44, 1
    s_and_b32 s55, s44, 3
    s_mul_i32 s55, s55, 167936
    s_add_u32 s55, s55, s34
    s_add_u32 s58, s55, s35
    s_and_b32 s57, s44, 63
    s_add_u32 s42, s44, 2
    s_or_b32 s28, s44, 63
    s_add_u32 s28, s28, 1
    s_min_u32 s42, s42, s28
    s_sub_u32 s61, s26, 6144
    s_cmp_ge_u32 s54, s42
    s_cselect_b32 s61, s61, 0x10000000
    s_nop 15
    s_nop 15
    s_nop 5
    s_mov_b32 m0, 13312
    s_nop 0
    buffer_load_dwordx4 v0, s[8:11], s48 offen offset:3072 sc1 lds
    s_mov_b32 m0, 17408
    s_add_u32 s59, s48, 4096
    buffer_load_dwordx4 v0, s[8:11], s59 offen offset:0 sc1 lds
    s_nop 13
    s_mov_b32 m0, 13312
    s_nop 0
    buffer_load_dwordx4 v0, s[8:11], s48 offen offset:3072 sc1 lds
    s_mov_b32 m0, 17408
    s_add_u32 s59, s48, 4096
    buffer_load_dwordx4 v0, s[8:11], s59 offen offset:0 sc1 lds
    s_nop 13
    s_mov_b32 m0, 13312
    s_nop 0
    buffer_load_dwordx4 v0, s[8:11], s48 offen offset:3072 sc1 lds
    s_mov_b32 m0, 17408
    s_add_u32 s59, s48, 4096
    buffer_load_dwordx4 v0, s[8:11], s59 offen offset:0 sc1 lds
    s_mov_b32 s70, 0
    s_branch M_c1_3_top
M_c1_3_restart:
    s_waitcnt vmcnt(0) lgkmcnt(0)
    s_nop 7
    s_barrier
    s_mov_b32 m0, 13312
    s_nop 0
    buffer_load_dwordx4 v0, s[8:11], s48 offen offset:3072 sc1 lds
    s_mov_b32 m0, 17408
    s_add_u32 s59, s48, 4096
    buffer_load_dwordx4 v0, s[8:11], s59 offen offset:0 sc1 lds
    ds_read_b128 v[56:59], v5 offset:0
    ds_read_b128 v[60:63], v5 offset:1024
    ds_read_b128 v[64:67], v5 offset:2048
    ds_read_b128 v[68:71], v5 offset:3072
    v_mov_b64 v[12:13], 0
    v_mov_b64 v[14:15], 0
    v_mov_b64 v[16:17], 0
    v_mov_b64 v[18:19], 0
    v_mov_b64 v[20:21], 0
    v_mov_b64 v[22:23], 0
    v_mov_b64 v[24:25], 0
    v_mov_b64 v[26:27], 0
    v_mov_b64 v[28:29], 0
    v_mov_b64 v[30:31], 0
    v_mov_b64 v[32:33], 0
    v_mov_b64 v[34:35], 0
    s_waitcnt vmcnt(0) lgkmcnt(0)
    s_branch M_c1_3_top
M_c1_3_zbad:
    s_cmp_eq_u32 s70, 2
    s_cbranch_scc1 M_c1_3_zok
    v_cmp_u_f32 vcc, v72, v72
    s_cbranch_vccz M_c1_3_exact
    s_cmp_eq_u32 s70, 1
    s_cbranch_scc1 M_c1_3_exact
M_c1_3_vfy0:
    s_mov_b32 s70, 1
    s_mov_b32 s30, 0
    s_waitcnt vmcnt(0) lgkmcnt(0)
    s_nop 7
M_c1_3_vfy:
    v_mov_b32 v10, 0
    s_add_u32 s59, s48, 4096
    buffer_load_dwordx4 v[36:39], v0, s[8:11], s48 offen offset:0 sc1
    buffer_load_dwordx4 v[40:43], v0, s[8:11], s48 offen offset:1024 sc1
    buffer_load_dwordx4 v[44:47], v0, s[8:11], s48 offen offset:2048 sc1
    buffer_load_dwordx4 v[48:51], v0, s[8:11], s48 offen offset:3072 sc1
    buffer_load_dwordx4 v[52:55], v0, s[8:11], s59 offen offset:0 sc1
    s_waitcnt vmcnt(4)
    v_max3_u32 v10, v10, v36, v37
    v_max3_u32 v10, v10, v38, v39
    s_waitcnt vmcnt(3)
    v_max3_u32 v10, v10, v40, v41
    v_max3_u32 v10, v10, v42, v43
    s_waitcnt vmcnt(2)
    v_max3_u32 v10, v10, v44, v45
    v_max3_u32 v10, v10, v46, v47
    s_waitcnt vmcnt(1)
    v_max3_u32 v10, v10, v48, v49
    v_max3_u32 v10, v10, v50, v51
    s_waitcnt vmcnt(0)
    v_max3_u32 v10, v10, v52, v53
    v_max3_u32 v10, v10, v54, v55
    s_add_u32 s59, s49, 4096
    buffer_load_dwordx4 v[36:39], v0, s[8:11], s49 offen offset:0 sc1
    buffer_load_dwordx4 v[40:43], v0, s[8:11], s49 offen offset:1024 sc1
    buffer_load_dwordx4 v[44:47], v0, s[8:11], s49 offen offset:2048 sc1
    buffer_load_dwordx4 v[48:51], v0, s[8:11], s49 offen offset:3072 sc1
    buffer_load_dwordx4 v[52:55], v0, s[8:11], s59 offen offset:0 sc1
    s_waitcnt vmcnt(4)
    v_max3_u32 v10, v10, v36, v37
    v_max3_u32 v10, v10, v38, v39
    s_waitcnt vmcnt(3)
    v_max3_u32 v10, v10, v40, v41
    v_max3_u32 v10, v10, v42, v43
    s_waitcnt vmcnt(2)
    v_max3_u32 v10, v10, v44, v45
    v_max3_u32 v10, v10, v46, v47
    s_waitcnt vmcnt(1)
    v_max3_u32 v10, v10, v48, v49
    v_max3_u32 v10, v10, v50, v51
    s_waitcnt vmcnt(0)
    v_max3_u32 v10, v10, v52, v53
    v_max3_u32 v10, v10, v54, v55
    v_cmp_eq_u32 vcc, -1, v10
    s_cbranch_vccz M_c1_3_restart
    s_add_u32 s30, s30, 1
    s_cmp_ge_u32 s30, 60000
    s_cbranch_scc1 M_fail
    s_branch M_c1_3_vfy
M_c1_3_exact:
    s_nop 7
    s_mov_b32 s70, 2
    s_waitcnt lgkmcnt(0)
    ds_read_b128 v[20:23], v3 offset:18432
    ds_read_b128 v[24:27], v3 offset:18496
    ds_read_b128 v[72:75], v3 offset:18560
    ds_read_b128 v[44:47], v3 offset:18624
    ds_read_b128 v[56:59], v0 offset:0
    s_waitcnt lgkmcnt(0)
    v_mfma_f32_16x16x32_bf16 v[28:31], v[56:59], v[20:23], 0
    s_nop 3
    ds_read_b128 v[60:63], v0 offset:1024
    s_waitcnt lgkmcnt(0)
    v_mfma_f32_16x16x32_bf16 v[28:31], v[60:63], v[24:27], v[28:31]
    s_nop 3
    ds_read_b128 v[56:59], v0 offset:2048
    s_waitcnt lgkmcnt(0)
    v_mfma_f32_16x16x32_bf16 v[28:31], v[56:59], v[72:75], v[28:31]
    s_nop 3
    ds_read_b128 v[60:63], v0 offset:3072
    s_waitcnt lgkmcnt(0)
    v_mfma_f32_16x16x32_bf16 v[28:31], v[60:63], v[44:47], v[28:31]
    s_nop 3
    ds_read_b128 v[56:59], v0 offset:4096
    s_waitcnt lgkmcnt(0)
    v_mfma_f32_16x16x32_bf16 v[32:35], v[56:59], v[20:23], 0
    s_nop 3
    ds_read_b128 v[60:63], v0 offset:5120
    s_waitcnt lgkmcnt(0)
    v_mfma_f32_16x16x32_bf16 v[32:35], v[60:63], v[24:27], v[32:35]
    s_nop 3
    ds_read_b128 v[56:59], v0 offset:6144
    s_waitcnt lgkmcnt(0)
    v_mfma_f32_16x16x32_bf16 v[32:35], v[56:59], v[72:75], v[32:35]
    s_nop 3
    ds_read_b128 v[60:63], v0 offset:7168
    s_waitcnt lgkmcnt(0)
    v_mfma_f32_16x16x32_bf16 v[32:35], v[60:63], v[44:47], v[32:35]
    s_nop 3
    ds_read_b128 v[56:59], v3 offset:20736
    s_waitcnt lgkmcnt(0)
    v_mfma_f32_16x16x32_bf16 v[40:43], v[56:59], v[20:23], 0
    s_nop 3
    ds_read_b128 v[60:63], v3 offset:20800
    s_waitcnt lgkmcnt(0)
    v_mfma_f32_16x16x32_bf16 v[40:43], v[60:63], v[24:27], v[40:43]
    s_nop 3
    ds_read_b128 v[56:59], v3 offset:20864
    s_waitcnt lgkmcnt(0)
    v_mfma_f32_16x16x32_bf16 v[40:43], v[56:59], v[72:75], v[40:43]
    s_nop 3
    ds_read_b128 v[60:63], v3 offset:20928
    s_waitcnt lgkmcnt(0)
    v_mfma_f32_16x16x32_bf16 v[40:43], v[60:63], v[44:47], v[40:43]
    s_nop 3
    v_max3_f32 v68, v28, v29, v30
    v_max3_f32 v68, v68, v31, v32
    v_max3_f32 v68, v68, v33, v34
    s_nop 0
    v_max3_f32 v68, v68, v35, v40
    v_max3_f32 v68, v68, v41, v42
    v_max_f32 v68, v68, v43
    v_mov_b32 v69, v68
    s_nop 1
    v_permlane16_swap_b32 v68, v69
    v_max_f32 v68, v68, v69
    v_mov_b32 v69, v68
    s_nop 1
    v_permlane32_swap_b32 v68, v69
    v_max_f32 v68, v68, v69
    v_sub_f32 v28, v28, v68
    v_exp_f32 v28, v28
    v_sub_f32 v29, v29, v68
    v_exp_f32 v29, v29
    v_sub_f32 v30, v30, v68
    v_exp_f32 v30, v30
    v_sub_f32 v31, v31, v68
    v_exp_f32 v31, v31
    v_sub_f32 v32, v32, v68
    v_exp_f32 v32, v32
    v_sub_f32 v33, v33, v68
    v_exp_f32 v33, v33
    v_sub_f32 v34, v34, v68
    v_exp_f32 v34, v34
    v_sub_f32 v35, v35, v68
    v_exp_f32 v35, v35
    v_sub_f32 v40, v40, v68
    v_exp_f32 v40, v40
    v_sub_f32 v41, v41, v68
    v_exp_f32 v41, v41
    v_sub_f32 v42, v42, v68
    v_exp_f32 v42, v42
    v_sub_f32 v43, v43, v68
    v_exp_f32 v43, v43
    v_cvt_pk_bf16_f32 v28, v28, v29
    v_cvt_pk_bf16_f32 v29, v30, v31
    v_cvt_pk_bf16_f32 v30, v32, v33
    v_cvt_pk_bf16_f32 v31, v34, v35
    v_cvt_pk_bf16_f32 v40, v40, v41
    v_cvt_pk_bf16_f32 v41, v42, v43
    v_mfma_f32_16x16x32_bf16 v[20:23], v[80:83], v[28:31], 0
    v_mfma_f32_16x16x32_bf16 v[24:27], v[84:87], v[28:31], 0
    v_mfma_f32_16x16x32_bf16 v[72:75], v[64:67], v[28:31], 0
    ds_read_b128 v[60:63], v3 offset:20928
    s_waitcnt lgkmcnt(0)
    s_nop 7
    v_mfma_f32_16x16x16_bf16 v[72:75], v[10:11], v[40:41], v[72:75]
    s_nop 7
    s_branch M_c1_3_fin
M_c1_3_last:
    s_cmp_lg_u32 s70, 0
    s_cbranch_scc1 M_c1_3_last2
    v_cmp_u_f32 vcc, v32, v32
    s_cbranch_vccnz M_c1_3_vfy0
M_c1_3_last2:
    s_lshl_b32 s4, s44, 18
    s_add_u32 s4, s4, s53
    buffer_store_dwordx4 v[76:79], v0, s[8:11], s4 offen offset:3072 sc1
    s_mov_b32 s4, 0x10000000
    s_waitcnt vmcnt(0) lgkmcnt(0)
    s_barrier
    s_nop 7
    v_mov_b64 v[72:73], -1
    v_mov_b64 v[74:75], -1
    s_add_u32 s28, s44, 3
    s_and_b32 s29, s28, 3
    s_mul_i32 s31, s22, 160
    s_waitcnt vmcnt(0)
    s_add_u32 s44, s44, 1
    s_branch M_c_fft
    s_cmp_eq_u32 s44, 128
    s_cbranch_scc1 M_end
    s_branch M_c1_3_layer
M_c1_3_lr:
    s_mov_b32 s30, 0
M_c1_3_lr_l:
    s_waitcnt lgkmcnt(0)
    s_and_b32 s27, s30, 1
    s_cbranch_scc0 M_c1_3_lr_n
    s_waitcnt vmcnt(2)
    s_mov_b32 m0, 13312
    s_nop 0
    buffer_load_dwordx4 v0, s[8:11], s48 offen offset:3072 sc1 lds
    s_mov_b32 m0, 17408
    s_add_u32 s59, s48, 4096
    buffer_load_dwordx4 v0, s[8:11], s59 offen offset:0 sc1 lds
M_c1_3_lr_n:
    ds_read_b128 v[36:39], v6 offset:13312
    ds_read_b128 v[40:43], v6 offset:14336
    ds_read_b128 v[44:47], v6 offset:15360
    ds_read_b128 v[48:51], v6 offset:16384
    ds_read_b128 v[52:55], v6 offset:17408
    s_waitcnt lgkmcnt(2)
    v_max3_u32 v10, v36, v40, v44
    s_waitcnt lgkmcnt(0)
    v_max3_u32 v10, v10, v48, v52
    v_cmp_eq_u32 vcc, -1, v10
    s_cbranch_vccz M_c1_3_lr_d
    s_add_u32 s30, s30, 1
    s_cmp_ge_u32 s30, 480000
    s_cbranch_scc1 M_fail
    s_branch M_c1_3_lr_l
M_c1_3_lr_d:
    ds_read_b128 v[56:59], v5 offset:0
    ds_read_b128 v[60:63], v5 offset:1024
    ds_read_b128 v[64:67], v5 offset:2048
    ds_read_b128 v[68:71], v5 offset:3072
    v_mov_b64 v[12:13], 0
    v_mov_b64 v[14:15], 0
    v_mov_b64 v[16:17], 0
    v_mov_b64 v[18:19], 0
    v_mov_b64 v[20:21], 0
    v_mov_b64 v[22:23], 0
    v_mov_b64 v[24:25], 0
    v_mov_b64 v[26:27], 0
    v_mov_b64 v[28:29], 0
    v_mov_b64 v[30:31], 0
    v_mov_b64 v[32:33], 0
    v_mov_b64 v[34:35], 0
    s_waitcnt lgkmcnt(0)
    s_branch M_c1_3_lr_r
M_c1_3_rr:
    s_mov_b32 s30, 0
M_c1_3_rr_l:
    s_waitcnt lgkmcnt(0)
    s_and_b32 s27, s30, 1
    s_cbranch_scc1 M_c1_3_rr_n
    s_waitcnt vmcnt(1)
    s_mov_b32 m0, 12288
    s_add_u32 s59, s49, 4096
    buffer_load_dwordx4 v0, s[8:11], s59 offen offset:0 sc1 lds
M_c1_3_rr_n:
    ds_read_b128 v[36:39], v6 offset:8192
    ds_read_b128 v[40:43], v6 offset:9216
    ds_read_b128 v[44:47], v6 offset:10240
    ds_read_b128 v[48:51], v6 offset:11264
    ds_read_b32 v11, v6 offset:12288
    s_waitcnt lgkmcnt(2)
    v_max3_u32 v10, v36, v40, v44
    s_waitcnt lgkmcnt(0)
    v_max3_u32 v10, v10, v48, v11
    v_cmp_eq_u32 vcc, -1, v10
    s_cbranch_vccz M_c1_3_rr_d
    s_add_u32 s30, s30, 1
    s_cmp_ge_u32 s30, 480000
    s_cbranch_scc1 M_fail
    s_branch M_c1_3_rr_l
M_c1_3_rr_d:
    s_branch M_c1_3_rr_r
M_c1_3_first:
    s_mul_i32 s27, s21, 167936
    s_add_u32 s27, s27, s34
    s_mul_i32 s28, s22, 4224
    s_add_u32 s28, s28, s27
    s_mov_b32 exec_hi, 0
    buffer_load_dword v10, v9, s[8:11], s28 offen sc1
    s_lshl_b32 s28, s22, 10
    s_add_u32 s28, s28, s27
    s_add_u32 s28, s28, 135168
    s_mov_b64 exec, 0xff
    buffer_load_dword v10, v9, s[8:11], s28 offen sc1
    s_mul_i32 s27, s21, 5120
    s_add_u32 s27, s27, s41
    s_mul_i32 s28, s22, 160
    s_add_u32 s28, s28, s27
    s_mov_b64 exec, 3
    buffer_load_dword v10, v9, s[8:11], s28 offen sc1
    s_mov_b64 exec, -1
    s_add_u32 s27, s44, 1
    s_or_b32 s28, s44, 63
    s_add_u32 s28, s28, 1
    s_min_u32 s27, s27, s28
    s_cmp_lt_u32 s54, s27
    s_cbranch_scc1 M_c1_3_p1
M_c1_3_p1_r:
    s_barrier
    s_and_b32 s26, s44, 63
    s_lshl_b32 s26, s26, 18
    s_add_u32 s26, s26, s50
    s_add_u32 s26, s26, 6144
    s_add_u32 s3, s26, 16777216
    s_mov_b32 m0, 6144
    s_nop 0
    buffer_load_dwordx4 v0, s[8:11], s26 offen offset:0 sc1 lds
    buffer_load_dwordx4 v0, s[8:11], s26 offen offset:1024 sc1 lds
    buffer_load_dwordx4 v[80:83], v0, s[8:11], s3 offen offset:0 sc1
    buffer_load_dwordx4 v[84:87], v0, s[8:11], s3 offen offset:1024 sc1
    s_and_b32 s26, s44, 63
    s_add_u32 s26, s26, 1
    s_min_u32 s26, s26, 63
    s_lshl_b32 s26, s26, 18
    s_add_u32 s26, s26, s50
    s_add_u32 s26, s26, 6144
    s_add_u32 s3, s26, 16777216
    s_waitcnt vmcnt(0) lgkmcnt(0)
    s_barrier
    s_branch M_c1_3_first_r
M_c1_3_first2:
    ds_read_b64 v[10:11], v0 offset:23296
    s_waitcnt lgkmcnt(0)
    v_min_u32 v10, v10, v11
    s_nop 0
    v_readfirstlane_b32 s28, v10
    s_nop 0
    s_max_u32 s54, s54, s28
    s_add_u32 s27, s44, 2
    s_or_b32 s28, s44, 63
    s_add_u32 s28, s28, 1
    s_min_u32 s27, s27, s28
    s_cmp_lt_u32 s54, s27
    s_cbranch_scc1 M_c1_3_p2
M_c1_3_p2_r:
    s_branch M_c1_3_first2_r
M_c1_3_p1:
    s_mov_b32 s30, 0
M_c1_3_p1_l:
    s_waitcnt lgkmcnt(0)
    s_mov_b64 exec, 3
    buffer_load_dword v10, v9, s[8:11], s51 offen sc1
    s_waitcnt vmcnt(0)
    s_mov_b64 exec, -1
    v_readlane_b32 s54, v10, 0
    v_readlane_b32 s28, v10, 1
    s_nop 3
    s_min_u32 s54, s54, s28
    s_cmp_ge_u32 s54, s27
    s_cbranch_scc1 M_c1_3_p1_r
    s_sleep 2
    s_add_u32 s30, s30, 1
    s_cmp_ge_u32 s30, 240000
    s_cbranch_scc1 M_fail
    s_branch M_c1_3_p1_l
M_c1_3_p2:
    s_mov_b32 s30, 0
M_c1_3_p2_l:
    s_waitcnt lgkmcnt(0)
    s_mov_b64 exec, 3
    buffer_load_dword v10, v9, s[8:11], s51 offen sc1
    s_waitcnt vmcnt(0)
    s_mov_b64 exec, -1
    v_readlane_b32 s54, v10, 0
    v_readlane_b32 s28, v10, 1
    s_nop 3
    s_min_u32 s54, s54, s28
    s_cmp_ge_u32 s54, s27
    s_cbranch_scc1 M_c1_3_p2_r
    s_sleep 2
    s_add_u32 s30, s30, 1
    s_cmp_ge_u32 s30, 240000
    s_cbranch_scc1 M_fail
    s_branch M_c1_3_p2_l
M_c_fft:
    s_lshr_b32 s72, s44, 6
    s_sub_u32 s72, s72, 1
    v_lshrrev_b32 v12, 4, v0
    s_lshl_b32 s27, s21, 6
    v_add_u32 v12, s27, v12
    v_lshlrev_b32 v13, 2, v12
    v_lshlrev_b32 v14, 3, v12
    v_lshlrev_b32 v19, 6, v12
    v_lshrrev_b32 v20, 5, v12
    v_mul_u32_u24 v20, 2304, v20
    v_and_b32 v15, 31, v12
    v_lshl_add_u32 v15, v15, 3, v20
    v_bfe_u32 v16, v12, 2, 3
    v_mul_u32_u24 v16, 288, v16
    v_add_u32 v16, v16, v20
    v_and_b32 v21, 3, v12
    v_lshl_add_u32 v17, v21, 6, v16
    v_lshl_add_u32 v16, v21, 3, v16
    v_and_b32 v18, 0xe0, v12
    v_and_b32 v20, 15, v12
    v_lshl_add_u32 v18, v20, 1, v18
    v_bfe_u32 v20, v12, 4, 1
    v_add_u32 v18, v18, v20
    v_lshlrev_b32 v18, 3, v18
    s_lshl_b32 s73, s20, 5
    s_add_u32 s73, s73, s22
    s_add_u32 s73, s73, 256
    s_mov_b32 s78, 0x3f3504f3
    s_mov_b32 s79, s78
    s_mul_i32 s74, s72, 6291456
    s_lshl_b32 s27, s73, 13
    s_add_u32 s74, s74, s27
    s_add_u32 s74, s74, 176160768
    s_add_u32 s75, s74, 2621440
    s_add_u32 s76, s74, 4096
    s_add_u32 s77, s75, 4096
    s_lshr_b32 s80, s73, 1
    s_lshl_b32 s80, s80, 14
    s_and_b32 s27, s73, 1
    s_lshl_b32 s28, s27, 4
    s_add_u32 s81, s80, s28
    s_add_u32 s81, s81, 148897792
    s_lshl_b32 s27, s27, 2
    s_add_u32 s80, s80, s27
    s_mul_i32 s27, s72, 3145728
    s_add_u32 s80, s80, s27
    s_add_u32 s80, s80, 157286400
    s_cmp_lg_u32 s21, 0
    s_cbranch_scc1 M_cp_1
    v_and_b32 v84, 7, v12
    v_lshlrev_b32 v84, 12, v84
    v_bfe_u32 v85, v12, 3, 1
    v_mul_u32_u24 v85, 1280, v85
    v_add_u32 v84, v84, v85
    s_mov_b64 exec, 0x1f1f
    s_lshr_b32 s31, s73, 5
    s_lshl_b32 s31, s31, 7
    s_add_u32 s31, s31, 167927808
    s_lshl_b32 s29, s72, 2
    s_add_u32 s29, s29, 2
    s_mov_b32 s30, 0
M_cp_2:
    buffer_load_dword v85, v84, s[8:11], s31 offen sc1
    s_add_u32 s30, s30, 1
    s_cmp_ge_u32 s30, 240000
    s_cbranch_scc1 M_fail
    s_sleep 4
    s_waitcnt vmcnt(0)
    v_cmp_gt_u32 vcc, s29, v85
    s_cbranch_vccnz M_cp_2
    s_mov_b64 exec, -1
M_cp_1:
    s_barrier
    buffer_load_dword v44, v13, s[8:11], s74 offen offset:0 sc1
    buffer_load_dword v45, v13, s[8:11], s75 offen offset:0 sc1
    buffer_load_dword v46, v13, s[8:11], s74 offen offset:1024 sc1
    buffer_load_dword v47, v13, s[8:11], s75 offen offset:1024 sc1
    buffer_load_dword v48, v13, s[8:11], s74 offen offset:2048 sc1
    buffer_load_dword v49, v13, s[8:11], s75 offen offset:2048 sc1
    buffer_load_dword v50, v13, s[8:11], s74 offen offset:3072 sc1
    buffer_load_dword v51, v13, s[8:11], s75 offen offset:3072 sc1
    buffer_load_dword v52, v13, s[8:11], s76 offen offset:0 sc1
    buffer_load_dword v53, v13, s[8:11], s77 offen offset:0 sc1
    buffer_load_dword v54, v13, s[8:11], s76 offen offset:1024 sc1
    buffer_load_dword v55, v13, s[8:11], s77 offen offset:1024 sc1
    buffer_load_dword v56, v13, s[8:11], s76 offen offset:2048 sc1
    buffer_load_dword v57, v13, s[8:11], s77 offen offset:2048 sc1
    buffer_load_dwordx4 v[36:39], v19, s[8:11], s81 offen sc1
    buffer_load_dwordx4 v[40:43], v19, s[8:11], s81 offen offset:32 sc1
    v_and_b32 v20, 255, v12
    v_cvt_f32_u32 v20, v20
    v_mul_f32 v21, 0xba000000, v20
    v_cos_f32 v22, v21
    v_sin_f32 v23, v21
    v_mul_f32 v21, 0xba800000, v20
    v_cos_f32 v24, v21
    v_sin_f32 v25, v21
    v_mul_f32 v21, 0xbac00000, v20
    v_cos_f32 v26, v21
    v_sin_f32 v27, v21
    v_mul_f32 v21, 0xbb000000, v20
    v_cos_f32 v28, v21
    v_sin_f32 v29, v21
    v_mul_f32 v21, 0xbb200000, v20
    v_cos_f32 v30, v21
    v_sin_f32 v31, v21
    v_mul_f32 v21, 0xbb400000, v20
    v_cos_f32 v32, v21
    v_sin_f32 v33, v21
    v_mul_f32 v21, 0xbb600000, v20
    v_cos_f32 v34, v21
    v_sin_f32 v35, v21
    s_waitcnt vmcnt(0)
    s_cmp_lg_u32 s21, 0
    s_cbranch_scc1 M_cp_3
    v_and_b32 v84, 7, v12
    v_lshlrev_b32 v84, 12, v84
    v_bfe_u32 v85, v12, 3, 1
    v_mul_u32_u24 v85, 1280, v85
    v_add_u32 v84, v84, v85
    s_mov_b64 exec, 0x1f1f
    s_lshr_b32 s31, s73, 5
    s_lshl_b32 s31, s31, 7
    s_add_u32 s31, s31, 167927808
    s_lshl_b32 s29, s72, 2
    s_add_u32 s29, s29, 3
    s_mov_b32 s30, 0
M_cp_4:
    buffer_load_dword v85, v84, s[8:11], s31 offen sc1
    s_add_u32 s30, s30, 1
    s_cmp_ge_u32 s30, 240000
    s_cbranch_scc1 M_fail
    s_sleep 1
    s_waitcnt vmcnt(0)
    v_cmp_gt_u32 vcc, s29, v85
    s_cbranch_vccnz M_cp_4
    s_mov_b64 exec, -1
M_cp_3:
    s_barrier
    buffer_load_dword v58, v13, s[8:11], s76 offen offset:3072 sc1
    buffer_load_dword v59, v13, s[8:11], s77 offen offset:3072 sc1
    v_pk_add_f32 v[60:61], v[44:45], v[52:53]
    v_pk_add_f32 v[62:63], v[44:45], v[52:53] neg_lo:[0,1] neg_hi:[0,1]
    v_pk_add_f32 v[64:65], v[46:47], v[54:55]
    v_pk_add_f32 v[66:67], v[46:47], v[54:55] neg_lo:[0,1] neg_hi:[0,1]
    v_pk_add_f32 v[68:69], v[48:49], v[56:57]
    v_pk_add_f32 v[70:71], v[48:49], v[56:57] neg_lo:[0,1] neg_hi:[0,1]
    s_waitcnt vmcnt(0)
    v_pk_add_f32 v[72:73], v[50:51], v[58:59]
    v_pk_add_f32 v[74:75], v[50:51], v[58:59] neg_lo:[0,1] neg_hi:[0,1]
    v_pk_add_f32 v[76:77], v[60:61], v[68:69]
    v_pk_add_f32 v[78:79], v[60:61], v[68:69] neg_lo:[0,1] neg_hi:[0,1]
    v_pk_add_f32 v[80:81], v[64:65], v[72:73]
    v_pk_add_f32 v[82:83], v[64:65], v[72:73] neg_lo:[0,1] neg_hi:[0,1]
    v_pk_add_f32 v[44:45], v[76:77], v[80:81]
    v_pk_add_f32 v[52:53], v[76:77], v[80:81] neg_lo:[0,1] neg_hi:[0,1]
    v_pk_add_f32 v[46:47], v[78:79], v[82:83] op_sel:[0,1] op_sel_hi:[1,0] neg_lo:[0,0] neg_hi:[0,1]
    v_pk_add_f32 v[54:55], v[78:79], v[82:83] op_sel:[0,1] op_sel_hi:[1,0] neg_lo:[0,1] neg_hi:[0,0]
    v_pk_add_f32 v[48:49], v[66:67], v[66:67] op_sel:[0,1] op_sel_hi:[1,0] neg_lo:[0,0] neg_hi:[0,1]
    v_pk_add_f32 v[56:57], v[74:75], v[74:75] op_sel:[0,1] op_sel_hi:[1,0] neg_lo:[1,0] neg_hi:[1,1]
    v_pk_add_f32 v[50:51], v[62:63], v[70:71] op_sel:[0,1] op_sel_hi:[1,0] neg_lo:[0,0] neg_hi:[0,1]
    v_pk_add_f32 v[58:59], v[62:63], v[70:71] op_sel:[0,1] op_sel_hi:[1,0] neg_lo:[0,1] neg_hi:[0,0]
    v_pk_add_f32 v[60:61], v[48:49], v[56:57]
    v_pk_add_f32 v[64:65], v[48:49], v[56:57] neg_lo:[0,1] neg_hi:[0,1]
    v_pk_fma_f32 v[68:69], v[60:61], s[78:79], v[50:51] neg_lo:[0,0,0] neg_hi:[0,0,0]
    v_pk_fma_f32 v[72:73], v[60:61], s[78:79], v[50:51] neg_lo:[1,0,0] neg_hi:[1,0,0]
    v_pk_fma_f32 v[76:77], v[64:65], s[78:79], v[58:59] op_sel:[1,0,0] op_sel_hi:[0,1,1] neg_lo:[0,0,0] neg_hi:[1,0,0]
    v_pk_fma_f32 v[78:79], v[64:65], s[78:79], v[58:59] op_sel:[1,0,0] op_sel_hi:[0,1,1] neg_lo:[1,0,0] neg_hi:[0,0,0]
    v_pk_mul_f32 v[80:81], v[68:69], v[22:23] op_sel:[0,0] op_sel_hi:[1,0]
    v_pk_mul_f32 v[82:83], v[46:47], v[24:25] op_sel:[0,0] op_sel_hi:[1,0]
    v_pk_mul_f32 v[62:63], v[76:77], v[26:27] op_sel:[0,0] op_sel_hi:[1,0]
    v_pk_mul_f32 v[66:67], v[52:53], v[28:29] op_sel:[0,0] op_sel_hi:[1,0]
    v_pk_mul_f32 v[70:71], v[72:73], v[30:31] op_sel:[0,0] op_sel_hi:[1,0]
    v_pk_mul_f32 v[74:75], v[54:55], v[32:33] op_sel:[0,0] op_sel_hi:[1,0]
    v_pk_mul_f32 v[48:49], v[78:79], v[34:35] op_sel:[0,0] op_sel_hi:[1,0]
    v_pk_fma_f32 v[80:81], v[68:69], v[22:23], v[80:81] op_sel:[1,1,0] op_sel_hi:[0,1,1] neg_lo:[1,0,0] neg_hi:[0,0,0]
    v_pk_fma_f32 v[82:83], v[46:47], v[24:25], v[82:83] op_sel:[1,1,0] op_sel_hi:[0,1,1] neg_lo:[1,0,0] neg_hi:[0,0,0]
    v_pk_fma_f32 v[62:63], v[76:77], v[26:27], v[62:63] op_sel:[1,1,0] op_sel_hi:[0,1,1] neg_lo:[1,0,0] neg_hi:[0,0,0]
    v_pk_fma_f32 v[66:67], v[52:53], v[28:29], v[66:67] op_sel:[1,1,0] op_sel_hi:[0,1,1] neg_lo:[1,0,0] neg_hi:[0,0,0]
    v_pk_fma_f32 v[70:71], v[72:73], v[30:31], v[70:71] op_sel:[1,1,0] op_sel_hi:[0,1,1] neg_lo:[1,0,0] neg_hi:[0,0,0]
    v_pk_fma_f32 v[74:75], v[54:55], v[32:33], v[74:75] op_sel:[1,1,0] op_sel_hi:[0,1,1] neg_lo:[1,0,0] neg_hi:[0,0,0]
    v_pk_fma_f32 v[48:49], v[78:79], v[34:35], v[48:49] op_sel:[1,1,0] op_sel_hi:[0,1,1] neg_lo:[1,0,0] neg_hi:[0,0,0]
    ds_write_b64 v14, v[44:45] offset:0
    ds_write_b64 v14, v[80:81] offset:2304
    ds_write_b64 v14, v[82:83] offset:4608
    ds_write_b64 v14, v[62:63] offset:6912
    ds_write_b64 v14, v[66:67] offset:9216
    ds_write_b64 v14, v[70:71] offset:11520
    ds_write_b64 v14, v[74:75] offset:13824
    ds_write_b64 v14, v[48:49] offset:16128
    s_waitcnt lgkmcnt(0)
    s_barrier
    ds_read_b64 v[56:57], v15 offset:0
    ds_read_b64 v[50:51], v15 offset:256
    ds_read_b64 v[58:59], v15 offset:512
    ds_read_b64 v[60:61], v15 offset:768
    ds_read_b64 v[64:65], v15 offset:1024
    ds_read_b64 v[68:69], v15 offset:1280
    ds_read_b64 v[46:47], v15 offset:1536
    ds_read_b64 v[76:77], v15 offset:1792
    v_and_b32 v20, 31, v12
    v_cvt_f32_u32 v20, v20
    v_mul_f32 v21, 0xbb800000, v20
    v_cos_f32 v22, v21
    v_sin_f32 v23, v21
    v_mul_f32 v21, 0xbc000000, v20
    v_cos_f32 v24, v21
    v_sin_f32 v25, v21
    v_mul_f32 v21, 0xbc400000, v20
    v_cos_f32 v26, v21
    v_sin_f32 v27, v21
    v_mul_f32 v21, 0xbc800000, v20
    v_cos_f32 v28, v21
    v_sin_f32 v29, v21
    v_mul_f32 v21, 0xbca00000, v20
    v_cos_f32 v30, v21
    v_sin_f32 v31, v21
    v_mul_f32 v21, 0xbcc00000, v20
    v_cos_f32 v32, v21
    v_sin_f32 v33, v21
    v_mul_f32 v21, 0xbce00000, v20
    v_cos_f32 v34, v21
    v_sin_f32 v35, v21
    s_waitcnt lgkmcnt(3)
    v_pk_add_f32 v[52:53], v[56:57], v[64:65]
    v_pk_add_f32 v[72:73], v[56:57], v[64:65] neg_lo:[0,1] neg_hi:[0,1]
    s_waitcnt lgkmcnt(2)
    v_pk_add_f32 v[54:55], v[50:51], v[68:69]
    v_pk_add_f32 v[78:79], v[50:51], v[68:69] neg_lo:[0,1] neg_hi:[0,1]
    s_waitcnt lgkmcnt(1)
    v_pk_add_f32 v[44:45], v[58:59], v[46:47]
    v_pk_add_f32 v[80:81], v[58:59], v[46:47] neg_lo:[0,1] neg_hi:[0,1]
    s_waitcnt lgkmcnt(0)
    v_pk_add_f32 v[82:83], v[60:61], v[76:77]
    v_pk_add_f32 v[62:63], v[60:61], v[76:77] neg_lo:[0,1] neg_hi:[0,1]
    v_pk_add_f32 v[66:67], v[52:53], v[44:45]
    v_pk_add_f32 v[70:71], v[52:53], v[44:45] neg_lo:[0,1] neg_hi:[0,1]
    v_pk_add_f32 v[74:75], v[54:55], v[82:83]
    v_pk_add_f32 v[48:49], v[54:55], v[82:83] neg_lo:[0,1] neg_hi:[0,1]
    v_pk_add_f32 v[56:57], v[66:67], v[74:75]
    v_pk_add_f32 v[64:65], v[66:67], v[74:75] neg_lo:[0,1] neg_hi:[0,1]
    v_pk_add_f32 v[50:51], v[70:71], v[48:49] op_sel:[0,1] op_sel_hi:[1,0] neg_lo:[0,0] neg_hi:[0,1]
    v_pk_add_f32 v[68:69], v[70:71], v[48:49] op_sel:[0,1] op_sel_hi:[1,0] neg_lo:[0,1] neg_hi:[0,0]
    v_pk_add_f32 v[58:59], v[78:79], v[78:79] op_sel:[0,1] op_sel_hi:[1,0] neg_lo:[0,0] neg_hi:[0,1]
    v_pk_add_f32 v[46:47], v[62:63], v[62:63] op_sel:[0,1] op_sel_hi:[1,0] neg_lo:[1,0] neg_hi:[1,1]
    v_pk_add_f32 v[60:61], v[72:73], v[80:81] op_sel:[0,1] op_sel_hi:[1,0] neg_lo:[0,0] neg_hi:[0,1]
    v_pk_add_f32 v[76:77], v[72:73], v[80:81] op_sel:[0,1] op_sel_hi:[1,0] neg_lo:[0,1] neg_hi:[0,0]
    v_pk_add_f32 v[52:53], v[58:59], v[46:47]
    v_pk_add_f32 v[54:55], v[58:59], v[46:47] neg_lo:[0,1] neg_hi:[0,1]
    v_pk_fma_f32 v[44:45], v[52:53], s[78:79], v[60:61] neg_lo:[0,0,0] neg_hi:[0,0,0]
    v_pk_fma_f32 v[82:83], v[52:53], s[78:79], v[60:61] neg_lo:[1,0,0] neg_hi:[1,0,0]
    v_pk_fma_f32 v[66:67], v[54:55], s[78:79], v[76:77] op_sel:[1,0,0] op_sel_hi:[0,1,1] neg_lo:[0,0,0] neg_hi:[1,0,0]
    v_pk_fma_f32 v[70:71], v[54:55], s[78:79], v[76:77] op_sel:[1,0,0] op_sel_hi:[0,1,1] neg_lo:[1,0,0] neg_hi:[0,0,0]
    v_pk_mul_f32 v[74:75], v[44:45], v[22:23] op_sel:[0,0] op_sel_hi:[1,0]
    v_pk_mul_f32 v[48:49], v[50:51], v[24:25] op_sel:[0,0] op_sel_hi:[1,0]
    v_pk_mul_f32 v[72:73], v[66:67], v[26:27] op_sel:[0,0] op_sel_hi:[1,0]
    v_pk_mul_f32 v[78:79], v[64:65], v[28:29] op_sel:[0,0] op_sel_hi:[1,0]
    v_pk_mul_f32 v[80:81], v[82:83], v[30:31] op_sel:[0,0] op_sel_hi:[1,0]
    v_pk_mul_f32 v[62:63], v[68:69], v[32:33] op_sel:[0,0] op_sel_hi:[1,0]
    v_pk_mul_f32 v[58:59], v[70:71], v[34:35] op_sel:[0,0] op_sel_hi:[1,0]
    v_pk_fma_f32 v[74:75], v[44:45], v[22:23], v[74:75] op_sel:[1,1,0] op_sel_hi:[0,1,1] neg_lo:[1,0,0] neg_hi:[0,0,0]
    v_pk_fma_f32 v[48:49], v[50:51], v[24:25], v[48:49] op_sel:[1,1,0] op_sel_hi:[0,1,1] neg_lo:[1,0,0] neg_hi:[0,0,0]
    v_pk_fma_f32 v[72:73], v[66:67], v[26:27], v[72:73] op_sel:[1,1,0] op_sel_hi:[0,1,1] neg_lo:[1,0,0] neg_hi:[0,0,0]
    v_pk_fma_f32 v[78:79], v[64:65], v[28:29], v[78:79] op_sel:[1,1,0] op_sel_hi:[0,1,1] neg_lo:[1,0,0] neg_hi:[0,0,0]
    v_pk_fma_f32 v[80:81], v[82:83], v[30:31], v[80:81] op_sel:[1,1,0] op_sel_hi:[0,1,1] neg_lo:[1,0,0] neg_hi:[0,0,0]
    v_pk_fma_f32 v[62:63], v[68:69], v[32:33], v[62:63] op_sel:[1,1,0] op_sel_hi:[0,1,1] neg_lo:[1,0,0] neg_hi:[0,0,0]
    v_pk_fma_f32 v[58:59], v[70:71], v[34:35], v[58:59] op_sel:[1,1,0] op_sel_hi:[0,1,1] neg_lo:[1,0,0] neg_hi:[0,0,0]
    ds_write_b64 v15, v[56:57] offset:0
    ds_write_b64 v15, v[74:75] offset:288
    ds_write_b64 v15, v[48:49] offset:576
    ds_write_b64 v15, v[72:73] offset:864
    ds_write_b64 v15, v[78:79] offset:1152
    ds_write_b64 v15, v[80:81] offset:1440
    ds_write_b64 v15, v[62:63] offset:1728
    ds_write_b64 v15, v[58:59] offset:2016
    ds_read_b64 v[46:47], v16 offset:0
    ds_read_b64 v[60:61], v16 offset:32
    ds_read_b64 v[76:77], v16 offset:64
    ds_read_b64 v[52:53], v16 offset:96
    ds_read_b64 v[54:55], v16 offset:128
    ds_read_b64 v[44:45], v16 offset:160
    ds_read_b64 v[50:51], v16 offset:192
    ds_read_b64 v[66:67], v16 offset:224
    v_and_b32 v20, 3, v12
    v_cvt_f32_u32 v20, v20
    v_mul_f32 v21, 0xbd000000, v20
    v_cos_f32 v22, v21
    v_sin_f32 v23, v21
    v_mul_f32 v21, 0xbd800000, v20
    v_cos_f32 v24, v21
    v_sin_f32 v25, v21
    v_mul_f32 v21, 0xbdc00000, v20
    v_cos_f32 v26, v21
    v_sin_f32 v27, v21
    v_mul_f32 v21, 0xbe000000, v20
    v_cos_f32 v28, v21
    v_sin_f32 v29, v21
    v_mul_f32 v21, 0xbe200000, v20
    v_cos_f32 v30, v21
    v_sin_f32 v31, v21
    v_mul_f32 v21, 0xbe400000, v20
    v_cos_f32 v32, v21
    v_sin_f32 v33, v21
    v_mul_f32 v21, 0xbe600000, v20
    v_cos_f32 v34, v21
    v_sin_f32 v35, v21
    s_waitcnt lgkmcnt(3)
    v_pk_add_f32 v[64:65], v[46:47], v[54:55]
    v_pk_add_f32 v[82:83], v[46:47], v[54:55] neg_lo:[0,1] neg_hi:[0,1]
    s_waitcnt lgkmcnt(2)
    v_pk_add_f32 v[68:69], v[60:61], v[44:45]
    v_pk_add_f32 v[70:71], v[60:61], v[44:45] neg_lo:[0,1] neg_hi:[0,1]
    s_waitcnt lgkmcnt(1)
    v_pk_add_f32 v[56:57], v[76:77], v[50:51]
    v_pk_add_f32 v[74:75], v[76:77], v[50:51] neg_lo:[0,1] neg_hi:[0,1]
    s_waitcnt lgkmcnt(0)
    v_pk_add_f32 v[48:49], v[52:53], v[66:67]
    v_pk_add_f32 v[72:73], v[52:53], v[66:67] neg_lo:[0,1] neg_hi:[0,1]
    v_pk_add_f32 v[78:79], v[64:65], v[56:57]
    v_pk_add_f32 v[80:81], v[64:65], v[56:57] neg_lo:[0,1] neg_hi:[0,1]
    v_pk_add_f32 v[62:63], v[68:69], v[48:49]
    v_pk_add_f32 v[58:59], v[68:69], v[48:49] neg_lo:[0,1] neg_hi:[0,1]
    v_pk_add_f32 v[46:47], v[78:79], v[62:63]
    v_pk_add_f32 v[54:55], v[78:79], v[62:63] neg_lo:[0,1] neg_hi:[0,1]
    v_pk_add_f32 v[60:61], v[80:81], v[58:59] op_sel:[0,1] op_sel_hi:[1,0] neg_lo:[0,0] neg_hi:[0,1]
    v_pk_add_f32 v[44:45], v[80:81], v[58:59] op_sel:[0,1] op_sel_hi:[1,0] neg_lo:[0,1] neg_hi:[0,0]
    v_pk_add_f32 v[76:77], v[70:71], v[70:71] op_sel:[0,1] op_sel_hi:[1,0] neg_lo:[0,0] neg_hi:[0,1]
    v_pk_add_f32 v[50:51], v[72:73], v[72:73] op_sel:[0,1] op_sel_hi:[1,0] neg_lo:[1,0] neg_hi:[1,1]
    v_pk_add_f32 v[52:53], v[82:83], v[74:75] op_sel:[0,1] op_sel_hi:[1,0] neg_lo:[0,0] neg_hi:[0,1]
    v_pk_add_f32 v[66:67], v[82:83], v[74:75] op_sel:[0,1] op_sel_hi:[1,0] neg_lo:[0,1] neg_hi:[0,0]
    v_pk_add_f32 v[64:65], v[76:77], v[50:51]
    v_pk_add_f32 v[68:69], v[76:77], v[50:51] neg_lo:[0,1] neg_hi:[0,1]
    v_pk_fma_f32 v[56:57], v[64:65], s[78:79], v[52:53] neg_lo:[0,0,0] neg_hi:[0,0,0]
    v_pk_fma_f32 v[48:49], v[64:65], s[78:79], v[52:53] neg_lo:[1,0,0] neg_hi:[1,0,0]
    v_pk_fma_f32 v[78:79], v[68:69], s[78:79], v[66:67] op_sel:[1,0,0] op_sel_hi:[0,1,1] neg_lo:[0,0,0] neg_hi:[1,0,0]
    v_pk_fma_f32 v[80:81], v[68:69], s[78:79], v[66:67] op_sel:[1,0,0] op_sel_hi:[0,1,1] neg_lo:[1,0,0] neg_hi:[0,0,0]
    v_pk_mul_f32 v[62:63], v[56:57], v[22:23] op_sel:[0,0] op_sel_hi:[1,0]
    v_pk_mul_f32 v[58:59], v[60:61], v[24:25] op_sel:[0,0] op_sel_hi:[1,0]
    v_pk_mul_f32 v[82:83], v[78:79], v[26:27] op_sel:[0,0] op_sel_hi:[1,0]
    v_pk_mul_f32 v[70:71], v[54:55], v[28:29] op_sel:[0,0] op_sel_hi:[1,0]
    v_pk_mul_f32 v[74:75], v[48:49], v[30:31] op_sel:[0,0] op_sel_hi:[1,0]
    v_pk_mul_f32 v[72:73], v[44:45], v[32:33] op_sel:[0,0] op_sel_hi:[1,0]
    v_pk_mul_f32 v[76:77], v[80:81], v[34:35] op_sel:[0,0] op_sel_hi:[1,0]
    v_pk_fma_f32 v[62:63], v[56:57], v[22:23], v[62:63] op_sel:[1,1,0] op_sel_hi:[0,1,1] neg_lo:[1,0,0] neg_hi:[0,0,0]
    v_pk_fma_f32 v[58:59], v[60:61], v[24:25], v[58:59] op_sel:[1,1,0] op_sel_hi:[0,1,1] neg_lo:[1,0,0] neg_hi:[0,0,0]
    v_pk_fma_f32 v[82:83], v[78:79], v[26:27], v[82:83] op_sel:[1,1,0] op_sel_hi:[0,1,1] neg_lo:[1,0,0] neg_hi:[0,0,0]
    v_pk_fma_f32 v[70:71], v[54:55], v[28:29], v[70:71] op_sel:[1,1,0] op_sel_hi:[0,1,1] neg_lo:[1,0,0] neg_hi:[0,0,0]
    v_pk_fma_f32 v[74:75], v[48:49], v[30:31], v[74:75] op_sel:[1,1,0] op_sel_hi:[0,1,1] neg_lo:[1,0,0] neg_hi:[0,0,0]
    v_pk_fma_f32 v[72:73], v[44:45], v[32:33], v[72:73] op_sel:[1,1,0] op_sel_hi:[0,1,1] neg_lo:[1,0,0] neg_hi:[0,0,0]
    v_pk_fma_f32 v[76:77], v[80:81], v[34:35], v[76:77] op_sel:[1,1,0] op_sel_hi:[0,1,1] neg_lo:[1,0,0] neg_hi:[0,0,0]
    ds_write_b64 v16, v[46:47] offset:0
    ds_write_b64 v16, v[62:63] offset:32
    ds_write_b64 v16, v[58:59] offset:64
    ds_write_b64 v16, v[82:83] offset:96
    ds_write_b64 v16, v[70:71] offset:128
    ds_write_b64 v16, v[74:75] offset:160
    ds_write_b64 v16, v[72:73] offset:192
    ds_write_b64 v16, v[76:77] offset:224
    ds_read_b64 v[50:51], v17 offset:0
    ds_read_b64 v[52:53], v17 offset:8
    ds_read_b64 v[66:67], v17 offset:16
    ds_read_b64 v[64:65], v17 offset:24
    ds_read_b64 v[68:69], v17 offset:32
    ds_read_b64 v[56:57], v17 offset:40
    ds_read_b64 v[60:61], v17 offset:48
    ds_read_b64 v[78:79], v17 offset:56
    s_waitcnt lgkmcnt(5)
    v_pk_add_f32 v[54:55], v[50:51], v[66:67]
    v_pk_add_f32 v[48:49], v[50:51], v[66:67] neg_lo:[0,1] neg_hi:[0,1]
    s_waitcnt lgkmcnt(4)
    v_pk_add_f32 v[44:45], v[52:53], v[64:65]
    v_pk_add_f32 v[80:81], v[52:53], v[64:65] neg_lo:[0,1] neg_hi:[0,1]
    v_pk_add_f32 v[46:47], v[54:55], v[44:45]
    v_pk_add_f32 v[62:63], v[54:55], v[44:45] neg_lo:[0,1] neg_hi:[0,1]
    v_pk_add_f32 v[58:59], v[48:49], v[80:81] op_sel:[0,1] op_sel_hi:[1,0] neg_lo:[0,0] neg_hi:[0,1]
    v_pk_add_f32 v[82:83], v[48:49], v[80:81] op_sel:[0,1] op_sel_hi:[1,0] neg_lo:[0,1] neg_hi:[0,0]
    s_waitcnt lgkmcnt(1)
    v_pk_add_f32 v[70:71], v[68:69], v[60:61]
    v_pk_add_f32 v[74:75], v[68:69], v[60:61] neg_lo:[0,1] neg_hi:[0,1]
    s_waitcnt lgkmcnt(0)
    v_pk_add_f32 v[72:73], v[56:57], v[78:79]
    v_pk_add_f32 v[76:77], v[56:57], v[78:79] neg_lo:[0,1] neg_hi:[0,1]
    v_pk_add_f32 v[50:51], v[70:71], v[72:73]
    v_pk_add_f32 v[52:53], v[70:71], v[72:73] neg_lo:[0,1] neg_hi:[0,1]
    v_pk_add_f32 v[66:67], v[74:75], v[76:77] op_sel:[0,1] op_sel_hi:[1,0] neg_lo:[0,0] neg_hi:[0,1]
    v_pk_add_f32 v[64:65], v[74:75], v[76:77] op_sel:[0,1] op_sel_hi:[1,0] neg_lo:[0,1] neg_hi:[0,0]
    v_lshlrev_b32 v54, 16, v36
    v_and_b32 v55, 0xffff0000, v36
    v_lshlrev_b32 v48, 16, v37
    v_and_b32 v49, 0xffff0000, v37
    v_lshlrev_b32 v44, 16, v38
    v_and_b32 v45, 0xffff0000, v38
    v_lshlrev_b32 v80, 16, v39
    v_and_b32 v81, 0xffff0000, v39
    v_pk_mul_f32 v[68:69], v[46:47], v[54:55] op_sel:[0,0] op_sel_hi:[1,0]
    v_pk_mul_f32 v[56:57], v[58:59], v[48:49] op_sel:[0,0] op_sel_hi:[1,0]
    v_pk_mul_f32 v[60:61], v[62:63], v[44:45] op_sel:[0,0] op_sel_hi:[1,0]
    v_pk_mul_f32 v[78:79], v[82:83], v[80:81] op_sel:[0,0] op_sel_hi:[1,0]
    v_pk_fma_f32 v[68:69], v[46:47], v[54:55], v[68:69] op_sel:[1,1,0] op_sel_hi:[0,1,1] neg_lo:[1,0,0] neg_hi:[0,0,0]
    v_pk_fma_f32 v[56:57], v[58:59], v[48:49], v[56:57] op_sel:[1,1,0] op_sel_hi:[0,1,1] neg_lo:[1,0,0] neg_hi:[0,0,0]
    v_pk_fma_f32 v[60:61], v[62:63], v[44:45], v[60:61] op_sel:[1,1,0] op_sel_hi:[0,1,1] neg_lo:[1,0,0] neg_hi:[0,0,0]
    v_pk_fma_f32 v[78:79], v[82:83], v[80:81], v[78:79] op_sel:[1,1,0] op_sel_hi:[0,1,1] neg_lo:[1,0,0] neg_hi:[0,0,0]
    v_lshlrev_b32 v70, 16, v40
    v_and_b32 v71, 0xffff0000, v40
    v_lshlrev_b32 v74, 16, v41
    v_and_b32 v75, 0xffff0000, v41
    v_lshlrev_b32 v72, 16, v42
    v_and_b32 v73, 0xffff0000, v42
    v_lshlrev_b32 v76, 16, v43
    v_and_b32 v77, 0xffff0000, v43
    v_pk_mul_f32 v[46:47], v[50:51], v[70:71] op_sel:[0,0] op_sel_hi:[1,0]
    v_pk_mul_f32 v[58:59], v[66:67], v[74:75] op_sel:[0,0] op_sel_hi:[1,0]
    v_pk_mul_f32 v[62:63], v[52:53], v[72:73] op_sel:[0,0] op_sel_hi:[1,0]
    v_pk_mul_f32 v[82:83], v[64:65], v[76:77] op_sel:[0,0] op_sel_hi:[1,0]
    v_pk_fma_f32 v[46:47], v[50:51], v[70:71], v[46:47] op_sel:[1,1,0] op_sel_hi:[0,1,1] neg_lo:[1,0,0] neg_hi:[0,0,0]
    v_pk_fma_f32 v[58:59], v[66:67], v[74:75], v[58:59] op_sel:[1,1,0] op_sel_hi:[0,1,1] neg_lo:[1,0,0] neg_hi:[0,0,0]
    v_pk_fma_f32 v[62:63], v[52:53], v[72:73], v[62:63] op_sel:[1,1,0] op_sel_hi:[0,1,1] neg_lo:[1,0,0] neg_hi:[0,0,0]
    v_pk_fma_f32 v[82:83], v[64:65], v[76:77], v[82:83] op_sel:[1,1,0] op_sel_hi:[0,1,1] neg_lo:[1,0,0] neg_hi:[0,0,0]
    v_pk_add_f32 v[54:55], v[68:69], v[60:61]
    v_pk_add_f32 v[48:49], v[68:69], v[60:61] neg_lo:[0,1] neg_hi:[0,1]
    v_pk_add_f32 v[44:45], v[56:57], v[78:79]
    v_pk_add_f32 v[80:81], v[56:57], v[78:79] neg_lo:[0,1] neg_hi:[0,1]
    v_pk_add_f32 v[50:51], v[54:55], v[44:45]
    v_pk_add_f32 v[66:67], v[54:55], v[44:45] neg_lo:[0,1] neg_hi:[0,1]
    v_pk_add_f32 v[52:53], v[48:49], v[80:81] op_sel:[0,1] op_sel_hi:[1,0] neg_lo:[0,1] neg_hi:[0,0]
    v_pk_add_f32 v[64:65], v[48:49], v[80:81] op_sel:[0,1] op_sel_hi:[1,0] neg_lo:[0,0] neg_hi:[0,1]
    v_pk_add_f32 v[70:71], v[46:47], v[62:63]
    v_pk_add_f32 v[74:75], v[46:47], v[62:63] neg_lo:[0,1] neg_hi:[0,1]
    v_pk_add_f32 v[72:73], v[58:59], v[82:83]
    v_pk_add_f32 v[76:77], v[58:59], v[82:83] neg_lo:[0,1] neg_hi:[0,1]
    v_pk_add_f32 v[68:69], v[70:71], v[72:73]
    v_pk_add_f32 v[56:57], v[70:71], v[72:73] neg_lo:[0,1] neg_hi:[0,1]
    v_pk_add_f32 v[60:61], v[74:75], v[76:77] op_sel:[0,1] op_sel_hi:[1,0] neg_lo:[0,1] neg_hi:[0,0]
    v_pk_add_f32 v[78:79], v[74:75], v[76:77] op_sel:[0,1] op_sel_hi:[1,0] neg_lo:[0,0] neg_hi:[0,1]
    ds_write_b64 v17, v[50:51] offset:0
    ds_write_b64 v17, v[52:53] offset:8
    ds_write_b64 v17, v[66:67] offset:16
    ds_write_b64 v17, v[64:65] offset:24
    ds_write_b64 v17, v[68:69] offset:32
    ds_write_b64 v17, v[60:61] offset:40
    ds_write_b64 v17, v[56:57] offset:48
    ds_write_b64 v17, v[78:79] offset:56
    ds_read_b64 v[54:55], v16 offset:0
    ds_read_b64 v[48:49], v16 offset:32
    ds_read_b64 v[44:45], v16 offset:64
    ds_read_b64 v[80:81], v16 offset:96
    ds_read_b64 v[46:47], v16 offset:128
    ds_read_b64 v[58:59], v16 offset:160
    ds_read_b64 v[62:63], v16 offset:192
    ds_read_b64 v[82:83], v16 offset:224
    s_waitcnt lgkmcnt(6)
    v_pk_mul_f32 v[70:71], v[48:49], v[22:23] op_sel:[0,0] op_sel_hi:[1,0]
    s_waitcnt lgkmcnt(5)
    v_pk_mul_f32 v[74:75], v[44:45], v[24:25] op_sel:[0,0] op_sel_hi:[1,0]
    s_waitcnt lgkmcnt(4)
    v_pk_mul_f32 v[72:73], v[80:81], v[26:27] op_sel:[0,0] op_sel_hi:[1,0]
    s_waitcnt lgkmcnt(3)
    v_pk_mul_f32 v[76:77], v[46:47], v[28:29] op_sel:[0,0] op_sel_hi:[1,0]
    s_waitcnt lgkmcnt(2)
    v_pk_mul_f32 v[50:51], v[58:59], v[30:31] op_sel:[0,0] op_sel_hi:[1,0]
    s_waitcnt lgkmcnt(1)
    v_pk_mul_f32 v[52:53], v[62:63], v[32:33] op_sel:[0,0] op_sel_hi:[1,0]
    s_waitcnt lgkmcnt(0)
    v_pk_mul_f32 v[66:67], v[82:83], v[34:35] op_sel:[0,0] op_sel_hi:[1,0]
    v_pk_fma_f32 v[70:71], v[48:49], v[22:23], v[70:71] op_sel:[1,1,0] op_sel_hi:[0,1,1] neg_lo:[0,0,0] neg_hi:[1,0,0]
    v_pk_fma_f32 v[74:75], v[44:45], v[24:25], v[74:75] op_sel:[1,1,0] op_sel_hi:[0,1,1] neg_lo:[0,0,0] neg_hi:[1,0,0]
    v_pk_fma_f32 v[72:73], v[80:81], v[26:27], v[72:73] op_sel:[1,1,0] op_sel_hi:[0,1,1] neg_lo:[0,0,0] neg_hi:[1,0,0]
    v_pk_fma_f32 v[76:77], v[46:47], v[28:29], v[76:77] op_sel:[1,1,0] op_sel_hi:[0,1,1] neg_lo:[0,0,0] neg_hi:[1,0,0]
    v_pk_fma_f32 v[50:51], v[58:59], v[30:31], v[50:51] op_sel:[1,1,0] op_sel_hi:[0,1,1] neg_lo:[0,0,0] neg_hi:[1,0,0]
    v_pk_fma_f32 v[52:53], v[62:63], v[32:33], v[52:53] op_sel:[1,1,0] op_sel_hi:[0,1,1] neg_lo:[0,0,0] neg_hi:[1,0,0]
    v_pk_fma_f32 v[66:67], v[82:83], v[34:35], v[66:67] op_sel:[1,1,0] op_sel_hi:[0,1,1] neg_lo:[0,0,0] neg_hi:[1,0,0]
    v_pk_add_f32 v[64:65], v[54:55], v[76:77]
    v_pk_add_f32 v[68:69], v[54:55], v[76:77] neg_lo:[0,1] neg_hi:[0,1]
    v_pk_add_f32 v[60:61], v[70:71], v[50:51]
    v_pk_add_f32 v[56:57], v[70:71], v[50:51] neg_lo:[0,1] neg_hi:[0,1]
    v_pk_add_f32 v[78:79], v[74:75], v[52:53]
    v_pk_add_f32 v[48:49], v[74:75], v[52:53] neg_lo:[0,1] neg_hi:[0,1]
    v_pk_add_f32 v[44:45], v[72:73], v[66:67]
    v_pk_add_f32 v[80:81], v[72:73], v[66:67] neg_lo:[0,1] neg_hi:[0,1]
    v_pk_add_f32 v[46:47], v[64:65], v[78:79]
    v_pk_add_f32 v[58:59], v[64:65], v[78:79] neg_lo:[0,1] neg_hi:[0,1]
    v_pk_add_f32 v[62:63], v[60:61], v[44:45]
    v_pk_add_f32 v[82:83], v[60:61], v[44:45] neg_lo:[0,1] neg_hi:[0,1]
    v_pk_add_f32 v[54:55], v[46:47], v[62:63]
    v_pk_add_f32 v[76:77], v[46:47], v[62:63] neg_lo:[0,1] neg_hi:[0,1]
    v_pk_add_f32 v[70:71], v[58:59], v[82:83] op_sel:[0,1] op_sel_hi:[1,0] neg_lo:[0,1] neg_hi:[0,0]
    v_pk_add_f32 v[50:51], v[58:59], v[82:83] op_sel:[0,1] op_sel_hi:[1,0] neg_lo:[0,0] neg_hi:[0,1]
    v_pk_add_f32 v[74:75], v[56:57], v[56:57] op_sel:[0,1] op_sel_hi:[1,0] neg_lo:[0,1] neg_hi:[0,0]
    v_pk_add_f32 v[52:53], v[80:81], v[80:81] op_sel:[0,1] op_sel_hi:[1,0] neg_lo:[1,1] neg_hi:[1,0]
    v_pk_add_f32 v[72:73], v[68:69], v[48:49] op_sel:[0,1] op_sel_hi:[1,0] neg_lo:[0,1] neg_hi:[0,0]
    v_pk_add_f32 v[66:67], v[68:69], v[48:49] op_sel:[0,1] op_sel_hi:[1,0] neg_lo:[0,0] neg_hi:[0,1]
    v_pk_add_f32 v[64:65], v[74:75], v[52:53]
    v_pk_add_f32 v[60:61], v[74:75], v[52:53] neg_lo:[0,1] neg_hi:[0,1]
    v_pk_fma_f32 v[78:79], v[64:65], s[78:79], v[72:73] neg_lo:[0,0,0] neg_hi:[0,0,0]
    v_pk_fma_f32 v[44:45], v[64:65], s[78:79], v[72:73] neg_lo:[1,0,0] neg_hi:[1,0,0]
    v_pk_fma_f32 v[46:47], v[60:61], s[78:79], v[66:67] op_sel:[1,0,0] op_sel_hi:[0,1,1] neg_lo:[1,0,0] neg_hi:[0,0,0]
    v_pk_fma_f32 v[58:59], v[60:61], s[78:79], v[66:67] op_sel:[1,0,0] op_sel_hi:[0,1,1] neg_lo:[0,0,0] neg_hi:[1,0,0]
    ds_write_b64 v16, v[54:55] offset:0
    ds_write_b64 v16, v[78:79] offset:32
    ds_write_b64 v16, v[70:71] offset:64
    ds_write_b64 v16, v[46:47] offset:96
    ds_write_b64 v16, v[76:77] offset:128
    ds_write_b64 v16, v[44:45] offset:160
    ds_write_b64 v16, v[50:51] offset:192
    ds_write_b64 v16, v[58:59] offset:224
    ds_read_b64 v[62:63], v15 offset:0
    ds_read_b64 v[82:83], v15 offset:288
    ds_read_b64 v[68:69], v15 offset:576
    ds_read_b64 v[56:57], v15 offset:864
    ds_read_b64 v[48:49], v15 offset:1152
    ds_read_b64 v[80:81], v15 offset:1440
    ds_read_b64 v[74:75], v15 offset:1728
    ds_read_b64 v[52:53], v15 offset:2016
    v_and_b32 v20, 31, v12
    v_cvt_f32_u32 v20, v20
    v_mul_f32 v21, 0xbb800000, v20
    v_cos_f32 v22, v21
    v_sin_f32 v23, v21
    v_mul_f32 v21, 0xbc000000, v20
    v_cos_f32 v24, v21
    v_sin_f32 v25, v21
    v_mul_f32 v21, 0xbc400000, v20
    v_cos_f32 v26, v21
    v_sin_f32 v27, v21
    v_mul_f32 v21, 0xbc800000, v20
    v_cos_f32 v28, v21
    v_sin_f32 v29, v21
    v_mul_f32 v21, 0xbca00000, v20
    v_cos_f32 v30, v21
    v_sin_f32 v31, v21
    v_mul_f32 v21, 0xbcc00000, v20
    v_cos_f32 v32, v21
    v_sin_f32 v33, v21
    v_mul_f32 v21, 0xbce00000, v20
    v_cos_f32 v34, v21
    v_sin_f32 v35, v21
    s_waitcnt lgkmcnt(6)
    v_pk_mul_f32 v[72:73], v[82:83], v[22:23] op_sel:[0,0] op_sel_hi:[1,0]
    s_waitcnt lgkmcnt(5)
    v_pk_mul_f32 v[66:67], v[68:69], v[24:25] op_sel:[0,0] op_sel_hi:[1,0]
    s_waitcnt lgkmcnt(4)
    v_pk_mul_f32 v[64:65], v[56:57], v[26:27] op_sel:[0,0] op_sel_hi:[1,0]
    s_waitcnt lgkmcnt(3)
    v_pk_mul_f32 v[60:61], v[48:49], v[28:29] op_sel:[0,0] op_sel_hi:[1,0]
    s_waitcnt lgkmcnt(2)
    v_pk_mul_f32 v[54:55], v[80:81], v[30:31] op_sel:[0,0] op_sel_hi:[1,0]
    s_waitcnt lgkmcnt(1)
    v_pk_mul_f32 v[78:79], v[74:75], v[32:33] op_sel:[0,0] op_sel_hi:[1,0]
    s_waitcnt lgkmcnt(0)
    v_pk_mul_f32 v[70:71], v[52:53], v[34:35] op_sel:[0,0] op_sel_hi:[1,0]
    v_pk_fma_f32 v[72:73], v[82:83], v[22:23], v[72:73] op_sel:[1,1,0] op_sel_hi:[0,1,1] neg_lo:[0,0,0] neg_hi:[1,0,0]
    v_pk_fma_f32 v[66:67], v[68:69], v[24:25], v[66:67] op_sel:[1,1,0] op_sel_hi:[0,1,1] neg_lo:[0,0,0] neg_hi:[1,0,0]
    v_pk_fma_f32 v[64:65], v[56:57], v[26:27], v[64:65] op_sel:[1,1,0] op_sel_hi:[0,1,1] neg_lo:[0,0,0] neg_hi:[1,0,0]
    v_pk_fma_f32 v[60:61], v[48:49], v[28:29], v[60:61] op_sel:[1,1,0] op_sel_hi:[0,1,1] neg_lo:[0,0,0] neg_hi:[1,0,0]
    v_pk_fma_f32 v[54:55], v[80:81], v[30:31], v[54:55] op_sel:[1,1,0] op_sel_hi:[0,1,1] neg_lo:[0,0,0] neg_hi:[1,0,0]
    v_pk_fma_f32 v[78:79], v[74:75], v[32:33], v[78:79] op_sel:[1,1,0] op_sel_hi:[0,1,1] neg_lo:[0,0,0] neg_hi:[1,0,0]
    v_pk_fma_f32 v[70:71], v[52:53], v[34:35], v[70:71] op_sel:[1,1,0] op_sel_hi:[0,1,1] neg_lo:[0,0,0] neg_hi:[1,0,0]
    v_pk_add_f32 v[46:47], v[62:63], v[60:61]
    v_pk_add_f32 v[76:77], v[62:63], v[60:61] neg_lo:[0,1] neg_hi:[0,1]
    v_pk_add_f32 v[44:45], v[72:73], v[54:55]
    v_pk_add_f32 v[50:51], v[72:73], v[54:55] neg_lo:[0,1] neg_hi:[0,1]
    v_pk_add_f32 v[58:59], v[66:67], v[78:79]
    v_pk_add_f32 v[82:83], v[66:67], v[78:79] neg_lo:[0,1] neg_hi:[0,1]
    v_pk_add_f32 v[68:69], v[64:65], v[70:71]
    v_pk_add_f32 v[56:57], v[64:65], v[70:71] neg_lo:[0,1] neg_hi:[0,1]
    v_pk_add_f32 v[48:49], v[46:47], v[58:59]
    v_pk_add_f32 v[80:81], v[46:47], v[58:59] neg_lo:[0,1] neg_hi:[0,1]
    v_pk_add_f32 v[74:75], v[44:45], v[68:69]
    v_pk_add_f32 v[52:53], v[44:45], v[68:69] neg_lo:[0,1] neg_hi:[0,1]
    v_pk_add_f32 v[62:63], v[48:49], v[74:75]
    v_pk_add_f32 v[60:61], v[48:49], v[74:75] neg_lo:[0,1] neg_hi:[0,1]
    v_pk_add_f32 v[72:73], v[80:81], v[52:53] op_sel:[0,1] op_sel_hi:[1,0] neg_lo:[0,1] neg_hi:[0,0]
    v_pk_add_f32 v[54:55], v[80:81], v[52:53] op_sel:[0,1] op_sel_hi:[1,0] neg_lo:[0,0] neg_hi:[0,1]
    v_pk_add_f32 v[66:67], v[50:51], v[50:51] op_sel:[0,1] op_sel_hi:[1,0] neg_lo:[0,1] neg_hi:[0,0]
    v_pk_add_f32 v[78:79], v[56:57], v[56:57] op_sel:[0,1] op_sel_hi:[1,0] neg_lo:[1,1] neg_hi:[1,0]
    v_pk_add_f32 v[64:65], v[76:77], v[82:83] op_sel:[0,1] op_sel_hi:[1,0] neg_lo:[0,1] neg_hi:[0,0]
    v_pk_add_f32 v[70:71], v[76:77], v[82:83] op_sel:[0,1] op_sel_hi:[1,0] neg_lo:[0,0] neg_hi:[0,1]
    v_pk_add_f32 v[46:47], v[66:67], v[78:79]
    v_pk_add_f32 v[44:45], v[66:67], v[78:79] neg_lo:[0,1] neg_hi:[0,1]
    v_pk_fma_f32 v[58:59], v[46:47], s[78:79], v[64:65] neg_lo:[0,0,0] neg_hi:[0,0,0]
    v_pk_fma_f32 v[68:69], v[46:47], s[78:79], v[64:65] neg_lo:[1,0,0] neg_hi:[1,0,0]
    v_pk_fma_f32 v[48:49], v[44:45], s[78:79], v[70:71] op_sel:[1,0,0] op_sel_hi:[0,1,1] neg_lo:[1,0,0] neg_hi:[0,0,0]
    v_pk_fma_f32 v[80:81], v[44:45], s[78:79], v[70:71] op_sel:[1,0,0] op_sel_hi:[0,1,1] neg_lo:[0,0,0] neg_hi:[1,0,0]
    ds_write_b64 v15, v[62:63] offset:0
    ds_write_b64 v15, v[58:59] offset:256
    ds_write_b64 v15, v[72:73] offset:512
    ds_write_b64 v15, v[48:49] offset:768
    ds_write_b64 v15, v[60:61] offset:1024
    ds_write_b64 v15, v[68:69] offset:1280
    ds_write_b64 v15, v[54:55] offset:1536
    ds_write_b64 v15, v[80:81] offset:1792
    v_and_b32 v20, 255, v12
    v_cvt_f32_u32 v20, v20
    v_mul_f32 v21, 0xba000000, v20
    v_cos_f32 v22, v21
    v_sin_f32 v23, v21
    v_mul_f32 v21, 0xba800000, v20
    v_cos_f32 v24, v21
    v_sin_f32 v25, v21
    v_mul_f32 v21, 0xbac00000, v20
    v_cos_f32 v26, v21
    v_sin_f32 v27, v21
    v_mul_f32 v21, 0xbb000000, v20
    v_cos_f32 v28, v21
    v_sin_f32 v29, v21
    v_mul_f32 v21, 0xbb200000, v20
    v_cos_f32 v30, v21
    v_sin_f32 v31, v21
    v_mul_f32 v21, 0xbb400000, v20
    v_cos_f32 v32, v21
    v_sin_f32 v33, v21
    v_mul_f32 v21, 0xbb600000, v20
    v_cos_f32 v34, v21
    v_sin_f32 v35, v21
    s_waitcnt lgkmcnt(0)
    s_barrier
    ds_read_b64 v[74:75], v14 offset:0
    ds_read_b64 v[52:53], v14 offset:2304
    ds_read_b64 v[76:77], v14 offset:4608
    ds_read_b64 v[50:51], v14 offset:6912
    ds_read_b64 v[82:83], v14 offset:9216
    ds_read_b64 v[56:57], v14 offset:11520
    ds_read_b64 v[66:67], v14 offset:13824
    ds_read_b64 v[78:79], v14 offset:16128
    s_waitcnt lgkmcnt(6)
    v_pk_mul_f32 v[64:65], v[52:53], v[22:23] op_sel:[0,0] op_sel_hi:[1,0]
    s_waitcnt lgkmcnt(5)
    v_pk_mul_f32 v[70:71], v[76:77], v[24:25] op_sel:[0,0] op_sel_hi:[1,0]
    s_waitcnt lgkmcnt(4)
    v_pk_mul_f32 v[46:47], v[50:51], v[26:27] op_sel:[0,0] op_sel_hi:[1,0]
    s_waitcnt lgkmcnt(3)
    v_pk_mul_f32 v[44:45], v[82:83], v[28:29] op_sel:[0,0] op_sel_hi:[1,0]
    s_waitcnt lgkmcnt(2)
    v_pk_mul_f32 v[62:63], v[56:57], v[30:31] op_sel:[0,0] op_sel_hi:[1,0]
    s_waitcnt lgkmcnt(1)
    v_pk_mul_f32 v[58:59], v[66:67], v[32:33] op_sel:[0,0] op_sel_hi:[1,0]
    s_waitcnt lgkmcnt(0)
    v_pk_mul_f32 v[72:73], v[78:79], v[34:35] op_sel:[0,0] op_sel_hi:[1,0]
    v_pk_fma_f32 v[64:65], v[52:53], v[22:23], v[64:65] op_sel:[1,1,0] op_sel_hi:[0,1,1] neg_lo:[0,0,0] neg_hi:[1,0,0]
    v_pk_fma_f32 v[70:71], v[76:77], v[24:25], v[70:71] op_sel:[1,1,0] op_sel_hi:[0,1,1] neg_lo:[0,0,0] neg_hi:[1,0,0]
    v_pk_fma_f32 v[46:47], v[50:51], v[26:27], v[46:47] op_sel:[1,1,0] op_sel_hi:[0,1,1] neg_lo:[0,0,0] neg_hi:[1,0,0]
    v_pk_fma_f32 v[44:45], v[82:83], v[28:29], v[44:45] op_sel:[1,1,0] op_sel_hi:[0,1,1] neg_lo:[0,0,0] neg_hi:[1,0,0]
    v_pk_fma_f32 v[62:63], v[56:57], v[30:31], v[62:63] op_sel:[1,1,0] op_sel_hi:[0,1,1] neg_lo:[0,0,0] neg_hi:[1,0,0]
    v_pk_fma_f32 v[58:59], v[66:67], v[32:33], v[58:59] op_sel:[1,1,0] op_sel_hi:[0,1,1] neg_lo:[0,0,0] neg_hi:[1,0,0]
    v_pk_fma_f32 v[72:73], v[78:79], v[34:35], v[72:73] op_sel:[1,1,0] op_sel_hi:[0,1,1] neg_lo:[0,0,0] neg_hi:[1,0,0]
    v_pk_add_f32 v[48:49], v[74:75], v[44:45]
    v_pk_add_f32 v[60:61], v[74:75], v[44:45] neg_lo:[0,1] neg_hi:[0,1]
    v_pk_add_f32 v[68:69], v[64:65], v[62:63]
    v_pk_add_f32 v[54:55], v[64:65], v[62:63] neg_lo:[0,1] neg_hi:[0,1]
    v_pk_add_f32 v[80:81], v[70:71], v[58:59]
    v_pk_add_f32 v[52:53], v[70:71], v[58:59] neg_lo:[0,1] neg_hi:[0,1]
    v_pk_add_f32 v[76:77], v[46:47], v[72:73]
    v_pk_add_f32 v[50:51], v[46:47], v[72:73] neg_lo:[0,1] neg_hi:[0,1]
    v_pk_add_f32 v[82:83], v[48:49], v[80:81]
    v_pk_add_f32 v[56:57], v[48:49], v[80:81] neg_lo:[0,1] neg_hi:[0,1]
    v_pk_add_f32 v[66:67], v[68:69], v[76:77]
    v_pk_add_f32 v[78:79], v[68:69], v[76:77] neg_lo:[0,1] neg_hi:[0,1]
    v_pk_add_f32 v[74:75], v[82:83], v[66:67]
    v_pk_add_f32 v[44:45], v[82:83], v[66:67] neg_lo:[0,1] neg_hi:[0,1]
    v_pk_add_f32 v[64:65], v[56:57], v[78:79] op_sel:[0,1] op_sel_hi:[1,0] neg_lo:[0,1] neg_hi:[0,0]
    v_pk_add_f32 v[62:63], v[56:57], v[78:79] op_sel:[0,1] op_sel_hi:[1,0] neg_lo:[0,0] neg_hi:[0,1]
    v_pk_add_f32 v[70:71], v[54:55], v[54:55] op_sel:[0,1] op_sel_hi:[1,0] neg_lo:[0,1] neg_hi:[0,0]
    v_pk_add_f32 v[58:59], v[50:51], v[50:51] op_sel:[0,1] op_sel_hi:[1,0] neg_lo:[1,1] neg_hi:[1,0]
    v_pk_add_f32 v[46:47], v[60:61], v[52:53] op_sel:[0,1] op_sel_hi:[1,0] neg_lo:[0,1] neg_hi:[0,0]
    v_pk_add_f32 v[72:73], v[60:61], v[52:53] op_sel:[0,1] op_sel_hi:[1,0] neg_lo:[0,0] neg_hi:[0,1]
    v_pk_add_f32 v[48:49], v[70:71], v[58:59]
    v_pk_add_f32 v[68:69], v[70:71], v[58:59] neg_lo:[0,1] neg_hi:[0,1]
    v_pk_fma_f32 v[80:81], v[48:49], s[78:79], v[46:47] neg_lo:[0,0,0] neg_hi:[0,0,0]
    v_pk_fma_f32 v[76:77], v[48:49], s[78:79], v[46:47] neg_lo:[1,0,0] neg_hi:[1,0,0]
    v_pk_fma_f32 v[82:83], v[68:69], s[78:79], v[72:73] op_sel:[1,0,0] op_sel_hi:[0,1,1] neg_lo:[1,0,0] neg_hi:[0,0,0]
    v_pk_fma_f32 v[56:57], v[68:69], s[78:79], v[72:73] op_sel:[1,0,0] op_sel_hi:[0,1,1] neg_lo:[0,0,0] neg_hi:[1,0,0]
    v_cvt_pk_bf16_f32 v74, v74, v75
    v_cvt_pk_bf16_f32 v80, v80, v81
    v_cvt_pk_bf16_f32 v64, v64, v65
    v_cvt_pk_bf16_f32 v82, v82, v83
    v_cvt_pk_bf16_f32 v44, v44, v45
    v_cvt_pk_bf16_f32 v76, v76, v77
    v_cvt_pk_bf16_f32 v62, v62, v63
    v_cvt_pk_bf16_f32 v56, v56, v57
    buffer_store_dword v74, v18, s[8:11], s80 offen offset:0 sc1
    buffer_store_dword v80, v18, s[8:11], s80 offen offset:2048 sc1
    s_add_u32 s80, s80, 4096
    buffer_store_dword v64, v18, s[8:11], s80 offen offset:0 sc1
    buffer_store_dword v82, v18, s[8:11], s80 offen offset:2048 sc1
    s_add_u32 s80, s80, 4096
    buffer_store_dword v44, v18, s[8:11], s80 offen offset:0 sc1
    buffer_store_dword v76, v18, s[8:11], s80 offen offset:2048 sc1
    s_add_u32 s80, s80, 4096
    buffer_store_dword v62, v18, s[8:11], s80 offen offset:0 sc1
    buffer_store_dword v56, v18, s[8:11], s80 offen offset:2048 sc1
    s_add_u32 s80, s80, 4096
    s_waitcnt vmcnt(0)
    s_barrier
    s_cmp_lg_u32 s21, 0
    s_cbranch_scc1 M_c_fd
    s_lshl_b32 s28, s72, 13
    s_add_u32 s28, s28, 167842560
    s_lshl_b32 s27, s20, 7
    s_add_u32 s28, s28, s27
    s_mov_b64 exec, 1
    v_mov_b32 v84, s22
    v_mov_b32 v85, 1
    s_cmp_lg_u32 s23, 0
    s_cbranch_scc1 M_ls_5
    buffer_store_byte v85, v84, s[8:11], s28 offen
M_ls_5_r:
    s_cmp_lg_u32 s22, 31
    s_cbranch_scc1 M_c_fe
    s_mov_b64 exec, 0xff
    s_mov_b32 s30, 0
M_c_fl:
    buffer_load_dword v85, v13, s[8:11], s28 offen sc1
    s_add_u32 s30, s30, 1
    s_cmp_ge_u32 s30, 240000
    s_cbranch_scc1 M_fail
    s_waitcnt vmcnt(0)
    v_cmp_ne_u32 vcc, 0x01010101, v85
    s_cbranch_vccnz M_c_fl
    s_mov_b64 exec, 1
    v_mov_b32 v85, 1
    buffer_store_dword v85, v13, s[8:11], s28 offen offset:1024 sc1
M_c_fe:
    s_mov_b64 exec, -1
M_c_fd:
    s_cmp_eq_u32 s44, 128
    s_cbranch_scc1 M_end
    s_branch M_c_disp
M_bulk:
    s_waitcnt vmcnt(0)
    s_barrier
    s_mul_i32 s42, s21, 10240
    s_mul_i32 s47, s101, 3145728
    s_add_u32 s47, s47, s42
    s_add_u32 s47, s47, 29360128
    s_mul_i32 s50, s101, 33554432
    s_lshl_b32 s27, s22, 13
    s_add_u32 s50, s50, s27
    s_add_u32 s50, s50, 37748736
    s_lshl_b32 s43, s101, 6
    s_sub_u32 s82, s20, 2
    s_mov_b32 s83, s21
    s_mov_b32 s84, s22
    s_mov_b32 s85, s23
    s_lshl_b32 s87, s82, 5
    s_add_u32 s87, s87, s22
    s_mul_i32 s86, s101, 8192
    s_mul_i32 s80, s101, 8388608
    s_add_u32 s80, s80, 134217728
    s_load_dwordx2 s[98:99], s[0:1], 80
    s_cmp_ge_u32 s87, 128
    s_cselect_b32 s81, 191, s87
    s_cmp_eq_u32 s87, 159
    s_cselect_b32 s81, 160, s81
    s_waitcnt lgkmcnt(0)
    s_mul_i32 s27, s22, 26
    s_lshr_b32 s27, s27, 8
    s_mul_i32 s28, s27, 10
    s_sub_u32 s88, s22, s28
    s_mul_i32 s28, s20, 3
    s_sub_u32 s28, s28, 8
    s_cmp_lt_u32 s20, 3
    s_cselect_b32 s28, 0, s28
    s_cselect_b32 s29, 1, 3
    s_add_u32 s28, s28, s27
    s_lshl_b32 s89, s28, 2
    s_add_u32 s89, s89, s21
    s_cmp_lt_u32 s27, s29
    s_cselect_b32 s89, s89, 64
    s_cmp_ge_u32 s20, 3
    s_cbranch_scc1 M_qao
    s_lshl_b32 s28, s21, 11
    s_add_u32 s52, s50, s28
    s_add_u32 s52, s52, 16777216
    s_lshl_b32 s28, s21, 10
    s_add_u32 s50, s50, s28
    s_lshl_b32 s51, s22, 8
    s_add_u32 s51, s51, 167854080
    v_lshlrev_b32 v3, 3, v0
    s_mov_b32 s44, 0
    s_mov_b32 s45, 0
    s_mul_i32 s53, s101, 76546048
    s_cmp_lg_u32 s101, 0
    s_cbranch_scc1 M_kv_l1
    s_cmp_lg_u32 s21, 0
    s_cbranch_scc1 M_kx_6
    v_lshlrev_b32 v190, 3, v0
    s_mov_b64 exec, 15
    s_mov_b32 s30, 0
    s_lshl_b32 s27, s101, 13
    s_add_u32 s27, s27, 167911424
M_kx_7:
    buffer_load_dwordx4 v[176:179], v190, s[8:11], s27 offen sc1
    buffer_load_dwordx4 v[180:183], v190, s[8:11], s27 offen offset:16 sc1
    buffer_load_dwordx2 v[184:185], v190, s[8:11], s27 offen offset:32 sc1
    s_add_u32 s30, s30, 1
    s_cmp_ge_u32 s30, 60000
    s_cbranch_scc1 M_fail
    s_waitcnt vmcnt(0)
    v_min3_u32 v176, v176, v177, v178
    v_min3_u32 v176, v176, v179, v180
    v_min3_u32 v176, v176, v181, v182
    v_min3_u32 v176, v176, v183, v184
    v_min_u32 v176, v176, v185
    v_cmp_eq_u32 vcc, 0, v176
    s_cbranch_vccz M_kx_7d
    s_sleep 4
    s_branch M_kx_7
M_kx_7d:
    s_mov_b64 exec, -1
M_kx_6:
    s_barrier
M_kx_8:
    s_branch M_kv_l2
M_kv_l1:
    s_mov_b32 s54, 167956480
    s_cmp_lg_u32 s21, 0
    s_cbranch_scc1 M_kl_9
    s_mov_b64 exec, 0x3ff
    s_mov_b32 s30, 0
    v_lshrrev_b32 v190, 2, v0
M_kl_10:
    buffer_load_dword v191, v190, s[8:11], s54 offen sc1
    s_add_u32 s30, s30, 1
    s_cmp_ge_u32 s30, 60000
    s_cbranch_scc1 M_fail
    s_waitcnt vmcnt(0)
    v_cmp_ne_u32 vcc, 0x01010101, v191
    s_cbranch_vccz M_kl_10d
    s_sleep 1
    s_branch M_kl_10
M_kl_10d:
    s_mov_b64 exec, -1
M_kl_9:
    s_barrier
M_kv_l2:
    s_min_u32 s27, s44, 63
    s_mul_i32 s27, s27, 40960
    s_add_u32 s27, s27, s47
    s_cmp_lt_u32 s44, 4
    s_cselect_b32 s28, s53, 0
    s_add_u32 s27, s27, s28
    s_add_u32 s28, s45, s42
    s_mov_b32 m0, s28
    s_nop 0
    buffer_load_dwordx4 v0, s[8:11], s27 offen offset:0 sc1 lds
    buffer_load_dwordx4 v0, s[8:11], s27 offen offset:1024 sc1 lds
    buffer_load_dwordx4 v0, s[8:11], s27 offen offset:2048 sc1 lds
    buffer_load_dwordx4 v0, s[8:11], s27 offen offset:3072 sc1 lds
    s_add_u32 s27, s27, 4096
    s_add_u32 s28, s28, 4096
    s_mov_b32 m0, s28
    s_nop 0
    buffer_load_dwordx4 v0, s[8:11], s27 offen offset:0 sc1 lds
    buffer_load_dwordx4 v0, s[8:11], s27 offen offset:1024 sc1 lds
    buffer_load_dwordx4 v0, s[8:11], s27 offen offset:2048 sc1 lds
    buffer_load_dwordx4 v0, s[8:11], s27 offen offset:3072 sc1 lds
    s_add_u32 s27, s27, 4096
    s_add_u32 s28, s28, 4096
    s_mov_b32 m0, s28
    s_nop 0
    buffer_load_dwordx4 v0, s[8:11], s27 offen offset:0 sc1 lds
    buffer_load_dwordx4 v0, s[8:11], s27 offen offset:1024 sc1 lds
    s_lshl_b32 s55, s89, 7
    s_lshl_b32 s27, s88, 2
    s_add_u32 s55, s55, s27
    s_add_u32 s55, s55, 167919616
    s_cmp_lt_u32 s89, 64
    s_cselect_b32 s27, s101, 0
    s_cmp_lg_u32 s27, 0
    s_cselect_b32 s55, s55, 0x10000000
    s_cbranch_scc1 M_kv_d1
    s_waitcnt vmcnt(0)
    s_barrier
    s_branch M_kv_d2
M_kv_d1:
    s_waitcnt vmcnt(0)
    s_barrier
    v_bfe_u32 v5, v0, 4, 4
    v_mul_u32_u24 v5, 1280, v5
    v_lshrrev_b32 v6, 8, v0
    v_lshl_add_u32 v5, v6, 4, v5
    buffer_store_dwordx4 v[12:15], v0, s[8:11], s68 offen offset:0 sc1
    buffer_store_dwordx4 v[104:107], v5, s[16:19], s70 offen offset:0 sc1
    buffer_store_dwordx4 v[16:19], v0, s[8:11], s68 offen offset:1024 sc1
    buffer_store_dwordx4 v[108:111], v5, s[16:19], s70 offen offset:64 sc1
    buffer_store_dwordx4 v[28:31], v0, s[8:11], s69 offen offset:0 sc1
    buffer_store_dwordx4 v[112:115], v5, s[16:19], s71 offen offset:0 sc1
    buffer_store_dwordx4 v[32:35], v0, s[8:11], s69 offen offset:1024 sc1
    buffer_store_dwordx4 v[116:119], v5, s[16:19], s71 offen offset:64 sc1
M_kv_d2:
    v_mov_b32 v6, 1
    v_mov_b32 v1, v0
    ds_read_b128 v[56:59], v1 offset:0
    ds_read_b128 v[60:63], v1 offset:1024
    ds_read_b128 v[64:67], v1 offset:2048
    ds_read_b128 v[68:71], v1 offset:3072
M_kv_top:
    s_add_u32 s27, s44, s43
    v_mov_b32 v2, s27
    s_sub_u32 s45, 40960, s45
    s_add_u32 s44, s44, 1
    v_add_u32 v4, s45, v0
    ds_read_b128 v[72:75], v1 offset:4096
    s_waitcnt lgkmcnt(4)
    v_mfma_f32_16x16x32_bf16 v[8:11], a[0:3], v[56:59], 0
    v_mfma_f32_16x16x32_bf16 v[24:27], v[56:59], a[160:163], 0
    v_mfma_f32_16x16x32_bf16 v[12:15], a[80:83], v[56:59], 0
    v_mfma_f32_16x16x32_bf16 v[28:31], v[56:59], a[240:243], 0
    ds_read_b128 v[56:59], v1 offset:5120
    s_waitcnt lgkmcnt(4)
    v_mfma_f32_16x16x32_bf16 v[8:11], a[4:7], v[60:63], v[8:11]
    v_mfma_f32_16x16x32_bf16 v[24:27], v[60:63], a[164:167], v[24:27]
    v_mfma_f32_16x16x32_bf16 v[12:15], a[84:87], v[60:63], v[12:15]
    v_mfma_f32_16x16x32_bf16 v[28:31], v[60:63], a[244:247], v[28:31]
    s_min_u32 s27, s44, 63
    s_mul_i32 s27, s27, 40960
    s_add_u32 s27, s27, s47
    s_cmp_lt_u32 s44, 4
    s_cselect_b32 s28, s53, 0
    s_add_u32 s27, s27, s28
    s_add_u32 s28, s45, s42
    s_mov_b32 m0, s28
    s_nop 0
    buffer_load_dwordx4 v0, s[8:11], s27 offen offset:0 sc1 lds
    buffer_load_dwordx4 v0, s[8:11], s27 offen offset:1024 sc1 lds
    ds_read_b128 v[60:63], v1 offset:6144
    s_waitcnt lgkmcnt(4)
    v_mfma_f32_16x16x32_bf16 v[8:11], a[8:11], v[64:67], v[8:11]
    v_mfma_f32_16x16x32_bf16 v[24:27], v[64:67], a[168:171], v[24:27]
    v_mfma_f32_16x16x32_bf16 v[12:15], a[88:91], v[64:67], v[12:15]
    v_mfma_f32_16x16x32_bf16 v[28:31], v[64:67], a[248:251], v[28:31]
    ds_read_b128 v[64:67], v1 offset:7168
    s_waitcnt lgkmcnt(4)
    v_mfma_f32_16x16x32_bf16 v[8:11], a[12:15], v[68:71], v[8:11]
    v_mfma_f32_16x16x32_bf16 v[24:27], v[68:71], a[172:175], v[24:27]
    v_mfma_f32_16x16x32_bf16 v[12:15], a[92:95], v[68:71], v[12:15]
    v_mfma_f32_16x16x32_bf16 v[28:31], v[68:71], a[252:255], v[28:31]
    ds_read_b128 v[68:71], v1 offset:8192
    s_waitcnt lgkmcnt(4)
    v_mfma_f32_16x16x32_bf16 v[8:11], a[16:19], v[72:75], v[8:11]
    v_mfma_f32_16x16x32_bf16 v[24:27], v[72:75], a[176:179], v[24:27]
    v_mfma_f32_16x16x32_bf16 v[12:15], a[96:99], v[72:75], v[12:15]
    v_mfma_f32_16x16x32_bf16 v[28:31], v[72:75], v[192:195], v[28:31]
    ds_read_b128 v[72:75], v1 offset:9216
    s_waitcnt lgkmcnt(4)
    v_mfma_f32_16x16x32_bf16 v[8:11], a[20:23], v[56:59], v[8:11]
    v_mfma_f32_16x16x32_bf16 v[24:27], v[56:59], a[180:183], v[24:27]
    v_mfma_f32_16x16x32_bf16 v[12:15], a[100:103], v[56:59], v[12:15]
    v_mfma_f32_16x16x32_bf16 v[28:31], v[56:59], v[196:199], v[28:31]
    buffer_load_dwordx4 v0, s[8:11], s27 offen offset:2048 sc1 lds
    buffer_load_dwordx4 v0, s[8:11], s27 offen offset:3072 sc1 lds
    ds_read_b128 v[56:59], v1 offset:10240
    s_waitcnt lgkmcnt(4)
    v_mfma_f32_16x16x32_bf16 v[8:11], a[24:27], v[60:63], v[8:11]
    v_mfma_f32_16x16x32_bf16 v[24:27], v[60:63], a[184:187], v[24:27]
    v_mfma_f32_16x16x32_bf16 v[12:15], a[104:107], v[60:63], v[12:15]
    v_mfma_f32_16x16x32_bf16 v[28:31], v[60:63], v[200:203], v[28:31]
    ds_read_b128 v[60:63], v1 offset:11264
    s_waitcnt lgkmcnt(4)
    v_mfma_f32_16x16x32_bf16 v[8:11], a[28:31], v[64:67], v[8:11]
    v_mfma_f32_16x16x32_bf16 v[24:27], v[64:67], a[188:191], v[24:27]
    v_mfma_f32_16x16x32_bf16 v[12:15], a[108:111], v[64:67], v[12:15]
    v_mfma_f32_16x16x32_bf16 v[28:31], v[64:67], v[204:207], v[28:31]
    ds_read_b128 v[64:67], v1 offset:12288
    s_waitcnt lgkmcnt(4)
    v_mfma_f32_16x16x32_bf16 v[8:11], a[32:35], v[68:71], v[8:11]
    v_mfma_f32_16x16x32_bf16 v[24:27], v[68:71], a[192:195], v[24:27]
    v_mfma_f32_16x16x32_bf16 v[12:15], a[112:115], v[68:71], v[12:15]
    v_mfma_f32_16x16x32_bf16 v[28:31], v[68:71], v[208:211], v[28:31]
    ds_read_b128 v[68:71], v1 offset:13312
    s_waitcnt lgkmcnt(4)
    v_mfma_f32_16x16x32_bf16 v[8:11], a[36:39], v[72:75], v[8:11]
    v_mfma_f32_16x16x32_bf16 v[24:27], v[72:75], a[196:199], v[24:27]
    v_mfma_f32_16x16x32_bf16 v[12:15], a[116:119], v[72:75], v[12:15]
    v_mfma_f32_16x16x32_bf16 v[28:31], v[72:75], v[212:215], v[28:31]
    s_waitcnt vmcnt(4)
    s_barrier
    s_cmp_lg_u32 s21, 0
    s_cbranch_scc1 M_kv_f0
    s_mov_b64 exec, 3
    buffer_store_dword v2, v3, s[8:11], s51 offen sc1
    s_mov_b64 exec, -1
M_kv_f0:
    s_mov_b64 exec, 1
    buffer_store_dword v6, v0, s[8:11], s55 offen sc1
    s_mov_b64 exec, -1
    s_mov_b32 s55, 0x10000000
    s_add_u32 s27, s27, 4096
    s_add_u32 s28, s28, 4096
    s_mov_b32 m0, s28
    s_nop 0
    buffer_load_dwordx4 v0, s[8:11], s27 offen offset:0 sc1 lds
    buffer_load_dwordx4 v0, s[8:11], s27 offen offset:1024 sc1 lds
    ds_read_b128 v[72:75], v1 offset:14336
    s_waitcnt lgkmcnt(4)
    v_mfma_f32_16x16x32_bf16 v[8:11], a[40:43], v[56:59], v[8:11]
    v_mfma_f32_16x16x32_bf16 v[24:27], v[56:59], a[200:203], v[24:27]
    v_mfma_f32_16x16x32_bf16 v[12:15], a[120:123], v[56:59], v[12:15]
    v_mfma_f32_16x16x32_bf16 v[28:31], v[56:59], v[216:219], v[28:31]
    ds_read_b128 v[56:59], v1 offset:15360
    s_waitcnt lgkmcnt(4)
    v_mfma_f32_16x16x32_bf16 v[8:11], a[44:47], v[60:63], v[8:11]
    v_mfma_f32_16x16x32_bf16 v[24:27], v[60:63], a[204:207], v[24:27]
    v_mfma_f32_16x16x32_bf16 v[12:15], a[124:127], v[60:63], v[12:15]
    v_mfma_f32_16x16x32_bf16 v[28:31], v[60:63], v[220:223], v[28:31]
    ds_read_b128 v[60:63], v1 offset:16384
    s_waitcnt lgkmcnt(4)
    v_mfma_f32_16x16x32_bf16 v[8:11], a[48:51], v[64:67], v[8:11]
    v_mfma_f32_16x16x32_bf16 v[24:27], v[64:67], a[208:211], v[24:27]
    v_mfma_f32_16x16x32_bf16 v[12:15], a[128:131], v[64:67], v[12:15]
    v_mfma_f32_16x16x32_bf16 v[28:31], v[64:67], v[224:227], v[28:31]
    ds_read_b128 v[64:67], v1 offset:17408
    s_waitcnt lgkmcnt(4)
    v_mfma_f32_16x16x32_bf16 v[8:11], a[52:55], v[68:71], v[8:11]
    v_mfma_f32_16x16x32_bf16 v[24:27], v[68:71], a[212:215], v[24:27]
    v_mfma_f32_16x16x32_bf16 v[12:15], a[132:135], v[68:71], v[12:15]
    v_mfma_f32_16x16x32_bf16 v[28:31], v[68:71], v[228:231], v[28:31]
    buffer_load_dwordx4 v0, s[8:11], s27 offen offset:2048 sc1 lds
    buffer_load_dwordx4 v0, s[8:11], s27 offen offset:3072 sc1 lds
    ds_read_b128 v[68:71], v1 offset:18432
    s_waitcnt lgkmcnt(4)
    v_mfma_f32_16x16x32_bf16 v[8:11], a[56:59], v[72:75], v[8:11]
    v_mfma_f32_16x16x32_bf16 v[24:27], v[72:75], a[216:219], v[24:27]
    v_mfma_f32_16x16x32_bf16 v[12:15], a[136:139], v[72:75], v[12:15]
    v_mfma_f32_16x16x32_bf16 v[28:31], v[72:75], v[232:235], v[28:31]
    ds_read_b128 v[72:75], v1 offset:19456
    s_waitcnt lgkmcnt(4)
    v_mfma_f32_16x16x32_bf16 v[8:11], a[60:63], v[56:59], v[8:11]
    v_mfma_f32_16x16x32_bf16 v[24:27], v[56:59], a[220:223], v[24:27]
    v_mfma_f32_16x16x32_bf16 v[12:15], a[140:143], v[56:59], v[12:15]
    v_mfma_f32_16x16x32_bf16 v[28:31], v[56:59], v[236:239], v[28:31]
    ds_read_b128 v[56:59], v1 offset:20480
    s_waitcnt lgkmcnt(4)
    v_mfma_f32_16x16x32_bf16 v[8:11], a[64:67], v[60:63], v[8:11]
    v_mfma_f32_16x16x32_bf16 v[24:27], v[60:63], a[224:227], v[24:27]
    v_mfma_f32_16x16x32_bf16 v[12:15], a[144:147], v[60:63], v[12:15]
    v_mfma_f32_16x16x32_bf16 v[28:31], v[60:63], v[240:243], v[28:31]
    ds_read_b128 v[60:63], v1 offset:21504
    s_waitcnt lgkmcnt(4)
    v_mfma_f32_16x16x32_bf16 v[8:11], a[68:71], v[64:67], v[8:11]
    v_mfma_f32_16x16x32_bf16 v[24:27], v[64:67], a[228:231], v[24:27]
    v_mfma_f32_16x16x32_bf16 v[12:15], a[148:151], v[64:67], v[12:15]
    v_mfma_f32_16x16x32_bf16 v[28:31], v[64:67], v[244:247], v[28:31]
    s_add_u32 s27, s27, 4096
    s_add_u32 s28, s28, 4096
    s_mov_b32 m0, s28
    s_nop 0
    buffer_load_dwordx4 v0, s[8:11], s27 offen offset:0 sc1 lds
    buffer_load_dwordx4 v0, s[8:11], s27 offen offset:1024 sc1 lds
    ds_read_b128 v[64:67], v1 offset:22528
    s_waitcnt lgkmcnt(4)
    v_mfma_f32_16x16x32_bf16 v[8:11], a[72:75], v[68:71], v[8:11]
    v_mfma_f32_16x16x32_bf16 v[24:27], v[68:71], a[232:235], v[24:27]
    v_mfma_f32_16x16x32_bf16 v[12:15], a[152:155], v[68:71], v[12:15]
    v_mfma_f32_16x16x32_bf16 v[28:31], v[68:71], v[248:251], v[28:31]
    ds_read_b128 v[68:71], v1 offset:23552
    s_waitcnt lgkmcnt(4)
    v_mfma_f32_16x16x32_bf16 v[8:11], a[76:79], v[72:75], v[8:11]
    v_mfma_f32_16x16x32_bf16 v[24:27], v[72:75], a[236:239], v[24:27]
    v_mfma_f32_16x16x32_bf16 v[12:15], a[156:159], v[72:75], v[12:15]
    v_mfma_f32_16x16x32_bf16 v[28:31], v[72:75], v[252:255], v[28:31]
    ds_read_b128 v[72:75], v1 offset:24576
    s_waitcnt lgkmcnt(4)
    v_mfma_f32_16x16x32_bf16 v[16:19], a[0:3], v[56:59], 0
    v_mfma_f32_16x16x32_bf16 v[32:35], v[56:59], a[160:163], 0
    v_mfma_f32_16x16x32_bf16 v[20:23], a[80:83], v[56:59], 0
    v_mfma_f32_16x16x32_bf16 v[36:39], v[56:59], a[240:243], 0
    ds_read_b128 v[56:59], v1 offset:25600
    s_waitcnt lgkmcnt(4)
    v_mfma_f32_16x16x32_bf16 v[16:19], a[4:7], v[60:63], v[16:19]
    v_mfma_f32_16x16x32_bf16 v[32:35], v[60:63], a[164:167], v[32:35]
    v_mfma_f32_16x16x32_bf16 v[20:23], a[84:87], v[60:63], v[20:23]
    v_mfma_f32_16x16x32_bf16 v[36:39], v[60:63], a[244:247], v[36:39]
    ds_read_b128 v[60:63], v1 offset:26624
    s_waitcnt lgkmcnt(4)
    v_mfma_f32_16x16x32_bf16 v[16:19], a[8:11], v[64:67], v[16:19]
    v_cvt_pk_bf16_f32 v40, v8, v12
    v_mfma_f32_16x16x32_bf16 v[32:35], v[64:67], a[168:171], v[32:35]
    v_mfma_f32_16x16x32_bf16 v[20:23], a[88:91], v[64:67], v[20:23]
    v_cvt_pk_bf16_f32 v41, v9, v13
    v_mfma_f32_16x16x32_bf16 v[36:39], v[64:67], a[248:251], v[36:39]
    ds_read_b128 v[64:67], v1 offset:27648
    s_waitcnt lgkmcnt(4)
    v_mfma_f32_16x16x32_bf16 v[16:19], a[12:15], v[68:71], v[16:19]
    v_cvt_pk_bf16_f32 v42, v10, v14
    v_mfma_f32_16x16x32_bf16 v[32:35], v[68:71], a[172:175], v[32:35]
    v_mfma_f32_16x16x32_bf16 v[20:23], a[92:95], v[68:71], v[20:23]
    v_cvt_pk_bf16_f32 v43, v11, v15
    v_mfma_f32_16x16x32_bf16 v[36:39], v[68:71], a[252:255], v[36:39]
    ds_read_b128 v[68:71], v1 offset:28672
    s_waitcnt lgkmcnt(4)
    v_mfma_f32_16x16x32_bf16 v[16:19], a[16:19], v[72:75], v[16:19]
    v_cvt_pk_bf16_f32 v48, v24, v25
    v_mfma_f32_16x16x32_bf16 v[32:35], v[72:75], a[176:179], v[32:35]
    v_mfma_f32_16x16x32_bf16 v[20:23], a[96:99], v[72:75], v[20:23]
    v_cvt_pk_bf16_f32 v49, v26, v27
    v_mfma_f32_16x16x32_bf16 v[36:39], v[72:75], v[192:195], v[36:39]
    ds_read_b128 v[72:75], v1 offset:29696
    s_waitcnt lgkmcnt(4)
    v_mfma_f32_16x16x32_bf16 v[16:19], a[20:23], v[56:59], v[16:19]
    v_cvt_pk_bf16_f32 v52, v28, v29
    v_mfma_f32_16x16x32_bf16 v[32:35], v[56:59], a[180:183], v[32:35]
    v_mfma_f32_16x16x32_bf16 v[20:23], a[100:103], v[56:59], v[20:23]
    v_cvt_pk_bf16_f32 v53, v30, v31
    v_mfma_f32_16x16x32_bf16 v[36:39], v[56:59], v[196:199], v[36:39]
    ds_read_b128 v[56:59], v1 offset:30720
    s_waitcnt lgkmcnt(4)
    v_mfma_f32_16x16x32_bf16 v[16:19], a[24:27], v[60:63], v[16:19]
    v_mfma_f32_16x16x32_bf16 v[32:35], v[60:63], a[184:187], v[32:35]
    v_mfma_f32_16x16x32_bf16 v[20:23], a[104:107], v[60:63], v[20:23]
    v_mfma_f32_16x16x32_bf16 v[36:39], v[60:63], v[200:203], v[36:39]
    ds_read_b128 v[60:63], v1 offset:31744
    s_waitcnt lgkmcnt(4)
    v_mfma_f32_16x16x32_bf16 v[16:19], a[28:31], v[64:67], v[16:19]
    v_mfma_f32_16x16x32_bf16 v[32:35], v[64:67], a[188:191], v[32:35]
    v_mfma_f32_16x16x32_bf16 v[20:23], a[108:111], v[64:67], v[20:23]
    v_mfma_f32_16x16x32_bf16 v[36:39], v[64:67], v[204:207], v[36:39]
    ds_read_b128 v[64:67], v1 offset:32768
    s_waitcnt lgkmcnt(4)
    v_mfma_f32_16x16x32_bf16 v[16:19], a[32:35], v[68:71], v[16:19]
    v_mfma_f32_16x16x32_bf16 v[32:35], v[68:71], a[192:195], v[32:35]
    v_mfma_f32_16x16x32_bf16 v[20:23], a[112:115], v[68:71], v[20:23]
    v_mfma_f32_16x16x32_bf16 v[36:39], v[68:71], v[208:211], v[36:39]
    ds_read_b128 v[68:71], v1 offset:33792
    s_waitcnt lgkmcnt(4)
    v_mfma_f32_16x16x32_bf16 v[16:19], a[36:39], v[72:75], v[16:19]
    v_mfma_f32_16x16x32_bf16 v[32:35], v[72:75], a[196:199], v[32:35]
    v_mfma_f32_16x16x32_bf16 v[20:23], a[116:119], v[72:75], v[20:23]
    v_mfma_f32_16x16x32_bf16 v[36:39], v[72:75], v[212:215], v[36:39]
    ds_read_b128 v[72:75], v1 offset:34816
    s_waitcnt lgkmcnt(4)
    v_mfma_f32_16x16x32_bf16 v[16:19], a[40:43], v[56:59], v[16:19]
    v_mfma_f32_16x16x32_bf16 v[32:35], v[56:59], a[200:203], v[32:35]
    v_mfma_f32_16x16x32_bf16 v[20:23], a[120:123], v[56:59], v[20:23]
    v_mfma_f32_16x16x32_bf16 v[36:39], v[56:59], v[216:219], v[36:39]
    ds_read_b128 v[56:59], v1 offset:35840
    s_waitcnt lgkmcnt(4)
    v_mfma_f32_16x16x32_bf16 v[16:19], a[44:47], v[60:63], v[16:19]
    v_mfma_f32_16x16x32_bf16 v[32:35], v[60:63], a[204:207], v[32:35]
    v_mfma_f32_16x16x32_bf16 v[20:23], a[124:127], v[60:63], v[20:23]
    v_mfma_f32_16x16x32_bf16 v[36:39], v[60:63], v[220:223], v[36:39]
    ds_read_b128 v[60:63], v1 offset:36864
    s_waitcnt lgkmcnt(4)
    v_mfma_f32_16x16x32_bf16 v[16:19], a[48:51], v[64:67], v[16:19]
    v_mfma_f32_16x16x32_bf16 v[32:35], v[64:67], a[208:211], v[32:35]
    v_mfma_f32_16x16x32_bf16 v[20:23], a[128:131], v[64:67], v[20:23]
    v_mfma_f32_16x16x32_bf16 v[36:39], v[64:67], v[224:227], v[36:39]
    ds_read_b128 v[64:67], v1 offset:37888
    s_waitcnt lgkmcnt(4)
    v_mfma_f32_16x16x32_bf16 v[16:19], a[52:55], v[68:71], v[16:19]
    v_mfma_f32_16x16x32_bf16 v[32:35], v[68:71], a[212:215], v[32:35]
    v_mfma_f32_16x16x32_bf16 v[20:23], a[132:135], v[68:71], v[20:23]
    v_mfma_f32_16x16x32_bf16 v[36:39], v[68:71], v[228:231], v[36:39]
    ds_read_b128 v[68:71], v1 offset:38912
    s_waitcnt lgkmcnt(4)
    v_mfma_f32_16x16x32_bf16 v[16:19], a[56:59], v[72:75], v[16:19]
    v_mfma_f32_16x16x32_bf16 v[32:35], v[72:75], a[216:219], v[32:35]
    v_mfma_f32_16x16x32_bf16 v[20:23], a[136:139], v[72:75], v[20:23]
    v_mfma_f32_16x16x32_bf16 v[36:39], v[72:75], v[232:235], v[36:39]
    ds_read_b128 v[72:75], v1 offset:39936
    s_waitcnt lgkmcnt(4)
    v_mfma_f32_16x16x32_bf16 v[16:19], a[60:63], v[56:59], v[16:19]
    v_mfma_f32_16x16x32_bf16 v[32:35], v[56:59], a[220:223], v[32:35]
    v_mfma_f32_16x16x32_bf16 v[20:23], a[140:143], v[56:59], v[20:23]
    v_mfma_f32_16x16x32_bf16 v[36:39], v[56:59], v[236:239], v[36:39]
    s_waitcnt vmcnt(0)
    s_barrier
    ds_read_b128 v[56:59], v4 offset:0
    s_waitcnt lgkmcnt(4)
    v_mfma_f32_16x16x32_bf16 v[16:19], a[64:67], v[60:63], v[16:19]
    v_mfma_f32_16x16x32_bf16 v[32:35], v[60:63], a[224:227], v[32:35]
    v_mfma_f32_16x16x32_bf16 v[20:23], a[144:147], v[60:63], v[20:23]
    v_mfma_f32_16x16x32_bf16 v[36:39], v[60:63], v[240:243], v[36:39]
    ds_read_b128 v[60:63], v4 offset:1024
    s_waitcnt lgkmcnt(4)
    v_mfma_f32_16x16x32_bf16 v[16:19], a[68:71], v[64:67], v[16:19]
    v_mfma_f32_16x16x32_bf16 v[32:35], v[64:67], a[228:231], v[32:35]
    v_mfma_f32_16x16x32_bf16 v[20:23], a[148:151], v[64:67], v[20:23]
    v_mfma_f32_16x16x32_bf16 v[36:39], v[64:67], v[244:247], v[36:39]
    ds_read_b128 v[64:67], v4 offset:2048
    s_waitcnt lgkmcnt(4)
    v_mfma_f32_16x16x32_bf16 v[16:19], a[72:75], v[68:71], v[16:19]
    v_mfma_f32_16x16x32_bf16 v[32:35], v[68:71], a[232:235], v[32:35]
    v_mfma_f32_16x16x32_bf16 v[20:23], a[152:155], v[68:71], v[20:23]
    v_mfma_f32_16x16x32_bf16 v[36:39], v[68:71], v[248:251], v[36:39]
    ds_read_b128 v[68:71], v4 offset:3072
    s_waitcnt lgkmcnt(4)
    v_mfma_f32_16x16x32_bf16 v[16:19], a[76:79], v[72:75], v[16:19]
    v_mfma_f32_16x16x32_bf16 v[32:35], v[72:75], a[236:239], v[32:35]
    v_mfma_f32_16x16x32_bf16 v[20:23], a[156:159], v[72:75], v[20:23]
    v_mfma_f32_16x16x32_bf16 v[36:39], v[72:75], v[252:255], v[36:39]
    s_add_u32 s27, s50, 4096
    v_mov_b32 v1, v4
    buffer_store_dwordx4 v[40:43], v0, s[8:11], s50 offen sc1
    s_nop 3
    v_cvt_pk_bf16_f32 v44, v16, v20
    v_cvt_pk_bf16_f32 v45, v17, v21
    v_cvt_pk_bf16_f32 v46, v18, v22
    v_cvt_pk_bf16_f32 v47, v19, v23
    v_cvt_pk_bf16_f32 v50, v32, v33
    v_cvt_pk_bf16_f32 v51, v34, v35
    v_cvt_pk_bf16_f32 v54, v36, v37
    v_cvt_pk_bf16_f32 v55, v38, v39
    buffer_store_dwordx4 v[44:47], v0, s[8:11], s27 offen sc1
    buffer_store_dwordx4 v[48:51], v0, s[8:11], s52 offen offset:0 sc1
    buffer_store_dwordx4 v[52:55], v0, s[8:11], s52 offen offset:1024 sc1
    s_add_u32 s50, s50, 262144
    s_add_u32 s52, s52, 262144
    s_barrier
    s_cmp_lg_u32 s44, 3
    s_cbranch_scc1 M_kv_np
    s_cmp_lg_u32 s21, 0
    s_cbranch_scc1 M_kx_11
    v_lshlrev_b32 v190, 3, v0
    s_mov_b64 exec, -1
    s_mov_b32 s30, 0
    s_lshl_b32 s27, s101, 13
    s_add_u32 s27, s27, 167911424
M_kx_12:
    buffer_load_dwordx4 v[176:179], v190, s[8:11], s27 offen sc1
    buffer_load_dwordx4 v[180:183], v190, s[8:11], s27 offen offset:16 sc1
    buffer_load_dwordx2 v[184:185], v190, s[8:11], s27 offen offset:32 sc1
    s_add_u32 s30, s30, 1
    s_cmp_ge_u32 s30, 60000
    s_cbranch_scc1 M_fail
    s_waitcnt vmcnt(0)
    v_min3_u32 v176, v176, v177, v178
    v_min3_u32 v176, v176, v179, v180
    v_min3_u32 v176, v176, v181, v182
    v_min3_u32 v176, v176, v183, v184
    v_min_u32 v176, v176, v185
    v_cmp_eq_u32 vcc, 0, v176
    s_cbranch_vccz M_kx_12d
    s_sleep 4
    s_branch M_kx_12
M_kx_12d:
    s_mov_b64 exec, -1
M_kx_11:
    s_barrier
M_kx_13:
M_kv_np:
    s_cmp_lt_u32 s44, 64
    s_cbranch_scc1 M_kv_top
    s_add_u32 s27, s44, s43
    v_mov_b32 v2, s27
    s_waitcnt vmcnt(0) lgkmcnt(0)
    s_barrier
    s_cmp_lg_u32 s21, 0
    s_cbranch_scc1 M_kv_f2
    s_mov_b64 exec, 3
    buffer_store_dword v2, v3, s[8:11], s51 offen sc1
    s_mov_b64 exec, -1
M_kv_f2:
    s_branch M_bphase
M_qao:
    s_cmp_lg_u32 s101, 0
    s_cbranch_scc1 M_q_ft
    v_lshrrev_b32 v1, 4, v0
    v_lshrrev_b32 v3, 8, v0
    v_and_b32 v4, 15, v1
    v_mov_b32 v5, v0
    s_min_u32 s36, s22, 19
    s_mul_i32 s36, s36, 40
    s_mul_i32 s27, s21, 10
    s_add_u32 s36, s36, s27
    s_add_u32 s35, s36, 10
    s_add_u32 s27, s42, 122880
    v_add_u32 v2, s27, v0
M_q_ftl:
    s_mul_hi_u32 s37, s36, 0xccccccd
    s_mul_i32 s38, s37, 20
    s_sub_u32 s38, s36, s38
    s_lshl_b32 s37, s37, 4
    s_lshl_b32 s38, s38, 5
    v_lshlrev_b32 v7, 3, v3
    v_add_u32 v7, s38, v7
    s_mov_b32 s39, 0x666667
    s_movk_i32 s40, 640
    v_add_u32 v6, s37, v4
    v_cmp_lt_u32 vcc, 320, v6
    v_subrev_u32 v8, 320, v6
    s_nop 1
    v_cndmask_b32 v8, v6, v8, vcc
    v_mov_b32 v9, 0
    v_mov_b32 v10, 0x3e800000
    v_cndmask_b32 v9, v9, v10, vcc
    v_add_u32 v11, 0, v7
    v_mul_u32_u24 v11, v11, v8
    v_mul_hi_u32 v12, v11, s39
    v_mul_lo_u32 v12, v12, s40
    v_sub_u32 v11, v11, v12
    v_cvt_f32_u32 v11, v11
    v_mov_b32 v12, v9
    v_fmac_f32 v12, 0x3acccccd, v11
    v_cos_f32 v16, v12
    v_add_u32 v11, 1, v7
    v_mul_u32_u24 v11, v11, v8
    v_mul_hi_u32 v12, v11, s39
    v_mul_lo_u32 v12, v12, s40
    v_sub_u32 v11, v11, v12
    v_cvt_f32_u32 v11, v11
    v_mov_b32 v12, v9
    v_fmac_f32 v12, 0x3acccccd, v11
    v_cos_f32 v17, v12
    v_add_u32 v11, 2, v7
    v_mul_u32_u24 v11, v11, v8
    v_mul_hi_u32 v12, v11, s39
    v_mul_lo_u32 v12, v12, s40
    v_sub_u32 v11, v11, v12
    v_cvt_f32_u32 v11, v11
    v_mov_b32 v12, v9
    v_fmac_f32 v12, 0x3acccccd, v11
    v_cos_f32 v18, v12
    v_add_u32 v11, 3, v7
    v_mul_u32_u24 v11, v11, v8
    v_mul_hi_u32 v12, v11, s39
    v_mul_lo_u32 v12, v12, s40
    v_sub_u32 v11, v11, v12
    v_cvt_f32_u32 v11, v11
    v_mov_b32 v12, v9
    v_fmac_f32 v12, 0x3acccccd, v11
    v_cos_f32 v19, v12
    v_add_u32 v11, 4, v7
    v_mul_u32_u24 v11, v11, v8
    v_mul_hi_u32 v12, v11, s39
    v_mul_lo_u32 v12, v12, s40
    v_sub_u32 v11, v11, v12
    v_cvt_f32_u32 v11, v11
    v_mov_b32 v12, v9
    v_fmac_f32 v12, 0x3acccccd, v11
    v_cos_f32 v20, v12
    v_add_u32 v11, 5, v7
    v_mul_u32_u24 v11, v11, v8
    v_mul_hi_u32 v12, v11, s39
    v_mul_lo_u32 v12, v12, s40
    v_sub_u32 v11, v11, v12
    v_cvt_f32_u32 v11, v11
    v_mov_b32 v12, v9
    v_fmac_f32 v12, 0x3acccccd, v11
    v_cos_f32 v21, v12
    v_add_u32 v11, 6, v7
    v_mul_u32_u24 v11, v11, v8
    v_mul_hi_u32 v12, v11, s39
    v_mul_lo_u32 v12, v12, s40
    v_sub_u32 v11, v11, v12
    v_cvt_f32_u32 v11, v11
    v_mov_b32 v12, v9
    v_fmac_f32 v12, 0x3acccccd, v11
    v_cos_f32 v22, v12
    v_add_u32 v11, 7, v7
    v_mul_u32_u24 v11, v11, v8
    v_mul_hi_u32 v12, v11, s39
    v_mul_lo_u32 v12, v12, s40
    v_sub_u32 v11, v11, v12
    v_cvt_f32_u32 v11, v11
    v_mov_b32 v12, v9
    v_fmac_f32 v12, 0x3acccccd, v11
    v_cos_f32 v23, v12
    s_nop 0
    v_cvt_pk_f16_f32 v24, v16, v17
    v_cvt_pk_f16_f32 v25, v18, v19
    v_cvt_pk_f16_f32 v26, v20, v21
    v_cvt_pk_f16_f32 v27, v22, v23
    ds_write_b128 v2, v[24:27]
    v_add_u32 v2, 1024, v2
    s_add_u32 s36, s36, 1
    s_cmp_lt_u32 s36, s35
    s_cbranch_scc1 M_q_ftl
    s_waitcnt lgkmcnt(0)
M_q_ft:
    v_lshrrev_b32 v1, 8, v0
    v_bfe_u32 v2, v0, 4, 4
    v_add_u32 v3, 81920, v0
    v_add_u32 v14, 122880, v0
    s_mul_i32 s28, s21, 320
    v_mul_u32_u24 v10, 163840, v1
    s_mul_i32 s27, s22, 1280
    s_add_u32 s29, s27, s28
    v_add_u32 v10, s29, v10
    v_lshl_add_u32 v4, v2, 4, v10
    v_mul_u32_u24 v10, 1280, v1
    s_mul_i32 s27, s22, 40960
    s_add_u32 s27, s27, s28
    v_add_u32 v10, s27, v10
    v_lshl_add_u32 v5, v2, 4, v10
    v_lshrrev_b32 v11, 2, v2
    v_mul_u32_u24 v15, 5120, v11
    v_add_u32 v10, v10, v15
    v_and_b32 v15, 0x30, v0
    v_add_u32 v6, v10, v15
    v_and_b32 v10, 1, v1
    v_lshlrev_b32 v10, 3, v10
    v_add_u32 v8, s29, v10
    v_lshl_add_u32 v7, v2, 4, v8
    v_add_u32 v8, v8, v15
    v_lshl_add_u32 v10, v11, 10, v10
    v_lshl_add_u32 v10, v15, 4, v10
    s_mul_i32 s27, s21, 5120
    s_and_b32 s28, s22, 15
    s_lshl_b32 s28, s28, 4
    s_add_u32 s27, s27, s28
    s_lshr_b32 s28, s22, 4
    s_mul_i32 s28, s28, 20480
    s_add_u32 s27, s27, s28
    v_add_u32 v12, s27, v10
    v_lshlrev_b32 v10, 13, v2
    v_lshl_add_u32 v10, v1, 4, v10
    s_lshl_b32 s27, s22, 18
    s_lshl_b32 s28, s21, 6
    s_add_u32 s27, s27, s28
    v_add_u32 v13, s27, v10
    s_and_b32 s58, s21, 1
    s_lshr_b32 s59, s21, 1
    v_lshlrev_b32 v10, 2, v1
    v_sub_u32 v10, v2, v10
    s_lshl_b32 s27, s58, 4
    v_add_u32 v9, s27, v10
    v_and_b32 v10, 16, v0
    s_movk_i32 s27, 0x3f80
    v_lshlrev_b32_e64 v10, v10, s27
    v_bfe_u32 v11, v0, 5, 2
    v_cmp_eq_u32 vcc, 0, v11
    s_nop 1
    v_cndmask_b32 v16, 0, v10, vcc
    v_cmp_eq_u32 vcc, 1, v11
    s_nop 1
    v_cndmask_b32 v17, 0, v10, vcc
    v_cmp_eq_u32 vcc, 2, v11
    s_nop 1
    v_cndmask_b32 v18, 0, v10, vcc
    v_cmp_eq_u32 vcc, 3, v11
    s_nop 1
    v_cndmask_b32 v19, 0, v10, vcc
    s_mov_b32 s40, 0x3e0293ee
    s_mov_b32 s41, s40
    s_sub_u32 s44, s20, 4
    s_min_u32 s44, s44, 4
    s_mov_b32 s45, 0
    s_load_dwordx2 s[72:73], s[0:1], 64
    s_load_dwordx2 s[76:77], s[0:1], 72
    s_mul_i32 s94, s44, 12
    s_add_u32 s94, s94, s22
    s_sub_u32 s94, s94, 20
    s_lshl_b32 s95, s94, 7
    s_add_u32 s95, s95, 167948288
    s_lshl_b32 s94, s94, 2
    s_add_u32 s94, s94, s21
    s_cmp_lg_u32 s101, 0
    s_cselect_b32 s94, 5000, s94
    s_waitcnt lgkmcnt(0)
    s_and_b32 s73, s73, 0xffff
    s_mov_b32 s74, 1314816
    s_mov_b32 s75, 0x00020000
    s_and_b32 s77, s77, 0xffff
    s_mov_b32 s78, 1314816
    s_mov_b32 s79, 0x00020000
    s_mul_i32 s48, s44, 2621440
    s_add_u32 s48, s48, 117440512
    s_mov_b32 s49, 0
    s_lshl_b32 s51, s44, 12
    s_lshl_b32 s27, s101, 11
    s_add_u32 s51, s51, s27
    s_add_u32 s51, s51, 167870464
    s_lshl_b32 s52, s22, 7
    s_lshl_b32 s27, s101, 12
    s_add_u32 s52, s52, s27
    s_add_u32 s52, s52, 167862272
    s_lshl_b32 s53, s22, 13
    s_add_u32 s53, s53, 218103808
    s_mul_i32 s54, s101, 8388608
    s_add_u32 s54, s54, 134217728
    s_lshl_b32 s60, s22, 8
    s_add_u32 s60, s60, 167854080
    s_mul_i32 s63, s44, 65536
    s_add_u32 s63, s63, 104857600
    s_add_u32 s64, s63, 4096
    v_mul_u32_u24 v10, 12, v2
    v_sub_u32 v1, v4, v10
    s_cmp_lg_u32 s21, 0
    s_cbranch_scc1 M_qx_14
    v_lshlrev_b32 v190, 3, v0
    s_mov_b64 exec, -1
    s_mov_b32 s30, 0
    s_lshl_b32 s27, s101, 13
    s_add_u32 s27, s27, 167911424
M_qx_15:
    buffer_load_dwordx4 v[176:179], v190, s[8:11], s27 offen sc1
    buffer_load_dwordx4 v[180:183], v190, s[8:11], s27 offen offset:16 sc1
    buffer_load_dwordx2 v[184:185], v190, s[8:11], s27 offen offset:32 sc1
    s_add_u32 s30, s30, 1
    s_cmp_ge_u32 s30, 60000
    s_cbranch_scc1 M_fail
    s_waitcnt vmcnt(0)
    v_min3_u32 v176, v176, v177, v178
    v_min3_u32 v176, v176, v179, v180
    v_min3_u32 v176, v176, v181, v182
    v_min3_u32 v176, v176, v183, v184
    v_min_u32 v176, v176, v185
    v_cmp_eq_u32 vcc, 0, v176
    s_cbranch_vccz M_qx_15d
    s_sleep 32
    s_branch M_qx_15
M_qx_15d:
    s_mov_b64 exec, -1
M_qx_14:
    s_barrier
M_qx_16:
    s_min_u32 s27, s44, 63
    s_mul_i32 s27, s27, 40960
    s_add_u32 s27, s27, s47
    s_add_u32 s28, 0, s42
    s_mov_b32 m0, s28
    s_nop 0
    buffer_load_dwordx4 v0, s[8:11], s27 offen offset:0 sc1 lds
    buffer_load_dwordx4 v0, s[8:11], s27 offen offset:1024 sc1 lds
    buffer_load_dwordx4 v0, s[8:11], s27 offen offset:2048 sc1 lds
    buffer_load_dwordx4 v0, s[8:11], s27 offen offset:3072 sc1 lds
    s_add_u32 s27, s27, 4096
    s_add_u32 s28, s28, 4096
    s_mov_b32 m0, s28
    s_nop 0
    buffer_load_dwordx4 v0, s[8:11], s27 offen offset:0 sc1 lds
    buffer_load_dwordx4 v0, s[8:11], s27 offen offset:1024 sc1 lds
    buffer_load_dwordx4 v0, s[8:11], s27 offen offset:2048 sc1 lds
    buffer_load_dwordx4 v0, s[8:11], s27 offen offset:3072 sc1 lds
    s_add_u32 s27, s27, 4096
    s_add_u32 s28, s28, 4096
    s_mov_b32 m0, s28
    s_nop 0
    buffer_load_dwordx4 v0, s[8:11], s27 offen offset:0 sc1 lds
    buffer_load_dwordx4 v0, s[8:11], s27 offen offset:1024 sc1 lds
    s_add_u32 s46, s44, 5
    s_min_u32 s27, s46, 63
    s_mul_i32 s27, s27, 40960
    s_add_u32 s27, s27, s47
    s_add_u32 s28, 40960, s42
    s_mov_b32 m0, s28
    s_nop 0
    buffer_load_dwordx4 v0, s[8:11], s27 offen offset:0 sc1 lds
    buffer_load_dwordx4 v0, s[8:11], s27 offen offset:1024 sc1 lds
    buffer_load_dwordx4 v0, s[8:11], s27 offen offset:2048 sc1 lds
    buffer_load_dwordx4 v0, s[8:11], s27 offen offset:3072 sc1 lds
    s_add_u32 s27, s27, 4096
    s_add_u32 s28, s28, 4096
    s_mov_b32 m0, s28
    s_nop 0
    buffer_load_dwordx4 v0, s[8:11], s27 offen offset:0 sc1 lds
    buffer_load_dwordx4 v0, s[8:11], s27 offen offset:1024 sc1 lds
    buffer_load_dwordx4 v0, s[8:11], s27 offen offset:2048 sc1 lds
    buffer_load_dwordx4 v0, s[8:11], s27 offen offset:3072 sc1 lds
    s_add_u32 s27, s27, 4096
    s_add_u32 s28, s28, 4096
    s_mov_b32 m0, s28
    s_nop 0
    buffer_load_dwordx4 v0, s[8:11], s27 offen offset:0 sc1 lds
    buffer_load_dwordx4 v0, s[8:11], s27 offen offset:1024 sc1 lds
    s_waitcnt vmcnt(0)
    s_barrier
    s_mov_b32 s65, 0
    s_mov_b32 s66, s44
    s_mov_b32 s62, 0x10000000
    s_mov_b32 s67, 0x10000000
    s_mov_b32 s68, 0x10000000
M_q_front:
    s_add_u32 s56, s66, s43
    s_mov_b32 s30, 0
M_q_kf:
    s_cmp_gt_u32 s65, s56
    s_cbranch_scc1 M_q_kg
    v_lshlrev_b32 v10, 3, v0
    s_mov_b64 exec, 3
    buffer_load_dword v15, v10, s[8:11], s60 offen sc1
    s_mov_b64 exec, -1
    s_waitcnt vmcnt(0)
    v_readlane_b32 s65, v15, 0
    v_readlane_b32 s27, v15, 1
    s_nop 3
    s_min_u32 s65, s65, s27
    s_sleep 1
    s_add_u32 s30, s30, 1
    s_cmp_lt_u32 s30, 60000
    s_cbranch_scc1 M_q_kf
    s_branch M_fail
M_q_kg:
    s_nop 1
    s_lshl_b32 s27, s66, 18
    s_add_u32 s27, s27, s50
    s_add_u32 s28, s27, 4096
    buffer_load_dwordx4 v[72:75], v0, s[8:11], s27 offen offset:0 sc1
    buffer_load_dwordx4 v[76:79], v0, s[8:11], s27 offen offset:1024 sc1
    buffer_load_dwordx4 v[80:83], v0, s[8:11], s27 offen offset:2048 sc1
    buffer_load_dwordx4 v[84:87], v0, s[8:11], s27 offen offset:3072 sc1
    buffer_load_dwordx4 v[88:91], v0, s[8:11], s28 offen offset:0 sc1
    buffer_load_dwordx4 v[92:95], v0, s[8:11], s28 offen offset:1024 sc1
    buffer_load_dwordx4 v[96:99], v0, s[8:11], s28 offen offset:2048 sc1
    buffer_load_dwordx4 v[100:103], v0, s[8:11], s28 offen offset:3072 sc1
    s_lshl_b32 s28, s59, 12
    s_add_u32 s27, s27, s28
    s_add_u32 s27, s27, 16777216
    buffer_load_dwordx4 v[104:107], v0, s[8:11], s27 offen offset:0 sc1
    buffer_load_dwordx4 v[108:111], v0, s[8:11], s27 offen offset:1024 sc1
    buffer_load_dwordx4 v[112:115], v0, s[8:11], s27 offen offset:2048 sc1
    buffer_load_dwordx4 v[116:119], v0, s[8:11], s27 offen offset:3072 sc1
    s_mul_i32 s27, s66, 40960
    buffer_load_dwordx2 v[184:185], v7, s[16:19], s27 offen sc1
    buffer_load_dwordx2 v[186:187], v8, s[16:19], s27 offen offset:256 sc1
    v_lshlrev_b32 v10, 3, v0
    s_mov_b64 exec, 3
    buffer_load_dword v15, v10, s[8:11], s60 offen sc1
    s_mov_b64 exec, -1
    v_add_u32 v11, s45, v0
    s_sub_u32 s45, 40960, s45
    ds_read_b128 v[40:43], v11 offset:0
    ds_read_b128 v[44:47], v11 offset:1024
    ds_read_b128 v[48:51], v11 offset:2048
    ds_read_b128 v[52:55], v11 offset:3072
    ds_read_b128 v[56:59], v11 offset:4096
    ds_read_b128 v[60:63], v11 offset:5120
    s_waitcnt lgkmcnt(5)
    v_mfma_f32_16x16x32_bf16 v[24:27], a[0:3], v[40:43], 0
    v_mfma_f32_16x16x32_bf16 v[28:31], a[80:83], v[40:43], 0
    ds_read_b128 v[40:43], v11 offset:6144
    s_waitcnt lgkmcnt(5)
    v_mfma_f32_16x16x32_bf16 v[24:27], a[4:7], v[44:47], v[24:27]
    v_mfma_f32_16x16x32_bf16 v[28:31], a[84:87], v[44:47], v[28:31]
    ds_read_b128 v[44:47], v11 offset:7168
    s_waitcnt lgkmcnt(5)
    v_mfma_f32_16x16x32_bf16 v[24:27], a[8:11], v[48:51], v[24:27]
    v_mfma_f32_16x16x32_bf16 v[28:31], a[88:91], v[48:51], v[28:31]
    ds_read_b128 v[48:51], v11 offset:8192
    s_waitcnt lgkmcnt(5)
    v_mfma_f32_16x16x32_bf16 v[24:27], a[12:15], v[52:55], v[24:27]
    v_mfma_f32_16x16x32_bf16 v[28:31], a[92:95], v[52:55], v[28:31]
    ds_read_b128 v[52:55], v11 offset:9216
    s_waitcnt lgkmcnt(5)
    v_mfma_f32_16x16x32_bf16 v[24:27], a[16:19], v[56:59], v[24:27]
    v_mfma_f32_16x16x32_bf16 v[28:31], a[96:99], v[56:59], v[28:31]
    ds_read_b128 v[56:59], v11 offset:10240
    s_waitcnt lgkmcnt(5)
    v_mfma_f32_16x16x32_bf16 v[24:27], a[20:23], v[60:63], v[24:27]
    v_mfma_f32_16x16x32_bf16 v[28:31], a[100:103], v[60:63], v[28:31]
    ds_read_b128 v[60:63], v11 offset:11264
    s_waitcnt lgkmcnt(5)
    v_mfma_f32_16x16x32_bf16 v[24:27], a[24:27], v[40:43], v[24:27]
    v_mfma_f32_16x16x32_bf16 v[28:31], a[104:107], v[40:43], v[28:31]
    ds_read_b128 v[40:43], v11 offset:12288
    s_waitcnt lgkmcnt(5)
    v_mfma_f32_16x16x32_bf16 v[24:27], a[28:31], v[44:47], v[24:27]
    v_mfma_f32_16x16x32_bf16 v[28:31], a[108:111], v[44:47], v[28:31]
    ds_read_b128 v[44:47], v11 offset:13312
    s_waitcnt lgkmcnt(5)
    v_mfma_f32_16x16x32_bf16 v[24:27], a[32:35], v[48:51], v[24:27]
    v_mfma_f32_16x16x32_bf16 v[28:31], a[112:115], v[48:51], v[28:31]
    ds_read_b128 v[48:51], v11 offset:14336
    s_waitcnt lgkmcnt(5)
    v_mfma_f32_16x16x32_bf16 v[24:27], a[36:39], v[52:55], v[24:27]
    v_mfma_f32_16x16x32_bf16 v[28:31], a[116:119], v[52:55], v[28:31]
    ds_read_b128 v[52:55], v11 offset:15360
    s_waitcnt lgkmcnt(5)
    v_mfma_f32_16x16x32_bf16 v[24:27], a[40:43], v[56:59], v[24:27]
    v_mfma_f32_16x16x32_bf16 v[28:31], a[120:123], v[56:59], v[28:31]
    ds_read_b128 v[56:59], v11 offset:16384
    s_waitcnt lgkmcnt(5)
    v_mfma_f32_16x16x32_bf16 v[24:27], a[44:47], v[60:63], v[24:27]
    v_mfma_f32_16x16x32_bf16 v[28:31], a[124:127], v[60:63], v[28:31]
    ds_read_b128 v[60:63], v11 offset:17408
    s_waitcnt lgkmcnt(5)
    v_mfma_f32_16x16x32_bf16 v[24:27], a[48:51], v[40:43], v[24:27]
    v_mfma_f32_16x16x32_bf16 v[28:31], a[128:131], v[40:43], v[28:31]
    ds_read_b128 v[40:43], v11 offset:18432
    s_waitcnt lgkmcnt(5)
    v_mfma_f32_16x16x32_bf16 v[24:27], a[52:55], v[44:47], v[24:27]
    v_mfma_f32_16x16x32_bf16 v[28:31], a[132:135], v[44:47], v[28:31]
    ds_read_b128 v[44:47], v11 offset:19456
    s_waitcnt lgkmcnt(5)
    v_mfma_f32_16x16x32_bf16 v[24:27], a[56:59], v[48:51], v[24:27]
    v_mfma_f32_16x16x32_bf16 v[28:31], a[136:139], v[48:51], v[28:31]
    ds_read_b128 v[48:51], v11 offset:20480
    s_waitcnt lgkmcnt(5)
    v_mfma_f32_16x16x32_bf16 v[24:27], a[60:63], v[52:55], v[24:27]
    v_mfma_f32_16x16x32_bf16 v[28:31], a[140:143], v[52:55], v[28:31]
    ds_read_b128 v[52:55], v11 offset:21504
    s_waitcnt lgkmcnt(5)
    v_mfma_f32_16x16x32_bf16 v[24:27], a[64:67], v[56:59], v[24:27]
    v_mfma_f32_16x16x32_bf16 v[28:31], a[144:147], v[56:59], v[28:31]
    ds_read_b128 v[56:59], v11 offset:22528
    s_waitcnt lgkmcnt(5)
    v_mfma_f32_16x16x32_bf16 v[24:27], a[68:71], v[60:63], v[24:27]
    v_mfma_f32_16x16x32_bf16 v[28:31], a[148:151], v[60:63], v[28:31]
    ds_read_b128 v[60:63], v11 offset:23552
    s_waitcnt lgkmcnt(5)
    v_mfma_f32_16x16x32_bf16 v[24:27], a[72:75], v[40:43], v[24:27]
    v_mfma_f32_16x16x32_bf16 v[28:31], a[152:155], v[40:43], v[28:31]
    ds_read_b128 v[40:43], v11 offset:24576
    s_waitcnt lgkmcnt(5)
    v_mfma_f32_16x16x32_bf16 v[24:27], a[76:79], v[44:47], v[24:27]
    v_mfma_f32_16x16x32_bf16 v[28:31], a[156:159], v[44:47], v[28:31]
    ds_read_b128 v[44:47], v11 offset:25600
    s_waitcnt lgkmcnt(5)
    v_mfma_f32_16x16x32_bf16 v[32:35], a[0:3], v[48:51], 0
    v_mfma_f32_16x16x32_bf16 v[36:39], a[80:83], v[48:51], 0
    ds_read_b128 v[48:51], v11 offset:26624
    s_waitcnt lgkmcnt(5)
    v_mfma_f32_16x16x32_bf16 v[32:35], a[4:7], v[52:55], v[32:35]
    v_mfma_f32_16x16x32_bf16 v[36:39], a[84:87], v[52:55], v[36:39]
    ds_read_b128 v[52:55], v11 offset:27648
    s_waitcnt lgkmcnt(5)
    v_mfma_f32_16x16x32_bf16 v[32:35], a[8:11], v[56:59], v[32:35]
    v_mfma_f32_16x16x32_bf16 v[36:39], a[88:91], v[56:59], v[36:39]
    ds_read_b128 v[56:59], v11 offset:28672
    s_waitcnt lgkmcnt(5)
    v_mfma_f32_16x16x32_bf16 v[32:35], a[12:15], v[60:63], v[32:35]
    v_mfma_f32_16x16x32_bf16 v[36:39], a[92:95], v[60:63], v[36:39]
    ds_read_b128 v[60:63], v11 offset:29696
    s_waitcnt lgkmcnt(5)
    v_mfma_f32_16x16x32_bf16 v[32:35], a[16:19], v[40:43], v[32:35]
    v_mfma_f32_16x16x32_bf16 v[36:39], a[96:99], v[40:43], v[36:39]
    ds_read_b128 v[40:43], v11 offset:30720
    s_waitcnt lgkmcnt(5)
    v_mfma_f32_16x16x32_bf16 v[32:35], a[20:23], v[44:47], v[32:35]
    v_mfma_f32_16x16x32_bf16 v[36:39], a[100:103], v[44:47], v[36:39]
    ds_read_b128 v[44:47], v11 offset:31744
    s_waitcnt lgkmcnt(5)
    v_mfma_f32_16x16x32_bf16 v[32:35], a[24:27], v[48:51], v[32:35]
    v_mfma_f32_16x16x32_bf16 v[36:39], a[104:107], v[48:51], v[36:39]
    ds_read_b128 v[48:51], v11 offset:32768
    s_waitcnt lgkmcnt(5)
    v_mfma_f32_16x16x32_bf16 v[32:35], a[28:31], v[52:55], v[32:35]
    v_mfma_f32_16x16x32_bf16 v[36:39], a[108:111], v[52:55], v[36:39]
    ds_read_b128 v[52:55], v11 offset:33792
    s_waitcnt lgkmcnt(5)
    v_mfma_f32_16x16x32_bf16 v[32:35], a[32:35], v[56:59], v[32:35]
    v_mfma_f32_16x16x32_bf16 v[36:39], a[112:115], v[56:59], v[36:39]
    ds_read_b128 v[56:59], v11 offset:34816
    s_waitcnt lgkmcnt(5)
    v_mfma_f32_16x16x32_bf16 v[32:35], a[36:39], v[60:63], v[32:35]
    v_mfma_f32_16x16x32_bf16 v[36:39], a[116:119], v[60:63], v[36:39]
    ds_read_b128 v[60:63], v11 offset:35840
    s_waitcnt lgkmcnt(5)
    v_mfma_f32_16x16x32_bf16 v[32:35], a[40:43], v[40:43], v[32:35]
    v_mfma_f32_16x16x32_bf16 v[36:39], a[120:123], v[40:43], v[36:39]
    ds_read_b128 v[40:43], v11 offset:36864
    s_waitcnt lgkmcnt(5)
    v_mfma_f32_16x16x32_bf16 v[32:35], a[44:47], v[44:47], v[32:35]
    v_mfma_f32_16x16x32_bf16 v[36:39], a[124:127], v[44:47], v[36:39]
    ds_read_b128 v[44:47], v11 offset:37888
    s_waitcnt lgkmcnt(5)
    v_mfma_f32_16x16x32_bf16 v[32:35], a[48:51], v[48:51], v[32:35]
    v_mfma_f32_16x16x32_bf16 v[36:39], a[128:131], v[48:51], v[36:39]
    ds_read_b128 v[48:51], v11 offset:38912
    s_waitcnt lgkmcnt(5)
    v_mfma_f32_16x16x32_bf16 v[32:35], a[52:55], v[52:55], v[32:35]
    v_mfma_f32_16x16x32_bf16 v[36:39], a[132:135], v[52:55], v[36:39]
    ds_read_b128 v[52:55], v11 offset:39936
    s_waitcnt lgkmcnt(5)
    v_mfma_f32_16x16x32_bf16 v[32:35], a[56:59], v[56:59], v[32:35]
    v_mfma_f32_16x16x32_bf16 v[36:39], a[136:139], v[56:59], v[36:39]
    s_waitcnt lgkmcnt(4)
    v_mfma_f32_16x16x32_bf16 v[32:35], a[60:63], v[60:63], v[32:35]
    v_mfma_f32_16x16x32_bf16 v[36:39], a[140:143], v[60:63], v[36:39]
    s_waitcnt lgkmcnt(3)
    v_mfma_f32_16x16x32_bf16 v[32:35], a[64:67], v[40:43], v[32:35]
    v_mfma_f32_16x16x32_bf16 v[36:39], a[144:147], v[40:43], v[36:39]
    s_waitcnt lgkmcnt(2)
    v_mfma_f32_16x16x32_bf16 v[32:35], a[68:71], v[44:47], v[32:35]
    v_mfma_f32_16x16x32_bf16 v[36:39], a[148:151], v[44:47], v[36:39]
    s_waitcnt lgkmcnt(1)
    v_mfma_f32_16x16x32_bf16 v[32:35], a[72:75], v[48:51], v[32:35]
    v_mfma_f32_16x16x32_bf16 v[36:39], a[152:155], v[48:51], v[36:39]
    s_waitcnt lgkmcnt(0)
    v_mfma_f32_16x16x32_bf16 v[32:35], a[76:79], v[52:55], v[32:35]
    v_mfma_f32_16x16x32_bf16 v[36:39], a[156:159], v[52:55], v[36:39]
    v_pk_mul_f32 v[24:25], v[24:25], s[40:41]
    v_pk_mul_f32 v[26:27], v[26:27], s[40:41]
    v_pk_mul_f32 v[28:29], v[28:29], s[40:41]
    v_pk_mul_f32 v[30:31], v[30:31], s[40:41]
    s_nop 2
    v_pk_mul_f32 v[32:33], v[32:33], s[40:41]
    v_pk_mul_f32 v[34:35], v[34:35], s[40:41]
    v_pk_mul_f32 v[36:37], v[36:37], s[40:41]
    v_pk_mul_f32 v[38:39], v[38:39], s[40:41]
    s_lshl_b32 s27, s21, 10
    v_add_u32 v10, s27, v3
    v_cvt_pk_bf16_f32 v40, v24, v28
    v_cvt_pk_bf16_f32 v41, v25, v29
    v_cvt_pk_bf16_f32 v42, v26, v30
    v_cvt_pk_bf16_f32 v43, v27, v31
    ds_write_b128 v10, v[40:43] offset:0
    v_cvt_pk_bf16_f32 v44, v32, v36
    v_cvt_pk_bf16_f32 v45, v33, v37
    v_cvt_pk_bf16_f32 v46, v34, v38
    v_cvt_pk_bf16_f32 v47, v35, v39
    ds_write_b128 v10, v[44:47] offset:4096
    s_lshl_b32 s27, s58, 12
    v_add_u32 v10, s27, v3
    s_waitcnt vmcnt(15) lgkmcnt(0)
    s_barrier
    ds_read_b128 v[160:163], v10 offset:0
    ds_read_b128 v[164:167], v10 offset:1024
    ds_read_b128 v[168:171], v10 offset:2048
    ds_read_b128 v[172:175], v10 offset:3072
    s_waitcnt vmcnt(0)
    s_cmp_lg_u32 s21, 0
    s_cbranch_scc1 M_q_fa
    s_mov_b64 exec, 1
    v_mov_b32 v10, s22
    v_mov_b32 v11, 1
    s_cmp_lg_u32 s23, 0
    s_cbranch_scc1 M_ls_17
    buffer_store_byte v11, v10, s[8:11], s62 offen
M_ls_17_r:
    s_mov_b64 exec, -1
M_q_fa:
    v_mov_b32 v11, 0xf149f2ca
    v_cmp_gt_i32 vcc, 0, v9
    s_nop 1
    v_cndmask_b32 v120, 0, v11, vcc
    v_cmp_gt_i32 vcc, 1, v9
    s_nop 1
    v_cndmask_b32 v121, 0, v11, vcc
    v_cmp_gt_i32 vcc, 2, v9
    s_nop 1
    v_cndmask_b32 v122, 0, v11, vcc
    v_cmp_gt_i32 vcc, 3, v9
    s_nop 1
    v_cndmask_b32 v123, 0, v11, vcc
    v_cmp_gt_i32 vcc, 16, v9
    s_nop 1
    v_cndmask_b32 v124, 0, v11, vcc
    v_cmp_gt_i32 vcc, 17, v9
    s_nop 1
    v_cndmask_b32 v125, 0, v11, vcc
    v_cmp_gt_i32 vcc, 18, v9
    s_nop 1
    v_cndmask_b32 v126, 0, v11, vcc
    v_cmp_gt_i32 vcc, 19, v9
    s_nop 1
    v_cndmask_b32 v127, 0, v11, vcc
    s_waitcnt lgkmcnt(3)
    v_mfma_f32_16x16x32_bf16 v[120:123], v[72:75], v[160:163], v[120:123]
    v_mfma_f32_16x16x32_bf16 v[124:127], v[88:91], v[160:163], v[124:127]
    s_waitcnt lgkmcnt(2)
    v_mfma_f32_16x16x32_bf16 v[120:123], v[76:79], v[164:167], v[120:123]
    v_mfma_f32_16x16x32_bf16 v[124:127], v[92:95], v[164:167], v[124:127]
    s_waitcnt lgkmcnt(1)
    v_mfma_f32_16x16x32_bf16 v[120:123], v[80:83], v[168:171], v[120:123]
    v_mfma_f32_16x16x32_bf16 v[124:127], v[96:99], v[168:171], v[124:127]
    s_waitcnt lgkmcnt(0)
    v_mfma_f32_16x16x32_bf16 v[120:123], v[84:87], v[172:175], v[120:123]
    v_mfma_f32_16x16x32_bf16 v[124:127], v[100:103], v[172:175], v[124:127]
    v_readlane_b32 s65, v15, 0
    v_readlane_b32 s27, v15, 1
    s_nop 3
    s_min_u32 s65, s65, s27
    v_max3_f32 v176, v120, v121, v122
    v_max3_f32 v176, v176, v123, v124
    v_max3_f32 v176, v176, v125, v126
    v_max_f32 v176, v176, v127
    v_mov_b32 v178, v176
    s_nop 1
    v_permlane16_swap_b32 v176, v178
    v_max_f32 v176, v176, v178
    v_mov_b32 v178, v176
    s_nop 1
    v_permlane32_swap_b32 v176, v178
    v_max_f32 v176, v176, v178
    v_sub_f32 v120, v120, v176
    v_sub_f32 v121, v121, v176
    v_sub_f32 v122, v122, v176
    v_sub_f32 v123, v123, v176
    v_sub_f32 v124, v124, v176
    v_sub_f32 v125, v125, v176
    v_sub_f32 v126, v126, v176
    v_sub_f32 v127, v127, v176
    v_exp_f32 v120, v120
    v_exp_f32 v121, v121
    v_exp_f32 v122, v122
    v_exp_f32 v123, v123
    v_exp_f32 v124, v124
    v_exp_f32 v125, v125
    v_exp_f32 v126, v126
    v_exp_f32 v127, v127
    v_cvt_pk_bf16_f32 v128, v120, v121
    v_cvt_pk_bf16_f32 v129, v122, v123
    v_cvt_pk_bf16_f32 v130, v124, v125
    v_cvt_pk_bf16_f32 v131, v126, v127
    v_add_f32 v177, v120, v121
    v_add_f32 v177, v177, v122
    v_add_f32 v177, v177, v123
    v_add_f32 v177, v177, v124
    v_add_f32 v177, v177, v125
    v_add_f32 v177, v177, v126
    v_add_f32 v177, v177, v127
    v_mfma_f32_16x16x32_bf16 v[144:147], v[104:107], v[128:131], 0
    v_mfma_f32_16x16x32_bf16 v[148:151], v[108:111], v[128:131], 0
    v_mfma_f32_16x16x32_bf16 v[152:155], v[112:115], v[128:131], 0
    v_mfma_f32_16x16x32_bf16 v[156:159], v[116:119], v[128:131], 0
    v_mov_b32 v178, v177
    s_nop 1
    v_permlane16_swap_b32 v177, v178
    v_add_f32 v177, v177, v178
    v_mov_b32 v178, v177
    s_nop 1
    v_permlane32_swap_b32 v177, v178
    v_add_f32 v177, v177, v178
    s_cmp_lg_u32 s66, s44
    s_cbranch_scc1 M_q_back2
M_q_top:
    s_add_u32 s56, s44, s43
    s_lshl_b32 s57, s44, 7
    s_mul_i32 s55, s44, 40960
    s_lshl_b32 s26, s56, 18
    s_add_u32 s26, s26, s53
    s_lshl_b32 s28, s59, 11
    s_add_u32 s29, s26, s28
    s_add_u32 s29, s29, 4096
    s_lshl_b32 s27, s58, 12
    s_add_u32 s27, s27, s28
    v_add_u32 v10, s27, v3
    s_cmp_lg_u32 s21, 0
    s_cbranch_scc1 M_cf_18
    s_mov_b64 exec, 0x3
    s_mov_b32 s30, 0
    v_lshrrev_b32 v190, 2, v0
M_cf_19:
    buffer_load_dword v191, v190, s[8:11], s52 offen sc1
    s_add_u32 s30, s30, 1
    s_cmp_ge_u32 s30, 60000
    s_cbranch_scc1 M_fail
    s_waitcnt vmcnt(0)
    v_cmp_ge_u32 vcc, s57, v191
    s_cbranch_vccz M_cf_19d
    s_sleep 1
    s_branch M_cf_19
M_cf_19d:
    s_mov_b64 exec, -1
M_cf_18:
    s_barrier
    buffer_load_dwordx4 v[24:27], v0, s[8:11], s26 offen offset:0 sc1
    buffer_load_dwordx4 v[28:31], v0, s[8:11], s26 offen offset:1024 sc1
    buffer_load_dwordx4 v[32:35], v0, s[8:11], s26 offen offset:2048 sc1
    buffer_load_dwordx4 v[36:39], v0, s[8:11], s26 offen offset:3072 sc1
    buffer_load_dwordx4 v[40:43], v0, s[8:11], s29 offen offset:0 sc1
    buffer_load_dwordx4 v[44:47], v0, s[8:11], s29 offen offset:1024 sc1
    s_waitcnt vmcnt(5)
    v_mfma_f32_16x16x32_bf16 v[48:51], v[24:27], v[160:163], 0
    s_waitcnt vmcnt(4)
    v_mfma_f32_16x16x32_bf16 v[48:51], v[28:31], v[164:167], v[48:51]
    s_waitcnt vmcnt(3)
    v_mfma_f32_16x16x32_bf16 v[48:51], v[32:35], v[168:171], v[48:51]
    s_waitcnt vmcnt(2)
    v_mfma_f32_16x16x32_bf16 v[48:51], v[36:39], v[172:175], v[48:51]
    s_nop 7
    v_max3_f32 v179, v176, v48, v49
    v_max3_f32 v179, v179, v50, v51
    v_mov_b32 v178, v179
    s_nop 1
    v_permlane16_swap_b32 v179, v178
    v_max_f32 v179, v179, v178
    v_sub_f32 v180, v176, v179
    v_sub_f32 v48, v48, v179
    v_sub_f32 v49, v49, v179
    v_sub_f32 v50, v50, v179
    v_sub_f32 v51, v51, v179
    v_exp_f32 v180, v180
    v_exp_f32 v48, v48
    v_exp_f32 v49, v49
    v_exp_f32 v50, v50
    v_exp_f32 v51, v51
    v_add_f32 v179, v48, v49
    v_add_f32 v176, v50, v51
    v_add_f32 v179, v179, v176
    v_mov_b32 v178, v179
    s_nop 1
    v_permlane16_swap_b32 v179, v178
    v_add_f32 v179, v179, v178
    v_fmac_f32 v179, v180, v177
    v_rcp_f32 v179, v179
    s_nop 0
    v_mul_f32 v180, v180, v179
    v_mul_f32 v48, v48, v179
    v_mul_f32 v49, v49, v179
    v_mul_f32 v50, v50, v179
    v_mul_f32 v51, v51, v179
    v_cvt_pk_bf16_f32 v48, v48, v49
    v_cvt_pk_bf16_f32 v49, v50, v51
    v_pk_mul_f32 v[144:145], v[144:145], v[180:181] op_sel_hi:[1,0]
    v_pk_mul_f32 v[146:147], v[146:147], v[180:181] op_sel_hi:[1,0]
    v_pk_mul_f32 v[148:149], v[148:149], v[180:181] op_sel_hi:[1,0]
    v_pk_mul_f32 v[150:151], v[150:151], v[180:181] op_sel_hi:[1,0]
    v_pk_mul_f32 v[152:153], v[152:153], v[180:181] op_sel_hi:[1,0]
    v_pk_mul_f32 v[154:155], v[154:155], v[180:181] op_sel_hi:[1,0]
    v_pk_mul_f32 v[156:157], v[156:157], v[180:181] op_sel_hi:[1,0]
    v_pk_mul_f32 v[158:159], v[158:159], v[180:181] op_sel_hi:[1,0]
    s_waitcnt vmcnt(1)
    v_mfma_f32_16x16x16_bf16 v[144:147], v[40:41], v[48:49], v[144:147]
    v_mfma_f32_16x16x16_bf16 v[148:151], v[42:43], v[48:49], v[148:151]
    s_waitcnt vmcnt(0)
    v_mfma_f32_16x16x16_bf16 v[152:155], v[44:45], v[48:49], v[152:155]
    v_mfma_f32_16x16x16_bf16 v[156:159], v[46:47], v[48:49], v[156:159]
    s_nop 4
    v_cvt_pk_bf16_f32 v56, v144, v148
    v_cvt_pk_bf16_f32 v57, v145, v149
    v_cvt_pk_bf16_f32 v58, v146, v150
    v_cvt_pk_bf16_f32 v59, v147, v151
    ds_write_b128 v10, v[56:59] offset:8192
    v_cvt_pk_bf16_f32 v60, v152, v156
    v_cvt_pk_bf16_f32 v61, v153, v157
    v_cvt_pk_bf16_f32 v62, v154, v158
    v_cvt_pk_bf16_f32 v63, v155, v159
    ds_write_b128 v10, v[60:63] offset:9216
    s_waitcnt lgkmcnt(0)
    s_barrier
    ds_read_b128 v[24:27], v3 offset:8192
    ds_read_b128 v[28:31], v3 offset:9216
    ds_read_b128 v[32:35], v3 offset:10240
    ds_read_b128 v[36:39], v3 offset:11264
    ds_read_b128 v[40:43], v3 offset:12288
    ds_read_b128 v[44:47], v3 offset:13312
    ds_read_b128 v[48:51], v3 offset:14336
    ds_read_b128 v[52:55], v3 offset:15360
    s_add_u32 s28, s68, 131072
    buffer_store_dwordx4 v[104:107], v13, s[8:11], s68 offen sc1
    buffer_store_dwordx4 v[108:111], v13, s[8:11], s28 offen sc1
    s_mov_b32 exec_hi, 0
    buffer_store_dwordx2 v[20:21], v7, s[8:11], s67 offen sc1
    s_mov_b32 exec_lo, 0x000f000f
    buffer_store_dwordx2 v[22:23], v7, s[8:11], s67 offen offset:256 sc1
    s_mov_b64 exec, -1
    v_mov_b64 v[20:21], v[184:185]
    v_mov_b64 v[22:23], v[186:187]
    s_add_u32 s46, s44, 10
    s_cmp_ge_u32 s46, 64
    s_cbranch_scc1 M_q_tb
    s_sub_u32 s29, 40960, s45
    s_min_u32 s27, s46, 63
    s_mul_i32 s27, s27, 40960
    s_add_u32 s27, s27, s47
    s_add_u32 s28, s29, s42
    s_mov_b32 m0, s28
    s_nop 0
    buffer_load_dwordx4 v0, s[8:11], s27 offen offset:0 sc1 lds
    buffer_load_dwordx4 v0, s[8:11], s27 offen offset:1024 sc1 lds
    buffer_load_dwordx4 v0, s[8:11], s27 offen offset:2048 sc1 lds
    buffer_load_dwordx4 v0, s[8:11], s27 offen offset:3072 sc1 lds
    s_add_u32 s27, s27, 4096
    s_add_u32 s28, s28, 4096
    s_mov_b32 m0, s28
    s_nop 0
    buffer_load_dwordx4 v0, s[8:11], s27 offen offset:0 sc1 lds
    buffer_load_dwordx4 v0, s[8:11], s27 offen offset:1024 sc1 lds
    buffer_load_dwordx4 v0, s[8:11], s27 offen offset:2048 sc1 lds
    buffer_load_dwordx4 v0, s[8:11], s27 offen offset:3072 sc1 lds
    s_add_u32 s27, s27, 4096
    s_add_u32 s28, s28, 4096
    s_mov_b32 m0, s28
    s_nop 0
    buffer_load_dwordx4 v0, s[8:11], s27 offen offset:0 sc1 lds
    buffer_load_dwordx4 v0, s[8:11], s27 offen offset:1024 sc1 lds
M_q_nx:
    s_mov_b32 s62, s51
    s_waitcnt lgkmcnt(7)
    v_mfma_f32_16x16x32_bf16 v[64:67], v[24:27], a[160:163], 0
    v_mfma_f32_16x16x32_bf16 v[68:71], v[24:27], a[176:179], 0
    v_mfma_f32_16x16x32_bf16 v[72:75], v[24:27], a[192:195], 0
    v_mfma_f32_16x16x32_bf16 v[76:79], v[24:27], a[208:211], 0
    v_mfma_f32_16x16x32_bf16 v[80:83], v[24:27], a[224:227], 0
    s_waitcnt lgkmcnt(6)
    v_mfma_f32_16x16x32_bf16 v[64:67], v[28:31], a[164:167], v[64:67]
    v_mfma_f32_16x16x32_bf16 v[68:71], v[28:31], a[180:183], v[68:71]
    v_mfma_f32_16x16x32_bf16 v[72:75], v[28:31], a[196:199], v[72:75]
    v_mfma_f32_16x16x32_bf16 v[76:79], v[28:31], a[212:215], v[76:79]
    v_mfma_f32_16x16x32_bf16 v[80:83], v[28:31], a[228:231], v[80:83]
    s_waitcnt lgkmcnt(5)
    v_mfma_f32_16x16x32_bf16 v[64:67], v[32:35], a[168:171], v[64:67]
    v_mfma_f32_16x16x32_bf16 v[68:71], v[32:35], a[184:187], v[68:71]
    v_mfma_f32_16x16x32_bf16 v[72:75], v[32:35], a[200:203], v[72:75]
    v_mfma_f32_16x16x32_bf16 v[76:79], v[32:35], a[216:219], v[76:79]
    v_mfma_f32_16x16x32_bf16 v[80:83], v[32:35], a[232:235], v[80:83]
    s_waitcnt lgkmcnt(4)
    v_mfma_f32_16x16x32_bf16 v[64:67], v[36:39], a[172:175], v[64:67]
    v_mfma_f32_16x16x32_bf16 v[68:71], v[36:39], a[188:191], v[68:71]
    v_mfma_f32_16x16x32_bf16 v[72:75], v[36:39], a[204:207], v[72:75]
    v_mfma_f32_16x16x32_bf16 v[76:79], v[36:39], a[220:223], v[76:79]
    v_mfma_f32_16x16x32_bf16 v[80:83], v[36:39], a[236:239], v[80:83]
    v_mfma_f32_16x16x32_bf16 v[84:87], v[24:27], a[240:243], 0
    v_mfma_f32_16x16x32_bf16 v[88:91], v[24:27], v[192:195], 0
    v_mfma_f32_16x16x32_bf16 v[92:95], v[24:27], v[208:211], 0
    v_mfma_f32_16x16x32_bf16 v[96:99], v[24:27], v[224:227], 0
    v_mfma_f32_16x16x32_bf16 v[100:103], v[24:27], v[240:243], 0
    v_mfma_f32_16x16x32_bf16 v[84:87], v[28:31], a[244:247], v[84:87]
    v_mfma_f32_16x16x32_bf16 v[88:91], v[28:31], v[196:199], v[88:91]
    v_mfma_f32_16x16x32_bf16 v[92:95], v[28:31], v[212:215], v[92:95]
    v_mfma_f32_16x16x32_bf16 v[96:99], v[28:31], v[228:231], v[96:99]
    v_mfma_f32_16x16x32_bf16 v[100:103], v[28:31], v[244:247], v[100:103]
    v_mfma_f32_16x16x32_bf16 v[84:87], v[32:35], a[248:251], v[84:87]
    v_mfma_f32_16x16x32_bf16 v[88:91], v[32:35], v[200:203], v[88:91]
    v_mfma_f32_16x16x32_bf16 v[92:95], v[32:35], v[216:219], v[92:95]
    v_mfma_f32_16x16x32_bf16 v[96:99], v[32:35], v[232:235], v[96:99]
    v_mfma_f32_16x16x32_bf16 v[100:103], v[32:35], v[248:251], v[100:103]
    v_mfma_f32_16x16x32_bf16 v[84:87], v[36:39], a[252:255], v[84:87]
    v_mfma_f32_16x16x32_bf16 v[88:91], v[36:39], v[204:207], v[88:91]
    v_mfma_f32_16x16x32_bf16 v[92:95], v[36:39], v[220:223], v[92:95]
    v_mfma_f32_16x16x32_bf16 v[96:99], v[36:39], v[236:239], v[96:99]
    v_mfma_f32_16x16x32_bf16 v[100:103], v[36:39], v[252:255], v[100:103]
    s_waitcnt lgkmcnt(3)
    v_mfma_f32_16x16x32_bf16 v[104:107], v[40:43], a[160:163], 0
    v_mfma_f32_16x16x32_bf16 v[108:111], v[40:43], a[176:179], 0
    v_mfma_f32_16x16x32_bf16 v[112:115], v[40:43], a[192:195], 0
    v_mfma_f32_16x16x32_bf16 v[116:119], v[40:43], a[208:211], 0
    v_mfma_f32_16x16x32_bf16 v[120:123], v[40:43], a[224:227], 0
    v_cvt_pk_bf16_f32 v56, v64, v68
    s_waitcnt lgkmcnt(2)
    v_mfma_f32_16x16x32_bf16 v[104:107], v[44:47], a[164:167], v[104:107]
    v_cvt_pk_bf16_f32 v57, v72, v76
    v_mfma_f32_16x16x32_bf16 v[108:111], v[44:47], a[180:183], v[108:111]
    v_cvt_pk_bf16_f32 v58, v80, v84
    v_mfma_f32_16x16x32_bf16 v[112:115], v[44:47], a[196:199], v[112:115]
    v_cvt_pk_bf16_f32 v59, v88, v92
    v_mfma_f32_16x16x32_bf16 v[116:119], v[44:47], a[212:215], v[116:119]
    v_cvt_pk_bf16_f32 v96, v96, v100
    v_mfma_f32_16x16x32_bf16 v[120:123], v[44:47], a[228:231], v[120:123]
    v_cvt_pk_bf16_f32 v60, v65, v69
    s_waitcnt lgkmcnt(1)
    v_mfma_f32_16x16x32_bf16 v[104:107], v[48:51], a[168:171], v[104:107]
    v_cvt_pk_bf16_f32 v61, v73, v77
    v_mfma_f32_16x16x32_bf16 v[108:111], v[48:51], a[184:187], v[108:111]
    v_cvt_pk_bf16_f32 v62, v81, v85
    v_mfma_f32_16x16x32_bf16 v[112:115], v[48:51], a[200:203], v[112:115]
    v_cvt_pk_bf16_f32 v63, v89, v93
    v_mfma_f32_16x16x32_bf16 v[116:119], v[48:51], a[216:219], v[116:119]
    v_cvt_pk_bf16_f32 v97, v97, v101
    v_mfma_f32_16x16x32_bf16 v[120:123], v[48:51], a[232:235], v[120:123]
    s_add_u32 s27, s48, 0
    s_add_u32 s28, s27, 40960
    s_cmp_lg_u32 s23, 0
    s_cbranch_scc1 M_ls_20
    buffer_store_dwordx4 v[56:59], v4, s[8:11], s27 offen
    buffer_store_dwordx4 v[60:63], v4, s[8:11], s28 offen
    buffer_store_dword v96, v1, s[8:11], s27 offen offset:256
    buffer_store_dword v97, v1, s[8:11], s28 offen offset:256
M_ls_20_r:
    s_waitcnt lgkmcnt(0)
    v_mfma_f32_16x16x32_bf16 v[104:107], v[52:55], a[172:175], v[104:107]
    v_cvt_pk_bf16_f32 v56, v66, v70
    v_mfma_f32_16x16x32_bf16 v[108:111], v[52:55], a[188:191], v[108:111]
    v_cvt_pk_bf16_f32 v57, v74, v78
    v_mfma_f32_16x16x32_bf16 v[112:115], v[52:55], a[204:207], v[112:115]
    v_cvt_pk_bf16_f32 v58, v82, v86
    v_mfma_f32_16x16x32_bf16 v[116:119], v[52:55], a[220:223], v[116:119]
    v_cvt_pk_bf16_f32 v59, v90, v94
    v_mfma_f32_16x16x32_bf16 v[120:123], v[52:55], a[236:239], v[120:123]
    v_cvt_pk_bf16_f32 v98, v98, v102
    v_mfma_f32_16x16x32_bf16 v[124:127], v[40:43], a[240:243], 0
    v_cvt_pk_bf16_f32 v60, v67, v71
    v_mfma_f32_16x16x32_bf16 v[128:131], v[40:43], v[192:195], 0
    v_cvt_pk_bf16_f32 v61, v75, v79
    v_mfma_f32_16x16x32_bf16 v[132:135], v[40:43], v[208:211], 0
    v_cvt_pk_bf16_f32 v62, v83, v87
    v_mfma_f32_16x16x32_bf16 v[136:139], v[40:43], v[224:227], 0
    v_cvt_pk_bf16_f32 v63, v91, v95
    v_mfma_f32_16x16x32_bf16 v[140:143], v[40:43], v[240:243], 0
    v_cvt_pk_bf16_f32 v99, v99, v103
    v_mfma_f32_16x16x32_bf16 v[124:127], v[44:47], a[244:247], v[124:127]
    s_add_u32 s27, s48, 81920
    s_add_u32 s28, s27, 40960
    s_cmp_lg_u32 s23, 0
    s_cbranch_scc1 M_ls_21
    buffer_store_dwordx4 v[56:59], v4, s[8:11], s27 offen
    buffer_store_dwordx4 v[60:63], v4, s[8:11], s28 offen
    buffer_store_dword v98, v1, s[8:11], s27 offen offset:256
    buffer_store_dword v99, v1, s[8:11], s28 offen offset:256
M_ls_21_r:
    v_mfma_f32_16x16x32_bf16 v[128:131], v[44:47], v[196:199], v[128:131]
    v_mfma_f32_16x16x32_bf16 v[132:135], v[44:47], v[212:215], v[132:135]
    v_mfma_f32_16x16x32_bf16 v[136:139], v[44:47], v[228:231], v[136:139]
    v_mfma_f32_16x16x32_bf16 v[140:143], v[44:47], v[244:247], v[140:143]
    v_mfma_f32_16x16x32_bf16 v[124:127], v[48:51], a[248:251], v[124:127]
    v_mfma_f32_16x16x32_bf16 v[128:131], v[48:51], v[200:203], v[128:131]
    v_mfma_f32_16x16x32_bf16 v[132:135], v[48:51], v[216:219], v[132:135]
    v_mfma_f32_16x16x32_bf16 v[136:139], v[48:51], v[232:235], v[136:139]
    v_mfma_f32_16x16x32_bf16 v[140:143], v[48:51], v[248:251], v[140:143]
    v_mfma_f32_16x16x32_bf16 v[124:127], v[52:55], a[252:255], v[124:127]
    v_mfma_f32_16x16x32_bf16 v[128:131], v[52:55], v[204:207], v[128:131]
    v_mfma_f32_16x16x32_bf16 v[132:135], v[52:55], v[220:223], v[132:135]
    v_mfma_f32_16x16x32_bf16 v[136:139], v[52:55], v[236:239], v[136:139]
    v_mfma_f32_16x16x32_bf16 v[140:143], v[52:55], v[252:255], v[140:143]
    v_cvt_pk_bf16_f32 v56, v104, v108
    v_cvt_pk_bf16_f32 v57, v112, v116
    s_nop 1
    v_cvt_pk_bf16_f32 v58, v120, v124
    s_nop 0
    v_cvt_pk_bf16_f32 v59, v128, v132
    s_nop 0
    v_cvt_pk_bf16_f32 v136, v136, v140
    v_cvt_pk_bf16_f32 v60, v105, v109
    v_cvt_pk_bf16_f32 v61, v113, v117
    v_cvt_pk_bf16_f32 v62, v121, v125
    v_cvt_pk_bf16_f32 v63, v129, v133
    v_cvt_pk_bf16_f32 v137, v137, v141
    s_add_u32 s27, s48, 655360
    s_add_u32 s28, s27, 40960
    s_cmp_lg_u32 s23, 0
    s_cbranch_scc1 M_ls_22
    buffer_store_dwordx4 v[56:59], v4, s[8:11], s27 offen
    buffer_store_dwordx4 v[60:63], v4, s[8:11], s28 offen
    buffer_store_dword v136, v1, s[8:11], s27 offen offset:256
    buffer_store_dword v137, v1, s[8:11], s28 offen offset:256
M_ls_22_r:
    v_cvt_pk_bf16_f32 v56, v106, v110
    v_cvt_pk_bf16_f32 v57, v114, v118
    v_cvt_pk_bf16_f32 v58, v122, v126
    v_cvt_pk_bf16_f32 v59, v130, v134
    v_cvt_pk_bf16_f32 v138, v138, v142
    v_cvt_pk_bf16_f32 v60, v107, v111
    v_cvt_pk_bf16_f32 v61, v115, v119
    v_cvt_pk_bf16_f32 v62, v123, v127
    v_cvt_pk_bf16_f32 v63, v131, v135
    v_cvt_pk_bf16_f32 v139, v139, v143
    s_add_u32 s27, s48, 737280
    s_add_u32 s28, s27, 40960
    s_cmp_lg_u32 s23, 0
    s_cbranch_scc1 M_ls_23
    buffer_store_dwordx4 v[56:59], v4, s[8:11], s27 offen
    buffer_store_dwordx4 v[60:63], v4, s[8:11], s28 offen
    buffer_store_dword v138, v1, s[8:11], s27 offen offset:256
    buffer_store_dword v139, v1, s[8:11], s28 offen offset:256
M_ls_23_r:
    s_add_u32 s66, s44, 5
    s_cmp_lt_u32 s66, 64
    s_cbranch_scc1 M_q_front
    s_waitcnt vmcnt(0)
    s_barrier
    s_cmp_lg_u32 s21, 0
    s_cbranch_scc1 M_q_na
    s_mov_b64 exec, 1
    v_mov_b32 v10, s22
    v_mov_b32 v11, 1
    s_cmp_lg_u32 s23, 0
    s_cbranch_scc1 M_ls_24
    buffer_store_byte v11, v10, s[8:11], s62 offen
M_ls_24_r:
    s_mov_b64 exec, -1
M_q_na:
M_q_back2:
    s_sub_u32 s27, s44, 48
    s_lshr_b32 s29, s27, 3
    s_add_u32 s29, s29, 1
    s_and_b32 s27, s27, 0xfffffff7
    s_cmp_ge_u32 s27, 5
    s_cbranch_scc1 M_q_nf1
    s_cmp_lg_u32 s21, 3
    s_cbranch_scc1 M_q_nf1
    s_lshl_b32 s27, s20, 12
    s_lshl_b32 s28, s22, 7
    s_add_u32 s27, s27, s28
    s_add_u32 s27, s27, 167915520
    s_lshl_b32 s28, s101, 2
    s_add_u32 s28, s28, s29
    v_mov_b32 v11, s28
    s_mov_b64 exec, 1
    buffer_store_dword v11, v0, s[8:11], s27 offen sc1
    s_mov_b64 exec, -1
M_q_nf1:
    s_cmp_lg_u32 s21, 0
    s_cbranch_scc1 M_ar_25
    s_mov_b64 exec, 0xff
    s_mov_b32 s30, 0
    v_lshrrev_b32 v190, 2, v0
M_ar_26:
    buffer_load_dword v191, v190, s[8:11], s62 offen sc1
    s_add_u32 s30, s30, 1
    s_cmp_ge_u32 s30, 60000
    s_cbranch_scc1 M_fail
    s_waitcnt vmcnt(0)
    v_cmp_ne_u32 vcc, 0x01010101, v191
    s_cbranch_vccz M_ar_26d
    s_branch M_ar_26
M_ar_26d:
    s_mov_b64 exec, -1
M_ar_25:
    s_barrier
    buffer_load_dwordx4 v[24:27], v5, s[8:11], s48 offen sc1
    buffer_load_dwordx4 v[56:59], v6, s[8:11], s48 offen offset:256 sc1
    s_add_u32 s27, s48, 5120
    buffer_load_dwordx4 v[28:31], v5, s[8:11], s27 offen sc1
    s_add_u32 s27, s48, 10240
    buffer_load_dwordx4 v[32:35], v5, s[8:11], s27 offen sc1
    s_add_u32 s27, s48, 15360
    buffer_load_dwordx4 v[36:39], v5, s[8:11], s27 offen sc1
    s_add_u32 s27, s48, 20480
    buffer_load_dwordx4 v[40:43], v5, s[8:11], s27 offen sc1
    buffer_load_dwordx4 v[60:63], v6, s[8:11], s27 offen offset:256 sc1
    s_add_u32 s27, s48, 25600
    buffer_load_dwordx4 v[44:47], v5, s[8:11], s27 offen sc1
    s_add_u32 s27, s48, 30720
    buffer_load_dwordx4 v[48:51], v5, s[8:11], s27 offen sc1
    s_add_u32 s27, s48, 35840
    buffer_load_dwordx4 v[52:55], v5, s[8:11], s27 offen sc1
    v_lshlrev_b32 v72, 16, v20
    v_and_b32 v73, 0xffff0000, v20
    v_lshlrev_b32 v74, 16, v21
    v_and_b32 v75, 0xffff0000, v21
    v_lshlrev_b32 v76, 16, v22
    v_and_b32 v77, 0xffff0000, v22
    v_lshlrev_b32 v78, 16, v23
    v_and_b32 v79, 0xffff0000, v23
    s_add_u32 s67, s55, s54
    s_waitcnt vmcnt(9)
    v_mfma_f32_16x16x32_bf16 v[64:67], v[16:19], v[24:27], 0
    s_waitcnt vmcnt(8)
    v_mfma_f32_16x16x32_bf16 v[68:71], v[16:19], v[56:59], 0
    s_waitcnt vmcnt(7)
    v_mfma_f32_16x16x32_bf16 v[64:67], v[16:19], v[28:31], v[64:67]
    s_waitcnt vmcnt(6)
    v_mfma_f32_16x16x32_bf16 v[64:67], v[16:19], v[32:35], v[64:67]
    s_waitcnt vmcnt(5)
    v_mfma_f32_16x16x32_bf16 v[64:67], v[16:19], v[36:39], v[64:67]
    s_waitcnt vmcnt(4)
    v_mfma_f32_16x16x32_bf16 v[64:67], v[16:19], v[40:43], v[64:67]
    s_waitcnt vmcnt(3)
    v_mfma_f32_16x16x32_bf16 v[68:71], v[16:19], v[60:63], v[68:71]
    s_waitcnt vmcnt(2)
    v_mfma_f32_16x16x32_bf16 v[64:67], v[16:19], v[44:47], v[64:67]
    s_waitcnt vmcnt(1)
    v_mfma_f32_16x16x32_bf16 v[64:67], v[16:19], v[48:51], v[64:67]
    s_waitcnt vmcnt(0)
    v_mfma_f32_16x16x32_bf16 v[64:67], v[16:19], v[52:55], v[64:67]
    s_nop 1
    v_add_f32_dpp v68, v68, v68 row_ror:8 row_mask:0xf bank_mask:0xf
    v_add_f32_dpp v69, v69, v69 row_ror:8 row_mask:0xf bank_mask:0xf
    v_add_f32_dpp v70, v70, v70 row_ror:8 row_mask:0xf bank_mask:0xf
    v_add_f32_dpp v71, v71, v71 row_ror:8 row_mask:0xf bank_mask:0xf
    v_add_f32_dpp v68, v68, v68 row_ror:4 row_mask:0xf bank_mask:0xf
    v_add_f32_dpp v69, v69, v69 row_ror:4 row_mask:0xf bank_mask:0xf
    v_add_f32_dpp v70, v70, v70 row_ror:4 row_mask:0xf bank_mask:0xf
    v_add_f32_dpp v71, v71, v71 row_ror:4 row_mask:0xf bank_mask:0xf
    v_pk_add_f32 v[72:73], v[72:73], v[64:65]
    v_pk_add_f32 v[74:75], v[74:75], v[66:67]
    v_pk_add_f32 v[76:77], v[76:77], v[68:69]
    v_pk_add_f32 v[78:79], v[78:79], v[70:71]
    v_cvt_pk_bf16_f32 v20, v72, v73
    v_cvt_pk_bf16_f32 v21, v74, v75
    v_cvt_pk_bf16_f32 v22, v76, v77
    v_cvt_pk_bf16_f32 v23, v78, v79
    v_lshlrev_b32 v72, 16, v20
    v_and_b32 v73, 0xffff0000, v20
    v_lshlrev_b32 v74, 16, v21
    v_and_b32 v75, 0xffff0000, v21
    v_lshlrev_b32 v76, 16, v22
    v_and_b32 v77, 0xffff0000, v22
    v_lshlrev_b32 v78, 16, v23
    v_and_b32 v79, 0xffff0000, v23
    v_pk_add_f32 v[92:93], v[72:73], v[74:75]
    v_pk_add_f32 v[94:95], v[76:77], v[78:79]
    v_add_f32 v92, v92, v93
    v_add_f32 v94, v94, v95
    v_mul_f32 v94, 0x3e800000, v94
    v_add_f32 v80, v92, v94
    s_nop 1
    v_add_f32_dpp v80, v80, v80 row_ror:8 row_mask:0xf bank_mask:0xf
    s_nop 1
    v_add_f32_dpp v80, v80, v80 row_ror:4 row_mask:0xf bank_mask:0xf
    s_nop 1
    v_add_f32_dpp v80, v80, v80 row_ror:2 row_mask:0xf bank_mask:0xf
    s_nop 1
    v_add_f32_dpp v80, v80, v80 row_ror:1 row_mask:0xf bank_mask:0xf
    v_mov_b32 v178, v80
    s_nop 1
    v_permlane16_swap_b32 v80, v178
    v_add_f32 v80, v80, v178
    v_mul_f32 v80, 0x3bcccccd, v80
    v_pk_add_f32 v[84:85], v[72:73], v[80:81] op_sel_hi:[1,0] neg_lo:[0,1] neg_hi:[0,1]
    v_pk_add_f32 v[86:87], v[74:75], v[80:81] op_sel_hi:[1,0] neg_lo:[0,1] neg_hi:[0,1]
    v_pk_add_f32 v[88:89], v[76:77], v[80:81] op_sel_hi:[1,0] neg_lo:[0,1] neg_hi:[0,1]
    v_pk_add_f32 v[90:91], v[78:79], v[80:81] op_sel_hi:[1,0] neg_lo:[0,1] neg_hi:[0,1]
    v_pk_mul_f32 v[84:85], v[84:85], v[84:85]
    v_pk_mul_f32 v[86:87], v[86:87], v[86:87]
    v_pk_mul_f32 v[88:89], v[88:89], v[88:89]
    v_pk_mul_f32 v[90:91], v[90:91], v[90:91]
    v_pk_add_f32 v[92:93], v[84:85], v[86:87]
    v_pk_add_f32 v[94:95], v[88:89], v[90:91]
    v_add_f32 v92, v92, v93
    v_add_f32 v94, v94, v95
    v_mul_f32 v94, 0x3e800000, v94
    v_add_f32 v81, v92, v94
    s_nop 1
    v_add_f32_dpp v81, v81, v81 row_ror:8 row_mask:0xf bank_mask:0xf
    s_nop 1
    v_add_f32_dpp v81, v81, v81 row_ror:4 row_mask:0xf bank_mask:0xf
    s_nop 1
    v_add_f32_dpp v81, v81, v81 row_ror:2 row_mask:0xf bank_mask:0xf
    s_nop 1
    v_add_f32_dpp v81, v81, v81 row_ror:1 row_mask:0xf bank_mask:0xf
    v_mov_b32 v178, v81
    s_nop 1
    v_permlane16_swap_b32 v81, v178
    v_add_f32 v81, v81, v178
    s_lshl_b32 s27, s21, 3
    s_add_u32 s27, s27, 98304
    v_mov_b32 v10, s27
    v_mov_b32 v11, 98304
    ds_write_b64 v10, v[80:81]
    s_waitcnt lgkmcnt(0)
    s_barrier
    ds_read_b128 v[84:87], v11 offset:0
    ds_read_b128 v[88:91], v11 offset:16
    s_waitcnt lgkmcnt(1)
    v_pk_add_f32 v[80:81], v[84:85], v[86:87]
    s_waitcnt lgkmcnt(0)
    v_pk_add_f32 v[92:93], v[88:89], v[90:91]
    v_pk_add_f32 v[80:81], v[80:81], v[92:93]
    v_mul_f32 v80, 0x3e800000, v80
    v_sub_f32 v84, v84, v80
    v_sub_f32 v86, v86, v80
    v_sub_f32 v88, v88, v80
    v_sub_f32 v90, v90, v80
    v_mul_f32 v85, 0x43200000, v84
    v_mul_f32 v87, 0x43200000, v86
    v_mul_f32 v89, 0x43200000, v88
    v_mul_f32 v91, 0x43200000, v90
    v_fmac_f32 v81, v84, v85
    v_fmac_f32 v81, v86, v87
    v_fmac_f32 v81, v88, v89
    v_fmac_f32 v81, v90, v91
    v_mov_b32 v82, 0x3727c5ac
    v_fmac_f32 v82, 0x3acccccd, v81
    v_rsq_f32 v82, v82
    v_pk_add_f32 v[72:73], v[72:73], v[80:81] op_sel_hi:[1,0] neg_lo:[0,1] neg_hi:[0,1]
    v_pk_add_f32 v[74:75], v[74:75], v[80:81] op_sel_hi:[1,0] neg_lo:[0,1] neg_hi:[0,1]
    v_pk_add_f32 v[76:77], v[76:77], v[80:81] op_sel_hi:[1,0] neg_lo:[0,1] neg_hi:[0,1]
    v_pk_add_f32 v[78:79], v[78:79], v[80:81] op_sel_hi:[1,0] neg_lo:[0,1] neg_hi:[0,1]
    v_pk_mul_f32 v[72:73], v[72:73], v[82:83] op_sel_hi:[1,0]
    v_pk_mul_f32 v[74:75], v[74:75], v[82:83] op_sel_hi:[1,0]
    v_pk_mul_f32 v[76:77], v[76:77], v[82:83] op_sel_hi:[1,0]
    v_pk_mul_f32 v[78:79], v[78:79], v[82:83] op_sel_hi:[1,0]
    v_cvt_pk_f16_f32 v72, v72, v73
    v_cvt_pk_f16_f32 v73, v74, v75
    v_cvt_pk_f16_f32 v74, v76, v77
    v_cvt_pk_f16_f32 v75, v78, v79
    s_cmp_lg_u32 s23, 0
    s_cbranch_scc1 M_ls_27
    s_mov_b32 exec_hi, 0
    buffer_store_dwordx2 v[72:73], v12, s[8:11], s63 offen
    s_mov_b32 exec_lo, 0x000f000f
    buffer_store_dwordx2 v[74:75], v12, s[8:11], s64 offen
    s_mov_b64 exec, -1
M_ls_27_r:
    s_add_u32 s62, s51, 20480
    s_waitcnt vmcnt(0)
    s_barrier
    s_cmp_lg_u32 s21, 0
    s_cbranch_scc1 M_q_nb
    s_mov_b64 exec, 1
    v_mov_b32 v10, s22
    v_mov_b32 v11, 1
    s_cmp_lg_u32 s23, 0
    s_cbranch_scc1 M_ls_28
    buffer_store_byte v11, v10, s[8:11], s62 offen
M_ls_28_r:
    s_mov_b64 exec, -1
M_q_nb:
    s_cmp_ge_u32 s22, 20
    s_cbranch_scc1 M_q_tab
    s_cmp_lg_u32 s21, 0
    s_cbranch_scc1 M_ar_29
    s_mov_b64 exec, 0xff
    s_mov_b32 s30, 0
    v_lshrrev_b32 v190, 2, v0
M_ar_30:
    buffer_load_dword v191, v190, s[8:11], s62 offen sc1
    s_add_u32 s30, s30, 1
    s_cmp_ge_u32 s30, 60000
    s_cbranch_scc1 M_fail
    s_waitcnt vmcnt(0)
    v_cmp_ne_u32 vcc, 0x01010101, v191
    s_cbranch_vccz M_ar_30d
    s_branch M_ar_30
M_ar_30d:
    s_mov_b64 exec, -1
M_ar_29:
    s_barrier
    s_cmp_ge_u32 s21, 2
    s_cbranch_scc1 M_q_nd
    s_mul_i32 s27, s21, 20480
    s_add_u32 s27, s27, s63
    buffer_load_dwordx4 v[24:27], v0, s[8:11], s27 offen offset:0 sc1
    buffer_load_dwordx4 v[28:31], v0, s[8:11], s27 offen offset:1024 sc1
    buffer_load_dwordx4 v[32:35], v0, s[8:11], s27 offen offset:2048 sc1
    buffer_load_dwordx4 v[36:39], v0, s[8:11], s27 offen offset:3072 sc1
    s_add_u32 s27, s27, 4096
    buffer_load_dwordx4 v[40:43], v0, s[8:11], s27 offen offset:0 sc1
    buffer_load_dwordx4 v[44:47], v0, s[8:11], s27 offen offset:1024 sc1
    buffer_load_dwordx4 v[48:51], v0, s[8:11], s27 offen offset:2048 sc1
    buffer_load_dwordx4 v[52:55], v0, s[8:11], s27 offen offset:3072 sc1
    s_add_u32 s27, s27, 4096
    buffer_load_dwordx4 v[56:59], v0, s[8:11], s27 offen offset:0 sc1
    buffer_load_dwordx4 v[60:63], v0, s[8:11], s27 offen offset:1024 sc1
    buffer_load_dwordx4 v[64:67], v0, s[8:11], s27 offen offset:2048 sc1
    buffer_load_dwordx4 v[68:71], v0, s[8:11], s27 offen offset:3072 sc1
    s_add_u32 s27, s27, 4096
    buffer_load_dwordx4 v[72:75], v0, s[8:11], s27 offen offset:0 sc1
    buffer_load_dwordx4 v[76:79], v0, s[8:11], s27 offen offset:1024 sc1
    buffer_load_dwordx4 v[80:83], v0, s[8:11], s27 offen offset:2048 sc1
    buffer_load_dwordx4 v[84:87], v0, s[8:11], s27 offen offset:3072 sc1
    s_add_u32 s27, s27, 4096
    buffer_load_dwordx4 v[88:91], v0, s[8:11], s27 offen offset:0 sc1
    buffer_load_dwordx4 v[92:95], v0, s[8:11], s27 offen offset:1024 sc1
    buffer_load_dwordx4 v[96:99], v0, s[8:11], s27 offen offset:2048 sc1
    buffer_load_dwordx4 v[100:103], v0, s[8:11], s27 offen offset:3072 sc1
    s_add_u32 s27, s27, 4096
    ds_read_b128 v[112:115], v14 offset:0
    ds_read_b128 v[116:119], v14 offset:20480
    ds_read_b128 v[120:123], v14 offset:1024
    ds_read_b128 v[124:127], v14 offset:21504
    ds_read_b128 v[128:131], v14 offset:2048
    ds_read_b128 v[132:135], v14 offset:22528
    ds_read_b128 v[136:139], v14 offset:3072
    s_lshl_b32 s27, s44, 7
    s_mul_i32 s68, s101, 6291456
    s_add_u32 s68, s68, s27
    s_add_u32 s68, s68, 176160768
    s_waitcnt vmcnt(19) lgkmcnt(6)
    v_mfma_f32_16x16x32_f16 v[104:107], v[24:27], v[112:115], 0
    ds_read_b128 v[140:143], v14 offset:23552
    s_waitcnt lgkmcnt(6)
    v_mfma_f32_16x16x32_f16 v[108:111], v[24:27], v[116:119], 0
    ds_read_b128 v[112:115], v14 offset:4096
    s_waitcnt vmcnt(18) lgkmcnt(6)
    v_mfma_f32_16x16x32_f16 v[104:107], v[28:31], v[120:123], v[104:107]
    ds_read_b128 v[116:119], v14 offset:24576
    s_waitcnt lgkmcnt(6)
    v_mfma_f32_16x16x32_f16 v[108:111], v[28:31], v[124:127], v[108:111]
    ds_read_b128 v[120:123], v14 offset:5120
    s_waitcnt vmcnt(17) lgkmcnt(6)
    v_mfma_f32_16x16x32_f16 v[104:107], v[32:35], v[128:131], v[104:107]
    ds_read_b128 v[124:127], v14 offset:25600
    s_waitcnt lgkmcnt(6)
    v_mfma_f32_16x16x32_f16 v[108:111], v[32:35], v[132:135], v[108:111]
    ds_read_b128 v[128:131], v14 offset:6144
    s_waitcnt vmcnt(16) lgkmcnt(6)
    v_mfma_f32_16x16x32_f16 v[104:107], v[36:39], v[136:139], v[104:107]
    ds_read_b128 v[132:135], v14 offset:26624
    s_waitcnt lgkmcnt(6)
    v_mfma_f32_16x16x32_f16 v[108:111], v[36:39], v[140:143], v[108:111]
    ds_read_b128 v[136:139], v14 offset:7168
    s_waitcnt vmcnt(15) lgkmcnt(6)
    v_mfma_f32_16x16x32_f16 v[104:107], v[40:43], v[112:115], v[104:107]
    ds_read_b128 v[140:143], v14 offset:27648
    s_waitcnt lgkmcnt(6)
    v_mfma_f32_16x16x32_f16 v[108:111], v[40:43], v[116:119], v[108:111]
    ds_read_b128 v[112:115], v14 offset:8192
    s_waitcnt vmcnt(14) lgkmcnt(6)
    v_mfma_f32_16x16x32_f16 v[104:107], v[44:47], v[120:123], v[104:107]
    ds_read_b128 v[116:119], v14 offset:28672
    s_waitcnt lgkmcnt(6)
    v_mfma_f32_16x16x32_f16 v[108:111], v[44:47], v[124:127], v[108:111]
    ds_read_b128 v[120:123], v14 offset:9216
    s_waitcnt vmcnt(13) lgkmcnt(6)
    v_mfma_f32_16x16x32_f16 v[104:107], v[48:51], v[128:131], v[104:107]
    ds_read_b128 v[124:127], v14 offset:29696
    s_waitcnt lgkmcnt(6)
    v_mfma_f32_16x16x32_f16 v[108:111], v[48:51], v[132:135], v[108:111]
    ds_read_b128 v[128:131], v14 offset:10240
    s_waitcnt vmcnt(12) lgkmcnt(6)
    v_mfma_f32_16x16x32_f16 v[104:107], v[52:55], v[136:139], v[104:107]
    ds_read_b128 v[132:135], v14 offset:30720
    s_waitcnt lgkmcnt(6)
    v_mfma_f32_16x16x32_f16 v[108:111], v[52:55], v[140:143], v[108:111]
    ds_read_b128 v[136:139], v14 offset:11264
    s_waitcnt vmcnt(11) lgkmcnt(6)
    v_mfma_f32_16x16x32_f16 v[104:107], v[56:59], v[112:115], v[104:107]
    ds_read_b128 v[140:143], v14 offset:31744
    s_waitcnt lgkmcnt(6)
    v_mfma_f32_16x16x32_f16 v[108:111], v[56:59], v[116:119], v[108:111]
    ds_read_b128 v[112:115], v14 offset:12288
    s_waitcnt vmcnt(10) lgkmcnt(6)
    v_mfma_f32_16x16x32_f16 v[104:107], v[60:63], v[120:123], v[104:107]
    ds_read_b128 v[116:119], v14 offset:32768
    s_waitcnt lgkmcnt(6)
    v_mfma_f32_16x16x32_f16 v[108:111], v[60:63], v[124:127], v[108:111]
    ds_read_b128 v[120:123], v14 offset:13312
    s_waitcnt vmcnt(9) lgkmcnt(6)
    v_mfma_f32_16x16x32_f16 v[104:107], v[64:67], v[128:131], v[104:107]
    ds_read_b128 v[124:127], v14 offset:33792
    s_waitcnt lgkmcnt(6)
    v_mfma_f32_16x16x32_f16 v[108:111], v[64:67], v[132:135], v[108:111]
    ds_read_b128 v[128:131], v14 offset:14336
    s_waitcnt vmcnt(8) lgkmcnt(6)
    v_mfma_f32_16x16x32_f16 v[104:107], v[68:71], v[136:139], v[104:107]
    ds_read_b128 v[132:135], v14 offset:34816
    s_waitcnt lgkmcnt(6)
    v_mfma_f32_16x16x32_f16 v[108:111], v[68:71], v[140:143], v[108:111]
    ds_read_b128 v[136:139], v14 offset:15360
    s_waitcnt vmcnt(7) lgkmcnt(6)
    v_mfma_f32_16x16x32_f16 v[104:107], v[72:75], v[112:115], v[104:107]
    ds_read_b128 v[140:143], v14 offset:35840
    s_waitcnt lgkmcnt(6)
    v_mfma_f32_16x16x32_f16 v[108:111], v[72:75], v[116:119], v[108:111]
    ds_read_b128 v[112:115], v14 offset:16384
    s_waitcnt vmcnt(6) lgkmcnt(6)
    v_mfma_f32_16x16x32_f16 v[104:107], v[76:79], v[120:123], v[104:107]
    ds_read_b128 v[116:119], v14 offset:36864
    s_waitcnt lgkmcnt(6)
    v_mfma_f32_16x16x32_f16 v[108:111], v[76:79], v[124:127], v[108:111]
    ds_read_b128 v[120:123], v14 offset:17408
    s_waitcnt vmcnt(5) lgkmcnt(6)
    v_mfma_f32_16x16x32_f16 v[104:107], v[80:83], v[128:131], v[104:107]
    ds_read_b128 v[124:127], v14 offset:37888
    s_waitcnt lgkmcnt(6)
    v_mfma_f32_16x16x32_f16 v[108:111], v[80:83], v[132:135], v[108:111]
    ds_read_b128 v[128:131], v14 offset:18432
    s_waitcnt vmcnt(4) lgkmcnt(6)
    v_mfma_f32_16x16x32_f16 v[104:107], v[84:87], v[136:139], v[104:107]
    ds_read_b128 v[132:135], v14 offset:38912
    s_waitcnt lgkmcnt(6)
    v_mfma_f32_16x16x32_f16 v[108:111], v[84:87], v[140:143], v[108:111]
    ds_read_b128 v[136:139], v14 offset:19456
    s_waitcnt vmcnt(3) lgkmcnt(6)
    v_mfma_f32_16x16x32_f16 v[104:107], v[88:91], v[112:115], v[104:107]
    ds_read_b128 v[140:143], v14 offset:39936
    s_waitcnt lgkmcnt(6)
    v_mfma_f32_16x16x32_f16 v[108:111], v[88:91], v[116:119], v[108:111]
    s_waitcnt vmcnt(2) lgkmcnt(5)
    v_mfma_f32_16x16x32_f16 v[104:107], v[92:95], v[120:123], v[104:107]
    s_waitcnt lgkmcnt(4)
    v_mfma_f32_16x16x32_f16 v[108:111], v[92:95], v[124:127], v[108:111]
    s_waitcnt vmcnt(1) lgkmcnt(3)
    v_mfma_f32_16x16x32_f16 v[104:107], v[96:99], v[128:131], v[104:107]
    s_waitcnt lgkmcnt(2)
    v_mfma_f32_16x16x32_f16 v[108:111], v[96:99], v[132:135], v[108:111]
    s_waitcnt vmcnt(0) lgkmcnt(1)
    v_mfma_f32_16x16x32_f16 v[104:107], v[100:103], v[136:139], v[104:107]
    s_waitcnt lgkmcnt(0)
    v_mfma_f32_16x16x32_f16 v[108:111], v[100:103], v[140:143], v[108:111]
    s_nop 7
M_q_nd:
    s_sub_u32 s27, s44, 54
    s_cmp_ge_u32 s27, 5
    s_cbranch_scc1 M_q_nt
    s_sub_u32 s27, 40960, s45
    s_mul_i32 s29, s21, 10240
    s_add_u32 s29, s29, s27
    s_mul_i32 s28, s88, 81920
    s_add_u32 s28, s28, s29
    s_add_u32 s28, s28, 147849216
    s_mov_b32 m0, s29
    s_nop 0
    buffer_load_dwordx4 v0, s[8:11], s28 offen offset:0 sc1 lds
    buffer_load_dwordx4 v0, s[8:11], s28 offen offset:1024 sc1 lds
    buffer_load_dwordx4 v0, s[8:11], s28 offen offset:2048 sc1 lds
    buffer_load_dwordx4 v0, s[8:11], s28 offen offset:3072 sc1 lds
    s_add_u32 s29, s29, 4096
    s_add_u32 s28, s28, 4096
    s_mov_b32 m0, s29
    s_nop 0
    buffer_load_dwordx4 v0, s[8:11], s28 offen offset:0 sc1 lds
    buffer_load_dwordx4 v0, s[8:11], s28 offen offset:1024 sc1 lds
    buffer_load_dwordx4 v0, s[8:11], s28 offen offset:2048 sc1 lds
    buffer_load_dwordx4 v0, s[8:11], s28 offen offset:3072 sc1 lds
    s_add_u32 s29, s29, 4096
    s_add_u32 s28, s28, 4096
    s_mov_b32 m0, s29
    s_nop 0
    buffer_load_dwordx4 v0, s[8:11], s28 offen offset:0 sc1 lds
    buffer_load_dwordx4 v0, s[8:11], s28 offen offset:1024 sc1 lds
    s_sub_u32 s27, s81, 1
    s_cmp_ge_u32 s27, 159
    s_cbranch_scc1 M_q_nt
    v_bfe_u32 v190, v0, 4, 3
    v_lshlrev_b32 v190, 12, v190
    v_bfe_u32 v191, v0, 7, 1
    v_mul_u32_u24 v191, 1280, v191
    v_add_u32 v190, v190, v191
    s_lshr_b32 s31, s81, 4
    s_lshl_b32 s31, s31, 7
    s_add_u32 s31, s31, 167927808
    s_lshl_b32 s32, s101, 2
    s_add_u32 s32, s32, 1
    s_mov_b64 exec, 0x1f1f
    buffer_load_dword v191, v190, s[8:11], s31 offen sc1
    s_waitcnt vmcnt(0)
    v_cmp_gt_u32 vcc, s32, v191
    s_mov_b64 exec, -1
    s_cbranch_vccnz M_q_nt
    v_lshlrev_b32 v24, 3, v0
    s_lshl_b32 s27, s81, 14
    s_lshl_b32 s28, s21, 12
    s_add_u32 s28, s28, s27
    s_add_u32 s28, s28, 148897792
    s_mov_b32 exec_hi, 0
    buffer_load_dword v25, v24, s[8:11], s28 offen sc1
    s_and_b32 s28, s21, 1
    s_lshl_b32 s28, s28, 13
    s_add_u32 s27, s27, s28
    s_lshr_b32 s28, s21, 1
    s_mul_i32 s28, s28, 2621440
    s_add_u32 s27, s27, s28
    s_mul_i32 s28, s101, 6291456
    s_add_u32 s27, s27, s28
    s_add_u32 s27, s27, 176160768
    s_mov_b32 exec_hi, 0xffff
    buffer_load_dword v25, v24, s[8:11], s27 offen sc1
    s_mov_b64 exec, -1
M_q_nt:
    s_add_u32 s48, s48, s49
    s_sub_u32 s49, 0, s49
    s_add_u32 s51, s51, 128
    s_add_u32 s44, s44, 5
    s_cmp_lt_u32 s44, 64
    s_cbranch_scc1 M_q_top
    s_cmp_ge_u32 s21, 2
    s_cbranch_scc1 M_q_e1
    s_add_u32 s28, s68, 131072
    buffer_store_dwordx4 v[104:107], v13, s[8:11], s68 offen sc1
    buffer_store_dwordx4 v[108:111], v13, s[8:11], s28 offen sc1
    s_mov_b32 exec_hi, 0
    buffer_store_dwordx2 v[20:21], v7, s[8:11], s67 offen sc1
    s_mov_b32 exec_lo, 0x000f000f
    buffer_store_dwordx2 v[22:23], v7, s[8:11], s67 offen offset:256 sc1
    s_mov_b64 exec, -1
    s_waitcnt vmcnt(2)
    s_barrier
    s_cmp_lg_u32 s21, 0
    s_cbranch_scc1 M_bphase
    s_lshl_b32 s27, s20, 12
    s_lshl_b32 s28, s22, 7
    s_add_u32 s27, s27, s28
    s_add_u32 s27, s27, 167915520
    s_lshl_b32 s28, s101, 2
    s_add_u32 s28, s28, 3
    v_mov_b32 v11, s28
    s_mov_b64 exec, 1
    buffer_store_dword v11, v0, s[8:11], s27 offen sc1
    s_mov_b64 exec, -1
    s_branch M_bphase
M_q_tb:
    s_cmp_ge_u32 s44, 59
    s_cbranch_scc1 M_q_nx
    s_cmp_lg_u32 s101, 0
    s_cbranch_scc1 M_q_tp2
    v_lshlrev_b32 v190, 3, v0
    s_mov_b32 exec_hi, 0x0fffffff
    s_mov_b32 s28, 167948288
    s_mov_b32 s30, 0
M_q_tpl:
    buffer_load_dword v191, v190, s[8:11], s28 offen sc1
    s_add_u32 s30, s30, 1
    s_cmp_ge_u32 s30, 240000
    s_cbranch_scc1 M_fail
    s_waitcnt vmcnt(0)
    v_cmp_ne_u32 vcc, 0x01010101, v191
    s_cbranch_vccz M_q_tpd
    s_sleep 8
    s_branch M_q_tpl
M_q_tpd:
    s_mov_b64 exec, -1
M_q_tp2:
    s_sub_u32 s27, 40960, s45
    s_mul_i32 s29, s21, 10240
    s_add_u32 s29, s29, s27
    s_mul_i32 s28, s88, 81920
    s_add_u32 s28, s28, s29
    s_add_u32 s28, s28, 147849216
    s_mov_b32 m0, s29
    s_nop 0
    buffer_load_dwordx4 v0, s[8:11], s28 offen offset:0 sc1 lds
    buffer_load_dwordx4 v0, s[8:11], s28 offen offset:1024 sc1 lds
    buffer_load_dwordx4 v0, s[8:11], s28 offen offset:2048 sc1 lds
    buffer_load_dwordx4 v0, s[8:11], s28 offen offset:3072 sc1 lds
    s_add_u32 s29, s29, 4096
    s_add_u32 s28, s28, 4096
    s_mov_b32 m0, s29
    s_nop 0
    buffer_load_dwordx4 v0, s[8:11], s28 offen offset:0 sc1 lds
    buffer_load_dwordx4 v0, s[8:11], s28 offen offset:1024 sc1 lds
    buffer_load_dwordx4 v0, s[8:11], s28 offen offset:2048 sc1 lds
    buffer_load_dwordx4 v0, s[8:11], s28 offen offset:3072 sc1 lds
    s_add_u32 s29, s29, 4096
    s_add_u32 s28, s28, 4096
    s_mov_b32 m0, s29
    s_nop 0
    buffer_load_dwordx4 v0, s[8:11], s28 offen offset:0 sc1 lds
    buffer_load_dwordx4 v0, s[8:11], s28 offen offset:1024 sc1 lds
    s_branch M_q_nx
M_q_tab:
    s_cmp_ge_u32 s44, 59
    s_cbranch_scc1 M_q_nd
    s_cmp_lg_u32 s21, 0
    s_cbranch_scc1 M_ar_31
    s_mov_b64 exec, 0xff
    s_mov_b32 s30, 0
    v_lshrrev_b32 v190, 2, v0
M_ar_32:
    buffer_load_dword v191, v190, s[8:11], s62 offen sc1
    s_add_u32 s30, s30, 1
    s_cmp_ge_u32 s30, 60000
    s_cbranch_scc1 M_fail
    s_waitcnt vmcnt(0)
    v_cmp_ne_u32 vcc, 0x01010101, v191
    s_cbranch_vccz M_ar_32d
    s_sleep 1
    s_branch M_ar_32
M_ar_32d:
    s_mov_b64 exec, -1
M_ar_31:
    s_barrier
    s_cmp_ge_u32 s94, 2400
    s_cbranch_scc1 M_q_nd
    v_mov_b32 v32, v0
    v_mov_b32 v33, v1
    v_mov_b32 v34, v2
    v_mov_b32 v35, v3
    v_mov_b32 v36, v4
    v_mov_b32 v37, v5
    v_mov_b32 v38, v6
    v_mov_b32 v39, v7
    v_mov_b32 v40, v8
    v_mov_b32 v41, v9
    v_mov_b32 v42, v10
    v_mov_b32 v43, v11
    v_mov_b32 v44, v12
    v_mov_b32 v45, v13
    v_mov_b32 v46, v14
    v_mov_b32 v47, v15
    v_mov_b32 v48, v16
    v_mov_b32 v49, v17
    v_mov_b32 v50, v18
    v_mov_b32 v51, v19
    v_mov_b32 v52, v20
    v_mov_b32 v53, v21
    v_mov_b32 v54, v22
    v_mov_b32 v55, v23
    v_lshrrev_b32 v1, 4, v0
    v_lshrrev_b32 v3, 8, v0
    v_and_b32 v4, 15, v1
    v_mov_b32 v5, v0
    s_cmp_ge_u32 s94, 800
    s_cbranch_scc1 M_q_wt
    s_mov_b32 s36, s94
    s_mul_hi_u32 s37, s36, 0xccccccd
    s_mul_i32 s38, s37, 20
    s_sub_u32 s38, s36, s38
    s_lshl_b32 s37, s37, 4
    s_lshl_b32 s38, s38, 5
    v_lshlrev_b32 v7, 3, v3
    v_add_u32 v7, s38, v7
    s_mov_b32 s39, 0x666667
    s_movk_i32 s40, 640
    s_and_b32 s41, s37, 16
    s_sub_u32 s37, s37, s41
    s_lshr_b32 s41, s41, 2
    s_add_u32 s37, s37, s41
    v_and_b32 v6, 12, v4
    v_add_u32 v6, v6, v4
    v_add_u32 v6, s37, v6
    v_lshrrev_b32 v8, 1, v7
    v_cmp_eq_u32 vcc, 0, v7
    v_add_u32 v11, 0, v8
    v_mov_b32 v13, 0x00000000
    v_mov_b32 v14, 0x35cccccd
    v_mov_b32 v15, 0x354ccccd
    v_cndmask_b32 v14, v14, v15, vcc
    v_mul_u32_u24 v11, v11, v6
    v_mul_hi_u32 v12, v11, s39
    v_mul_lo_u32 v12, v12, s40
    v_sub_u32 v11, v11, v12
    v_cvt_f32_u32 v11, v11
    v_fmac_f32 v13, 0x3acccccd, v11
    v_cos_f32 v13, v13
    s_nop 0
    v_mul_f32 v16, v13, v14
    v_add_u32 v11, 0, v8
    v_mov_b32 v13, 0x3e800000
    v_mov_b32 v14, 0x35cccccd
    v_mov_b32 v15, 0x354ccccd
    v_cndmask_b32 v14, v14, v15, vcc
    v_mov_b32 v15, 320
    v_cndmask_b32 v11, v11, v15, vcc
    v_mov_b32 v15, 0
    v_cndmask_b32 v13, v13, v15, vcc
    v_mul_u32_u24 v11, v11, v6
    v_mul_hi_u32 v12, v11, s39
    v_mul_lo_u32 v12, v12, s40
    v_sub_u32 v11, v11, v12
    v_cvt_f32_u32 v11, v11
    v_fmac_f32 v13, 0x3acccccd, v11
    v_cos_f32 v13, v13
    s_nop 0
    v_mul_f32 v17, v13, v14
    v_add_u32 v11, 1, v8
    v_mov_b32 v13, 0x00000000
    v_mov_b32 v14, 0x35cccccd
    v_mul_u32_u24 v11, v11, v6
    v_mul_hi_u32 v12, v11, s39
    v_mul_lo_u32 v12, v12, s40
    v_sub_u32 v11, v11, v12
    v_cvt_f32_u32 v11, v11
    v_fmac_f32 v13, 0x3acccccd, v11
    v_cos_f32 v13, v13
    s_nop 0
    v_mul_f32 v18, v13, v14
    v_add_u32 v11, 1, v8
    v_mov_b32 v13, 0x3e800000
    v_mov_b32 v14, 0x35cccccd
    v_mul_u32_u24 v11, v11, v6
    v_mul_hi_u32 v12, v11, s39
    v_mul_lo_u32 v12, v12, s40
    v_sub_u32 v11, v11, v12
    v_cvt_f32_u32 v11, v11
    v_fmac_f32 v13, 0x3acccccd, v11
    v_cos_f32 v13, v13
    s_nop 0
    v_mul_f32 v19, v13, v14
    v_add_u32 v11, 2, v8
    v_mov_b32 v13, 0x00000000
    v_mov_b32 v14, 0x35cccccd
    v_mul_u32_u24 v11, v11, v6
    v_mul_hi_u32 v12, v11, s39
    v_mul_lo_u32 v12, v12, s40
    v_sub_u32 v11, v11, v12
    v_cvt_f32_u32 v11, v11
    v_fmac_f32 v13, 0x3acccccd, v11
    v_cos_f32 v13, v13
    s_nop 0
    v_mul_f32 v20, v13, v14
    v_add_u32 v11, 2, v8
    v_mov_b32 v13, 0x3e800000
    v_mov_b32 v14, 0x35cccccd
    v_mul_u32_u24 v11, v11, v6
    v_mul_hi_u32 v12, v11, s39
    v_mul_lo_u32 v12, v12, s40
    v_sub_u32 v11, v11, v12
    v_cvt_f32_u32 v11, v11
    v_fmac_f32 v13, 0x3acccccd, v11
    v_cos_f32 v13, v13
    s_nop 0
    v_mul_f32 v21, v13, v14
    v_add_u32 v11, 3, v8
    v_mov_b32 v13, 0x00000000
    v_mov_b32 v14, 0x35cccccd
    v_mul_u32_u24 v11, v11, v6
    v_mul_hi_u32 v12, v11, s39
    v_mul_lo_u32 v12, v12, s40
    v_sub_u32 v11, v11, v12
    v_cvt_f32_u32 v11, v11
    v_fmac_f32 v13, 0x3acccccd, v11
    v_cos_f32 v13, v13
    s_nop 0
    v_mul_f32 v22, v13, v14
    v_add_u32 v11, 3, v8
    v_mov_b32 v13, 0x3e800000
    v_mov_b32 v14, 0x35cccccd
    v_mul_u32_u24 v11, v11, v6
    v_mul_hi_u32 v12, v11, s39
    v_mul_lo_u32 v12, v12, s40
    v_sub_u32 v11, v11, v12
    v_cvt_f32_u32 v11, v11
    v_fmac_f32 v13, 0x3acccccd, v11
    v_cos_f32 v13, v13
    s_nop 0
    v_mul_f32 v23, v13, v14
    v_cvt_pk_bf16_f32 v24, v16, v17
    v_cvt_pk_bf16_f32 v25, v18, v19
    v_cvt_pk_bf16_f32 v26, v20, v21
    v_cvt_pk_bf16_f32 v27, v22, v23
    s_lshl_b32 s37, s36, 10
    s_add_u32 s37, s37, 147849216
    buffer_store_dwordx4 v[24:27], v5, s[8:11], s37 offen sc1
    s_branch M_q_te
M_q_wt:
    s_sub_u32 s37, s94, 800
    s_lshr_b32 s36, s37, 8
    s_and_b32 s37, s37, 255
    s_lshl_b32 s38, s36, 6
    v_add_u32 v6, s38, v1
    s_lshr_b32 s38, s37, 5
    s_bfe_u32 s39, s37, 0x30002
    s_lshl_b32 s39, s39, 3
    s_add_u32 s38, s38, s39
    s_and_b32 s39, s37, 3
    s_lshl_b32 s39, s39, 7
    s_add_u32 s38, s38, s39
    s_mul_i32 s38, s38, 642
    v_lshlrev_b32 v7, 1, v6
    v_lshrrev_b32 v2, 1, v6
    v_lshlrev_b32 v2, 14, v2
    v_and_b32 v24, 1, v6
    v_lshl_add_u32 v2, v24, 4, v2
    v_cmp_gt_u32 vcc, 321, v6
    s_and_saveexec_b64 s[90:91], vcc
    s_cbranch_execz M_q_ws
    s_add_u32 s39, s38, 0
    buffer_load_ushort v8, v7, s[72:75], s39 offen
    buffer_load_ushort v16, v7, s[76:79], s39 offen
    s_add_u32 s39, s38, 328704
    buffer_load_ushort v9, v7, s[72:75], s39 offen
    buffer_load_ushort v17, v7, s[76:79], s39 offen
    s_add_u32 s39, s38, 657408
    buffer_load_ushort v10, v7, s[72:75], s39 offen
    buffer_load_ushort v18, v7, s[76:79], s39 offen
    s_add_u32 s39, s38, 986112
    buffer_load_ushort v11, v7, s[72:75], s39 offen
    buffer_load_ushort v19, v7, s[76:79], s39 offen
    s_add_u32 s39, s38, 41088
    buffer_load_ushort v12, v7, s[72:75], s39 offen
    buffer_load_ushort v20, v7, s[76:79], s39 offen
    s_add_u32 s39, s38, 369792
    buffer_load_ushort v13, v7, s[72:75], s39 offen
    buffer_load_ushort v21, v7, s[76:79], s39 offen
    s_add_u32 s39, s38, 698496
    buffer_load_ushort v14, v7, s[72:75], s39 offen
    buffer_load_ushort v22, v7, s[76:79], s39 offen
    s_add_u32 s39, s38, 1027200
    buffer_load_ushort v15, v7, s[72:75], s39 offen
    buffer_load_ushort v23, v7, s[76:79], s39 offen
    s_lshl_b32 s39, s37, 6
    s_add_u32 s39, s39, 148897792
    s_waitcnt vmcnt(0)
    v_lshl_or_b32 v8, v16, 16, v8
    v_lshl_or_b32 v9, v17, 16, v9
    v_lshl_or_b32 v10, v18, 16, v10
    v_lshl_or_b32 v11, v19, 16, v11
    v_lshl_or_b32 v12, v20, 16, v12
    v_lshl_or_b32 v13, v21, 16, v13
    v_lshl_or_b32 v14, v22, 16, v14
    v_lshl_or_b32 v15, v23, 16, v15
    buffer_store_dwordx4 v[8:11], v2, s[8:11], s39 offen sc1
    buffer_store_dwordx4 v[12:15], v2, s[8:11], s39 offen offset:32 sc1
M_q_ws:
    s_mov_b64 exec, s[90:91]
M_q_te:
    s_add_u32 s94, s94, 240
    s_mov_b32 s40, 0x3e0293ee
    s_mov_b32 s41, s40
    s_cmp_lt_u32 s94, 2400
    s_cbranch_scc1 M_q_tr
    s_waitcnt vmcnt(0)
    v_mov_b32 v1, s21
    v_mov_b32 v2, 1
    s_mov_b64 exec, 1
    buffer_store_byte v2, v1, s[8:11], s95 offen sc1
    s_mov_b64 exec, -1
M_q_tr:
    s_nop 1
    v_mov_b32 v1, v33
    v_mov_b32 v2, v34
    v_mov_b32 v3, v35
    v_mov_b32 v4, v36
    v_mov_b32 v5, v37
    v_mov_b32 v6, v38
    v_mov_b32 v7, v39
    v_mov_b32 v8, v40
    v_mov_b32 v9, v41
    v_mov_b32 v10, v42
    v_mov_b32 v11, v43
    v_mov_b32 v12, v44
    v_mov_b32 v13, v45
    v_mov_b32 v14, v46
    v_mov_b32 v15, v47
    v_mov_b32 v16, v48
    v_mov_b32 v17, v49
    v_mov_b32 v18, v50
    v_mov_b32 v19, v51
    v_mov_b32 v20, v52
    v_mov_b32 v21, v53
    v_mov_b32 v22, v54
    v_mov_b32 v23, v55
    s_branch M_q_nd
M_q_e1:
    s_barrier
    s_add_u32 s28, s68, 131072
    buffer_store_dwordx4 v[104:107], v13, s[8:11], s68 offen sc1
    buffer_store_dwordx4 v[108:111], v13, s[8:11], s28 offen sc1
    s_mov_b32 exec_hi, 0
    buffer_store_dwordx2 v[20:21], v7, s[8:11], s67 offen sc1
    s_mov_b32 exec_lo, 0x000f000f
    buffer_store_dwordx2 v[22:23], v7, s[8:11], s67 offen offset:256 sc1
    s_mov_b64 exec, -1
M_bphase:
    s_mov_b32 s16, s98
    s_and_b32 s17, s99, 0xffff
    s_cmp_eq_u32 s101, 1
    s_cbranch_scc1 M_osrd
    s_add_u32 s16, s8, 138412032
    s_addc_u32 s17, s9, 0
M_osrd:
    s_cmp_ge_u32 s82, 1
    s_cbranch_scc1 M_tabok2
    s_cmp_lg_u32 s101, 0
    s_cbranch_scc1 M_b_tp2
    v_lshlrev_b32 v190, 3, v0
    s_mov_b32 exec_hi, 0x0fffffff
    s_mov_b32 s28, 167948288
    s_mov_b32 s30, 0
M_b_tpl:
    buffer_load_dword v191, v190, s[8:11], s28 offen sc1
    s_add_u32 s30, s30, 1
    s_cmp_ge_u32 s30, 240000
    s_cbranch_scc1 M_fail
    s_waitcnt vmcnt(0)
    v_cmp_ne_u32 vcc, 0x01010101, v191
    s_cbranch_vccz M_b_tpd
    s_sleep 8
    s_branch M_b_tpl
M_b_tpd:
    s_mov_b64 exec, -1
M_b_tp2:
    s_mul_i32 s29, s83, 10240
    s_add_u32 s29, s29, 0
    s_mul_i32 s28, s88, 81920
    s_add_u32 s28, s28, s29
    s_add_u32 s28, s28, 147849216
    s_mov_b32 m0, s29
    s_nop 0
    buffer_load_dwordx4 v0, s[8:11], s28 offen offset:0 sc1 lds
    buffer_load_dwordx4 v0, s[8:11], s28 offen offset:1024 sc1 lds
    buffer_load_dwordx4 v0, s[8:11], s28 offen offset:2048 sc1 lds
    buffer_load_dwordx4 v0, s[8:11], s28 offen offset:3072 sc1 lds
    s_add_u32 s29, s29, 4096
    s_add_u32 s28, s28, 4096
    s_mov_b32 m0, s29
    s_nop 0
    buffer_load_dwordx4 v0, s[8:11], s28 offen offset:0 sc1 lds
    buffer_load_dwordx4 v0, s[8:11], s28 offen offset:1024 sc1 lds
    buffer_load_dwordx4 v0, s[8:11], s28 offen offset:2048 sc1 lds
    buffer_load_dwordx4 v0, s[8:11], s28 offen offset:3072 sc1 lds
    s_add_u32 s29, s29, 4096
    s_add_u32 s28, s28, 4096
    s_mov_b32 m0, s29
    s_nop 0
    buffer_load_dwordx4 v0, s[8:11], s28 offen offset:0 sc1 lds
    buffer_load_dwordx4 v0, s[8:11], s28 offen offset:1024 sc1 lds
    s_mul_i32 s29, s83, 10240
    s_add_u32 s29, s29, 40960
    s_mul_i32 s28, s88, 81920
    s_add_u32 s28, s28, s29
    s_add_u32 s28, s28, 147849216
    s_mov_b32 m0, s29
    s_nop 0
    buffer_load_dwordx4 v0, s[8:11], s28 offen offset:0 sc1 lds
    buffer_load_dwordx4 v0, s[8:11], s28 offen offset:1024 sc1 lds
    buffer_load_dwordx4 v0, s[8:11], s28 offen offset:2048 sc1 lds
    buffer_load_dwordx4 v0, s[8:11], s28 offen offset:3072 sc1 lds
    s_add_u32 s29, s29, 4096
    s_add_u32 s28, s28, 4096
    s_mov_b32 m0, s29
    s_nop 0
    buffer_load_dwordx4 v0, s[8:11], s28 offen offset:0 sc1 lds
    buffer_load_dwordx4 v0, s[8:11], s28 offen offset:1024 sc1 lds
    buffer_load_dwordx4 v0, s[8:11], s28 offen offset:2048 sc1 lds
    buffer_load_dwordx4 v0, s[8:11], s28 offen offset:3072 sc1 lds
    s_add_u32 s29, s29, 4096
    s_add_u32 s28, s28, 4096
    s_mov_b32 m0, s29
    s_nop 0
    buffer_load_dwordx4 v0, s[8:11], s28 offen offset:0 sc1 lds
    buffer_load_dwordx4 v0, s[8:11], s28 offen offset:1024 sc1 lds
M_tabok2:
    v_mbcnt_lo_u32_b32 v0, -1, 0
    v_mbcnt_hi_u32_b32 v0, -1, v0
    s_lshl_b32 s27, s83, 6
    v_add_u32 v0, s27, v0
    s_mov_b32 s2, s81
    v_lshlrev_b32 v1, 2, v0
    v_and_b32 v102, 63, v0
    v_lshlrev_b32 v102, 4, v102
    v_lshlrev_b32 v2, 6, v0
    s_cmp_lt_u32 s2, 161
    s_cbranch_scc1 M_fft_go
    s_min_u32 s28, s89, 63
    s_lshl_b32 s29, s28, 12
    s_add_u32 s29, s29, 173654016
    v_lshlrev_b32 v190, 3, v102
    s_mov_b32 exec_hi, 0
    buffer_load_dword v191, v190, s[8:11], s29 offen sc1
    s_mov_b64 exec, 1
    s_mul_i32 s28, s28, 40960
    s_lshl_b32 s29, s88, 7
    s_add_u32 s29, s29, s28
    buffer_load_dword v191, v190, s[16:19], s29 offen sc1
    s_lshl_b32 s29, s88, 11
    s_add_u32 s29, s29, s28
    s_add_u32 s29, s29, 32505856
    buffer_load_dword v191, v190, s[8:11], s29 offen sc1
    s_mul_i32 s28, s101, 3145728
    s_min_u32 s29, s2, 159
    s_lshl_b32 s29, s29, 14
    s_add_u32 s28, s28, s29
    s_lshl_b32 s29, s83, 9
    s_add_u32 s28, s28, s29
    s_add_u32 s28, s28, 157286400
    s_cmp_lt_u32 s2, 160
    s_cselect_b32 s28, s28, 0x10000000
    buffer_load_dword v191, v190, s[8:11], s28 offen sc1
    s_mov_b64 exec, -1
    s_branch M_fft_end
M_fft_go:
    s_mov_b32 s26, 0x3f3504f3
    s_mov_b32 s27, s26
    s_lshl_b32 s34, s2, 1
    s_add_u32 s35, s34, 1
    s_cmp_eq_u32 s2, 0
    s_cselect_b32 s35, 320, s35
    s_cmp_eq_u32 s2, 160
    s_cselect_b32 s34, 1, s34
    s_cselect_b32 s35, 1, s35
    s_mul_i32 s21, s101, 6291456
    s_add_u32 s21, s21, 176160768
    s_lshl_b32 s20, s34, 13
    s_add_u32 s20, s20, s21
    s_lshl_b32 s36, s35, 13
    s_add_u32 s36, s36, s21
    s_add_u32 s21, s20, 2621440
    s_add_u32 s37, s36, 2621440
    s_cmp_eq_u32 s2, 0
    s_cselect_b32 s21, 0x10000000, s21
    s_cselect_b32 s37, 0x10000000, s37
    s_add_u32 s22, s20, 4096
    s_add_u32 s23, s21, 4096
    s_add_u32 s38, s36, 4096
    s_add_u32 s39, s37, 4096
    s_cmp_lg_u32 s83, 0
    s_cbranch_scc1 M_dp_33
    v_and_b32 v190, 7, v0
    v_lshlrev_b32 v190, 12, v190
    v_bfe_u32 v191, v0, 3, 1
    v_mul_u32_u24 v191, 1280, v191
    v_add_u32 v190, v190, v191
    s_mov_b64 exec, 0x1f1f
    s_lshr_b32 s31, s34, 5
    s_lshl_b32 s31, s31, 7
    s_add_u32 s31, s31, 167927808
    s_lshl_b32 s32, s101, 2
    s_add_u32 s32, s32, 2
    s_mov_b32 s30, 0
M_dp_34:
    buffer_load_dword v191, v190, s[8:11], s31 offen sc1
    s_add_u32 s30, s30, 1
    s_cmp_ge_u32 s30, 240000
    s_cbranch_scc1 M_fail
    s_sleep 4
    s_waitcnt vmcnt(0)
    v_cmp_gt_u32 vcc, s32, v191
    s_cbranch_vccnz M_dp_34
    s_mov_b64 exec, -1
M_dp_33:
    s_barrier
    buffer_load_dword v8, v1, s[8:11], s20 offen offset:0 sc1
    buffer_load_dword v9, v1, s[8:11], s21 offen offset:0 sc1
    buffer_load_dword v10, v1, s[8:11], s20 offen offset:1024 sc1
    buffer_load_dword v11, v1, s[8:11], s21 offen offset:1024 sc1
    buffer_load_dword v12, v1, s[8:11], s20 offen offset:2048 sc1
    buffer_load_dword v13, v1, s[8:11], s21 offen offset:2048 sc1
    buffer_load_dword v14, v1, s[8:11], s20 offen offset:3072 sc1
    buffer_load_dword v15, v1, s[8:11], s21 offen offset:3072 sc1
    buffer_load_dword v16, v1, s[8:11], s22 offen offset:0 sc1
    buffer_load_dword v17, v1, s[8:11], s23 offen offset:0 sc1
    buffer_load_dword v18, v1, s[8:11], s22 offen offset:1024 sc1
    buffer_load_dword v19, v1, s[8:11], s23 offen offset:1024 sc1
    buffer_load_dword v20, v1, s[8:11], s22 offen offset:2048 sc1
    buffer_load_dword v21, v1, s[8:11], s23 offen offset:2048 sc1
    buffer_load_dword v112, v1, s[8:11], s36 offen offset:0 sc1
    buffer_load_dword v113, v1, s[8:11], s37 offen offset:0 sc1
    buffer_load_dword v114, v1, s[8:11], s36 offen offset:1024 sc1
    buffer_load_dword v115, v1, s[8:11], s37 offen offset:1024 sc1
    buffer_load_dword v116, v1, s[8:11], s36 offen offset:2048 sc1
    buffer_load_dword v117, v1, s[8:11], s37 offen offset:2048 sc1
    buffer_load_dword v118, v1, s[8:11], s36 offen offset:3072 sc1
    buffer_load_dword v119, v1, s[8:11], s37 offen offset:3072 sc1
    buffer_load_dword v120, v1, s[8:11], s38 offen offset:0 sc1
    buffer_load_dword v121, v1, s[8:11], s39 offen offset:0 sc1
    buffer_load_dword v122, v1, s[8:11], s38 offen offset:1024 sc1
    buffer_load_dword v123, v1, s[8:11], s39 offen offset:1024 sc1
    buffer_load_dword v124, v1, s[8:11], s38 offen offset:2048 sc1
    buffer_load_dword v125, v1, s[8:11], s39 offen offset:2048 sc1
    s_lshr_b32 s24, s34, 1
    s_lshl_b32 s24, s24, 14
    s_and_b32 s25, s34, 1
    s_lshl_b32 s25, s25, 4
    s_add_u32 s24, s24, s25
    s_add_u32 s24, s24, 148897792
    buffer_load_dwordx4 v[92:95], v2, s[8:11], s24 offen sc1
    buffer_load_dwordx4 v[96:99], v2, s[8:11], s24 offen offset:32 sc1
    s_lshr_b32 s24, s35, 1
    s_lshl_b32 s24, s24, 14
    s_and_b32 s25, s35, 1
    s_lshl_b32 s25, s25, 4
    s_add_u32 s24, s24, s25
    s_add_u32 s24, s24, 148897792
    buffer_load_dwordx4 v[104:107], v2, s[8:11], s24 offen sc1
    buffer_load_dwordx4 v[108:111], v2, s[8:11], s24 offen offset:32 sc1
    s_min_u32 s28, s89, 63
    s_lshl_b32 s29, s28, 12
    s_add_u32 s29, s29, 173654016
    v_lshlrev_b32 v190, 3, v102
    s_mov_b32 exec_hi, 0
    buffer_load_dword v191, v190, s[8:11], s29 offen sc1
    s_mov_b64 exec, 1
    s_mul_i32 s28, s28, 40960
    s_lshl_b32 s29, s88, 7
    s_add_u32 s29, s29, s28
    buffer_load_dword v191, v190, s[16:19], s29 offen sc1
    s_lshl_b32 s29, s88, 11
    s_add_u32 s29, s29, s28
    s_add_u32 s29, s29, 32505856
    buffer_load_dword v191, v190, s[8:11], s29 offen sc1
    s_mul_i32 s28, s101, 3145728
    s_min_u32 s29, s2, 159
    s_lshl_b32 s29, s29, 14
    s_add_u32 s28, s28, s29
    s_lshl_b32 s29, s83, 9
    s_add_u32 s28, s28, s29
    s_add_u32 s28, s28, 157286400
    s_cmp_lt_u32 s2, 160
    s_cselect_b32 s28, s28, 0x10000000
    buffer_load_dword v191, v190, s[8:11], s28 offen sc1
    s_mov_b64 exec, -1
    v_and_b32 v3, 255, v0
    v_cvt_f32_u32 v3, v3
    v_mul_f32 v4, 0xba000000, v3
    v_cos_f32 v48, v4
    v_sin_f32 v49, v4
    v_mul_f32 v4, 0xba800000, v3
    v_cos_f32 v50, v4
    v_sin_f32 v51, v4
    v_mul_f32 v4, 0xbac00000, v3
    v_cos_f32 v52, v4
    v_sin_f32 v53, v4
    v_mul_f32 v4, 0xbb000000, v3
    v_cos_f32 v54, v4
    v_sin_f32 v55, v4
    v_mul_f32 v4, 0xbb200000, v3
    v_cos_f32 v56, v4
    v_sin_f32 v57, v4
    v_mul_f32 v4, 0xbb400000, v3
    v_cos_f32 v58, v4
    v_sin_f32 v59, v4
    v_mul_f32 v4, 0xbb600000, v3
    v_cos_f32 v60, v4
    v_sin_f32 v61, v4
    v_and_b32 v3, 31, v0
    v_cvt_f32_u32 v3, v3
    v_mul_f32 v4, 0xbb800000, v3
    v_cos_f32 v62, v4
    v_sin_f32 v63, v4
    v_mul_f32 v4, 0xbc000000, v3
    v_cos_f32 v64, v4
    v_sin_f32 v65, v4
    v_mul_f32 v4, 0xbc400000, v3
    v_cos_f32 v66, v4
    v_sin_f32 v67, v4
    v_mul_f32 v4, 0xbc800000, v3
    v_cos_f32 v68, v4
    v_sin_f32 v69, v4
    v_mul_f32 v4, 0xbca00000, v3
    v_cos_f32 v70, v4
    v_sin_f32 v71, v4
    v_mul_f32 v4, 0xbcc00000, v3
    v_cos_f32 v72, v4
    v_sin_f32 v73, v4
    v_mul_f32 v4, 0xbce00000, v3
    v_cos_f32 v74, v4
    v_sin_f32 v75, v4
    v_and_b32 v3, 3, v0
    v_cvt_f32_u32 v3, v3
    v_mul_f32 v4, 0xbd000000, v3
    v_cos_f32 v76, v4
    v_sin_f32 v77, v4
    v_mul_f32 v4, 0xbd800000, v3
    v_cos_f32 v78, v4
    v_sin_f32 v79, v4
    v_mul_f32 v4, 0xbdc00000, v3
    v_cos_f32 v80, v4
    v_sin_f32 v81, v4
    v_mul_f32 v4, 0xbe000000, v3
    v_cos_f32 v82, v4
    v_sin_f32 v83, v4
    v_mul_f32 v4, 0xbe200000, v3
    v_cos_f32 v84, v4
    v_sin_f32 v85, v4
    v_mul_f32 v4, 0xbe400000, v3
    v_cos_f32 v86, v4
    v_sin_f32 v87, v4
    v_mul_f32 v4, 0xbe600000, v3
    v_cos_f32 v88, v4
    v_sin_f32 v89, v4
    v_lshlrev_b32 v3, 3, v0
    v_lshrrev_b32 v4, 5, v0
    v_mul_u32_u24 v4, 2304, v4
    v_add_u32 v3, 81920, v3
    v_add_u32 v4, 81920, v4
    v_and_b32 v5, 31, v0
    v_lshl_add_u32 v5, v5, 3, v4
    v_bfe_u32 v6, v0, 2, 3
    v_mul_u32_u24 v6, 288, v6
    v_add_u32 v6, v6, v4
    v_and_b32 v7, 3, v0
    v_lshl_add_u32 v100, v7, 6, v6
    v_lshl_add_u32 v6, v7, 3, v6
    v_and_b32 v101, 0xe0, v0
    v_and_b32 v7, 15, v0
    v_lshl_add_u32 v101, v7, 1, v101
    v_bfe_u32 v7, v0, 4, 1
    v_add_u32 v101, v101, v7
    v_lshlrev_b32 v101, 3, v101
    s_waitcnt vmcnt(0)
    s_cmp_lg_u32 s83, 0
    s_cbranch_scc1 M_dp_35
    v_and_b32 v190, 7, v0
    v_lshlrev_b32 v190, 12, v190
    v_bfe_u32 v191, v0, 3, 1
    v_mul_u32_u24 v191, 1280, v191
    v_add_u32 v190, v190, v191
    s_mov_b64 exec, 0x1f1f
    s_lshr_b32 s31, s34, 5
    s_lshl_b32 s31, s31, 7
    s_add_u32 s31, s31, 167927808
    s_lshl_b32 s32, s101, 2
    s_add_u32 s32, s32, 3
    s_mov_b32 s30, 0
M_dp_36:
    buffer_load_dword v191, v190, s[8:11], s31 offen sc1
    s_add_u32 s30, s30, 1
    s_cmp_ge_u32 s30, 240000
    s_cbranch_scc1 M_fail
    s_waitcnt vmcnt(0)
    v_cmp_gt_u32 vcc, s32, v191
    s_cbranch_vccnz M_dp_36
    s_mov_b64 exec, -1
M_dp_35:
    s_barrier
    buffer_load_dword v22, v1, s[8:11], s22 offen offset:3072 sc1
    buffer_load_dword v23, v1, s[8:11], s23 offen offset:3072 sc1
    buffer_load_dword v126, v1, s[8:11], s38 offen offset:3072 sc1
    buffer_load_dword v127, v1, s[8:11], s39 offen offset:3072 sc1
    v_pk_add_f32 v[24:25], v[8:9], v[16:17]
    v_pk_add_f32 v[26:27], v[8:9], v[16:17] neg_lo:[0,1] neg_hi:[0,1]
    v_pk_add_f32 v[28:29], v[10:11], v[18:19]
    v_pk_add_f32 v[30:31], v[10:11], v[18:19] neg_lo:[0,1] neg_hi:[0,1]
    v_pk_add_f32 v[32:33], v[12:13], v[20:21]
    v_pk_add_f32 v[34:35], v[12:13], v[20:21] neg_lo:[0,1] neg_hi:[0,1]
    s_waitcnt vmcnt(2)
    v_pk_add_f32 v[36:37], v[14:15], v[22:23]
    v_pk_add_f32 v[38:39], v[14:15], v[22:23] neg_lo:[0,1] neg_hi:[0,1]
    v_pk_add_f32 v[40:41], v[24:25], v[32:33]
    v_pk_add_f32 v[42:43], v[24:25], v[32:33] neg_lo:[0,1] neg_hi:[0,1]
    v_pk_add_f32 v[44:45], v[28:29], v[36:37]
    v_pk_add_f32 v[46:47], v[28:29], v[36:37] neg_lo:[0,1] neg_hi:[0,1]
    v_pk_add_f32 v[8:9], v[40:41], v[44:45]
    v_pk_add_f32 v[16:17], v[40:41], v[44:45] neg_lo:[0,1] neg_hi:[0,1]
    v_pk_add_f32 v[10:11], v[42:43], v[46:47] op_sel:[0,1] op_sel_hi:[1,0] neg_lo:[0,0] neg_hi:[0,1]
    v_pk_add_f32 v[18:19], v[42:43], v[46:47] op_sel:[0,1] op_sel_hi:[1,0] neg_lo:[0,1] neg_hi:[0,0]
    v_pk_add_f32 v[12:13], v[30:31], v[30:31] op_sel:[0,1] op_sel_hi:[1,0] neg_lo:[0,0] neg_hi:[0,1]
    v_pk_add_f32 v[20:21], v[38:39], v[38:39] op_sel:[0,1] op_sel_hi:[1,0] neg_lo:[1,0] neg_hi:[1,1]
    v_pk_add_f32 v[14:15], v[26:27], v[34:35] op_sel:[0,1] op_sel_hi:[1,0] neg_lo:[0,0] neg_hi:[0,1]
    v_pk_add_f32 v[22:23], v[26:27], v[34:35] op_sel:[0,1] op_sel_hi:[1,0] neg_lo:[0,1] neg_hi:[0,0]
    v_pk_add_f32 v[24:25], v[12:13], v[20:21]
    v_pk_add_f32 v[28:29], v[12:13], v[20:21] neg_lo:[0,1] neg_hi:[0,1]
    v_pk_fma_f32 v[32:33], v[24:25], s[26:27], v[14:15] neg_lo:[0,0,0] neg_hi:[0,0,0]
    v_pk_fma_f32 v[36:37], v[24:25], s[26:27], v[14:15] neg_lo:[1,0,0] neg_hi:[1,0,0]
    v_pk_fma_f32 v[40:41], v[28:29], s[26:27], v[22:23] op_sel:[1,0,0] op_sel_hi:[0,1,1] neg_lo:[0,0,0] neg_hi:[1,0,0]
    v_pk_fma_f32 v[42:43], v[28:29], s[26:27], v[22:23] op_sel:[1,0,0] op_sel_hi:[0,1,1] neg_lo:[1,0,0] neg_hi:[0,0,0]
    v_pk_mul_f32 v[44:45], v[32:33], v[48:49] op_sel:[0,0] op_sel_hi:[1,0]
    v_pk_mul_f32 v[46:47], v[10:11], v[50:51] op_sel:[0,0] op_sel_hi:[1,0]
    v_pk_mul_f32 v[26:27], v[40:41], v[52:53] op_sel:[0,0] op_sel_hi:[1,0]
    v_pk_mul_f32 v[30:31], v[16:17], v[54:55] op_sel:[0,0] op_sel_hi:[1,0]
    v_pk_mul_f32 v[34:35], v[36:37], v[56:57] op_sel:[0,0] op_sel_hi:[1,0]
    v_pk_mul_f32 v[38:39], v[18:19], v[58:59] op_sel:[0,0] op_sel_hi:[1,0]
    v_pk_mul_f32 v[12:13], v[42:43], v[60:61] op_sel:[0,0] op_sel_hi:[1,0]
    v_pk_fma_f32 v[44:45], v[32:33], v[48:49], v[44:45] op_sel:[1,1,0] op_sel_hi:[0,1,1] neg_lo:[1,0,0] neg_hi:[0,0,0]
    v_pk_fma_f32 v[46:47], v[10:11], v[50:51], v[46:47] op_sel:[1,1,0] op_sel_hi:[0,1,1] neg_lo:[1,0,0] neg_hi:[0,0,0]
    v_pk_fma_f32 v[26:27], v[40:41], v[52:53], v[26:27] op_sel:[1,1,0] op_sel_hi:[0,1,1] neg_lo:[1,0,0] neg_hi:[0,0,0]
    v_pk_fma_f32 v[30:31], v[16:17], v[54:55], v[30:31] op_sel:[1,1,0] op_sel_hi:[0,1,1] neg_lo:[1,0,0] neg_hi:[0,0,0]
    v_pk_fma_f32 v[34:35], v[36:37], v[56:57], v[34:35] op_sel:[1,1,0] op_sel_hi:[0,1,1] neg_lo:[1,0,0] neg_hi:[0,0,0]
    v_pk_fma_f32 v[38:39], v[18:19], v[58:59], v[38:39] op_sel:[1,1,0] op_sel_hi:[0,1,1] neg_lo:[1,0,0] neg_hi:[0,0,0]
    v_pk_fma_f32 v[12:13], v[42:43], v[60:61], v[12:13] op_sel:[1,1,0] op_sel_hi:[0,1,1] neg_lo:[1,0,0] neg_hi:[0,0,0]
    ds_write_b64 v3, v[8:9] offset:0
    v_pk_add_f32 v[128:129], v[112:113], v[120:121]
    v_pk_add_f32 v[130:131], v[112:113], v[120:121] neg_lo:[0,1] neg_hi:[0,1]
    v_pk_add_f32 v[132:133], v[114:115], v[122:123]
    ds_write_b64 v3, v[44:45] offset:2304
    v_pk_add_f32 v[134:135], v[114:115], v[122:123] neg_lo:[0,1] neg_hi:[0,1]
    v_pk_add_f32 v[136:137], v[116:117], v[124:125]
    v_pk_add_f32 v[138:139], v[116:117], v[124:125] neg_lo:[0,1] neg_hi:[0,1]
    ds_write_b64 v3, v[46:47] offset:4608
    s_waitcnt vmcnt(0)
    v_pk_add_f32 v[140:141], v[118:119], v[126:127]
    v_pk_add_f32 v[142:143], v[118:119], v[126:127] neg_lo:[0,1] neg_hi:[0,1]
    v_pk_add_f32 v[144:145], v[128:129], v[136:137]
    ds_write_b64 v3, v[26:27] offset:6912
    v_pk_add_f32 v[146:147], v[128:129], v[136:137] neg_lo:[0,1] neg_hi:[0,1]
    v_pk_add_f32 v[148:149], v[132:133], v[140:141]
    v_pk_add_f32 v[150:151], v[132:133], v[140:141] neg_lo:[0,1] neg_hi:[0,1]
    ds_write_b64 v3, v[30:31] offset:9216
    v_pk_add_f32 v[112:113], v[144:145], v[148:149]
    v_pk_add_f32 v[120:121], v[144:145], v[148:149] neg_lo:[0,1] neg_hi:[0,1]
    v_pk_add_f32 v[114:115], v[146:147], v[150:151] op_sel:[0,1] op_sel_hi:[1,0] neg_lo:[0,0] neg_hi:[0,1]
    ds_write_b64 v3, v[34:35] offset:11520
    v_pk_add_f32 v[122:123], v[146:147], v[150:151] op_sel:[0,1] op_sel_hi:[1,0] neg_lo:[0,1] neg_hi:[0,0]
    v_pk_add_f32 v[116:117], v[134:135], v[134:135] op_sel:[0,1] op_sel_hi:[1,0] neg_lo:[0,0] neg_hi:[0,1]
    v_pk_add_f32 v[124:125], v[142:143], v[142:143] op_sel:[0,1] op_sel_hi:[1,0] neg_lo:[1,0] neg_hi:[1,1]
    ds_write_b64 v3, v[38:39] offset:13824
    v_pk_add_f32 v[118:119], v[130:131], v[138:139] op_sel:[0,1] op_sel_hi:[1,0] neg_lo:[0,0] neg_hi:[0,1]
    v_pk_add_f32 v[126:127], v[130:131], v[138:139] op_sel:[0,1] op_sel_hi:[1,0] neg_lo:[0,1] neg_hi:[0,0]
    v_pk_add_f32 v[128:129], v[116:117], v[124:125]
    ds_write_b64 v3, v[12:13] offset:16128
    v_pk_add_f32 v[132:133], v[116:117], v[124:125] neg_lo:[0,1] neg_hi:[0,1]
    v_pk_fma_f32 v[136:137], v[128:129], s[26:27], v[118:119] neg_lo:[0,0,0] neg_hi:[0,0,0]
    v_pk_fma_f32 v[140:141], v[128:129], s[26:27], v[118:119] neg_lo:[1,0,0] neg_hi:[1,0,0]
    v_pk_fma_f32 v[144:145], v[132:133], s[26:27], v[126:127] op_sel:[1,0,0] op_sel_hi:[0,1,1] neg_lo:[0,0,0] neg_hi:[1,0,0]
    v_pk_fma_f32 v[146:147], v[132:133], s[26:27], v[126:127] op_sel:[1,0,0] op_sel_hi:[0,1,1] neg_lo:[1,0,0] neg_hi:[0,0,0]
    v_pk_mul_f32 v[148:149], v[136:137], v[48:49] op_sel:[0,0] op_sel_hi:[1,0]
    v_pk_mul_f32 v[150:151], v[114:115], v[50:51] op_sel:[0,0] op_sel_hi:[1,0]
    v_pk_mul_f32 v[130:131], v[144:145], v[52:53] op_sel:[0,0] op_sel_hi:[1,0]
    v_pk_mul_f32 v[134:135], v[120:121], v[54:55] op_sel:[0,0] op_sel_hi:[1,0]
    v_pk_mul_f32 v[138:139], v[140:141], v[56:57] op_sel:[0,0] op_sel_hi:[1,0]
    v_pk_mul_f32 v[142:143], v[122:123], v[58:59] op_sel:[0,0] op_sel_hi:[1,0]
    v_pk_mul_f32 v[116:117], v[146:147], v[60:61] op_sel:[0,0] op_sel_hi:[1,0]
    v_pk_fma_f32 v[148:149], v[136:137], v[48:49], v[148:149] op_sel:[1,1,0] op_sel_hi:[0,1,1] neg_lo:[1,0,0] neg_hi:[0,0,0]
    v_pk_fma_f32 v[150:151], v[114:115], v[50:51], v[150:151] op_sel:[1,1,0] op_sel_hi:[0,1,1] neg_lo:[1,0,0] neg_hi:[0,0,0]
    v_pk_fma_f32 v[130:131], v[144:145], v[52:53], v[130:131] op_sel:[1,1,0] op_sel_hi:[0,1,1] neg_lo:[1,0,0] neg_hi:[0,0,0]
    v_pk_fma_f32 v[134:135], v[120:121], v[54:55], v[134:135] op_sel:[1,1,0] op_sel_hi:[0,1,1] neg_lo:[1,0,0] neg_hi:[0,0,0]
    v_pk_fma_f32 v[138:139], v[140:141], v[56:57], v[138:139] op_sel:[1,1,0] op_sel_hi:[0,1,1] neg_lo:[1,0,0] neg_hi:[0,0,0]
    v_pk_fma_f32 v[142:143], v[122:123], v[58:59], v[142:143] op_sel:[1,1,0] op_sel_hi:[0,1,1] neg_lo:[1,0,0] neg_hi:[0,0,0]
    v_pk_fma_f32 v[116:117], v[146:147], v[60:61], v[116:117] op_sel:[1,1,0] op_sel_hi:[0,1,1] neg_lo:[1,0,0] neg_hi:[0,0,0]
    ds_write_b64 v3, v[112:113] offset:18432
    ds_write_b64 v3, v[148:149] offset:20736
    ds_write_b64 v3, v[150:151] offset:23040
    ds_write_b64 v3, v[130:131] offset:25344
    ds_write_b64 v3, v[134:135] offset:27648
    ds_write_b64 v3, v[138:139] offset:29952
    ds_write_b64 v3, v[142:143] offset:32256
    ds_write_b64 v3, v[116:117] offset:34560
    s_waitcnt lgkmcnt(0)
    s_barrier
    ds_read_b64 v[20:21], v5 offset:0
    ds_read_b64 v[14:15], v5 offset:256
    ds_read_b64 v[22:23], v5 offset:512
    ds_read_b64 v[24:25], v5 offset:768
    ds_read_b64 v[28:29], v5 offset:1024
    ds_read_b64 v[32:33], v5 offset:1280
    ds_read_b64 v[10:11], v5 offset:1536
    ds_read_b64 v[40:41], v5 offset:1792
    ds_read_b64 v[124:125], v5 offset:18432
    ds_read_b64 v[118:119], v5 offset:18688
    ds_read_b64 v[126:127], v5 offset:18944
    ds_read_b64 v[128:129], v5 offset:19200
    ds_read_b64 v[132:133], v5 offset:19456
    ds_read_b64 v[136:137], v5 offset:19712
    ds_read_b64 v[114:115], v5 offset:19968
    ds_read_b64 v[144:145], v5 offset:20224
    s_waitcnt lgkmcnt(11)
    v_pk_add_f32 v[16:17], v[20:21], v[28:29]
    v_pk_add_f32 v[36:37], v[20:21], v[28:29] neg_lo:[0,1] neg_hi:[0,1]
    s_waitcnt lgkmcnt(10)
    v_pk_add_f32 v[18:19], v[14:15], v[32:33]
    v_pk_add_f32 v[42:43], v[14:15], v[32:33] neg_lo:[0,1] neg_hi:[0,1]
    s_waitcnt lgkmcnt(9)
    v_pk_add_f32 v[8:9], v[22:23], v[10:11]
    v_pk_add_f32 v[44:45], v[22:23], v[10:11] neg_lo:[0,1] neg_hi:[0,1]
    s_waitcnt lgkmcnt(8)
    v_pk_add_f32 v[46:47], v[24:25], v[40:41]
    v_pk_add_f32 v[26:27], v[24:25], v[40:41] neg_lo:[0,1] neg_hi:[0,1]
    v_pk_add_f32 v[30:31], v[16:17], v[8:9]
    v_pk_add_f32 v[34:35], v[16:17], v[8:9] neg_lo:[0,1] neg_hi:[0,1]
    v_pk_add_f32 v[38:39], v[18:19], v[46:47]
    v_pk_add_f32 v[12:13], v[18:19], v[46:47] neg_lo:[0,1] neg_hi:[0,1]
    v_pk_add_f32 v[20:21], v[30:31], v[38:39]
    v_pk_add_f32 v[28:29], v[30:31], v[38:39] neg_lo:[0,1] neg_hi:[0,1]
    v_pk_add_f32 v[14:15], v[34:35], v[12:13] op_sel:[0,1] op_sel_hi:[1,0] neg_lo:[0,0] neg_hi:[0,1]
    v_pk_add_f32 v[32:33], v[34:35], v[12:13] op_sel:[0,1] op_sel_hi:[1,0] neg_lo:[0,1] neg_hi:[0,0]
    v_pk_add_f32 v[22:23], v[42:43], v[42:43] op_sel:[0,1] op_sel_hi:[1,0] neg_lo:[0,0] neg_hi:[0,1]
    v_pk_add_f32 v[10:11], v[26:27], v[26:27] op_sel:[0,1] op_sel_hi:[1,0] neg_lo:[1,0] neg_hi:[1,1]
    v_pk_add_f32 v[24:25], v[36:37], v[44:45] op_sel:[0,1] op_sel_hi:[1,0] neg_lo:[0,0] neg_hi:[0,1]
    v_pk_add_f32 v[40:41], v[36:37], v[44:45] op_sel:[0,1] op_sel_hi:[1,0] neg_lo:[0,1] neg_hi:[0,0]
    v_pk_add_f32 v[16:17], v[22:23], v[10:11]
    v_pk_add_f32 v[18:19], v[22:23], v[10:11] neg_lo:[0,1] neg_hi:[0,1]
    v_pk_fma_f32 v[8:9], v[16:17], s[26:27], v[24:25] neg_lo:[0,0,0] neg_hi:[0,0,0]
    v_pk_fma_f32 v[46:47], v[16:17], s[26:27], v[24:25] neg_lo:[1,0,0] neg_hi:[1,0,0]
    v_pk_fma_f32 v[30:31], v[18:19], s[26:27], v[40:41] op_sel:[1,0,0] op_sel_hi:[0,1,1] neg_lo:[0,0,0] neg_hi:[1,0,0]
    v_pk_fma_f32 v[34:35], v[18:19], s[26:27], v[40:41] op_sel:[1,0,0] op_sel_hi:[0,1,1] neg_lo:[1,0,0] neg_hi:[0,0,0]
    v_pk_mul_f32 v[38:39], v[8:9], v[62:63] op_sel:[0,0] op_sel_hi:[1,0]
    v_pk_mul_f32 v[12:13], v[14:15], v[64:65] op_sel:[0,0] op_sel_hi:[1,0]
    v_pk_mul_f32 v[36:37], v[30:31], v[66:67] op_sel:[0,0] op_sel_hi:[1,0]
    v_pk_mul_f32 v[42:43], v[28:29], v[68:69] op_sel:[0,0] op_sel_hi:[1,0]
    v_pk_mul_f32 v[44:45], v[46:47], v[70:71] op_sel:[0,0] op_sel_hi:[1,0]
    v_pk_mul_f32 v[26:27], v[32:33], v[72:73] op_sel:[0,0] op_sel_hi:[1,0]
    v_pk_mul_f32 v[22:23], v[34:35], v[74:75] op_sel:[0,0] op_sel_hi:[1,0]
    v_pk_fma_f32 v[38:39], v[8:9], v[62:63], v[38:39] op_sel:[1,1,0] op_sel_hi:[0,1,1] neg_lo:[1,0,0] neg_hi:[0,0,0]
    v_pk_fma_f32 v[12:13], v[14:15], v[64:65], v[12:13] op_sel:[1,1,0] op_sel_hi:[0,1,1] neg_lo:[1,0,0] neg_hi:[0,0,0]
    v_pk_fma_f32 v[36:37], v[30:31], v[66:67], v[36:37] op_sel:[1,1,0] op_sel_hi:[0,1,1] neg_lo:[1,0,0] neg_hi:[0,0,0]
    v_pk_fma_f32 v[42:43], v[28:29], v[68:69], v[42:43] op_sel:[1,1,0] op_sel_hi:[0,1,1] neg_lo:[1,0,0] neg_hi:[0,0,0]
    v_pk_fma_f32 v[44:45], v[46:47], v[70:71], v[44:45] op_sel:[1,1,0] op_sel_hi:[0,1,1] neg_lo:[1,0,0] neg_hi:[0,0,0]
    v_pk_fma_f32 v[26:27], v[32:33], v[72:73], v[26:27] op_sel:[1,1,0] op_sel_hi:[0,1,1] neg_lo:[1,0,0] neg_hi:[0,0,0]
    v_pk_fma_f32 v[22:23], v[34:35], v[74:75], v[22:23] op_sel:[1,1,0] op_sel_hi:[0,1,1] neg_lo:[1,0,0] neg_hi:[0,0,0]
    ds_write_b64 v5, v[20:21] offset:0
    s_waitcnt lgkmcnt(4)
    v_pk_add_f32 v[120:121], v[124:125], v[132:133]
    v_pk_add_f32 v[140:141], v[124:125], v[132:133] neg_lo:[0,1] neg_hi:[0,1]
    s_waitcnt lgkmcnt(3)
    v_pk_add_f32 v[122:123], v[118:119], v[136:137]
    ds_write_b64 v5, v[38:39] offset:288
    v_pk_add_f32 v[146:147], v[118:119], v[136:137] neg_lo:[0,1] neg_hi:[0,1]
    s_waitcnt lgkmcnt(3)
    v_pk_add_f32 v[112:113], v[126:127], v[114:115]
    v_pk_add_f32 v[148:149], v[126:127], v[114:115] neg_lo:[0,1] neg_hi:[0,1]
    ds_write_b64 v5, v[12:13] offset:576
    s_waitcnt lgkmcnt(3)
    v_pk_add_f32 v[150:151], v[128:129], v[144:145]
    v_pk_add_f32 v[130:131], v[128:129], v[144:145] neg_lo:[0,1] neg_hi:[0,1]
    v_pk_add_f32 v[134:135], v[120:121], v[112:113]
    ds_write_b64 v5, v[36:37] offset:864
    v_pk_add_f32 v[138:139], v[120:121], v[112:113] neg_lo:[0,1] neg_hi:[0,1]
    v_pk_add_f32 v[142:143], v[122:123], v[150:151]
    v_pk_add_f32 v[116:117], v[122:123], v[150:151] neg_lo:[0,1] neg_hi:[0,1]
    ds_write_b64 v5, v[42:43] offset:1152
    v_pk_add_f32 v[124:125], v[134:135], v[142:143]
    v_pk_add_f32 v[132:133], v[134:135], v[142:143] neg_lo:[0,1] neg_hi:[0,1]
    v_pk_add_f32 v[118:119], v[138:139], v[116:117] op_sel:[0,1] op_sel_hi:[1,0] neg_lo:[0,0] neg_hi:[0,1]
    ds_write_b64 v5, v[44:45] offset:1440
    v_pk_add_f32 v[136:137], v[138:139], v[116:117] op_sel:[0,1] op_sel_hi:[1,0] neg_lo:[0,1] neg_hi:[0,0]
    v_pk_add_f32 v[126:127], v[146:147], v[146:147] op_sel:[0,1] op_sel_hi:[1,0] neg_lo:[0,0] neg_hi:[0,1]
    v_pk_add_f32 v[114:115], v[130:131], v[130:131] op_sel:[0,1] op_sel_hi:[1,0] neg_lo:[1,0] neg_hi:[1,1]
    ds_write_b64 v5, v[26:27] offset:1728
    v_pk_add_f32 v[128:129], v[140:141], v[148:149] op_sel:[0,1] op_sel_hi:[1,0] neg_lo:[0,0] neg_hi:[0,1]
    v_pk_add_f32 v[144:145], v[140:141], v[148:149] op_sel:[0,1] op_sel_hi:[1,0] neg_lo:[0,1] neg_hi:[0,0]
    v_pk_add_f32 v[120:121], v[126:127], v[114:115]
    ds_write_b64 v5, v[22:23] offset:2016
    v_pk_add_f32 v[122:123], v[126:127], v[114:115] neg_lo:[0,1] neg_hi:[0,1]
    v_pk_fma_f32 v[112:113], v[120:121], s[26:27], v[128:129] neg_lo:[0,0,0] neg_hi:[0,0,0]
    ds_read_b64 v[10:11], v6 offset:0
    v_pk_fma_f32 v[150:151], v[120:121], s[26:27], v[128:129] neg_lo:[1,0,0] neg_hi:[1,0,0]
    v_pk_fma_f32 v[134:135], v[122:123], s[26:27], v[144:145] op_sel:[1,0,0] op_sel_hi:[0,1,1] neg_lo:[0,0,0] neg_hi:[1,0,0]
    ds_read_b64 v[24:25], v6 offset:32
    v_pk_fma_f32 v[138:139], v[122:123], s[26:27], v[144:145] op_sel:[1,0,0] op_sel_hi:[0,1,1] neg_lo:[1,0,0] neg_hi:[0,0,0]
    v_pk_mul_f32 v[142:143], v[112:113], v[62:63] op_sel:[0,0] op_sel_hi:[1,0]
    ds_read_b64 v[40:41], v6 offset:64
    v_pk_mul_f32 v[116:117], v[118:119], v[64:65] op_sel:[0,0] op_sel_hi:[1,0]
    v_pk_mul_f32 v[140:141], v[134:135], v[66:67] op_sel:[0,0] op_sel_hi:[1,0]
    ds_read_b64 v[16:17], v6 offset:96
    v_pk_mul_f32 v[146:147], v[132:133], v[68:69] op_sel:[0,0] op_sel_hi:[1,0]
    v_pk_mul_f32 v[148:149], v[150:151], v[70:71] op_sel:[0,0] op_sel_hi:[1,0]
    ds_read_b64 v[18:19], v6 offset:128
    v_pk_mul_f32 v[130:131], v[136:137], v[72:73] op_sel:[0,0] op_sel_hi:[1,0]
    v_pk_mul_f32 v[126:127], v[138:139], v[74:75] op_sel:[0,0] op_sel_hi:[1,0]
    ds_read_b64 v[8:9], v6 offset:160
    v_pk_fma_f32 v[142:143], v[112:113], v[62:63], v[142:143] op_sel:[1,1,0] op_sel_hi:[0,1,1] neg_lo:[1,0,0] neg_hi:[0,0,0]
    v_pk_fma_f32 v[116:117], v[118:119], v[64:65], v[116:117] op_sel:[1,1,0] op_sel_hi:[0,1,1] neg_lo:[1,0,0] neg_hi:[0,0,0]
    ds_read_b64 v[14:15], v6 offset:192
    v_pk_fma_f32 v[140:141], v[134:135], v[66:67], v[140:141] op_sel:[1,1,0] op_sel_hi:[0,1,1] neg_lo:[1,0,0] neg_hi:[0,0,0]
    v_pk_fma_f32 v[146:147], v[132:133], v[68:69], v[146:147] op_sel:[1,1,0] op_sel_hi:[0,1,1] neg_lo:[1,0,0] neg_hi:[0,0,0]
    ds_read_b64 v[30:31], v6 offset:224
    v_pk_fma_f32 v[148:149], v[150:151], v[70:71], v[148:149] op_sel:[1,1,0] op_sel_hi:[0,1,1] neg_lo:[1,0,0] neg_hi:[0,0,0]
    v_pk_fma_f32 v[130:131], v[136:137], v[72:73], v[130:131] op_sel:[1,1,0] op_sel_hi:[0,1,1] neg_lo:[1,0,0] neg_hi:[0,0,0]
    v_pk_fma_f32 v[126:127], v[138:139], v[74:75], v[126:127] op_sel:[1,1,0] op_sel_hi:[0,1,1] neg_lo:[1,0,0] neg_hi:[0,0,0]
    ds_write_b64 v5, v[124:125] offset:18432
    s_waitcnt lgkmcnt(4)
    v_pk_add_f32 v[28:29], v[10:11], v[18:19]
    v_pk_add_f32 v[46:47], v[10:11], v[18:19] neg_lo:[0,1] neg_hi:[0,1]
    s_waitcnt lgkmcnt(3)
    v_pk_add_f32 v[32:33], v[24:25], v[8:9]
    ds_write_b64 v5, v[142:143] offset:18720
    v_pk_add_f32 v[34:35], v[24:25], v[8:9] neg_lo:[0,1] neg_hi:[0,1]
    s_waitcnt lgkmcnt(3)
    v_pk_add_f32 v[20:21], v[40:41], v[14:15]
    v_pk_add_f32 v[38:39], v[40:41], v[14:15] neg_lo:[0,1] neg_hi:[0,1]
    ds_write_b64 v5, v[116:117] offset:19008
    s_waitcnt lgkmcnt(3)
    v_pk_add_f32 v[12:13], v[16:17], v[30:31]
    v_pk_add_f32 v[36:37], v[16:17], v[30:31] neg_lo:[0,1] neg_hi:[0,1]
    v_pk_add_f32 v[42:43], v[28:29], v[20:21]
    ds_write_b64 v5, v[140:141] offset:19296
    v_pk_add_f32 v[44:45], v[28:29], v[20:21] neg_lo:[0,1] neg_hi:[0,1]
    v_pk_add_f32 v[26:27], v[32:33], v[12:13]
    v_pk_add_f32 v[22:23], v[32:33], v[12:13] neg_lo:[0,1] neg_hi:[0,1]
    ds_write_b64 v5, v[146:147] offset:19584
    v_pk_add_f32 v[10:11], v[42:43], v[26:27]
    v_pk_add_f32 v[18:19], v[42:43], v[26:27] neg_lo:[0,1] neg_hi:[0,1]
    v_pk_add_f32 v[24:25], v[44:45], v[22:23] op_sel:[0,1] op_sel_hi:[1,0] neg_lo:[0,0] neg_hi:[0,1]
    ds_write_b64 v5, v[148:149] offset:19872
    v_pk_add_f32 v[8:9], v[44:45], v[22:23] op_sel:[0,1] op_sel_hi:[1,0] neg_lo:[0,1] neg_hi:[0,0]
    v_pk_add_f32 v[40:41], v[34:35], v[34:35] op_sel:[0,1] op_sel_hi:[1,0] neg_lo:[0,0] neg_hi:[0,1]
    v_pk_add_f32 v[14:15], v[36:37], v[36:37] op_sel:[0,1] op_sel_hi:[1,0] neg_lo:[1,0] neg_hi:[1,1]
    ds_write_b64 v5, v[130:131] offset:20160
    v_pk_add_f32 v[16:17], v[46:47], v[38:39] op_sel:[0,1] op_sel_hi:[1,0] neg_lo:[0,0] neg_hi:[0,1]
    v_pk_add_f32 v[30:31], v[46:47], v[38:39] op_sel:[0,1] op_sel_hi:[1,0] neg_lo:[0,1] neg_hi:[0,0]
    v_pk_add_f32 v[28:29], v[40:41], v[14:15]
    ds_write_b64 v5, v[126:127] offset:20448
    v_pk_add_f32 v[32:33], v[40:41], v[14:15] neg_lo:[0,1] neg_hi:[0,1]
    v_pk_fma_f32 v[20:21], v[28:29], s[26:27], v[16:17] neg_lo:[0,0,0] neg_hi:[0,0,0]
    ds_read_b64 v[114:115], v6 offset:18432
    v_pk_fma_f32 v[12:13], v[28:29], s[26:27], v[16:17] neg_lo:[1,0,0] neg_hi:[1,0,0]
    v_pk_fma_f32 v[42:43], v[32:33], s[26:27], v[30:31] op_sel:[1,0,0] op_sel_hi:[0,1,1] neg_lo:[0,0,0] neg_hi:[1,0,0]
    ds_read_b64 v[128:129], v6 offset:18464
    v_pk_fma_f32 v[44:45], v[32:33], s[26:27], v[30:31] op_sel:[1,0,0] op_sel_hi:[0,1,1] neg_lo:[1,0,0] neg_hi:[0,0,0]
    v_pk_mul_f32 v[26:27], v[20:21], v[76:77] op_sel:[0,0] op_sel_hi:[1,0]
    ds_read_b64 v[144:145], v6 offset:18496
    v_pk_mul_f32 v[22:23], v[24:25], v[78:79] op_sel:[0,0] op_sel_hi:[1,0]
    v_pk_mul_f32 v[46:47], v[42:43], v[80:81] op_sel:[0,0] op_sel_hi:[1,0]
    ds_read_b64 v[120:121], v6 offset:18528
    v_pk_mul_f32 v[34:35], v[18:19], v[82:83] op_sel:[0,0] op_sel_hi:[1,0]
    v_pk_mul_f32 v[38:39], v[12:13], v[84:85] op_sel:[0,0] op_sel_hi:[1,0]
    ds_read_b64 v[122:123], v6 offset:18560
    v_pk_mul_f32 v[36:37], v[8:9], v[86:87] op_sel:[0,0] op_sel_hi:[1,0]
    v_pk_mul_f32 v[40:41], v[44:45], v[88:89] op_sel:[0,0] op_sel_hi:[1,0]
    ds_read_b64 v[112:113], v6 offset:18592
    v_pk_fma_f32 v[26:27], v[20:21], v[76:77], v[26:27] op_sel:[1,1,0] op_sel_hi:[0,1,1] neg_lo:[1,0,0] neg_hi:[0,0,0]
    v_pk_fma_f32 v[22:23], v[24:25], v[78:79], v[22:23] op_sel:[1,1,0] op_sel_hi:[0,1,1] neg_lo:[1,0,0] neg_hi:[0,0,0]
    ds_read_b64 v[118:119], v6 offset:18624
    v_pk_fma_f32 v[46:47], v[42:43], v[80:81], v[46:47] op_sel:[1,1,0] op_sel_hi:[0,1,1] neg_lo:[1,0,0] neg_hi:[0,0,0]
    v_pk_fma_f32 v[34:35], v[18:19], v[82:83], v[34:35] op_sel:[1,1,0] op_sel_hi:[0,1,1] neg_lo:[1,0,0] neg_hi:[0,0,0]
    ds_read_b64 v[134:135], v6 offset:18656
    v_pk_fma_f32 v[38:39], v[12:13], v[84:85], v[38:39] op_sel:[1,1,0] op_sel_hi:[0,1,1] neg_lo:[1,0,0] neg_hi:[0,0,0]
    v_pk_fma_f32 v[36:37], v[8:9], v[86:87], v[36:37] op_sel:[1,1,0] op_sel_hi:[0,1,1] neg_lo:[1,0,0] neg_hi:[0,0,0]
    v_pk_fma_f32 v[40:41], v[44:45], v[88:89], v[40:41] op_sel:[1,1,0] op_sel_hi:[0,1,1] neg_lo:[1,0,0] neg_hi:[0,0,0]
    ds_write_b64 v6, v[10:11] offset:0
    s_waitcnt lgkmcnt(4)
    v_pk_add_f32 v[132:133], v[114:115], v[122:123]
    v_pk_add_f32 v[150:151], v[114:115], v[122:123] neg_lo:[0,1] neg_hi:[0,1]
    s_waitcnt lgkmcnt(3)
    v_pk_add_f32 v[136:137], v[128:129], v[112:113]
    ds_write_b64 v6, v[26:27] offset:32
    v_pk_add_f32 v[138:139], v[128:129], v[112:113] neg_lo:[0,1] neg_hi:[0,1]
    s_waitcnt lgkmcnt(3)
    v_pk_add_f32 v[124:125], v[144:145], v[118:119]
    v_pk_add_f32 v[142:143], v[144:145], v[118:119] neg_lo:[0,1] neg_hi:[0,1]
    ds_write_b64 v6, v[22:23] offset:64
    s_waitcnt lgkmcnt(3)
    v_pk_add_f32 v[116:117], v[120:121], v[134:135]
    v_pk_add_f32 v[140:141], v[120:121], v[134:135] neg_lo:[0,1] neg_hi:[0,1]
    v_pk_add_f32 v[146:147], v[132:133], v[124:125]
    ds_write_b64 v6, v[46:47] offset:96
    v_pk_add_f32 v[148:149], v[132:133], v[124:125] neg_lo:[0,1] neg_hi:[0,1]
    v_pk_add_f32 v[130:131], v[136:137], v[116:117]
    v_pk_add_f32 v[126:127], v[136:137], v[116:117] neg_lo:[0,1] neg_hi:[0,1]
    ds_write_b64 v6, v[34:35] offset:128
    v_pk_add_f32 v[114:115], v[146:147], v[130:131]
    v_pk_add_f32 v[122:123], v[146:147], v[130:131] neg_lo:[0,1] neg_hi:[0,1]
    v_pk_add_f32 v[128:129], v[148:149], v[126:127] op_sel:[0,1] op_sel_hi:[1,0] neg_lo:[0,0] neg_hi:[0,1]
    ds_write_b64 v6, v[38:39] offset:160
    v_pk_add_f32 v[112:113], v[148:149], v[126:127] op_sel:[0,1] op_sel_hi:[1,0] neg_lo:[0,1] neg_hi:[0,0]
    v_pk_add_f32 v[144:145], v[138:139], v[138:139] op_sel:[0,1] op_sel_hi:[1,0] neg_lo:[0,0] neg_hi:[0,1]
    v_pk_add_f32 v[118:119], v[140:141], v[140:141] op_sel:[0,1] op_sel_hi:[1,0] neg_lo:[1,0] neg_hi:[1,1]
    ds_write_b64 v6, v[36:37] offset:192
    v_pk_add_f32 v[120:121], v[150:151], v[142:143] op_sel:[0,1] op_sel_hi:[1,0] neg_lo:[0,0] neg_hi:[0,1]
    v_pk_add_f32 v[134:135], v[150:151], v[142:143] op_sel:[0,1] op_sel_hi:[1,0] neg_lo:[0,1] neg_hi:[0,0]
    v_pk_add_f32 v[132:133], v[144:145], v[118:119]
    ds_write_b64 v6, v[40:41] offset:224
    v_pk_add_f32 v[136:137], v[144:145], v[118:119] neg_lo:[0,1] neg_hi:[0,1]
    v_pk_fma_f32 v[124:125], v[132:133], s[26:27], v[120:121] neg_lo:[0,0,0] neg_hi:[0,0,0]
    ds_read_b64 v[14:15], v100 offset:0
    v_pk_fma_f32 v[116:117], v[132:133], s[26:27], v[120:121] neg_lo:[1,0,0] neg_hi:[1,0,0]
    v_pk_fma_f32 v[146:147], v[136:137], s[26:27], v[134:135] op_sel:[1,0,0] op_sel_hi:[0,1,1] neg_lo:[0,0,0] neg_hi:[1,0,0]
    ds_read_b64 v[16:17], v100 offset:8
    v_pk_fma_f32 v[148:149], v[136:137], s[26:27], v[134:135] op_sel:[1,0,0] op_sel_hi:[0,1,1] neg_lo:[1,0,0] neg_hi:[0,0,0]
    v_pk_mul_f32 v[130:131], v[124:125], v[76:77] op_sel:[0,0] op_sel_hi:[1,0]
    ds_read_b64 v[30:31], v100 offset:16
    v_pk_mul_f32 v[126:127], v[128:129], v[78:79] op_sel:[0,0] op_sel_hi:[1,0]
    v_pk_mul_f32 v[150:151], v[146:147], v[80:81] op_sel:[0,0] op_sel_hi:[1,0]
    ds_read_b64 v[28:29], v100 offset:24
    v_pk_mul_f32 v[138:139], v[122:123], v[82:83] op_sel:[0,0] op_sel_hi:[1,0]
    v_pk_mul_f32 v[142:143], v[116:117], v[84:85] op_sel:[0,0] op_sel_hi:[1,0]
    ds_read_b64 v[32:33], v100 offset:32
    v_pk_mul_f32 v[140:141], v[112:113], v[86:87] op_sel:[0,0] op_sel_hi:[1,0]
    v_pk_mul_f32 v[144:145], v[148:149], v[88:89] op_sel:[0,0] op_sel_hi:[1,0]
    ds_read_b64 v[20:21], v100 offset:40
    v_pk_fma_f32 v[130:131], v[124:125], v[76:77], v[130:131] op_sel:[1,1,0] op_sel_hi:[0,1,1] neg_lo:[1,0,0] neg_hi:[0,0,0]
    v_pk_fma_f32 v[126:127], v[128:129], v[78:79], v[126:127] op_sel:[1,1,0] op_sel_hi:[0,1,1] neg_lo:[1,0,0] neg_hi:[0,0,0]
    ds_read_b64 v[24:25], v100 offset:48
    v_pk_fma_f32 v[150:151], v[146:147], v[80:81], v[150:151] op_sel:[1,1,0] op_sel_hi:[0,1,1] neg_lo:[1,0,0] neg_hi:[0,0,0]
    v_pk_fma_f32 v[138:139], v[122:123], v[82:83], v[138:139] op_sel:[1,1,0] op_sel_hi:[0,1,1] neg_lo:[1,0,0] neg_hi:[0,0,0]
    ds_read_b64 v[42:43], v100 offset:56
    v_pk_fma_f32 v[142:143], v[116:117], v[84:85], v[142:143] op_sel:[1,1,0] op_sel_hi:[0,1,1] neg_lo:[1,0,0] neg_hi:[0,0,0]
    v_pk_fma_f32 v[140:141], v[112:113], v[86:87], v[140:141] op_sel:[1,1,0] op_sel_hi:[0,1,1] neg_lo:[1,0,0] neg_hi:[0,0,0]
    v_pk_fma_f32 v[144:145], v[148:149], v[88:89], v[144:145] op_sel:[1,1,0] op_sel_hi:[0,1,1] neg_lo:[1,0,0] neg_hi:[0,0,0]
    ds_write_b64 v6, v[114:115] offset:18432
    s_waitcnt lgkmcnt(6)
    v_pk_add_f32 v[18:19], v[14:15], v[30:31]
    v_pk_add_f32 v[12:13], v[14:15], v[30:31] neg_lo:[0,1] neg_hi:[0,1]
    s_waitcnt lgkmcnt(5)
    v_pk_add_f32 v[8:9], v[16:17], v[28:29]
    ds_write_b64 v6, v[130:131] offset:18464
    v_pk_add_f32 v[44:45], v[16:17], v[28:29] neg_lo:[0,1] neg_hi:[0,1]
    v_pk_add_f32 v[10:11], v[18:19], v[8:9]
    v_pk_add_f32 v[26:27], v[18:19], v[8:9] neg_lo:[0,1] neg_hi:[0,1]
    ds_write_b64 v6, v[126:127] offset:18496
    v_pk_add_f32 v[22:23], v[12:13], v[44:45] op_sel:[0,1] op_sel_hi:[1,0] neg_lo:[0,0] neg_hi:[0,1]
    v_pk_add_f32 v[46:47], v[12:13], v[44:45] op_sel:[0,1] op_sel_hi:[1,0] neg_lo:[0,1] neg_hi:[0,0]
    s_waitcnt lgkmcnt(4)
    v_pk_add_f32 v[34:35], v[32:33], v[24:25]
    ds_write_b64 v6, v[150:151] offset:18528
    v_pk_add_f32 v[38:39], v[32:33], v[24:25] neg_lo:[0,1] neg_hi:[0,1]
    s_waitcnt lgkmcnt(4)
    v_pk_add_f32 v[36:37], v[20:21], v[42:43]
    v_pk_add_f32 v[40:41], v[20:21], v[42:43] neg_lo:[0,1] neg_hi:[0,1]
    ds_write_b64 v6, v[138:139] offset:18560
    v_pk_add_f32 v[14:15], v[34:35], v[36:37]
    v_pk_add_f32 v[16:17], v[34:35], v[36:37] neg_lo:[0,1] neg_hi:[0,1]
    v_pk_add_f32 v[30:31], v[38:39], v[40:41] op_sel:[0,1] op_sel_hi:[1,0] neg_lo:[0,0] neg_hi:[0,1]
    ds_write_b64 v6, v[142:143] offset:18592
    v_pk_add_f32 v[28:29], v[38:39], v[40:41] op_sel:[0,1] op_sel_hi:[1,0] neg_lo:[0,1] neg_hi:[0,0]
    v_lshlrev_b32 v18, 16, v92
    v_and_b32 v19, 0xffff0000, v92
    ds_write_b64 v6, v[140:141] offset:18624
    v_lshlrev_b32 v12, 16, v93
    v_and_b32 v13, 0xffff0000, v93
    v_lshlrev_b32 v8, 16, v94
    ds_write_b64 v6, v[144:145] offset:18656
    v_and_b32 v9, 0xffff0000, v94
    v_lshlrev_b32 v44, 16, v95
    ds_read_b64 v[118:119], v100 offset:18432
    v_and_b32 v45, 0xffff0000, v95
    v_pk_mul_f32 v[32:33], v[10:11], v[18:19] op_sel:[0,0] op_sel_hi:[1,0]
    ds_read_b64 v[120:121], v100 offset:18440
    v_pk_mul_f32 v[20:21], v[22:23], v[12:13] op_sel:[0,0] op_sel_hi:[1,0]
    v_pk_mul_f32 v[24:25], v[26:27], v[8:9] op_sel:[0,0] op_sel_hi:[1,0]
    ds_read_b64 v[134:135], v100 offset:18448
    v_pk_mul_f32 v[42:43], v[46:47], v[44:45] op_sel:[0,0] op_sel_hi:[1,0]
    v_pk_fma_f32 v[32:33], v[10:11], v[18:19], v[32:33] op_sel:[1,1,0] op_sel_hi:[0,1,1] neg_lo:[1,0,0] neg_hi:[0,0,0]
    ds_read_b64 v[132:133], v100 offset:18456
    v_pk_fma_f32 v[20:21], v[22:23], v[12:13], v[20:21] op_sel:[1,1,0] op_sel_hi:[0,1,1] neg_lo:[1,0,0] neg_hi:[0,0,0]
    v_pk_fma_f32 v[24:25], v[26:27], v[8:9], v[24:25] op_sel:[1,1,0] op_sel_hi:[0,1,1] neg_lo:[1,0,0] neg_hi:[0,0,0]
    ds_read_b64 v[136:137], v100 offset:18464
    v_pk_fma_f32 v[42:43], v[46:47], v[44:45], v[42:43] op_sel:[1,1,0] op_sel_hi:[0,1,1] neg_lo:[1,0,0] neg_hi:[0,0,0]
    v_lshlrev_b32 v34, 16, v96
    ds_read_b64 v[124:125], v100 offset:18472
    v_and_b32 v35, 0xffff0000, v96
    v_lshlrev_b32 v38, 16, v97
    ds_read_b64 v[128:129], v100 offset:18480
    v_and_b32 v39, 0xffff0000, v97
    v_lshlrev_b32 v36, 16, v98
    ds_read_b64 v[146:147], v100 offset:18488
    v_and_b32 v37, 0xffff0000, v98
    v_lshlrev_b32 v40, 16, v99
    v_and_b32 v41, 0xffff0000, v99
    v_pk_mul_f32 v[10:11], v[14:15], v[34:35] op_sel:[0,0] op_sel_hi:[1,0]
    v_pk_mul_f32 v[22:23], v[30:31], v[38:39] op_sel:[0,0] op_sel_hi:[1,0]
    v_pk_mul_f32 v[26:27], v[16:17], v[36:37] op_sel:[0,0] op_sel_hi:[1,0]
    v_pk_mul_f32 v[46:47], v[28:29], v[40:41] op_sel:[0,0] op_sel_hi:[1,0]
    v_pk_fma_f32 v[10:11], v[14:15], v[34:35], v[10:11] op_sel:[1,1,0] op_sel_hi:[0,1,1] neg_lo:[1,0,0] neg_hi:[0,0,0]
    v_pk_fma_f32 v[22:23], v[30:31], v[38:39], v[22:23] op_sel:[1,1,0] op_sel_hi:[0,1,1] neg_lo:[1,0,0] neg_hi:[0,0,0]
    v_pk_fma_f32 v[26:27], v[16:17], v[36:37], v[26:27] op_sel:[1,1,0] op_sel_hi:[0,1,1] neg_lo:[1,0,0] neg_hi:[0,0,0]
    v_pk_fma_f32 v[46:47], v[28:29], v[40:41], v[46:47] op_sel:[1,1,0] op_sel_hi:[0,1,1] neg_lo:[1,0,0] neg_hi:[0,0,0]
    v_pk_add_f32 v[18:19], v[32:33], v[24:25]
    v_pk_add_f32 v[12:13], v[32:33], v[24:25] neg_lo:[0,1] neg_hi:[0,1]
    v_pk_add_f32 v[8:9], v[20:21], v[42:43]
    v_pk_add_f32 v[44:45], v[20:21], v[42:43] neg_lo:[0,1] neg_hi:[0,1]
    v_pk_add_f32 v[14:15], v[18:19], v[8:9]
    v_pk_add_f32 v[30:31], v[18:19], v[8:9] neg_lo:[0,1] neg_hi:[0,1]
    v_pk_add_f32 v[16:17], v[12:13], v[44:45] op_sel:[0,1] op_sel_hi:[1,0] neg_lo:[0,1] neg_hi:[0,0]
    v_pk_add_f32 v[28:29], v[12:13], v[44:45] op_sel:[0,1] op_sel_hi:[1,0] neg_lo:[0,0] neg_hi:[0,1]
    v_pk_add_f32 v[34:35], v[10:11], v[26:27]
    v_pk_add_f32 v[38:39], v[10:11], v[26:27] neg_lo:[0,1] neg_hi:[0,1]
    v_pk_add_f32 v[36:37], v[22:23], v[46:47]
    v_pk_add_f32 v[40:41], v[22:23], v[46:47] neg_lo:[0,1] neg_hi:[0,1]
    v_pk_add_f32 v[32:33], v[34:35], v[36:37]
    v_pk_add_f32 v[20:21], v[34:35], v[36:37] neg_lo:[0,1] neg_hi:[0,1]
    v_pk_add_f32 v[24:25], v[38:39], v[40:41] op_sel:[0,1] op_sel_hi:[1,0] neg_lo:[0,1] neg_hi:[0,0]
    v_pk_add_f32 v[42:43], v[38:39], v[40:41] op_sel:[0,1] op_sel_hi:[1,0] neg_lo:[0,0] neg_hi:[0,1]
    ds_write_b64 v100, v[14:15] offset:0
    s_waitcnt lgkmcnt(6)
    v_pk_add_f32 v[122:123], v[118:119], v[134:135]
    v_pk_add_f32 v[116:117], v[118:119], v[134:135] neg_lo:[0,1] neg_hi:[0,1]
    s_waitcnt lgkmcnt(5)
    v_pk_add_f32 v[112:113], v[120:121], v[132:133]
    ds_write_b64 v100, v[16:17] offset:8
    v_pk_add_f32 v[148:149], v[120:121], v[132:133] neg_lo:[0,1] neg_hi:[0,1]
    v_pk_add_f32 v[114:115], v[122:123], v[112:113]
    v_pk_add_f32 v[130:131], v[122:123], v[112:113] neg_lo:[0,1] neg_hi:[0,1]
    ds_write_b64 v100, v[30:31] offset:16
    v_pk_add_f32 v[126:127], v[116:117], v[148:149] op_sel:[0,1] op_sel_hi:[1,0] neg_lo:[0,0] neg_hi:[0,1]
    v_pk_add_f32 v[150:151], v[116:117], v[148:149] op_sel:[0,1] op_sel_hi:[1,0] neg_lo:[0,1] neg_hi:[0,0]
    s_waitcnt lgkmcnt(4)
    v_pk_add_f32 v[138:139], v[136:137], v[128:129]
    ds_write_b64 v100, v[28:29] offset:24
    v_pk_add_f32 v[142:143], v[136:137], v[128:129] neg_lo:[0,1] neg_hi:[0,1]
    s_waitcnt lgkmcnt(4)
    v_pk_add_f32 v[140:141], v[124:125], v[146:147]
    v_pk_add_f32 v[144:145], v[124:125], v[146:147] neg_lo:[0,1] neg_hi:[0,1]
    ds_write_b64 v100, v[32:33] offset:32
    v_pk_add_f32 v[118:119], v[138:139], v[140:141]
    v_pk_add_f32 v[120:121], v[138:139], v[140:141] neg_lo:[0,1] neg_hi:[0,1]
    v_pk_add_f32 v[134:135], v[142:143], v[144:145] op_sel:[0,1] op_sel_hi:[1,0] neg_lo:[0,0] neg_hi:[0,1]
    ds_write_b64 v100, v[24:25] offset:40
    v_pk_add_f32 v[132:133], v[142:143], v[144:145] op_sel:[0,1] op_sel_hi:[1,0] neg_lo:[0,1] neg_hi:[0,0]
    v_lshlrev_b32 v122, 16, v104
    v_and_b32 v123, 0xffff0000, v104
    ds_write_b64 v100, v[20:21] offset:48
    v_lshlrev_b32 v116, 16, v105
    v_and_b32 v117, 0xffff0000, v105
    v_lshlrev_b32 v112, 16, v106
    ds_write_b64 v100, v[42:43] offset:56
    v_and_b32 v113, 0xffff0000, v106
    v_lshlrev_b32 v148, 16, v107
    ds_read_b64 v[18:19], v6 offset:0
    v_and_b32 v149, 0xffff0000, v107
    v_pk_mul_f32 v[136:137], v[114:115], v[122:123] op_sel:[0,0] op_sel_hi:[1,0]
    ds_read_b64 v[12:13], v6 offset:32
    v_pk_mul_f32 v[124:125], v[126:127], v[116:117] op_sel:[0,0] op_sel_hi:[1,0]
    v_pk_mul_f32 v[128:129], v[130:131], v[112:113] op_sel:[0,0] op_sel_hi:[1,0]
    ds_read_b64 v[8:9], v6 offset:64
    v_pk_mul_f32 v[146:147], v[150:151], v[148:149] op_sel:[0,0] op_sel_hi:[1,0]
    v_pk_fma_f32 v[136:137], v[114:115], v[122:123], v[136:137] op_sel:[1,1,0] op_sel_hi:[0,1,1] neg_lo:[1,0,0] neg_hi:[0,0,0]
    ds_read_b64 v[44:45], v6 offset:96
    v_pk_fma_f32 v[124:125], v[126:127], v[116:117], v[124:125] op_sel:[1,1,0] op_sel_hi:[0,1,1] neg_lo:[1,0,0] neg_hi:[0,0,0]
    v_pk_fma_f32 v[128:129], v[130:131], v[112:113], v[128:129] op_sel:[1,1,0] op_sel_hi:[0,1,1] neg_lo:[1,0,0] neg_hi:[0,0,0]
    ds_read_b64 v[10:11], v6 offset:128
    v_pk_fma_f32 v[146:147], v[150:151], v[148:149], v[146:147] op_sel:[1,1,0] op_sel_hi:[0,1,1] neg_lo:[1,0,0] neg_hi:[0,0,0]
    v_lshlrev_b32 v138, 16, v108
    ds_read_b64 v[22:23], v6 offset:160
    v_and_b32 v139, 0xffff0000, v108
    v_lshlrev_b32 v142, 16, v109
    ds_read_b64 v[26:27], v6 offset:192
    v_and_b32 v143, 0xffff0000, v109
    v_lshlrev_b32 v140, 16, v110
    ds_read_b64 v[46:47], v6 offset:224
    v_and_b32 v141, 0xffff0000, v110
    v_lshlrev_b32 v144, 16, v111
    v_and_b32 v145, 0xffff0000, v111
    v_pk_mul_f32 v[114:115], v[118:119], v[138:139] op_sel:[0,0] op_sel_hi:[1,0]
    v_pk_mul_f32 v[126:127], v[134:135], v[142:143] op_sel:[0,0] op_sel_hi:[1,0]
    v_pk_mul_f32 v[130:131], v[120:121], v[140:141] op_sel:[0,0] op_sel_hi:[1,0]
    v_pk_mul_f32 v[150:151], v[132:133], v[144:145] op_sel:[0,0] op_sel_hi:[1,0]
    v_pk_fma_f32 v[114:115], v[118:119], v[138:139], v[114:115] op_sel:[1,1,0] op_sel_hi:[0,1,1] neg_lo:[1,0,0] neg_hi:[0,0,0]
    v_pk_fma_f32 v[126:127], v[134:135], v[142:143], v[126:127] op_sel:[1,1,0] op_sel_hi:[0,1,1] neg_lo:[1,0,0] neg_hi:[0,0,0]
    v_pk_fma_f32 v[130:131], v[120:121], v[140:141], v[130:131] op_sel:[1,1,0] op_sel_hi:[0,1,1] neg_lo:[1,0,0] neg_hi:[0,0,0]
    v_pk_fma_f32 v[150:151], v[132:133], v[144:145], v[150:151] op_sel:[1,1,0] op_sel_hi:[0,1,1] neg_lo:[1,0,0] neg_hi:[0,0,0]
    v_pk_add_f32 v[122:123], v[136:137], v[128:129]
    v_pk_add_f32 v[116:117], v[136:137], v[128:129] neg_lo:[0,1] neg_hi:[0,1]
    v_pk_add_f32 v[112:113], v[124:125], v[146:147]
    v_pk_add_f32 v[148:149], v[124:125], v[146:147] neg_lo:[0,1] neg_hi:[0,1]
    v_pk_add_f32 v[118:119], v[122:123], v[112:113]
    v_pk_add_f32 v[134:135], v[122:123], v[112:113] neg_lo:[0,1] neg_hi:[0,1]
    v_pk_add_f32 v[120:121], v[116:117], v[148:149] op_sel:[0,1] op_sel_hi:[1,0] neg_lo:[0,1] neg_hi:[0,0]
    v_pk_add_f32 v[132:133], v[116:117], v[148:149] op_sel:[0,1] op_sel_hi:[1,0] neg_lo:[0,0] neg_hi:[0,1]
    v_pk_add_f32 v[138:139], v[114:115], v[130:131]
    v_pk_add_f32 v[142:143], v[114:115], v[130:131] neg_lo:[0,1] neg_hi:[0,1]
    v_pk_add_f32 v[140:141], v[126:127], v[150:151]
    v_pk_add_f32 v[144:145], v[126:127], v[150:151] neg_lo:[0,1] neg_hi:[0,1]
    v_pk_add_f32 v[136:137], v[138:139], v[140:141]
    v_pk_add_f32 v[124:125], v[138:139], v[140:141] neg_lo:[0,1] neg_hi:[0,1]
    v_pk_add_f32 v[128:129], v[142:143], v[144:145] op_sel:[0,1] op_sel_hi:[1,0] neg_lo:[0,1] neg_hi:[0,0]
    v_pk_add_f32 v[146:147], v[142:143], v[144:145] op_sel:[0,1] op_sel_hi:[1,0] neg_lo:[0,0] neg_hi:[0,1]
    ds_write_b64 v100, v[118:119] offset:18432
    s_waitcnt lgkmcnt(7)
    v_pk_mul_f32 v[34:35], v[12:13], v[76:77] op_sel:[0,0] op_sel_hi:[1,0]
    s_waitcnt lgkmcnt(6)
    v_pk_mul_f32 v[38:39], v[8:9], v[78:79] op_sel:[0,0] op_sel_hi:[1,0]
    s_waitcnt lgkmcnt(5)
    v_pk_mul_f32 v[36:37], v[44:45], v[80:81] op_sel:[0,0] op_sel_hi:[1,0]
    ds_write_b64 v100, v[120:121] offset:18440
    s_waitcnt lgkmcnt(5)
    v_pk_mul_f32 v[40:41], v[10:11], v[82:83] op_sel:[0,0] op_sel_hi:[1,0]
    s_waitcnt lgkmcnt(4)
    v_pk_mul_f32 v[14:15], v[22:23], v[84:85] op_sel:[0,0] op_sel_hi:[1,0]
    s_waitcnt lgkmcnt(3)
    v_pk_mul_f32 v[16:17], v[26:27], v[86:87] op_sel:[0,0] op_sel_hi:[1,0]
    ds_write_b64 v100, v[134:135] offset:18448
    s_waitcnt lgkmcnt(3)
    v_pk_mul_f32 v[30:31], v[46:47], v[88:89] op_sel:[0,0] op_sel_hi:[1,0]
    v_pk_fma_f32 v[34:35], v[12:13], v[76:77], v[34:35] op_sel:[1,1,0] op_sel_hi:[0,1,1] neg_lo:[0,0,0] neg_hi:[1,0,0]
    v_pk_fma_f32 v[38:39], v[8:9], v[78:79], v[38:39] op_sel:[1,1,0] op_sel_hi:[0,1,1] neg_lo:[0,0,0] neg_hi:[1,0,0]
    ds_write_b64 v100, v[132:133] offset:18456
    v_pk_fma_f32 v[36:37], v[44:45], v[80:81], v[36:37] op_sel:[1,1,0] op_sel_hi:[0,1,1] neg_lo:[0,0,0] neg_hi:[1,0,0]
    v_pk_fma_f32 v[40:41], v[10:11], v[82:83], v[40:41] op_sel:[1,1,0] op_sel_hi:[0,1,1] neg_lo:[0,0,0] neg_hi:[1,0,0]
    v_pk_fma_f32 v[14:15], v[22:23], v[84:85], v[14:15] op_sel:[1,1,0] op_sel_hi:[0,1,1] neg_lo:[0,0,0] neg_hi:[1,0,0]
    ds_write_b64 v100, v[136:137] offset:18464
    v_pk_fma_f32 v[16:17], v[26:27], v[86:87], v[16:17] op_sel:[1,1,0] op_sel_hi:[0,1,1] neg_lo:[0,0,0] neg_hi:[1,0,0]
    v_pk_fma_f32 v[30:31], v[46:47], v[88:89], v[30:31] op_sel:[1,1,0] op_sel_hi:[0,1,1] neg_lo:[0,0,0] neg_hi:[1,0,0]
    v_pk_add_f32 v[28:29], v[18:19], v[40:41]
    ds_write_b64 v100, v[128:129] offset:18472
    v_pk_add_f32 v[32:33], v[18:19], v[40:41] neg_lo:[0,1] neg_hi:[0,1]
    v_pk_add_f32 v[24:25], v[34:35], v[14:15]
    v_pk_add_f32 v[20:21], v[34:35], v[14:15] neg_lo:[0,1] neg_hi:[0,1]
    ds_write_b64 v100, v[124:125] offset:18480
    v_pk_add_f32 v[42:43], v[38:39], v[16:17]
    v_pk_add_f32 v[12:13], v[38:39], v[16:17] neg_lo:[0,1] neg_hi:[0,1]
    v_pk_add_f32 v[8:9], v[36:37], v[30:31]
    ds_write_b64 v100, v[146:147] offset:18488
    v_pk_add_f32 v[44:45], v[36:37], v[30:31] neg_lo:[0,1] neg_hi:[0,1]
    v_pk_add_f32 v[10:11], v[28:29], v[42:43]
    ds_read_b64 v[122:123], v6 offset:18432
    v_pk_add_f32 v[22:23], v[28:29], v[42:43] neg_lo:[0,1] neg_hi:[0,1]
    v_pk_add_f32 v[26:27], v[24:25], v[8:9]
    ds_read_b64 v[116:117], v6 offset:18464
    v_pk_add_f32 v[46:47], v[24:25], v[8:9] neg_lo:[0,1] neg_hi:[0,1]
    v_pk_add_f32 v[18:19], v[10:11], v[26:27]
    ds_read_b64 v[112:113], v6 offset:18496
    v_pk_add_f32 v[40:41], v[10:11], v[26:27] neg_lo:[0,1] neg_hi:[0,1]
    v_pk_add_f32 v[34:35], v[22:23], v[46:47] op_sel:[0,1] op_sel_hi:[1,0] neg_lo:[0,1] neg_hi:[0,0]
    ds_read_b64 v[148:149], v6 offset:18528
    v_pk_add_f32 v[14:15], v[22:23], v[46:47] op_sel:[0,1] op_sel_hi:[1,0] neg_lo:[0,0] neg_hi:[0,1]
    v_pk_add_f32 v[38:39], v[20:21], v[20:21] op_sel:[0,1] op_sel_hi:[1,0] neg_lo:[0,1] neg_hi:[0,0]
    ds_read_b64 v[114:115], v6 offset:18560
    v_pk_add_f32 v[16:17], v[44:45], v[44:45] op_sel:[0,1] op_sel_hi:[1,0] neg_lo:[1,1] neg_hi:[1,0]
    v_pk_add_f32 v[36:37], v[32:33], v[12:13] op_sel:[0,1] op_sel_hi:[1,0] neg_lo:[0,1] neg_hi:[0,0]
    ds_read_b64 v[126:127], v6 offset:18592
    v_pk_add_f32 v[30:31], v[32:33], v[12:13] op_sel:[0,1] op_sel_hi:[1,0] neg_lo:[0,0] neg_hi:[0,1]
    v_pk_add_f32 v[28:29], v[38:39], v[16:17]
    ds_read_b64 v[130:131], v6 offset:18624
    v_pk_add_f32 v[24:25], v[38:39], v[16:17] neg_lo:[0,1] neg_hi:[0,1]
    v_pk_fma_f32 v[42:43], v[28:29], s[26:27], v[36:37] neg_lo:[0,0,0] neg_hi:[0,0,0]
    ds_read_b64 v[150:151], v6 offset:18656
    v_pk_fma_f32 v[8:9], v[28:29], s[26:27], v[36:37] neg_lo:[1,0,0] neg_hi:[1,0,0]
    v_pk_fma_f32 v[10:11], v[24:25], s[26:27], v[30:31] op_sel:[1,0,0] op_sel_hi:[0,1,1] neg_lo:[1,0,0] neg_hi:[0,0,0]
    v_pk_fma_f32 v[22:23], v[24:25], s[26:27], v[30:31] op_sel:[1,0,0] op_sel_hi:[0,1,1] neg_lo:[0,0,0] neg_hi:[1,0,0]
    ds_write_b64 v6, v[18:19] offset:0
    s_waitcnt lgkmcnt(7)
    v_pk_mul_f32 v[138:139], v[116:117], v[76:77] op_sel:[0,0] op_sel_hi:[1,0]
    s_waitcnt lgkmcnt(6)
    v_pk_mul_f32 v[142:143], v[112:113], v[78:79] op_sel:[0,0] op_sel_hi:[1,0]
    s_waitcnt lgkmcnt(5)
    v_pk_mul_f32 v[140:141], v[148:149], v[80:81] op_sel:[0,0] op_sel_hi:[1,0]
    ds_write_b64 v6, v[42:43] offset:32
    s_waitcnt lgkmcnt(5)
    v_pk_mul_f32 v[144:145], v[114:115], v[82:83] op_sel:[0,0] op_sel_hi:[1,0]
    s_waitcnt lgkmcnt(4)
    v_pk_mul_f32 v[118:119], v[126:127], v[84:85] op_sel:[0,0] op_sel_hi:[1,0]
    s_waitcnt lgkmcnt(3)
    v_pk_mul_f32 v[120:121], v[130:131], v[86:87] op_sel:[0,0] op_sel_hi:[1,0]
    ds_write_b64 v6, v[34:35] offset:64
    s_waitcnt lgkmcnt(3)
    v_pk_mul_f32 v[134:135], v[150:151], v[88:89] op_sel:[0,0] op_sel_hi:[1,0]
    v_pk_fma_f32 v[138:139], v[116:117], v[76:77], v[138:139] op_sel:[1,1,0] op_sel_hi:[0,1,1] neg_lo:[0,0,0] neg_hi:[1,0,0]
    v_pk_fma_f32 v[142:143], v[112:113], v[78:79], v[142:143] op_sel:[1,1,0] op_sel_hi:[0,1,1] neg_lo:[0,0,0] neg_hi:[1,0,0]
    ds_write_b64 v6, v[10:11] offset:96
    v_pk_fma_f32 v[140:141], v[148:149], v[80:81], v[140:141] op_sel:[1,1,0] op_sel_hi:[0,1,1] neg_lo:[0,0,0] neg_hi:[1,0,0]
    v_pk_fma_f32 v[144:145], v[114:115], v[82:83], v[144:145] op_sel:[1,1,0] op_sel_hi:[0,1,1] neg_lo:[0,0,0] neg_hi:[1,0,0]
    v_pk_fma_f32 v[118:119], v[126:127], v[84:85], v[118:119] op_sel:[1,1,0] op_sel_hi:[0,1,1] neg_lo:[0,0,0] neg_hi:[1,0,0]
    ds_write_b64 v6, v[40:41] offset:128
    v_pk_fma_f32 v[120:121], v[130:131], v[86:87], v[120:121] op_sel:[1,1,0] op_sel_hi:[0,1,1] neg_lo:[0,0,0] neg_hi:[1,0,0]
    v_pk_fma_f32 v[134:135], v[150:151], v[88:89], v[134:135] op_sel:[1,1,0] op_sel_hi:[0,1,1] neg_lo:[0,0,0] neg_hi:[1,0,0]
    v_pk_add_f32 v[132:133], v[122:123], v[144:145]
    ds_write_b64 v6, v[8:9] offset:160
    v_pk_add_f32 v[136:137], v[122:123], v[144:145] neg_lo:[0,1] neg_hi:[0,1]
    v_pk_add_f32 v[128:129], v[138:139], v[118:119]
    v_pk_add_f32 v[124:125], v[138:139], v[118:119] neg_lo:[0,1] neg_hi:[0,1]
    ds_write_b64 v6, v[14:15] offset:192
    v_pk_add_f32 v[146:147], v[142:143], v[120:121]
    v_pk_add_f32 v[116:117], v[142:143], v[120:121] neg_lo:[0,1] neg_hi:[0,1]
    v_pk_add_f32 v[112:113], v[140:141], v[134:135]
    ds_write_b64 v6, v[22:23] offset:224
    v_pk_add_f32 v[148:149], v[140:141], v[134:135] neg_lo:[0,1] neg_hi:[0,1]
    v_pk_add_f32 v[114:115], v[132:133], v[146:147]
    ds_read_b64 v[26:27], v5 offset:0
    v_pk_add_f32 v[126:127], v[132:133], v[146:147] neg_lo:[0,1] neg_hi:[0,1]
    v_pk_add_f32 v[130:131], v[128:129], v[112:113]
    ds_read_b64 v[46:47], v5 offset:288
    v_pk_add_f32 v[150:151], v[128:129], v[112:113] neg_lo:[0,1] neg_hi:[0,1]
    v_pk_add_f32 v[122:123], v[114:115], v[130:131]
    ds_read_b64 v[32:33], v5 offset:576
    v_pk_add_f32 v[144:145], v[114:115], v[130:131] neg_lo:[0,1] neg_hi:[0,1]
    v_pk_add_f32 v[138:139], v[126:127], v[150:151] op_sel:[0,1] op_sel_hi:[1,0] neg_lo:[0,1] neg_hi:[0,0]
    ds_read_b64 v[20:21], v5 offset:864
    v_pk_add_f32 v[118:119], v[126:127], v[150:151] op_sel:[0,1] op_sel_hi:[1,0] neg_lo:[0,0] neg_hi:[0,1]
    v_pk_add_f32 v[142:143], v[124:125], v[124:125] op_sel:[0,1] op_sel_hi:[1,0] neg_lo:[0,1] neg_hi:[0,0]
    ds_read_b64 v[12:13], v5 offset:1152
    v_pk_add_f32 v[120:121], v[148:149], v[148:149] op_sel:[0,1] op_sel_hi:[1,0] neg_lo:[1,1] neg_hi:[1,0]
    v_pk_add_f32 v[140:141], v[136:137], v[116:117] op_sel:[0,1] op_sel_hi:[1,0] neg_lo:[0,1] neg_hi:[0,0]
    ds_read_b64 v[44:45], v5 offset:1440
    v_pk_add_f32 v[134:135], v[136:137], v[116:117] op_sel:[0,1] op_sel_hi:[1,0] neg_lo:[0,0] neg_hi:[0,1]
    v_pk_add_f32 v[132:133], v[142:143], v[120:121]
    ds_read_b64 v[38:39], v5 offset:1728
    v_pk_add_f32 v[128:129], v[142:143], v[120:121] neg_lo:[0,1] neg_hi:[0,1]
    v_pk_fma_f32 v[146:147], v[132:133], s[26:27], v[140:141] neg_lo:[0,0,0] neg_hi:[0,0,0]
    ds_read_b64 v[16:17], v5 offset:2016
    v_pk_fma_f32 v[112:113], v[132:133], s[26:27], v[140:141] neg_lo:[1,0,0] neg_hi:[1,0,0]
    v_pk_fma_f32 v[114:115], v[128:129], s[26:27], v[134:135] op_sel:[1,0,0] op_sel_hi:[0,1,1] neg_lo:[1,0,0] neg_hi:[0,0,0]
    v_pk_fma_f32 v[126:127], v[128:129], s[26:27], v[134:135] op_sel:[1,0,0] op_sel_hi:[0,1,1] neg_lo:[0,0,0] neg_hi:[1,0,0]
    ds_write_b64 v6, v[122:123] offset:18432
    s_waitcnt lgkmcnt(7)
    v_pk_mul_f32 v[36:37], v[46:47], v[62:63] op_sel:[0,0] op_sel_hi:[1,0]
    s_waitcnt lgkmcnt(6)
    v_pk_mul_f32 v[30:31], v[32:33], v[64:65] op_sel:[0,0] op_sel_hi:[1,0]
    s_waitcnt lgkmcnt(5)
    v_pk_mul_f32 v[28:29], v[20:21], v[66:67] op_sel:[0,0] op_sel_hi:[1,0]
    ds_write_b64 v6, v[146:147] offset:18464
    s_waitcnt lgkmcnt(5)
    v_pk_mul_f32 v[24:25], v[12:13], v[68:69] op_sel:[0,0] op_sel_hi:[1,0]
    s_waitcnt lgkmcnt(4)
    v_pk_mul_f32 v[18:19], v[44:45], v[70:71] op_sel:[0,0] op_sel_hi:[1,0]
    s_waitcnt lgkmcnt(3)
    v_pk_mul_f32 v[42:43], v[38:39], v[72:73] op_sel:[0,0] op_sel_hi:[1,0]
    ds_write_b64 v6, v[138:139] offset:18496
    s_waitcnt lgkmcnt(3)
    v_pk_mul_f32 v[34:35], v[16:17], v[74:75] op_sel:[0,0] op_sel_hi:[1,0]
    v_pk_fma_f32 v[36:37], v[46:47], v[62:63], v[36:37] op_sel:[1,1,0] op_sel_hi:[0,1,1] neg_lo:[0,0,0] neg_hi:[1,0,0]
    v_pk_fma_f32 v[30:31], v[32:33], v[64:65], v[30:31] op_sel:[1,1,0] op_sel_hi:[0,1,1] neg_lo:[0,0,0] neg_hi:[1,0,0]
    ds_write_b64 v6, v[114:115] offset:18528
    v_pk_fma_f32 v[28:29], v[20:21], v[66:67], v[28:29] op_sel:[1,1,0] op_sel_hi:[0,1,1] neg_lo:[0,0,0] neg_hi:[1,0,0]
    v_pk_fma_f32 v[24:25], v[12:13], v[68:69], v[24:25] op_sel:[1,1,0] op_sel_hi:[0,1,1] neg_lo:[0,0,0] neg_hi:[1,0,0]
    v_pk_fma_f32 v[18:19], v[44:45], v[70:71], v[18:19] op_sel:[1,1,0] op_sel_hi:[0,1,1] neg_lo:[0,0,0] neg_hi:[1,0,0]
    ds_write_b64 v6, v[144:145] offset:18560
    v_pk_fma_f32 v[42:43], v[38:39], v[72:73], v[42:43] op_sel:[1,1,0] op_sel_hi:[0,1,1] neg_lo:[0,0,0] neg_hi:[1,0,0]
    v_pk_fma_f32 v[34:35], v[16:17], v[74:75], v[34:35] op_sel:[1,1,0] op_sel_hi:[0,1,1] neg_lo:[0,0,0] neg_hi:[1,0,0]
    v_pk_add_f32 v[10:11], v[26:27], v[24:25]
    ds_write_b64 v6, v[112:113] offset:18592
    v_pk_add_f32 v[40:41], v[26:27], v[24:25] neg_lo:[0,1] neg_hi:[0,1]
    v_pk_add_f32 v[8:9], v[36:37], v[18:19]
    v_pk_add_f32 v[14:15], v[36:37], v[18:19] neg_lo:[0,1] neg_hi:[0,1]
    ds_write_b64 v6, v[118:119] offset:18624
    v_pk_add_f32 v[22:23], v[30:31], v[42:43]
    v_pk_add_f32 v[46:47], v[30:31], v[42:43] neg_lo:[0,1] neg_hi:[0,1]
    v_pk_add_f32 v[32:33], v[28:29], v[34:35]
    ds_write_b64 v6, v[126:127] offset:18656
    v_pk_add_f32 v[20:21], v[28:29], v[34:35] neg_lo:[0,1] neg_hi:[0,1]
    v_pk_add_f32 v[12:13], v[10:11], v[22:23]
    ds_read_b64 v[130:131], v5 offset:18432
    v_pk_add_f32 v[44:45], v[10:11], v[22:23] neg_lo:[0,1] neg_hi:[0,1]
    v_pk_add_f32 v[38:39], v[8:9], v[32:33]
    ds_read_b64 v[150:151], v5 offset:18720
    v_pk_add_f32 v[16:17], v[8:9], v[32:33] neg_lo:[0,1] neg_hi:[0,1]
    v_pk_add_f32 v[26:27], v[12:13], v[38:39]
    ds_read_b64 v[136:137], v5 offset:19008
    v_pk_add_f32 v[24:25], v[12:13], v[38:39] neg_lo:[0,1] neg_hi:[0,1]
    v_pk_add_f32 v[36:37], v[44:45], v[16:17] op_sel:[0,1] op_sel_hi:[1,0] neg_lo:[0,1] neg_hi:[0,0]
    ds_read_b64 v[124:125], v5 offset:19296
    v_pk_add_f32 v[18:19], v[44:45], v[16:17] op_sel:[0,1] op_sel_hi:[1,0] neg_lo:[0,0] neg_hi:[0,1]
    v_pk_add_f32 v[30:31], v[14:15], v[14:15] op_sel:[0,1] op_sel_hi:[1,0] neg_lo:[0,1] neg_hi:[0,0]
    ds_read_b64 v[116:117], v5 offset:19584
    v_pk_add_f32 v[42:43], v[20:21], v[20:21] op_sel:[0,1] op_sel_hi:[1,0] neg_lo:[1,1] neg_hi:[1,0]
    v_pk_add_f32 v[28:29], v[40:41], v[46:47] op_sel:[0,1] op_sel_hi:[1,0] neg_lo:[0,1] neg_hi:[0,0]
    ds_read_b64 v[148:149], v5 offset:19872
    v_pk_add_f32 v[34:35], v[40:41], v[46:47] op_sel:[0,1] op_sel_hi:[1,0] neg_lo:[0,0] neg_hi:[0,1]
    v_pk_add_f32 v[10:11], v[30:31], v[42:43]
    ds_read_b64 v[142:143], v5 offset:20160
    v_pk_add_f32 v[8:9], v[30:31], v[42:43] neg_lo:[0,1] neg_hi:[0,1]
    v_pk_fma_f32 v[22:23], v[10:11], s[26:27], v[28:29] neg_lo:[0,0,0] neg_hi:[0,0,0]
    ds_read_b64 v[120:121], v5 offset:20448
    v_pk_fma_f32 v[32:33], v[10:11], s[26:27], v[28:29] neg_lo:[1,0,0] neg_hi:[1,0,0]
    v_pk_fma_f32 v[12:13], v[8:9], s[26:27], v[34:35] op_sel:[1,0,0] op_sel_hi:[0,1,1] neg_lo:[1,0,0] neg_hi:[0,0,0]
    v_pk_fma_f32 v[44:45], v[8:9], s[26:27], v[34:35] op_sel:[1,0,0] op_sel_hi:[0,1,1] neg_lo:[0,0,0] neg_hi:[1,0,0]
    ds_write_b64 v5, v[26:27] offset:0
    s_waitcnt lgkmcnt(7)
    v_pk_mul_f32 v[140:141], v[150:151], v[62:63] op_sel:[0,0] op_sel_hi:[1,0]
    s_waitcnt lgkmcnt(6)
    v_pk_mul_f32 v[134:135], v[136:137], v[64:65] op_sel:[0,0] op_sel_hi:[1,0]
    s_waitcnt lgkmcnt(5)
    v_pk_mul_f32 v[132:133], v[124:125], v[66:67] op_sel:[0,0] op_sel_hi:[1,0]
    ds_write_b64 v5, v[22:23] offset:256
    s_waitcnt lgkmcnt(5)
    v_pk_mul_f32 v[128:129], v[116:117], v[68:69] op_sel:[0,0] op_sel_hi:[1,0]
    s_waitcnt lgkmcnt(4)
    v_pk_mul_f32 v[122:123], v[148:149], v[70:71] op_sel:[0,0] op_sel_hi:[1,0]
    s_waitcnt lgkmcnt(3)
    v_pk_mul_f32 v[146:147], v[142:143], v[72:73] op_sel:[0,0] op_sel_hi:[1,0]
    ds_write_b64 v5, v[36:37] offset:512
    s_waitcnt lgkmcnt(3)
    v_pk_mul_f32 v[138:139], v[120:121], v[74:75] op_sel:[0,0] op_sel_hi:[1,0]
    v_pk_fma_f32 v[140:141], v[150:151], v[62:63], v[140:141] op_sel:[1,1,0] op_sel_hi:[0,1,1] neg_lo:[0,0,0] neg_hi:[1,0,0]
    v_pk_fma_f32 v[134:135], v[136:137], v[64:65], v[134:135] op_sel:[1,1,0] op_sel_hi:[0,1,1] neg_lo:[0,0,0] neg_hi:[1,0,0]
    ds_write_b64 v5, v[12:13] offset:768
    v_pk_fma_f32 v[132:133], v[124:125], v[66:67], v[132:133] op_sel:[1,1,0] op_sel_hi:[0,1,1] neg_lo:[0,0,0] neg_hi:[1,0,0]
    v_pk_fma_f32 v[128:129], v[116:117], v[68:69], v[128:129] op_sel:[1,1,0] op_sel_hi:[0,1,1] neg_lo:[0,0,0] neg_hi:[1,0,0]
    v_pk_fma_f32 v[122:123], v[148:149], v[70:71], v[122:123] op_sel:[1,1,0] op_sel_hi:[0,1,1] neg_lo:[0,0,0] neg_hi:[1,0,0]
    ds_write_b64 v5, v[24:25] offset:1024
    v_pk_fma_f32 v[146:147], v[142:143], v[72:73], v[146:147] op_sel:[1,1,0] op_sel_hi:[0,1,1] neg_lo:[0,0,0] neg_hi:[1,0,0]
    v_pk_fma_f32 v[138:139], v[120:121], v[74:75], v[138:139] op_sel:[1,1,0] op_sel_hi:[0,1,1] neg_lo:[0,0,0] neg_hi:[1,0,0]
    v_pk_add_f32 v[114:115], v[130:131], v[128:129]
    ds_write_b64 v5, v[32:33] offset:1280
    v_pk_add_f32 v[144:145], v[130:131], v[128:129] neg_lo:[0,1] neg_hi:[0,1]
    v_pk_add_f32 v[112:113], v[140:141], v[122:123]
    v_pk_add_f32 v[118:119], v[140:141], v[122:123] neg_lo:[0,1] neg_hi:[0,1]
    ds_write_b64 v5, v[18:19] offset:1536
    v_pk_add_f32 v[126:127], v[134:135], v[146:147]
    v_pk_add_f32 v[150:151], v[134:135], v[146:147] neg_lo:[0,1] neg_hi:[0,1]
    v_pk_add_f32 v[136:137], v[132:133], v[138:139]
    ds_write_b64 v5, v[44:45] offset:1792
    v_pk_add_f32 v[124:125], v[132:133], v[138:139] neg_lo:[0,1] neg_hi:[0,1]
    v_pk_add_f32 v[116:117], v[114:115], v[126:127]
    v_pk_add_f32 v[148:149], v[114:115], v[126:127] neg_lo:[0,1] neg_hi:[0,1]
    v_pk_add_f32 v[142:143], v[112:113], v[136:137]
    v_pk_add_f32 v[120:121], v[112:113], v[136:137] neg_lo:[0,1] neg_hi:[0,1]
    v_pk_add_f32 v[130:131], v[116:117], v[142:143]
    v_pk_add_f32 v[128:129], v[116:117], v[142:143] neg_lo:[0,1] neg_hi:[0,1]
    v_pk_add_f32 v[140:141], v[148:149], v[120:121] op_sel:[0,1] op_sel_hi:[1,0] neg_lo:[0,1] neg_hi:[0,0]
    v_pk_add_f32 v[122:123], v[148:149], v[120:121] op_sel:[0,1] op_sel_hi:[1,0] neg_lo:[0,0] neg_hi:[0,1]
    v_pk_add_f32 v[134:135], v[118:119], v[118:119] op_sel:[0,1] op_sel_hi:[1,0] neg_lo:[0,1] neg_hi:[0,0]
    v_pk_add_f32 v[146:147], v[124:125], v[124:125] op_sel:[0,1] op_sel_hi:[1,0] neg_lo:[1,1] neg_hi:[1,0]
    v_pk_add_f32 v[132:133], v[144:145], v[150:151] op_sel:[0,1] op_sel_hi:[1,0] neg_lo:[0,1] neg_hi:[0,0]
    v_pk_add_f32 v[138:139], v[144:145], v[150:151] op_sel:[0,1] op_sel_hi:[1,0] neg_lo:[0,0] neg_hi:[0,1]
    v_pk_add_f32 v[114:115], v[134:135], v[146:147]
    v_pk_add_f32 v[112:113], v[134:135], v[146:147] neg_lo:[0,1] neg_hi:[0,1]
    v_pk_fma_f32 v[126:127], v[114:115], s[26:27], v[132:133] neg_lo:[0,0,0] neg_hi:[0,0,0]
    v_pk_fma_f32 v[136:137], v[114:115], s[26:27], v[132:133] neg_lo:[1,0,0] neg_hi:[1,0,0]
    v_pk_fma_f32 v[116:117], v[112:113], s[26:27], v[138:139] op_sel:[1,0,0] op_sel_hi:[0,1,1] neg_lo:[1,0,0] neg_hi:[0,0,0]
    v_pk_fma_f32 v[148:149], v[112:113], s[26:27], v[138:139] op_sel:[1,0,0] op_sel_hi:[0,1,1] neg_lo:[0,0,0] neg_hi:[1,0,0]
    ds_write_b64 v5, v[130:131] offset:18432
    ds_write_b64 v5, v[126:127] offset:18688
    ds_write_b64 v5, v[140:141] offset:18944
    ds_write_b64 v5, v[116:117] offset:19200
    ds_write_b64 v5, v[128:129] offset:19456
    ds_write_b64 v5, v[136:137] offset:19712
    ds_write_b64 v5, v[122:123] offset:19968
    ds_write_b64 v5, v[148:149] offset:20224
    s_waitcnt lgkmcnt(0)
    s_barrier
    ds_read_b64 v[38:39], v3 offset:0
    ds_read_b64 v[16:17], v3 offset:2304
    ds_read_b64 v[40:41], v3 offset:4608
    ds_read_b64 v[14:15], v3 offset:6912
    ds_read_b64 v[46:47], v3 offset:9216
    ds_read_b64 v[20:21], v3 offset:11520
    ds_read_b64 v[30:31], v3 offset:13824
    ds_read_b64 v[42:43], v3 offset:16128
    ds_read_b64 v[142:143], v3 offset:18432
    ds_read_b64 v[120:121], v3 offset:20736
    ds_read_b64 v[144:145], v3 offset:23040
    ds_read_b64 v[118:119], v3 offset:25344
    ds_read_b64 v[150:151], v3 offset:27648
    ds_read_b64 v[124:125], v3 offset:29952
    ds_read_b64 v[134:135], v3 offset:32256
    ds_read_b64 v[146:147], v3 offset:34560
    s_waitcnt lgkmcnt(14)
    v_pk_mul_f32 v[28:29], v[16:17], v[48:49] op_sel:[0,0] op_sel_hi:[1,0]
    s_waitcnt lgkmcnt(13)
    v_pk_mul_f32 v[34:35], v[40:41], v[50:51] op_sel:[0,0] op_sel_hi:[1,0]
    s_waitcnt lgkmcnt(12)
    v_pk_mul_f32 v[10:11], v[14:15], v[52:53] op_sel:[0,0] op_sel_hi:[1,0]
    s_waitcnt lgkmcnt(11)
    v_pk_mul_f32 v[8:9], v[46:47], v[54:55] op_sel:[0,0] op_sel_hi:[1,0]
    s_waitcnt lgkmcnt(10)
    v_pk_mul_f32 v[26:27], v[20:21], v[56:57] op_sel:[0,0] op_sel_hi:[1,0]
    s_waitcnt lgkmcnt(9)
    v_pk_mul_f32 v[22:23], v[30:31], v[58:59] op_sel:[0,0] op_sel_hi:[1,0]
    s_waitcnt lgkmcnt(8)
    v_pk_mul_f32 v[36:37], v[42:43], v[60:61] op_sel:[0,0] op_sel_hi:[1,0]
    v_pk_fma_f32 v[28:29], v[16:17], v[48:49], v[28:29] op_sel:[1,1,0] op_sel_hi:[0,1,1] neg_lo:[0,0,0] neg_hi:[1,0,0]
    v_pk_fma_f32 v[34:35], v[40:41], v[50:51], v[34:35] op_sel:[1,1,0] op_sel_hi:[0,1,1] neg_lo:[0,0,0] neg_hi:[1,0,0]
    v_pk_fma_f32 v[10:11], v[14:15], v[52:53], v[10:11] op_sel:[1,1,0] op_sel_hi:[0,1,1] neg_lo:[0,0,0] neg_hi:[1,0,0]
    v_pk_fma_f32 v[8:9], v[46:47], v[54:55], v[8:9] op_sel:[1,1,0] op_sel_hi:[0,1,1] neg_lo:[0,0,0] neg_hi:[1,0,0]
    v_pk_fma_f32 v[26:27], v[20:21], v[56:57], v[26:27] op_sel:[1,1,0] op_sel_hi:[0,1,1] neg_lo:[0,0,0] neg_hi:[1,0,0]
    v_pk_fma_f32 v[22:23], v[30:31], v[58:59], v[22:23] op_sel:[1,1,0] op_sel_hi:[0,1,1] neg_lo:[0,0,0] neg_hi:[1,0,0]
    v_pk_fma_f32 v[36:37], v[42:43], v[60:61], v[36:37] op_sel:[1,1,0] op_sel_hi:[0,1,1] neg_lo:[0,0,0] neg_hi:[1,0,0]
    v_pk_add_f32 v[12:13], v[38:39], v[8:9]
    v_pk_add_f32 v[24:25], v[38:39], v[8:9] neg_lo:[0,1] neg_hi:[0,1]
    v_pk_add_f32 v[32:33], v[28:29], v[26:27]
    v_pk_add_f32 v[18:19], v[28:29], v[26:27] neg_lo:[0,1] neg_hi:[0,1]
    v_pk_add_f32 v[44:45], v[34:35], v[22:23]
    v_pk_add_f32 v[16:17], v[34:35], v[22:23] neg_lo:[0,1] neg_hi:[0,1]
    v_pk_add_f32 v[40:41], v[10:11], v[36:37]
    v_pk_add_f32 v[14:15], v[10:11], v[36:37] neg_lo:[0,1] neg_hi:[0,1]
    v_pk_add_f32 v[46:47], v[12:13], v[44:45]
    v_pk_add_f32 v[20:21], v[12:13], v[44:45] neg_lo:[0,1] neg_hi:[0,1]
    v_pk_add_f32 v[30:31], v[32:33], v[40:41]
    v_pk_add_f32 v[42:43], v[32:33], v[40:41] neg_lo:[0,1] neg_hi:[0,1]
    v_pk_add_f32 v[38:39], v[46:47], v[30:31]
    v_pk_add_f32 v[8:9], v[46:47], v[30:31] neg_lo:[0,1] neg_hi:[0,1]
    v_pk_add_f32 v[28:29], v[20:21], v[42:43] op_sel:[0,1] op_sel_hi:[1,0] neg_lo:[0,1] neg_hi:[0,0]
    v_pk_add_f32 v[26:27], v[20:21], v[42:43] op_sel:[0,1] op_sel_hi:[1,0] neg_lo:[0,0] neg_hi:[0,1]
    v_pk_add_f32 v[34:35], v[18:19], v[18:19] op_sel:[0,1] op_sel_hi:[1,0] neg_lo:[0,1] neg_hi:[0,0]
    v_pk_add_f32 v[22:23], v[14:15], v[14:15] op_sel:[0,1] op_sel_hi:[1,0] neg_lo:[1,1] neg_hi:[1,0]
    v_pk_add_f32 v[10:11], v[24:25], v[16:17] op_sel:[0,1] op_sel_hi:[1,0] neg_lo:[0,1] neg_hi:[0,0]
    v_pk_add_f32 v[36:37], v[24:25], v[16:17] op_sel:[0,1] op_sel_hi:[1,0] neg_lo:[0,0] neg_hi:[0,1]
    v_pk_add_f32 v[12:13], v[34:35], v[22:23]
    v_pk_add_f32 v[32:33], v[34:35], v[22:23] neg_lo:[0,1] neg_hi:[0,1]
    v_pk_fma_f32 v[44:45], v[12:13], s[26:27], v[10:11] neg_lo:[0,0,0] neg_hi:[0,0,0]
    v_pk_fma_f32 v[40:41], v[12:13], s[26:27], v[10:11] neg_lo:[1,0,0] neg_hi:[1,0,0]
    v_pk_fma_f32 v[46:47], v[32:33], s[26:27], v[36:37] op_sel:[1,0,0] op_sel_hi:[0,1,1] neg_lo:[1,0,0] neg_hi:[0,0,0]
    v_pk_fma_f32 v[20:21], v[32:33], s[26:27], v[36:37] op_sel:[1,0,0] op_sel_hi:[0,1,1] neg_lo:[0,0,0] neg_hi:[1,0,0]
    s_waitcnt lgkmcnt(6)
    v_pk_mul_f32 v[132:133], v[120:121], v[48:49] op_sel:[0,0] op_sel_hi:[1,0]
    s_waitcnt lgkmcnt(5)
    v_pk_mul_f32 v[138:139], v[144:145], v[50:51] op_sel:[0,0] op_sel_hi:[1,0]
    s_waitcnt lgkmcnt(4)
    v_pk_mul_f32 v[114:115], v[118:119], v[52:53] op_sel:[0,0] op_sel_hi:[1,0]
    s_waitcnt lgkmcnt(3)
    v_pk_mul_f32 v[112:113], v[150:151], v[54:55] op_sel:[0,0] op_sel_hi:[1,0]
    s_waitcnt lgkmcnt(2)
    v_pk_mul_f32 v[130:131], v[124:125], v[56:57] op_sel:[0,0] op_sel_hi:[1,0]
    s_waitcnt lgkmcnt(1)
    v_pk_mul_f32 v[126:127], v[134:135], v[58:59] op_sel:[0,0] op_sel_hi:[1,0]
    s_waitcnt lgkmcnt(0)
    v_pk_mul_f32 v[140:141], v[146:147], v[60:61] op_sel:[0,0] op_sel_hi:[1,0]
    v_pk_fma_f32 v[132:133], v[120:121], v[48:49], v[132:133] op_sel:[1,1,0] op_sel_hi:[0,1,1] neg_lo:[0,0,0] neg_hi:[1,0,0]
    v_pk_fma_f32 v[138:139], v[144:145], v[50:51], v[138:139] op_sel:[1,1,0] op_sel_hi:[0,1,1] neg_lo:[0,0,0] neg_hi:[1,0,0]
    v_pk_fma_f32 v[114:115], v[118:119], v[52:53], v[114:115] op_sel:[1,1,0] op_sel_hi:[0,1,1] neg_lo:[0,0,0] neg_hi:[1,0,0]
    v_pk_fma_f32 v[112:113], v[150:151], v[54:55], v[112:113] op_sel:[1,1,0] op_sel_hi:[0,1,1] neg_lo:[0,0,0] neg_hi:[1,0,0]
    v_pk_fma_f32 v[130:131], v[124:125], v[56:57], v[130:131] op_sel:[1,1,0] op_sel_hi:[0,1,1] neg_lo:[0,0,0] neg_hi:[1,0,0]
    v_pk_fma_f32 v[126:127], v[134:135], v[58:59], v[126:127] op_sel:[1,1,0] op_sel_hi:[0,1,1] neg_lo:[0,0,0] neg_hi:[1,0,0]
    v_pk_fma_f32 v[140:141], v[146:147], v[60:61], v[140:141] op_sel:[1,1,0] op_sel_hi:[0,1,1] neg_lo:[0,0,0] neg_hi:[1,0,0]
    v_pk_add_f32 v[116:117], v[142:143], v[112:113]
    v_pk_add_f32 v[128:129], v[142:143], v[112:113] neg_lo:[0,1] neg_hi:[0,1]
    v_pk_add_f32 v[136:137], v[132:133], v[130:131]
    v_pk_add_f32 v[122:123], v[132:133], v[130:131] neg_lo:[0,1] neg_hi:[0,1]
    v_pk_add_f32 v[148:149], v[138:139], v[126:127]
    v_pk_add_f32 v[120:121], v[138:139], v[126:127] neg_lo:[0,1] neg_hi:[0,1]
    v_pk_add_f32 v[144:145], v[114:115], v[140:141]
    v_pk_add_f32 v[118:119], v[114:115], v[140:141] neg_lo:[0,1] neg_hi:[0,1]
    v_pk_add_f32 v[150:151], v[116:117], v[148:149]
    v_pk_add_f32 v[124:125], v[116:117], v[148:149] neg_lo:[0,1] neg_hi:[0,1]
    v_pk_add_f32 v[134:135], v[136:137], v[144:145]
    v_pk_add_f32 v[146:147], v[136:137], v[144:145] neg_lo:[0,1] neg_hi:[0,1]
    v_pk_add_f32 v[142:143], v[150:151], v[134:135]
    v_pk_add_f32 v[112:113], v[150:151], v[134:135] neg_lo:[0,1] neg_hi:[0,1]
    v_pk_add_f32 v[132:133], v[124:125], v[146:147] op_sel:[0,1] op_sel_hi:[1,0] neg_lo:[0,1] neg_hi:[0,0]
    v_pk_add_f32 v[130:131], v[124:125], v[146:147] op_sel:[0,1] op_sel_hi:[1,0] neg_lo:[0,0] neg_hi:[0,1]
    v_pk_add_f32 v[138:139], v[122:123], v[122:123] op_sel:[0,1] op_sel_hi:[1,0] neg_lo:[0,1] neg_hi:[0,0]
    v_pk_add_f32 v[126:127], v[118:119], v[118:119] op_sel:[0,1] op_sel_hi:[1,0] neg_lo:[1,1] neg_hi:[1,0]
    v_pk_add_f32 v[114:115], v[128:129], v[120:121] op_sel:[0,1] op_sel_hi:[1,0] neg_lo:[0,1] neg_hi:[0,0]
    v_pk_add_f32 v[140:141], v[128:129], v[120:121] op_sel:[0,1] op_sel_hi:[1,0] neg_lo:[0,0] neg_hi:[0,1]
    v_pk_add_f32 v[116:117], v[138:139], v[126:127]
    v_pk_add_f32 v[136:137], v[138:139], v[126:127] neg_lo:[0,1] neg_hi:[0,1]
    v_pk_fma_f32 v[148:149], v[116:117], s[26:27], v[114:115] neg_lo:[0,0,0] neg_hi:[0,0,0]
    v_pk_fma_f32 v[144:145], v[116:117], s[26:27], v[114:115] neg_lo:[1,0,0] neg_hi:[1,0,0]
    v_pk_fma_f32 v[150:151], v[136:137], s[26:27], v[140:141] op_sel:[1,0,0] op_sel_hi:[0,1,1] neg_lo:[1,0,0] neg_hi:[0,0,0]
    v_pk_fma_f32 v[124:125], v[136:137], s[26:27], v[140:141] op_sel:[1,0,0] op_sel_hi:[0,1,1] neg_lo:[0,0,0] neg_hi:[1,0,0]
    s_mul_i32 s22, s101, 3145728
    s_add_u32 s22, s22, 157286400
    s_lshl_b32 s21, s2, 14
    s_add_u32 s21, s21, s22
    s_cmp_eq_u32 s2, 0
    s_cbranch_scc1 M_fft_c0
    v_cvt_pk_bf16_f32 v38, v38, v39
    v_cvt_pk_bf16_f32 v39, v142, v143
    v_cvt_pk_bf16_f32 v44, v44, v45
    v_cvt_pk_bf16_f32 v45, v148, v149
    v_cvt_pk_bf16_f32 v28, v28, v29
    v_cvt_pk_bf16_f32 v29, v132, v133
    v_cvt_pk_bf16_f32 v46, v46, v47
    v_cvt_pk_bf16_f32 v47, v150, v151
    v_cvt_pk_bf16_f32 v8, v8, v9
    v_cvt_pk_bf16_f32 v9, v112, v113
    v_cvt_pk_bf16_f32 v40, v40, v41
    v_cvt_pk_bf16_f32 v41, v144, v145
    v_cvt_pk_bf16_f32 v26, v26, v27
    v_cvt_pk_bf16_f32 v27, v130, v131
    v_cvt_pk_bf16_f32 v20, v20, v21
    v_cvt_pk_bf16_f32 v21, v124, v125
    s_cmp_eq_u32 s2, 160
    s_cbranch_scc1 M_fft_c1
    buffer_store_dwordx2 v[38:39], v101, s[8:11], s21 offen offset:0 sc1
    buffer_store_dwordx2 v[44:45], v101, s[8:11], s21 offen offset:2048 sc1
    s_add_u32 s21, s21, 4096
    buffer_store_dwordx2 v[28:29], v101, s[8:11], s21 offen offset:0 sc1
    buffer_store_dwordx2 v[46:47], v101, s[8:11], s21 offen offset:2048 sc1
    s_add_u32 s21, s21, 4096
    buffer_store_dwordx2 v[8:9], v101, s[8:11], s21 offen offset:0 sc1
    buffer_store_dwordx2 v[40:41], v101, s[8:11], s21 offen offset:2048 sc1
    s_add_u32 s21, s21, 4096
    buffer_store_dwordx2 v[26:27], v101, s[8:11], s21 offen offset:0 sc1
    buffer_store_dwordx2 v[20:21], v101, s[8:11], s21 offen offset:2048 sc1
    s_add_u32 s21, s21, 4096
    s_branch M_fft_end
M_fft_c0:
    v_cvt_pk_bf16_f32 v38, v38, v142
    v_cvt_pk_bf16_f32 v44, v44, v148
    v_cvt_pk_bf16_f32 v28, v28, v132
    v_cvt_pk_bf16_f32 v46, v46, v150
    v_cvt_pk_bf16_f32 v8, v8, v112
    v_cvt_pk_bf16_f32 v40, v40, v144
    v_cvt_pk_bf16_f32 v26, v26, v130
    v_cvt_pk_bf16_f32 v20, v20, v124
    s_sub_u32 s22, s22, 4
M_fft_c1:
    buffer_store_dword v38, v101, s[8:11], s22 offen offset:4 sc1
    buffer_store_dword v44, v101, s[8:11], s22 offen offset:2052 sc1
    s_add_u32 s22, s22, 4096
    buffer_store_dword v28, v101, s[8:11], s22 offen offset:4 sc1
    buffer_store_dword v46, v101, s[8:11], s22 offen offset:2052 sc1
    s_add_u32 s22, s22, 4096
    buffer_store_dword v8, v101, s[8:11], s22 offen offset:4 sc1
    buffer_store_dword v40, v101, s[8:11], s22 offen offset:2052 sc1
    s_add_u32 s22, s22, 4096
    buffer_store_dword v26, v101, s[8:11], s22 offen offset:4 sc1
    buffer_store_dword v20, v101, s[8:11], s22 offen offset:2052 sc1
    s_add_u32 s22, s22, 4096
M_fft_end:
    s_waitcnt vmcnt(0) lgkmcnt(0)
    s_barrier
    s_cmp_lg_u32 s83, 0
    s_cbranch_scc1 M_gb_39
    s_mov_b32 s23, s85
    s_add_u32 s28, s86, 167841792
    s_lshl_b32 s27, s82, 7
    s_mov_b64 exec, 1
    s_add_u32 s31, s27, s84
    v_mov_b32 v190, s31
    v_mov_b32 v191, 1
    s_cmp_lg_u32 s23, 0
    s_cbranch_scc1 M_ls_40
    buffer_store_byte v191, v190, s[8:11], s28 offen
M_ls_40_r:
    s_cmp_lg_u32 s84, 31
    s_cbranch_scc1 M_gb_37
    s_mov_b64 exec, -1
    v_mbcnt_lo_u32_b32 v189, -1, 0
    s_mov_b64 exec, 0xff
    v_lshl_add_u32 v190, v189, 2, s27
    s_mov_b32 s30, 0
M_gs_41:
    buffer_load_dword v191, v190, s[8:11], s28 offen sc1
    s_add_u32 s30, s30, 1
    s_cmp_ge_u32 s30, 240000
    s_cbranch_scc1 M_fail
    s_waitcnt vmcnt(0)
    v_cmp_ne_u32 vcc, 0x1010101, v191
    s_cbranch_vccnz M_gs_41
    s_mov_b64 exec, 1
    v_mov_b32 v190, s27
    v_mov_b32 v191, 1
    buffer_store_dword v191, v190, s[8:11], s28 offen offset:1024 sc1
M_gb_37:
    s_mov_b64 exec, -1
M_gb_39:
    s_cmp_lg_u32 s83, 0
    s_cbranch_scc1 M_gb_38
    s_add_u32 s28, s86, 167841792
    v_mbcnt_lo_u32_b32 v189, -1, 0
    s_mov_b64 exec, 0xff
    v_lshlrev_b32 v190, 7, v189
    v_add_u32 v190, 1024, v190
    s_mov_b32 s30, 0
M_gs_42:
    buffer_load_dword v191, v190, s[8:11], s28 offen sc1
    s_add_u32 s30, s30, 1
    s_cmp_ge_u32 s30, 240000
    s_cbranch_scc1 M_fail
    s_waitcnt vmcnt(0)
    v_cmp_ne_u32 vcc, 0x1, v191
    s_cbranch_vccnz M_gs_42
    s_mov_b64 exec, -1
M_gb_38:
    s_barrier
    s_cmp_ge_u32 s89, 64
    s_cbranch_scc1 M_noid
    v_mbcnt_lo_u32_b32 v0, -1, 0
    v_mbcnt_hi_u32_b32 v0, -1, v0
    s_mov_b32 s23, s85
    v_lshlrev_b32 v1, 4, v0
    v_lshrrev_b32 v3, 4, v0
    v_and_b32 v4, 15, v0
    v_lshlrev_b32 v2, 15, v3
    v_lshl_add_u32 v2, v4, 4, v2
    s_mul_i32 s24, s101, 3145728
    s_lshl_b32 s25, s89, 8
    s_add_u32 s24, s24, s25
    s_add_u32 s24, s24, 157286400
    s_add_u32 s25, s24, 0
    buffer_load_dwordx4 v[64:67], v2, s[8:11], s25 offen sc1
    s_add_u32 s25, s24, 16384
    buffer_load_dwordx4 v[68:71], v2, s[8:11], s25 offen sc1
    s_add_u32 s25, s24, 131072
    buffer_load_dwordx4 v[72:75], v2, s[8:11], s25 offen sc1
    s_add_u32 s25, s24, 147456
    buffer_load_dwordx4 v[76:79], v2, s[8:11], s25 offen sc1
    s_add_u32 s25, s24, 262144
    buffer_load_dwordx4 v[80:83], v2, s[8:11], s25 offen sc1
    s_add_u32 s25, s24, 278528
    buffer_load_dwordx4 v[84:87], v2, s[8:11], s25 offen sc1
    s_add_u32 s25, s24, 393216
    buffer_load_dwordx4 v[88:91], v2, s[8:11], s25 offen sc1
    s_add_u32 s25, s24, 409600
    buffer_load_dwordx4 v[92:95], v2, s[8:11], s25 offen sc1
    s_add_u32 s25, s24, 524288
    buffer_load_dwordx4 v[96:99], v2, s[8:11], s25 offen sc1
    s_add_u32 s25, s24, 540672
    buffer_load_dwordx4 v[100:103], v2, s[8:11], s25 offen sc1
    s_add_u32 s25, s24, 655360
    buffer_load_dwordx4 v[104:107], v2, s[8:11], s25 offen sc1
    s_add_u32 s25, s24, 671744
    buffer_load_dwordx4 v[108:111], v2, s[8:11], s25 offen sc1
    s_add_u32 s25, s24, 786432
    buffer_load_dwordx4 v[112:115], v2, s[8:11], s25 offen sc1
    s_add_u32 s25, s24, 802816
    buffer_load_dwordx4 v[116:119], v2, s[8:11], s25 offen sc1
    s_add_u32 s25, s24, 917504
    buffer_load_dwordx4 v[120:123], v2, s[8:11], s25 offen sc1
    s_add_u32 s25, s24, 933888
    buffer_load_dwordx4 v[124:127], v2, s[8:11], s25 offen sc1
    s_mul_i32 s29, s89, 40960
    v_mul_u32_u24 v5, 1280, v4
    v_lshl_add_u32 v5, v3, 4, v5
    v_add_u32 v6, 40960, v1
    s_lshl_b32 s31, s88, 7
    s_add_u32 s30, s29, s31
    s_add_u32 s31, s30, s80
    s_add_u32 s32, s31, 20480
    s_add_u32 s33, s30, 20480
    ds_read_b128 v[44:47], v1 offset:0
    ds_read_b128 v[48:51], v1 offset:20480
    ds_read_b128 v[52:55], v6 offset:0
    ds_read_b128 v[56:59], v6 offset:20480
    s_waitcnt vmcnt(14)
    v_swap_b32 v66, v68
    v_swap_b32 v67, v69
    s_waitcnt lgkmcnt(3)
    s_nop 0
    v_mfma_f32_16x16x32_bf16 v[12:15], v[44:47], v[64:67], 0
    ds_read_b128 v[60:63], v1 offset:1024
    v_mfma_f32_16x16x32_bf16 v[28:31], v[44:47], v[68:71], 0
    s_waitcnt lgkmcnt(3)
    v_mfma_f32_16x16x32_bf16 v[16:19], v[48:51], v[64:67], 0
    ds_read_b128 v[44:47], v1 offset:21504
    v_mfma_f32_16x16x32_bf16 v[32:35], v[48:51], v[68:71], 0
    s_waitcnt lgkmcnt(3)
    v_mfma_f32_16x16x32_bf16 v[20:23], v[52:55], v[64:67], 0
    ds_read_b128 v[48:51], v6 offset:1024
    v_mfma_f32_16x16x32_bf16 v[36:39], v[52:55], v[68:71], 0
    s_waitcnt vmcnt(12)
    v_swap_b32 v74, v76
    v_swap_b32 v75, v77
    s_waitcnt lgkmcnt(3)
    v_mfma_f32_16x16x32_bf16 v[24:27], v[56:59], v[64:67], 0
    ds_read_b128 v[52:55], v6 offset:21504
    v_mfma_f32_16x16x32_bf16 v[40:43], v[56:59], v[68:71], 0
    s_add_u32 s25, s24, 1048576
    buffer_load_dwordx4 v[128:131], v2, s[8:11], s25 offen sc1
    s_add_u32 s25, s24, 1064960
    buffer_load_dwordx4 v[132:135], v2, s[8:11], s25 offen sc1
    s_add_u32 s25, s24, 1179648
    buffer_load_dwordx4 v[136:139], v2, s[8:11], s25 offen sc1
    s_add_u32 s25, s24, 1196032
    buffer_load_dwordx4 v[140:143], v2, s[8:11], s25 offen sc1
    s_add_u32 s25, s24, 1310720
    buffer_load_dwordx4 v[144:147], v2, s[8:11], s25 offen sc1
    s_add_u32 s25, s24, 1327104
    buffer_load_dwordx4 v[148:151], v2, s[8:11], s25 offen sc1
    s_add_u32 s25, s24, 1441792
    buffer_load_dwordx4 v[152:155], v2, s[8:11], s25 offen sc1
    s_add_u32 s25, s24, 1458176
    buffer_load_dwordx4 v[156:159], v2, s[8:11], s25 offen sc1
    s_waitcnt lgkmcnt(3)
    v_mfma_f32_16x16x32_bf16 v[12:15], v[60:63], v[72:75], v[12:15]
    ds_read_b128 v[56:59], v1 offset:2048
    v_mfma_f32_16x16x32_bf16 v[28:31], v[60:63], v[76:79], v[28:31]
    s_waitcnt lgkmcnt(3)
    v_mfma_f32_16x16x32_bf16 v[16:19], v[44:47], v[72:75], v[16:19]
    ds_read_b128 v[60:63], v1 offset:22528
    v_mfma_f32_16x16x32_bf16 v[32:35], v[44:47], v[76:79], v[32:35]
    s_waitcnt lgkmcnt(3)
    v_mfma_f32_16x16x32_bf16 v[20:23], v[48:51], v[72:75], v[20:23]
    ds_read_b128 v[44:47], v6 offset:2048
    v_mfma_f32_16x16x32_bf16 v[36:39], v[48:51], v[76:79], v[36:39]
    s_waitcnt vmcnt(18)
    v_swap_b32 v82, v84
    v_swap_b32 v83, v85
    s_waitcnt lgkmcnt(3)
    v_mfma_f32_16x16x32_bf16 v[24:27], v[52:55], v[72:75], v[24:27]
    ds_read_b128 v[48:51], v6 offset:22528
    v_mfma_f32_16x16x32_bf16 v[40:43], v[52:55], v[76:79], v[40:43]
    s_waitcnt lgkmcnt(3)
    v_mfma_f32_16x16x32_bf16 v[12:15], v[56:59], v[80:83], v[12:15]
    ds_read_b128 v[52:55], v1 offset:3072
    v_mfma_f32_16x16x32_bf16 v[28:31], v[56:59], v[84:87], v[28:31]
    s_waitcnt lgkmcnt(3)
    v_mfma_f32_16x16x32_bf16 v[16:19], v[60:63], v[80:83], v[16:19]
    ds_read_b128 v[56:59], v1 offset:23552
    v_mfma_f32_16x16x32_bf16 v[32:35], v[60:63], v[84:87], v[32:35]
    s_waitcnt lgkmcnt(3)
    v_mfma_f32_16x16x32_bf16 v[20:23], v[44:47], v[80:83], v[20:23]
    ds_read_b128 v[60:63], v6 offset:3072
    v_mfma_f32_16x16x32_bf16 v[36:39], v[44:47], v[84:87], v[36:39]
    s_waitcnt vmcnt(16)
    v_swap_b32 v90, v92
    v_swap_b32 v91, v93
    s_waitcnt lgkmcnt(3)
    v_mfma_f32_16x16x32_bf16 v[24:27], v[48:51], v[80:83], v[24:27]
    ds_read_b128 v[44:47], v6 offset:23552
    v_mfma_f32_16x16x32_bf16 v[40:43], v[48:51], v[84:87], v[40:43]
    s_add_u32 s25, s24, 1572864
    buffer_load_dwordx4 v[160:163], v2, s[8:11], s25 offen sc1
    s_add_u32 s25, s24, 1589248
    buffer_load_dwordx4 v[164:167], v2, s[8:11], s25 offen sc1
    s_add_u32 s25, s24, 1703936
    buffer_load_dwordx4 v[168:171], v2, s[8:11], s25 offen sc1
    s_add_u32 s25, s24, 1720320
    buffer_load_dwordx4 v[172:175], v2, s[8:11], s25 offen sc1
    s_add_u32 s25, s24, 1835008
    buffer_load_dwordx4 v[176:179], v2, s[8:11], s25 offen sc1
    s_add_u32 s25, s24, 1851392
    buffer_load_dwordx4 v[180:183], v2, s[8:11], s25 offen sc1
    s_add_u32 s25, s24, 1966080
    buffer_load_dwordx4 v[64:67], v2, s[8:11], s25 offen sc1
    s_add_u32 s25, s24, 1982464
    buffer_load_dwordx4 v[68:71], v2, s[8:11], s25 offen sc1
    s_waitcnt lgkmcnt(3)
    v_mfma_f32_16x16x32_bf16 v[12:15], v[52:55], v[88:91], v[12:15]
    ds_read_b128 v[48:51], v1 offset:4096
    v_mfma_f32_16x16x32_bf16 v[28:31], v[52:55], v[92:95], v[28:31]
    s_waitcnt lgkmcnt(3)
    v_mfma_f32_16x16x32_bf16 v[16:19], v[56:59], v[88:91], v[16:19]
    ds_read_b128 v[52:55], v1 offset:24576
    v_mfma_f32_16x16x32_bf16 v[32:35], v[56:59], v[92:95], v[32:35]
    s_waitcnt lgkmcnt(3)
    v_mfma_f32_16x16x32_bf16 v[20:23], v[60:63], v[88:91], v[20:23]
    ds_read_b128 v[56:59], v6 offset:4096
    v_mfma_f32_16x16x32_bf16 v[36:39], v[60:63], v[92:95], v[36:39]
    s_waitcnt vmcnt(22)
    v_swap_b32 v98, v100
    v_swap_b32 v99, v101
    s_waitcnt lgkmcnt(3)
    v_mfma_f32_16x16x32_bf16 v[24:27], v[44:47], v[88:91], v[24:27]
    ds_read_b128 v[60:63], v6 offset:24576
    v_mfma_f32_16x16x32_bf16 v[40:43], v[44:47], v[92:95], v[40:43]
    s_waitcnt lgkmcnt(3)
    v_mfma_f32_16x16x32_bf16 v[12:15], v[48:51], v[96:99], v[12:15]
    ds_read_b128 v[44:47], v1 offset:5120
    v_mfma_f32_16x16x32_bf16 v[28:31], v[48:51], v[100:103], v[28:31]
    s_waitcnt lgkmcnt(3)
    v_mfma_f32_16x16x32_bf16 v[16:19], v[52:55], v[96:99], v[16:19]
    ds_read_b128 v[48:51], v1 offset:25600
    v_mfma_f32_16x16x32_bf16 v[32:35], v[52:55], v[100:103], v[32:35]
    s_waitcnt lgkmcnt(3)
    v_mfma_f32_16x16x32_bf16 v[20:23], v[56:59], v[96:99], v[20:23]
    ds_read_b128 v[52:55], v6 offset:5120
    v_mfma_f32_16x16x32_bf16 v[36:39], v[56:59], v[100:103], v[36:39]
    s_waitcnt vmcnt(20)
    v_swap_b32 v106, v108
    v_swap_b32 v107, v109
    s_waitcnt lgkmcnt(3)
    v_mfma_f32_16x16x32_bf16 v[24:27], v[60:63], v[96:99], v[24:27]
    ds_read_b128 v[56:59], v6 offset:25600
    v_mfma_f32_16x16x32_bf16 v[40:43], v[60:63], v[100:103], v[40:43]
    s_add_u32 s25, s24, 2097152
    buffer_load_dwordx4 v[72:75], v2, s[8:11], s25 offen sc1
    s_add_u32 s25, s24, 2113536
    buffer_load_dwordx4 v[76:79], v2, s[8:11], s25 offen sc1
    s_add_u32 s25, s24, 2228224
    buffer_load_dwordx4 v[80:83], v2, s[8:11], s25 offen sc1
    s_add_u32 s25, s24, 2244608
    buffer_load_dwordx4 v[84:87], v2, s[8:11], s25 offen sc1
    s_add_u32 s25, s24, 2359296
    buffer_load_dwordx4 v[88:91], v2, s[8:11], s25 offen sc1
    s_add_u32 s25, s24, 2375680
    buffer_load_dwordx4 v[92:95], v2, s[8:11], s25 offen sc1
    s_add_u32 s25, s24, 2490368
    buffer_load_dwordx4 v[96:99], v2, s[8:11], s25 offen sc1
    s_add_u32 s25, s24, 2506752
    buffer_load_dwordx4 v[100:103], v2, s[8:11], s25 offen sc1
    s_waitcnt lgkmcnt(3)
    v_mfma_f32_16x16x32_bf16 v[12:15], v[44:47], v[104:107], v[12:15]
    ds_read_b128 v[60:63], v1 offset:6144
    v_mfma_f32_16x16x32_bf16 v[28:31], v[44:47], v[108:111], v[28:31]
    s_waitcnt lgkmcnt(3)
    v_mfma_f32_16x16x32_bf16 v[16:19], v[48:51], v[104:107], v[16:19]
    ds_read_b128 v[44:47], v1 offset:26624
    v_mfma_f32_16x16x32_bf16 v[32:35], v[48:51], v[108:111], v[32:35]
    s_waitcnt lgkmcnt(3)
    v_mfma_f32_16x16x32_bf16 v[20:23], v[52:55], v[104:107], v[20:23]
    ds_read_b128 v[48:51], v6 offset:6144
    v_mfma_f32_16x16x32_bf16 v[36:39], v[52:55], v[108:111], v[36:39]
    s_waitcnt vmcnt(26)
    v_swap_b32 v114, v116
    v_swap_b32 v115, v117
    s_waitcnt lgkmcnt(3)
    v_mfma_f32_16x16x32_bf16 v[24:27], v[56:59], v[104:107], v[24:27]
    ds_read_b128 v[52:55], v6 offset:26624
    v_mfma_f32_16x16x32_bf16 v[40:43], v[56:59], v[108:111], v[40:43]
    s_waitcnt lgkmcnt(3)
    v_mfma_f32_16x16x32_bf16 v[12:15], v[60:63], v[112:115], v[12:15]
    ds_read_b128 v[56:59], v1 offset:7168
    v_mfma_f32_16x16x32_bf16 v[28:31], v[60:63], v[116:119], v[28:31]
    s_waitcnt lgkmcnt(3)
    v_mfma_f32_16x16x32_bf16 v[16:19], v[44:47], v[112:115], v[16:19]
    ds_read_b128 v[60:63], v1 offset:27648
    v_mfma_f32_16x16x32_bf16 v[32:35], v[44:47], v[116:119], v[32:35]
    s_waitcnt lgkmcnt(3)
    v_mfma_f32_16x16x32_bf16 v[20:23], v[48:51], v[112:115], v[20:23]
    ds_read_b128 v[44:47], v6 offset:7168
    v_mfma_f32_16x16x32_bf16 v[36:39], v[48:51], v[116:119], v[36:39]
    s_waitcnt vmcnt(24)
    v_swap_b32 v122, v124
    v_swap_b32 v123, v125
    s_waitcnt lgkmcnt(3)
    v_mfma_f32_16x16x32_bf16 v[24:27], v[52:55], v[112:115], v[24:27]
    ds_read_b128 v[48:51], v6 offset:27648
    v_mfma_f32_16x16x32_bf16 v[40:43], v[52:55], v[116:119], v[40:43]
    s_waitcnt lgkmcnt(3)
    v_mfma_f32_16x16x32_bf16 v[12:15], v[56:59], v[120:123], v[12:15]
    ds_read_b128 v[52:55], v1 offset:8192
    v_mfma_f32_16x16x32_bf16 v[28:31], v[56:59], v[124:127], v[28:31]
    s_waitcnt lgkmcnt(3)
    v_mfma_f32_16x16x32_bf16 v[16:19], v[60:63], v[120:123], v[16:19]
    ds_read_b128 v[56:59], v1 offset:28672
    v_mfma_f32_16x16x32_bf16 v[32:35], v[60:63], v[124:127], v[32:35]
    s_waitcnt lgkmcnt(3)
    v_mfma_f32_16x16x32_bf16 v[20:23], v[44:47], v[120:123], v[20:23]
    ds_read_b128 v[60:63], v6 offset:8192
    v_mfma_f32_16x16x32_bf16 v[36:39], v[44:47], v[124:127], v[36:39]
    s_waitcnt vmcnt(22)
    v_swap_b32 v130, v132
    v_swap_b32 v131, v133
    s_waitcnt lgkmcnt(3)
    v_mfma_f32_16x16x32_bf16 v[24:27], v[48:51], v[120:123], v[24:27]
    ds_read_b128 v[44:47], v6 offset:28672
    v_mfma_f32_16x16x32_bf16 v[40:43], v[48:51], v[124:127], v[40:43]
    s_waitcnt lgkmcnt(3)
    v_mfma_f32_16x16x32_bf16 v[12:15], v[52:55], v[128:131], v[12:15]
    ds_read_b128 v[48:51], v1 offset:9216
    v_mfma_f32_16x16x32_bf16 v[28:31], v[52:55], v[132:135], v[28:31]
    s_waitcnt lgkmcnt(3)
    v_mfma_f32_16x16x32_bf16 v[16:19], v[56:59], v[128:131], v[16:19]
    ds_read_b128 v[52:55], v1 offset:29696
    v_mfma_f32_16x16x32_bf16 v[32:35], v[56:59], v[132:135], v[32:35]
    s_waitcnt lgkmcnt(3)
    v_mfma_f32_16x16x32_bf16 v[20:23], v[60:63], v[128:131], v[20:23]
    ds_read_b128 v[56:59], v6 offset:9216
    v_mfma_f32_16x16x32_bf16 v[36:39], v[60:63], v[132:135], v[36:39]
    s_waitcnt vmcnt(20)
    v_swap_b32 v138, v140
    v_swap_b32 v139, v141
    s_waitcnt lgkmcnt(3)
    v_mfma_f32_16x16x32_bf16 v[24:27], v[44:47], v[128:131], v[24:27]
    ds_read_b128 v[60:63], v6 offset:29696
    v_mfma_f32_16x16x32_bf16 v[40:43], v[44:47], v[132:135], v[40:43]
    s_waitcnt lgkmcnt(3)
    v_mfma_f32_16x16x32_bf16 v[12:15], v[48:51], v[136:139], v[12:15]
    ds_read_b128 v[44:47], v1 offset:10240
    v_mfma_f32_16x16x32_bf16 v[28:31], v[48:51], v[140:143], v[28:31]
    s_waitcnt lgkmcnt(3)
    v_mfma_f32_16x16x32_bf16 v[16:19], v[52:55], v[136:139], v[16:19]
    ds_read_b128 v[48:51], v1 offset:30720
    v_mfma_f32_16x16x32_bf16 v[32:35], v[52:55], v[140:143], v[32:35]
    s_waitcnt lgkmcnt(3)
    v_mfma_f32_16x16x32_bf16 v[20:23], v[56:59], v[136:139], v[20:23]
    ds_read_b128 v[52:55], v6 offset:10240
    v_mfma_f32_16x16x32_bf16 v[36:39], v[56:59], v[140:143], v[36:39]
    s_waitcnt vmcnt(18)
    v_swap_b32 v146, v148
    v_swap_b32 v147, v149
    s_waitcnt lgkmcnt(3)
    v_mfma_f32_16x16x32_bf16 v[24:27], v[60:63], v[136:139], v[24:27]
    ds_read_b128 v[56:59], v6 offset:30720
    v_mfma_f32_16x16x32_bf16 v[40:43], v[60:63], v[140:143], v[40:43]
    buffer_load_dwordx4 v[104:107], v5, s[8:11], s31 offen offset:0 sc1
    buffer_load_dwordx4 v[108:111], v5, s[8:11], s31 offen offset:64 sc1
    buffer_load_dwordx4 v[112:115], v5, s[8:11], s32 offen offset:0 sc1
    buffer_load_dwordx4 v[116:119], v5, s[8:11], s32 offen offset:64 sc1
    s_waitcnt lgkmcnt(3)
    v_mfma_f32_16x16x32_bf16 v[12:15], v[44:47], v[144:147], v[12:15]
    ds_read_b128 v[60:63], v1 offset:11264
    v_mfma_f32_16x16x32_bf16 v[28:31], v[44:47], v[148:151], v[28:31]
    s_waitcnt lgkmcnt(3)
    v_mfma_f32_16x16x32_bf16 v[16:19], v[48:51], v[144:147], v[16:19]
    ds_read_b128 v[44:47], v1 offset:31744
    v_mfma_f32_16x16x32_bf16 v[32:35], v[48:51], v[148:151], v[32:35]
    s_waitcnt lgkmcnt(3)
    v_mfma_f32_16x16x32_bf16 v[20:23], v[52:55], v[144:147], v[20:23]
    ds_read_b128 v[48:51], v6 offset:11264
    v_mfma_f32_16x16x32_bf16 v[36:39], v[52:55], v[148:151], v[36:39]
    s_waitcnt vmcnt(20)
    v_swap_b32 v154, v156
    v_swap_b32 v155, v157
    s_waitcnt lgkmcnt(3)
    v_mfma_f32_16x16x32_bf16 v[24:27], v[56:59], v[144:147], v[24:27]
    ds_read_b128 v[52:55], v6 offset:31744
    v_mfma_f32_16x16x32_bf16 v[40:43], v[56:59], v[148:151], v[40:43]
    s_waitcnt lgkmcnt(3)
    v_mfma_f32_16x16x32_bf16 v[12:15], v[60:63], v[152:155], v[12:15]
    ds_read_b128 v[56:59], v1 offset:12288
    v_mfma_f32_16x16x32_bf16 v[28:31], v[60:63], v[156:159], v[28:31]
    s_waitcnt lgkmcnt(3)
    v_mfma_f32_16x16x32_bf16 v[16:19], v[44:47], v[152:155], v[16:19]
    ds_read_b128 v[60:63], v1 offset:32768
    v_mfma_f32_16x16x32_bf16 v[32:35], v[44:47], v[156:159], v[32:35]
    s_waitcnt lgkmcnt(3)
    v_mfma_f32_16x16x32_bf16 v[20:23], v[48:51], v[152:155], v[20:23]
    ds_read_b128 v[44:47], v6 offset:12288
    v_mfma_f32_16x16x32_bf16 v[36:39], v[48:51], v[156:159], v[36:39]
    s_waitcnt vmcnt(18)
    v_swap_b32 v162, v164
    v_swap_b32 v163, v165
    s_waitcnt lgkmcnt(3)
    v_mfma_f32_16x16x32_bf16 v[24:27], v[52:55], v[152:155], v[24:27]
    ds_read_b128 v[48:51], v6 offset:32768
    v_mfma_f32_16x16x32_bf16 v[40:43], v[52:55], v[156:159], v[40:43]
    s_waitcnt lgkmcnt(3)
    v_mfma_f32_16x16x32_bf16 v[12:15], v[56:59], v[160:163], v[12:15]
    ds_read_b128 v[52:55], v1 offset:13312
    v_mfma_f32_16x16x32_bf16 v[28:31], v[56:59], v[164:167], v[28:31]
    s_waitcnt lgkmcnt(3)
    v_mfma_f32_16x16x32_bf16 v[16:19], v[60:63], v[160:163], v[16:19]
    ds_read_b128 v[56:59], v1 offset:33792
    v_mfma_f32_16x16x32_bf16 v[32:35], v[60:63], v[164:167], v[32:35]
    s_waitcnt lgkmcnt(3)
    v_mfma_f32_16x16x32_bf16 v[20:23], v[44:47], v[160:163], v[20:23]
    ds_read_b128 v[60:63], v6 offset:13312
    v_mfma_f32_16x16x32_bf16 v[36:39], v[44:47], v[164:167], v[36:39]
    s_waitcnt vmcnt(16)
    v_swap_b32 v170, v172
    v_swap_b32 v171, v173
    s_waitcnt lgkmcnt(3)
    v_mfma_f32_16x16x32_bf16 v[24:27], v[48:51], v[160:163], v[24:27]
    ds_read_b128 v[44:47], v6 offset:33792
    v_mfma_f32_16x16x32_bf16 v[40:43], v[48:51], v[164:167], v[40:43]
    s_waitcnt lgkmcnt(3)
    v_mfma_f32_16x16x32_bf16 v[12:15], v[52:55], v[168:171], v[12:15]
    ds_read_b128 v[48:51], v1 offset:14336
    v_mfma_f32_16x16x32_bf16 v[28:31], v[52:55], v[172:175], v[28:31]
    s_waitcnt lgkmcnt(3)
    v_mfma_f32_16x16x32_bf16 v[16:19], v[56:59], v[168:171], v[16:19]
    ds_read_b128 v[52:55], v1 offset:34816
    v_mfma_f32_16x16x32_bf16 v[32:35], v[56:59], v[172:175], v[32:35]
    s_waitcnt lgkmcnt(3)
    v_mfma_f32_16x16x32_bf16 v[20:23], v[60:63], v[168:171], v[20:23]
    ds_read_b128 v[56:59], v6 offset:14336
    v_mfma_f32_16x16x32_bf16 v[36:39], v[60:63], v[172:175], v[36:39]
    s_waitcnt vmcnt(14)
    v_swap_b32 v178, v180
    v_swap_b32 v179, v181
    s_waitcnt lgkmcnt(3)
    v_mfma_f32_16x16x32_bf16 v[24:27], v[44:47], v[168:171], v[24:27]
    ds_read_b128 v[60:63], v6 offset:34816
    v_mfma_f32_16x16x32_bf16 v[40:43], v[44:47], v[172:175], v[40:43]
    s_waitcnt lgkmcnt(3)
    v_mfma_f32_16x16x32_bf16 v[12:15], v[48:51], v[176:179], v[12:15]
    ds_read_b128 v[44:47], v1 offset:15360
    v_mfma_f32_16x16x32_bf16 v[28:31], v[48:51], v[180:183], v[28:31]
    s_waitcnt lgkmcnt(3)
    v_mfma_f32_16x16x32_bf16 v[16:19], v[52:55], v[176:179], v[16:19]
    ds_read_b128 v[48:51], v1 offset:35840
    v_mfma_f32_16x16x32_bf16 v[32:35], v[52:55], v[180:183], v[32:35]
    s_waitcnt lgkmcnt(3)
    v_mfma_f32_16x16x32_bf16 v[20:23], v[56:59], v[176:179], v[20:23]
    ds_read_b128 v[52:55], v6 offset:15360
    v_mfma_f32_16x16x32_bf16 v[36:39], v[56:59], v[180:183], v[36:39]
    s_waitcnt vmcnt(12)
    v_swap_b32 v66, v68
    v_swap_b32 v67, v69
    s_waitcnt lgkmcnt(3)
    v_mfma_f32_16x16x32_bf16 v[24:27], v[60:63], v[176:179], v[24:27]
    ds_read_b128 v[56:59], v6 offset:35840
    v_mfma_f32_16x16x32_bf16 v[40:43], v[60:63], v[180:183], v[40:43]
    s_waitcnt lgkmcnt(3)
    v_mfma_f32_16x16x32_bf16 v[12:15], v[44:47], v[64:67], v[12:15]
    ds_read_b128 v[60:63], v1 offset:16384
    v_mfma_f32_16x16x32_bf16 v[28:31], v[44:47], v[68:71], v[28:31]
    s_waitcnt lgkmcnt(3)
    v_mfma_f32_16x16x32_bf16 v[16:19], v[48:51], v[64:67], v[16:19]
    ds_read_b128 v[44:47], v1 offset:36864
    v_mfma_f32_16x16x32_bf16 v[32:35], v[48:51], v[68:71], v[32:35]
    s_waitcnt lgkmcnt(3)
    v_mfma_f32_16x16x32_bf16 v[20:23], v[52:55], v[64:67], v[20:23]
    ds_read_b128 v[48:51], v6 offset:16384
    v_mfma_f32_16x16x32_bf16 v[36:39], v[52:55], v[68:71], v[36:39]
    s_waitcnt vmcnt(10)
    v_swap_b32 v74, v76
    v_swap_b32 v75, v77
    s_waitcnt lgkmcnt(3)
    v_mfma_f32_16x16x32_bf16 v[24:27], v[56:59], v[64:67], v[24:27]
    ds_read_b128 v[52:55], v6 offset:36864
    v_mfma_f32_16x16x32_bf16 v[40:43], v[56:59], v[68:71], v[40:43]
    s_waitcnt lgkmcnt(3)
    v_mfma_f32_16x16x32_bf16 v[12:15], v[60:63], v[72:75], v[12:15]
    ds_read_b128 v[56:59], v1 offset:17408
    v_mfma_f32_16x16x32_bf16 v[28:31], v[60:63], v[76:79], v[28:31]
    s_waitcnt lgkmcnt(3)
    v_mfma_f32_16x16x32_bf16 v[16:19], v[44:47], v[72:75], v[16:19]
    ds_read_b128 v[60:63], v1 offset:37888
    v_mfma_f32_16x16x32_bf16 v[32:35], v[44:47], v[76:79], v[32:35]
    s_waitcnt lgkmcnt(3)
    v_mfma_f32_16x16x32_bf16 v[20:23], v[48:51], v[72:75], v[20:23]
    ds_read_b128 v[44:47], v6 offset:17408
    v_mfma_f32_16x16x32_bf16 v[36:39], v[48:51], v[76:79], v[36:39]
    s_waitcnt vmcnt(8)
    v_swap_b32 v82, v84
    v_swap_b32 v83, v85
    s_waitcnt lgkmcnt(3)
    v_mfma_f32_16x16x32_bf16 v[24:27], v[52:55], v[72:75], v[24:27]
    ds_read_b128 v[48:51], v6 offset:37888
    v_mfma_f32_16x16x32_bf16 v[40:43], v[52:55], v[76:79], v[40:43]
    s_waitcnt lgkmcnt(3)
    v_mfma_f32_16x16x32_bf16 v[12:15], v[56:59], v[80:83], v[12:15]
    ds_read_b128 v[52:55], v1 offset:18432
    v_mfma_f32_16x16x32_bf16 v[28:31], v[56:59], v[84:87], v[28:31]
    s_waitcnt lgkmcnt(3)
    v_mfma_f32_16x16x32_bf16 v[16:19], v[60:63], v[80:83], v[16:19]
    ds_read_b128 v[56:59], v1 offset:38912
    v_mfma_f32_16x16x32_bf16 v[32:35], v[60:63], v[84:87], v[32:35]
    s_waitcnt lgkmcnt(3)
    v_mfma_f32_16x16x32_bf16 v[20:23], v[44:47], v[80:83], v[20:23]
    ds_read_b128 v[60:63], v6 offset:18432
    v_mfma_f32_16x16x32_bf16 v[36:39], v[44:47], v[84:87], v[36:39]
    s_waitcnt vmcnt(6)
    v_swap_b32 v90, v92
    v_swap_b32 v91, v93
    s_waitcnt lgkmcnt(3)
    v_mfma_f32_16x16x32_bf16 v[24:27], v[48:51], v[80:83], v[24:27]
    ds_read_b128 v[44:47], v6 offset:38912
    v_mfma_f32_16x16x32_bf16 v[40:43], v[48:51], v[84:87], v[40:43]
    s_waitcnt lgkmcnt(3)
    v_mfma_f32_16x16x32_bf16 v[12:15], v[52:55], v[88:91], v[12:15]
    ds_read_b128 v[48:51], v1 offset:19456
    v_mfma_f32_16x16x32_bf16 v[28:31], v[52:55], v[92:95], v[28:31]
    s_waitcnt lgkmcnt(3)
    v_mfma_f32_16x16x32_bf16 v[16:19], v[56:59], v[88:91], v[16:19]
    ds_read_b128 v[52:55], v1 offset:39936
    v_mfma_f32_16x16x32_bf16 v[32:35], v[56:59], v[92:95], v[32:35]
    s_waitcnt lgkmcnt(3)
    v_mfma_f32_16x16x32_bf16 v[20:23], v[60:63], v[88:91], v[20:23]
    ds_read_b128 v[56:59], v6 offset:19456
    v_mfma_f32_16x16x32_bf16 v[36:39], v[60:63], v[92:95], v[36:39]
    s_waitcnt vmcnt(4)
    v_swap_b32 v98, v100
    v_swap_b32 v99, v101
    s_waitcnt lgkmcnt(3)
    v_mfma_f32_16x16x32_bf16 v[24:27], v[44:47], v[88:91], v[24:27]
    ds_read_b128 v[60:63], v6 offset:39936
    v_mfma_f32_16x16x32_bf16 v[40:43], v[44:47], v[92:95], v[40:43]
    s_waitcnt lgkmcnt(3)
    v_mfma_f32_16x16x32_bf16 v[12:15], v[48:51], v[96:99], v[12:15]
    v_mfma_f32_16x16x32_bf16 v[28:31], v[48:51], v[100:103], v[28:31]
    s_waitcnt lgkmcnt(2)
    v_mfma_f32_16x16x32_bf16 v[16:19], v[52:55], v[96:99], v[16:19]
    v_mfma_f32_16x16x32_bf16 v[32:35], v[52:55], v[100:103], v[32:35]
    s_waitcnt lgkmcnt(1)
    v_mfma_f32_16x16x32_bf16 v[20:23], v[56:59], v[96:99], v[20:23]
    v_mfma_f32_16x16x32_bf16 v[36:39], v[56:59], v[100:103], v[36:39]
    s_waitcnt lgkmcnt(0)
    v_mfma_f32_16x16x32_bf16 v[24:27], v[60:63], v[96:99], v[24:27]
    v_mfma_f32_16x16x32_bf16 v[40:43], v[60:63], v[100:103], v[40:43]
    s_waitcnt vmcnt(3)
    v_lshlrev_b32 v8, 16, v104
    v_and_b32 v9, 0xffff0000, v104
    v_pk_add_f32 v[12:13], v[12:13], v[8:9]
    v_cvt_pk_bf16_f32 v104, v12, v13
    v_lshlrev_b32 v8, 16, v105
    v_and_b32 v9, 0xffff0000, v105
    v_pk_add_f32 v[14:15], v[14:15], v[8:9]
    v_cvt_pk_bf16_f32 v105, v14, v15
    v_lshlrev_b32 v8, 16, v106
    v_and_b32 v9, 0xffff0000, v106
    v_pk_add_f32 v[16:17], v[16:17], v[8:9]
    v_cvt_pk_bf16_f32 v106, v16, v17
    v_lshlrev_b32 v8, 16, v107
    v_and_b32 v9, 0xffff0000, v107
    v_pk_add_f32 v[18:19], v[18:19], v[8:9]
    v_cvt_pk_bf16_f32 v107, v18, v19
    s_waitcnt vmcnt(2)
    v_lshlrev_b32 v8, 16, v108
    v_and_b32 v9, 0xffff0000, v108
    v_pk_add_f32 v[20:21], v[20:21], v[8:9]
    v_cvt_pk_bf16_f32 v108, v20, v21
    v_lshlrev_b32 v8, 16, v109
    v_and_b32 v9, 0xffff0000, v109
    v_pk_add_f32 v[22:23], v[22:23], v[8:9]
    v_cvt_pk_bf16_f32 v109, v22, v23
    v_lshlrev_b32 v8, 16, v110
    v_and_b32 v9, 0xffff0000, v110
    v_pk_add_f32 v[24:25], v[24:25], v[8:9]
    v_cvt_pk_bf16_f32 v110, v24, v25
    v_lshlrev_b32 v8, 16, v111
    v_and_b32 v9, 0xffff0000, v111
    v_pk_add_f32 v[26:27], v[26:27], v[8:9]
    v_cvt_pk_bf16_f32 v111, v26, v27
    s_waitcnt vmcnt(1)
    v_lshlrev_b32 v8, 16, v112
    v_and_b32 v9, 0xffff0000, v112
    v_pk_add_f32 v[28:29], v[28:29], v[8:9]
    v_cvt_pk_bf16_f32 v112, v28, v29
    v_lshlrev_b32 v8, 16, v113
    v_and_b32 v9, 0xffff0000, v113
    v_pk_add_f32 v[30:31], v[30:31], v[8:9]
    v_cvt_pk_bf16_f32 v113, v30, v31
    v_lshlrev_b32 v8, 16, v114
    v_and_b32 v9, 0xffff0000, v114
    v_pk_add_f32 v[32:33], v[32:33], v[8:9]
    v_cvt_pk_bf16_f32 v114, v32, v33
    v_lshlrev_b32 v8, 16, v115
    v_and_b32 v9, 0xffff0000, v115
    v_pk_add_f32 v[34:35], v[34:35], v[8:9]
    v_cvt_pk_bf16_f32 v115, v34, v35
    s_waitcnt vmcnt(0)
    v_lshlrev_b32 v8, 16, v116
    v_and_b32 v9, 0xffff0000, v116
    v_pk_add_f32 v[36:37], v[36:37], v[8:9]
    v_cvt_pk_bf16_f32 v116, v36, v37
    v_lshlrev_b32 v8, 16, v117
    v_and_b32 v9, 0xffff0000, v117
    v_pk_add_f32 v[38:39], v[38:39], v[8:9]
    v_cvt_pk_bf16_f32 v117, v38, v39
    v_lshlrev_b32 v8, 16, v118
    v_and_b32 v9, 0xffff0000, v118
    v_pk_add_f32 v[40:41], v[40:41], v[8:9]
    v_cvt_pk_bf16_f32 v118, v40, v41
    v_lshlrev_b32 v8, 16, v119
    v_and_b32 v9, 0xffff0000, v119
    v_pk_add_f32 v[42:43], v[42:43], v[8:9]
    v_cvt_pk_bf16_f32 v119, v42, v43
    s_cmp_eq_u32 s101, 1
    s_cbranch_scc1 M_id_out
    v_lshlrev_b32 v12, 16, v104
    v_and_b32 v13, 0xffff0000, v104
    v_lshlrev_b32 v14, 16, v105
    v_and_b32 v15, 0xffff0000, v105
    v_lshlrev_b32 v16, 16, v106
    v_and_b32 v17, 0xffff0000, v106
    v_lshlrev_b32 v18, 16, v107
    v_and_b32 v19, 0xffff0000, v107
    v_lshlrev_b32 v20, 16, v108
    v_and_b32 v21, 0xffff0000, v108
    v_lshlrev_b32 v22, 16, v109
    v_and_b32 v23, 0xffff0000, v109
    v_lshlrev_b32 v24, 16, v110
    v_and_b32 v25, 0xffff0000, v110
    v_lshlrev_b32 v26, 16, v111
    v_and_b32 v27, 0xffff0000, v111
    v_lshlrev_b32 v28, 16, v112
    v_and_b32 v29, 0xffff0000, v112
    v_lshlrev_b32 v30, 16, v113
    v_and_b32 v31, 0xffff0000, v113
    v_lshlrev_b32 v32, 16, v114
    v_and_b32 v33, 0xffff0000, v114
    v_lshlrev_b32 v34, 16, v115
    v_and_b32 v35, 0xffff0000, v115
    v_lshlrev_b32 v36, 16, v116
    v_and_b32 v37, 0xffff0000, v116
    v_lshlrev_b32 v38, 16, v117
    v_and_b32 v39, 0xffff0000, v117
    v_lshlrev_b32 v40, 16, v118
    v_and_b32 v41, 0xffff0000, v118
    v_lshlrev_b32 v42, 16, v119
    v_and_b32 v43, 0xffff0000, v119
    v_pk_add_f32 v[124:125], v[12:13], v[14:15]
    v_pk_add_f32 v[128:129], v[28:29], v[30:31]
    v_pk_add_f32 v[124:125], v[124:125], v[16:17]
    v_pk_add_f32 v[128:129], v[128:129], v[32:33]
    v_pk_add_f32 v[124:125], v[124:125], v[18:19]
    v_pk_add_f32 v[128:129], v[128:129], v[34:35]
    v_pk_add_f32 v[124:125], v[124:125], v[20:21]
    v_pk_add_f32 v[128:129], v[128:129], v[36:37]
    v_pk_add_f32 v[124:125], v[124:125], v[22:23]
    v_pk_add_f32 v[128:129], v[128:129], v[38:39]
    v_pk_add_f32 v[124:125], v[124:125], v[24:25]
    v_pk_add_f32 v[128:129], v[128:129], v[40:41]
    v_pk_add_f32 v[124:125], v[124:125], v[26:27]
    v_pk_add_f32 v[128:129], v[128:129], v[42:43]
    v_add_f32 v124, v124, v125
    v_add_f32 v128, v128, v129
    v_mov_b32 v132, v124
    v_mov_b32 v133, v128
    s_nop 0
    v_permlane16_swap_b32 v124, v132
    v_permlane16_swap_b32 v128, v133
    v_add_f32 v124, v124, v132
    v_add_f32 v128, v128, v133
    v_mov_b32 v132, v124
    v_mov_b32 v133, v128
    s_nop 0
    v_permlane32_swap_b32 v124, v132
    v_permlane32_swap_b32 v128, v133
    v_add_f32 v124, v124, v132
    v_add_f32 v128, v128, v133
    v_mul_f32 v124, 0x3c800000, v124
    v_mov_b64 v[126:127], 0
    v_mul_f32 v128, 0x3c800000, v128
    v_mov_b64 v[130:131], 0
    v_pk_add_f32 v[8:9], v[12:13], v[124:125] op_sel_hi:[1,0] neg_lo:[0,1] neg_hi:[0,1]
    v_pk_add_f32 v[10:11], v[28:29], v[128:129] op_sel_hi:[1,0] neg_lo:[0,1] neg_hi:[0,1]
    v_pk_fma_f32 v[126:127], v[8:9], v[8:9], v[126:127]
    v_pk_fma_f32 v[130:131], v[10:11], v[10:11], v[130:131]
    v_pk_add_f32 v[8:9], v[14:15], v[124:125] op_sel_hi:[1,0] neg_lo:[0,1] neg_hi:[0,1]
    v_pk_add_f32 v[10:11], v[30:31], v[128:129] op_sel_hi:[1,0] neg_lo:[0,1] neg_hi:[0,1]
    v_pk_fma_f32 v[126:127], v[8:9], v[8:9], v[126:127]
    v_pk_fma_f32 v[130:131], v[10:11], v[10:11], v[130:131]
    v_pk_add_f32 v[8:9], v[16:17], v[124:125] op_sel_hi:[1,0] neg_lo:[0,1] neg_hi:[0,1]
    v_pk_add_f32 v[10:11], v[32:33], v[128:129] op_sel_hi:[1,0] neg_lo:[0,1] neg_hi:[0,1]
    v_pk_fma_f32 v[126:127], v[8:9], v[8:9], v[126:127]
    v_pk_fma_f32 v[130:131], v[10:11], v[10:11], v[130:131]
    v_pk_add_f32 v[8:9], v[18:19], v[124:125] op_sel_hi:[1,0] neg_lo:[0,1] neg_hi:[0,1]
    v_pk_add_f32 v[10:11], v[34:35], v[128:129] op_sel_hi:[1,0] neg_lo:[0,1] neg_hi:[0,1]
    v_pk_fma_f32 v[126:127], v[8:9], v[8:9], v[126:127]
    v_pk_fma_f32 v[130:131], v[10:11], v[10:11], v[130:131]
    v_pk_add_f32 v[8:9], v[20:21], v[124:125] op_sel_hi:[1,0] neg_lo:[0,1] neg_hi:[0,1]
    v_pk_add_f32 v[10:11], v[36:37], v[128:129] op_sel_hi:[1,0] neg_lo:[0,1] neg_hi:[0,1]
    v_pk_fma_f32 v[126:127], v[8:9], v[8:9], v[126:127]
    v_pk_fma_f32 v[130:131], v[10:11], v[10:11], v[130:131]
    v_pk_add_f32 v[8:9], v[22:23], v[124:125] op_sel_hi:[1,0] neg_lo:[0,1] neg_hi:[0,1]
    v_pk_add_f32 v[10:11], v[38:39], v[128:129] op_sel_hi:[1,0] neg_lo:[0,1] neg_hi:[0,1]
    v_pk_fma_f32 v[126:127], v[8:9], v[8:9], v[126:127]
    v_pk_fma_f32 v[130:131], v[10:11], v[10:11], v[130:131]
    v_pk_add_f32 v[8:9], v[24:25], v[124:125] op_sel_hi:[1,0] neg_lo:[0,1] neg_hi:[0,1]
    v_pk_add_f32 v[10:11], v[40:41], v[128:129] op_sel_hi:[1,0] neg_lo:[0,1] neg_hi:[0,1]
    v_pk_fma_f32 v[126:127], v[8:9], v[8:9], v[126:127]
    v_pk_fma_f32 v[130:131], v[10:11], v[10:11], v[130:131]
    v_pk_add_f32 v[8:9], v[26:27], v[124:125] op_sel_hi:[1,0] neg_lo:[0,1] neg_hi:[0,1]
    v_pk_add_f32 v[10:11], v[42:43], v[128:129] op_sel_hi:[1,0] neg_lo:[0,1] neg_hi:[0,1]
    v_pk_fma_f32 v[126:127], v[8:9], v[8:9], v[126:127]
    v_pk_fma_f32 v[130:131], v[10:11], v[10:11], v[130:131]
    v_add_f32 v125, v126, v127
    v_add_f32 v129, v130, v131
    v_mov_b32 v132, v125
    v_mov_b32 v133, v129
    s_nop 0
    v_permlane16_swap_b32 v125, v132
    v_permlane16_swap_b32 v129, v133
    v_add_f32 v125, v125, v132
    v_add_f32 v129, v129, v133
    v_mov_b32 v132, v125
    v_mov_b32 v133, v129
    s_nop 0
    v_permlane32_swap_b32 v125, v132
    v_permlane32_swap_b32 v129, v133
    v_add_f32 v125, v125, v132
    v_add_f32 v129, v129, v133
    v_min_u32 v124, -2, v124
    v_min_u32 v125, -2, v125
    v_min_u32 v128, -2, v128
    v_min_u32 v129, -2, v129
    s_lshl_b32 s24, s89, 12
    s_add_u32 s24, s24, 173654016
    s_lshl_b32 s25, s88, 3
    s_add_u32 s25, s25, s24
    v_lshlrev_b32 v7, 7, v4
    v_lshl_add_u32 v2, v3, 5, v7
    s_mov_b64 exec, 0xffff
    s_cmp_lg_u32 s23, 0
    s_cbranch_scc1 M_ls_43
    buffer_store_dwordx2 v[124:125], v7, s[8:11], s25 offen offset:0
    buffer_store_dwordx2 v[128:129], v7, s[8:11], s25 offen offset:2048
M_ls_43_r:
    s_mov_b64 exec, -1
    v_cmp_gt_u32_e64 s[36:37], 3, v3
    v_cmp_gt_u32_e64 s[38:39], 2, v3
    s_mov_b32 s34, 0
M_id_poll:
    buffer_load_dwordx4 v[136:139], v2, s[8:11], s24 offen offset:0 sc1
    buffer_load_dwordx4 v[140:143], v2, s[8:11], s24 offen offset:16 sc1
    buffer_load_dwordx4 v[144:147], v2, s[8:11], s24 offen offset:2048 sc1
    buffer_load_dwordx4 v[148:151], v2, s[8:11], s24 offen offset:2064 sc1
    s_add_u32 s34, s34, 1
    s_cmp_ge_u32 s34, 60000
    s_cbranch_scc1 M_fail
    s_waitcnt vmcnt(3)
    v_cndmask_b32_e64 v136, 0, v136, s[36:37]
    v_cndmask_b32_e64 v137, 0, v137, s[36:37]
    v_cndmask_b32_e64 v138, 0, v138, s[36:37]
    v_cndmask_b32_e64 v139, 0, v139, s[36:37]
    s_waitcnt vmcnt(2)
    v_cndmask_b32_e64 v140, 0, v140, s[38:39]
    v_cndmask_b32_e64 v141, 0, v141, s[38:39]
    v_cndmask_b32_e64 v142, 0, v142, s[38:39]
    v_cndmask_b32_e64 v143, 0, v143, s[38:39]
    s_waitcnt vmcnt(1)
    v_cndmask_b32_e64 v144, 0, v144, s[36:37]
    v_cndmask_b32_e64 v145, 0, v145, s[36:37]
    v_cndmask_b32_e64 v146, 0, v146, s[36:37]
    v_cndmask_b32_e64 v147, 0, v147, s[36:37]
    s_waitcnt vmcnt(0)
    v_cndmask_b32_e64 v148, 0, v148, s[38:39]
    v_cndmask_b32_e64 v149, 0, v149, s[38:39]
    v_cndmask_b32_e64 v150, 0, v150, s[38:39]
    v_cndmask_b32_e64 v151, 0, v151, s[38:39]
    v_max3_u32 v8, v136, v137, v138
    v_max3_u32 v8, v8, v139, v140
    v_max3_u32 v8, v8, v141, v142
    v_max3_u32 v8, v8, v143, v144
    v_max3_u32 v8, v8, v145, v146
    v_max3_u32 v8, v8, v147, v148
    v_max3_u32 v8, v8, v149, v150
    v_max_u32 v8, v8, v151
    v_cmp_eq_u32 vcc, -1, v8
    s_cbranch_vccnz M_id_poll
    v_add_f32 v124, v136, v138
    v_add_f32 v125, v140, v142
    v_add_f32 v124, v124, v125
    v_add_f32 v128, v144, v146
    v_add_f32 v129, v148, v150
    v_add_f32 v128, v128, v129
    v_mov_b32 v132, v124
    v_mov_b32 v133, v128
    s_nop 0
    v_permlane16_swap_b32 v124, v132
    v_permlane16_swap_b32 v128, v133
    v_add_f32 v124, v124, v132
    v_add_f32 v128, v128, v133
    v_mov_b32 v132, v124
    v_mov_b32 v133, v128
    s_nop 0
    v_permlane32_swap_b32 v124, v132
    v_permlane32_swap_b32 v128, v133
    v_add_f32 v124, v124, v132
    v_add_f32 v128, v128, v133
    v_mul_f32 v124, 0x3dcccccd, v124
    v_add_f32 v125, v137, v139
    v_add_f32 v126, v141, v143
    v_add_f32 v125, v125, v126
    v_sub_f32 v8, v136, v124
    v_cndmask_b32_e64 v8, 0, v8, s[36:37]
    v_mul_f32 v9, 0x42800000, v8
    v_fmac_f32 v125, v8, v9
    v_sub_f32 v8, v138, v124
    v_cndmask_b32_e64 v8, 0, v8, s[36:37]
    v_mul_f32 v9, 0x42800000, v8
    v_fmac_f32 v125, v8, v9
    v_sub_f32 v8, v140, v124
    v_cndmask_b32_e64 v8, 0, v8, s[38:39]
    v_mul_f32 v9, 0x42800000, v8
    v_fmac_f32 v125, v8, v9
    v_sub_f32 v8, v142, v124
    v_cndmask_b32_e64 v8, 0, v8, s[38:39]
    v_mul_f32 v9, 0x42800000, v8
    v_fmac_f32 v125, v8, v9
    v_mul_f32 v128, 0x3dcccccd, v128
    v_add_f32 v129, v145, v147
    v_add_f32 v130, v149, v151
    v_add_f32 v129, v129, v130
    v_sub_f32 v8, v144, v128
    v_cndmask_b32_e64 v8, 0, v8, s[36:37]
    v_mul_f32 v9, 0x42800000, v8
    v_fmac_f32 v129, v8, v9
    v_sub_f32 v8, v146, v128
    v_cndmask_b32_e64 v8, 0, v8, s[36:37]
    v_mul_f32 v9, 0x42800000, v8
    v_fmac_f32 v129, v8, v9
    v_sub_f32 v8, v148, v128
    v_cndmask_b32_e64 v8, 0, v8, s[38:39]
    v_mul_f32 v9, 0x42800000, v8
    v_fmac_f32 v129, v8, v9
    v_sub_f32 v8, v150, v128
    v_cndmask_b32_e64 v8, 0, v8, s[38:39]
    v_mul_f32 v9, 0x42800000, v8
    v_fmac_f32 v129, v8, v9
    v_mov_b32 v132, v125
    v_mov_b32 v133, v129
    s_nop 0
    v_permlane16_swap_b32 v125, v132
    v_permlane16_swap_b32 v129, v133
    v_add_f32 v125, v125, v132
    v_add_f32 v129, v129, v133
    v_mov_b32 v132, v125
    v_mov_b32 v133, v129
    s_nop 0
    v_permlane32_swap_b32 v125, v132
    v_permlane32_swap_b32 v129, v133
    v_add_f32 v125, v125, v132
    v_add_f32 v129, v129, v133
    v_mov_b32 v126, 0x3727c5ac
    v_fmac_f32 v126, 0x3acccccd, v125
    v_rsq_f32 v126, v126
    v_mov_b32 v130, 0x3727c5ac
    v_fmac_f32 v130, 0x3acccccd, v129
    v_rsq_f32 v130, v130
    s_lshl_b32 s25, s88, 11
    s_add_u32 s25, s25, s29
    s_add_u32 s25, s25, 32505856
    s_add_u32 s24, s25, 20480
    v_pk_add_f32 v[12:13], v[12:13], v[124:125] op_sel_hi:[1,0] neg_lo:[0,1] neg_hi:[0,1]
    v_pk_add_f32 v[14:15], v[14:15], v[124:125] op_sel_hi:[1,0] neg_lo:[0,1] neg_hi:[0,1]
    v_pk_add_f32 v[16:17], v[16:17], v[124:125] op_sel_hi:[1,0] neg_lo:[0,1] neg_hi:[0,1]
    v_pk_add_f32 v[18:19], v[18:19], v[124:125] op_sel_hi:[1,0] neg_lo:[0,1] neg_hi:[0,1]
    v_pk_add_f32 v[20:21], v[20:21], v[124:125] op_sel_hi:[1,0] neg_lo:[0,1] neg_hi:[0,1]
    v_pk_add_f32 v[22:23], v[22:23], v[124:125] op_sel_hi:[1,0] neg_lo:[0,1] neg_hi:[0,1]
    v_pk_add_f32 v[24:25], v[24:25], v[124:125] op_sel_hi:[1,0] neg_lo:[0,1] neg_hi:[0,1]
    v_pk_add_f32 v[26:27], v[26:27], v[124:125] op_sel_hi:[1,0] neg_lo:[0,1] neg_hi:[0,1]
    v_pk_mul_f32 v[12:13], v[12:13], v[126:127] op_sel_hi:[1,0]
    v_pk_mul_f32 v[14:15], v[14:15], v[126:127] op_sel_hi:[1,0]
    v_pk_mul_f32 v[16:17], v[16:17], v[126:127] op_sel_hi:[1,0]
    v_pk_mul_f32 v[18:19], v[18:19], v[126:127] op_sel_hi:[1,0]
    v_pk_mul_f32 v[20:21], v[20:21], v[126:127] op_sel_hi:[1,0]
    v_pk_mul_f32 v[22:23], v[22:23], v[126:127] op_sel_hi:[1,0]
    v_pk_mul_f32 v[24:25], v[24:25], v[126:127] op_sel_hi:[1,0]
    v_pk_mul_f32 v[26:27], v[26:27], v[126:127] op_sel_hi:[1,0]
    v_cvt_pk_bf16_f32 v12, v12, v13
    v_cvt_pk_bf16_f32 v13, v14, v15
    v_cvt_pk_bf16_f32 v14, v16, v17
    v_cvt_pk_bf16_f32 v15, v18, v19
    v_cvt_pk_bf16_f32 v16, v20, v21
    v_cvt_pk_bf16_f32 v17, v22, v23
    v_cvt_pk_bf16_f32 v18, v24, v25
    v_cvt_pk_bf16_f32 v19, v26, v27
    v_pk_add_f32 v[28:29], v[28:29], v[128:129] op_sel_hi:[1,0] neg_lo:[0,1] neg_hi:[0,1]
    v_pk_add_f32 v[30:31], v[30:31], v[128:129] op_sel_hi:[1,0] neg_lo:[0,1] neg_hi:[0,1]
    v_pk_add_f32 v[32:33], v[32:33], v[128:129] op_sel_hi:[1,0] neg_lo:[0,1] neg_hi:[0,1]
    v_pk_add_f32 v[34:35], v[34:35], v[128:129] op_sel_hi:[1,0] neg_lo:[0,1] neg_hi:[0,1]
    v_pk_add_f32 v[36:37], v[36:37], v[128:129] op_sel_hi:[1,0] neg_lo:[0,1] neg_hi:[0,1]
    v_pk_add_f32 v[38:39], v[38:39], v[128:129] op_sel_hi:[1,0] neg_lo:[0,1] neg_hi:[0,1]
    v_pk_add_f32 v[40:41], v[40:41], v[128:129] op_sel_hi:[1,0] neg_lo:[0,1] neg_hi:[0,1]
    v_pk_add_f32 v[42:43], v[42:43], v[128:129] op_sel_hi:[1,0] neg_lo:[0,1] neg_hi:[0,1]
    v_pk_mul_f32 v[28:29], v[28:29], v[130:131] op_sel_hi:[1,0]
    v_pk_mul_f32 v[30:31], v[30:31], v[130:131] op_sel_hi:[1,0]
    v_pk_mul_f32 v[32:33], v[32:33], v[130:131] op_sel_hi:[1,0]
    v_pk_mul_f32 v[34:35], v[34:35], v[130:131] op_sel_hi:[1,0]
    v_pk_mul_f32 v[36:37], v[36:37], v[130:131] op_sel_hi:[1,0]
    v_pk_mul_f32 v[38:39], v[38:39], v[130:131] op_sel_hi:[1,0]
    v_pk_mul_f32 v[40:41], v[40:41], v[130:131] op_sel_hi:[1,0]
    v_pk_mul_f32 v[42:43], v[42:43], v[130:131] op_sel_hi:[1,0]
    v_cvt_pk_bf16_f32 v28, v28, v29
    v_cvt_pk_bf16_f32 v29, v30, v31
    v_cvt_pk_bf16_f32 v30, v32, v33
    v_cvt_pk_bf16_f32 v31, v34, v35
    v_cvt_pk_bf16_f32 v32, v36, v37
    v_cvt_pk_bf16_f32 v33, v38, v39
    v_cvt_pk_bf16_f32 v34, v40, v41
    v_cvt_pk_bf16_f32 v35, v42, v43
    s_cmp_lg_u32 s82, 0
    s_cbranch_scc1 M_id_nl
    s_add_u32 s34, s25, 76546048
    s_add_u32 s35, s34, 20480
    s_cmp_lg_u32 s23, 0
    s_cbranch_scc1 M_ls_44
    buffer_store_dwordx4 v[12:15], v1, s[8:11], s34 offen offset:0
    buffer_store_dwordx4 v[16:19], v1, s[8:11], s34 offen offset:1024
    buffer_store_dwordx4 v[28:31], v1, s[8:11], s35 offen offset:0
    buffer_store_dwordx4 v[32:35], v1, s[8:11], s35 offen offset:1024
M_ls_44_r:
    s_mul_i32 s34, s89, 10
    s_add_u32 s34, s34, s88
    s_add_u32 s34, s34, 167956480
    v_mov_b32 v8, 1
    s_waitcnt vmcnt(0)
    s_mov_b64 exec, 1
    s_cmp_lg_u32 s23, 0
    s_cbranch_scc1 M_ls_45
    buffer_store_byte v8, v1, s[8:11], s34 offen
M_ls_45_r:
    s_mov_b64 exec, -1
    s_mov_b32 s68, s25
    s_mov_b32 s69, s24
    s_mov_b32 s70, s30
    s_mov_b32 s71, s33
    s_branch M_noid
M_id_nl:
    buffer_store_dwordx4 v[12:15], v1, s[8:11], s25 offen offset:0 sc1
    buffer_store_dwordx4 v[16:19], v1, s[8:11], s25 offen offset:1024 sc1
    buffer_store_dwordx4 v[28:31], v1, s[8:11], s24 offen offset:0 sc1
    buffer_store_dwordx4 v[32:35], v1, s[8:11], s24 offen offset:1024 sc1
M_id_out:
    buffer_store_dwordx4 v[104:107], v5, s[16:19], s30 offen offset:0 sc1
    buffer_store_dwordx4 v[108:111], v5, s[16:19], s30 offen offset:64 sc1
    buffer_store_dwordx4 v[112:115], v5, s[16:19], s33 offen offset:0 sc1
    buffer_store_dwordx4 v[116:119], v5, s[16:19], s33 offen offset:64 sc1
    s_cmp_eq_u32 s101, 1
    s_cbranch_scc1 M_end
    s_lshl_b32 s24, s89, 7
    s_lshl_b32 s25, s88, 2
    s_add_u32 s24, s24, s25
    s_add_u32 s24, s24, 167919616
    v_mov_b32 v8, 1
    s_waitcnt vmcnt(0)
    s_mov_b64 exec, 1
    buffer_store_dword v8, v1, s[8:11], s24 offen sc1
    s_mov_b64 exec, -1
M_noid:
    s_add_u32 s20, s82, 2
    s_mov_b32 s21, s83
    s_mov_b32 s22, s84
    s_mov_b32 s23, s85
    s_cmp_eq_u32 s101, 1
    s_cbranch_scc1 M_end
    s_mov_b32 s101, 1
    v_mbcnt_lo_u32_b32 v0, -1, 0
    v_mbcnt_hi_u32_b32 v0, -1, v0
    v_lshlrev_b32 v0, 4, v0
    s_waitcnt lgkmcnt(0)
    s_barrier
    s_branch M_bulk
M_ls_5:
    s_nop 7
    buffer_store_byte v85, v84, s[8:11], s28 offen sc1
    s_branch M_ls_5_r
M_ls_17:
    s_nop 7
    buffer_store_byte v11, v10, s[8:11], s62 offen sc1
    s_branch M_ls_17_r
M_ls_20:
    s_nop 7
    buffer_store_dwordx4 v[56:59], v4, s[8:11], s27 offen sc1
    buffer_store_dwordx4 v[60:63], v4, s[8:11], s28 offen sc1
    buffer_store_dword v96, v1, s[8:11], s27 offen offset:256 sc1
    buffer_store_dword v97, v1, s[8:11], s28 offen offset:256 sc1
    s_branch M_ls_20_r
M_ls_21:
    s_nop 7
    buffer_store_dwordx4 v[56:59], v4, s[8:11], s27 offen sc1
    buffer_store_dwordx4 v[60:63], v4, s[8:11], s28 offen sc1
    buffer_store_dword v98, v1, s[8:11], s27 offen offset:256 sc1
    buffer_store_dword v99, v1, s[8:11], s28 offen offset:256 sc1
    s_branch M_ls_21_r
M_ls_22:
    s_nop 7
    buffer_store_dwordx4 v[56:59], v4, s[8:11], s27 offen sc1
    buffer_store_dwordx4 v[60:63], v4, s[8:11], s28 offen sc1
    buffer_store_dword v136, v1, s[8:11], s27 offen offset:256 sc1
    buffer_store_dword v137, v1, s[8:11], s28 offen offset:256 sc1
    s_branch M_ls_22_r
M_ls_23:
    s_nop 7
    buffer_store_dwordx4 v[56:59], v4, s[8:11], s27 offen sc1
    buffer_store_dwordx4 v[60:63], v4, s[8:11], s28 offen sc1
    buffer_store_dword v138, v1, s[8:11], s27 offen offset:256 sc1
    buffer_store_dword v139, v1, s[8:11], s28 offen offset:256 sc1
    s_branch M_ls_23_r
M_ls_24:
    s_nop 7
    buffer_store_byte v11, v10, s[8:11], s62 offen sc1
    s_branch M_ls_24_r
M_ls_27:
    s_nop 7
    s_mov_b32 exec_hi, 0
    buffer_store_dwordx2 v[72:73], v12, s[8:11], s63 offen sc1
    s_mov_b32 exec_lo, 0x000f000f
    buffer_store_dwordx2 v[74:75], v12, s[8:11], s64 offen sc1
    s_mov_b64 exec, -1
    s_branch M_ls_27_r
M_ls_28:
    s_nop 7
    buffer_store_byte v11, v10, s[8:11], s62 offen sc1
    s_branch M_ls_28_r
M_ls_40:
    s_nop 7
    buffer_store_byte v191, v190, s[8:11], s28 offen sc1
    s_branch M_ls_40_r
M_ls_43:
    s_nop 7
    buffer_store_dwordx2 v[124:125], v7, s[8:11], s25 offen offset:0 sc1
    buffer_store_dwordx2 v[128:129], v7, s[8:11], s25 offen offset:2048 sc1
    s_branch M_ls_43_r
M_ls_44:
    s_nop 7
    buffer_store_dwordx4 v[12:15], v1, s[8:11], s34 offen offset:0 sc1
    buffer_store_dwordx4 v[16:19], v1, s[8:11], s34 offen offset:1024 sc1
    buffer_store_dwordx4 v[28:31], v1, s[8:11], s35 offen offset:0 sc1
    buffer_store_dwordx4 v[32:35], v1, s[8:11], s35 offen offset:1024 sc1
    s_branch M_ls_44_r
M_ls_45:
    s_nop 7
    buffer_store_byte v8, v1, s[8:11], s34 offen sc1
    s_branch M_ls_45_r
M_fail:
    s_mov_b64 exec, 1
    v_mov_b32 v12, 1
    v_mov_b32 v13, 48
    buffer_atomic_add v12, v13, s[12:15], 0 offen
M_end:
    s_endpgm

.section .rodata,"a"
.p2align 6
.amdhsa_kernel interleave_layers__memory_aug_recurrent_mem_tr__spectral_gfnet__prompt_kernel
  .amdhsa_next_free_vgpr 512
  .amdhsa_next_free_sgpr 102
  .amdhsa_accum_offset 256
  .amdhsa_group_segment_fixed_size 0
  .amdhsa_kernarg_size 104
  .amdhsa_user_sgpr_count 2
  .amdhsa_user_sgpr_kernarg_segment_ptr 1
  .amdhsa_system_sgpr_workgroup_id_x 1
  .amdhsa_float_denorm_mode_32 3
  .amdhsa_float_denorm_mode_16_64 3
.end_amdhsa_kernel
```
